```python
import torch

def _softmax(x, axis=-1):
    return torch.softmax(x, dim=axis)
def _gelu(x):
    return torch.nn.functional.gelu(x, approximate="tanh")
def _silu(x):
    return torch.nn.functional.silu(x)
def _sigmoid(x):
    return torch.sigmoid(x)
def _layernorm(x, axis=-1, eps=1e-5):
    m = x.mean(dim=axis, keepdim=True)
    v = x.var(dim=axis, keepdim=True, unbiased=False)
    return (x - m) / torch.sqrt(v + eps)
def _scatter_add(tgt, idx, src, axis=0):
    return tgt.clone().index_add_(axis, idx, src)
def _segment_sum(src, seg, n):
    out = torch.zeros((n,) + src.shape[1:], dtype=src.dtype)
    return out.index_add_(0, seg, src)
def _pad(x, pw):
    flat = tuple(v for pair in reversed(pw) for v in pair)
    return torch.nn.functional.pad(x, flat)

kernel_name = 'gated_mix__ssm_conv_s5__ssm_conv_h3__prompt'

def setup_inputs():

    _w = (lambda a: (lambda t: t.to(torch.bfloat16) if t.is_floating_point() else t)(torch.as_tensor(a)))
    def _A_setup():
        B, S, D = 1, 2048, 1024
        P = D
        Lambda_re = -0.5 * (lambda _x: torch.exp(torch.as_tensor(_x)))((lambda *s: torch.randn(*s, dtype=torch.bfloat16) * 0.2)(P))
        Lambda_im = (lambda *s: torch.randn(*s, dtype=torch.bfloat16) * 0.4)(P) * 1.0
        B_re = (lambda *s: torch.randn(*s, dtype=torch.bfloat16) * 0.2)(P, D) * (D ** -0.5)
        B_im = (lambda *s: torch.randn(*s, dtype=torch.bfloat16) * 0.2)(P, D) * (D ** -0.5)
        C_re = (lambda *s: torch.randn(*s, dtype=torch.bfloat16) * 0.2)(D, P) * (P ** -0.5)
        C_im = (lambda *s: torch.randn(*s, dtype=torch.bfloat16) * 0.2)(D, P) * (P ** -0.5)
        log_dt = (lambda *s: torch.randn(*s, dtype=torch.bfloat16) * 0.2)(P) * 0.3 - 2.0
        Dskip = (lambda *s: torch.randn(*s, dtype=torch.bfloat16) * 0.05)(D)
        return {
            "x": _w((lambda *s: torch.randn(*s, dtype=torch.bfloat16) * 0.05)(B, S, D)),
            "Lambda_re": _w(Lambda_re),
            "Lambda_im": _w(Lambda_im),
            "B_re": _w(B_re),
            "B_im": _w(B_im),
            "C_re": _w(C_re),
            "C_im": _w(C_im),
            "log_dt": _w(log_dt),
            "Dskip": _w(Dskip),
        }
    _A_in = _A_setup()

    def _B_setup():
        B, S, D = 1, 2048, 1024
        ks = 4
        return {
            "q": _w((lambda *s: torch.randn(*s, dtype=torch.bfloat16) * 0.05)(B, S, D)),
            "k": _w((lambda *s: torch.randn(*s, dtype=torch.bfloat16) * 0.4)(B, S, D)),
            "v": _w((lambda *s: torch.randn(*s, dtype=torch.bfloat16) * 0.2)(B, S, D)),
            "shift_k": _w((lambda *s: torch.randn(*s, dtype=torch.bfloat16) * 0.4)(D, ks) * 0.5),
            "ssm_k": _w((lambda *s: torch.randn(*s, dtype=torch.bfloat16) * 0.4)(D, S) * (1.0 / S ** 0.5)),
            "ssm_D": _w((lambda *s: torch.randn(*s, dtype=torch.bfloat16) * 0.2)(D)),
        }
    _B_in = _B_setup()

    return {
        "A_x": _A_in["x"],
        "A_Lambda_re": _A_in["Lambda_re"],
        "A_Lambda_im": _A_in["Lambda_im"],
        "A_B_re": _A_in["B_re"],
        "A_B_im": _A_in["B_im"],
        "A_C_re": _A_in["C_re"],
        "A_C_im": _A_in["C_im"],
        "A_log_dt": _A_in["log_dt"],
        "A_Dskip": _A_in["Dskip"],
        "B_q": _B_in["q"],
        "B_k": _B_in["k"],
        "B_v": _B_in["v"],
        "B_shift_k": _B_in["shift_k"],
        "B_ssm_k": _B_in["ssm_k"],
        "B_ssm_D": _B_in["ssm_D"],
        "gate_w": _w((lambda *s: torch.randn(*s, dtype=torch.bfloat16) * 0.05)(1024) * 16.0),
    }

def reference(A_x, A_Lambda_re, A_Lambda_im, A_B_re, A_B_im, A_C_re, A_C_im, A_log_dt, A_Dskip, B_q, B_k, B_v, B_shift_k, B_ssm_k, B_ssm_D, gate_w):
    def _A_ref(x, Lambda_re, Lambda_im, B_re, B_im, C_re, C_im, log_dt, Dskip):
        Bsz, L, H = x.shape
        Lam = Lambda_re + 1j * Lambda_im
        Bmat = B_re + 1j * B_im
        Cmat = C_re + 1j * C_im
        dt = torch.exp(log_dt)
        Lam_bar = torch.exp(dt * Lam)
        B_bar = ((Lam_bar - 1.0) / Lam)[:, None] * Bmat
        Bu = torch.einsum("bld,pd->blp", x + 0j, B_bar)
        h = torch.zeros_like(Bu[:, 0, :])
        hs = []
        for t in range(L):
            h = Lam_bar[None, :] * h + Bu[:, t, :]
            hs.append(h)
        hseq = torch.stack(hs, 1)
        y = 2.0 * torch.einsum("blp,dp->bld", hseq, Cmat).real + x * Dskip[None, None, :]
        return y

    def _B_ref(q, k, v, shift_k, ssm_k, ssm_D):
        B, S, D = q.shape
        ks = shift_k.shape[-1]
        k_pad = _pad(k, ((0, 0), (ks - 1, 0), (0, 0)))
        k_shift = torch.zeros_like(k)
        for t in range(ks):
            k_shift = k_shift + k_pad[:, t:t + S, :] * shift_k[:, ks - 1 - t][None, None, :]
        kv = k_shift * v
        L = 2 * S
        kv_pad = _pad(kv, ((0, 0), (0, S), (0, 0)))
        kf_pad = _pad(ssm_k, ((0, 0), (0, S)))
        kv_f = (lambda x, axes=(-2,-1): torch.fft.rfft2(x.float(), dim=axes))(kv_pad[:, None, :, :], axes=(1, 2))
        kf_f = (lambda x, axes=(-2,-1): torch.fft.rfft2(x.float(), dim=axes))(kf_pad[:, None, :], axes=(1, 2))
        kf_f = (lambda x, *d: x.permute(*d))(kf_f, 1, 2, 0)
        y_f = kv_f * kf_f[None, :, :, :]
        y = (lambda x, s, axes=(-2,-1): torch.fft.irfft2(x, s=s, dim=axes).to(torch.bfloat16))(y_f, (1, L), axes=(1, 2))[:, 0, :S, :]
        y = y + kv * ssm_D[None, None, :]
        return q * y

    x = A_x
    g = _sigmoid((x * gate_w).sum(-1, keepdims=True))
    a = _A_ref(x, A_Lambda_re, A_Lambda_im, A_B_re, A_B_im, A_C_re, A_C_im, A_log_dt, A_Dskip)
    b = _B_ref(x, B_k, B_v, B_shift_k, B_ssm_k, B_ssm_D)
    return g * a + (1 - g) * b
```

```asm
; @launch grid=(256,1,1) block=(512,1,1) lds=163840
.amdgcn_target "amdgcn-amd-amdhsa--gfx950"
.text
.globl gated_mix__ssm_conv_s5__ssm_conv_h3__prompt_kernel
.p2align 8
.type gated_mix__ssm_conv_s5__ssm_conv_h3__prompt_kernel,@function
gated_mix__ssm_conv_s5__ssm_conv_h3__prompt_kernel:
    s_cmp_ge_u32 s2, 256
    s_cbranch_scc1 L_end
    s_load_dwordx16 s[16:31], s[0:1], 0
    s_load_dwordx16 s[32:47], s[0:1], 64
    s_load_dwordx4 s[48:51], s[0:1], 128
    s_load_dwordx2 s[52:53], s[0:1], 144
    s_and_b32 s54, s2, 7
    s_lshr_b32 s55, s2, 3
    s_lshr_b32 s4, s54, 1
    s_lshl_b32 s4, s4, 2
    s_and_b32 s6, s55, 3
    s_add_u32 s4, s4, s6
    s_and_b32 s5, s54, 1
    s_lshl_b32 s5, s5, 3
    s_lshr_b32 s6, s55, 2
    s_add_u32 s5, s5, s6
    v_and_b32 v1, 63, v0
    v_lshrrev_b32 v2, 6, v0
    s_and_b32 s15, s5, 7
    v_readfirstlane_b32 s3, v2
    s_nop 1
    s_cmp_ge_u32 s3, 4
    s_cbranch_scc0 L_consumer
    s_sub_u32 s3, s3, 4
    s_lshr_b32 s6, s3, 1
    s_and_b32 s7, s3, 1
    v_lshrrev_b32 v3, 5, v1
    v_lshlrev_b32 v3, 5, v3
    v_bfe_u32 v4, v1, 3, 1
    v_lshl_add_u32 v3, v4, 4, v3
    v_bfe_u32 v4, v1, 4, 1
    v_add_u32 v3, v3, v4
    s_lshl_b32 s8, s4, 7
    s_lshl_b32 s9, s6, 6
    s_add_u32 s8, s8, s9
    s_lshl_b32 s9, s7, 3
    s_add_u32 s8, s8, s9
    v_add_u32 v3, s8, v3
    v_lshlrev_b32 v3, 11, v3
    v_and_b32 v4, 7, v1
    v_lshrrev_b32 v5, 4, v1
    v_xor_b32 v4, v4, v5
    v_lshlrev_b32 v4, 4, v4
    v_xor_b32 v5, 64, v4
    s_lshl_b32 s8, s5, 6
    s_lshl_b32 s9, s7, 5
    s_add_u32 s8, s8, s9
    v_lshrrev_b32 v6, 3, v1
    v_add_u32 v7, s8, v6
    v_lshlrev_b32 v7, 11, v7
    v_add_u32 v8, v3, v4
    v_add_u32 v12, v7, v4
    v_add_u32 v9, v3, v5
    v_add_u32 v13, v7, v5
    v_add_u32 v9, 3072, v9
    v_add_u32 v13, 15360, v13
    v_add_u32 v10, v3, v4
    v_add_u32 v14, v7, v4
    v_add_u32 v10, 6144, v10
    v_add_u32 v14, 30720, v14
    v_add_u32 v11, v3, v5
    v_add_u32 v15, v7, v5
    v_add_u32 v11, 9216, v11
    v_add_u32 v15, 46080, v15
    s_lshl_b32 s10, s3, 12
    s_lshr_b32 s90, s55, 2
    s_lshl_b32 s90, s90, 1
    s_and_b32 s91, s55, 3
    s_lshl_b32 s91, s91, 2
    s_add_u32 s90, s90, s91
    s_waitcnt lgkmcnt(0)
    s_mov_b32 s56, s16
    s_mov_b32 s57, s17
    s_mov_b32 s58, 0x400000
    s_mov_b32 s59, 0x20000
    s_cmp_ge_u32 s3, 2
    s_cselect_b32 s60, s24, s22
    s_cselect_b32 s61, s25, s23
    s_mov_b32 s62, 0x200000
    s_mov_b32 s63, 0x20000
    s_add_u32 s11, s90, 0
    s_and_b32 s11, s11, 15
    s_lshl_b32 s11, s11, 7
    s_add_u32 m0, s10, 0x0
    s_nop 0
    buffer_load_dwordx4 v8, s[56:59], s11 offen offset:0 lds
    buffer_load_dwordx4 v9, s[56:59], s11 offen offset:1024 lds
    buffer_load_dwordx4 v10, s[56:59], s11 offen offset:2048 lds
    buffer_load_dwordx4 v11, s[56:59], s11 offen offset:3072 lds
    s_add_u32 m0, s10, 0x4000
    s_nop 0
    buffer_load_dwordx4 v12, s[60:63], s11 offen offset:0 lds
    buffer_load_dwordx4 v13, s[60:63], s11 offen offset:1024 lds
    buffer_load_dwordx4 v14, s[60:63], s11 offen offset:2048 lds
    buffer_load_dwordx4 v15, s[60:63], s11 offen offset:3072 lds
    s_and_b32 s8, s5, 7
    s_lshl_b32 s8, s8, 6
    s_lshl_b32 s9, s3, 4
    s_add_u32 s8, s8, s9
    v_add_u32 v7, s8, v6
    v_lshlrev_b32 v7, 11, v7
    v_add_u32 v28, v7, v4
    v_add_u32 v29, v7, v5
    v_add_u32 v29, 15360, v29
    s_and_b32 s12, s55, 1
    s_lshl_b32 s13, s54, 1
    s_add_u32 s12, s12, s13
    s_lshr_b32 s13, s55, 1
    s_lshl_b32 s8, s2, 7
    s_add_u32 s8, s8, 0x20000
    v_mov_b32 v30, s8
    s_lshl_b32 s88, s54, 5
    s_add_u32 s88, s88, s55
    s_lshl_b32 s8, s88, 7
    s_add_u32 s8, s8, 0x28000
    v_mov_b32 v31, s8
    s_lshl_b32 s88, s88, 2
    s_add_u32 s88, s88, s3
    v_mov_b32 v2, 0
    s_add_u32 s92, s52, 0x1200000
    s_addc_u32 s93, s53, 0
    s_mov_b32 s94, 0x50000
    s_mov_b32 s95, 0x20000
    s_lshl_b32 s8, s88, 12
    s_load_dword s100, s[42:43], s8
    s_lshr_b32 s8, s88, 1
    s_lshl_b32 s8, s8, 2
    s_load_dword s101, s[44:45], s8
    buffer_store_dword v2, v30, s[92:95], 0 offen sc1
    buffer_store_dword v2, v31, s[92:95], 0 offen sc1
    s_add_u32 s11, s90, 1
    s_and_b32 s11, s11, 15
    s_lshl_b32 s11, s11, 7
    s_add_u32 m0, s10, 0x8000
    s_nop 0
    buffer_load_dwordx4 v8, s[56:59], s11 offen offset:0 lds
    buffer_load_dwordx4 v9, s[56:59], s11 offen offset:1024 lds
    buffer_load_dwordx4 v10, s[56:59], s11 offen offset:2048 lds
    buffer_load_dwordx4 v11, s[56:59], s11 offen offset:3072 lds
    s_add_u32 m0, s10, 0xc000
    s_nop 0
    buffer_load_dwordx4 v12, s[60:63], s11 offen offset:0 lds
    buffer_load_dwordx4 v13, s[60:63], s11 offen offset:1024 lds
    buffer_load_dwordx4 v14, s[60:63], s11 offen offset:2048 lds
    buffer_load_dwordx4 v15, s[60:63], s11 offen offset:3072 lds
    s_lshl_b32 s13, s13, 7
    s_lshl_b32 s14, s3, 5
    s_add_u32 s13, s13, s14
    v_and_b32 v17, 31, v1
    s_lshl_b32 s14, s12, 5
    v_add_u32 v17, s14, v17
    v_lshlrev_b32 v22, 4, v17
    v_and_b32 v23, 31, v1
    v_mul_u32_u24 v23, 544, v23
    v_lshrrev_b32 v24, 5, v1
    v_lshlrev_b32 v24, 5, v24
    v_sub_u32 v23, v23, v24
    s_lshl_b32 s8, s3, 6
    s_sub_u32 s8, 131808, s8
    v_add_u32 v23, s8, v23
    v_lshrrev_b32 v24, 4, v1
    s_lshl_b32 s8, s3, 4
    v_add_u32 v24, s8, v24
    v_and_b32 v2, 15, v1
    v_lshlrev_b32 v2, 4, v2
    s_lshl_b32 s8, s12, 6
    v_add_u32 v27, s8, v24
    v_lshl_add_u32 v27, v27, 12, v2
    s_lshr_b32 s8, s55, 1
    s_lshl_b32 s8, s8, 8
    s_sub_u32 s8, 3840, s8
    v_add_u32 v27, s8, v27
    v_mul_u32_u24 v24, 272, v24
    v_add_u32 v24, v24, v2
    v_add_u32 v24, 0x20200, v24
    s_lshl_b32 s14, s4, 7
    s_lshl_b32 s8, s5, 3
    s_add_u32 s14, s14, s8
    s_lshl_b32 s8, s3, 1
    s_add_u32 s14, s14, s8
    s_lshl_b32 s8, s14, 11
    v_lshlrev_b32 v25, 4, v1
    v_add_u32 v26, s8, v25
    v_add_u32 v3, 0x8000, v27
    s_mov_b32 s64, s36
    s_mov_b32 s65, s37
    s_mov_b32 s66, 0x400000
    s_mov_b32 s67, 0x20000
    s_mov_b32 s68, s38
    s_mov_b32 s69, s39
    s_mov_b32 s70, 0x400000
    s_mov_b32 s71, 0x20000
    s_add_u32 s72, s52, 0x800000
    s_addc_u32 s73, s53, 0
    s_mov_b32 s74, 0x400000
    s_mov_b32 s75, 0x20000
    s_add_u32 s76, s52, 0x1000000
    s_addc_u32 s77, s53, 0
    s_mov_b32 s78, 0x2000
    s_mov_b32 s79, 0x20000
    s_mov_b32 s80, 0
    s_mov_b32 s81, 4096
    s_mov_b32 s82, 8192
    s_mov_b32 s83, 12288
    s_mov_b32 s84, 16384
    s_mov_b32 s85, 20480
    s_mov_b32 s86, 24576
    s_mov_b32 s87, 28672
    v_lshrrev_b32 v19, 3, v1
    v_add_u32 v19, s13, v19
    v_lshlrev_b32 v19, 11, v19
    v_and_b32 v20, 7, v1
    v_lshl_add_u32 v19, v20, 4, v19
    s_lshl_b32 s8, s12, 7
    v_add_u32 v19, s8, v19
    v_subrev_u32 v20, 16384, v19
    v_lshrrev_b32 v21, 5, v1
    v_lshlrev_b32 v21, 11, v21
    v_and_b32 v18, 31, v1
    v_lshl_add_u32 v21, v18, 2, v21
    s_lshl_b32 s8, s3, 12
    s_add_u32 s91, s8, 98304
    v_add_u32 v21, s91, v21
    v_mov_b32 v6, 0x24a00
    v_mov_b32 v7, 0
    ds_write_b32 v6, v7 offset:4
    ds_write_b32 v6, v7 offset:8
    ds_write_b32 v6, v7 offset:12
    ds_write_b32 v6, v7 offset:16
    s_waitcnt lgkmcnt(0)
    s_waitcnt vmcnt(8)
    s_barrier
    s_add_u32 s11, s90, 2
    s_and_b32 s11, s11, 15
    s_lshl_b32 s11, s11, 7
    s_add_u32 m0, s10, 0x10000
    s_nop 0
    buffer_load_dwordx4 v8, s[56:59], s11 offen offset:0 lds
    buffer_load_dwordx4 v9, s[56:59], s11 offen offset:1024 lds
    buffer_load_dwordx4 v10, s[56:59], s11 offen offset:2048 lds
    buffer_load_dwordx4 v11, s[56:59], s11 offen offset:3072 lds
    s_add_u32 m0, s10, 0x14000
    s_nop 0
    buffer_load_dwordx4 v12, s[60:63], s11 offen offset:0 lds
    buffer_load_dwordx4 v13, s[60:63], s11 offen offset:1024 lds
    buffer_load_dwordx4 v14, s[60:63], s11 offen offset:2048 lds
    buffer_load_dwordx4 v15, s[60:63], s11 offen offset:3072 lds
    buffer_load_dwordx4 v[72:75], v26, s[56:59], 0 offen offset:0
    buffer_load_dwordx4 v[76:79], v26, s[56:59], 0 offen offset:1024
    buffer_load_dwordx4 v[80:83], v26, s[56:59], 0 offen offset:2048
    buffer_load_dwordx4 v[84:87], v26, s[56:59], 0 offen offset:3072
    global_load_dwordx4 v[88:91], v25, s[46:47] offset:0
    global_load_dwordx4 v[92:95], v25, s[46:47] offset:1024
    s_waitcnt vmcnt(14)
    s_barrier
    s_add_u32 s11, s90, 3
    s_and_b32 s11, s11, 15
    s_lshl_b32 s11, s11, 7
    s_add_u32 m0, s10, 0x0
    s_nop 0
    buffer_load_dwordx4 v8, s[56:59], s11 offen offset:0 lds
    buffer_load_dwordx4 v9, s[56:59], s11 offen offset:1024 lds
    buffer_load_dwordx4 v10, s[56:59], s11 offen offset:2048 lds
    buffer_load_dwordx4 v11, s[56:59], s11 offen offset:3072 lds
    s_add_u32 m0, s10, 0x4000
    s_nop 0
    buffer_load_dwordx4 v12, s[60:63], s11 offen offset:0 lds
    buffer_load_dwordx4 v13, s[60:63], s11 offen offset:1024 lds
    buffer_load_dwordx4 v14, s[60:63], s11 offen offset:2048 lds
    buffer_load_dwordx4 v15, s[60:63], s11 offen offset:3072 lds
    s_waitcnt vmcnt(14)
    s_barrier
    s_add_u32 s11, s90, 4
    s_and_b32 s11, s11, 15
    s_lshl_b32 s11, s11, 7
    s_add_u32 m0, s10, 0x8000
    s_nop 0
    buffer_load_dwordx4 v8, s[56:59], s11 offen offset:0 lds
    s_mov_b32 s12, 0xffff0000
    s_waitcnt vmcnt(9)
    v_lshlrev_b32 v96, 16, v88
    v_and_b32 v97, s12, v88
    v_lshlrev_b32 v98, 16, v89
    v_and_b32 v99, s12, v89
    v_lshlrev_b32 v100, 16, v90
    v_and_b32 v101, s12, v90
    v_lshlrev_b32 v102, 16, v91
    v_and_b32 v103, s12, v91
    buffer_load_dwordx4 v9, s[56:59], s11 offen offset:1024 lds
    v_lshlrev_b32 v104, 16, v92
    v_and_b32 v105, s12, v92
    v_lshlrev_b32 v106, 16, v93
    v_and_b32 v107, s12, v93
    v_lshlrev_b32 v108, 16, v94
    v_and_b32 v109, s12, v94
    v_lshlrev_b32 v110, 16, v95
    v_and_b32 v111, s12, v95
    v_mov_b32 v112, 0
    v_lshlrev_b32 v116, 16, v72
    buffer_load_dwordx4 v10, s[56:59], s11 offen offset:2048 lds
    v_and_b32 v117, s12, v72
    v_mul_f32 v116, v116, v96
    v_mul_f32 v117, v117, v97
    v_cvt_pk_bf16_f32 v118, v116, v117
    v_lshlrev_b32 v116, 16, v118
    v_and_b32 v117, s12, v118
    v_add_f32 v112, v112, v116
    v_add_f32 v112, v112, v117
    v_lshlrev_b32 v116, 16, v73
    v_and_b32 v117, s12, v73
    buffer_load_dwordx4 v11, s[56:59], s11 offen offset:3072 lds
    v_mul_f32 v116, v116, v98
    v_mul_f32 v117, v117, v99
    v_cvt_pk_bf16_f32 v118, v116, v117
    v_lshlrev_b32 v116, 16, v118
    v_and_b32 v117, s12, v118
    v_add_f32 v112, v112, v116
    v_add_f32 v112, v112, v117
    v_lshlrev_b32 v116, 16, v74
    v_and_b32 v117, s12, v74
    v_mul_f32 v116, v116, v100
    s_add_u32 m0, s10, 0xc000
    s_nop 0
    buffer_load_dwordx4 v12, s[60:63], s11 offen offset:0 lds
    v_mul_f32 v117, v117, v101
    v_cvt_pk_bf16_f32 v118, v116, v117
    v_lshlrev_b32 v116, 16, v118
    v_and_b32 v117, s12, v118
    v_add_f32 v112, v112, v116
    v_add_f32 v112, v112, v117
    v_lshlrev_b32 v116, 16, v75
    v_and_b32 v117, s12, v75
    v_mul_f32 v116, v116, v102
    v_mul_f32 v117, v117, v103
    buffer_load_dwordx4 v13, s[60:63], s11 offen offset:1024 lds
    v_cvt_pk_bf16_f32 v118, v116, v117
    v_lshlrev_b32 v116, 16, v118
    v_and_b32 v117, s12, v118
    v_add_f32 v112, v112, v116
    v_add_f32 v112, v112, v117
    v_lshlrev_b32 v116, 16, v76
    v_and_b32 v117, s12, v76
    v_mul_f32 v116, v116, v104
    v_mul_f32 v117, v117, v105
    v_cvt_pk_bf16_f32 v118, v116, v117
    buffer_load_dwordx4 v14, s[60:63], s11 offen offset:2048 lds
    v_lshlrev_b32 v116, 16, v118
    v_and_b32 v117, s12, v118
    v_add_f32 v112, v112, v116
    v_add_f32 v112, v112, v117
    v_lshlrev_b32 v116, 16, v77
    v_and_b32 v117, s12, v77
    v_mul_f32 v116, v116, v106
    v_mul_f32 v117, v117, v107
    v_cvt_pk_bf16_f32 v118, v116, v117
    v_lshlrev_b32 v116, 16, v118
    buffer_load_dwordx4 v15, s[60:63], s11 offen offset:3072 lds
    v_and_b32 v117, s12, v118
    v_add_f32 v112, v112, v116
    v_add_f32 v112, v112, v117
    v_lshlrev_b32 v116, 16, v78
    v_and_b32 v117, s12, v78
    v_mul_f32 v116, v116, v108
    v_mul_f32 v117, v117, v109
    v_cvt_pk_bf16_f32 v118, v116, v117
    v_lshlrev_b32 v116, 16, v118
    v_and_b32 v117, s12, v118
    s_add_u32 m0, s91, 16384
    s_nop 0
    buffer_load_dwordx4 v20, s[64:67], 0 offen lds
    s_add_u32 m0, s91, 17408
    s_mov_b32 s99, 0
    buffer_load_dwordx4 v19, s[64:67], s99 offen lds
    s_add_u32 m0, s91, 18432
    s_mov_b32 s99, 16384
    buffer_load_dwordx4 v19, s[64:67], s99 offen lds
    s_add_u32 m0, s91, 19456
    s_mov_b32 s99, 32768
    buffer_load_dwordx4 v19, s[64:67], s99 offen lds
    s_add_u32 m0, s91, 20480
    s_mov_b32 s99, 49152
    buffer_load_dwordx4 v19, s[64:67], s99 offen lds
    global_load_dwordx4 v[68:71], v22, s[40:41]
    s_add_u32 m0, s91, 0
    s_mov_b32 s99, 0
    buffer_load_dwordx4 v19, s[68:71], s99 offen lds
    s_add_u32 m0, s91, 1024
    s_mov_b32 s99, 16384
    buffer_load_dwordx4 v19, s[68:71], s99 offen lds
    s_add_u32 m0, s91, 2048
    s_mov_b32 s99, 32768
    buffer_load_dwordx4 v19, s[68:71], s99 offen lds
    s_add_u32 m0, s91, 3072
    s_mov_b32 s99, 49152
    buffer_load_dwordx4 v19, s[68:71], s99 offen lds
    s_waitcnt vmcnt(18)
    s_barrier
    s_add_u32 s11, s90, 5
    s_and_b32 s11, s11, 15
    s_lshl_b32 s11, s11, 7
    s_add_u32 m0, s10, 0x10000
    s_nop 0
    buffer_load_dwordx4 v8, s[56:59], s11 offen offset:0 lds
    v_add_f32 v112, v112, v116
    v_add_f32 v112, v112, v117
    v_lshlrev_b32 v116, 16, v79
    v_and_b32 v117, s12, v79
    v_mul_f32 v116, v116, v110
    v_mul_f32 v117, v117, v111
    v_cvt_pk_bf16_f32 v118, v116, v117
    v_lshlrev_b32 v116, 16, v118
    v_and_b32 v117, s12, v118
    v_add_f32 v112, v112, v116
    buffer_load_dwordx4 v9, s[56:59], s11 offen offset:1024 lds
    v_add_f32 v112, v112, v117
    v_mov_b32 v113, 0
    v_lshlrev_b32 v116, 16, v80
    v_and_b32 v117, s12, v80
    v_mul_f32 v116, v116, v96
    v_mul_f32 v117, v117, v97
    v_cvt_pk_bf16_f32 v118, v116, v117
    v_lshlrev_b32 v116, 16, v118
    v_and_b32 v117, s12, v118
    v_add_f32 v113, v113, v116
    buffer_load_dwordx4 v10, s[56:59], s11 offen offset:2048 lds
    v_add_f32 v113, v113, v117
    v_lshlrev_b32 v116, 16, v81
    v_and_b32 v117, s12, v81
    v_mul_f32 v116, v116, v98
    v_mul_f32 v117, v117, v99
    v_cvt_pk_bf16_f32 v118, v116, v117
    v_lshlrev_b32 v116, 16, v118
    v_and_b32 v117, s12, v118
    v_add_f32 v113, v113, v116
    v_add_f32 v113, v113, v117
    buffer_load_dwordx4 v11, s[56:59], s11 offen offset:3072 lds
    v_lshlrev_b32 v116, 16, v82
    v_and_b32 v117, s12, v82
    v_mul_f32 v116, v116, v100
    v_mul_f32 v117, v117, v101
    v_cvt_pk_bf16_f32 v118, v116, v117
    v_lshlrev_b32 v116, 16, v118
    v_and_b32 v117, s12, v118
    v_add_f32 v113, v113, v116
    v_add_f32 v113, v113, v117
    v_lshlrev_b32 v116, 16, v83
    s_add_u32 m0, s10, 0x14000
    s_nop 0
    buffer_load_dwordx4 v12, s[60:63], s11 offen offset:0 lds
    v_and_b32 v117, s12, v83
    v_mul_f32 v116, v116, v102
    v_mul_f32 v117, v117, v103
    v_cvt_pk_bf16_f32 v118, v116, v117
    v_lshlrev_b32 v116, 16, v118
    v_and_b32 v117, s12, v118
    v_add_f32 v113, v113, v116
    v_add_f32 v113, v113, v117
    v_lshlrev_b32 v116, 16, v84
    v_and_b32 v117, s12, v84
    buffer_load_dwordx4 v13, s[60:63], s11 offen offset:1024 lds
    v_mul_f32 v116, v116, v104
    v_mul_f32 v117, v117, v105
    v_cvt_pk_bf16_f32 v118, v116, v117
    v_lshlrev_b32 v116, 16, v118
    v_and_b32 v117, s12, v118
    v_add_f32 v113, v113, v116
    v_add_f32 v113, v113, v117
    v_lshlrev_b32 v116, 16, v85
    v_and_b32 v117, s12, v85
    v_mul_f32 v116, v116, v106
    buffer_load_dwordx4 v14, s[60:63], s11 offen offset:2048 lds
    v_mul_f32 v117, v117, v107
    v_cvt_pk_bf16_f32 v118, v116, v117
    v_lshlrev_b32 v116, 16, v118
    v_and_b32 v117, s12, v118
    v_add_f32 v113, v113, v116
    v_add_f32 v113, v113, v117
    v_lshlrev_b32 v116, 16, v86
    v_and_b32 v117, s12, v86
    v_mul_f32 v116, v116, v108
    v_mul_f32 v117, v117, v109
    buffer_load_dwordx4 v15, s[60:63], s11 offen offset:3072 lds
    v_cvt_pk_bf16_f32 v118, v116, v117
    v_lshlrev_b32 v116, 16, v118
    v_and_b32 v117, s12, v118
    v_add_f32 v113, v113, v116
    v_add_f32 v113, v113, v117
    v_lshlrev_b32 v116, 16, v87
    v_and_b32 v117, s12, v87
    v_mul_f32 v116, v116, v110
    v_mul_f32 v117, v117, v111
    v_cvt_pk_bf16_f32 v118, v116, v117
    s_waitcnt vmcnt(18)
    s_barrier
    s_add_u32 s11, s90, 6
    s_and_b32 s11, s11, 15
    s_lshl_b32 s11, s11, 7
    s_add_u32 m0, s10, 0x0
    s_nop 0
    buffer_load_dwordx4 v8, s[56:59], s11 offen offset:0 lds
    v_lshlrev_b32 v116, 16, v118
    v_and_b32 v117, s12, v118
    v_add_f32 v113, v113, v116
    v_add_f32 v113, v113, v117
    v_add_f32_dpp v112, v112, v112 row_shr:1 row_mask:0xf bank_mask:0xf bound_ctrl:0
    s_nop 1
    v_add_f32_dpp v112, v112, v112 row_shr:2 row_mask:0xf bank_mask:0xf bound_ctrl:0
    s_nop 1
    v_add_f32_dpp v112, v112, v112 row_shr:4 row_mask:0xf bank_mask:0xf bound_ctrl:0
    s_nop 1
    v_add_f32_dpp v112, v112, v112 row_shr:8 row_mask:0xf bank_mask:0xf bound_ctrl:0
    s_nop 1
    v_add_f32_dpp v112, v112, v112 row_bcast:15 row_mask:0xa bank_mask:0xf
    s_nop 1
    v_add_f32_dpp v112, v112, v112 row_bcast:31 row_mask:0xc bank_mask:0xf
    buffer_load_dwordx4 v9, s[56:59], s11 offen offset:1024 lds
    v_add_f32_dpp v113, v113, v113 row_shr:1 row_mask:0xf bank_mask:0xf bound_ctrl:0
    s_nop 1
    v_add_f32_dpp v113, v113, v113 row_shr:2 row_mask:0xf bank_mask:0xf bound_ctrl:0
    s_nop 1
    v_add_f32_dpp v113, v113, v113 row_shr:4 row_mask:0xf bank_mask:0xf bound_ctrl:0
    s_nop 1
    v_add_f32_dpp v113, v113, v113 row_shr:8 row_mask:0xf bank_mask:0xf bound_ctrl:0
    s_nop 1
    v_add_f32_dpp v113, v113, v113 row_bcast:15 row_mask:0xa bank_mask:0xf
    s_nop 1
    v_add_f32_dpp v113, v113, v113 row_bcast:31 row_mask:0xc bank_mask:0xf
    v_readlane_b32 s8, v112, 63
    v_readlane_b32 s9, v113, 63
    s_nop 0
    v_mov_b32 v116, s8
    v_mov_b32 v117, s9
    buffer_load_dwordx4 v10, s[56:59], s11 offen offset:2048 lds
    v_cmp_eq_u32 vcc, 1, v1
    s_nop 1
    v_cndmask_b32 v116, v116, v117, vcc
    v_cvt_pk_bf16_f32 v116, v116, v116
    v_lshlrev_b32 v116, 16, v116
    v_mul_f32 v116, 0xbfb8aa3b, v116
    v_exp_f32 v116, v116
    s_nop 0
    v_add_f32 v116, 1.0, v116
    v_rcp_f32 v116, v116
    s_nop 0
    v_cvt_pk_bf16_f32 v117, v116, v116
    v_lshlrev_b32 v116, 16, v117
    buffer_load_dwordx4 v11, s[56:59], s11 offen offset:3072 lds
    v_sub_f32 v118, 1.0, v116
    v_cvt_pk_bf16_f32 v116, v116, v118
    s_lshl_b32 s14, s14, 2
    v_lshl_add_u32 v117, v1, 2, s14
    s_mov_b64 exec, 3
    buffer_store_dword v116, v117, s[76:79], 0 offen sc1
    s_mov_b64 exec, -1
    s_add_u32 m0, s10, 0x4000
    s_nop 0
    buffer_load_dwordx4 v12, s[60:63], s11 offen offset:0 lds
    buffer_load_dwordx4 v13, s[60:63], s11 offen offset:1024 lds
    buffer_load_dwordx4 v14, s[60:63], s11 offen offset:2048 lds
    buffer_load_dwordx4 v15, s[60:63], s11 offen offset:3072 lds
    s_waitcnt vmcnt(9)
    s_barrier
    s_add_u32 s11, s90, 7
    s_and_b32 s11, s11, 15
    s_lshl_b32 s11, s11, 7
    s_add_u32 m0, s10, 0x8000
    s_nop 0
    buffer_load_dwordx4 v8, s[56:59], s11 offen offset:0 lds
    ds_read_b32 v32, v21 offset:17024
    ds_read_b32 v33, v21 offset:17152
    ds_read_b32 v34, v21 offset:17280
    ds_read_b32 v35, v21 offset:17408
    ds_read_b32 v36, v21 offset:17536
    ds_read_b32 v37, v21 offset:17664
    ds_read_b32 v38, v21 offset:17792
    ds_read_b32 v39, v21 offset:17920
    ds_read_b32 v40, v21 offset:18048
    buffer_load_dwordx4 v9, s[56:59], s11 offen offset:1024 lds
    ds_read_b32 v41, v21 offset:18176
    s_waitcnt lgkmcnt(0)
    ds_read_b32 v42, v21 offset:18304
    ds_read_b32 v43, v21 offset:18432
    ds_read_b32 v44, v21 offset:18560
    ds_read_b32 v45, v21 offset:18688
    ds_read_b32 v46, v21 offset:18816
    ds_read_b32 v47, v21 offset:18944
    ds_read_b32 v48, v21 offset:19072
    ds_read_b32 v49, v21 offset:19200
    buffer_load_dwordx4 v10, s[56:59], s11 offen offset:2048 lds
    ds_read_b32 v50, v21 offset:19328
    s_waitcnt lgkmcnt(0)
    v_lshlrev_b32 v96, 16, v32
    v_and_b32 v97, s12, v32
    v_lshlrev_b32 v98, 16, v33
    v_and_b32 v99, s12, v33
    v_lshlrev_b32 v100, 16, v34
    v_and_b32 v101, s12, v34
    v_lshlrev_b32 v102, 16, v35
    v_and_b32 v103, s12, v35
    buffer_load_dwordx4 v11, s[56:59], s11 offen offset:3072 lds
    v_lshlrev_b32 v104, 16, v36
    v_and_b32 v105, s12, v36
    v_lshlrev_b32 v106, 16, v37
    v_and_b32 v107, s12, v37
    v_lshlrev_b32 v108, 16, v38
    v_and_b32 v109, s12, v38
    v_lshlrev_b32 v110, 16, v39
    v_and_b32 v111, s12, v39
    v_lshlrev_b32 v112, 16, v40
    v_and_b32 v113, s12, v40
    s_add_u32 m0, s10, 0xc000
    s_nop 0
    buffer_load_dwordx4 v12, s[60:63], s11 offen offset:0 lds
    v_lshlrev_b32 v114, 16, v41
    v_and_b32 v115, s12, v41
    v_lshlrev_b32 v116, 16, v42
    v_and_b32 v117, s12, v42
    v_lshlrev_b32 v118, 16, v43
    v_and_b32 v119, s12, v43
    v_lshlrev_b32 v120, 16, v44
    v_and_b32 v121, s12, v44
    v_lshlrev_b32 v122, 16, v45
    v_and_b32 v123, s12, v45
    buffer_load_dwordx4 v13, s[60:63], s11 offen offset:1024 lds
    v_lshlrev_b32 v124, 16, v46
    v_and_b32 v125, s12, v46
    v_lshlrev_b32 v126, 16, v47
    v_and_b32 v127, s12, v47
    v_lshlrev_b32 v128, 16, v48
    v_and_b32 v129, s12, v48
    v_lshlrev_b32 v130, 16, v49
    v_and_b32 v131, s12, v49
    v_lshlrev_b32 v132, 16, v50
    v_and_b32 v133, s12, v50
    buffer_load_dwordx4 v14, s[60:63], s11 offen offset:2048 lds
    v_lshlrev_b32 v136, 16, v68
    v_lshlrev_b32 v137, 16, v70
    v_and_b32 v138, s12, v68
    v_and_b32 v139, s12, v70
    v_lshlrev_b32 v140, 16, v69
    v_lshlrev_b32 v141, 16, v71
    v_and_b32 v142, s12, v69
    v_and_b32 v143, s12, v71
    ds_read_b32 v208, v21 offset:0
    buffer_load_dwordx4 v15, s[60:63], s11 offen offset:3072 lds
    ds_read_b32 v209, v21 offset:128
    ds_read_b32 v210, v21 offset:256
    ds_read_b32 v211, v21 offset:384
    ds_read_b32 v212, v21 offset:512
    ds_read_b32 v213, v21 offset:640
    ds_read_b32 v214, v21 offset:768
    ds_read_b32 v215, v21 offset:896
    s_waitcnt lgkmcnt(0)
    ds_read_b32 v216, v21 offset:1024
    ds_read_b32 v217, v21 offset:1152
    s_waitcnt vmcnt(8)
    s_barrier
    s_add_u32 s11, s90, 8
    s_and_b32 s11, s11, 15
    s_lshl_b32 s11, s11, 7
    s_add_u32 m0, s10, 0x10000
    s_nop 0
    buffer_load_dwordx4 v8, s[56:59], s11 offen offset:0 lds
    ds_read_b32 v218, v21 offset:1280
    ds_read_b32 v219, v21 offset:1408
    ds_read_b32 v220, v21 offset:1536
    ds_read_b32 v221, v21 offset:1664
    ds_read_b32 v222, v21 offset:1792
    ds_read_b32 v223, v21 offset:1920
    s_waitcnt lgkmcnt(0)
    v_lshlrev_b32 v176, 16, v208
    v_and_b32 v177, s12, v208
    v_mul_f32 v144, v96, v142
    buffer_load_dwordx4 v9, s[56:59], s11 offen offset:1024 lds
    v_mul_f32 v145, v97, v143
    v_fmac_f32 v144, v98, v140
    v_fmac_f32 v145, v99, v141
    v_fmac_f32 v144, v100, v138
    v_fmac_f32 v145, v101, v139
    v_fmac_f32 v144, v102, v136
    v_fmac_f32 v145, v103, v137
    v_mul_f32 v144, v144, v176
    v_mul_f32 v145, v145, v177
    v_lshlrev_b32 v178, 16, v209
    buffer_load_dwordx4 v10, s[56:59], s11 offen offset:2048 lds
    v_and_b32 v179, s12, v209
    v_mul_f32 v146, v98, v142
    v_mul_f32 v147, v99, v143
    v_fmac_f32 v146, v100, v140
    v_fmac_f32 v147, v101, v141
    v_fmac_f32 v146, v102, v138
    v_fmac_f32 v147, v103, v139
    v_fmac_f32 v146, v104, v136
    v_fmac_f32 v147, v105, v137
    v_mul_f32 v146, v146, v178
    buffer_load_dwordx4 v11, s[56:59], s11 offen offset:3072 lds
    v_mul_f32 v147, v147, v179
    v_lshlrev_b32 v176, 16, v210
    v_and_b32 v177, s12, v210
    v_mul_f32 v148, v100, v142
    v_mul_f32 v149, v101, v143
    v_fmac_f32 v148, v102, v140
    v_fmac_f32 v149, v103, v141
    v_fmac_f32 v148, v104, v138
    v_fmac_f32 v149, v105, v139
    v_fmac_f32 v148, v106, v136
    s_add_u32 m0, s10, 0x14000
    s_nop 0
    buffer_load_dwordx4 v12, s[60:63], s11 offen offset:0 lds
    v_fmac_f32 v149, v107, v137
    v_mul_f32 v148, v148, v176
    v_mul_f32 v149, v149, v177
    v_lshlrev_b32 v178, 16, v211
    v_and_b32 v179, s12, v211
    v_mul_f32 v150, v102, v142
    v_mul_f32 v151, v103, v143
    v_fmac_f32 v150, v104, v140
    v_fmac_f32 v151, v105, v141
    v_fmac_f32 v150, v106, v138
    buffer_load_dwordx4 v13, s[60:63], s11 offen offset:1024 lds
    v_fmac_f32 v151, v107, v139
    v_fmac_f32 v150, v108, v136
    v_fmac_f32 v151, v109, v137
    v_mul_f32 v150, v150, v178
    v_mul_f32 v151, v151, v179
    v_lshlrev_b32 v176, 16, v212
    v_and_b32 v177, s12, v212
    v_mul_f32 v152, v104, v142
    v_mul_f32 v153, v105, v143
    v_fmac_f32 v152, v106, v140
    buffer_load_dwordx4 v14, s[60:63], s11 offen offset:2048 lds
    v_fmac_f32 v153, v107, v141
    v_fmac_f32 v152, v108, v138
    v_fmac_f32 v153, v109, v139
    v_fmac_f32 v152, v110, v136
    v_fmac_f32 v153, v111, v137
    v_mul_f32 v152, v152, v176
    v_mul_f32 v153, v153, v177
    v_lshlrev_b32 v178, 16, v213
    v_and_b32 v179, s12, v213
    v_mul_f32 v154, v106, v142
    buffer_load_dwordx4 v15, s[60:63], s11 offen offset:3072 lds
    v_mul_f32 v155, v107, v143
    v_fmac_f32 v154, v108, v140
    v_fmac_f32 v155, v109, v141
    v_fmac_f32 v154, v110, v138
    v_fmac_f32 v155, v111, v139
    v_fmac_f32 v154, v112, v136
    v_fmac_f32 v155, v113, v137
    v_mul_f32 v154, v154, v178
    v_mul_f32 v155, v155, v179
    v_lshlrev_b32 v176, 16, v214
    s_waitcnt vmcnt(8)
    s_barrier
    s_add_u32 s11, s90, 9
    s_and_b32 s11, s11, 15
    s_lshl_b32 s11, s11, 7
    s_add_u32 m0, s10, 0x0
    s_nop 0
    buffer_load_dwordx4 v8, s[56:59], s11 offen offset:0 lds
    v_and_b32 v177, s12, v214
    v_mul_f32 v156, v108, v142
    v_mul_f32 v157, v109, v143
    v_fmac_f32 v156, v110, v140
    v_fmac_f32 v157, v111, v141
    v_fmac_f32 v156, v112, v138
    v_fmac_f32 v157, v113, v139
    v_fmac_f32 v156, v114, v136
    v_fmac_f32 v157, v115, v137
    v_mul_f32 v156, v156, v176
    buffer_load_dwordx4 v9, s[56:59], s11 offen offset:1024 lds
    v_mul_f32 v157, v157, v177
    v_lshlrev_b32 v178, 16, v215
    v_and_b32 v179, s12, v215
    v_mul_f32 v158, v110, v142
    v_mul_f32 v159, v111, v143
    v_fmac_f32 v158, v112, v140
    v_fmac_f32 v159, v113, v141
    v_fmac_f32 v158, v114, v138
    v_fmac_f32 v159, v115, v139
    v_fmac_f32 v158, v116, v136
    buffer_load_dwordx4 v10, s[56:59], s11 offen offset:2048 lds
    v_fmac_f32 v159, v117, v137
    v_mul_f32 v158, v158, v178
    v_mul_f32 v159, v159, v179
    v_lshlrev_b32 v176, 16, v216
    v_and_b32 v177, s12, v216
    v_mul_f32 v160, v112, v142
    v_mul_f32 v161, v113, v143
    v_fmac_f32 v160, v114, v140
    v_fmac_f32 v161, v115, v141
    v_fmac_f32 v160, v116, v138
    buffer_load_dwordx4 v11, s[56:59], s11 offen offset:3072 lds
    v_fmac_f32 v161, v117, v139
    v_fmac_f32 v160, v118, v136
    v_fmac_f32 v161, v119, v137
    v_mul_f32 v160, v160, v176
    v_mul_f32 v161, v161, v177
    v_lshlrev_b32 v178, 16, v217
    v_and_b32 v179, s12, v217
    v_mul_f32 v162, v114, v142
    v_mul_f32 v163, v115, v143
    v_fmac_f32 v162, v116, v140
    s_add_u32 m0, s10, 0x4000
    s_nop 0
    buffer_load_dwordx4 v12, s[60:63], s11 offen offset:0 lds
    v_fmac_f32 v163, v117, v141
    v_fmac_f32 v162, v118, v138
    v_fmac_f32 v163, v119, v139
    v_fmac_f32 v162, v120, v136
    v_fmac_f32 v163, v121, v137
    v_mul_f32 v162, v162, v178
    v_mul_f32 v163, v163, v179
    v_lshlrev_b32 v176, 16, v218
    v_and_b32 v177, s12, v218
    v_mul_f32 v164, v116, v142
    buffer_load_dwordx4 v13, s[60:63], s11 offen offset:1024 lds
    v_mul_f32 v165, v117, v143
    v_fmac_f32 v164, v118, v140
    v_fmac_f32 v165, v119, v141
    v_fmac_f32 v164, v120, v138
    v_fmac_f32 v165, v121, v139
    v_fmac_f32 v164, v122, v136
    v_fmac_f32 v165, v123, v137
    v_mul_f32 v164, v164, v176
    v_mul_f32 v165, v165, v177
    v_lshlrev_b32 v178, 16, v219
    buffer_load_dwordx4 v14, s[60:63], s11 offen offset:2048 lds
    v_and_b32 v179, s12, v219
    v_mul_f32 v166, v118, v142
    v_mul_f32 v167, v119, v143
    v_fmac_f32 v166, v120, v140
    v_fmac_f32 v167, v121, v141
    v_fmac_f32 v166, v122, v138
    v_fmac_f32 v167, v123, v139
    v_fmac_f32 v166, v124, v136
    v_fmac_f32 v167, v125, v137
    v_mul_f32 v166, v166, v178
    buffer_load_dwordx4 v15, s[60:63], s11 offen offset:3072 lds
    v_mul_f32 v167, v167, v179
    v_lshlrev_b32 v176, 16, v220
    v_and_b32 v177, s12, v220
    v_mul_f32 v168, v120, v142
    v_mul_f32 v169, v121, v143
    v_fmac_f32 v168, v122, v140
    v_fmac_f32 v169, v123, v141
    v_fmac_f32 v168, v124, v138
    v_fmac_f32 v169, v125, v139
    v_fmac_f32 v168, v126, v136
    s_cmp_ge_u32 s3, 2
    s_cselect_b32 s96, s28, s26
    s_cselect_b32 s97, s29, s27
    s_lshl_b32 s98, s2, 13
    s_and_b32 s99, s3, 1
    s_lshl_b32 s99, s99, 12
    s_add_u32 s98, s98, s99
    v_and_b32 v240, 31, v1
    v_lshl_add_u32 v240, v240, 7, s98
    global_load_dword v241, v240, s[96:97]
    v_lshlrev_b32 v246, 2, v1
    global_load_dword v247, v246, s[50:51] sc1
    s_waitcnt vmcnt(10)
    s_barrier
    s_add_u32 s11, s90, 10
    s_and_b32 s11, s11, 15
    s_lshl_b32 s11, s11, 7
    s_add_u32 m0, s10, 0x8000
    s_nop 0
    buffer_load_dwordx4 v8, s[56:59], s11 offen offset:0 lds
    v_fmac_f32 v169, v127, v137
    v_mul_f32 v168, v168, v176
    v_mul_f32 v169, v169, v177
    v_lshlrev_b32 v178, 16, v221
    v_and_b32 v179, s12, v221
    v_mul_f32 v170, v122, v142
    v_mul_f32 v171, v123, v143
    v_fmac_f32 v170, v124, v140
    v_fmac_f32 v171, v125, v141
    v_fmac_f32 v170, v126, v138
    buffer_load_dwordx4 v9, s[56:59], s11 offen offset:1024 lds
    v_fmac_f32 v171, v127, v139
    v_fmac_f32 v170, v128, v136
    v_fmac_f32 v171, v129, v137
    v_mul_f32 v170, v170, v178
    v_mul_f32 v171, v171, v179
    v_lshlrev_b32 v176, 16, v222
    v_and_b32 v177, s12, v222
    v_mul_f32 v172, v124, v142
    v_mul_f32 v173, v125, v143
    v_fmac_f32 v172, v126, v140
    buffer_load_dwordx4 v10, s[56:59], s11 offen offset:2048 lds
    v_fmac_f32 v173, v127, v141
    v_fmac_f32 v172, v128, v138
    v_fmac_f32 v173, v129, v139
    v_fmac_f32 v172, v130, v136
    v_fmac_f32 v173, v131, v137
    v_mul_f32 v172, v172, v176
    v_mul_f32 v173, v173, v177
    v_lshlrev_b32 v178, 16, v223
    v_and_b32 v179, s12, v223
    v_mul_f32 v174, v126, v142
    buffer_load_dwordx4 v11, s[56:59], s11 offen offset:3072 lds
    v_mul_f32 v175, v127, v143
    v_fmac_f32 v174, v128, v140
    v_fmac_f32 v175, v129, v141
    v_fmac_f32 v174, v130, v138
    v_fmac_f32 v175, v131, v139
    v_fmac_f32 v174, v132, v136
    v_fmac_f32 v175, v133, v137
    v_mul_f32 v174, v174, v178
    v_mul_f32 v175, v175, v179
    v_cvt_pk_bf16_f32 v192, v174, v172
    s_add_u32 m0, s10, 0xc000
    s_nop 0
    buffer_load_dwordx4 v12, s[60:63], s11 offen offset:0 lds
    v_cvt_pk_bf16_f32 v193, v170, v168
    v_cvt_pk_bf16_f32 v194, v166, v164
    v_cvt_pk_bf16_f32 v195, v162, v160
    ds_write_b128 v23, v[192:195] offset:0
    v_cvt_pk_bf16_f32 v196, v158, v156
    v_cvt_pk_bf16_f32 v197, v154, v152
    v_cvt_pk_bf16_f32 v198, v150, v148
    v_cvt_pk_bf16_f32 v199, v146, v144
    ds_write_b128 v23, v[196:199] offset:16
    v_cvt_pk_bf16_f32 v200, v175, v173
    buffer_load_dwordx4 v13, s[60:63], s11 offen offset:1024 lds
    v_cvt_pk_bf16_f32 v201, v171, v169
    v_cvt_pk_bf16_f32 v202, v167, v165
    v_cvt_pk_bf16_f32 v203, v163, v161
    ds_write_b128 v23, v[200:203] offset:272
    v_cvt_pk_bf16_f32 v204, v159, v157
    v_cvt_pk_bf16_f32 v205, v155, v153
    v_cvt_pk_bf16_f32 v206, v151, v149
    v_cvt_pk_bf16_f32 v207, v147, v145
    ds_write_b128 v23, v[204:207] offset:288
    s_waitcnt lgkmcnt(0)
    buffer_load_dwordx4 v14, s[60:63], s11 offen offset:2048 lds
    buffer_load_dwordx4 v15, s[60:63], s11 offen offset:3072 lds
    s_waitcnt vmcnt(10)
    s_barrier
    s_add_u32 s11, s90, 11
    s_and_b32 s11, s11, 15
    s_lshl_b32 s11, s11, 7
    s_add_u32 m0, s10, 0x10000
    s_nop 0
    buffer_load_dwordx4 v8, s[56:59], s11 offen offset:0 lds
    ds_read_b128 v[192:195], v24 offset:0
    ds_read_b128 v[196:199], v24 offset:1088
    ds_read_b128 v[200:203], v24 offset:2176
    ds_read_b128 v[204:207], v24 offset:3264
    s_waitcnt vmcnt(9)
    s_getreg_b32 s98, hwreg(HW_REG_XCC_ID, 0, 4)
    s_lshl_b32 s98, 0x100, s98
    s_or_b32 s98, s98, 15
    v_and_b32 v246, 7, v1
    v_cmp_eq_u32 s[96:97], s54, v246
    v_cmp_ne_u32 vcc, s98, v247
    s_nop 1
    s_and_b64 vcc, vcc, s[96:97]
    s_cbranch_scc0 h_kvl
    s_waitcnt lgkmcnt(3)
    buffer_store_dwordx4 v[192:195], v27, s[72:75], s80 offen sc1
    s_waitcnt lgkmcnt(2)
    buffer_store_dwordx4 v[196:199], v27, s[72:75], s84 offen sc1
    s_waitcnt lgkmcnt(1)
    buffer_store_dwordx4 v[200:203], v3, s[72:75], s80 offen sc1
    s_waitcnt lgkmcnt(0)
    buffer_store_dwordx4 v[204:207], v3, s[72:75], s84 offen sc1
    s_branch h_kve
h_kvl:
    s_waitcnt lgkmcnt(3)
    buffer_store_dwordx4 v[192:195], v27, s[72:75], s80 offen
    s_waitcnt lgkmcnt(2)
    buffer_store_dwordx4 v[196:199], v27, s[72:75], s84 offen
    s_waitcnt lgkmcnt(1)
    buffer_store_dwordx4 v[200:203], v3, s[72:75], s80 offen
    s_waitcnt lgkmcnt(0)
    buffer_store_dwordx4 v[204:207], v3, s[72:75], s84 offen
h_kve:
    s_lshl_b32 s12, s88, 12
    s_add_u32 s64, s42, s12
    s_addc_u32 s65, s43, 0
    s_mov_b32 s66, 0x1000
    s_mov_b32 s67, 0x20000
    buffer_load_dwordx4 v9, s[56:59], s11 offen offset:1024 lds
    s_add_u32 s68, s52, s12
    s_addc_u32 s69, s53, 0
    s_add_u32 s68, s68, 0x800000
    s_addc_u32 s69, s69, 0
    s_mov_b32 s70, 0x1000
    s_mov_b32 s71, 0x20000
    s_mov_b32 s80, s100
    s_mov_b32 s81, s101
    v_and_b32 v37, 15, v1
    s_lshr_b32 s8, s88, 6
    buffer_load_dwordx4 v10, s[56:59], s11 offen offset:2048 lds
    s_and_b32 s8, s8, 1
    s_lshl_b32 s8, s8, 3
    s_add_u32 s8, s8, s54
    v_lshl_add_u32 v32, v37, 4, s8
    s_lshr_b32 s8, s4, 2
    s_lshl_b32 s8, s8, 1
    s_and_b32 s9, s4, 3
    s_lshl_b32 s9, s9, 3
    s_add_u32 s8, s8, s9
    v_lshrrev_b32 v38, 3, v37
    buffer_load_dwordx4 v11, s[56:59], s11 offen offset:3072 lds
    v_and_b32 v39, 7, v37
    v_lshl_add_u32 v38, v39, 5, v38
    v_add_u32 v38, s8, v38
    v_and_b32 v39, 16, v1
    v_cmp_ne_u32 vcc, 0, v39
    s_nop 1
    v_cndmask_b32 v32, v32, v38, vcc
    v_lshlrev_b32 v32, 7, v32
    v_add_u32 v32, 0x20000, v32
    v_lshlrev_b32 v33, 2, v1
    s_mov_b32 s76, s50
    s_add_u32 m0, s10, 0x14000
    s_nop 0
    buffer_load_dwordx4 v12, s[60:63], s11 offen offset:0 lds
    s_mov_b32 s77, s51
    s_mov_b32 s78, 0x100
    s_mov_b32 s79, 0x20000
    s_mul_i32 s13, s3, 8320
    s_add_u32 s13, s13, 98304
    s_mul_i32 s82, s3, 4608
    s_add_u32 s82, s82, 131584
    v_add_u32 v36, 2, v25
    v_lshrrev_b32 v5, 4, v1
    v_and_b32 v37, 15, v1
    buffer_load_dwordx4 v13, s[60:63], s11 offen offset:1024 lds
    v_lshl_add_u32 v38, v5, 3, v37
    v_lshlrev_b32 v38, 1, v38
    v_and_b32 v39, 1, v1
    v_mul_u32_u24 v39, 4158, v39
    v_sub_u32 v38, v38, v39
    s_add_u32 s14, s13, 4160
    v_add_u32 v16, s14, v38
    v_add_u32 v17, 1024, v16
    v_add_u32 v18, 2048, v16
    v_add_u32 v19, 3072, v16
    buffer_load_dwordx4 v14, s[60:63], s11 offen offset:2048 lds
    v_lshlrev_b32 v38, 5, v37
    v_lshlrev_b32 v39, 4, v5
    v_sub_u32 v20, v39, v38
    s_add_u32 s14, s82, 480
    v_add_u32 v20, s14, v20
    v_lshl_add_u32 v39, v5, 3, v38
    s_add_u32 s14, s82, 504
    v_sub_u32 v21, s14, v39
    v_and_b32 v39, 1, v5
    v_lshl_add_u32 v22, v39, 9, v38
    buffer_load_dwordx4 v15, s[60:63], s11 offen offset:3072 lds
    v_lshrrev_b32 v39, 1, v5
    v_lshl_add_u32 v22, v39, 4, v22
    v_add_u32 v23, s82, v25
    v_and_b32 v38, 7, v1
    v_lshlrev_b32 v38, 2, v38
    v_bfe_u32 v39, v1, 3, 1
    v_mul_u32_u24 v39, 4160, v39
    v_add3_u32 v38, v38, v39, s13
    s_lshl_b32 s80, s80, 16
    v_mov_b32 v56, s80
    s_waitcnt vmcnt(12)
    s_barrier
    s_add_u32 s11, s90, 12
    s_and_b32 s11, s11, 15
    s_lshl_b32 s11, s11, 7
    s_add_u32 m0, s10, 0x0
    s_nop 0
    buffer_load_dwordx4 v8, s[56:59], s11 offen offset:0 lds
    v_cmp_eq_u32 vcc, 15, v37
    s_nop 1
    v_cndmask_b32 v56, 0, v56, vcc
    ds_write_b32 v38, v56
    s_and_b32 s14, s88, 1
    s_lshl_b32 s14, s14, 4
    s_lshr_b32 s81, s81, s14
    s_lshl_b32 s81, s81, 16
    v_mov_b32 v60, 0x24a00
    v_mov_b32 v61, 1
    buffer_load_dwordx4 v9, s[56:59], s11 offen offset:1024 lds
    buffer_load_dwordx4 v10, s[56:59], s11 offen offset:2048 lds
    buffer_load_dwordx4 v11, s[56:59], s11 offen offset:3072 lds
    s_add_u32 m0, s10, 0x4000
    s_nop 0
    buffer_load_dwordx4 v12, s[60:63], s11 offen offset:0 lds
    buffer_load_dwordx4 v13, s[60:63], s11 offen offset:1024 lds
    buffer_load_dwordx4 v14, s[60:63], s11 offen offset:2048 lds
    buffer_load_dwordx4 v15, s[60:63], s11 offen offset:3072 lds
    s_waitcnt vmcnt(8)
    s_barrier
    s_cmp_lg_u32 s3, 0
    s_cbranch_scc1 h_kflag
    v_mov_b32 v6, 1
    buffer_store_dword v6, v30, s[92:95], 0 offen sc1
h_kflag:
    s_add_u32 s11, s90, 13
    s_and_b32 s11, s11, 15
    s_lshl_b32 s11, s11, 7
    s_add_u32 m0, s10, 0x8000
    s_nop 0
    buffer_load_dwordx4 v8, s[56:59], s11 offen offset:0 lds
    buffer_load_dwordx4 v9, s[56:59], s11 offen offset:1024 lds
    buffer_load_dwordx4 v10, s[56:59], s11 offen offset:2048 lds
    buffer_load_dwordx4 v11, s[56:59], s11 offen offset:3072 lds
    s_add_u32 m0, s10, 0xc000
    s_nop 0
    buffer_load_dwordx4 v12, s[60:63], s11 offen offset:0 lds
    buffer_load_dwordx4 v13, s[60:63], s11 offen offset:1024 lds
    buffer_load_dwordx4 v14, s[60:63], s11 offen offset:2048 lds
    buffer_load_dwordx4 v15, s[60:63], s11 offen offset:3072 lds
    s_waitcnt vmcnt(8)
    s_barrier
    s_add_u32 s11, s90, 14
    s_and_b32 s11, s11, 15
    s_lshl_b32 s11, s11, 7
    s_add_u32 m0, s10, 0x10000
    s_nop 0
    buffer_load_dwordx4 v8, s[56:59], s11 offen offset:0 lds
    buffer_load_dwordx4 v9, s[56:59], s11 offen offset:1024 lds
    buffer_load_dwordx4 v10, s[56:59], s11 offen offset:2048 lds
    buffer_load_dwordx4 v11, s[56:59], s11 offen offset:3072 lds
    s_add_u32 m0, s10, 0x14000
    s_nop 0
    buffer_load_dwordx4 v12, s[60:63], s11 offen offset:0 lds
    buffer_load_dwordx4 v13, s[60:63], s11 offen offset:1024 lds
    buffer_load_dwordx4 v14, s[60:63], s11 offen offset:2048 lds
    buffer_load_dwordx4 v15, s[60:63], s11 offen offset:3072 lds
    s_waitcnt vmcnt(8)
    s_barrier
    s_add_u32 s11, s90, 15
    s_and_b32 s11, s11, 15
    s_lshl_b32 s11, s11, 7
    s_add_u32 m0, s10, 0x0
    s_nop 0
    buffer_load_dwordx4 v8, s[56:59], s11 offen offset:0 lds
    buffer_load_dwordx4 v9, s[56:59], s11 offen offset:1024 lds
    buffer_load_dwordx4 v10, s[56:59], s11 offen offset:2048 lds
    buffer_load_dwordx4 v11, s[56:59], s11 offen offset:3072 lds
    s_add_u32 m0, s10, 0x4000
    s_nop 0
    buffer_load_dwordx4 v12, s[60:63], s11 offen offset:0 lds
    buffer_load_dwordx4 v13, s[60:63], s11 offen offset:1024 lds
    buffer_load_dwordx4 v14, s[60:63], s11 offen offset:2048 lds
    buffer_load_dwordx4 v15, s[60:63], s11 offen offset:3072 lds
    buffer_load_dword v34, v33, s[76:79], 0 offen sc1
    buffer_load_dword v35, v32, s[92:95], 0 offen sc1
    s_add_u32 m0, s13, 32
    s_nop 0
    buffer_load_dwordx4 v25, s[64:67], 0 offen offset:0 lds
    buffer_load_dwordx4 v25, s[64:67], 0 offen offset:1024 lds
    buffer_load_dwordx4 v25, s[64:67], 0 offen offset:2048 lds
    buffer_load_dwordx4 v25, s[64:67], 0 offen offset:3072 lds
    s_add_u32 m0, s13, 4192
    s_nop 0
    buffer_load_dwordx4 v36, s[64:67], 0 offen offset:0 lds
    buffer_load_dwordx4 v36, s[64:67], 0 offen offset:1024 lds
    buffer_load_dwordx4 v36, s[64:67], 0 offen offset:2048 lds
    buffer_load_dwordx4 v36, s[64:67], 0 offen offset:3072 lds
    s_waitcnt vmcnt(18)
    s_barrier
    s_mov_b32 s56, s26
    s_mov_b32 s57, s27
    s_mov_b32 s58, 0x200000
    s_mov_b32 s59, 0x20000
    s_mov_b32 s60, s28
    s_mov_b32 s61, s29
    s_mov_b32 s62, 0x200000
    s_mov_b32 s63, 0x20000
    s_lshl_b32 s10, s3, 11
    s_add_u32 s10, s10, 0x8000
    s_lshr_b32 s90, s5, 3
    s_xor_b32 s91, s90, 1
    s_lshl_b32 s91, s91, 20
    s_lshl_b32 s11, s90, 10
    s_add_u32 s91, s91, s11
    s_mul_i32 s90, s90, 0x100400
    v_mov_b32 v56, 0
    v_mov_b32 v57, 0
    v_lshlrev_b32 v38, 3, v1
    v_add_u32 v38, s82, v38
    ds_write_b64 v38, v[56:57] offset:4096
    s_waitcnt vmcnt(8)
    s_mov_b32 s83, 0
    v_and_b32 v34, 15, v34
    v_cmp_ne_u32 vcc, 15, v34
    v_cmp_ne_u32 s[84:85], 1, v35
    s_nop 1
    s_or_b64 vcc, vcc, s[84:85]
    s_cbranch_scc1 h_nou
    s_mov_b32 s83, 1
    buffer_load_dwordx4 v[40:43], v25, s[68:71], 0 offen offset:0 sc1
    buffer_load_dwordx4 v[44:47], v25, s[68:71], 0 offen offset:1024 sc1
    buffer_load_dwordx4 v[48:51], v25, s[68:71], 0 offen offset:2048 sc1
    buffer_load_dwordx4 v[52:55], v25, s[68:71], 0 offen offset:3072 sc1
h_nou:
    s_barrier
    s_cmp_lg_u32 s83, 1
    s_cbranch_scc1 h_nouw
    s_waitcnt vmcnt(0)
    ds_write_b128 v23, v[40:43] offset:0
    ds_write_b128 v23, v[44:47] offset:1024
    ds_write_b128 v23, v[48:51] offset:2048
    ds_write_b128 v23, v[52:55] offset:3072
h_nouw:
    s_barrier
    s_mov_b32 s11, s15
    s_lshl_b32 s11, s11, 7
    s_add_u32 s99, s11, s91
    s_add_u32 m0, s10, 0x0
    s_nop 0
    buffer_load_dwordx4 v28, s[56:59], s99 offen offset:0 lds
    buffer_load_dwordx4 v29, s[56:59], s99 offen offset:1024 lds
    s_add_u32 s11, s11, s90
    s_add_u32 m0, s10, 0x2000
    s_nop 0
    buffer_load_dwordx4 v28, s[56:59], s11 offen offset:0 lds
    buffer_load_dwordx4 v29, s[56:59], s11 offen offset:1024 lds
    s_mov_b32 s11, s15
    s_lshl_b32 s11, s11, 7
    s_add_u32 s99, s11, s91
    s_add_u32 m0, s10, 0x4000
    s_nop 0
    buffer_load_dwordx4 v28, s[60:63], s99 offen offset:0 lds
    buffer_load_dwordx4 v29, s[60:63], s99 offen offset:1024 lds
    s_add_u32 s11, s11, s90
    s_add_u32 m0, s10, 0x6000
    s_nop 0
    buffer_load_dwordx4 v28, s[60:63], s11 offen offset:0 lds
    buffer_load_dwordx4 v29, s[60:63], s11 offen offset:1024 lds
    s_cmp_lg_u32 s83, 0
    s_cbranch_scc1 h_haveu
    s_mov_b32 s89, 65536
h_init_chk:
    v_and_b32 v34, 15, v34
    v_cmp_ne_u32 vcc, 15, v34
    s_nop 1
    s_cmp_eq_u64 vcc, 0
    s_cbranch_scc1 h_init_ok
    s_sub_u32 s89, s89, 1
    s_cbranch_scc1 h_init_ok
    s_sleep 4
    buffer_load_dword v34, v33, s[76:79], 0 offen sc1
    s_waitcnt vmcnt(0)
    s_branch h_init_chk
h_init_ok:
    s_mov_b32 s89, 65536
h_kf_chk:
    v_cmp_ne_u32 vcc, 1, v35
    s_nop 1
    s_cmp_eq_u64 vcc, 0
    s_cbranch_scc1 h_kf_ok
    s_sub_u32 s89, s89, 1
    s_cbranch_scc1 h_kf_ok
    s_sleep 4
    buffer_load_dword v35, v32, s[92:95], 0 offen sc1
    s_waitcnt vmcnt(0)
    s_branch h_kf_chk
h_kf_ok:
    buffer_load_dwordx4 v[40:43], v25, s[68:71], 0 offen offset:0 sc1
    buffer_load_dwordx4 v[44:47], v25, s[68:71], 0 offen offset:1024 sc1
    buffer_load_dwordx4 v[48:51], v25, s[68:71], 0 offen offset:2048 sc1
    buffer_load_dwordx4 v[52:55], v25, s[68:71], 0 offen offset:3072 sc1
    s_waitcnt vmcnt(0)
    ds_write_b128 v23, v[40:43] offset:0
    ds_write_b128 v23, v[44:47] offset:1024
    ds_write_b128 v23, v[48:51] offset:2048
    ds_write_b128 v23, v[52:55] offset:3072
h_haveu:
    s_mov_b64 exec, 1
    ds_add_u32 v60, v61 offset:8
    s_mov_b64 exec, -1
    s_mov_b32 s84, s68
    s_mov_b32 s85, s69
    s_mov_b32 s86, s70
    s_mov_b32 s87, s71
    s_add_u32 s68, s52, 0x800000
    s_addc_u32 s69, s53, 0
    s_mov_b32 s70, 0x400000
    s_mov_b32 s71, 0x20000
    s_waitcnt lgkmcnt(0)
    ds_read_b64 v[40:41], v21 offset:3584
    ds_read_b64 v[42:43], v21 offset:3072
    ds_read_b64 v[44:45], v21 offset:2560
    ds_read_b64 v[46:47], v21 offset:2048
    ds_read_b64 v[48:49], v21 offset:1536
    ds_read_b64 v[50:51], v21 offset:1024
    ds_read_b64 v[52:53], v21 offset:512
    ds_read_b64 v[54:55], v21 offset:0
    ds_read2_b32 v[160:161], v16 offset0:0 offset1:1
    ds_read2_b32 v[162:163], v16 offset0:2 offset1:3
    ds_read_b128 v[96:99], v20 offset:3584
    ds_read_b128 v[100:103], v20 offset:3072
    ds_read_b128 v[104:107], v20 offset:2560
    ds_read_b128 v[108:111], v20 offset:2048
    ds_read_b128 v[112:115], v20 offset:1536
    ds_read_b128 v[116:119], v20 offset:1024
    ds_read_b128 v[120:123], v20 offset:512
    ds_read_b128 v[124:127], v20 offset:0
    ds_read2_b32 v[164:165], v16 offset0:128 offset1:129
    ds_read2_b32 v[166:167], v16 offset0:130 offset1:131
    ds_read2_b32 v[168:169], v17 offset0:0 offset1:1
    ds_read2_b32 v[170:171], v17 offset0:2 offset1:3
    ds_read2_b32 v[172:173], v17 offset0:128 offset1:129
    ds_read2_b32 v[174:175], v17 offset0:130 offset1:131
    ds_read2_b32 v[176:177], v18 offset0:0 offset1:1
    ds_read2_b32 v[178:179], v18 offset0:2 offset1:3
    ds_read2_b32 v[180:181], v18 offset0:128 offset1:129
    ds_read2_b32 v[182:183], v18 offset0:130 offset1:131
    ds_read2_b32 v[184:185], v19 offset0:0 offset1:1
    ds_read2_b32 v[186:187], v19 offset0:2 offset1:3
    ds_read2_b32 v[188:189], v19 offset0:128 offset1:129
    ds_read2_b32 v[190:191], v19 offset0:130 offset1:131
    s_waitcnt lgkmcnt(15)
    v_mfma_f32_16x16x32_bf16 v[64:67], v[160:163], v[96:99], 0
    s_mov_b32 s12, 0xffff0000
    v_mov_b32 v26, s81
    v_mfma_f32_16x16x32_bf16 v[68:71], v[160:163], v[100:103], 0
    ds_read2_b32 v[192:193], v16 offset0:16 offset1:17
    v_mfma_f32_16x16x32_bf16 v[72:75], v[160:163], v[104:107], 0
    ds_read2_b32 v[194:195], v16 offset0:18 offset1:19
    v_mfma_f32_16x16x32_bf16 v[76:79], v[160:163], v[108:111], 0
    ds_read_b128 v[128:131], v20 offset:3648
    v_mfma_f32_16x16x32_bf16 v[80:83], v[160:163], v[112:115], 0
    ds_read_b128 v[132:135], v20 offset:3136
    v_mfma_f32_16x16x32_bf16 v[84:87], v[160:163], v[116:119], 0
    ds_read_b128 v[136:139], v20 offset:2624
    v_mfma_f32_16x16x32_bf16 v[88:91], v[160:163], v[120:123], 0
    ds_read_b128 v[140:143], v20 offset:2112
    s_waitcnt lgkmcnt(15)
    v_mfma_f32_16x16x32_bf16 v[92:95], v[160:163], v[124:127], 0
    ds_read_b128 v[144:147], v20 offset:1600
    v_mfma_f32_16x16x32_bf16 v[68:71], v[164:167], v[96:99], v[68:71]
    ds_read_b128 v[148:151], v20 offset:1088
    v_mfma_f32_16x16x32_bf16 v[72:75], v[164:167], v[100:103], v[72:75]
    ds_read_b128 v[152:155], v20 offset:576
    v_mfma_f32_16x16x32_bf16 v[76:79], v[164:167], v[104:107], v[76:79]
    ds_read_b128 v[156:159], v20 offset:64
    v_mfma_f32_16x16x32_bf16 v[80:83], v[164:167], v[108:111], v[80:83]
    ds_read2_b32 v[196:197], v16 offset0:144 offset1:145
    v_mfma_f32_16x16x32_bf16 v[84:87], v[164:167], v[112:115], v[84:87]
    ds_read2_b32 v[198:199], v16 offset0:146 offset1:147
    v_mfma_f32_16x16x32_bf16 v[88:91], v[164:167], v[116:119], v[88:91]
    ds_read2_b32 v[200:201], v17 offset0:16 offset1:17
    v_mfma_f32_16x16x32_bf16 v[92:95], v[164:167], v[120:123], v[92:95]
    ds_read2_b32 v[202:203], v17 offset0:18 offset1:19
    v_mfma_f32_16x16x32_bf16 v[72:75], v[168:171], v[96:99], v[72:75]
    ds_read2_b32 v[204:205], v17 offset0:144 offset1:145
    v_mfma_f32_16x16x32_bf16 v[76:79], v[168:171], v[100:103], v[76:79]
    ds_read2_b32 v[206:207], v17 offset0:146 offset1:147
    v_mfma_f32_16x16x32_bf16 v[80:83], v[168:171], v[104:107], v[80:83]
    ds_read2_b32 v[208:209], v18 offset0:16 offset1:17
    v_mfma_f32_16x16x32_bf16 v[84:87], v[168:171], v[108:111], v[84:87]
    ds_read2_b32 v[210:211], v18 offset0:18 offset1:19
    v_mfma_f32_16x16x32_bf16 v[88:91], v[168:171], v[112:115], v[88:91]
    ds_read2_b32 v[212:213], v18 offset0:144 offset1:145
    v_mfma_f32_16x16x32_bf16 v[92:95], v[168:171], v[116:119], v[92:95]
    ds_read2_b32 v[214:215], v18 offset0:146 offset1:147
    s_waitcnt lgkmcnt(15)
    v_mfma_f32_16x16x32_bf16 v[76:79], v[172:175], v[96:99], v[76:79]
    ds_read2_b32 v[216:217], v19 offset0:16 offset1:17
    v_mfma_f32_16x16x32_bf16 v[80:83], v[172:175], v[100:103], v[80:83]
    ds_read2_b32 v[218:219], v19 offset0:18 offset1:19
    v_mfma_f32_16x16x32_bf16 v[84:87], v[172:175], v[104:107], v[84:87]
    ds_read2_b32 v[220:221], v19 offset0:144 offset1:145
    v_mfma_f32_16x16x32_bf16 v[88:91], v[172:175], v[108:111], v[88:91]
    ds_read2_b32 v[222:223], v19 offset0:146 offset1:147
    v_mfma_f32_16x16x32_bf16 v[92:95], v[172:175], v[112:115], v[92:95]
    v_and_b32 v224, s12, v41
    v_lshlrev_b32 v225, 16, v41
    v_mfma_f32_16x16x32_bf16 v[80:83], v[176:179], v[96:99], v[80:83]
    v_and_b32 v226, s12, v40
    v_lshlrev_b32 v227, 16, v40
    v_mfma_f32_16x16x32_bf16 v[84:87], v[176:179], v[100:103], v[84:87]
    v_mul_f32 v224, v224, v26
    v_mul_f32 v225, v225, v26
    v_mfma_f32_16x16x32_bf16 v[88:91], v[176:179], v[104:107], v[88:91]
    v_mul_f32 v226, v226, v26
    v_mul_f32 v227, v227, v26
    v_mfma_f32_16x16x32_bf16 v[92:95], v[176:179], v[108:111], v[92:95]
    v_cvt_pk_bf16_f32 v56, v224, v225
    v_cvt_pk_bf16_f32 v57, v226, v227
    v_mfma_f32_16x16x32_bf16 v[84:87], v[180:183], v[96:99], v[84:87]
    v_lshlrev_b32 v224, 16, v56
    v_and_b32 v225, s12, v56
    v_mfma_f32_16x16x32_bf16 v[88:91], v[180:183], v[100:103], v[88:91]
    v_lshlrev_b32 v226, 16, v57
    v_and_b32 v227, s12, v57
    v_mfma_f32_16x16x32_bf16 v[92:95], v[180:183], v[104:107], v[92:95]
    v_and_b32 v228, s12, v43
    v_lshlrev_b32 v229, 16, v43
    v_mfma_f32_16x16x32_bf16 v[88:91], v[184:187], v[96:99], v[88:91]
    v_and_b32 v230, s12, v42
    v_lshlrev_b32 v231, 16, v42
    v_mfma_f32_16x16x32_bf16 v[92:95], v[184:187], v[100:103], v[92:95]
    v_mul_f32 v228, v228, v26
    v_mul_f32 v229, v229, v26
    v_mfma_f32_16x16x32_bf16 v[92:95], v[188:191], v[96:99], v[92:95]
    v_mul_f32 v230, v230, v26
    v_mul_f32 v231, v231, v26
    v_mfma_f32_16x16x32_bf16 v[64:67], v[192:195], v[128:131], v[64:67]
    v_cvt_pk_bf16_f32 v56, v228, v229
    v_cvt_pk_bf16_f32 v57, v230, v231
    v_mfma_f32_16x16x32_bf16 v[68:71], v[192:195], v[132:135], v[68:71]
    ds_read2_b32 v[160:161], v16 offset0:32 offset1:33
    v_mfma_f32_16x16x32_bf16 v[72:75], v[192:195], v[136:139], v[72:75]
    ds_read2_b32 v[162:163], v16 offset0:34 offset1:35
    s_waitcnt lgkmcnt(15)
    v_mfma_f32_16x16x32_bf16 v[76:79], v[192:195], v[140:143], v[76:79]
    ds_read_b128 v[96:99], v20 offset:3712
    v_mfma_f32_16x16x32_bf16 v[80:83], v[192:195], v[144:147], v[80:83]
    ds_read_b128 v[100:103], v20 offset:3200
    v_mfma_f32_16x16x32_bf16 v[84:87], v[192:195], v[148:151], v[84:87]
    ds_read_b128 v[104:107], v20 offset:2688
    v_mfma_f32_16x16x32_bf16 v[88:91], v[192:195], v[152:155], v[88:91]
    ds_read_b128 v[108:111], v20 offset:2176
    v_mfma_f32_16x16x32_bf16 v[92:95], v[192:195], v[156:159], v[92:95]
    ds_read_b128 v[112:115], v20 offset:1664
    s_waitcnt lgkmcnt(15)
    v_mfma_f32_16x16x32_bf16 v[68:71], v[196:199], v[128:131], v[68:71]
    ds_read_b128 v[116:119], v20 offset:1152
    v_mfma_f32_16x16x32_bf16 v[72:75], v[196:199], v[132:135], v[72:75]
    ds_read_b128 v[120:123], v20 offset:640
    v_mfma_f32_16x16x32_bf16 v[76:79], v[196:199], v[136:139], v[76:79]
    ds_read_b128 v[124:127], v20 offset:128
    v_mfma_f32_16x16x32_bf16 v[80:83], v[196:199], v[140:143], v[80:83]
    ds_read2_b32 v[164:165], v16 offset0:160 offset1:161
    v_mfma_f32_16x16x32_bf16 v[84:87], v[196:199], v[144:147], v[84:87]
    ds_read2_b32 v[166:167], v16 offset0:162 offset1:163
    v_mfma_f32_16x16x32_bf16 v[88:91], v[196:199], v[148:151], v[88:91]
    ds_read2_b32 v[168:169], v17 offset0:32 offset1:33
    v_mfma_f32_16x16x32_bf16 v[92:95], v[196:199], v[152:155], v[92:95]
    ds_read2_b32 v[170:171], v17 offset0:34 offset1:35
    v_mfma_f32_16x16x32_bf16 v[72:75], v[200:203], v[128:131], v[72:75]
    ds_read2_b32 v[172:173], v17 offset0:160 offset1:161
    v_mfma_f32_16x16x32_bf16 v[76:79], v[200:203], v[132:135], v[76:79]
    ds_read2_b32 v[174:175], v17 offset0:162 offset1:163
    v_mfma_f32_16x16x32_bf16 v[80:83], v[200:203], v[136:139], v[80:83]
    ds_read2_b32 v[176:177], v18 offset0:32 offset1:33
    v_mfma_f32_16x16x32_bf16 v[84:87], v[200:203], v[140:143], v[84:87]
    ds_read2_b32 v[178:179], v18 offset0:34 offset1:35
    v_mfma_f32_16x16x32_bf16 v[88:91], v[200:203], v[144:147], v[88:91]
    ds_read2_b32 v[180:181], v18 offset0:160 offset1:161
    v_mfma_f32_16x16x32_bf16 v[92:95], v[200:203], v[148:151], v[92:95]
    ds_read2_b32 v[182:183], v18 offset0:162 offset1:163
    v_mfma_f32_16x16x32_bf16 v[76:79], v[204:207], v[128:131], v[76:79]
    ds_read2_b32 v[184:185], v19 offset0:32 offset1:33
    v_mfma_f32_16x16x32_bf16 v[80:83], v[204:207], v[132:135], v[80:83]
    ds_read2_b32 v[186:187], v19 offset0:34 offset1:35
    v_mfma_f32_16x16x32_bf16 v[84:87], v[204:207], v[136:139], v[84:87]
    ds_read2_b32 v[188:189], v19 offset0:160 offset1:161
    v_mfma_f32_16x16x32_bf16 v[88:91], v[204:207], v[140:143], v[88:91]
    ds_read2_b32 v[190:191], v19 offset0:162 offset1:163
    v_mfma_f32_16x16x32_bf16 v[92:95], v[204:207], v[144:147], v[92:95]
    v_lshlrev_b32 v228, 16, v56
    v_and_b32 v229, s12, v56
    s_waitcnt lgkmcnt(15)
    v_mfma_f32_16x16x32_bf16 v[80:83], v[208:211], v[128:131], v[80:83]
    v_lshlrev_b32 v230, 16, v57
    v_and_b32 v231, s12, v57
    v_mfma_f32_16x16x32_bf16 v[84:87], v[208:211], v[132:135], v[84:87]
    v_and_b32 v232, s12, v45
    v_lshlrev_b32 v233, 16, v45
    v_mfma_f32_16x16x32_bf16 v[88:91], v[208:211], v[136:139], v[88:91]
    v_and_b32 v234, s12, v44
    v_lshlrev_b32 v235, 16, v44
    v_mfma_f32_16x16x32_bf16 v[92:95], v[208:211], v[140:143], v[92:95]
    v_mul_f32 v232, v232, v26
    v_mul_f32 v233, v233, v26
    v_mfma_f32_16x16x32_bf16 v[84:87], v[212:215], v[128:131], v[84:87]
    v_mul_f32 v234, v234, v26
    v_mul_f32 v235, v235, v26
    v_mfma_f32_16x16x32_bf16 v[88:91], v[212:215], v[132:135], v[88:91]
    v_cvt_pk_bf16_f32 v56, v232, v233
    v_cvt_pk_bf16_f32 v57, v234, v235
    v_mfma_f32_16x16x32_bf16 v[92:95], v[212:215], v[136:139], v[92:95]
    v_lshlrev_b32 v232, 16, v56
    v_and_b32 v233, s12, v56
    v_mfma_f32_16x16x32_bf16 v[88:91], v[216:219], v[128:131], v[88:91]
    v_lshlrev_b32 v234, 16, v57
    v_and_b32 v235, s12, v57
    v_mfma_f32_16x16x32_bf16 v[92:95], v[216:219], v[132:135], v[92:95]
    v_and_b32 v236, s12, v47
    v_lshlrev_b32 v237, 16, v47
    v_mfma_f32_16x16x32_bf16 v[92:95], v[220:223], v[128:131], v[92:95]
    v_and_b32 v238, s12, v46
    v_lshlrev_b32 v239, 16, v46
    v_mfma_f32_16x16x32_bf16 v[64:67], v[160:163], v[96:99], v[64:67]
    v_mul_f32 v236, v236, v26
    v_mul_f32 v237, v237, v26
    v_mfma_f32_16x16x32_bf16 v[68:71], v[160:163], v[100:103], v[68:71]
    ds_read2_b32 v[192:193], v16 offset0:48 offset1:49
    v_mfma_f32_16x16x32_bf16 v[72:75], v[160:163], v[104:107], v[72:75]
    ds_read2_b32 v[194:195], v16 offset0:50 offset1:51
    v_mfma_f32_16x16x32_bf16 v[76:79], v[160:163], v[108:111], v[76:79]
    ds_read_b128 v[128:131], v20 offset:3776
    v_mfma_f32_16x16x32_bf16 v[80:83], v[160:163], v[112:115], v[80:83]
    ds_read_b128 v[132:135], v20 offset:3264
    v_mfma_f32_16x16x32_bf16 v[84:87], v[160:163], v[116:119], v[84:87]
    ds_read_b128 v[136:139], v20 offset:2752
    v_mfma_f32_16x16x32_bf16 v[88:91], v[160:163], v[120:123], v[88:91]
    ds_read_b128 v[140:143], v20 offset:2240
    s_waitcnt lgkmcnt(15)
    v_mfma_f32_16x16x32_bf16 v[92:95], v[160:163], v[124:127], v[92:95]
    ds_read_b128 v[144:147], v20 offset:1728
    s_waitcnt vmcnt(0)
    s_mov_b64 exec, 1
    ds_add_u32 v60, v61 offset:16
    s_mov_b64 exec, -1
    v_mfma_f32_16x16x32_bf16 v[68:71], v[164:167], v[96:99], v[68:71]
    ds_read_b128 v[148:151], v20 offset:1216
    v_mfma_f32_16x16x32_bf16 v[72:75], v[164:167], v[100:103], v[72:75]
    ds_read_b128 v[152:155], v20 offset:704
    v_mfma_f32_16x16x32_bf16 v[76:79], v[164:167], v[104:107], v[76:79]
    ds_read_b128 v[156:159], v20 offset:192
    v_mfma_f32_16x16x32_bf16 v[80:83], v[164:167], v[108:111], v[80:83]
    ds_read2_b32 v[196:197], v16 offset0:176 offset1:177
    v_mfma_f32_16x16x32_bf16 v[84:87], v[164:167], v[112:115], v[84:87]
    ds_read2_b32 v[198:199], v16 offset0:178 offset1:179
    v_mfma_f32_16x16x32_bf16 v[88:91], v[164:167], v[116:119], v[88:91]
    ds_read2_b32 v[200:201], v17 offset0:48 offset1:49
    v_mfma_f32_16x16x32_bf16 v[92:95], v[164:167], v[120:123], v[92:95]
    ds_read2_b32 v[202:203], v17 offset0:50 offset1:51
    v_mfma_f32_16x16x32_bf16 v[72:75], v[168:171], v[96:99], v[72:75]
    ds_read2_b32 v[204:205], v17 offset0:176 offset1:177
    v_mfma_f32_16x16x32_bf16 v[76:79], v[168:171], v[100:103], v[76:79]
    ds_read2_b32 v[206:207], v17 offset0:178 offset1:179
    v_mfma_f32_16x16x32_bf16 v[80:83], v[168:171], v[104:107], v[80:83]
    ds_read2_b32 v[208:209], v18 offset0:48 offset1:49
    v_mfma_f32_16x16x32_bf16 v[84:87], v[168:171], v[108:111], v[84:87]
    ds_read2_b32 v[210:211], v18 offset0:50 offset1:51
    v_mfma_f32_16x16x32_bf16 v[88:91], v[168:171], v[112:115], v[88:91]
    ds_read2_b32 v[212:213], v18 offset0:176 offset1:177
    v_mfma_f32_16x16x32_bf16 v[92:95], v[168:171], v[116:119], v[92:95]
    ds_read2_b32 v[214:215], v18 offset0:178 offset1:179
    s_waitcnt lgkmcnt(15)
    v_mfma_f32_16x16x32_bf16 v[76:79], v[172:175], v[96:99], v[76:79]
    ds_read2_b32 v[216:217], v19 offset0:48 offset1:49
    v_mfma_f32_16x16x32_bf16 v[80:83], v[172:175], v[100:103], v[80:83]
    ds_read2_b32 v[218:219], v19 offset0:50 offset1:51
    v_mfma_f32_16x16x32_bf16 v[84:87], v[172:175], v[104:107], v[84:87]
    ds_read2_b32 v[220:221], v19 offset0:176 offset1:177
    v_mfma_f32_16x16x32_bf16 v[88:91], v[172:175], v[108:111], v[88:91]
    ds_read2_b32 v[222:223], v19 offset0:178 offset1:179
    v_mfma_f32_16x16x32_bf16 v[92:95], v[172:175], v[112:115], v[92:95]
    v_mul_f32 v238, v238, v26
    v_mul_f32 v239, v239, v26
    v_mfma_f32_16x16x32_bf16 v[80:83], v[176:179], v[96:99], v[80:83]
    v_cvt_pk_bf16_f32 v56, v236, v237
    v_cvt_pk_bf16_f32 v57, v238, v239
    v_mfma_f32_16x16x32_bf16 v[84:87], v[176:179], v[100:103], v[84:87]
    v_lshlrev_b32 v236, 16, v56
    v_and_b32 v237, s12, v56
    v_mfma_f32_16x16x32_bf16 v[88:91], v[176:179], v[104:107], v[88:91]
    v_lshlrev_b32 v238, 16, v57
    v_and_b32 v239, s12, v57
    v_mfma_f32_16x16x32_bf16 v[92:95], v[176:179], v[108:111], v[92:95]
    v_and_b32 v240, s12, v49
    v_lshlrev_b32 v241, 16, v49
    v_mfma_f32_16x16x32_bf16 v[84:87], v[180:183], v[96:99], v[84:87]
    v_and_b32 v242, s12, v48
    v_lshlrev_b32 v243, 16, v48
    v_mfma_f32_16x16x32_bf16 v[88:91], v[180:183], v[100:103], v[88:91]
    v_mul_f32 v240, v240, v26
    v_mul_f32 v241, v241, v26
    v_mfma_f32_16x16x32_bf16 v[92:95], v[180:183], v[104:107], v[92:95]
    v_mul_f32 v242, v242, v26
    v_mul_f32 v243, v243, v26
    v_mfma_f32_16x16x32_bf16 v[88:91], v[184:187], v[96:99], v[88:91]
    v_cvt_pk_bf16_f32 v56, v240, v241
    v_cvt_pk_bf16_f32 v57, v242, v243
    v_mfma_f32_16x16x32_bf16 v[92:95], v[184:187], v[100:103], v[92:95]
    v_lshlrev_b32 v240, 16, v56
    v_and_b32 v241, s12, v56
    v_mfma_f32_16x16x32_bf16 v[92:95], v[188:191], v[96:99], v[92:95]
    v_lshlrev_b32 v242, 16, v57
    v_and_b32 v243, s12, v57
    v_mfma_f32_16x16x32_bf16 v[64:67], v[192:195], v[128:131], v[64:67]
    v_and_b32 v244, s12, v51
    v_lshlrev_b32 v245, 16, v51
    v_mfma_f32_16x16x32_bf16 v[68:71], v[192:195], v[132:135], v[68:71]
    ds_read2_b32 v[160:161], v16 offset0:64 offset1:65
    v_mfma_f32_16x16x32_bf16 v[72:75], v[192:195], v[136:139], v[72:75]
    ds_read2_b32 v[162:163], v16 offset0:66 offset1:67
    v_mfma_f32_16x16x32_bf16 v[76:79], v[192:195], v[140:143], v[76:79]
    ds_read_b128 v[96:99], v20 offset:3840
    s_waitcnt lgkmcnt(15)
    v_mfma_f32_16x16x32_bf16 v[80:83], v[192:195], v[144:147], v[80:83]
    ds_read_b128 v[100:103], v20 offset:3328
    v_mfma_f32_16x16x32_bf16 v[84:87], v[192:195], v[148:151], v[84:87]
    ds_read_b128 v[104:107], v20 offset:2816
    v_mfma_f32_16x16x32_bf16 v[88:91], v[192:195], v[152:155], v[88:91]
    ds_read_b128 v[108:111], v20 offset:2304
    v_mfma_f32_16x16x32_bf16 v[92:95], v[192:195], v[156:159], v[92:95]
    ds_read_b128 v[112:115], v20 offset:1792
    v_mfma_f32_16x16x32_bf16 v[68:71], v[196:199], v[128:131], v[68:71]
    ds_read_b128 v[116:119], v20 offset:1280
    v_mfma_f32_16x16x32_bf16 v[72:75], v[196:199], v[132:135], v[72:75]
    ds_read_b128 v[120:123], v20 offset:768
    v_mfma_f32_16x16x32_bf16 v[76:79], v[196:199], v[136:139], v[76:79]
    ds_read_b128 v[124:127], v20 offset:256
    v_mfma_f32_16x16x32_bf16 v[80:83], v[196:199], v[140:143], v[80:83]
    ds_read2_b32 v[164:165], v16 offset0:192 offset1:193
    v_mfma_f32_16x16x32_bf16 v[84:87], v[196:199], v[144:147], v[84:87]
    ds_read2_b32 v[166:167], v16 offset0:194 offset1:195
    v_mfma_f32_16x16x32_bf16 v[88:91], v[196:199], v[148:151], v[88:91]
    ds_read2_b32 v[168:169], v17 offset0:64 offset1:65
    v_mfma_f32_16x16x32_bf16 v[92:95], v[196:199], v[152:155], v[92:95]
    ds_read2_b32 v[170:171], v17 offset0:66 offset1:67
    s_waitcnt lgkmcnt(15)
    v_mfma_f32_16x16x32_bf16 v[72:75], v[200:203], v[128:131], v[72:75]
    ds_read2_b32 v[172:173], v17 offset0:192 offset1:193
    v_mfma_f32_16x16x32_bf16 v[76:79], v[200:203], v[132:135], v[76:79]
    ds_read2_b32 v[174:175], v17 offset0:194 offset1:195
    v_mfma_f32_16x16x32_bf16 v[80:83], v[200:203], v[136:139], v[80:83]
    ds_read2_b32 v[176:177], v18 offset0:64 offset1:65
    v_mfma_f32_16x16x32_bf16 v[84:87], v[200:203], v[140:143], v[84:87]
    ds_read2_b32 v[178:179], v18 offset0:66 offset1:67
    v_mfma_f32_16x16x32_bf16 v[88:91], v[200:203], v[144:147], v[88:91]
    ds_read2_b32 v[180:181], v18 offset0:192 offset1:193
    v_mfma_f32_16x16x32_bf16 v[92:95], v[200:203], v[148:151], v[92:95]
    ds_read2_b32 v[182:183], v18 offset0:194 offset1:195
    v_mfma_f32_16x16x32_bf16 v[76:79], v[204:207], v[128:131], v[76:79]
    ds_read2_b32 v[184:185], v19 offset0:64 offset1:65
    v_mfma_f32_16x16x32_bf16 v[80:83], v[204:207], v[132:135], v[80:83]
    ds_read2_b32 v[186:187], v19 offset0:66 offset1:67
    v_mfma_f32_16x16x32_bf16 v[84:87], v[204:207], v[136:139], v[84:87]
    ds_read2_b32 v[188:189], v19 offset0:192 offset1:193
    v_mfma_f32_16x16x32_bf16 v[88:91], v[204:207], v[140:143], v[88:91]
    ds_read2_b32 v[190:191], v19 offset0:194 offset1:195
    v_mfma_f32_16x16x32_bf16 v[92:95], v[204:207], v[144:147], v[92:95]
    v_and_b32 v246, s12, v50
    v_lshlrev_b32 v247, 16, v50
    v_mfma_f32_16x16x32_bf16 v[80:83], v[208:211], v[128:131], v[80:83]
    v_mul_f32 v244, v244, v26
    v_mul_f32 v245, v245, v26
    v_mfma_f32_16x16x32_bf16 v[84:87], v[208:211], v[132:135], v[84:87]
    v_mul_f32 v246, v246, v26
    v_mul_f32 v247, v247, v26
    v_mfma_f32_16x16x32_bf16 v[88:91], v[208:211], v[136:139], v[88:91]
    v_cvt_pk_bf16_f32 v56, v244, v245
    v_cvt_pk_bf16_f32 v57, v246, v247
    v_mfma_f32_16x16x32_bf16 v[92:95], v[208:211], v[140:143], v[92:95]
    v_lshlrev_b32 v244, 16, v56
    v_and_b32 v245, s12, v56
    v_mfma_f32_16x16x32_bf16 v[84:87], v[212:215], v[128:131], v[84:87]
    v_lshlrev_b32 v246, 16, v57
    v_and_b32 v247, s12, v57
    v_mfma_f32_16x16x32_bf16 v[88:91], v[212:215], v[132:135], v[88:91]
    v_and_b32 v248, s12, v53
    v_lshlrev_b32 v249, 16, v53
    v_mfma_f32_16x16x32_bf16 v[92:95], v[212:215], v[136:139], v[92:95]
    v_and_b32 v250, s12, v52
    v_lshlrev_b32 v251, 16, v52
    v_mfma_f32_16x16x32_bf16 v[88:91], v[216:219], v[128:131], v[88:91]
    v_mul_f32 v248, v248, v26
    v_mul_f32 v249, v249, v26
    v_mfma_f32_16x16x32_bf16 v[92:95], v[216:219], v[132:135], v[92:95]
    v_mul_f32 v250, v250, v26
    v_mul_f32 v251, v251, v26
    s_waitcnt lgkmcnt(15)
    v_mfma_f32_16x16x32_bf16 v[92:95], v[220:223], v[128:131], v[92:95]
    v_cvt_pk_bf16_f32 v56, v248, v249
    v_cvt_pk_bf16_f32 v57, v250, v251
    v_mfma_f32_16x16x32_bf16 v[64:67], v[160:163], v[96:99], v[64:67]
    v_lshlrev_b32 v248, 16, v56
    v_and_b32 v249, s12, v56
    v_mfma_f32_16x16x32_bf16 v[68:71], v[160:163], v[100:103], v[68:71]
    ds_read2_b32 v[192:193], v16 offset0:80 offset1:81
    v_mfma_f32_16x16x32_bf16 v[72:75], v[160:163], v[104:107], v[72:75]
    ds_read2_b32 v[194:195], v16 offset0:82 offset1:83
    v_mfma_f32_16x16x32_bf16 v[76:79], v[160:163], v[108:111], v[76:79]
    ds_read_b128 v[128:131], v20 offset:3904
    v_mfma_f32_16x16x32_bf16 v[80:83], v[160:163], v[112:115], v[80:83]
    ds_read_b128 v[132:135], v20 offset:3392
    v_mfma_f32_16x16x32_bf16 v[84:87], v[160:163], v[116:119], v[84:87]
    ds_read_b128 v[136:139], v20 offset:2880
    v_mfma_f32_16x16x32_bf16 v[88:91], v[160:163], v[120:123], v[88:91]
    ds_read_b128 v[140:143], v20 offset:2368
    s_waitcnt lgkmcnt(15)
    v_mfma_f32_16x16x32_bf16 v[92:95], v[160:163], v[124:127], v[92:95]
    ds_read_b128 v[144:147], v20 offset:1856
    v_mfma_f32_16x16x32_bf16 v[68:71], v[164:167], v[96:99], v[68:71]
    ds_read_b128 v[148:151], v20 offset:1344
    v_mfma_f32_16x16x32_bf16 v[72:75], v[164:167], v[100:103], v[72:75]
    ds_read_b128 v[152:155], v20 offset:832
    v_mfma_f32_16x16x32_bf16 v[76:79], v[164:167], v[104:107], v[76:79]
    ds_read_b128 v[156:159], v20 offset:320
    v_mfma_f32_16x16x32_bf16 v[80:83], v[164:167], v[108:111], v[80:83]
    ds_read2_b32 v[196:197], v16 offset0:208 offset1:209
    v_mfma_f32_16x16x32_bf16 v[84:87], v[164:167], v[112:115], v[84:87]
    ds_read2_b32 v[198:199], v16 offset0:210 offset1:211
    v_mfma_f32_16x16x32_bf16 v[88:91], v[164:167], v[116:119], v[88:91]
    ds_read2_b32 v[200:201], v17 offset0:80 offset1:81
    v_mfma_f32_16x16x32_bf16 v[92:95], v[164:167], v[120:123], v[92:95]
    ds_read2_b32 v[202:203], v17 offset0:82 offset1:83
    v_mfma_f32_16x16x32_bf16 v[72:75], v[168:171], v[96:99], v[72:75]
    ds_read2_b32 v[204:205], v17 offset0:208 offset1:209
    v_mfma_f32_16x16x32_bf16 v[76:79], v[168:171], v[100:103], v[76:79]
    ds_read2_b32 v[206:207], v17 offset0:210 offset1:211
    v_mfma_f32_16x16x32_bf16 v[80:83], v[168:171], v[104:107], v[80:83]
    ds_read2_b32 v[208:209], v18 offset0:80 offset1:81
    v_mfma_f32_16x16x32_bf16 v[84:87], v[168:171], v[108:111], v[84:87]
    ds_read2_b32 v[210:211], v18 offset0:82 offset1:83
    v_mfma_f32_16x16x32_bf16 v[88:91], v[168:171], v[112:115], v[88:91]
    ds_read2_b32 v[212:213], v18 offset0:208 offset1:209
    v_mfma_f32_16x16x32_bf16 v[92:95], v[168:171], v[116:119], v[92:95]
    ds_read2_b32 v[214:215], v18 offset0:210 offset1:211
    s_waitcnt lgkmcnt(15)
    v_mfma_f32_16x16x32_bf16 v[76:79], v[172:175], v[96:99], v[76:79]
    ds_read2_b32 v[216:217], v19 offset0:80 offset1:81
    v_mfma_f32_16x16x32_bf16 v[80:83], v[172:175], v[100:103], v[80:83]
    ds_read2_b32 v[218:219], v19 offset0:82 offset1:83
    v_mfma_f32_16x16x32_bf16 v[84:87], v[172:175], v[104:107], v[84:87]
    ds_read2_b32 v[220:221], v19 offset0:208 offset1:209
    v_mfma_f32_16x16x32_bf16 v[88:91], v[172:175], v[108:111], v[88:91]
    ds_read2_b32 v[222:223], v19 offset0:210 offset1:211
    v_mfma_f32_16x16x32_bf16 v[92:95], v[172:175], v[112:115], v[92:95]
    v_lshlrev_b32 v250, 16, v57
    v_and_b32 v251, s12, v57
    v_mfma_f32_16x16x32_bf16 v[80:83], v[176:179], v[96:99], v[80:83]
    v_and_b32 v252, s12, v55
    v_lshlrev_b32 v253, 16, v55
    v_mfma_f32_16x16x32_bf16 v[84:87], v[176:179], v[100:103], v[84:87]
    v_and_b32 v254, s12, v54
    v_lshlrev_b32 v255, 16, v54
    v_mfma_f32_16x16x32_bf16 v[88:91], v[176:179], v[104:107], v[88:91]
    v_mul_f32 v252, v252, v26
    v_mul_f32 v253, v253, v26
    v_mfma_f32_16x16x32_bf16 v[92:95], v[176:179], v[108:111], v[92:95]
    v_mul_f32 v254, v254, v26
    v_mul_f32 v255, v255, v26
    v_mfma_f32_16x16x32_bf16 v[84:87], v[180:183], v[96:99], v[84:87]
    v_cvt_pk_bf16_f32 v56, v252, v253
    v_cvt_pk_bf16_f32 v57, v254, v255
    v_mfma_f32_16x16x32_bf16 v[88:91], v[180:183], v[100:103], v[88:91]
    v_lshlrev_b32 v252, 16, v56
    v_and_b32 v253, s12, v56
    v_mfma_f32_16x16x32_bf16 v[92:95], v[180:183], v[104:107], v[92:95]
    v_lshlrev_b32 v254, 16, v57
    v_and_b32 v255, s12, v57
    v_mfma_f32_16x16x32_bf16 v[88:91], v[184:187], v[96:99], v[88:91]
    v_mfma_f32_16x16x32_bf16 v[92:95], v[184:187], v[100:103], v[92:95]
    v_mfma_f32_16x16x32_bf16 v[92:95], v[188:191], v[96:99], v[92:95]
    v_mfma_f32_16x16x32_bf16 v[64:67], v[192:195], v[128:131], v[64:67]
    v_mfma_f32_16x16x32_bf16 v[68:71], v[192:195], v[132:135], v[68:71]
    ds_read2_b32 v[160:161], v16 offset0:96 offset1:97
    v_mfma_f32_16x16x32_bf16 v[72:75], v[192:195], v[136:139], v[72:75]
    ds_read2_b32 v[162:163], v16 offset0:98 offset1:99
    s_waitcnt lgkmcnt(15)
    v_mfma_f32_16x16x32_bf16 v[76:79], v[192:195], v[140:143], v[76:79]
    ds_read_b128 v[96:99], v20 offset:3968
    v_mfma_f32_16x16x32_bf16 v[80:83], v[192:195], v[144:147], v[80:83]
    ds_read_b128 v[100:103], v20 offset:3456
    v_mfma_f32_16x16x32_bf16 v[84:87], v[192:195], v[148:151], v[84:87]
    ds_read_b128 v[104:107], v20 offset:2944
    v_mfma_f32_16x16x32_bf16 v[88:91], v[192:195], v[152:155], v[88:91]
    ds_read_b128 v[108:111], v20 offset:2432
    v_mfma_f32_16x16x32_bf16 v[92:95], v[192:195], v[156:159], v[92:95]
    ds_read_b128 v[112:115], v20 offset:1920
    s_waitcnt lgkmcnt(15)
    v_mfma_f32_16x16x32_bf16 v[68:71], v[196:199], v[128:131], v[68:71]
    ds_read_b128 v[116:119], v20 offset:1408
    v_mfma_f32_16x16x32_bf16 v[72:75], v[196:199], v[132:135], v[72:75]
    ds_read_b128 v[120:123], v20 offset:896
    v_mfma_f32_16x16x32_bf16 v[76:79], v[196:199], v[136:139], v[76:79]
    ds_read_b128 v[124:127], v20 offset:384
    v_mfma_f32_16x16x32_bf16 v[80:83], v[196:199], v[140:143], v[80:83]
    ds_read2_b32 v[164:165], v16 offset0:224 offset1:225
    v_mfma_f32_16x16x32_bf16 v[84:87], v[196:199], v[144:147], v[84:87]
    ds_read2_b32 v[166:167], v16 offset0:226 offset1:227
    v_mfma_f32_16x16x32_bf16 v[88:91], v[196:199], v[148:151], v[88:91]
    ds_read2_b32 v[168:169], v17 offset0:96 offset1:97
    v_mfma_f32_16x16x32_bf16 v[92:95], v[196:199], v[152:155], v[92:95]
    ds_read2_b32 v[170:171], v17 offset0:98 offset1:99
    v_mfma_f32_16x16x32_bf16 v[72:75], v[200:203], v[128:131], v[72:75]
    ds_read2_b32 v[172:173], v17 offset0:224 offset1:225
    v_mfma_f32_16x16x32_bf16 v[76:79], v[200:203], v[132:135], v[76:79]
    ds_read2_b32 v[174:175], v17 offset0:226 offset1:227
    v_mfma_f32_16x16x32_bf16 v[80:83], v[200:203], v[136:139], v[80:83]
    ds_read2_b32 v[176:177], v18 offset0:96 offset1:97
    v_mfma_f32_16x16x32_bf16 v[84:87], v[200:203], v[140:143], v[84:87]
    ds_read2_b32 v[178:179], v18 offset0:98 offset1:99
    v_mfma_f32_16x16x32_bf16 v[88:91], v[200:203], v[144:147], v[88:91]
    ds_read2_b32 v[180:181], v18 offset0:224 offset1:225
    s_cmp_le_u32 s15, 0
    s_cselect_b32 s11, 1, 0
    s_lshl_b32 s11, s11, 7
    s_add_u32 s99, s11, s91
    s_add_u32 m0, s10, 0x8000
    s_nop 0
    buffer_load_dwordx4 v28, s[56:59], s99 offen offset:0 lds
    buffer_load_dwordx4 v29, s[56:59], s99 offen offset:1024 lds
    s_add_u32 s11, s11, s90
    s_add_u32 m0, s10, 0xa000
    s_nop 0
    buffer_load_dwordx4 v28, s[56:59], s11 offen offset:0 lds
    buffer_load_dwordx4 v29, s[56:59], s11 offen offset:1024 lds
    s_cmp_le_u32 s15, 0
    s_cselect_b32 s11, 1, 0
    s_lshl_b32 s11, s11, 7
    s_add_u32 s99, s11, s91
    s_add_u32 m0, s10, 0xc000
    s_nop 0
    buffer_load_dwordx4 v28, s[60:63], s99 offen offset:0 lds
    buffer_load_dwordx4 v29, s[60:63], s99 offen offset:1024 lds
    s_add_u32 s11, s11, s90
    s_add_u32 m0, s10, 0xe000
    s_nop 0
    buffer_load_dwordx4 v28, s[60:63], s11 offen offset:0 lds
    buffer_load_dwordx4 v29, s[60:63], s11 offen offset:1024 lds
    v_mfma_f32_16x16x32_bf16 v[92:95], v[200:203], v[148:151], v[92:95]
    ds_read2_b32 v[182:183], v18 offset0:226 offset1:227
    v_mfma_f32_16x16x32_bf16 v[76:79], v[204:207], v[128:131], v[76:79]
    ds_read2_b32 v[184:185], v19 offset0:96 offset1:97
    v_mfma_f32_16x16x32_bf16 v[80:83], v[204:207], v[132:135], v[80:83]
    ds_read2_b32 v[186:187], v19 offset0:98 offset1:99
    v_mfma_f32_16x16x32_bf16 v[84:87], v[204:207], v[136:139], v[84:87]
    ds_read2_b32 v[188:189], v19 offset0:224 offset1:225
    v_mfma_f32_16x16x32_bf16 v[88:91], v[204:207], v[140:143], v[88:91]
    ds_read2_b32 v[190:191], v19 offset0:226 offset1:227
    v_mfma_f32_16x16x32_bf16 v[92:95], v[204:207], v[144:147], v[92:95]
    s_waitcnt lgkmcnt(15)
    v_mfma_f32_16x16x32_bf16 v[80:83], v[208:211], v[128:131], v[80:83]
    v_mfma_f32_16x16x32_bf16 v[84:87], v[208:211], v[132:135], v[84:87]
    v_mfma_f32_16x16x32_bf16 v[88:91], v[208:211], v[136:139], v[88:91]
    v_mfma_f32_16x16x32_bf16 v[92:95], v[208:211], v[140:143], v[92:95]
    v_mfma_f32_16x16x32_bf16 v[84:87], v[212:215], v[128:131], v[84:87]
    v_mfma_f32_16x16x32_bf16 v[88:91], v[212:215], v[132:135], v[88:91]
    v_mfma_f32_16x16x32_bf16 v[92:95], v[212:215], v[136:139], v[92:95]
    v_mfma_f32_16x16x32_bf16 v[88:91], v[216:219], v[128:131], v[88:91]
    v_mfma_f32_16x16x32_bf16 v[92:95], v[216:219], v[132:135], v[92:95]
    v_mfma_f32_16x16x32_bf16 v[92:95], v[220:223], v[128:131], v[92:95]
    v_mfma_f32_16x16x32_bf16 v[64:67], v[160:163], v[96:99], v[64:67]
    v_mfma_f32_16x16x32_bf16 v[68:71], v[160:163], v[100:103], v[68:71]
    ds_read2_b32 v[192:193], v16 offset0:112 offset1:113
    v_mfma_f32_16x16x32_bf16 v[72:75], v[160:163], v[104:107], v[72:75]
    ds_read2_b32 v[194:195], v16 offset0:114 offset1:115
    v_mfma_f32_16x16x32_bf16 v[76:79], v[160:163], v[108:111], v[76:79]
    ds_read_b128 v[128:131], v20 offset:4032
    v_mfma_f32_16x16x32_bf16 v[80:83], v[160:163], v[112:115], v[80:83]
    ds_read_b128 v[132:135], v20 offset:3520
    v_mfma_f32_16x16x32_bf16 v[84:87], v[160:163], v[116:119], v[84:87]
    ds_read_b128 v[136:139], v20 offset:3008
    v_mfma_f32_16x16x32_bf16 v[88:91], v[160:163], v[120:123], v[88:91]
    ds_read_b128 v[140:143], v20 offset:2496
    s_waitcnt lgkmcnt(15)
    v_mfma_f32_16x16x32_bf16 v[92:95], v[160:163], v[124:127], v[92:95]
    ds_read_b128 v[144:147], v20 offset:1984
    v_mfma_f32_16x16x32_bf16 v[68:71], v[164:167], v[96:99], v[68:71]
    ds_read_b128 v[148:151], v20 offset:1472
    v_mfma_f32_16x16x32_bf16 v[72:75], v[164:167], v[100:103], v[72:75]
    ds_read_b128 v[152:155], v20 offset:960
    v_mfma_f32_16x16x32_bf16 v[76:79], v[164:167], v[104:107], v[76:79]
    ds_read_b128 v[156:159], v20 offset:448
    v_mfma_f32_16x16x32_bf16 v[80:83], v[164:167], v[108:111], v[80:83]
    ds_read2_b32 v[196:197], v16 offset0:240 offset1:241
    v_mfma_f32_16x16x32_bf16 v[84:87], v[164:167], v[112:115], v[84:87]
    ds_read2_b32 v[198:199], v16 offset0:242 offset1:243
    v_mfma_f32_16x16x32_bf16 v[88:91], v[164:167], v[116:119], v[88:91]
    ds_read2_b32 v[200:201], v17 offset0:112 offset1:113
    v_mfma_f32_16x16x32_bf16 v[92:95], v[164:167], v[120:123], v[92:95]
    ds_read2_b32 v[202:203], v17 offset0:114 offset1:115
    v_mfma_f32_16x16x32_bf16 v[72:75], v[168:171], v[96:99], v[72:75]
    ds_read2_b32 v[204:205], v17 offset0:240 offset1:241
    v_mfma_f32_16x16x32_bf16 v[76:79], v[168:171], v[100:103], v[76:79]
    ds_read2_b32 v[206:207], v17 offset0:242 offset1:243
    v_mfma_f32_16x16x32_bf16 v[80:83], v[168:171], v[104:107], v[80:83]
    ds_read2_b32 v[208:209], v18 offset0:112 offset1:113
    v_mfma_f32_16x16x32_bf16 v[84:87], v[168:171], v[108:111], v[84:87]
    ds_read2_b32 v[210:211], v18 offset0:114 offset1:115
    v_mfma_f32_16x16x32_bf16 v[88:91], v[168:171], v[112:115], v[88:91]
    ds_read2_b32 v[212:213], v18 offset0:240 offset1:241
    v_mfma_f32_16x16x32_bf16 v[92:95], v[168:171], v[116:119], v[92:95]
    ds_read2_b32 v[214:215], v18 offset0:242 offset1:243
    s_waitcnt lgkmcnt(15)
    v_mfma_f32_16x16x32_bf16 v[76:79], v[172:175], v[96:99], v[76:79]
    ds_read2_b32 v[216:217], v19 offset0:112 offset1:113
    v_mfma_f32_16x16x32_bf16 v[80:83], v[172:175], v[100:103], v[80:83]
    ds_read2_b32 v[218:219], v19 offset0:114 offset1:115
    v_mfma_f32_16x16x32_bf16 v[84:87], v[172:175], v[104:107], v[84:87]
    ds_read2_b32 v[220:221], v19 offset0:240 offset1:241
    v_mfma_f32_16x16x32_bf16 v[88:91], v[172:175], v[108:111], v[88:91]
    ds_read2_b32 v[222:223], v19 offset0:242 offset1:243
    v_mfma_f32_16x16x32_bf16 v[92:95], v[172:175], v[112:115], v[92:95]
    v_mfma_f32_16x16x32_bf16 v[80:83], v[176:179], v[96:99], v[80:83]
    v_mfma_f32_16x16x32_bf16 v[84:87], v[176:179], v[100:103], v[84:87]
    v_mfma_f32_16x16x32_bf16 v[88:91], v[176:179], v[104:107], v[88:91]
    v_mfma_f32_16x16x32_bf16 v[92:95], v[176:179], v[108:111], v[92:95]
    v_mfma_f32_16x16x32_bf16 v[84:87], v[180:183], v[96:99], v[84:87]
    v_mfma_f32_16x16x32_bf16 v[88:91], v[180:183], v[100:103], v[88:91]
    v_mfma_f32_16x16x32_bf16 v[92:95], v[180:183], v[104:107], v[92:95]
    v_mfma_f32_16x16x32_bf16 v[88:91], v[184:187], v[96:99], v[88:91]
    v_mfma_f32_16x16x32_bf16 v[92:95], v[184:187], v[100:103], v[92:95]
    v_mfma_f32_16x16x32_bf16 v[92:95], v[188:191], v[96:99], v[92:95]
    v_mfma_f32_16x16x32_bf16 v[64:67], v[192:195], v[128:131], v[64:67]
    v_mfma_f32_16x16x32_bf16 v[68:71], v[192:195], v[132:135], v[68:71]
    v_mfma_f32_16x16x32_bf16 v[72:75], v[192:195], v[136:139], v[72:75]
    s_waitcnt lgkmcnt(15)
    v_mfma_f32_16x16x32_bf16 v[76:79], v[192:195], v[140:143], v[76:79]
    s_nop 3
    v_cvt_pk_bf16_f32 v56, v64, v65
    v_cvt_pk_bf16_f32 v57, v66, v67
    v_lshlrev_b32 v64, 16, v56
    v_mfma_f32_16x16x32_bf16 v[80:83], v[192:195], v[144:147], v[80:83]
    v_and_b32 v65, s12, v56
    v_lshlrev_b32 v66, 16, v57
    v_and_b32 v67, s12, v57
    v_mfma_f32_16x16x32_bf16 v[84:87], v[192:195], v[148:151], v[84:87]
    v_add_f32 v224, v224, v64
    v_add_f32 v225, v225, v65
    v_add_f32 v226, v226, v66
    v_mfma_f32_16x16x32_bf16 v[88:91], v[192:195], v[152:155], v[88:91]
    v_add_f32 v227, v227, v67
    v_cvt_pk_bf16_f32 v40, v224, v225
    v_cvt_pk_bf16_f32 v41, v226, v227
    s_waitcnt lgkmcnt(14)
    v_mfma_f32_16x16x32_bf16 v[92:95], v[192:195], v[156:159], v[92:95]
    s_waitcnt lgkmcnt(12)
    v_mfma_f32_16x16x32_bf16 v[68:71], v[196:199], v[128:131], v[68:71]
    v_mfma_f32_16x16x32_bf16 v[72:75], v[196:199], v[132:135], v[72:75]
    v_mfma_f32_16x16x32_bf16 v[76:79], v[196:199], v[136:139], v[76:79]
    v_mfma_f32_16x16x32_bf16 v[80:83], v[196:199], v[140:143], v[80:83]
    s_nop 4
    v_cvt_pk_bf16_f32 v56, v68, v69
    v_cvt_pk_bf16_f32 v57, v70, v71
    v_lshlrev_b32 v68, 16, v56
    v_mfma_f32_16x16x32_bf16 v[84:87], v[196:199], v[144:147], v[84:87]
    v_and_b32 v69, s12, v56
    v_lshlrev_b32 v70, 16, v57
    v_and_b32 v71, s12, v57
    v_mfma_f32_16x16x32_bf16 v[88:91], v[196:199], v[148:151], v[88:91]
    v_add_f32 v228, v228, v68
    v_add_f32 v229, v229, v69
    v_add_f32 v230, v230, v70
    v_mfma_f32_16x16x32_bf16 v[92:95], v[196:199], v[152:155], v[92:95]
    v_add_f32 v231, v231, v71
    v_cvt_pk_bf16_f32 v42, v228, v229
    v_cvt_pk_bf16_f32 v43, v230, v231
    s_waitcnt lgkmcnt(10)
    v_mfma_f32_16x16x32_bf16 v[72:75], v[200:203], v[128:131], v[72:75]
    v_permlane16_swap_b32 v40, v42
    v_permlane16_swap_b32 v41, v43
    v_mfma_f32_16x16x32_bf16 v[76:79], v[200:203], v[132:135], v[76:79]
    v_mfma_f32_16x16x32_bf16 v[80:83], v[200:203], v[136:139], v[80:83]
    v_mfma_f32_16x16x32_bf16 v[84:87], v[200:203], v[140:143], v[84:87]
    s_nop 2
    v_cvt_pk_bf16_f32 v56, v72, v73
    v_cvt_pk_bf16_f32 v57, v74, v75
    v_lshlrev_b32 v72, 16, v56
    v_mfma_f32_16x16x32_bf16 v[88:91], v[200:203], v[144:147], v[88:91]
    v_and_b32 v73, s12, v56
    v_lshlrev_b32 v74, 16, v57
    v_and_b32 v75, s12, v57
    v_mfma_f32_16x16x32_bf16 v[92:95], v[200:203], v[148:151], v[92:95]
    v_add_f32 v232, v232, v72
    v_add_f32 v233, v233, v73
    v_add_f32 v234, v234, v74
    s_waitcnt lgkmcnt(8)
    v_mfma_f32_16x16x32_bf16 v[76:79], v[204:207], v[128:131], v[76:79]
    v_add_f32 v235, v235, v75
    v_cvt_pk_bf16_f32 v44, v232, v233
    v_cvt_pk_bf16_f32 v45, v234, v235
    v_mfma_f32_16x16x32_bf16 v[80:83], v[204:207], v[132:135], v[80:83]
    v_mfma_f32_16x16x32_bf16 v[84:87], v[204:207], v[136:139], v[84:87]
    v_mfma_f32_16x16x32_bf16 v[88:91], v[204:207], v[140:143], v[88:91]
    s_nop 1
    v_cvt_pk_bf16_f32 v56, v76, v77
    v_cvt_pk_bf16_f32 v57, v78, v79
    v_lshlrev_b32 v76, 16, v56
    v_mfma_f32_16x16x32_bf16 v[92:95], v[204:207], v[144:147], v[92:95]
    v_and_b32 v77, s12, v56
    v_lshlrev_b32 v78, 16, v57
    v_and_b32 v79, s12, v57
    s_waitcnt lgkmcnt(6)
    v_mfma_f32_16x16x32_bf16 v[80:83], v[208:211], v[128:131], v[80:83]
    v_add_f32 v236, v236, v76
    v_add_f32 v237, v237, v77
    v_add_f32 v238, v238, v78
    v_mfma_f32_16x16x32_bf16 v[84:87], v[208:211], v[132:135], v[84:87]
    v_add_f32 v239, v239, v79
    v_cvt_pk_bf16_f32 v46, v236, v237
    v_cvt_pk_bf16_f32 v47, v238, v239
    v_mfma_f32_16x16x32_bf16 v[88:91], v[208:211], v[136:139], v[88:91]
    v_permlane16_swap_b32 v44, v46
    v_permlane16_swap_b32 v45, v47
    v_mfma_f32_16x16x32_bf16 v[92:95], v[208:211], v[140:143], v[92:95]
    v_cvt_pk_bf16_f32 v56, v80, v81
    v_cvt_pk_bf16_f32 v57, v82, v83
    v_lshlrev_b32 v80, 16, v56
    s_waitcnt lgkmcnt(4)
    v_mfma_f32_16x16x32_bf16 v[84:87], v[212:215], v[128:131], v[84:87]
    v_and_b32 v81, s12, v56
    v_lshlrev_b32 v82, 16, v57
    v_and_b32 v83, s12, v57
    v_mfma_f32_16x16x32_bf16 v[88:91], v[212:215], v[132:135], v[88:91]
    v_add_f32 v240, v240, v80
    v_add_f32 v241, v241, v81
    v_add_f32 v242, v242, v82
    v_mfma_f32_16x16x32_bf16 v[92:95], v[212:215], v[136:139], v[92:95]
    v_add_f32 v243, v243, v83
    v_cvt_pk_bf16_f32 v48, v240, v241
    v_cvt_pk_bf16_f32 v49, v242, v243
    s_waitcnt lgkmcnt(2)
    v_mfma_f32_16x16x32_bf16 v[88:91], v[216:219], v[128:131], v[88:91]
    v_cvt_pk_bf16_f32 v56, v84, v85
    v_cvt_pk_bf16_f32 v57, v86, v87
    v_lshlrev_b32 v84, 16, v56
    v_mfma_f32_16x16x32_bf16 v[92:95], v[216:219], v[132:135], v[92:95]
    v_and_b32 v85, s12, v56
    v_lshlrev_b32 v86, 16, v57
    v_and_b32 v87, s12, v57
    s_waitcnt lgkmcnt(0)
    v_mfma_f32_16x16x32_bf16 v[92:95], v[220:223], v[128:131], v[92:95]
    v_add_f32 v244, v244, v84
    v_add_f32 v245, v245, v85
    v_add_f32 v246, v246, v86
    v_add_f32 v247, v247, v87
    v_cvt_pk_bf16_f32 v50, v244, v245
    v_cvt_pk_bf16_f32 v51, v246, v247
    s_nop 0
    v_permlane16_swap_b32 v48, v50
    v_permlane16_swap_b32 v49, v51
    v_cvt_pk_bf16_f32 v56, v88, v89
    v_cvt_pk_bf16_f32 v57, v90, v91
    v_lshlrev_b32 v88, 16, v56
    v_and_b32 v89, s12, v56
    v_lshlrev_b32 v90, 16, v57
    v_and_b32 v91, s12, v57
    v_add_f32 v248, v248, v88
    v_add_f32 v249, v249, v89
    v_add_f32 v250, v250, v90
    v_add_f32 v251, v251, v91
    v_cvt_pk_bf16_f32 v52, v248, v249
    v_cvt_pk_bf16_f32 v53, v250, v251
    v_cvt_pk_bf16_f32 v56, v92, v93
    v_cvt_pk_bf16_f32 v57, v94, v95
    v_lshlrev_b32 v92, 16, v56
    v_and_b32 v93, s12, v56
    v_lshlrev_b32 v94, 16, v57
    v_and_b32 v95, s12, v57
    v_add_f32 v252, v252, v92
    v_add_f32 v253, v253, v93
    v_add_f32 v254, v254, v94
    v_add_f32 v255, v255, v95
    v_cvt_pk_bf16_f32 v54, v252, v253
    v_cvt_pk_bf16_f32 v55, v254, v255
    s_nop 0
    v_permlane16_swap_b32 v52, v54
    v_permlane16_swap_b32 v53, v55
    buffer_store_dwordx4 v[40:43], v22, s[84:87], 0 offen offset:0 sc1
    buffer_store_dwordx4 v[44:47], v22, s[84:87], 0 offen offset:1024 sc1
    buffer_store_dwordx4 v[48:51], v22, s[84:87], 0 offen offset:2048 sc1
    buffer_store_dwordx4 v[52:55], v22, s[84:87], 0 offen offset:3072 sc1
    v_lshrrev_b32 v8, 4, v1
    s_lshl_b32 s8, s3, 4
    v_add_u32 v8, s8, v8
    v_and_b32 v11, 15, v1
    s_lshl_b32 s9, s5, 11
    s_add_u32 s9, s9, 0x28000
    v_lshl_add_u32 v10, v11, 7, s9
    v_lshlrev_b32 v11, 4, v11
    v_mul_u32_u24 v9, 272, v8
    v_add_u32 v9, v9, v11
    s_lshl_b32 s8, s5, 6
    v_add_u32 v8, s8, v8
    v_lshl_add_u32 v8, v8, 12, v11
    s_lshl_b32 s8, s4, 8
    v_add_u32 v8, s8, v8
    s_mov_b32 s64, s16
    s_mov_b32 s65, s17
    s_mov_b32 s66, 0x400000
    s_mov_b32 s67, 0x20000
    s_lshl_b32 s8, s4, 2
    s_add_u32 s8, s8, s3
    s_lshl_b32 s8, s8, 5
    v_lshrrev_b32 v12, 3, v1
    v_add_u32 v12, s8, v12
    v_lshlrev_b32 v12, 11, v12
    v_and_b32 v11, 7, v1
    v_lshl_add_u32 v12, v11, 4, v12
    s_lshl_b32 s8, s5, 7
    v_add_u32 v12, s8, v12
    s_waitcnt vmcnt(8)
    s_barrier
    s_cmp_le_u32 s15, 1
    s_cselect_b32 s11, 2, 1
    s_lshl_b32 s11, s11, 7
    s_add_u32 s99, s11, s91
    s_add_u32 m0, s10, 0x0
    s_nop 0
    buffer_load_dwordx4 v28, s[56:59], s99 offen offset:0 lds
    buffer_load_dwordx4 v29, s[56:59], s99 offen offset:1024 lds
    s_add_u32 s11, s11, s90
    s_add_u32 m0, s10, 0x2000
    s_nop 0
    buffer_load_dwordx4 v28, s[56:59], s11 offen offset:0 lds
    buffer_load_dwordx4 v29, s[56:59], s11 offen offset:1024 lds
    s_waitcnt vmcnt(8)
    s_barrier
    s_cmp_le_u32 s15, 1
    s_cselect_b32 s11, 2, 1
    s_lshl_b32 s11, s11, 7
    s_add_u32 s99, s11, s91
    s_add_u32 m0, s10, 0x4000
    s_nop 0
    buffer_load_dwordx4 v28, s[60:63], s99 offen offset:0 lds
    buffer_load_dwordx4 v29, s[60:63], s99 offen offset:1024 lds
    s_add_u32 s11, s11, s90
    s_add_u32 m0, s10, 0x6000
    s_nop 0
    buffer_load_dwordx4 v28, s[60:63], s11 offen offset:0 lds
    buffer_load_dwordx4 v29, s[60:63], s11 offen offset:1024 lds
    s_waitcnt vmcnt(4)
    s_barrier
    s_cmp_le_u32 s15, 2
    s_cselect_b32 s11, 3, 2
    s_lshl_b32 s11, s11, 7
    s_add_u32 s99, s11, s91
    s_add_u32 m0, s10, 0x8000
    s_nop 0
    buffer_load_dwordx4 v28, s[56:59], s99 offen offset:0 lds
    buffer_load_dwordx4 v29, s[56:59], s99 offen offset:1024 lds
    s_add_u32 s11, s11, s90
    s_add_u32 m0, s10, 0xa000
    s_nop 0
    buffer_load_dwordx4 v28, s[56:59], s11 offen offset:0 lds
    buffer_load_dwordx4 v29, s[56:59], s11 offen offset:1024 lds
    s_waitcnt vmcnt(4)
    s_barrier
    s_cmp_le_u32 s15, 2
    s_cselect_b32 s11, 3, 2
    s_lshl_b32 s11, s11, 7
    s_add_u32 s99, s11, s91
    s_add_u32 m0, s10, 0xc000
    s_nop 0
    buffer_load_dwordx4 v28, s[60:63], s99 offen offset:0 lds
    buffer_load_dwordx4 v29, s[60:63], s99 offen offset:1024 lds
    s_add_u32 s11, s11, s90
    s_add_u32 m0, s10, 0xe000
    s_nop 0
    buffer_load_dwordx4 v28, s[60:63], s11 offen offset:0 lds
    buffer_load_dwordx4 v29, s[60:63], s11 offen offset:1024 lds
    s_waitcnt vmcnt(4)
    s_barrier
    s_cmp_le_u32 s15, 3
    s_cselect_b32 s11, 4, 3
    s_lshl_b32 s11, s11, 7
    s_add_u32 s99, s11, s91
    s_add_u32 m0, s10, 0x0
    s_nop 0
    buffer_load_dwordx4 v28, s[56:59], s99 offen offset:0 lds
    buffer_load_dwordx4 v29, s[56:59], s99 offen offset:1024 lds
    s_add_u32 s11, s11, s90
    s_add_u32 m0, s10, 0x2000
    s_nop 0
    buffer_load_dwordx4 v28, s[56:59], s11 offen offset:0 lds
    buffer_load_dwordx4 v29, s[56:59], s11 offen offset:1024 lds
    s_mov_b64 exec, 1
    ds_add_rtn_u32 v62, v60, v61 offset:4
    s_mov_b64 exec, -1
    s_waitcnt lgkmcnt(0)
    v_readfirstlane_b32 s83, v62
    s_nop 1
    s_cmp_lg_u32 s83, 3
    s_cbranch_scc1 h_noy
    buffer_store_dword v61, v31, s[92:95], 0 offen sc1
h_noy:
    s_waitcnt vmcnt(4)
    s_barrier
    s_cmp_le_u32 s15, 3
    s_cselect_b32 s11, 4, 3
    s_lshl_b32 s11, s11, 7
    s_add_u32 s99, s11, s91
    s_add_u32 m0, s10, 0x4000
    s_nop 0
    buffer_load_dwordx4 v28, s[60:63], s99 offen offset:0 lds
    buffer_load_dwordx4 v29, s[60:63], s99 offen offset:1024 lds
    s_add_u32 s11, s11, s90
    s_add_u32 m0, s10, 0x6000
    s_nop 0
    buffer_load_dwordx4 v28, s[60:63], s11 offen offset:0 lds
    buffer_load_dwordx4 v29, s[60:63], s11 offen offset:1024 lds
    s_waitcnt vmcnt(4)
    s_barrier
    s_cmp_le_u32 s15, 4
    s_cselect_b32 s11, 5, 4
    s_lshl_b32 s11, s11, 7
    s_add_u32 s99, s11, s91
    s_add_u32 m0, s10, 0x8000
    s_nop 0
    buffer_load_dwordx4 v28, s[56:59], s99 offen offset:0 lds
    buffer_load_dwordx4 v29, s[56:59], s99 offen offset:1024 lds
    s_add_u32 s11, s11, s90
    s_add_u32 m0, s10, 0xa000
    s_nop 0
    buffer_load_dwordx4 v28, s[56:59], s11 offen offset:0 lds
    buffer_load_dwordx4 v29, s[56:59], s11 offen offset:1024 lds
    s_add_u32 m0, s82, 0
    s_mov_b32 s8, 0
    buffer_load_dwordx4 v12, s[64:67], s8 offen lds
    s_add_u32 m0, s82, 1024
    s_mov_b32 s8, 16384
    buffer_load_dwordx4 v12, s[64:67], s8 offen lds
    s_add_u32 m0, s82, 2048
    s_mov_b32 s8, 32768
    buffer_load_dwordx4 v12, s[64:67], s8 offen lds
    s_add_u32 m0, s82, 3072
    s_mov_b32 s8, 49152
    buffer_load_dwordx4 v12, s[64:67], s8 offen lds
    s_waitcnt vmcnt(8)
    s_barrier
    s_cmp_le_u32 s15, 4
    s_cselect_b32 s11, 5, 4
    s_lshl_b32 s11, s11, 7
    s_add_u32 s99, s11, s91
    s_add_u32 m0, s10, 0xc000
    s_nop 0
    buffer_load_dwordx4 v28, s[60:63], s99 offen offset:0 lds
    buffer_load_dwordx4 v29, s[60:63], s99 offen offset:1024 lds
    s_add_u32 s11, s11, s90
    s_add_u32 m0, s10, 0xe000
    s_nop 0
    buffer_load_dwordx4 v28, s[60:63], s11 offen offset:0 lds
    buffer_load_dwordx4 v29, s[60:63], s11 offen offset:1024 lds
    buffer_load_dword v19, v10, s[92:95], 0 offen sc1
    s_waitcnt vmcnt(9)
    s_barrier
    s_cmp_le_u32 s15, 5
    s_cselect_b32 s11, 6, 5
    s_lshl_b32 s11, s11, 7
    s_add_u32 s99, s11, s91
    s_add_u32 m0, s10, 0x0
    s_nop 0
    buffer_load_dwordx4 v28, s[56:59], s99 offen offset:0 lds
    buffer_load_dwordx4 v29, s[56:59], s99 offen offset:1024 lds
    s_add_u32 s11, s11, s90
    s_add_u32 m0, s10, 0x2000
    s_nop 0
    buffer_load_dwordx4 v28, s[56:59], s11 offen offset:0 lds
    buffer_load_dwordx4 v29, s[56:59], s11 offen offset:1024 lds
    s_waitcnt vmcnt(5)
    s_barrier
    s_cmp_le_u32 s15, 5
    s_cselect_b32 s11, 6, 5
    s_lshl_b32 s11, s11, 7
    s_add_u32 s99, s11, s91
    s_add_u32 m0, s10, 0x4000
    s_nop 0
    buffer_load_dwordx4 v28, s[60:63], s99 offen offset:0 lds
    buffer_load_dwordx4 v29, s[60:63], s99 offen offset:1024 lds
    s_add_u32 s11, s11, s90
    s_add_u32 m0, s10, 0x6000
    s_nop 0
    buffer_load_dwordx4 v28, s[60:63], s11 offen offset:0 lds
    buffer_load_dwordx4 v29, s[60:63], s11 offen offset:1024 lds
    s_waitcnt vmcnt(8)
    s_mov_b32 s89, 65536
h_yf_chk:
    v_cmp_ne_u32 vcc, 1, v19
    s_nop 1
    s_cmp_eq_u64 vcc, 0
    s_cbranch_scc1 h_yf_ok
    s_sub_u32 s89, s89, 1
    s_cbranch_scc1 h_yf_ok
    s_sleep 4
    buffer_load_dword v19, v10, s[92:95], 0 offen sc1
    s_waitcnt vmcnt(0)
    s_branch h_yf_chk
h_yf_ok:
    s_mov_b32 s8, 0
    buffer_load_dwordx4 v[116:119], v8, s[68:71], s8 offen sc1
    s_mov_b32 s8, 16384
    buffer_load_dwordx4 v[120:123], v8, s[68:71], s8 offen sc1
    s_mov_b32 s8, 32768
    buffer_load_dwordx4 v[124:127], v8, s[68:71], s8 offen sc1
    s_mov_b32 s8, 49152
    buffer_load_dwordx4 v[128:131], v8, s[68:71], s8 offen sc1
    s_waitcnt vmcnt(8)
    s_barrier
    s_cmp_le_u32 s15, 6
    s_cselect_b32 s11, 7, 6
    s_lshl_b32 s11, s11, 7
    s_add_u32 s99, s11, s91
    s_add_u32 m0, s10, 0x8000
    s_nop 0
    buffer_load_dwordx4 v28, s[56:59], s99 offen offset:0 lds
    buffer_load_dwordx4 v29, s[56:59], s99 offen offset:1024 lds
    s_add_u32 s11, s11, s90
    s_add_u32 m0, s10, 0xa000
    s_nop 0
    buffer_load_dwordx4 v28, s[56:59], s11 offen offset:0 lds
    buffer_load_dwordx4 v29, s[56:59], s11 offen offset:1024 lds
    s_waitcnt vmcnt(8)
    s_barrier
    s_cmp_le_u32 s15, 6
    s_cselect_b32 s11, 7, 6
    s_lshl_b32 s11, s11, 7
    s_add_u32 s99, s11, s91
    s_add_u32 m0, s10, 0xc000
    s_nop 0
    buffer_load_dwordx4 v28, s[60:63], s99 offen offset:0 lds
    buffer_load_dwordx4 v29, s[60:63], s99 offen offset:1024 lds
    s_add_u32 s11, s11, s90
    s_add_u32 m0, s10, 0xe000
    s_nop 0
    buffer_load_dwordx4 v28, s[60:63], s11 offen offset:0 lds
    buffer_load_dwordx4 v29, s[60:63], s11 offen offset:1024 lds
    s_waitcnt vmcnt(8)
    ds_write_b128 v9, v[116:119] offset:0
    ds_write_b128 v9, v[120:123] offset:1088
    ds_write_b128 v9, v[124:127] offset:2176
    ds_write_b128 v9, v[128:131] offset:3264
    s_waitcnt lgkmcnt(0)
    s_waitcnt vmcnt(4)
    s_barrier
    s_waitcnt vmcnt(0)
    s_barrier
    s_endpgm
L_consumer:
    s_setprio 2
    s_and_b32 s6, s3, 1
    s_lshr_b32 s7, s3, 1
    v_and_b32 v4, 31, v1
    s_lshl_b32 s8, s5, 6
    s_lshl_b32 s9, s7, 5
    s_add_u32 s8, s8, s9
    v_add_u32 v3, s8, v4
    v_lshlrev_b32 v5, 1, v3
    v_lshrrev_b32 v6, 5, v1
    s_lshl_b32 s10, s4, 1
    s_add_u32 s10, s10, s6
    s_getpc_b64 s[12:13]
c_pc:
    s_sub_u32 s12, s12, c_pc-gated_mix__ssm_conv_s5__ssm_conv_h3__prompt_kernel
    s_subb_u32 s13, s13, 0
    s_lshl_b32 s11, s3, 14
    v_lshl_add_u32 v24, v1, 7, s11
    v_min_u32 v24, 0x8944, v24
    global_load_dword v25, v24, s[12:13]
    v_add_u32 v24, 0x2000, v24
    v_min_u32 v24, 0x8944, v24
    global_load_dword v26, v24, s[12:13]
    s_waitcnt lgkmcnt(0)
    global_load_ushort v8, v5, s[18:19]
    global_load_ushort v9, v5, s[20:21]
    global_load_ushort v10, v5, s[30:31]
    s_add_u32 s56, s52, 0x1100000
    s_addc_u32 s57, s53, 0
    s_mov_b32 s58, 0x40000
    s_mov_b32 s59, 0x20000
    s_mov_b32 s60, s52
    s_mov_b32 s61, s53
    s_mov_b32 s62, 0x800000
    s_mov_b32 s63, 0x20000
    s_mov_b32 s64, s50
    s_mov_b32 s65, s51
    s_mov_b32 s66, 0x100
    s_mov_b32 s67, 0x20000
    s_add_u32 s68, s52, 0x1200000
    s_addc_u32 s69, s53, 0
    s_mov_b32 s70, 0x50000
    s_mov_b32 s71, 0x20000
    s_lshl_b32 s11, s10, 13
    v_lshl_add_u32 v7, v3, 3, s11
    v_mov_b32 v12, 0
    v_mov_b32 v13, 0
    buffer_store_dwordx2 v[12:13], v7, s[56:59], 0 offen sc1
    s_lshl_b32 s11, s10, 4
    s_add_u32 s11, s11, s5
    s_lshl_b32 s11, s11, 1
    s_add_u32 s11, s11, s7
    s_lshl_b32 s11, s11, 7
    v_mov_b32 v60, s11
    buffer_store_dword v12, v60, s[68:71], 0 offen sc1
    s_lshl_b32 s72, s4, 4
    s_add_u32 s72, s72, s5
    s_lshl_b32 s72, s72, 2
    s_add_u32 s72, s72, s3
    s_lshl_b32 s72, s72, 7
    s_add_u32 s11, s72, 0x30000
    v_mov_b32 v30, s11
    buffer_store_dword v12, v30, s[68:71], 0 offen sc1
    v_mov_b32 v23, 1
    v_bfe_u32 v11, v1, 1, 3
    v_xor_b32 v11, v11, v6
    s_lshl_b32 s11, s6, 13
    v_lshl_add_u32 v14, v4, 7, s11
    s_lshl_b32 s11, s7, 12
    s_add_u32 s11, s11, 16384
    v_lshl_add_u32 v15, v4, 7, s11
    v_xor_b32 v16, 0, v11
    v_lshl_add_u32 v160, v16, 4, v14
    v_lshl_add_u32 v168, v16, 4, v15
    v_add_u32 v164, 0x10000, v160
    v_add_u32 v172, 0x10000, v168
    v_xor_b32 v16, 2, v11
    v_lshl_add_u32 v161, v16, 4, v14
    v_lshl_add_u32 v169, v16, 4, v15
    v_add_u32 v165, 0x10000, v161
    v_add_u32 v173, 0x10000, v169
    v_xor_b32 v16, 4, v11
    v_lshl_add_u32 v162, v16, 4, v14
    v_lshl_add_u32 v170, v16, 4, v15
    v_add_u32 v166, 0x10000, v162
    v_add_u32 v174, 0x10000, v170
    v_xor_b32 v16, 6, v11
    v_lshl_add_u32 v163, v16, 4, v14
    v_lshl_add_u32 v171, v16, 4, v15
    v_add_u32 v167, 0x10000, v163
    v_add_u32 v175, 0x10000, v171
    v_lshlrev_b32 v21, 2, v1
    s_waitcnt vmcnt(0)
    v_lshlrev_b32 v8, 16, v8
    v_lshlrev_b32 v9, 16, v9
    v_lshlrev_b32 v10, 16, v10
    s_mov_b32 s12, 0x3fb8aa3b
    v_mul_f32 v10, s12, v10
    v_exp_f32 v10, v10
    s_nop 0
    v_cvt_pk_bf16_f32 v10, v10, v10
    v_lshlrev_b32 v10, 16, v10
    v_mul_f32 v16, v10, v8
    v_mul_f32 v17, v10, v9
    v_mul_f32 v16, s12, v16
    v_exp_f32 v16, v16
    v_mul_f32 v17, 0.15915494, v17
    v_rndne_f32 v18, v17
    v_sub_f32 v17, v17, v18
    v_cos_f32 v18, v17
    v_sin_f32 v19, v17
    v_mul_f32 v176, v16, v18
    v_mul_f32 v177, v16, v19
    v_add_f32 v16, -1.0, v176
    v_mul_f32 v17, v8, v8
    v_fma_f32 v17, v9, v9, v17
    v_rcp_f32 v17, v17
    v_mul_f32 v18, v16, v8
    v_fma_f32 v18, v177, v9, v18
    v_mul_f32 v19, v177, v8
    v_fma_f32 v19, -v16, v9, v19
    v_add_f32 v17, v17, v17
    v_mul_f32 v178, v18, v17
    v_mul_f32 v179, v19, v17
    v_mul_f32 v16, v176, v176
    v_mul_f32 v17, v176, v177
    v_fma_f32 v16, -v177, v177, v16
    v_fma_f32 v17, v177, v176, v17
    v_mul_f32 v18, v16, v16
    v_mul_f32 v19, v16, v17
    v_fma_f32 v18, -v17, v17, v18
    v_fma_f32 v19, v17, v16, v19
    v_mul_f32 v16, v18, v18
    v_mul_f32 v17, v18, v19
    v_fma_f32 v16, -v19, v19, v16
    v_fma_f32 v17, v19, v18, v17
    v_mul_f32 v180, v16, v16
    v_mul_f32 v181, v16, v17
    v_fma_f32 v180, -v17, v17, v180
    v_fma_f32 v181, v17, v16, v181
    v_mul_f32 v182, v180, v180
    v_mul_f32 v183, v180, v181
    v_fma_f32 v182, -v181, v181, v182
    v_fma_f32 v183, v181, v180, v183
    v_mul_f32 v184, v182, v182
    v_mul_f32 v185, v182, v183
    v_fma_f32 v184, -v183, v183, v184
    v_fma_f32 v185, v183, v182, v185
    v_mul_f32 v186, v184, v184
    v_mul_f32 v187, v184, v185
    v_fma_f32 v186, -v185, v185, v186
    v_fma_f32 v187, v185, v184, v187
    v_mul_f32 v48, v178, v182
    v_mul_f32 v49, v178, v183
    v_fma_f32 v48, -v179, v183, v48
    v_fma_f32 v49, v179, v182, v49
    v_cmp_lt_u32 vcc, 31, v1
    s_nop 1
    v_cndmask_b32 v48, v178, v48, vcc
    v_cndmask_b32 v49, v179, v49, vcc
    v_lshlrev_b32 v50, 13, v6
    v_sub_u32 v50, v7, v50
    s_add_u32 s11, s10, 1
    v_sub_u32 v51, s11, v6
    v_lshrrev_b32 v51, 1, v51
    s_barrier
    s_cmp_lg_u32 s3, 0
    s_cbranch_scc1 c_noflag
    s_lshr_b32 s11, s2, 6
    s_lshl_b32 s11, 1, s11
    s_getreg_b32 s12, hwreg(HW_REG_XCC_ID, 0, 4)
    s_lshl_b32 s12, 0x100, s12
    s_or_b32 s11, s11, s12
    v_mov_b32 v16, s11
    s_and_b32 s11, s2, 63
    s_lshl_b32 s11, s11, 2
    v_mov_b32 v17, s11
    s_mov_b64 exec, 1
    buffer_atomic_or v16, v17, s[64:67], 0 offen sc1
    s_mov_b64 exec, -1
c_noflag:
    ds_read_b128 v[128:131], v160 offset:0
    ds_read_b128 v[144:147], v168 offset:0
    ds_read_b128 v[132:135], v160 offset:4096
    ds_read_b128 v[148:151], v168 offset:8192
    s_waitcnt lgkmcnt(2)
    v_mfma_f32_32x32x16_bf16 v[64:79], v[128:131], v[144:147], 0
    ds_read_b128 v[136:139], v161 offset:0
    s_waitcnt lgkmcnt(2)
    v_mfma_f32_32x32x16_bf16 v[80:95], v[132:135], v[144:147], 0
    ds_read_b128 v[152:155], v169 offset:0
    s_waitcnt lgkmcnt(2)
    v_mfma_f32_32x32x16_bf16 v[112:127], v[132:135], v[148:151], 0
    ds_read_b128 v[140:143], v161 offset:4096
    v_mfma_f32_32x32x16_bf16 v[96:111], v[128:131], v[148:151], 0
    ds_read_b128 v[156:159], v169 offset:8192
    s_waitcnt lgkmcnt(2)
    v_mfma_f32_32x32x16_bf16 v[64:79], v[136:139], v[152:155], v[64:79]
    ds_read_b128 v[128:131], v162 offset:0
    s_waitcnt lgkmcnt(2)
    v_mfma_f32_32x32x16_bf16 v[80:95], v[140:143], v[152:155], v[80:95]
    ds_read_b128 v[144:147], v170 offset:0
    s_waitcnt lgkmcnt(2)
    v_mfma_f32_32x32x16_bf16 v[112:127], v[140:143], v[156:159], v[112:127]
    ds_read_b128 v[132:135], v162 offset:4096
    v_mfma_f32_32x32x16_bf16 v[96:111], v[136:139], v[156:159], v[96:111]
    ds_read_b128 v[148:151], v170 offset:8192
    s_waitcnt lgkmcnt(2)
    v_mfma_f32_32x32x16_bf16 v[64:79], v[128:131], v[144:147], v[64:79]
    ds_read_b128 v[136:139], v163 offset:0
    s_waitcnt lgkmcnt(2)
    v_mfma_f32_32x32x16_bf16 v[80:95], v[132:135], v[144:147], v[80:95]
    ds_read_b128 v[152:155], v171 offset:0
    s_waitcnt lgkmcnt(2)
    v_mfma_f32_32x32x16_bf16 v[112:127], v[132:135], v[148:151], v[112:127]
    ds_read_b128 v[140:143], v163 offset:4096
    v_mfma_f32_32x32x16_bf16 v[96:111], v[128:131], v[148:151], v[96:111]
    ds_read_b128 v[156:159], v171 offset:8192
    s_waitcnt lgkmcnt(0)
    s_barrier
    v_mfma_f32_32x32x16_bf16 v[64:79], v[136:139], v[152:155], v[64:79]
    ds_read_b128 v[128:131], v160 offset:32768
    v_mfma_f32_32x32x16_bf16 v[80:95], v[140:143], v[152:155], v[80:95]
    ds_read_b128 v[144:147], v168 offset:32768
    v_mfma_f32_32x32x16_bf16 v[112:127], v[140:143], v[156:159], v[112:127]
    ds_read_b128 v[132:135], v160 offset:36864
    v_mfma_f32_32x32x16_bf16 v[96:111], v[136:139], v[156:159], v[96:111]
    ds_read_b128 v[148:151], v168 offset:40960
    s_waitcnt lgkmcnt(2)
    v_mfma_f32_32x32x16_bf16 v[64:79], v[128:131], v[144:147], v[64:79]
    ds_read_b128 v[136:139], v161 offset:32768
    s_waitcnt lgkmcnt(2)
    v_mfma_f32_32x32x16_bf16 v[80:95], v[132:135], v[144:147], v[80:95]
    ds_read_b128 v[152:155], v169 offset:32768
    s_waitcnt lgkmcnt(2)
    v_mfma_f32_32x32x16_bf16 v[112:127], v[132:135], v[148:151], v[112:127]
    ds_read_b128 v[140:143], v161 offset:36864
    v_mfma_f32_32x32x16_bf16 v[96:111], v[128:131], v[148:151], v[96:111]
    ds_read_b128 v[156:159], v169 offset:40960
    s_waitcnt lgkmcnt(2)
    v_mfma_f32_32x32x16_bf16 v[64:79], v[136:139], v[152:155], v[64:79]
    ds_read_b128 v[128:131], v162 offset:32768
    s_waitcnt lgkmcnt(2)
    v_mfma_f32_32x32x16_bf16 v[80:95], v[140:143], v[152:155], v[80:95]
    ds_read_b128 v[144:147], v170 offset:32768
    s_waitcnt lgkmcnt(2)
    v_mfma_f32_32x32x16_bf16 v[112:127], v[140:143], v[156:159], v[112:127]
    ds_read_b128 v[132:135], v162 offset:36864
    v_mfma_f32_32x32x16_bf16 v[96:111], v[136:139], v[156:159], v[96:111]
    ds_read_b128 v[148:151], v170 offset:40960
    s_waitcnt lgkmcnt(2)
    v_mfma_f32_32x32x16_bf16 v[64:79], v[128:131], v[144:147], v[64:79]
    ds_read_b128 v[136:139], v163 offset:32768
    s_waitcnt lgkmcnt(2)
    v_mfma_f32_32x32x16_bf16 v[80:95], v[132:135], v[144:147], v[80:95]
    ds_read_b128 v[152:155], v171 offset:32768
    s_waitcnt lgkmcnt(2)
    v_mfma_f32_32x32x16_bf16 v[112:127], v[132:135], v[148:151], v[112:127]
    ds_read_b128 v[140:143], v163 offset:36864
    v_mfma_f32_32x32x16_bf16 v[96:111], v[128:131], v[148:151], v[96:111]
    ds_read_b128 v[156:159], v171 offset:40960
    s_waitcnt lgkmcnt(0)
    s_barrier
    v_mfma_f32_32x32x16_bf16 v[64:79], v[136:139], v[152:155], v[64:79]
    ds_read_b128 v[128:131], v164 offset:0
    v_mfma_f32_32x32x16_bf16 v[80:95], v[140:143], v[152:155], v[80:95]
    ds_read_b128 v[144:147], v172 offset:0
    v_mfma_f32_32x32x16_bf16 v[112:127], v[140:143], v[156:159], v[112:127]
    ds_read_b128 v[132:135], v164 offset:4096
    v_mfma_f32_32x32x16_bf16 v[96:111], v[136:139], v[156:159], v[96:111]
    ds_read_b128 v[148:151], v172 offset:8192
    s_waitcnt lgkmcnt(2)
    v_mfma_f32_32x32x16_bf16 v[64:79], v[128:131], v[144:147], v[64:79]
    ds_read_b128 v[136:139], v165 offset:0
    s_waitcnt lgkmcnt(2)
    v_mfma_f32_32x32x16_bf16 v[80:95], v[132:135], v[144:147], v[80:95]
    ds_read_b128 v[152:155], v173 offset:0
    s_waitcnt lgkmcnt(2)
    v_mfma_f32_32x32x16_bf16 v[112:127], v[132:135], v[148:151], v[112:127]
    ds_read_b128 v[140:143], v165 offset:4096
    v_mfma_f32_32x32x16_bf16 v[96:111], v[128:131], v[148:151], v[96:111]
    ds_read_b128 v[156:159], v173 offset:8192
    s_waitcnt lgkmcnt(2)
    v_mfma_f32_32x32x16_bf16 v[64:79], v[136:139], v[152:155], v[64:79]
    ds_read_b128 v[128:131], v166 offset:0
    s_waitcnt lgkmcnt(2)
    v_mfma_f32_32x32x16_bf16 v[80:95], v[140:143], v[152:155], v[80:95]
    ds_read_b128 v[144:147], v174 offset:0
    s_waitcnt lgkmcnt(2)
    v_mfma_f32_32x32x16_bf16 v[112:127], v[140:143], v[156:159], v[112:127]
    ds_read_b128 v[132:135], v166 offset:4096
    v_mfma_f32_32x32x16_bf16 v[96:111], v[136:139], v[156:159], v[96:111]
    ds_read_b128 v[148:151], v174 offset:8192
    s_waitcnt lgkmcnt(2)
    v_mfma_f32_32x32x16_bf16 v[64:79], v[128:131], v[144:147], v[64:79]
    ds_read_b128 v[136:139], v167 offset:0
    s_waitcnt lgkmcnt(2)
    v_mfma_f32_32x32x16_bf16 v[80:95], v[132:135], v[144:147], v[80:95]
    ds_read_b128 v[152:155], v175 offset:0
    s_waitcnt lgkmcnt(2)
    v_mfma_f32_32x32x16_bf16 v[112:127], v[132:135], v[148:151], v[112:127]
    ds_read_b128 v[140:143], v167 offset:4096
    v_mfma_f32_32x32x16_bf16 v[96:111], v[128:131], v[148:151], v[96:111]
    ds_read_b128 v[156:159], v175 offset:8192
    s_waitcnt lgkmcnt(0)
    s_barrier
    v_mfma_f32_32x32x16_bf16 v[64:79], v[136:139], v[152:155], v[64:79]
    ds_read_b128 v[128:131], v160 offset:0
    v_mfma_f32_32x32x16_bf16 v[80:95], v[140:143], v[152:155], v[80:95]
    ds_read_b128 v[144:147], v168 offset:0
    v_mfma_f32_32x32x16_bf16 v[112:127], v[140:143], v[156:159], v[112:127]
    ds_read_b128 v[132:135], v160 offset:4096
    v_mfma_f32_32x32x16_bf16 v[96:111], v[136:139], v[156:159], v[96:111]
    ds_read_b128 v[148:151], v168 offset:8192
    s_waitcnt lgkmcnt(2)
    v_mfma_f32_32x32x16_bf16 v[64:79], v[128:131], v[144:147], v[64:79]
    ds_read_b128 v[136:139], v161 offset:0
    s_waitcnt lgkmcnt(2)
    v_mfma_f32_32x32x16_bf16 v[80:95], v[132:135], v[144:147], v[80:95]
    ds_read_b128 v[152:155], v169 offset:0
    s_waitcnt lgkmcnt(2)
    v_mfma_f32_32x32x16_bf16 v[112:127], v[132:135], v[148:151], v[112:127]
    ds_read_b128 v[140:143], v161 offset:4096
    v_mfma_f32_32x32x16_bf16 v[96:111], v[128:131], v[148:151], v[96:111]
    ds_read_b128 v[156:159], v169 offset:8192
    s_waitcnt lgkmcnt(2)
    v_mfma_f32_32x32x16_bf16 v[64:79], v[136:139], v[152:155], v[64:79]
    ds_read_b128 v[128:131], v162 offset:0
    s_waitcnt lgkmcnt(2)
    v_mfma_f32_32x32x16_bf16 v[80:95], v[140:143], v[152:155], v[80:95]
    ds_read_b128 v[144:147], v170 offset:0
    s_waitcnt lgkmcnt(2)
    v_mfma_f32_32x32x16_bf16 v[112:127], v[140:143], v[156:159], v[112:127]
    ds_read_b128 v[132:135], v162 offset:4096
    v_mfma_f32_32x32x16_bf16 v[96:111], v[136:139], v[156:159], v[96:111]
    ds_read_b128 v[148:151], v170 offset:8192
    s_waitcnt lgkmcnt(2)
    v_mfma_f32_32x32x16_bf16 v[64:79], v[128:131], v[144:147], v[64:79]
    ds_read_b128 v[136:139], v163 offset:0
    s_waitcnt lgkmcnt(2)
    v_mfma_f32_32x32x16_bf16 v[80:95], v[132:135], v[144:147], v[80:95]
    ds_read_b128 v[152:155], v171 offset:0
    s_waitcnt lgkmcnt(2)
    v_mfma_f32_32x32x16_bf16 v[112:127], v[132:135], v[148:151], v[112:127]
    ds_read_b128 v[140:143], v163 offset:4096
    v_mfma_f32_32x32x16_bf16 v[96:111], v[128:131], v[148:151], v[96:111]
    ds_read_b128 v[156:159], v171 offset:8192
    s_waitcnt lgkmcnt(0)
    s_barrier
    v_mfma_f32_32x32x16_bf16 v[64:79], v[136:139], v[152:155], v[64:79]
    ds_read_b128 v[128:131], v160 offset:32768
    v_mfma_f32_32x32x16_bf16 v[80:95], v[140:143], v[152:155], v[80:95]
    ds_read_b128 v[144:147], v168 offset:32768
    v_mfma_f32_32x32x16_bf16 v[112:127], v[140:143], v[156:159], v[112:127]
    ds_read_b128 v[132:135], v160 offset:36864
    v_mfma_f32_32x32x16_bf16 v[96:111], v[136:139], v[156:159], v[96:111]
    ds_read_b128 v[148:151], v168 offset:40960
    s_waitcnt lgkmcnt(2)
    v_mfma_f32_32x32x16_bf16 v[64:79], v[128:131], v[144:147], v[64:79]
    ds_read_b128 v[136:139], v161 offset:32768
    s_waitcnt lgkmcnt(2)
    v_mfma_f32_32x32x16_bf16 v[80:95], v[132:135], v[144:147], v[80:95]
    ds_read_b128 v[152:155], v169 offset:32768
    s_waitcnt lgkmcnt(2)
    v_mfma_f32_32x32x16_bf16 v[112:127], v[132:135], v[148:151], v[112:127]
    ds_read_b128 v[140:143], v161 offset:36864
    v_mfma_f32_32x32x16_bf16 v[96:111], v[128:131], v[148:151], v[96:111]
    ds_read_b128 v[156:159], v169 offset:40960
    s_waitcnt lgkmcnt(2)
    v_mfma_f32_32x32x16_bf16 v[64:79], v[136:139], v[152:155], v[64:79]
    ds_read_b128 v[128:131], v162 offset:32768
    s_waitcnt lgkmcnt(2)
    v_mfma_f32_32x32x16_bf16 v[80:95], v[140:143], v[152:155], v[80:95]
    ds_read_b128 v[144:147], v170 offset:32768
    s_waitcnt lgkmcnt(2)
    v_mfma_f32_32x32x16_bf16 v[112:127], v[140:143], v[156:159], v[112:127]
    ds_read_b128 v[132:135], v162 offset:36864
    v_mfma_f32_32x32x16_bf16 v[96:111], v[136:139], v[156:159], v[96:111]
    ds_read_b128 v[148:151], v170 offset:40960
    s_waitcnt lgkmcnt(2)
    v_mfma_f32_32x32x16_bf16 v[64:79], v[128:131], v[144:147], v[64:79]
    ds_read_b128 v[136:139], v163 offset:32768
    s_waitcnt lgkmcnt(2)
    v_mfma_f32_32x32x16_bf16 v[80:95], v[132:135], v[144:147], v[80:95]
    ds_read_b128 v[152:155], v171 offset:32768
    s_waitcnt lgkmcnt(2)
    v_mfma_f32_32x32x16_bf16 v[112:127], v[132:135], v[148:151], v[112:127]
    ds_read_b128 v[140:143], v163 offset:36864
    v_mfma_f32_32x32x16_bf16 v[96:111], v[128:131], v[148:151], v[96:111]
    ds_read_b128 v[156:159], v171 offset:40960
    s_waitcnt lgkmcnt(0)
    s_barrier
    v_mfma_f32_32x32x16_bf16 v[64:79], v[136:139], v[152:155], v[64:79]
    ds_read_b128 v[128:131], v164 offset:0
    v_mfma_f32_32x32x16_bf16 v[80:95], v[140:143], v[152:155], v[80:95]
    ds_read_b128 v[144:147], v172 offset:0
    v_mfma_f32_32x32x16_bf16 v[112:127], v[140:143], v[156:159], v[112:127]
    ds_read_b128 v[132:135], v164 offset:4096
    v_mfma_f32_32x32x16_bf16 v[96:111], v[136:139], v[156:159], v[96:111]
    ds_read_b128 v[148:151], v172 offset:8192
    s_waitcnt lgkmcnt(2)
    v_mfma_f32_32x32x16_bf16 v[64:79], v[128:131], v[144:147], v[64:79]
    ds_read_b128 v[136:139], v165 offset:0
    s_waitcnt lgkmcnt(2)
    v_mfma_f32_32x32x16_bf16 v[80:95], v[132:135], v[144:147], v[80:95]
    ds_read_b128 v[152:155], v173 offset:0
    s_waitcnt lgkmcnt(2)
    v_mfma_f32_32x32x16_bf16 v[112:127], v[132:135], v[148:151], v[112:127]
    ds_read_b128 v[140:143], v165 offset:4096
    v_mfma_f32_32x32x16_bf16 v[96:111], v[128:131], v[148:151], v[96:111]
    ds_read_b128 v[156:159], v173 offset:8192
    s_waitcnt lgkmcnt(2)
    v_mfma_f32_32x32x16_bf16 v[64:79], v[136:139], v[152:155], v[64:79]
    ds_read_b128 v[128:131], v166 offset:0
    s_waitcnt lgkmcnt(2)
    v_mfma_f32_32x32x16_bf16 v[80:95], v[140:143], v[152:155], v[80:95]
    ds_read_b128 v[144:147], v174 offset:0
    s_waitcnt lgkmcnt(2)
    v_mfma_f32_32x32x16_bf16 v[112:127], v[140:143], v[156:159], v[112:127]
    ds_read_b128 v[132:135], v166 offset:4096
    v_mfma_f32_32x32x16_bf16 v[96:111], v[136:139], v[156:159], v[96:111]
    ds_read_b128 v[148:151], v174 offset:8192
    s_waitcnt lgkmcnt(2)
    v_mfma_f32_32x32x16_bf16 v[64:79], v[128:131], v[144:147], v[64:79]
    ds_read_b128 v[136:139], v167 offset:0
    s_waitcnt lgkmcnt(2)
    v_mfma_f32_32x32x16_bf16 v[80:95], v[132:135], v[144:147], v[80:95]
    ds_read_b128 v[152:155], v175 offset:0
    s_waitcnt lgkmcnt(2)
    v_mfma_f32_32x32x16_bf16 v[112:127], v[132:135], v[148:151], v[112:127]
    ds_read_b128 v[140:143], v167 offset:4096
    v_mfma_f32_32x32x16_bf16 v[96:111], v[128:131], v[148:151], v[96:111]
    ds_read_b128 v[156:159], v175 offset:8192
    s_waitcnt lgkmcnt(0)
    s_barrier
    v_mfma_f32_32x32x16_bf16 v[64:79], v[136:139], v[152:155], v[64:79]
    ds_read_b128 v[128:131], v160 offset:0
    v_mfma_f32_32x32x16_bf16 v[80:95], v[140:143], v[152:155], v[80:95]
    ds_read_b128 v[144:147], v168 offset:0
    v_mfma_f32_32x32x16_bf16 v[112:127], v[140:143], v[156:159], v[112:127]
    ds_read_b128 v[132:135], v160 offset:4096
    v_mfma_f32_32x32x16_bf16 v[96:111], v[136:139], v[156:159], v[96:111]
    ds_read_b128 v[148:151], v168 offset:8192
    s_waitcnt lgkmcnt(2)
    v_mfma_f32_32x32x16_bf16 v[64:79], v[128:131], v[144:147], v[64:79]
    ds_read_b128 v[136:139], v161 offset:0
    s_waitcnt lgkmcnt(2)
    v_mfma_f32_32x32x16_bf16 v[80:95], v[132:135], v[144:147], v[80:95]
    ds_read_b128 v[152:155], v169 offset:0
    s_waitcnt lgkmcnt(2)
    v_mfma_f32_32x32x16_bf16 v[112:127], v[132:135], v[148:151], v[112:127]
    ds_read_b128 v[140:143], v161 offset:4096
    v_mfma_f32_32x32x16_bf16 v[96:111], v[128:131], v[148:151], v[96:111]
    ds_read_b128 v[156:159], v169 offset:8192
    s_waitcnt lgkmcnt(2)
    v_mfma_f32_32x32x16_bf16 v[64:79], v[136:139], v[152:155], v[64:79]
    ds_read_b128 v[128:131], v162 offset:0
    s_waitcnt lgkmcnt(2)
    v_mfma_f32_32x32x16_bf16 v[80:95], v[140:143], v[152:155], v[80:95]
    ds_read_b128 v[144:147], v170 offset:0
    s_waitcnt lgkmcnt(2)
    v_mfma_f32_32x32x16_bf16 v[112:127], v[140:143], v[156:159], v[112:127]
    ds_read_b128 v[132:135], v162 offset:4096
    v_mfma_f32_32x32x16_bf16 v[96:111], v[136:139], v[156:159], v[96:111]
    ds_read_b128 v[148:151], v170 offset:8192
    s_waitcnt lgkmcnt(2)
    v_mfma_f32_32x32x16_bf16 v[64:79], v[128:131], v[144:147], v[64:79]
    ds_read_b128 v[136:139], v163 offset:0
    s_waitcnt lgkmcnt(2)
    v_mfma_f32_32x32x16_bf16 v[80:95], v[132:135], v[144:147], v[80:95]
    ds_read_b128 v[152:155], v171 offset:0
    s_waitcnt lgkmcnt(2)
    v_mfma_f32_32x32x16_bf16 v[112:127], v[132:135], v[148:151], v[112:127]
    ds_read_b128 v[140:143], v163 offset:4096
    v_mfma_f32_32x32x16_bf16 v[96:111], v[128:131], v[148:151], v[96:111]
    ds_read_b128 v[156:159], v171 offset:8192
    s_waitcnt lgkmcnt(0)
    s_barrier
    v_mfma_f32_32x32x16_bf16 v[64:79], v[136:139], v[152:155], v[64:79]
    ds_read_b128 v[128:131], v160 offset:32768
    v_mfma_f32_32x32x16_bf16 v[80:95], v[140:143], v[152:155], v[80:95]
    ds_read_b128 v[144:147], v168 offset:32768
    v_mfma_f32_32x32x16_bf16 v[112:127], v[140:143], v[156:159], v[112:127]
    ds_read_b128 v[132:135], v160 offset:36864
    v_mfma_f32_32x32x16_bf16 v[96:111], v[136:139], v[156:159], v[96:111]
    ds_read_b128 v[148:151], v168 offset:40960
    s_waitcnt lgkmcnt(2)
    v_mfma_f32_32x32x16_bf16 v[64:79], v[128:131], v[144:147], v[64:79]
    ds_read_b128 v[136:139], v161 offset:32768
    s_waitcnt lgkmcnt(2)
    v_mfma_f32_32x32x16_bf16 v[80:95], v[132:135], v[144:147], v[80:95]
    ds_read_b128 v[152:155], v169 offset:32768
    s_waitcnt lgkmcnt(2)
    v_mfma_f32_32x32x16_bf16 v[112:127], v[132:135], v[148:151], v[112:127]
    ds_read_b128 v[140:143], v161 offset:36864
    v_mfma_f32_32x32x16_bf16 v[96:111], v[128:131], v[148:151], v[96:111]
    ds_read_b128 v[156:159], v169 offset:40960
    s_waitcnt lgkmcnt(2)
    v_mfma_f32_32x32x16_bf16 v[64:79], v[136:139], v[152:155], v[64:79]
    ds_read_b128 v[128:131], v162 offset:32768
    s_waitcnt lgkmcnt(2)
    v_mfma_f32_32x32x16_bf16 v[80:95], v[140:143], v[152:155], v[80:95]
    ds_read_b128 v[144:147], v170 offset:32768
    s_waitcnt lgkmcnt(2)
    v_mfma_f32_32x32x16_bf16 v[112:127], v[140:143], v[156:159], v[112:127]
    ds_read_b128 v[132:135], v162 offset:36864
    v_mfma_f32_32x32x16_bf16 v[96:111], v[136:139], v[156:159], v[96:111]
    ds_read_b128 v[148:151], v170 offset:40960
    s_waitcnt lgkmcnt(2)
    v_mfma_f32_32x32x16_bf16 v[64:79], v[128:131], v[144:147], v[64:79]
    ds_read_b128 v[136:139], v163 offset:32768
    s_waitcnt lgkmcnt(2)
    v_mfma_f32_32x32x16_bf16 v[80:95], v[132:135], v[144:147], v[80:95]
    ds_read_b128 v[152:155], v171 offset:32768
    s_waitcnt lgkmcnt(2)
    v_mfma_f32_32x32x16_bf16 v[112:127], v[132:135], v[148:151], v[112:127]
    ds_read_b128 v[140:143], v163 offset:36864
    v_mfma_f32_32x32x16_bf16 v[96:111], v[128:131], v[148:151], v[96:111]
    ds_read_b128 v[156:159], v171 offset:40960
    s_waitcnt lgkmcnt(0)
    s_barrier
    v_mfma_f32_32x32x16_bf16 v[64:79], v[136:139], v[152:155], v[64:79]
    ds_read_b128 v[128:131], v164 offset:0
    v_mfma_f32_32x32x16_bf16 v[80:95], v[140:143], v[152:155], v[80:95]
    ds_read_b128 v[144:147], v172 offset:0
    v_mfma_f32_32x32x16_bf16 v[112:127], v[140:143], v[156:159], v[112:127]
    ds_read_b128 v[132:135], v164 offset:4096
    v_mfma_f32_32x32x16_bf16 v[96:111], v[136:139], v[156:159], v[96:111]
    ds_read_b128 v[148:151], v172 offset:8192
    s_waitcnt lgkmcnt(2)
    v_mfma_f32_32x32x16_bf16 v[64:79], v[128:131], v[144:147], v[64:79]
    ds_read_b128 v[136:139], v165 offset:0
    s_waitcnt lgkmcnt(2)
    v_mfma_f32_32x32x16_bf16 v[80:95], v[132:135], v[144:147], v[80:95]
    ds_read_b128 v[152:155], v173 offset:0
    s_waitcnt lgkmcnt(2)
    v_mfma_f32_32x32x16_bf16 v[112:127], v[132:135], v[148:151], v[112:127]
    ds_read_b128 v[140:143], v165 offset:4096
    v_mfma_f32_32x32x16_bf16 v[96:111], v[128:131], v[148:151], v[96:111]
    ds_read_b128 v[156:159], v173 offset:8192
    s_waitcnt lgkmcnt(2)
    v_mfma_f32_32x32x16_bf16 v[64:79], v[136:139], v[152:155], v[64:79]
    ds_read_b128 v[128:131], v166 offset:0
    s_waitcnt lgkmcnt(2)
    v_mfma_f32_32x32x16_bf16 v[80:95], v[140:143], v[152:155], v[80:95]
    ds_read_b128 v[144:147], v174 offset:0
    s_waitcnt lgkmcnt(2)
    v_mfma_f32_32x32x16_bf16 v[112:127], v[140:143], v[156:159], v[112:127]
    ds_read_b128 v[132:135], v166 offset:4096
    v_mfma_f32_32x32x16_bf16 v[96:111], v[136:139], v[156:159], v[96:111]
    ds_read_b128 v[148:151], v174 offset:8192
    s_waitcnt lgkmcnt(2)
    v_mfma_f32_32x32x16_bf16 v[64:79], v[128:131], v[144:147], v[64:79]
    ds_read_b128 v[136:139], v167 offset:0
    s_waitcnt lgkmcnt(2)
    v_mfma_f32_32x32x16_bf16 v[80:95], v[132:135], v[144:147], v[80:95]
    ds_read_b128 v[152:155], v175 offset:0
    s_waitcnt lgkmcnt(2)
    v_mfma_f32_32x32x16_bf16 v[112:127], v[132:135], v[148:151], v[112:127]
    ds_read_b128 v[140:143], v167 offset:4096
    v_mfma_f32_32x32x16_bf16 v[96:111], v[128:131], v[148:151], v[96:111]
    ds_read_b128 v[156:159], v175 offset:8192
    s_waitcnt lgkmcnt(0)
    s_barrier
    v_mfma_f32_32x32x16_bf16 v[64:79], v[136:139], v[152:155], v[64:79]
    ds_read_b128 v[128:131], v160 offset:0
    v_mfma_f32_32x32x16_bf16 v[80:95], v[140:143], v[152:155], v[80:95]
    ds_read_b128 v[144:147], v168 offset:0
    v_mfma_f32_32x32x16_bf16 v[112:127], v[140:143], v[156:159], v[112:127]
    ds_read_b128 v[132:135], v160 offset:4096
    v_mfma_f32_32x32x16_bf16 v[96:111], v[136:139], v[156:159], v[96:111]
    ds_read_b128 v[148:151], v168 offset:8192
    s_waitcnt lgkmcnt(2)
    v_mfma_f32_32x32x16_bf16 v[64:79], v[128:131], v[144:147], v[64:79]
    ds_read_b128 v[136:139], v161 offset:0
    s_waitcnt lgkmcnt(2)
    v_mfma_f32_32x32x16_bf16 v[80:95], v[132:135], v[144:147], v[80:95]
    ds_read_b128 v[152:155], v169 offset:0
    s_waitcnt lgkmcnt(2)
    v_mfma_f32_32x32x16_bf16 v[112:127], v[132:135], v[148:151], v[112:127]
    ds_read_b128 v[140:143], v161 offset:4096
    v_mfma_f32_32x32x16_bf16 v[96:111], v[128:131], v[148:151], v[96:111]
    ds_read_b128 v[156:159], v169 offset:8192
    s_waitcnt lgkmcnt(2)
    v_mfma_f32_32x32x16_bf16 v[64:79], v[136:139], v[152:155], v[64:79]
    ds_read_b128 v[128:131], v162 offset:0
    s_waitcnt lgkmcnt(2)
    v_mfma_f32_32x32x16_bf16 v[80:95], v[140:143], v[152:155], v[80:95]
    ds_read_b128 v[144:147], v170 offset:0
    s_waitcnt lgkmcnt(2)
    v_mfma_f32_32x32x16_bf16 v[112:127], v[140:143], v[156:159], v[112:127]
    ds_read_b128 v[132:135], v162 offset:4096
    v_mfma_f32_32x32x16_bf16 v[96:111], v[136:139], v[156:159], v[96:111]
    ds_read_b128 v[148:151], v170 offset:8192
    s_waitcnt lgkmcnt(2)
    v_mfma_f32_32x32x16_bf16 v[64:79], v[128:131], v[144:147], v[64:79]
    ds_read_b128 v[136:139], v163 offset:0
    s_waitcnt lgkmcnt(2)
    v_mfma_f32_32x32x16_bf16 v[80:95], v[132:135], v[144:147], v[80:95]
    ds_read_b128 v[152:155], v171 offset:0
    s_waitcnt lgkmcnt(2)
    v_mfma_f32_32x32x16_bf16 v[112:127], v[132:135], v[148:151], v[112:127]
    ds_read_b128 v[140:143], v163 offset:4096
    v_mfma_f32_32x32x16_bf16 v[96:111], v[128:131], v[148:151], v[96:111]
    ds_read_b128 v[156:159], v171 offset:8192
    s_waitcnt lgkmcnt(0)
    s_barrier
    v_mfma_f32_32x32x16_bf16 v[64:79], v[136:139], v[152:155], v[64:79]
    ds_read_b128 v[128:131], v160 offset:32768
    v_mfma_f32_32x32x16_bf16 v[80:95], v[140:143], v[152:155], v[80:95]
    ds_read_b128 v[144:147], v168 offset:32768
    v_mfma_f32_32x32x16_bf16 v[112:127], v[140:143], v[156:159], v[112:127]
    ds_read_b128 v[132:135], v160 offset:36864
    v_mfma_f32_32x32x16_bf16 v[96:111], v[136:139], v[156:159], v[96:111]
    ds_read_b128 v[148:151], v168 offset:40960
    s_waitcnt lgkmcnt(2)
    v_mfma_f32_32x32x16_bf16 v[64:79], v[128:131], v[144:147], v[64:79]
    ds_read_b128 v[136:139], v161 offset:32768
    s_waitcnt lgkmcnt(2)
    v_mfma_f32_32x32x16_bf16 v[80:95], v[132:135], v[144:147], v[80:95]
    ds_read_b128 v[152:155], v169 offset:32768
    s_waitcnt lgkmcnt(2)
    v_mfma_f32_32x32x16_bf16 v[112:127], v[132:135], v[148:151], v[112:127]
    ds_read_b128 v[140:143], v161 offset:36864
    v_mfma_f32_32x32x16_bf16 v[96:111], v[128:131], v[148:151], v[96:111]
    ds_read_b128 v[156:159], v169 offset:40960
    s_waitcnt lgkmcnt(2)
    v_mfma_f32_32x32x16_bf16 v[64:79], v[136:139], v[152:155], v[64:79]
    ds_read_b128 v[128:131], v162 offset:32768
    s_waitcnt lgkmcnt(2)
    v_mfma_f32_32x32x16_bf16 v[80:95], v[140:143], v[152:155], v[80:95]
    ds_read_b128 v[144:147], v170 offset:32768
    s_waitcnt lgkmcnt(2)
    v_mfma_f32_32x32x16_bf16 v[112:127], v[140:143], v[156:159], v[112:127]
    ds_read_b128 v[132:135], v162 offset:36864
    v_mfma_f32_32x32x16_bf16 v[96:111], v[136:139], v[156:159], v[96:111]
    ds_read_b128 v[148:151], v170 offset:40960
    s_waitcnt lgkmcnt(2)
    v_mfma_f32_32x32x16_bf16 v[64:79], v[128:131], v[144:147], v[64:79]
    ds_read_b128 v[136:139], v163 offset:32768
    s_waitcnt lgkmcnt(2)
    v_mfma_f32_32x32x16_bf16 v[80:95], v[132:135], v[144:147], v[80:95]
    ds_read_b128 v[152:155], v171 offset:32768
    s_waitcnt lgkmcnt(2)
    v_mfma_f32_32x32x16_bf16 v[112:127], v[132:135], v[148:151], v[112:127]
    ds_read_b128 v[140:143], v163 offset:36864
    v_mfma_f32_32x32x16_bf16 v[96:111], v[128:131], v[148:151], v[96:111]
    ds_read_b128 v[156:159], v171 offset:40960
    s_waitcnt lgkmcnt(0)
    s_barrier
    v_mfma_f32_32x32x16_bf16 v[64:79], v[136:139], v[152:155], v[64:79]
    ds_read_b128 v[128:131], v164 offset:0
    v_mfma_f32_32x32x16_bf16 v[80:95], v[140:143], v[152:155], v[80:95]
    ds_read_b128 v[144:147], v172 offset:0
    v_mfma_f32_32x32x16_bf16 v[112:127], v[140:143], v[156:159], v[112:127]
    ds_read_b128 v[132:135], v164 offset:4096
    v_mfma_f32_32x32x16_bf16 v[96:111], v[136:139], v[156:159], v[96:111]
    ds_read_b128 v[148:151], v172 offset:8192
    s_waitcnt lgkmcnt(2)
    v_mfma_f32_32x32x16_bf16 v[64:79], v[128:131], v[144:147], v[64:79]
    ds_read_b128 v[136:139], v165 offset:0
    s_waitcnt lgkmcnt(2)
    v_mfma_f32_32x32x16_bf16 v[80:95], v[132:135], v[144:147], v[80:95]
    ds_read_b128 v[152:155], v173 offset:0
    s_waitcnt lgkmcnt(2)
    v_mfma_f32_32x32x16_bf16 v[112:127], v[132:135], v[148:151], v[112:127]
    ds_read_b128 v[140:143], v165 offset:4096
    v_mfma_f32_32x32x16_bf16 v[96:111], v[128:131], v[148:151], v[96:111]
    ds_read_b128 v[156:159], v173 offset:8192
    s_waitcnt lgkmcnt(2)
    v_mfma_f32_32x32x16_bf16 v[64:79], v[136:139], v[152:155], v[64:79]
    ds_read_b128 v[128:131], v166 offset:0
    s_waitcnt lgkmcnt(2)
    v_mfma_f32_32x32x16_bf16 v[80:95], v[140:143], v[152:155], v[80:95]
    ds_read_b128 v[144:147], v174 offset:0
    s_waitcnt lgkmcnt(2)
    v_mfma_f32_32x32x16_bf16 v[112:127], v[140:143], v[156:159], v[112:127]
    ds_read_b128 v[132:135], v166 offset:4096
    v_mfma_f32_32x32x16_bf16 v[96:111], v[136:139], v[156:159], v[96:111]
    ds_read_b128 v[148:151], v174 offset:8192
    s_waitcnt lgkmcnt(2)
    v_mfma_f32_32x32x16_bf16 v[64:79], v[128:131], v[144:147], v[64:79]
    ds_read_b128 v[136:139], v167 offset:0
    s_waitcnt lgkmcnt(2)
    v_mfma_f32_32x32x16_bf16 v[80:95], v[132:135], v[144:147], v[80:95]
    ds_read_b128 v[152:155], v175 offset:0
    s_waitcnt lgkmcnt(2)
    v_mfma_f32_32x32x16_bf16 v[112:127], v[132:135], v[148:151], v[112:127]
    ds_read_b128 v[140:143], v167 offset:4096
    v_mfma_f32_32x32x16_bf16 v[96:111], v[128:131], v[148:151], v[96:111]
    ds_read_b128 v[156:159], v175 offset:8192
    s_waitcnt lgkmcnt(0)
    s_barrier
    v_mfma_f32_32x32x16_bf16 v[64:79], v[136:139], v[152:155], v[64:79]
    ds_read_b128 v[128:131], v160 offset:0
    v_mfma_f32_32x32x16_bf16 v[80:95], v[140:143], v[152:155], v[80:95]
    ds_read_b128 v[144:147], v168 offset:0
    v_mfma_f32_32x32x16_bf16 v[112:127], v[140:143], v[156:159], v[112:127]
    ds_read_b128 v[132:135], v160 offset:4096
    v_mfma_f32_32x32x16_bf16 v[96:111], v[136:139], v[156:159], v[96:111]
    ds_read_b128 v[148:151], v168 offset:8192
    s_waitcnt lgkmcnt(2)
    v_mfma_f32_32x32x16_bf16 v[64:79], v[128:131], v[144:147], v[64:79]
    ds_read_b128 v[136:139], v161 offset:0
    s_waitcnt lgkmcnt(2)
    v_mfma_f32_32x32x16_bf16 v[80:95], v[132:135], v[144:147], v[80:95]
    ds_read_b128 v[152:155], v169 offset:0
    s_waitcnt lgkmcnt(2)
    v_mfma_f32_32x32x16_bf16 v[112:127], v[132:135], v[148:151], v[112:127]
    ds_read_b128 v[140:143], v161 offset:4096
    v_mfma_f32_32x32x16_bf16 v[96:111], v[128:131], v[148:151], v[96:111]
    ds_read_b128 v[156:159], v169 offset:8192
    buffer_load_dword v20, v21, s[64:67], 0 offen sc1
    s_waitcnt lgkmcnt(2)
    v_mfma_f32_32x32x16_bf16 v[64:79], v[136:139], v[152:155], v[64:79]
    ds_read_b128 v[128:131], v162 offset:0
    s_waitcnt lgkmcnt(2)
    v_mfma_f32_32x32x16_bf16 v[80:95], v[140:143], v[152:155], v[80:95]
    ds_read_b128 v[144:147], v170 offset:0
    s_waitcnt lgkmcnt(2)
    v_mfma_f32_32x32x16_bf16 v[112:127], v[140:143], v[156:159], v[112:127]
    ds_read_b128 v[132:135], v162 offset:4096
    v_mfma_f32_32x32x16_bf16 v[96:111], v[136:139], v[156:159], v[96:111]
    ds_read_b128 v[148:151], v170 offset:8192
    s_waitcnt lgkmcnt(2)
    v_mfma_f32_32x32x16_bf16 v[64:79], v[128:131], v[144:147], v[64:79]
    ds_read_b128 v[136:139], v163 offset:0
    s_waitcnt lgkmcnt(2)
    v_mfma_f32_32x32x16_bf16 v[80:95], v[132:135], v[144:147], v[80:95]
    ds_read_b128 v[152:155], v171 offset:0
    s_waitcnt lgkmcnt(2)
    v_mfma_f32_32x32x16_bf16 v[112:127], v[132:135], v[148:151], v[112:127]
    ds_read_b128 v[140:143], v163 offset:4096
    v_mfma_f32_32x32x16_bf16 v[96:111], v[128:131], v[148:151], v[96:111]
    ds_read_b128 v[156:159], v171 offset:8192
    s_waitcnt lgkmcnt(0)
    s_barrier
    v_mfma_f32_32x32x16_bf16 v[64:79], v[136:139], v[152:155], v[64:79]
    ds_read_b128 v[128:131], v160 offset:32768
    v_mfma_f32_32x32x16_bf16 v[80:95], v[140:143], v[152:155], v[80:95]
    ds_read_b128 v[144:147], v168 offset:32768
    v_mfma_f32_32x32x16_bf16 v[112:127], v[140:143], v[156:159], v[112:127]
    ds_read_b128 v[132:135], v160 offset:36864
    v_mfma_f32_32x32x16_bf16 v[96:111], v[136:139], v[156:159], v[96:111]
    ds_read_b128 v[148:151], v168 offset:40960
    s_waitcnt lgkmcnt(2)
    v_mfma_f32_32x32x16_bf16 v[64:79], v[128:131], v[144:147], v[64:79]
    ds_read_b128 v[136:139], v161 offset:32768
    s_waitcnt lgkmcnt(2)
    v_mfma_f32_32x32x16_bf16 v[80:95], v[132:135], v[144:147], v[80:95]
    ds_read_b128 v[152:155], v169 offset:32768
    s_waitcnt lgkmcnt(2)
    v_mfma_f32_32x32x16_bf16 v[112:127], v[132:135], v[148:151], v[112:127]
    ds_read_b128 v[140:143], v161 offset:36864
    v_mfma_f32_32x32x16_bf16 v[96:111], v[128:131], v[148:151], v[96:111]
    ds_read_b128 v[156:159], v169 offset:40960
    s_waitcnt lgkmcnt(2)
    v_mfma_f32_32x32x16_bf16 v[64:79], v[136:139], v[152:155], v[64:79]
    ds_read_b128 v[128:131], v162 offset:32768
    s_waitcnt lgkmcnt(2)
    v_mfma_f32_32x32x16_bf16 v[80:95], v[140:143], v[152:155], v[80:95]
    ds_read_b128 v[144:147], v170 offset:32768
    s_waitcnt lgkmcnt(2)
    v_mfma_f32_32x32x16_bf16 v[112:127], v[140:143], v[156:159], v[112:127]
    ds_read_b128 v[132:135], v162 offset:36864
    v_mfma_f32_32x32x16_bf16 v[96:111], v[136:139], v[156:159], v[96:111]
    ds_read_b128 v[148:151], v170 offset:40960
    s_waitcnt lgkmcnt(2)
    v_mfma_f32_32x32x16_bf16 v[64:79], v[128:131], v[144:147], v[64:79]
    ds_read_b128 v[136:139], v163 offset:32768
    s_waitcnt lgkmcnt(2)
    v_mfma_f32_32x32x16_bf16 v[80:95], v[132:135], v[144:147], v[80:95]
    ds_read_b128 v[152:155], v171 offset:32768
    s_waitcnt lgkmcnt(2)
    v_mfma_f32_32x32x16_bf16 v[112:127], v[132:135], v[148:151], v[112:127]
    ds_read_b128 v[140:143], v163 offset:36864
    v_mfma_f32_32x32x16_bf16 v[96:111], v[128:131], v[148:151], v[96:111]
    ds_read_b128 v[156:159], v171 offset:40960
    s_waitcnt lgkmcnt(0)
    s_barrier
    v_mfma_f32_32x32x16_bf16 v[64:79], v[136:139], v[152:155], v[64:79]
    ds_read_b128 v[128:131], v164 offset:0
    v_mfma_f32_32x32x16_bf16 v[80:95], v[140:143], v[152:155], v[80:95]
    ds_read_b128 v[144:147], v172 offset:0
    v_mfma_f32_32x32x16_bf16 v[112:127], v[140:143], v[156:159], v[112:127]
    ds_read_b128 v[132:135], v164 offset:4096
    v_mfma_f32_32x32x16_bf16 v[96:111], v[136:139], v[156:159], v[96:111]
    ds_read_b128 v[148:151], v172 offset:8192
    s_waitcnt lgkmcnt(2)
    v_mfma_f32_32x32x16_bf16 v[64:79], v[128:131], v[144:147], v[64:79]
    ds_read_b128 v[136:139], v165 offset:0
    s_waitcnt lgkmcnt(2)
    v_mfma_f32_32x32x16_bf16 v[80:95], v[132:135], v[144:147], v[80:95]
    ds_read_b128 v[152:155], v173 offset:0
    s_waitcnt lgkmcnt(2)
    v_mfma_f32_32x32x16_bf16 v[112:127], v[132:135], v[148:151], v[112:127]
    ds_read_b128 v[140:143], v165 offset:4096
    v_mfma_f32_32x32x16_bf16 v[96:111], v[128:131], v[148:151], v[96:111]
    ds_read_b128 v[156:159], v173 offset:8192
    s_waitcnt lgkmcnt(2)
    v_mfma_f32_32x32x16_bf16 v[64:79], v[136:139], v[152:155], v[64:79]
    ds_read_b128 v[128:131], v166 offset:0
    s_waitcnt lgkmcnt(2)
    v_mfma_f32_32x32x16_bf16 v[80:95], v[140:143], v[152:155], v[80:95]
    ds_read_b128 v[144:147], v174 offset:0
    s_waitcnt lgkmcnt(2)
    v_mfma_f32_32x32x16_bf16 v[112:127], v[140:143], v[156:159], v[112:127]
    ds_read_b128 v[132:135], v166 offset:4096
    v_mfma_f32_32x32x16_bf16 v[96:111], v[136:139], v[156:159], v[96:111]
    ds_read_b128 v[148:151], v174 offset:8192
    s_waitcnt lgkmcnt(2)
    v_mfma_f32_32x32x16_bf16 v[64:79], v[128:131], v[144:147], v[64:79]
    ds_read_b128 v[136:139], v167 offset:0
    s_waitcnt lgkmcnt(2)
    v_mfma_f32_32x32x16_bf16 v[80:95], v[132:135], v[144:147], v[80:95]
    ds_read_b128 v[152:155], v175 offset:0
    s_waitcnt lgkmcnt(2)
    v_mfma_f32_32x32x16_bf16 v[112:127], v[132:135], v[148:151], v[112:127]
    ds_read_b128 v[140:143], v167 offset:4096
    v_mfma_f32_32x32x16_bf16 v[96:111], v[128:131], v[148:151], v[96:111]
    ds_read_b128 v[156:159], v175 offset:8192
    s_waitcnt lgkmcnt(0)
    s_barrier
    v_mfma_f32_32x32x16_bf16 v[64:79], v[136:139], v[152:155], v[64:79]
    ds_read_b128 v[128:131], v160 offset:0
    v_mfma_f32_32x32x16_bf16 v[80:95], v[140:143], v[152:155], v[80:95]
    ds_read_b128 v[144:147], v168 offset:0
    v_mfma_f32_32x32x16_bf16 v[112:127], v[140:143], v[156:159], v[112:127]
    ds_read_b128 v[132:135], v160 offset:4096
    v_mfma_f32_32x32x16_bf16 v[96:111], v[136:139], v[156:159], v[96:111]
    ds_read_b128 v[148:151], v168 offset:8192
    s_waitcnt lgkmcnt(2)
    v_mfma_f32_32x32x16_bf16 v[64:79], v[128:131], v[144:147], v[64:79]
    ds_read_b128 v[136:139], v161 offset:0
    s_waitcnt lgkmcnt(2)
    v_mfma_f32_32x32x16_bf16 v[80:95], v[132:135], v[144:147], v[80:95]
    ds_read_b128 v[152:155], v169 offset:0
    s_waitcnt lgkmcnt(2)
    v_mfma_f32_32x32x16_bf16 v[112:127], v[132:135], v[148:151], v[112:127]
    ds_read_b128 v[140:143], v161 offset:4096
    v_mfma_f32_32x32x16_bf16 v[96:111], v[128:131], v[148:151], v[96:111]
    ds_read_b128 v[156:159], v169 offset:8192
    s_waitcnt lgkmcnt(2)
    v_mfma_f32_32x32x16_bf16 v[64:79], v[136:139], v[152:155], v[64:79]
    ds_read_b128 v[128:131], v162 offset:0
    s_waitcnt lgkmcnt(2)
    v_mfma_f32_32x32x16_bf16 v[80:95], v[140:143], v[152:155], v[80:95]
    ds_read_b128 v[144:147], v170 offset:0
    s_waitcnt lgkmcnt(2)
    v_mfma_f32_32x32x16_bf16 v[112:127], v[140:143], v[156:159], v[112:127]
    ds_read_b128 v[132:135], v162 offset:4096
    v_mfma_f32_32x32x16_bf16 v[96:111], v[136:139], v[156:159], v[96:111]
    ds_read_b128 v[148:151], v170 offset:8192
    s_waitcnt lgkmcnt(2)
    v_mfma_f32_32x32x16_bf16 v[64:79], v[128:131], v[144:147], v[64:79]
    ds_read_b128 v[136:139], v163 offset:0
    s_waitcnt lgkmcnt(2)
    v_mfma_f32_32x32x16_bf16 v[80:95], v[132:135], v[144:147], v[80:95]
    ds_read_b128 v[152:155], v171 offset:0
    s_waitcnt lgkmcnt(2)
    v_mfma_f32_32x32x16_bf16 v[112:127], v[132:135], v[148:151], v[112:127]
    ds_read_b128 v[140:143], v163 offset:4096
    v_mfma_f32_32x32x16_bf16 v[96:111], v[128:131], v[148:151], v[96:111]
    ds_read_b128 v[156:159], v171 offset:8192
    s_waitcnt lgkmcnt(0)
    s_barrier
    v_mfma_f32_32x32x16_bf16 v[64:79], v[136:139], v[152:155], v[64:79]
    v_mfma_f32_32x32x16_bf16 v[80:95], v[140:143], v[152:155], v[80:95]
    v_mfma_f32_32x32x16_bf16 v[112:127], v[140:143], v[156:159], v[112:127]
    v_mfma_f32_32x32x16_bf16 v[96:111], v[136:139], v[156:159], v[96:111]
    s_nop 8
    v_fma_f32 v28, v64, v176, v66
    v_fma_f32 v29, v65, v176, v67
    s_nop 0
    v_fma_f32 v44, v96, v176, v98
    v_fma_f32 v45, v97, v176, v99
    v_fma_f32 v28, v96, -v177, v28
    v_fma_f32 v29, v97, -v177, v29
    v_fma_f32 v44, v64, v177, v44
    v_fma_f32 v45, v65, v177, v45
    v_fma_f32 v24, v28, v176, v68
    v_fma_f32 v25, v29, v176, v69
    v_fma_f32 v26, v44, v176, v100
    v_fma_f32 v27, v45, v176, v101
    v_fma_f32 v24, v44, -v177, v24
    v_fma_f32 v25, v45, -v177, v25
    v_fma_f32 v26, v28, v177, v26
    v_fma_f32 v27, v29, v177, v27
    v_fma_f32 v28, v24, v176, v70
    v_fma_f32 v29, v25, v176, v71
    v_fma_f32 v44, v26, v176, v102
    v_fma_f32 v45, v27, v176, v103
    v_fma_f32 v28, v26, -v177, v28
    v_fma_f32 v29, v27, -v177, v29
    v_fma_f32 v44, v24, v177, v44
    v_fma_f32 v45, v25, v177, v45
    v_fma_f32 v24, v28, v176, v72
    v_fma_f32 v25, v29, v176, v73
    v_fma_f32 v26, v44, v176, v104
    v_fma_f32 v27, v45, v176, v105
    v_fma_f32 v24, v44, -v177, v24
    v_fma_f32 v25, v45, -v177, v25
    v_fma_f32 v26, v28, v177, v26
    v_fma_f32 v27, v29, v177, v27
    v_fma_f32 v28, v24, v176, v74
    v_fma_f32 v29, v25, v176, v75
    v_fma_f32 v44, v26, v176, v106
    v_fma_f32 v45, v27, v176, v107
    v_fma_f32 v28, v26, -v177, v28
    v_fma_f32 v29, v27, -v177, v29
    v_fma_f32 v44, v24, v177, v44
    v_fma_f32 v45, v25, v177, v45
    v_fma_f32 v24, v28, v176, v76
    v_fma_f32 v25, v29, v176, v77
    v_fma_f32 v26, v44, v176, v108
    v_fma_f32 v27, v45, v176, v109
    v_fma_f32 v24, v44, -v177, v24
    v_fma_f32 v25, v45, -v177, v25
    v_fma_f32 v26, v28, v177, v26
    v_fma_f32 v27, v29, v177, v27
    v_fma_f32 v28, v24, v176, v78
    v_fma_f32 v29, v25, v176, v79
    v_fma_f32 v44, v26, v176, v110
    v_fma_f32 v45, v27, v176, v111
    v_fma_f32 v28, v26, -v177, v28
    v_fma_f32 v29, v27, -v177, v29
    v_fma_f32 v44, v24, v177, v44
    v_fma_f32 v45, v25, v177, v45
    v_fma_f32 v24, v28, v176, v80
    v_fma_f32 v25, v29, v176, v81
    v_fma_f32 v26, v44, v176, v112
    v_fma_f32 v27, v45, v176, v113
    v_fma_f32 v24, v44, -v177, v24
    v_fma_f32 v25, v45, -v177, v25
    v_fma_f32 v26, v28, v177, v26
    v_fma_f32 v27, v29, v177, v27
    v_fma_f32 v28, v24, v176, v82
    v_fma_f32 v29, v25, v176, v83
    v_fma_f32 v44, v26, v176, v114
    v_fma_f32 v45, v27, v176, v115
    v_fma_f32 v28, v26, -v177, v28
    v_fma_f32 v29, v27, -v177, v29
    v_fma_f32 v44, v24, v177, v44
    v_fma_f32 v45, v25, v177, v45
    v_fma_f32 v24, v28, v176, v84
    v_fma_f32 v25, v29, v176, v85
    v_fma_f32 v26, v44, v176, v116
    v_fma_f32 v27, v45, v176, v117
    v_fma_f32 v24, v44, -v177, v24
    v_fma_f32 v25, v45, -v177, v25
    v_fma_f32 v26, v28, v177, v26
    v_fma_f32 v27, v29, v177, v27
    v_fma_f32 v28, v24, v176, v86
    v_fma_f32 v29, v25, v176, v87
    v_fma_f32 v44, v26, v176, v118
    v_fma_f32 v45, v27, v176, v119
    v_fma_f32 v28, v26, -v177, v28
    v_fma_f32 v29, v27, -v177, v29
    v_fma_f32 v44, v24, v177, v44
    v_fma_f32 v45, v25, v177, v45
    v_fma_f32 v24, v28, v176, v88
    v_fma_f32 v25, v29, v176, v89
    v_fma_f32 v26, v44, v176, v120
    v_fma_f32 v27, v45, v176, v121
    v_fma_f32 v24, v44, -v177, v24
    v_fma_f32 v25, v45, -v177, v25
    v_fma_f32 v26, v28, v177, v26
    v_fma_f32 v27, v29, v177, v27
    v_fma_f32 v28, v24, v176, v90
    v_fma_f32 v29, v25, v176, v91
    v_fma_f32 v44, v26, v176, v122
    v_fma_f32 v45, v27, v176, v123
    v_fma_f32 v28, v26, -v177, v28
    v_fma_f32 v29, v27, -v177, v29
    v_fma_f32 v44, v24, v177, v44
    v_fma_f32 v45, v25, v177, v45
    v_fma_f32 v24, v28, v176, v92
    v_fma_f32 v25, v29, v176, v93
    v_fma_f32 v26, v44, v176, v124
    v_fma_f32 v27, v45, v176, v125
    v_fma_f32 v24, v44, -v177, v24
    v_fma_f32 v25, v45, -v177, v25
    v_fma_f32 v26, v28, v177, v26
    v_fma_f32 v27, v29, v177, v27
    v_fma_f32 v28, v24, v176, v94
    v_fma_f32 v29, v25, v176, v95
    v_fma_f32 v44, v26, v176, v126
    v_fma_f32 v45, v27, v176, v127
    v_fma_f32 v28, v26, -v177, v28
    v_fma_f32 v29, v27, -v177, v29
    v_fma_f32 v44, v24, v177, v44
    v_fma_f32 v45, v25, v177, v45
    v_mov_b32 v32, v28
    v_mov_b32 v33, v44
    v_mov_b32 v34, v29
    v_mov_b32 v35, v45
    v_fma_f32 v36, v180, v32, v34
    v_fma_f32 v37, v180, v33, v35
    v_fma_f32 v36, -v181, v33, v36
    v_fma_f32 v37, v181, v32, v37
    v_mov_b32 v38, v36
    v_mov_b32 v39, v37
    v_mov_b32 v40, 0
    v_mov_b32 v41, 0
    s_nop 0
    v_permlane32_swap_b32 v40, v38
    v_permlane32_swap_b32 v41, v39
    v_fma_f32 v42, v182, v40, v36
    v_fma_f32 v43, v182, v41, v37
    v_fma_f32 v42, -v183, v41, v42
    v_fma_f32 v43, v183, v40, v43
    v_or_b32 v42, 1, v42
    s_mov_b32 s12, 0
    s_mov_b32 s13, -1
    s_mov_b64 exec, s[12:13]
    buffer_store_dwordx2 v[42:43], v7, s[56:59], 0 offen sc1
    s_mov_b64 exec, -1
    v_mul_f32 v224, v64, v178
    v_mul_f32 v225, v65, v178
    v_fma_f32 v224, v96, -v179, v224
    v_fma_f32 v225, v97, -v179, v225
    v_mul_f32 v96, v96, v178
    v_mul_f32 v97, v97, v178
    v_fma_f32 v96, v64, v179, v96
    v_fma_f32 v97, v65, v179, v97
    v_mul_f32 v226, v66, v178
    v_mul_f32 v227, v67, v178
    v_fma_f32 v226, v98, -v179, v226
    v_fma_f32 v227, v99, -v179, v227
    v_mul_f32 v98, v98, v178
    v_mul_f32 v99, v99, v178
    v_fma_f32 v98, v66, v179, v98
    v_fma_f32 v99, v67, v179, v99
    v_mul_f32 v228, v68, v178
    v_mul_f32 v229, v69, v178
    v_fma_f32 v228, v100, -v179, v228
    v_fma_f32 v229, v101, -v179, v229
    v_mul_f32 v100, v100, v178
    v_mul_f32 v101, v101, v178
    v_fma_f32 v100, v68, v179, v100
    v_fma_f32 v101, v69, v179, v101
    v_mul_f32 v230, v70, v178
    v_mul_f32 v231, v71, v178
    v_fma_f32 v230, v102, -v179, v230
    v_fma_f32 v231, v103, -v179, v231
    v_mul_f32 v102, v102, v178
    v_mul_f32 v103, v103, v178
    v_fma_f32 v102, v70, v179, v102
    v_fma_f32 v103, v71, v179, v103
    v_mul_f32 v232, v72, v178
    v_mul_f32 v233, v73, v178
    v_fma_f32 v232, v104, -v179, v232
    v_fma_f32 v233, v105, -v179, v233
    v_mul_f32 v104, v104, v178
    v_mul_f32 v105, v105, v178
    v_fma_f32 v104, v72, v179, v104
    v_fma_f32 v105, v73, v179, v105
    v_mul_f32 v234, v74, v178
    v_mul_f32 v235, v75, v178
    v_fma_f32 v234, v106, -v179, v234
    v_fma_f32 v235, v107, -v179, v235
    v_mul_f32 v106, v106, v178
    v_mul_f32 v107, v107, v178
    v_fma_f32 v106, v74, v179, v106
    v_fma_f32 v107, v75, v179, v107
    v_mul_f32 v236, v76, v178
    v_mul_f32 v237, v77, v178
    v_fma_f32 v236, v108, -v179, v236
    v_fma_f32 v237, v109, -v179, v237
    v_mul_f32 v108, v108, v178
    v_mul_f32 v109, v109, v178
    v_fma_f32 v108, v76, v179, v108
    v_fma_f32 v109, v77, v179, v109
    v_mul_f32 v238, v78, v178
    v_mul_f32 v239, v79, v178
    v_fma_f32 v238, v110, -v179, v238
    v_fma_f32 v239, v111, -v179, v239
    v_mul_f32 v110, v110, v178
    v_mul_f32 v111, v111, v178
    v_fma_f32 v110, v78, v179, v110
    v_fma_f32 v111, v79, v179, v111
    v_mul_f32 v240, v80, v178
    v_mul_f32 v241, v81, v178
    v_fma_f32 v240, v112, -v179, v240
    v_fma_f32 v241, v113, -v179, v241
    v_mul_f32 v112, v112, v178
    v_mul_f32 v113, v113, v178
    v_fma_f32 v112, v80, v179, v112
    v_fma_f32 v113, v81, v179, v113
    v_mul_f32 v242, v82, v178
    v_mul_f32 v243, v83, v178
    v_fma_f32 v242, v114, -v179, v242
    v_fma_f32 v243, v115, -v179, v243
    v_mul_f32 v114, v114, v178
    v_mul_f32 v115, v115, v178
    v_fma_f32 v114, v82, v179, v114
    v_fma_f32 v115, v83, v179, v115
    v_mul_f32 v244, v84, v178
    v_mul_f32 v245, v85, v178
    v_fma_f32 v244, v116, -v179, v244
    v_fma_f32 v245, v117, -v179, v245
    v_mul_f32 v116, v116, v178
    v_mul_f32 v117, v117, v178
    v_fma_f32 v116, v84, v179, v116
    v_fma_f32 v117, v85, v179, v117
    v_mul_f32 v246, v86, v178
    v_mul_f32 v247, v87, v178
    v_fma_f32 v246, v118, -v179, v246
    v_fma_f32 v247, v119, -v179, v247
    v_mul_f32 v118, v118, v178
    v_mul_f32 v119, v119, v178
    v_fma_f32 v118, v86, v179, v118
    v_fma_f32 v119, v87, v179, v119
    v_mul_f32 v248, v88, v178
    v_mul_f32 v249, v89, v178
    v_fma_f32 v248, v120, -v179, v248
    v_fma_f32 v249, v121, -v179, v249
    v_mul_f32 v120, v120, v178
    v_mul_f32 v121, v121, v178
    v_fma_f32 v120, v88, v179, v120
    v_fma_f32 v121, v89, v179, v121
    v_mul_f32 v250, v90, v178
    v_mul_f32 v251, v91, v178
    v_fma_f32 v250, v122, -v179, v250
    v_fma_f32 v251, v123, -v179, v251
    v_mul_f32 v122, v122, v178
    v_mul_f32 v123, v123, v178
    v_fma_f32 v122, v90, v179, v122
    v_fma_f32 v123, v91, v179, v123
    v_mul_f32 v252, v92, v178
    v_mul_f32 v253, v93, v178
    v_fma_f32 v252, v124, -v179, v252
    v_fma_f32 v253, v125, -v179, v253
    v_mul_f32 v124, v124, v178
    v_mul_f32 v125, v125, v178
    v_fma_f32 v124, v92, v179, v124
    v_fma_f32 v125, v93, v179, v125
    v_mul_f32 v254, v94, v178
    v_mul_f32 v255, v95, v178
    v_fma_f32 v254, v126, -v179, v254
    v_fma_f32 v255, v127, -v179, v255
    v_mul_f32 v126, v126, v178
    v_mul_f32 v127, v127, v178
    v_fma_f32 v126, v94, v179, v126
    v_fma_f32 v127, v95, v179, v127
    v_mul_f32 v44, v178, v40
    v_mul_f32 v45, v178, v41
    v_fma_f32 v44, -v179, v41, v44
    v_fma_f32 v45, v179, v40, v45
    v_mul_f32 v46, v178, v32
    v_mul_f32 v47, v178, v33
    v_fma_f32 v46, -v179, v33, v46
    v_fma_f32 v47, v179, v32, v47
    v_subrev_u32 v128, 0x2000, v50
    v_subrev_u32 v129, 0x6000, v50
    v_subrev_u32 v130, 0xa000, v50
    v_subrev_u32 v131, 0xe000, v50
    v_subrev_u32 v132, 0x12000, v50
    v_subrev_u32 v133, 0x16000, v50
    v_subrev_u32 v134, 0x1a000, v50
    v_subrev_u32 v135, 0x1e000, v50
    v_subrev_u32 v136, 0x22000, v50
    v_subrev_u32 v137, 0x26000, v50
    v_subrev_u32 v138, 0x2a000, v50
    v_subrev_u32 v139, 0x2e000, v50
    v_subrev_u32 v140, 0x32000, v50
    v_subrev_u32 v141, 0x36000, v50
    v_subrev_u32 v142, 0x3a000, v50
    v_subrev_u32 v143, 0x3e000, v50
    s_waitcnt vmcnt(1)
    s_mov_b32 s89, 65536
c_init_chk:
    v_and_b32 v52, 15, v20
    v_cmp_ne_u32 vcc, 15, v52
    s_nop 1
    s_cmp_eq_u64 vcc, 0
    s_cbranch_scc1 c_init_ok
    s_sub_u32 s89, s89, 1
    s_cbranch_scc1 c_init_ok
    s_sleep 4
    buffer_load_dword v20, v21, s[64:67], 0 offen sc1
    s_waitcnt vmcnt(0)
    s_branch c_init_chk
c_init_ok:
    s_getreg_b32 s11, hwreg(HW_REG_XCC_ID, 0, 4)
    s_lshl_b32 s11, 0x100, s11
    s_or_b32 s11, s11, 15
    v_and_b32 v52, 7, v1
    v_cmp_eq_u32 s[12:13], s54, v52
    v_cmp_ne_u32 vcc, s11, v20
    s_nop 1
    s_and_b64 vcc, vcc, s[12:13]
    s_cselect_b32 s14, 0, 1
    buffer_load_dwordx2 v[192:193], v128, s[56:59], 0 offen sc1
    buffer_load_dwordx2 v[194:195], v129, s[56:59], 0 offen sc1
    buffer_load_dwordx2 v[196:197], v130, s[56:59], 0 offen sc1
    buffer_load_dwordx2 v[198:199], v131, s[56:59], 0 offen sc1
    buffer_load_dwordx2 v[200:201], v132, s[56:59], 0 offen sc1
    buffer_load_dwordx2 v[202:203], v133, s[56:59], 0 offen sc1
    buffer_load_dwordx2 v[204:205], v134, s[56:59], 0 offen sc1
    buffer_load_dwordx2 v[206:207], v135, s[56:59], 0 offen sc1
    buffer_load_dwordx2 v[208:209], v136, s[56:59], 0 offen sc1
    buffer_load_dwordx2 v[210:211], v137, s[56:59], 0 offen sc1
    buffer_load_dwordx2 v[212:213], v138, s[56:59], 0 offen sc1
    buffer_load_dwordx2 v[214:215], v139, s[56:59], 0 offen sc1
    buffer_load_dwordx2 v[216:217], v140, s[56:59], 0 offen sc1
    buffer_load_dwordx2 v[218:219], v141, s[56:59], 0 offen sc1
    buffer_load_dwordx2 v[220:221], v142, s[56:59], 0 offen sc1
    buffer_load_dwordx2 v[222:223], v143, s[56:59], 0 offen sc1
    s_mov_b32 s88, 65536
c_poll:
    s_waitcnt vmcnt(0)
    v_mov_b32 v52, 0
    v_and_b32 v144, 1, v192
    v_and_b32 v145, 1, v194
    v_and_b32 v146, 1, v196
    v_and_b32 v147, 1, v198
    v_and_b32 v148, 1, v200
    v_and_b32 v149, 1, v202
    v_and_b32 v150, 1, v204
    v_and_b32 v151, 1, v206
    v_and_b32 v152, 1, v208
    v_and_b32 v153, 1, v210
    v_and_b32 v154, 1, v212
    v_and_b32 v155, 1, v214
    v_and_b32 v156, 1, v216
    v_and_b32 v157, 1, v218
    v_and_b32 v158, 1, v220
    v_and_b32 v159, 1, v222
    v_add3_u32 v52, v52, v144, v145
    v_add3_u32 v52, v52, v146, v147
    v_add3_u32 v52, v52, v148, v149
    v_add3_u32 v52, v52, v150, v151
    v_add3_u32 v52, v52, v152, v153
    v_add3_u32 v52, v52, v154, v155
    v_add3_u32 v52, v52, v156, v157
    v_add3_u32 v52, v52, v158, v159
    v_cmp_ne_u32 vcc, v52, v51
    s_nop 1
    s_cmp_eq_u64 vcc, 0
    s_cbranch_scc1 c_polled
    s_sub_u32 s88, s88, 1
    s_cbranch_scc1 c_polled
    s_sleep 4
    v_cmp_eq_u32 vcc, 0, v144
    s_nop 1
    s_mov_b64 exec, vcc
    buffer_load_dwordx2 v[192:193], v128, s[56:59], 0 offen sc1
    s_mov_b64 exec, -1
    v_cmp_eq_u32 vcc, 0, v145
    s_nop 1
    s_mov_b64 exec, vcc
    buffer_load_dwordx2 v[194:195], v129, s[56:59], 0 offen sc1
    s_mov_b64 exec, -1
    v_cmp_eq_u32 vcc, 0, v146
    s_nop 1
    s_mov_b64 exec, vcc
    buffer_load_dwordx2 v[196:197], v130, s[56:59], 0 offen sc1
    s_mov_b64 exec, -1
    v_cmp_eq_u32 vcc, 0, v147
    s_nop 1
    s_mov_b64 exec, vcc
    buffer_load_dwordx2 v[198:199], v131, s[56:59], 0 offen sc1
    s_mov_b64 exec, -1
    v_cmp_eq_u32 vcc, 0, v148
    s_nop 1
    s_mov_b64 exec, vcc
    buffer_load_dwordx2 v[200:201], v132, s[56:59], 0 offen sc1
    s_mov_b64 exec, -1
    v_cmp_eq_u32 vcc, 0, v149
    s_nop 1
    s_mov_b64 exec, vcc
    buffer_load_dwordx2 v[202:203], v133, s[56:59], 0 offen sc1
    s_mov_b64 exec, -1
    v_cmp_eq_u32 vcc, 0, v150
    s_nop 1
    s_mov_b64 exec, vcc
    buffer_load_dwordx2 v[204:205], v134, s[56:59], 0 offen sc1
    s_mov_b64 exec, -1
    v_cmp_eq_u32 vcc, 0, v151
    s_nop 1
    s_mov_b64 exec, vcc
    buffer_load_dwordx2 v[206:207], v135, s[56:59], 0 offen sc1
    s_mov_b64 exec, -1
    v_cmp_eq_u32 vcc, 0, v152
    s_nop 1
    s_mov_b64 exec, vcc
    buffer_load_dwordx2 v[208:209], v136, s[56:59], 0 offen sc1
    s_mov_b64 exec, -1
    v_cmp_eq_u32 vcc, 0, v153
    s_nop 1
    s_mov_b64 exec, vcc
    buffer_load_dwordx2 v[210:211], v137, s[56:59], 0 offen sc1
    s_mov_b64 exec, -1
    v_cmp_eq_u32 vcc, 0, v154
    s_nop 1
    s_mov_b64 exec, vcc
    buffer_load_dwordx2 v[212:213], v138, s[56:59], 0 offen sc1
    s_mov_b64 exec, -1
    v_cmp_eq_u32 vcc, 0, v155
    s_nop 1
    s_mov_b64 exec, vcc
    buffer_load_dwordx2 v[214:215], v139, s[56:59], 0 offen sc1
    s_mov_b64 exec, -1
    v_cmp_eq_u32 vcc, 0, v156
    s_nop 1
    s_mov_b64 exec, vcc
    buffer_load_dwordx2 v[216:217], v140, s[56:59], 0 offen sc1
    s_mov_b64 exec, -1
    v_cmp_eq_u32 vcc, 0, v157
    s_nop 1
    s_mov_b64 exec, vcc
    buffer_load_dwordx2 v[218:219], v141, s[56:59], 0 offen sc1
    s_mov_b64 exec, -1
    v_cmp_eq_u32 vcc, 0, v158
    s_nop 1
    s_mov_b64 exec, vcc
    buffer_load_dwordx2 v[220:221], v142, s[56:59], 0 offen sc1
    s_mov_b64 exec, -1
    v_cmp_eq_u32 vcc, 0, v159
    s_nop 1
    s_mov_b64 exec, vcc
    buffer_load_dwordx2 v[222:223], v143, s[56:59], 0 offen sc1
    s_mov_b64 exec, -1
    s_branch c_poll
c_polled:
    v_fma_f32 v52, v222, v186, v220
    v_fma_f32 v53, v223, v186, v221
    v_fma_f32 v52, -v223, v187, v52
    v_fma_f32 v53, v222, v187, v53
    v_fma_f32 v54, v52, v186, v218
    v_fma_f32 v55, v53, v186, v219
    v_fma_f32 v54, -v53, v187, v54
    v_fma_f32 v55, v52, v187, v55
    v_fma_f32 v52, v54, v186, v216
    v_fma_f32 v53, v55, v186, v217
    v_fma_f32 v52, -v55, v187, v52
    v_fma_f32 v53, v54, v187, v53
    v_fma_f32 v54, v52, v186, v214
    v_fma_f32 v55, v53, v186, v215
    v_fma_f32 v54, -v53, v187, v54
    v_fma_f32 v55, v52, v187, v55
    v_fma_f32 v52, v54, v186, v212
    v_fma_f32 v53, v55, v186, v213
    v_fma_f32 v52, -v55, v187, v52
    v_fma_f32 v53, v54, v187, v53
    v_fma_f32 v54, v52, v186, v210
    v_fma_f32 v55, v53, v186, v211
    v_fma_f32 v54, -v53, v187, v54
    v_fma_f32 v55, v52, v187, v55
    v_fma_f32 v52, v54, v186, v208
    v_fma_f32 v53, v55, v186, v209
    v_fma_f32 v52, -v55, v187, v52
    v_fma_f32 v53, v54, v187, v53
    v_fma_f32 v54, v52, v186, v206
    v_fma_f32 v55, v53, v186, v207
    v_fma_f32 v54, -v53, v187, v54
    v_fma_f32 v55, v52, v187, v55
    v_fma_f32 v52, v54, v186, v204
    v_fma_f32 v53, v55, v186, v205
    v_fma_f32 v52, -v55, v187, v52
    v_fma_f32 v53, v54, v187, v53
    v_fma_f32 v54, v52, v186, v202
    v_fma_f32 v55, v53, v186, v203
    v_fma_f32 v54, -v53, v187, v54
    v_fma_f32 v55, v52, v187, v55
    v_fma_f32 v52, v54, v186, v200
    v_fma_f32 v53, v55, v186, v201
    v_fma_f32 v52, -v55, v187, v52
    v_fma_f32 v53, v54, v187, v53
    v_fma_f32 v54, v52, v186, v198
    v_fma_f32 v55, v53, v186, v199
    v_fma_f32 v54, -v53, v187, v54
    v_fma_f32 v55, v52, v187, v55
    v_fma_f32 v52, v54, v186, v196
    v_fma_f32 v53, v55, v186, v197
    v_fma_f32 v52, -v55, v187, v52
    v_fma_f32 v53, v54, v187, v53
    v_fma_f32 v54, v52, v186, v194
    v_fma_f32 v55, v53, v186, v195
    v_fma_f32 v54, -v53, v187, v54
    v_fma_f32 v55, v52, v187, v55
    v_fma_f32 v52, v54, v186, v192
    v_fma_f32 v53, v55, v186, v193
    v_fma_f32 v52, -v55, v187, v52
    v_fma_f32 v53, v54, v187, v53
    v_mov_b32 v54, v52
    v_mov_b32 v55, v53
    v_mov_b32 v56, v52
    v_mov_b32 v57, v53
    s_nop 0
    v_permlane32_swap_b32 v54, v56
    v_permlane32_swap_b32 v55, v57
    v_fma_f32 v58, v184, v56, v54
    v_fma_f32 v59, v184, v57, v55
    v_fma_f32 v58, -v185, v57, v58
    v_fma_f32 v59, v185, v56, v59
    v_fma_f32 v52, v48, v58, v44
    v_fma_f32 v53, v48, v59, v45
    v_fma_f32 v52, -v49, v59, v52
    v_fma_f32 v53, v49, v58, v53
    v_fma_f32 v54, v180, v52, v46
    v_fma_f32 v55, v180, v53, v47
    v_fma_f32 v54, -v181, v53, v54
    v_fma_f32 v55, v181, v52, v55
    v_mov_b32 v56, v52
    v_mov_b32 v57, v54
    v_mov_b32 v58, v53
    v_mov_b32 v59, v55
    s_lshl_b32 s11, s3, 13
    v_lshl_add_u32 v16, v6, 11, s11
    v_lshl_add_u32 v16, v4, 6, v16
    v_bfe_u32 v17, v1, 1, 2
    v_xor_b32 v18, 0, v17
    v_lshl_add_u32 v20, v18, 4, v16
    v_xor_b32 v18, 1, v17
    v_lshl_add_u32 v21, v18, 4, v16
    v_xor_b32 v18, 2, v17
    v_lshl_add_u32 v22, v18, 4, v16
    v_xor_b32 v18, 3, v17
    v_lshl_add_u32 v23, v18, 4, v16
    v_mov_b32 v31, 1
    v_fma_f32 v224, v56, v176, v224
    v_fma_f32 v225, v57, v176, v225
    v_fma_f32 v96, v58, v176, v96
    v_fma_f32 v97, v59, v176, v97
    v_fma_f32 v224, v58, -v177, v224
    v_fma_f32 v225, v59, -v177, v225
    v_fma_f32 v96, v56, v177, v96
    v_fma_f32 v97, v57, v177, v97
    v_fma_f32 v226, v224, v176, v226
    v_fma_f32 v227, v225, v176, v227
    v_fma_f32 v98, v96, v176, v98
    v_fma_f32 v99, v97, v176, v99
    v_fma_f32 v226, v96, -v177, v226
    v_fma_f32 v227, v97, -v177, v227
    v_fma_f32 v98, v224, v177, v98
    v_fma_f32 v99, v225, v177, v99
    v_fma_f32 v228, v226, v176, v228
    v_fma_f32 v229, v227, v176, v229
    v_fma_f32 v100, v98, v176, v100
    v_fma_f32 v101, v99, v176, v101
    v_fma_f32 v228, v98, -v177, v228
    v_fma_f32 v229, v99, -v177, v229
    v_fma_f32 v100, v226, v177, v100
    v_fma_f32 v101, v227, v177, v101
    v_fma_f32 v230, v228, v176, v230
    v_fma_f32 v231, v229, v176, v231
    v_fma_f32 v102, v100, v176, v102
    v_fma_f32 v103, v101, v176, v103
    v_fma_f32 v230, v100, -v177, v230
    v_fma_f32 v231, v101, -v177, v231
    v_fma_f32 v102, v228, v177, v102
    v_fma_f32 v103, v229, v177, v103
    v_fma_f32 v232, v230, v176, v232
    v_fma_f32 v233, v231, v176, v233
    v_fma_f32 v104, v102, v176, v104
    v_fma_f32 v105, v103, v176, v105
    v_fma_f32 v232, v102, -v177, v232
    v_fma_f32 v233, v103, -v177, v233
    v_fma_f32 v104, v230, v177, v104
    v_fma_f32 v105, v231, v177, v105
    v_fma_f32 v234, v232, v176, v234
    v_fma_f32 v235, v233, v176, v235
    v_fma_f32 v106, v104, v176, v106
    v_fma_f32 v107, v105, v176, v107
    v_fma_f32 v234, v104, -v177, v234
    v_fma_f32 v235, v105, -v177, v235
    v_fma_f32 v106, v232, v177, v106
    v_fma_f32 v107, v233, v177, v107
    v_fma_f32 v236, v234, v176, v236
    v_fma_f32 v237, v235, v176, v237
    v_fma_f32 v108, v106, v176, v108
    v_fma_f32 v109, v107, v176, v109
    v_fma_f32 v236, v106, -v177, v236
    v_fma_f32 v237, v107, -v177, v237
    v_fma_f32 v108, v234, v177, v108
    v_fma_f32 v109, v235, v177, v109
    v_fma_f32 v238, v236, v176, v238
    v_fma_f32 v239, v237, v176, v239
    v_fma_f32 v110, v108, v176, v110
    v_fma_f32 v111, v109, v176, v111
    v_fma_f32 v238, v108, -v177, v238
    v_fma_f32 v239, v109, -v177, v239
    v_fma_f32 v110, v236, v177, v110
    v_fma_f32 v111, v237, v177, v111
    v_cvt_pk_bf16_f32 v128, v224, v226
    v_cvt_pk_bf16_f32 v129, v228, v230
    v_cvt_pk_bf16_f32 v130, v232, v234
    v_cvt_pk_bf16_f32 v131, v236, v238
    ds_write_b128 v20, v[128:131] offset:0
    v_cvt_pk_bf16_f32 v136, v225, v227
    v_cvt_pk_bf16_f32 v137, v229, v231
    v_cvt_pk_bf16_f32 v138, v233, v235
    v_cvt_pk_bf16_f32 v139, v237, v239
    ds_write_b128 v22, v[136:139] offset:0
    v_cvt_pk_bf16_f32 v144, -v96, -v98
    v_cvt_pk_bf16_f32 v145, -v100, -v102
    v_cvt_pk_bf16_f32 v146, -v104, -v106
    v_cvt_pk_bf16_f32 v147, -v108, -v110
    ds_write_b128 v20, v[144:147] offset:4096
    v_cvt_pk_bf16_f32 v152, -v97, -v99
    v_cvt_pk_bf16_f32 v153, -v101, -v103
    v_cvt_pk_bf16_f32 v154, -v105, -v107
    v_cvt_pk_bf16_f32 v155, -v109, -v111
    ds_write_b128 v22, v[152:155] offset:4096
    v_fma_f32 v240, v238, v176, v240
    v_fma_f32 v241, v239, v176, v241
    v_fma_f32 v112, v110, v176, v112
    v_fma_f32 v113, v111, v176, v113
    v_fma_f32 v240, v110, -v177, v240
    v_fma_f32 v241, v111, -v177, v241
    v_fma_f32 v112, v238, v177, v112
    v_fma_f32 v113, v239, v177, v113
    v_fma_f32 v242, v240, v176, v242
    v_fma_f32 v243, v241, v176, v243
    v_fma_f32 v114, v112, v176, v114
    v_fma_f32 v115, v113, v176, v115
    v_fma_f32 v242, v112, -v177, v242
    v_fma_f32 v243, v113, -v177, v243
    v_fma_f32 v114, v240, v177, v114
    v_fma_f32 v115, v241, v177, v115
    v_fma_f32 v244, v242, v176, v244
    v_fma_f32 v245, v243, v176, v245
    v_fma_f32 v116, v114, v176, v116
    v_fma_f32 v117, v115, v176, v117
    v_fma_f32 v244, v114, -v177, v244
    v_fma_f32 v245, v115, -v177, v245
    v_fma_f32 v116, v242, v177, v116
    v_fma_f32 v117, v243, v177, v117
    v_fma_f32 v246, v244, v176, v246
    v_fma_f32 v247, v245, v176, v247
    v_fma_f32 v118, v116, v176, v118
    v_fma_f32 v119, v117, v176, v119
    v_fma_f32 v246, v116, -v177, v246
    v_fma_f32 v247, v117, -v177, v247
    v_fma_f32 v118, v244, v177, v118
    v_fma_f32 v119, v245, v177, v119
    v_fma_f32 v248, v246, v176, v248
    v_fma_f32 v249, v247, v176, v249
    v_fma_f32 v120, v118, v176, v120
    v_fma_f32 v121, v119, v176, v121
    v_fma_f32 v248, v118, -v177, v248
    v_fma_f32 v249, v119, -v177, v249
    v_fma_f32 v120, v246, v177, v120
    v_fma_f32 v121, v247, v177, v121
    v_fma_f32 v250, v248, v176, v250
    v_fma_f32 v251, v249, v176, v251
    v_fma_f32 v122, v120, v176, v122
    v_fma_f32 v123, v121, v176, v123
    v_fma_f32 v250, v120, -v177, v250
    v_fma_f32 v251, v121, -v177, v251
    v_fma_f32 v122, v248, v177, v122
    v_fma_f32 v123, v249, v177, v123
    v_fma_f32 v252, v250, v176, v252
    v_fma_f32 v253, v251, v176, v253
    v_fma_f32 v124, v122, v176, v124
    v_fma_f32 v125, v123, v176, v125
    v_fma_f32 v252, v122, -v177, v252
    v_fma_f32 v253, v123, -v177, v253
    v_fma_f32 v124, v250, v177, v124
    v_fma_f32 v125, v251, v177, v125
    v_fma_f32 v254, v252, v176, v254
    v_fma_f32 v255, v253, v176, v255
    v_fma_f32 v126, v124, v176, v126
    v_fma_f32 v127, v125, v176, v127
    v_fma_f32 v254, v124, -v177, v254
    v_fma_f32 v255, v125, -v177, v255
    v_fma_f32 v126, v252, v177, v126
    v_fma_f32 v127, v253, v177, v127
    v_cvt_pk_bf16_f32 v132, v240, v242
    v_cvt_pk_bf16_f32 v133, v244, v246
    v_cvt_pk_bf16_f32 v134, v248, v250
    v_cvt_pk_bf16_f32 v135, v252, v254
    ds_write_b128 v21, v[132:135] offset:0
    v_cvt_pk_bf16_f32 v140, v241, v243
    v_cvt_pk_bf16_f32 v141, v245, v247
    v_cvt_pk_bf16_f32 v142, v249, v251
    v_cvt_pk_bf16_f32 v143, v253, v255
    ds_write_b128 v23, v[140:143] offset:0
    v_cvt_pk_bf16_f32 v148, -v112, -v114
    v_cvt_pk_bf16_f32 v149, -v116, -v118
    v_cvt_pk_bf16_f32 v150, -v120, -v122
    v_cvt_pk_bf16_f32 v151, -v124, -v126
    ds_write_b128 v21, v[148:151] offset:4096
    v_cvt_pk_bf16_f32 v156, -v113, -v115
    v_cvt_pk_bf16_f32 v157, -v117, -v119
    v_cvt_pk_bf16_f32 v158, -v121, -v123
    v_cvt_pk_bf16_f32 v159, -v125, -v127
    ds_write_b128 v23, v[156:159] offset:4096
    v_bfe_u32 v16, v1, 2, 2
    v_lshl_add_u32 v16, v6, 3, v16
    v_and_b32 v24, 1, v1
    v_bfe_u32 v18, v1, 4, 1
    v_lshl_add_u32 v24, v24, 1, v18
    v_bfe_u32 v18, v16, 1, 2
    v_xor_b32 v24, v24, v18
    v_lshlrev_b32 v24, 4, v24
    v_lshl_add_u32 v24, v16, 6, v24
    v_bfe_u32 v18, v1, 1, 1
    v_lshl_add_u32 v24, v18, 3, v24
    v_xor_b32 v25, 32, v24
    v_add_u32 v25, 256, v25
    v_add_u32 v17, s11, v24
    v_add_u32 v18, s11, v25
    s_lshl_b32 s11, s4, 7
    s_lshl_b32 s12, s6, 6
    s_add_u32 s11, s11, s12
    s_and_b32 s12, s5, 7
    s_lshl_b32 s12, s12, 2
    s_add_u32 s11, s11, s12
    s_add_u32 s11, s11, s7
    s_lshl_b32 s11, s11, 12
    s_lshr_b32 s13, s5, 3
    s_lshl_b32 s13, s13, 11
    s_add_u32 s11, s11, s13
    v_lshl_add_u32 v19, v1, 4, s11
    v_mov_b32 v20, 0x24a00
    s_waitcnt lgkmcnt(0)
    s_mov_b64 exec, 1
    ds_add_u32 v20, v31 offset:12
    s_mov_b64 exec, -1
    ds_read_b64_tr_b16 v[160:161], v17 offset:0
    ds_read_b64_tr_b16 v[162:163], v18 offset:0
    ds_read_b64_tr_b16 v[164:165], v17 offset:1024
    ds_read_b64_tr_b16 v[166:167], v18 offset:1024
    ds_read_b64_tr_b16 v[168:169], v17 offset:4096
    ds_read_b64_tr_b16 v[170:171], v18 offset:4096
    ds_read_b64_tr_b16 v[172:173], v17 offset:5120
    ds_read_b64_tr_b16 v[174:175], v18 offset:5120
    ds_read_b64_tr_b16 v[176:177], v17 offset:2048
    ds_read_b64_tr_b16 v[178:179], v18 offset:2048
    ds_read_b64_tr_b16 v[180:181], v17 offset:3072
    ds_read_b64_tr_b16 v[182:183], v18 offset:3072
    ds_read_b64_tr_b16 v[184:185], v17 offset:6144
    ds_read_b64_tr_b16 v[186:187], v18 offset:6144
    ds_read_b64_tr_b16 v[188:189], v17 offset:7168
    ds_read_b64_tr_b16 v[190:191], v18 offset:7168
    s_mov_b32 s12, 0x0
    s_waitcnt lgkmcnt(14)
    buffer_store_dwordx4 v[160:163], v19, s[60:63], s12 offen offset:0 sc1
    s_waitcnt lgkmcnt(12)
    buffer_store_dwordx4 v[164:167], v19, s[60:63], s12 offen offset:1024 sc1
    s_mov_b32 s12, 0x2000
    s_waitcnt lgkmcnt(10)
    buffer_store_dwordx4 v[168:171], v19, s[60:63], s12 offen offset:0 sc1
    s_waitcnt lgkmcnt(8)
    buffer_store_dwordx4 v[172:175], v19, s[60:63], s12 offen offset:1024 sc1
    s_mov_b32 s12, 0x20000
    s_waitcnt lgkmcnt(6)
    buffer_store_dwordx4 v[176:179], v19, s[60:63], s12 offen offset:0 sc1
    s_waitcnt lgkmcnt(4)
    buffer_store_dwordx4 v[180:183], v19, s[60:63], s12 offen offset:1024 sc1
    s_mov_b32 s12, 0x22000
    s_waitcnt lgkmcnt(2)
    buffer_store_dwordx4 v[184:187], v19, s[60:63], s12 offen offset:0 sc1
    s_waitcnt lgkmcnt(0)
    buffer_store_dwordx4 v[188:191], v19, s[60:63], s12 offen offset:1024 sc1
    s_lshl_b32 s6, s4, 2
    s_add_u32 s6, s6, s3
    s_lshr_b32 s7, s3, 1
    s_lshl_b32 s7, s7, 13
    s_and_b32 s8, s3, 1
    s_lshl_b32 s8, s8, 11
    s_add_u32 s7, s7, s8
    v_add_u32 v17, s7, v24
    v_add_u32 v18, s7, v25
    s_lshl_b32 s7, s6, 17
    s_add_u32 s7, s7, s13
    v_lshl_add_u32 v3, v1, 4, s7
    v_add_u32 v2, 0x1000, v3
    v_lshlrev_b32 v14, 7, v4
    v_add_u32 v14, 0x8000, v14
    v_xor_b32 v16, 0, v11
    v_lshl_add_u32 v32, v16, 4, v14
    v_xor_b32 v16, 2, v11
    v_lshl_add_u32 v33, v16, 4, v14
    v_xor_b32 v16, 4, v11
    v_lshl_add_u32 v34, v16, 4, v14
    v_xor_b32 v16, 6, v11
    v_lshl_add_u32 v35, v16, 4, v14
    s_lshr_b32 s7, s6, 1
    s_lshl_b32 s7, s7, 12
    s_add_u32 s7, s7, s13
    v_bfe_u32 v16, v1, 1, 3
    v_subrev_u32 v14, 1, v16
    v_cmp_le_u32 vcc, s15, v14
    s_nop 1
    v_cndmask_b32 v14, v14, v16, vcc
    v_mov_b32 v19, s15
    v_cmp_eq_u32 vcc, 0, v16
    s_nop 1
    v_cndmask_b32 v16, v14, v19, vcc
    v_and_b32 v14, 1, v1
    v_lshl_add_u32 v16, v16, 1, v14
    v_lshl_add_u32 v22, v16, 7, s7
    s_add_u32 s64, s52, 0x1000000
    s_addc_u32 s65, s53, 0
    s_mov_b32 s66, 0x2000
    s_mov_b32 s67, 0x20000
    s_mov_b32 s76, s48
    s_mov_b32 s77, s49
    s_mov_b32 s78, 0x800000
    s_mov_b32 s79, 0x20000
    s_add_u32 s92, s52, 0x1800000
    s_addc_u32 s93, s53, 0
    s_mov_b32 s94, 0x800000
    s_mov_b32 s95, 0x20000
    s_mov_b32 s80, 0
    s_mov_b32 s81, 4096
    s_mov_b32 s82, 8192
    s_mov_b32 s83, 12288
    s_mov_b32 s84, 16384
    s_mov_b32 s85, 20480
    s_mov_b32 s86, 24576
    s_mov_b32 s87, 28672
    s_lshl_b32 s7, s6, 5
    v_lshl_add_u32 v7, v6, 4, s7
    s_lshl_b32 s8, s5, 6
    v_add_u32 v8, s8, v4
    v_lshlrev_b32 v26, 12, v7
    v_lshl_add_u32 v26, v8, 2, v26
    v_add_u32 v27, 0x8000, v26
    v_lshlrev_b32 v7, 2, v7
    v_lshlrev_b32 v8, 1, v8
    s_mul_i32 s8, s3, 4608
    s_add_u32 s8, s8, 131584
    v_lshlrev_b32 v61, 11, v6
    v_lshl_add_u32 v61, v4, 1, v61
    v_add_u32 v61, s8, v61
    v_mul_u32_u24 v21, 272, v4
    v_lshl_add_u32 v21, v6, 5, v21
    s_lshl_b32 s8, s3, 6
    v_add_u32 v21, s8, v21
    s_xor_b32 s73, s72, 4096
    s_lshl_b32 s74, s73, 6
    s_add_u32 s75, s74, 4096
    s_add_u32 s8, s73, 0x30000
    v_mov_b32 v29, s8
    v_lshlrev_b32 v28, 4, v1
    v_mov_b32 v23, 1
    s_mov_b32 s89, 262144
c_lw:
    ds_read_b128 v[52:55], v20 offset:4
    s_waitcnt lgkmcnt(0)
    v_min_u32 v54, v54, v55
    v_min_u32 v53, 1, v53
    v_readfirstlane_b32 s8, v54
    v_readfirstlane_b32 s9, v53
    s_nop 1
    s_add_u32 s8, s8, s9
    s_cmp_ge_u32 s8, 5
    s_cbranch_scc1 c_lwok
    s_sub_u32 s89, s89, 1
    s_cbranch_scc0 c_lw
c_lwok:
    ds_read_b64_tr_b16 v[160:161], v17 offset:0
    ds_read_b64_tr_b16 v[162:163], v18 offset:0
    ds_read_b64_tr_b16 v[164:165], v17 offset:1024
    ds_read_b64_tr_b16 v[166:167], v18 offset:1024
    ds_read_b64_tr_b16 v[168:169], v17 offset:16384
    ds_read_b64_tr_b16 v[170:171], v18 offset:16384
    ds_read_b64_tr_b16 v[172:173], v17 offset:17408
    ds_read_b64_tr_b16 v[174:175], v18 offset:17408
    ds_read_b64_tr_b16 v[176:177], v17 offset:4096
    ds_read_b64_tr_b16 v[178:179], v18 offset:4096
    ds_read_b64_tr_b16 v[180:181], v17 offset:5120
    ds_read_b64_tr_b16 v[182:183], v18 offset:5120
    ds_read_b64_tr_b16 v[184:185], v17 offset:20480
    ds_read_b64_tr_b16 v[186:187], v18 offset:20480
    ds_read_b64_tr_b16 v[188:189], v17 offset:21504
    ds_read_b64_tr_b16 v[190:191], v18 offset:21504
    buffer_load_dwordx4 v[36:39], v7, s[64:67], 0 offen offset:0 sc1
    buffer_load_dwordx4 v[40:43], v7, s[64:67], 0 offen offset:16 sc1
    buffer_load_dwordx4 v[44:47], v7, s[64:67], 0 offen offset:32 sc1
    buffer_load_dwordx4 v[48:51], v7, s[64:67], 0 offen offset:48 sc1
    global_load_ushort v52, v8, s[32:33] offset:0
    global_load_ushort v53, v8, s[32:33] offset:64
    ds_read_b128 v[224:227], v32 offset:0
    ds_read_b128 v[228:231], v32 offset:4096
    ds_read_b128 v[232:235], v32 offset:8192
    ds_read_b128 v[236:239], v32 offset:12288
    s_waitcnt lgkmcnt(15)
    s_waitcnt lgkmcnt(3)
    v_mfma_f32_32x32x16_bf16 v[96:111], v[160:163], v[224:227], 0
    ds_read_b128 v[240:243], v33 offset:0
    s_waitcnt lgkmcnt(3)
    v_mfma_f32_32x32x16_bf16 v[112:127], v[160:163], v[228:231], 0
    ds_read_b128 v[244:247], v33 offset:4096
    s_waitcnt lgkmcnt(3)
    v_mfma_f32_32x32x16_bf16 v[128:143], v[160:163], v[232:235], 0
    ds_read_b128 v[248:251], v33 offset:8192
    s_waitcnt lgkmcnt(3)
    v_mfma_f32_32x32x16_bf16 v[144:159], v[160:163], v[236:239], 0
    ds_read_b128 v[252:255], v33 offset:12288
    s_waitcnt lgkmcnt(3)
    v_mfma_f32_32x32x16_bf16 v[96:111], v[164:167], v[240:243], v[96:111]
    ds_read_b128 v[224:227], v34 offset:0
    s_waitcnt lgkmcnt(3)
    v_mfma_f32_32x32x16_bf16 v[112:127], v[164:167], v[244:247], v[112:127]
    ds_read_b128 v[228:231], v34 offset:4096
    s_waitcnt lgkmcnt(3)
    v_mfma_f32_32x32x16_bf16 v[128:143], v[164:167], v[248:251], v[128:143]
    ds_read_b128 v[232:235], v34 offset:8192
    s_waitcnt lgkmcnt(3)
    v_mfma_f32_32x32x16_bf16 v[144:159], v[164:167], v[252:255], v[144:159]
    ds_read_b128 v[236:239], v34 offset:12288
    s_waitcnt lgkmcnt(3)
    v_mfma_f32_32x32x16_bf16 v[96:111], v[168:171], v[224:227], v[96:111]
    ds_read_b128 v[240:243], v35 offset:0
    s_waitcnt lgkmcnt(3)
    v_mfma_f32_32x32x16_bf16 v[112:127], v[168:171], v[228:231], v[112:127]
    ds_read_b128 v[244:247], v35 offset:4096
    s_waitcnt lgkmcnt(3)
    v_mfma_f32_32x32x16_bf16 v[128:143], v[168:171], v[232:235], v[128:143]
    ds_read_b128 v[248:251], v35 offset:8192
    s_waitcnt lgkmcnt(3)
    v_mfma_f32_32x32x16_bf16 v[144:159], v[168:171], v[236:239], v[144:159]
    ds_read_b128 v[252:255], v35 offset:12288
    s_waitcnt lgkmcnt(3)
    v_mfma_f32_32x32x16_bf16 v[96:111], v[172:175], v[240:243], v[96:111]
    ds_read_b128 v[224:227], v32 offset:16384
    s_waitcnt lgkmcnt(3)
    v_mfma_f32_32x32x16_bf16 v[112:127], v[172:175], v[244:247], v[112:127]
    ds_read_b128 v[228:231], v32 offset:20480
    s_waitcnt lgkmcnt(3)
    v_mfma_f32_32x32x16_bf16 v[128:143], v[172:175], v[248:251], v[128:143]
    ds_read_b128 v[232:235], v32 offset:24576
    s_waitcnt lgkmcnt(3)
    v_mfma_f32_32x32x16_bf16 v[144:159], v[172:175], v[252:255], v[144:159]
    ds_read_b128 v[236:239], v32 offset:28672
    s_waitcnt vmcnt(6)
    s_cmp_eq_u32 s14, 1
    s_cbranch_scc1 c_hfs_l
    buffer_store_dword v23, v60, s[68:71], 0 offen sc1
    s_branch c_hfs_e
c_hfs_l:
    buffer_store_dword v23, v60, s[68:71], 0 offen
c_hfs_e:
    buffer_load_dword v19, v22, s[68:71], 0 offen sc1
    s_waitcnt lgkmcnt(3)
    v_mfma_f32_32x32x16_bf16 v[96:111], v[176:179], v[224:227], v[96:111]
    ds_read_b128 v[240:243], v33 offset:16384
    s_waitcnt lgkmcnt(3)
    v_mfma_f32_32x32x16_bf16 v[112:127], v[176:179], v[228:231], v[112:127]
    ds_read_b128 v[244:247], v33 offset:20480
    s_waitcnt lgkmcnt(3)
    v_mfma_f32_32x32x16_bf16 v[128:143], v[176:179], v[232:235], v[128:143]
    ds_read_b128 v[248:251], v33 offset:24576
    s_waitcnt lgkmcnt(3)
    v_mfma_f32_32x32x16_bf16 v[144:159], v[176:179], v[236:239], v[144:159]
    ds_read_b128 v[252:255], v33 offset:28672
    s_waitcnt lgkmcnt(3)
    v_mfma_f32_32x32x16_bf16 v[96:111], v[180:183], v[240:243], v[96:111]
    ds_read_b128 v[224:227], v34 offset:16384
    s_waitcnt lgkmcnt(3)
    v_mfma_f32_32x32x16_bf16 v[112:127], v[180:183], v[244:247], v[112:127]
    ds_read_b128 v[228:231], v34 offset:20480
    s_waitcnt lgkmcnt(3)
    v_mfma_f32_32x32x16_bf16 v[128:143], v[180:183], v[248:251], v[128:143]
    ds_read_b128 v[232:235], v34 offset:24576
    s_waitcnt lgkmcnt(3)
    v_mfma_f32_32x32x16_bf16 v[144:159], v[180:183], v[252:255], v[144:159]
    ds_read_b128 v[236:239], v34 offset:28672
    s_waitcnt lgkmcnt(3)
    v_mfma_f32_32x32x16_bf16 v[96:111], v[184:187], v[224:227], v[96:111]
    ds_read_b128 v[240:243], v35 offset:16384
    s_waitcnt lgkmcnt(3)
    v_mfma_f32_32x32x16_bf16 v[112:127], v[184:187], v[228:231], v[112:127]
    ds_read_b128 v[244:247], v35 offset:20480
    s_waitcnt lgkmcnt(3)
    v_mfma_f32_32x32x16_bf16 v[128:143], v[184:187], v[232:235], v[128:143]
    ds_read_b128 v[248:251], v35 offset:24576
    s_waitcnt lgkmcnt(3)
    v_mfma_f32_32x32x16_bf16 v[144:159], v[184:187], v[236:239], v[144:159]
    ds_read_b128 v[252:255], v35 offset:28672
    s_waitcnt vmcnt(0)
    v_cmp_eq_u32 s[90:91], 1, v19
    s_nop 1
    s_and_b32 s88, s90, 0xc
    s_cmp_eq_u32 s88, 0xc
    s_cbranch_scc0 c_n0_s
c_n0:
    s_cmp_le_u32 s15, 0
    s_cselect_b32 s11, 1, 0
    s_lshl_b32 s11, s11, 14
    buffer_load_dwordx4 v[192:195], v3, s[60:63], s11 offen offset:0 sc1
    buffer_load_dwordx4 v[196:199], v3, s[60:63], s11 offen offset:1024 sc1
    buffer_load_dwordx4 v[200:203], v2, s[60:63], s11 offen offset:0 sc1
    buffer_load_dwordx4 v[204:207], v2, s[60:63], s11 offen offset:1024 sc1
    s_cmp_le_u32 s15, 0
    s_cselect_b32 s11, 1, 0
    s_lshl_b32 s11, s11, 14
    s_add_u32 s11, s11, 8192
    buffer_load_dwordx4 v[208:211], v3, s[60:63], s11 offen offset:0 sc1
    buffer_load_dwordx4 v[212:215], v3, s[60:63], s11 offen offset:1024 sc1
    buffer_load_dwordx4 v[216:219], v2, s[60:63], s11 offen offset:0 sc1
    buffer_load_dwordx4 v[220:223], v2, s[60:63], s11 offen offset:1024 sc1
    buffer_load_dword v19, v22, s[68:71], 0 offen sc1
    s_barrier
    s_waitcnt lgkmcnt(3)
    v_mfma_f32_32x32x16_bf16 v[96:111], v[188:191], v[240:243], v[96:111]
    ds_read_b128 v[224:227], v32 offset:32768
    s_waitcnt lgkmcnt(3)
    v_mfma_f32_32x32x16_bf16 v[112:127], v[188:191], v[244:247], v[112:127]
    ds_read_b128 v[228:231], v32 offset:36864
    s_waitcnt lgkmcnt(3)
    v_mfma_f32_32x32x16_bf16 v[128:143], v[188:191], v[248:251], v[128:143]
    ds_read_b128 v[232:235], v32 offset:40960
    s_waitcnt lgkmcnt(3)
    v_mfma_f32_32x32x16_bf16 v[144:159], v[188:191], v[252:255], v[144:159]
    ds_read_b128 v[236:239], v32 offset:45056
    s_waitcnt vmcnt(8)
    s_waitcnt lgkmcnt(3)
    v_mfma_f32_32x32x16_bf16 v[96:111], v[192:195], v[224:227], v[96:111]
    ds_read_b128 v[240:243], v33 offset:32768
    s_waitcnt lgkmcnt(3)
    v_mfma_f32_32x32x16_bf16 v[112:127], v[192:195], v[228:231], v[112:127]
    ds_read_b128 v[244:247], v33 offset:36864
    s_waitcnt lgkmcnt(3)
    v_mfma_f32_32x32x16_bf16 v[128:143], v[192:195], v[232:235], v[128:143]
    ds_read_b128 v[248:251], v33 offset:40960
    s_waitcnt lgkmcnt(3)
    v_mfma_f32_32x32x16_bf16 v[144:159], v[192:195], v[236:239], v[144:159]
    ds_read_b128 v[252:255], v33 offset:45056
    s_waitcnt vmcnt(0)
    v_cmp_eq_u32 s[90:91], 1, v19
    s_nop 1
    s_and_b32 s88, s90, 0x3c
    s_cmp_eq_u32 s88, 0x3c
    s_cbranch_scc0 c_n1_s
c_n1:
    s_cmp_le_u32 s15, 1
    s_cselect_b32 s11, 2, 1
    s_lshl_b32 s11, s11, 14
    buffer_load_dwordx4 v[160:163], v3, s[60:63], s11 offen offset:0 sc1
    buffer_load_dwordx4 v[164:167], v3, s[60:63], s11 offen offset:1024 sc1
    buffer_load_dwordx4 v[168:171], v2, s[60:63], s11 offen offset:0 sc1
    buffer_load_dwordx4 v[172:175], v2, s[60:63], s11 offen offset:1024 sc1
    buffer_load_dword v19, v22, s[68:71], 0 offen sc1
    s_cmp_le_u32 s15, 1
    s_cselect_b32 s11, 2, 1
    s_lshl_b32 s11, s11, 14
    s_add_u32 s11, s11, 8192
    buffer_load_dwordx4 v[176:179], v3, s[60:63], s11 offen offset:0 sc1
    s_waitcnt lgkmcnt(3)
    v_mfma_f32_32x32x16_bf16 v[96:111], v[196:199], v[240:243], v[96:111]
    ds_read_b128 v[224:227], v34 offset:32768
    s_waitcnt lgkmcnt(3)
    v_mfma_f32_32x32x16_bf16 v[112:127], v[196:199], v[244:247], v[112:127]
    ds_read_b128 v[228:231], v34 offset:36864
    s_waitcnt lgkmcnt(3)
    v_mfma_f32_32x32x16_bf16 v[128:143], v[196:199], v[248:251], v[128:143]
    ds_read_b128 v[232:235], v34 offset:40960
    s_waitcnt lgkmcnt(3)
    v_mfma_f32_32x32x16_bf16 v[144:159], v[196:199], v[252:255], v[144:159]
    ds_read_b128 v[236:239], v34 offset:45056
    buffer_load_dwordx4 v[180:183], v3, s[60:63], s11 offen offset:1024 sc1
    s_waitcnt lgkmcnt(3)
    v_mfma_f32_32x32x16_bf16 v[96:111], v[200:203], v[224:227], v[96:111]
    ds_read_b128 v[240:243], v35 offset:32768
    s_waitcnt lgkmcnt(3)
    v_mfma_f32_32x32x16_bf16 v[112:127], v[200:203], v[228:231], v[112:127]
    ds_read_b128 v[244:247], v35 offset:36864
    s_waitcnt lgkmcnt(3)
    v_mfma_f32_32x32x16_bf16 v[128:143], v[200:203], v[232:235], v[128:143]
    ds_read_b128 v[248:251], v35 offset:40960
    s_waitcnt lgkmcnt(3)
    v_mfma_f32_32x32x16_bf16 v[144:159], v[200:203], v[236:239], v[144:159]
    ds_read_b128 v[252:255], v35 offset:45056
    buffer_load_dwordx4 v[184:187], v2, s[60:63], s11 offen offset:0 sc1
    s_barrier
    s_waitcnt lgkmcnt(3)
    v_mfma_f32_32x32x16_bf16 v[96:111], v[204:207], v[240:243], v[96:111]
    ds_read_b128 v[224:227], v32 offset:49152
    s_waitcnt lgkmcnt(3)
    v_mfma_f32_32x32x16_bf16 v[112:127], v[204:207], v[244:247], v[112:127]
    ds_read_b128 v[228:231], v32 offset:53248
    s_waitcnt lgkmcnt(3)
    v_mfma_f32_32x32x16_bf16 v[128:143], v[204:207], v[248:251], v[128:143]
    ds_read_b128 v[232:235], v32 offset:57344
    s_waitcnt lgkmcnt(3)
    v_mfma_f32_32x32x16_bf16 v[144:159], v[204:207], v[252:255], v[144:159]
    ds_read_b128 v[236:239], v32 offset:61440
    buffer_load_dwordx4 v[188:191], v2, s[60:63], s11 offen offset:1024 sc1
    s_waitcnt lgkmcnt(3)
    v_mfma_f32_32x32x16_bf16 v[96:111], v[208:211], v[224:227], v[96:111]
    ds_read_b128 v[240:243], v33 offset:49152
    s_waitcnt lgkmcnt(3)
    v_mfma_f32_32x32x16_bf16 v[112:127], v[208:211], v[228:231], v[112:127]
    ds_read_b128 v[244:247], v33 offset:53248
    s_waitcnt lgkmcnt(3)
    v_mfma_f32_32x32x16_bf16 v[128:143], v[208:211], v[232:235], v[128:143]
    ds_read_b128 v[248:251], v33 offset:57344
    s_waitcnt lgkmcnt(3)
    v_mfma_f32_32x32x16_bf16 v[144:159], v[208:211], v[236:239], v[144:159]
    ds_read_b128 v[252:255], v33 offset:61440
    s_waitcnt vmcnt(4)
    v_cmp_eq_u32 s[90:91], 1, v19
    s_nop 1
    s_and_b32 s88, s90, 0xfc
    s_cmp_eq_u32 s88, 0xfc
    s_cbranch_scc0 c_n2_s
c_n2:
    s_cmp_le_u32 s15, 2
    s_cselect_b32 s11, 3, 2
    s_lshl_b32 s11, s11, 14
    buffer_load_dwordx4 v[192:195], v3, s[60:63], s11 offen offset:0 sc1
    s_waitcnt lgkmcnt(3)
    v_mfma_f32_32x32x16_bf16 v[96:111], v[212:215], v[240:243], v[96:111]
    ds_read_b128 v[224:227], v34 offset:49152
    s_waitcnt lgkmcnt(3)
    v_mfma_f32_32x32x16_bf16 v[112:127], v[212:215], v[244:247], v[112:127]
    ds_read_b128 v[228:231], v34 offset:53248
    s_waitcnt lgkmcnt(3)
    v_mfma_f32_32x32x16_bf16 v[128:143], v[212:215], v[248:251], v[128:143]
    ds_read_b128 v[232:235], v34 offset:57344
    s_waitcnt lgkmcnt(3)
    v_mfma_f32_32x32x16_bf16 v[144:159], v[212:215], v[252:255], v[144:159]
    ds_read_b128 v[236:239], v34 offset:61440
    buffer_load_dwordx4 v[196:199], v3, s[60:63], s11 offen offset:1024 sc1
    s_waitcnt lgkmcnt(3)
    v_mfma_f32_32x32x16_bf16 v[96:111], v[216:219], v[224:227], v[96:111]
    ds_read_b128 v[240:243], v35 offset:49152
    s_waitcnt lgkmcnt(3)
    v_mfma_f32_32x32x16_bf16 v[112:127], v[216:219], v[228:231], v[112:127]
    ds_read_b128 v[244:247], v35 offset:53248
    s_waitcnt lgkmcnt(3)
    v_mfma_f32_32x32x16_bf16 v[128:143], v[216:219], v[232:235], v[128:143]
    ds_read_b128 v[248:251], v35 offset:57344
    s_waitcnt lgkmcnt(3)
    v_mfma_f32_32x32x16_bf16 v[144:159], v[216:219], v[236:239], v[144:159]
    ds_read_b128 v[252:255], v35 offset:61440
    buffer_load_dwordx4 v[200:203], v2, s[60:63], s11 offen offset:0 sc1
    s_barrier
    s_waitcnt lgkmcnt(3)
    v_mfma_f32_32x32x16_bf16 v[96:111], v[220:223], v[240:243], v[96:111]
    ds_read_b128 v[224:227], v32 offset:0
    s_waitcnt lgkmcnt(3)
    v_mfma_f32_32x32x16_bf16 v[112:127], v[220:223], v[244:247], v[112:127]
    ds_read_b128 v[228:231], v32 offset:4096
    s_waitcnt lgkmcnt(3)
    v_mfma_f32_32x32x16_bf16 v[128:143], v[220:223], v[248:251], v[128:143]
    ds_read_b128 v[232:235], v32 offset:8192
    s_waitcnt lgkmcnt(3)
    v_mfma_f32_32x32x16_bf16 v[144:159], v[220:223], v[252:255], v[144:159]
    ds_read_b128 v[236:239], v32 offset:12288
    buffer_load_dwordx4 v[204:207], v2, s[60:63], s11 offen offset:1024 sc1
    s_waitcnt lgkmcnt(3)
    v_mfma_f32_32x32x16_bf16 v[96:111], v[160:163], v[224:227], v[96:111]
    ds_read_b128 v[240:243], v33 offset:0
    s_waitcnt lgkmcnt(3)
    v_mfma_f32_32x32x16_bf16 v[112:127], v[160:163], v[228:231], v[112:127]
    ds_read_b128 v[244:247], v33 offset:4096
    s_waitcnt lgkmcnt(3)
    v_mfma_f32_32x32x16_bf16 v[128:143], v[160:163], v[232:235], v[128:143]
    ds_read_b128 v[248:251], v33 offset:8192
    s_waitcnt lgkmcnt(3)
    v_mfma_f32_32x32x16_bf16 v[144:159], v[160:163], v[236:239], v[144:159]
    ds_read_b128 v[252:255], v33 offset:12288
    s_cmp_le_u32 s15, 2
    s_cselect_b32 s11, 3, 2
    s_lshl_b32 s11, s11, 14
    s_add_u32 s11, s11, 8192
    buffer_load_dwordx4 v[208:211], v3, s[60:63], s11 offen offset:0 sc1
    s_waitcnt lgkmcnt(3)
    v_mfma_f32_32x32x16_bf16 v[96:111], v[164:167], v[240:243], v[96:111]
    ds_read_b128 v[224:227], v34 offset:0
    s_waitcnt lgkmcnt(3)
    v_mfma_f32_32x32x16_bf16 v[112:127], v[164:167], v[244:247], v[112:127]
    ds_read_b128 v[228:231], v34 offset:4096
    s_waitcnt lgkmcnt(3)
    v_mfma_f32_32x32x16_bf16 v[128:143], v[164:167], v[248:251], v[128:143]
    ds_read_b128 v[232:235], v34 offset:8192
    s_waitcnt lgkmcnt(3)
    v_mfma_f32_32x32x16_bf16 v[144:159], v[164:167], v[252:255], v[144:159]
    ds_read_b128 v[236:239], v34 offset:12288
    buffer_load_dwordx4 v[212:215], v3, s[60:63], s11 offen offset:1024 sc1
    s_waitcnt lgkmcnt(3)
    v_mfma_f32_32x32x16_bf16 v[96:111], v[168:171], v[224:227], v[96:111]
    ds_read_b128 v[240:243], v35 offset:0
    s_waitcnt lgkmcnt(3)
    v_mfma_f32_32x32x16_bf16 v[112:127], v[168:171], v[228:231], v[112:127]
    ds_read_b128 v[244:247], v35 offset:4096
    s_waitcnt lgkmcnt(3)
    v_mfma_f32_32x32x16_bf16 v[128:143], v[168:171], v[232:235], v[128:143]
    ds_read_b128 v[248:251], v35 offset:8192
    s_waitcnt lgkmcnt(3)
    v_mfma_f32_32x32x16_bf16 v[144:159], v[168:171], v[236:239], v[144:159]
    ds_read_b128 v[252:255], v35 offset:12288
    buffer_load_dwordx4 v[216:219], v2, s[60:63], s11 offen offset:0 sc1
    s_barrier
    s_waitcnt lgkmcnt(3)
    v_mfma_f32_32x32x16_bf16 v[96:111], v[172:175], v[240:243], v[96:111]
    ds_read_b128 v[224:227], v32 offset:16384
    s_waitcnt lgkmcnt(3)
    v_mfma_f32_32x32x16_bf16 v[112:127], v[172:175], v[244:247], v[112:127]
    ds_read_b128 v[228:231], v32 offset:20480
    s_waitcnt lgkmcnt(3)
    v_mfma_f32_32x32x16_bf16 v[128:143], v[172:175], v[248:251], v[128:143]
    ds_read_b128 v[232:235], v32 offset:24576
    s_waitcnt lgkmcnt(3)
    v_mfma_f32_32x32x16_bf16 v[144:159], v[172:175], v[252:255], v[144:159]
    ds_read_b128 v[236:239], v32 offset:28672
    buffer_load_dwordx4 v[220:223], v2, s[60:63], s11 offen offset:1024 sc1
    s_waitcnt vmcnt(11)
    s_waitcnt lgkmcnt(3)
    v_mfma_f32_32x32x16_bf16 v[96:111], v[176:179], v[224:227], v[96:111]
    ds_read_b128 v[240:243], v33 offset:16384
    s_waitcnt lgkmcnt(3)
    v_mfma_f32_32x32x16_bf16 v[112:127], v[176:179], v[228:231], v[112:127]
    ds_read_b128 v[244:247], v33 offset:20480
    s_waitcnt lgkmcnt(3)
    v_mfma_f32_32x32x16_bf16 v[128:143], v[176:179], v[232:235], v[128:143]
    ds_read_b128 v[248:251], v33 offset:24576
    s_waitcnt lgkmcnt(3)
    v_mfma_f32_32x32x16_bf16 v[144:159], v[176:179], v[236:239], v[144:159]
    ds_read_b128 v[252:255], v33 offset:28672
    s_and_b32 s88, s90, 0x3fc
    s_cmp_eq_u32 s88, 0x3fc
    s_cbranch_scc0 c_n3_s
c_n3:
    s_cmp_le_u32 s15, 3
    s_cselect_b32 s11, 4, 3
    s_lshl_b32 s11, s11, 14
    buffer_load_dwordx4 v[160:163], v3, s[60:63], s11 offen offset:0 sc1
    s_waitcnt vmcnt(11)
    s_waitcnt lgkmcnt(3)
    v_mfma_f32_32x32x16_bf16 v[96:111], v[180:183], v[240:243], v[96:111]
    ds_read_b128 v[224:227], v34 offset:16384
    s_waitcnt lgkmcnt(3)
    v_mfma_f32_32x32x16_bf16 v[112:127], v[180:183], v[244:247], v[112:127]
    ds_read_b128 v[228:231], v34 offset:20480
    s_waitcnt lgkmcnt(3)
    v_mfma_f32_32x32x16_bf16 v[128:143], v[180:183], v[248:251], v[128:143]
    ds_read_b128 v[232:235], v34 offset:24576
    s_waitcnt lgkmcnt(3)
    v_mfma_f32_32x32x16_bf16 v[144:159], v[180:183], v[252:255], v[144:159]
    ds_read_b128 v[236:239], v34 offset:28672
    buffer_load_dwordx4 v[164:167], v3, s[60:63], s11 offen offset:1024 sc1
    s_waitcnt vmcnt(11)
    s_waitcnt lgkmcnt(3)
    v_mfma_f32_32x32x16_bf16 v[96:111], v[184:187], v[224:227], v[96:111]
    ds_read_b128 v[240:243], v35 offset:16384
    s_waitcnt lgkmcnt(3)
    v_mfma_f32_32x32x16_bf16 v[112:127], v[184:187], v[228:231], v[112:127]
    ds_read_b128 v[244:247], v35 offset:20480
    s_waitcnt lgkmcnt(3)
    v_mfma_f32_32x32x16_bf16 v[128:143], v[184:187], v[232:235], v[128:143]
    ds_read_b128 v[248:251], v35 offset:24576
    s_waitcnt lgkmcnt(3)
    v_mfma_f32_32x32x16_bf16 v[144:159], v[184:187], v[236:239], v[144:159]
    ds_read_b128 v[252:255], v35 offset:28672
    buffer_load_dwordx4 v[168:171], v2, s[60:63], s11 offen offset:0 sc1
    s_barrier
    s_waitcnt vmcnt(11)
    s_waitcnt lgkmcnt(3)
    v_mfma_f32_32x32x16_bf16 v[96:111], v[188:191], v[240:243], v[96:111]
    ds_read_b128 v[224:227], v32 offset:32768
    s_waitcnt lgkmcnt(3)
    v_mfma_f32_32x32x16_bf16 v[112:127], v[188:191], v[244:247], v[112:127]
    ds_read_b128 v[228:231], v32 offset:36864
    s_waitcnt lgkmcnt(3)
    v_mfma_f32_32x32x16_bf16 v[128:143], v[188:191], v[248:251], v[128:143]
    ds_read_b128 v[232:235], v32 offset:40960
    s_waitcnt lgkmcnt(3)
    v_mfma_f32_32x32x16_bf16 v[144:159], v[188:191], v[252:255], v[144:159]
    ds_read_b128 v[236:239], v32 offset:45056
    buffer_load_dwordx4 v[172:175], v2, s[60:63], s11 offen offset:1024 sc1
    s_waitcnt vmcnt(11)
    s_waitcnt lgkmcnt(3)
    v_mfma_f32_32x32x16_bf16 v[96:111], v[192:195], v[224:227], v[96:111]
    ds_read_b128 v[240:243], v33 offset:32768
    s_waitcnt lgkmcnt(3)
    v_mfma_f32_32x32x16_bf16 v[112:127], v[192:195], v[228:231], v[112:127]
    ds_read_b128 v[244:247], v33 offset:36864
    s_waitcnt lgkmcnt(3)
    v_mfma_f32_32x32x16_bf16 v[128:143], v[192:195], v[232:235], v[128:143]
    ds_read_b128 v[248:251], v33 offset:40960
    s_waitcnt lgkmcnt(3)
    v_mfma_f32_32x32x16_bf16 v[144:159], v[192:195], v[236:239], v[144:159]
    ds_read_b128 v[252:255], v33 offset:45056
    s_cmp_le_u32 s15, 3
    s_cselect_b32 s11, 4, 3
    s_lshl_b32 s11, s11, 14
    s_add_u32 s11, s11, 8192
    buffer_load_dwordx4 v[176:179], v3, s[60:63], s11 offen offset:0 sc1
    s_waitcnt vmcnt(11)
    s_waitcnt lgkmcnt(3)
    v_mfma_f32_32x32x16_bf16 v[96:111], v[196:199], v[240:243], v[96:111]
    ds_read_b128 v[224:227], v34 offset:32768
    s_waitcnt lgkmcnt(3)
    v_mfma_f32_32x32x16_bf16 v[112:127], v[196:199], v[244:247], v[112:127]
    ds_read_b128 v[228:231], v34 offset:36864
    s_waitcnt lgkmcnt(3)
    v_mfma_f32_32x32x16_bf16 v[128:143], v[196:199], v[248:251], v[128:143]
    ds_read_b128 v[232:235], v34 offset:40960
    s_waitcnt lgkmcnt(3)
    v_mfma_f32_32x32x16_bf16 v[144:159], v[196:199], v[252:255], v[144:159]
    ds_read_b128 v[236:239], v34 offset:45056
    buffer_load_dwordx4 v[180:183], v3, s[60:63], s11 offen offset:1024 sc1
    s_waitcnt vmcnt(11)
    s_waitcnt lgkmcnt(3)
    v_mfma_f32_32x32x16_bf16 v[96:111], v[200:203], v[224:227], v[96:111]
    ds_read_b128 v[240:243], v35 offset:32768
    s_waitcnt lgkmcnt(3)
    v_mfma_f32_32x32x16_bf16 v[112:127], v[200:203], v[228:231], v[112:127]
    ds_read_b128 v[244:247], v35 offset:36864
    s_waitcnt lgkmcnt(3)
    v_mfma_f32_32x32x16_bf16 v[128:143], v[200:203], v[232:235], v[128:143]
    ds_read_b128 v[248:251], v35 offset:40960
    s_waitcnt lgkmcnt(3)
    v_mfma_f32_32x32x16_bf16 v[144:159], v[200:203], v[236:239], v[144:159]
    ds_read_b128 v[252:255], v35 offset:45056
    buffer_load_dwordx4 v[184:187], v2, s[60:63], s11 offen offset:0 sc1
    s_barrier
    s_waitcnt vmcnt(11)
    s_waitcnt lgkmcnt(3)
    v_mfma_f32_32x32x16_bf16 v[96:111], v[204:207], v[240:243], v[96:111]
    ds_read_b128 v[224:227], v32 offset:49152
    s_waitcnt lgkmcnt(3)
    v_mfma_f32_32x32x16_bf16 v[112:127], v[204:207], v[244:247], v[112:127]
    ds_read_b128 v[228:231], v32 offset:53248
    s_waitcnt lgkmcnt(3)
    v_mfma_f32_32x32x16_bf16 v[128:143], v[204:207], v[248:251], v[128:143]
    ds_read_b128 v[232:235], v32 offset:57344
    s_waitcnt lgkmcnt(3)
    v_mfma_f32_32x32x16_bf16 v[144:159], v[204:207], v[252:255], v[144:159]
    ds_read_b128 v[236:239], v32 offset:61440
    buffer_load_dwordx4 v[188:191], v2, s[60:63], s11 offen offset:1024 sc1
    s_waitcnt vmcnt(11)
    s_waitcnt lgkmcnt(3)
    v_mfma_f32_32x32x16_bf16 v[96:111], v[208:211], v[224:227], v[96:111]
    ds_read_b128 v[240:243], v33 offset:49152
    s_waitcnt lgkmcnt(3)
    v_mfma_f32_32x32x16_bf16 v[112:127], v[208:211], v[228:231], v[112:127]
    ds_read_b128 v[244:247], v33 offset:53248
    s_waitcnt lgkmcnt(3)
    v_mfma_f32_32x32x16_bf16 v[128:143], v[208:211], v[232:235], v[128:143]
    ds_read_b128 v[248:251], v33 offset:57344
    s_waitcnt lgkmcnt(3)
    v_mfma_f32_32x32x16_bf16 v[144:159], v[208:211], v[236:239], v[144:159]
    ds_read_b128 v[252:255], v33 offset:61440
    s_and_b32 s88, s90, 0xffc
    s_cmp_eq_u32 s88, 0xffc
    s_cbranch_scc0 c_n4_s
c_n4:
    s_cmp_le_u32 s15, 4
    s_cselect_b32 s11, 5, 4
    s_lshl_b32 s11, s11, 14
    buffer_load_dwordx4 v[192:195], v3, s[60:63], s11 offen offset:0 sc1
    s_waitcnt vmcnt(11)
    s_waitcnt lgkmcnt(3)
    v_mfma_f32_32x32x16_bf16 v[96:111], v[212:215], v[240:243], v[96:111]
    ds_read_b128 v[224:227], v34 offset:49152
    s_waitcnt lgkmcnt(3)
    v_mfma_f32_32x32x16_bf16 v[112:127], v[212:215], v[244:247], v[112:127]
    ds_read_b128 v[228:231], v34 offset:53248
    s_waitcnt lgkmcnt(3)
    v_mfma_f32_32x32x16_bf16 v[128:143], v[212:215], v[248:251], v[128:143]
    ds_read_b128 v[232:235], v34 offset:57344
    s_waitcnt lgkmcnt(3)
    v_mfma_f32_32x32x16_bf16 v[144:159], v[212:215], v[252:255], v[144:159]
    ds_read_b128 v[236:239], v34 offset:61440
    buffer_load_dwordx4 v[196:199], v3, s[60:63], s11 offen offset:1024 sc1
    s_waitcnt vmcnt(11)
    s_waitcnt lgkmcnt(3)
    v_mfma_f32_32x32x16_bf16 v[96:111], v[216:219], v[224:227], v[96:111]
    ds_read_b128 v[240:243], v35 offset:49152
    s_waitcnt lgkmcnt(3)
    v_mfma_f32_32x32x16_bf16 v[112:127], v[216:219], v[228:231], v[112:127]
    ds_read_b128 v[244:247], v35 offset:53248
    s_waitcnt lgkmcnt(3)
    v_mfma_f32_32x32x16_bf16 v[128:143], v[216:219], v[232:235], v[128:143]
    ds_read_b128 v[248:251], v35 offset:57344
    s_waitcnt lgkmcnt(3)
    v_mfma_f32_32x32x16_bf16 v[144:159], v[216:219], v[236:239], v[144:159]
    ds_read_b128 v[252:255], v35 offset:61440
    buffer_load_dwordx4 v[200:203], v2, s[60:63], s11 offen offset:0 sc1
    s_barrier
    s_waitcnt vmcnt(11)
    s_waitcnt lgkmcnt(3)
    v_mfma_f32_32x32x16_bf16 v[96:111], v[220:223], v[240:243], v[96:111]
    ds_read_b128 v[224:227], v32 offset:0
    s_waitcnt lgkmcnt(3)
    v_mfma_f32_32x32x16_bf16 v[112:127], v[220:223], v[244:247], v[112:127]
    ds_read_b128 v[228:231], v32 offset:4096
    s_waitcnt lgkmcnt(3)
    v_mfma_f32_32x32x16_bf16 v[128:143], v[220:223], v[248:251], v[128:143]
    ds_read_b128 v[232:235], v32 offset:8192
    s_waitcnt lgkmcnt(3)
    v_mfma_f32_32x32x16_bf16 v[144:159], v[220:223], v[252:255], v[144:159]
    ds_read_b128 v[236:239], v32 offset:12288
    buffer_load_dwordx4 v[204:207], v2, s[60:63], s11 offen offset:1024 sc1
    s_waitcnt vmcnt(11)
    s_waitcnt lgkmcnt(3)
    v_mfma_f32_32x32x16_bf16 v[96:111], v[160:163], v[224:227], v[96:111]
    ds_read_b128 v[240:243], v33 offset:0
    s_waitcnt lgkmcnt(3)
    v_mfma_f32_32x32x16_bf16 v[112:127], v[160:163], v[228:231], v[112:127]
    ds_read_b128 v[244:247], v33 offset:4096
    s_waitcnt lgkmcnt(3)
    v_mfma_f32_32x32x16_bf16 v[128:143], v[160:163], v[232:235], v[128:143]
    ds_read_b128 v[248:251], v33 offset:8192
    s_waitcnt lgkmcnt(3)
    v_mfma_f32_32x32x16_bf16 v[144:159], v[160:163], v[236:239], v[144:159]
    ds_read_b128 v[252:255], v33 offset:12288
    s_cmp_le_u32 s15, 4
    s_cselect_b32 s11, 5, 4
    s_lshl_b32 s11, s11, 14
    s_add_u32 s11, s11, 8192
    buffer_load_dwordx4 v[208:211], v3, s[60:63], s11 offen offset:0 sc1
    s_waitcnt vmcnt(11)
    s_waitcnt lgkmcnt(3)
    v_mfma_f32_32x32x16_bf16 v[96:111], v[164:167], v[240:243], v[96:111]
    ds_read_b128 v[224:227], v34 offset:0
    s_waitcnt lgkmcnt(3)
    v_mfma_f32_32x32x16_bf16 v[112:127], v[164:167], v[244:247], v[112:127]
    ds_read_b128 v[228:231], v34 offset:4096
    s_waitcnt lgkmcnt(3)
    v_mfma_f32_32x32x16_bf16 v[128:143], v[164:167], v[248:251], v[128:143]
    ds_read_b128 v[232:235], v34 offset:8192
    s_waitcnt lgkmcnt(3)
    v_mfma_f32_32x32x16_bf16 v[144:159], v[164:167], v[252:255], v[144:159]
    ds_read_b128 v[236:239], v34 offset:12288
    buffer_load_dwordx4 v[212:215], v3, s[60:63], s11 offen offset:1024 sc1
    s_waitcnt vmcnt(11)
    s_waitcnt lgkmcnt(3)
    v_mfma_f32_32x32x16_bf16 v[96:111], v[168:171], v[224:227], v[96:111]
    ds_read_b128 v[240:243], v35 offset:0
    s_waitcnt lgkmcnt(3)
    v_mfma_f32_32x32x16_bf16 v[112:127], v[168:171], v[228:231], v[112:127]
    ds_read_b128 v[244:247], v35 offset:4096
    s_waitcnt lgkmcnt(3)
    v_mfma_f32_32x32x16_bf16 v[128:143], v[168:171], v[232:235], v[128:143]
    ds_read_b128 v[248:251], v35 offset:8192
    s_waitcnt lgkmcnt(3)
    v_mfma_f32_32x32x16_bf16 v[144:159], v[168:171], v[236:239], v[144:159]
    ds_read_b128 v[252:255], v35 offset:12288
    buffer_load_dwordx4 v[216:219], v2, s[60:63], s11 offen offset:0 sc1
    s_barrier
    s_waitcnt vmcnt(11)
    s_waitcnt lgkmcnt(3)
    v_mfma_f32_32x32x16_bf16 v[96:111], v[172:175], v[240:243], v[96:111]
    ds_read_b128 v[224:227], v32 offset:16384
    s_waitcnt lgkmcnt(3)
    v_mfma_f32_32x32x16_bf16 v[112:127], v[172:175], v[244:247], v[112:127]
    ds_read_b128 v[228:231], v32 offset:20480
    s_waitcnt lgkmcnt(3)
    v_mfma_f32_32x32x16_bf16 v[128:143], v[172:175], v[248:251], v[128:143]
    ds_read_b128 v[232:235], v32 offset:24576
    s_waitcnt lgkmcnt(3)
    v_mfma_f32_32x32x16_bf16 v[144:159], v[172:175], v[252:255], v[144:159]
    ds_read_b128 v[236:239], v32 offset:28672
    buffer_load_dwordx4 v[220:223], v2, s[60:63], s11 offen offset:1024 sc1
    s_waitcnt vmcnt(11)
    s_waitcnt lgkmcnt(3)
    v_mfma_f32_32x32x16_bf16 v[96:111], v[176:179], v[224:227], v[96:111]
    ds_read_b128 v[240:243], v33 offset:16384
    s_waitcnt lgkmcnt(3)
    v_mfma_f32_32x32x16_bf16 v[112:127], v[176:179], v[228:231], v[112:127]
    ds_read_b128 v[244:247], v33 offset:20480
    s_waitcnt lgkmcnt(3)
    v_mfma_f32_32x32x16_bf16 v[128:143], v[176:179], v[232:235], v[128:143]
    ds_read_b128 v[248:251], v33 offset:24576
    s_waitcnt lgkmcnt(3)
    v_mfma_f32_32x32x16_bf16 v[144:159], v[176:179], v[236:239], v[144:159]
    ds_read_b128 v[252:255], v33 offset:28672
    s_and_b32 s88, s90, 0x3ffc
    s_cmp_eq_u32 s88, 0x3ffc
    s_cbranch_scc0 c_n5_s
c_n5:
    s_cmp_le_u32 s15, 5
    s_cselect_b32 s11, 6, 5
    s_lshl_b32 s11, s11, 14
    buffer_load_dwordx4 v[160:163], v3, s[60:63], s11 offen offset:0 sc1
    s_waitcnt vmcnt(11)
    s_waitcnt lgkmcnt(3)
    v_mfma_f32_32x32x16_bf16 v[96:111], v[180:183], v[240:243], v[96:111]
    ds_read_b128 v[224:227], v34 offset:16384
    s_waitcnt lgkmcnt(3)
    v_mfma_f32_32x32x16_bf16 v[112:127], v[180:183], v[244:247], v[112:127]
    ds_read_b128 v[228:231], v34 offset:20480
    s_waitcnt lgkmcnt(3)
    v_mfma_f32_32x32x16_bf16 v[128:143], v[180:183], v[248:251], v[128:143]
    ds_read_b128 v[232:235], v34 offset:24576
    s_waitcnt lgkmcnt(3)
    v_mfma_f32_32x32x16_bf16 v[144:159], v[180:183], v[252:255], v[144:159]
    ds_read_b128 v[236:239], v34 offset:28672
    buffer_load_dwordx4 v[164:167], v3, s[60:63], s11 offen offset:1024 sc1
    s_waitcnt vmcnt(11)
    s_waitcnt lgkmcnt(3)
    v_mfma_f32_32x32x16_bf16 v[96:111], v[184:187], v[224:227], v[96:111]
    ds_read_b128 v[240:243], v35 offset:16384
    s_waitcnt lgkmcnt(3)
    v_mfma_f32_32x32x16_bf16 v[112:127], v[184:187], v[228:231], v[112:127]
    ds_read_b128 v[244:247], v35 offset:20480
    s_waitcnt lgkmcnt(3)
    v_mfma_f32_32x32x16_bf16 v[128:143], v[184:187], v[232:235], v[128:143]
    ds_read_b128 v[248:251], v35 offset:24576
    s_waitcnt lgkmcnt(3)
    v_mfma_f32_32x32x16_bf16 v[144:159], v[184:187], v[236:239], v[144:159]
    ds_read_b128 v[252:255], v35 offset:28672
    buffer_load_dwordx4 v[168:171], v2, s[60:63], s11 offen offset:0 sc1
    s_barrier
    s_waitcnt vmcnt(11)
    s_waitcnt lgkmcnt(3)
    v_mfma_f32_32x32x16_bf16 v[96:111], v[188:191], v[240:243], v[96:111]
    ds_read_b128 v[224:227], v32 offset:32768
    s_waitcnt lgkmcnt(3)
    v_mfma_f32_32x32x16_bf16 v[112:127], v[188:191], v[244:247], v[112:127]
    ds_read_b128 v[228:231], v32 offset:36864
    s_waitcnt lgkmcnt(3)
    v_mfma_f32_32x32x16_bf16 v[128:143], v[188:191], v[248:251], v[128:143]
    ds_read_b128 v[232:235], v32 offset:40960
    s_waitcnt lgkmcnt(3)
    v_mfma_f32_32x32x16_bf16 v[144:159], v[188:191], v[252:255], v[144:159]
    ds_read_b128 v[236:239], v32 offset:45056
    buffer_load_dwordx4 v[172:175], v2, s[60:63], s11 offen offset:1024 sc1
    s_waitcnt vmcnt(11)
    s_waitcnt lgkmcnt(3)
    v_mfma_f32_32x32x16_bf16 v[96:111], v[192:195], v[224:227], v[96:111]
    ds_read_b128 v[240:243], v33 offset:32768
    s_waitcnt lgkmcnt(3)
    v_mfma_f32_32x32x16_bf16 v[112:127], v[192:195], v[228:231], v[112:127]
    ds_read_b128 v[244:247], v33 offset:36864
    s_waitcnt lgkmcnt(3)
    v_mfma_f32_32x32x16_bf16 v[128:143], v[192:195], v[232:235], v[128:143]
    ds_read_b128 v[248:251], v33 offset:40960
    s_waitcnt lgkmcnt(3)
    v_mfma_f32_32x32x16_bf16 v[144:159], v[192:195], v[236:239], v[144:159]
    ds_read_b128 v[252:255], v33 offset:45056
    s_cmp_le_u32 s15, 5
    s_cselect_b32 s11, 6, 5
    s_lshl_b32 s11, s11, 14
    s_add_u32 s11, s11, 8192
    buffer_load_dwordx4 v[176:179], v3, s[60:63], s11 offen offset:0 sc1
    s_waitcnt vmcnt(11)
    s_waitcnt lgkmcnt(3)
    v_mfma_f32_32x32x16_bf16 v[96:111], v[196:199], v[240:243], v[96:111]
    ds_read_b128 v[224:227], v34 offset:32768
    s_waitcnt lgkmcnt(3)
    v_mfma_f32_32x32x16_bf16 v[112:127], v[196:199], v[244:247], v[112:127]
    ds_read_b128 v[228:231], v34 offset:36864
    s_waitcnt lgkmcnt(3)
    v_mfma_f32_32x32x16_bf16 v[128:143], v[196:199], v[248:251], v[128:143]
    ds_read_b128 v[232:235], v34 offset:40960
    s_waitcnt lgkmcnt(3)
    v_mfma_f32_32x32x16_bf16 v[144:159], v[196:199], v[252:255], v[144:159]
    ds_read_b128 v[236:239], v34 offset:45056
    buffer_load_dwordx4 v[180:183], v3, s[60:63], s11 offen offset:1024 sc1
    s_waitcnt vmcnt(11)
    s_waitcnt lgkmcnt(3)
    v_mfma_f32_32x32x16_bf16 v[96:111], v[200:203], v[224:227], v[96:111]
    ds_read_b128 v[240:243], v35 offset:32768
    s_waitcnt lgkmcnt(3)
    v_mfma_f32_32x32x16_bf16 v[112:127], v[200:203], v[228:231], v[112:127]
    ds_read_b128 v[244:247], v35 offset:36864
    s_waitcnt lgkmcnt(3)
    v_mfma_f32_32x32x16_bf16 v[128:143], v[200:203], v[232:235], v[128:143]
    ds_read_b128 v[248:251], v35 offset:40960
    s_waitcnt lgkmcnt(3)
    v_mfma_f32_32x32x16_bf16 v[144:159], v[200:203], v[236:239], v[144:159]
    ds_read_b128 v[252:255], v35 offset:45056
    buffer_load_dwordx4 v[184:187], v2, s[60:63], s11 offen offset:0 sc1
    s_barrier
    s_waitcnt vmcnt(11)
    s_waitcnt lgkmcnt(3)
    v_mfma_f32_32x32x16_bf16 v[96:111], v[204:207], v[240:243], v[96:111]
    ds_read_b128 v[224:227], v32 offset:49152
    s_waitcnt lgkmcnt(3)
    v_mfma_f32_32x32x16_bf16 v[112:127], v[204:207], v[244:247], v[112:127]
    ds_read_b128 v[228:231], v32 offset:53248
    s_waitcnt lgkmcnt(3)
    v_mfma_f32_32x32x16_bf16 v[128:143], v[204:207], v[248:251], v[128:143]
    ds_read_b128 v[232:235], v32 offset:57344
    s_waitcnt lgkmcnt(3)
    v_mfma_f32_32x32x16_bf16 v[144:159], v[204:207], v[252:255], v[144:159]
    ds_read_b128 v[236:239], v32 offset:61440
    buffer_load_dwordx4 v[188:191], v2, s[60:63], s11 offen offset:1024 sc1
    s_waitcnt vmcnt(11)
    s_waitcnt lgkmcnt(3)
    v_mfma_f32_32x32x16_bf16 v[96:111], v[208:211], v[224:227], v[96:111]
    ds_read_b128 v[240:243], v33 offset:49152
    s_waitcnt lgkmcnt(3)
    v_mfma_f32_32x32x16_bf16 v[112:127], v[208:211], v[228:231], v[112:127]
    ds_read_b128 v[244:247], v33 offset:53248
    s_waitcnt lgkmcnt(3)
    v_mfma_f32_32x32x16_bf16 v[128:143], v[208:211], v[232:235], v[128:143]
    ds_read_b128 v[248:251], v33 offset:57344
    s_waitcnt lgkmcnt(3)
    v_mfma_f32_32x32x16_bf16 v[144:159], v[208:211], v[236:239], v[144:159]
    ds_read_b128 v[252:255], v33 offset:61440
    s_and_b32 s88, s90, 0xfffc
    s_cmp_eq_u32 s88, 0xfffc
    s_cbranch_scc0 c_n6_s
c_n6:
    s_cmp_le_u32 s15, 6
    s_cselect_b32 s11, 7, 6
    s_lshl_b32 s11, s11, 14
    buffer_load_dwordx4 v[192:195], v3, s[60:63], s11 offen offset:0 sc1
    s_waitcnt vmcnt(11)
    s_waitcnt lgkmcnt(3)
    v_mfma_f32_32x32x16_bf16 v[96:111], v[212:215], v[240:243], v[96:111]
    ds_read_b128 v[224:227], v34 offset:49152
    s_waitcnt lgkmcnt(3)
    v_mfma_f32_32x32x16_bf16 v[112:127], v[212:215], v[244:247], v[112:127]
    ds_read_b128 v[228:231], v34 offset:53248
    s_waitcnt lgkmcnt(3)
    v_mfma_f32_32x32x16_bf16 v[128:143], v[212:215], v[248:251], v[128:143]
    ds_read_b128 v[232:235], v34 offset:57344
    s_waitcnt lgkmcnt(3)
    v_mfma_f32_32x32x16_bf16 v[144:159], v[212:215], v[252:255], v[144:159]
    ds_read_b128 v[236:239], v34 offset:61440
    buffer_load_dwordx4 v[196:199], v3, s[60:63], s11 offen offset:1024 sc1
    s_waitcnt vmcnt(11)
    s_waitcnt lgkmcnt(3)
    v_mfma_f32_32x32x16_bf16 v[96:111], v[216:219], v[224:227], v[96:111]
    ds_read_b128 v[240:243], v35 offset:49152
    s_waitcnt lgkmcnt(3)
    v_mfma_f32_32x32x16_bf16 v[112:127], v[216:219], v[228:231], v[112:127]
    ds_read_b128 v[244:247], v35 offset:53248
    s_waitcnt lgkmcnt(3)
    v_mfma_f32_32x32x16_bf16 v[128:143], v[216:219], v[232:235], v[128:143]
    ds_read_b128 v[248:251], v35 offset:57344
    s_waitcnt lgkmcnt(3)
    v_mfma_f32_32x32x16_bf16 v[144:159], v[216:219], v[236:239], v[144:159]
    ds_read_b128 v[252:255], v35 offset:61440
    buffer_load_dwordx4 v[200:203], v2, s[60:63], s11 offen offset:0 sc1
    s_barrier
    s_waitcnt vmcnt(11)
    s_waitcnt lgkmcnt(3)
    v_mfma_f32_32x32x16_bf16 v[96:111], v[220:223], v[240:243], v[96:111]
    ds_read_b128 v[224:227], v32 offset:0
    s_waitcnt lgkmcnt(3)
    v_mfma_f32_32x32x16_bf16 v[112:127], v[220:223], v[244:247], v[112:127]
    ds_read_b128 v[228:231], v32 offset:4096
    s_waitcnt lgkmcnt(3)
    v_mfma_f32_32x32x16_bf16 v[128:143], v[220:223], v[248:251], v[128:143]
    ds_read_b128 v[232:235], v32 offset:8192
    s_waitcnt lgkmcnt(3)
    v_mfma_f32_32x32x16_bf16 v[144:159], v[220:223], v[252:255], v[144:159]
    ds_read_b128 v[236:239], v32 offset:12288
    buffer_load_dwordx4 v[204:207], v2, s[60:63], s11 offen offset:1024 sc1
    s_waitcnt vmcnt(11)
    s_waitcnt lgkmcnt(3)
    v_mfma_f32_32x32x16_bf16 v[96:111], v[160:163], v[224:227], v[96:111]
    ds_read_b128 v[240:243], v33 offset:0
    s_waitcnt lgkmcnt(3)
    v_mfma_f32_32x32x16_bf16 v[112:127], v[160:163], v[228:231], v[112:127]
    ds_read_b128 v[244:247], v33 offset:4096
    s_waitcnt lgkmcnt(3)
    v_mfma_f32_32x32x16_bf16 v[128:143], v[160:163], v[232:235], v[128:143]
    ds_read_b128 v[248:251], v33 offset:8192
    s_waitcnt lgkmcnt(3)
    v_mfma_f32_32x32x16_bf16 v[144:159], v[160:163], v[236:239], v[144:159]
    ds_read_b128 v[252:255], v33 offset:12288
    s_cmp_le_u32 s15, 6
    s_cselect_b32 s11, 7, 6
    s_lshl_b32 s11, s11, 14
    s_add_u32 s11, s11, 8192
    buffer_load_dwordx4 v[208:211], v3, s[60:63], s11 offen offset:0 sc1
    s_waitcnt vmcnt(11)
    s_waitcnt lgkmcnt(3)
    v_mfma_f32_32x32x16_bf16 v[96:111], v[164:167], v[240:243], v[96:111]
    ds_read_b128 v[224:227], v34 offset:0
    s_waitcnt lgkmcnt(3)
    v_mfma_f32_32x32x16_bf16 v[112:127], v[164:167], v[244:247], v[112:127]
    ds_read_b128 v[228:231], v34 offset:4096
    s_waitcnt lgkmcnt(3)
    v_mfma_f32_32x32x16_bf16 v[128:143], v[164:167], v[248:251], v[128:143]
    ds_read_b128 v[232:235], v34 offset:8192
    s_waitcnt lgkmcnt(3)
    v_mfma_f32_32x32x16_bf16 v[144:159], v[164:167], v[252:255], v[144:159]
    ds_read_b128 v[236:239], v34 offset:12288
    buffer_load_dwordx4 v[212:215], v3, s[60:63], s11 offen offset:1024 sc1
    s_waitcnt vmcnt(11)
    s_waitcnt lgkmcnt(3)
    v_mfma_f32_32x32x16_bf16 v[96:111], v[168:171], v[224:227], v[96:111]
    ds_read_b128 v[240:243], v35 offset:0
    s_waitcnt lgkmcnt(3)
    v_mfma_f32_32x32x16_bf16 v[112:127], v[168:171], v[228:231], v[112:127]
    ds_read_b128 v[244:247], v35 offset:4096
    s_waitcnt lgkmcnt(3)
    v_mfma_f32_32x32x16_bf16 v[128:143], v[168:171], v[232:235], v[128:143]
    ds_read_b128 v[248:251], v35 offset:8192
    s_waitcnt lgkmcnt(3)
    v_mfma_f32_32x32x16_bf16 v[144:159], v[168:171], v[236:239], v[144:159]
    ds_read_b128 v[252:255], v35 offset:12288
    buffer_load_dwordx4 v[216:219], v2, s[60:63], s11 offen offset:0 sc1
    s_barrier
    s_waitcnt vmcnt(11)
    s_waitcnt lgkmcnt(3)
    v_mfma_f32_32x32x16_bf16 v[96:111], v[172:175], v[240:243], v[96:111]
    ds_read_b128 v[224:227], v32 offset:16384
    s_waitcnt lgkmcnt(3)
    v_mfma_f32_32x32x16_bf16 v[112:127], v[172:175], v[244:247], v[112:127]
    ds_read_b128 v[228:231], v32 offset:20480
    s_waitcnt lgkmcnt(3)
    v_mfma_f32_32x32x16_bf16 v[128:143], v[172:175], v[248:251], v[128:143]
    ds_read_b128 v[232:235], v32 offset:24576
    s_waitcnt lgkmcnt(3)
    v_mfma_f32_32x32x16_bf16 v[144:159], v[172:175], v[252:255], v[144:159]
    ds_read_b128 v[236:239], v32 offset:28672
    buffer_load_dwordx4 v[220:223], v2, s[60:63], s11 offen offset:1024 sc1
    s_waitcnt vmcnt(11)
    s_waitcnt lgkmcnt(3)
    v_mfma_f32_32x32x16_bf16 v[96:111], v[176:179], v[224:227], v[96:111]
    ds_read_b128 v[240:243], v33 offset:16384
    s_waitcnt lgkmcnt(3)
    v_mfma_f32_32x32x16_bf16 v[112:127], v[176:179], v[228:231], v[112:127]
    ds_read_b128 v[244:247], v33 offset:20480
    s_waitcnt lgkmcnt(3)
    v_mfma_f32_32x32x16_bf16 v[128:143], v[176:179], v[232:235], v[128:143]
    ds_read_b128 v[248:251], v33 offset:24576
    s_waitcnt lgkmcnt(3)
    v_mfma_f32_32x32x16_bf16 v[144:159], v[176:179], v[236:239], v[144:159]
    ds_read_b128 v[252:255], v33 offset:28672
    s_waitcnt vmcnt(10)
    s_waitcnt lgkmcnt(3)
    v_mfma_f32_32x32x16_bf16 v[96:111], v[180:183], v[240:243], v[96:111]
    ds_read_b128 v[224:227], v34 offset:16384
    s_waitcnt lgkmcnt(3)
    v_mfma_f32_32x32x16_bf16 v[112:127], v[180:183], v[244:247], v[112:127]
    ds_read_b128 v[228:231], v34 offset:20480
    s_waitcnt lgkmcnt(3)
    v_mfma_f32_32x32x16_bf16 v[128:143], v[180:183], v[248:251], v[128:143]
    ds_read_b128 v[232:235], v34 offset:24576
    s_waitcnt lgkmcnt(3)
    v_mfma_f32_32x32x16_bf16 v[144:159], v[180:183], v[252:255], v[144:159]
    ds_read_b128 v[236:239], v34 offset:28672
    s_waitcnt vmcnt(9)
    s_waitcnt lgkmcnt(3)
    v_mfma_f32_32x32x16_bf16 v[96:111], v[184:187], v[224:227], v[96:111]
    ds_read_b128 v[240:243], v35 offset:16384
    s_waitcnt lgkmcnt(3)
    v_mfma_f32_32x32x16_bf16 v[112:127], v[184:187], v[228:231], v[112:127]
    ds_read_b128 v[244:247], v35 offset:20480
    s_waitcnt lgkmcnt(3)
    v_mfma_f32_32x32x16_bf16 v[128:143], v[184:187], v[232:235], v[128:143]
    ds_read_b128 v[248:251], v35 offset:24576
    s_waitcnt lgkmcnt(3)
    v_mfma_f32_32x32x16_bf16 v[144:159], v[184:187], v[236:239], v[144:159]
    ds_read_b128 v[252:255], v35 offset:28672
    s_barrier
    s_waitcnt vmcnt(8)
    s_waitcnt lgkmcnt(3)
    v_mfma_f32_32x32x16_bf16 v[96:111], v[188:191], v[240:243], v[96:111]
    ds_read_b128 v[224:227], v32 offset:32768
    s_waitcnt lgkmcnt(3)
    v_mfma_f32_32x32x16_bf16 v[112:127], v[188:191], v[244:247], v[112:127]
    ds_read_b128 v[228:231], v32 offset:36864
    s_waitcnt lgkmcnt(3)
    v_mfma_f32_32x32x16_bf16 v[128:143], v[188:191], v[248:251], v[128:143]
    ds_read_b128 v[232:235], v32 offset:40960
    s_waitcnt lgkmcnt(3)
    v_mfma_f32_32x32x16_bf16 v[144:159], v[188:191], v[252:255], v[144:159]
    ds_read_b128 v[236:239], v32 offset:45056
    s_waitcnt vmcnt(7)
    s_waitcnt lgkmcnt(3)
    v_mfma_f32_32x32x16_bf16 v[96:111], v[192:195], v[224:227], v[96:111]
    ds_read_b128 v[240:243], v33 offset:32768
    s_waitcnt lgkmcnt(3)
    v_mfma_f32_32x32x16_bf16 v[112:127], v[192:195], v[228:231], v[112:127]
    ds_read_b128 v[244:247], v33 offset:36864
    s_waitcnt lgkmcnt(3)
    v_mfma_f32_32x32x16_bf16 v[128:143], v[192:195], v[232:235], v[128:143]
    ds_read_b128 v[248:251], v33 offset:40960
    s_waitcnt lgkmcnt(3)
    v_mfma_f32_32x32x16_bf16 v[144:159], v[192:195], v[236:239], v[144:159]
    ds_read_b128 v[252:255], v33 offset:45056
    s_waitcnt vmcnt(6)
    s_waitcnt lgkmcnt(3)
    v_mfma_f32_32x32x16_bf16 v[96:111], v[196:199], v[240:243], v[96:111]
    ds_read_b128 v[224:227], v34 offset:32768
    s_waitcnt lgkmcnt(3)
    v_mfma_f32_32x32x16_bf16 v[112:127], v[196:199], v[244:247], v[112:127]
    ds_read_b128 v[228:231], v34 offset:36864
    s_waitcnt lgkmcnt(3)
    v_mfma_f32_32x32x16_bf16 v[128:143], v[196:199], v[248:251], v[128:143]
    ds_read_b128 v[232:235], v34 offset:40960
    s_waitcnt lgkmcnt(3)
    v_mfma_f32_32x32x16_bf16 v[144:159], v[196:199], v[252:255], v[144:159]
    ds_read_b128 v[236:239], v34 offset:45056
    s_waitcnt vmcnt(5)
    s_waitcnt lgkmcnt(3)
    v_mfma_f32_32x32x16_bf16 v[96:111], v[200:203], v[224:227], v[96:111]
    ds_read_b128 v[240:243], v35 offset:32768
    s_waitcnt lgkmcnt(3)
    v_mfma_f32_32x32x16_bf16 v[112:127], v[200:203], v[228:231], v[112:127]
    ds_read_b128 v[244:247], v35 offset:36864
    s_waitcnt lgkmcnt(3)
    v_mfma_f32_32x32x16_bf16 v[128:143], v[200:203], v[232:235], v[128:143]
    ds_read_b128 v[248:251], v35 offset:40960
    s_waitcnt lgkmcnt(3)
    v_mfma_f32_32x32x16_bf16 v[144:159], v[200:203], v[236:239], v[144:159]
    ds_read_b128 v[252:255], v35 offset:45056
    s_barrier
    s_waitcnt vmcnt(4)
    s_waitcnt lgkmcnt(3)
    v_mfma_f32_32x32x16_bf16 v[96:111], v[204:207], v[240:243], v[96:111]
    ds_read_b128 v[224:227], v32 offset:49152
    s_waitcnt lgkmcnt(3)
    v_mfma_f32_32x32x16_bf16 v[112:127], v[204:207], v[244:247], v[112:127]
    ds_read_b128 v[228:231], v32 offset:53248
    s_waitcnt lgkmcnt(3)
    v_mfma_f32_32x32x16_bf16 v[128:143], v[204:207], v[248:251], v[128:143]
    ds_read_b128 v[232:235], v32 offset:57344
    s_waitcnt lgkmcnt(3)
    v_mfma_f32_32x32x16_bf16 v[144:159], v[204:207], v[252:255], v[144:159]
    ds_read_b128 v[236:239], v32 offset:61440
    ds_read_b128 v[240:243], v33 offset:49152
    ds_read_b128 v[244:247], v33 offset:53248
    ds_read_b128 v[248:251], v34 offset:49152
    s_waitcnt vmcnt(3)
    s_waitcnt lgkmcnt(6)
    v_mfma_f32_32x32x16_bf16 v[96:111], v[208:211], v[224:227], v[96:111]
    ds_read_b128 v[252:255], v34 offset:53248
    s_waitcnt lgkmcnt(6)
    v_mfma_f32_32x32x16_bf16 v[112:127], v[208:211], v[228:231], v[112:127]
    ds_read_b128 v[224:227], v35 offset:49152
    s_waitcnt vmcnt(2)
    s_waitcnt lgkmcnt(4)
    v_mfma_f32_32x32x16_bf16 v[96:111], v[212:215], v[240:243], v[96:111]
    ds_read_b128 v[228:231], v35 offset:53248
    s_waitcnt lgkmcnt(4)
    v_mfma_f32_32x32x16_bf16 v[112:127], v[212:215], v[244:247], v[112:127]
    ds_read_b128 v[240:243], v33 offset:57344
    s_waitcnt vmcnt(1)
    s_waitcnt lgkmcnt(4)
    v_mfma_f32_32x32x16_bf16 v[96:111], v[216:219], v[248:251], v[96:111]
    ds_read_b128 v[244:247], v33 offset:61440
    s_waitcnt lgkmcnt(4)
    v_mfma_f32_32x32x16_bf16 v[112:127], v[216:219], v[252:255], v[112:127]
    ds_read_b128 v[248:251], v34 offset:57344
    s_waitcnt vmcnt(0)
    s_waitcnt lgkmcnt(4)
    v_mfma_f32_32x32x16_bf16 v[96:111], v[220:223], v[224:227], v[96:111]
    ds_read_b128 v[252:255], v34 offset:61440
    s_waitcnt lgkmcnt(4)
    v_mfma_f32_32x32x16_bf16 v[112:127], v[220:223], v[228:231], v[112:127]
    ds_read_b128 v[224:227], v35 offset:57344
    v_mfma_f32_32x32x16_bf16 v[128:143], v[208:211], v[232:235], v[128:143]
    ds_read_b128 v[228:231], v35 offset:61440
    v_mfma_f32_32x32x16_bf16 v[144:159], v[208:211], v[236:239], v[144:159]
    s_waitcnt lgkmcnt(5)
    v_mfma_f32_32x32x16_bf16 v[128:143], v[212:215], v[240:243], v[128:143]
    s_nop 2
    buffer_store_dwordx4 v[96:99], v28, s[92:95], s74 offen offset:0 sc1
    buffer_store_dwordx4 v[100:103], v28, s[92:95], s74 offen offset:1024 sc1
    s_waitcnt lgkmcnt(4)
    v_mfma_f32_32x32x16_bf16 v[144:159], v[212:215], v[244:247], v[144:159]
    buffer_store_dwordx4 v[104:107], v28, s[92:95], s74 offen offset:2048 sc1
    buffer_store_dwordx4 v[108:111], v28, s[92:95], s74 offen offset:3072 sc1
    s_waitcnt lgkmcnt(3)
    v_mfma_f32_32x32x16_bf16 v[128:143], v[216:219], v[248:251], v[128:143]
    buffer_store_dwordx4 v[112:115], v28, s[92:95], s75 offen offset:0 sc1
    buffer_store_dwordx4 v[116:119], v28, s[92:95], s75 offen offset:1024 sc1
    s_waitcnt lgkmcnt(2)
    v_mfma_f32_32x32x16_bf16 v[144:159], v[216:219], v[252:255], v[144:159]
    buffer_store_dwordx4 v[120:123], v28, s[92:95], s75 offen offset:2048 sc1
    buffer_store_dwordx4 v[124:127], v28, s[92:95], s75 offen offset:3072 sc1
    s_waitcnt lgkmcnt(1)
    v_mfma_f32_32x32x16_bf16 v[128:143], v[220:223], v[224:227], v[128:143]
    s_waitcnt lgkmcnt(0)
    v_mfma_f32_32x32x16_bf16 v[144:159], v[220:223], v[228:231], v[144:159]
    s_mov_b32 s12, 0xffff0000
    ds_read_u16 v64, v61 offset:0
    ds_read_u16 v65, v61 offset:128
    ds_read_u16 v66, v61 offset:256
    ds_read_u16 v67, v61 offset:384
    ds_read_u16 v68, v61 offset:512
    ds_read_u16 v69, v61 offset:640
    ds_read_u16 v70, v61 offset:768
    ds_read_u16 v71, v61 offset:896
    ds_read_u16 v72, v61 offset:1024
    ds_read_u16 v73, v61 offset:1152
    ds_read_u16 v74, v61 offset:1280
    ds_read_u16 v75, v61 offset:1408
    ds_read_u16 v76, v61 offset:1536
    ds_read_u16 v77, v61 offset:1664
    ds_read_u16 v78, v61 offset:1792
    ds_read_u16 v79, v61 offset:1920
    ds_read_u16 v80, v61 offset:64
    ds_read_u16 v81, v61 offset:192
    ds_read_u16 v82, v61 offset:320
    ds_read_u16 v83, v61 offset:448
    ds_read_u16 v84, v61 offset:576
    ds_read_u16 v85, v61 offset:704
    ds_read_u16 v86, v61 offset:832
    ds_read_u16 v87, v61 offset:960
    ds_read_u16 v88, v61 offset:1088
    ds_read_u16 v89, v61 offset:1216
    ds_read_u16 v90, v61 offset:1344
    ds_read_u16 v91, v61 offset:1472
    ds_read_u16 v92, v61 offset:1600
    ds_read_u16 v93, v61 offset:1728
    ds_read_u16 v94, v61 offset:1856
    ds_read_u16 v95, v61 offset:1984
    ds_read_b128 v[160:163], v21 offset:0
    ds_read_b128 v[164:167], v21 offset:16
    ds_read_b128 v[168:171], v21 offset:8704
    ds_read_b128 v[172:175], v21 offset:8720
    v_lshlrev_b32 v192, 16, v36
    v_and_b32 v176, s12, v36
    v_lshlrev_b32 v193, 16, v37
    v_and_b32 v177, s12, v37
    v_lshlrev_b32 v194, 16, v38
    v_and_b32 v178, s12, v38
    v_lshlrev_b32 v195, 16, v39
    v_and_b32 v179, s12, v39
    v_lshlrev_b32 v196, 16, v40
    v_and_b32 v180, s12, v40
    v_lshlrev_b32 v197, 16, v41
    v_and_b32 v181, s12, v41
    v_lshlrev_b32 v198, 16, v42
    v_and_b32 v182, s12, v42
    v_lshlrev_b32 v199, 16, v43
    v_and_b32 v183, s12, v43
    v_lshlrev_b32 v200, 16, v44
    v_and_b32 v184, s12, v44
    v_lshlrev_b32 v201, 16, v45
    v_and_b32 v185, s12, v45
    v_lshlrev_b32 v202, 16, v46
    v_and_b32 v186, s12, v46
    v_lshlrev_b32 v203, 16, v47
    v_and_b32 v187, s12, v47
    v_lshlrev_b32 v204, 16, v48
    v_and_b32 v188, s12, v48
    v_lshlrev_b32 v205, 16, v49
    v_and_b32 v189, s12, v49
    v_lshlrev_b32 v206, 16, v50
    v_and_b32 v190, s12, v50
    v_lshlrev_b32 v207, 16, v51
    v_and_b32 v191, s12, v51
    v_lshlrev_b32 v52, 16, v52
    v_lshlrev_b32 v53, 16, v53
    s_waitcnt lgkmcnt(0)
    v_lshlrev_b32 v64, 16, v64
    v_lshlrev_b32 v66, 16, v66
    v_lshlrev_b32 v68, 16, v68
    v_lshlrev_b32 v70, 16, v70
    v_lshlrev_b32 v65, 16, v65
    v_lshlrev_b32 v67, 16, v67
    v_lshlrev_b32 v69, 16, v69
    v_lshlrev_b32 v71, 16, v71
    v_lshlrev_b32 v208, 16, v160
    v_lshlrev_b32 v214, 16, v161
    v_lshlrev_b32 v220, 16, v162
    v_lshlrev_b32 v226, 16, v163
    v_and_b32 v209, s12, v160
    v_and_b32 v215, s12, v161
    v_and_b32 v221, s12, v162
    v_and_b32 v227, s12, v163
    v_mul_f32 v210, v64, v52
    v_mul_f32 v216, v66, v52
    v_mul_f32 v222, v68, v52
    v_mul_f32 v228, v70, v52
    v_mul_f32 v211, v65, v52
    v_mul_f32 v217, v67, v52
    v_mul_f32 v223, v69, v52
    v_mul_f32 v229, v71, v52
    v_mul_f32 v208, v64, v208
    v_mul_f32 v214, v66, v214
    v_mul_f32 v220, v68, v220
    v_mul_f32 v226, v70, v226
    v_mul_f32 v209, v65, v209
    v_mul_f32 v215, v67, v215
    v_mul_f32 v221, v69, v221
    v_mul_f32 v227, v71, v227
    v_cvt_pk_bf16_f32 v212, v210, v211
    v_cvt_pk_bf16_f32 v218, v216, v217
    v_cvt_pk_bf16_f32 v224, v222, v223
    v_cvt_pk_bf16_f32 v230, v228, v229
    v_cvt_pk_bf16_f32 v213, v208, v209
    v_cvt_pk_bf16_f32 v219, v214, v215
    v_cvt_pk_bf16_f32 v225, v220, v221
    v_cvt_pk_bf16_f32 v231, v226, v227
    v_lshlrev_b32 v210, 16, v212
    v_lshlrev_b32 v216, 16, v218
    v_lshlrev_b32 v222, 16, v224
    v_lshlrev_b32 v228, 16, v230
    v_and_b32 v211, s12, v212
    v_and_b32 v217, s12, v218
    v_and_b32 v223, s12, v224
    v_and_b32 v229, s12, v230
    v_lshlrev_b32 v208, 16, v213
    v_lshlrev_b32 v214, 16, v219
    v_lshlrev_b32 v220, 16, v225
    v_lshlrev_b32 v226, 16, v231
    v_and_b32 v209, s12, v213
    v_and_b32 v215, s12, v219
    v_and_b32 v221, s12, v225
    v_and_b32 v227, s12, v231
    v_add_f32 v128, v128, v210
    v_add_f32 v130, v130, v216
    v_add_f32 v132, v132, v222
    v_add_f32 v134, v134, v228
    v_add_f32 v129, v129, v211
    v_add_f32 v131, v131, v217
    v_add_f32 v133, v133, v223
    v_add_f32 v135, v135, v229
    v_mul_f32 v208, v208, v176
    v_mul_f32 v214, v214, v178
    v_mul_f32 v220, v220, v180
    v_mul_f32 v226, v226, v182
    v_mul_f32 v209, v209, v177
    v_mul_f32 v215, v215, v179
    v_mul_f32 v221, v221, v181
    v_mul_f32 v227, v227, v183
    v_cvt_pk_bf16_f32 v212, v208, v209
    v_cvt_pk_bf16_f32 v218, v214, v215
    v_cvt_pk_bf16_f32 v224, v220, v221
    v_cvt_pk_bf16_f32 v230, v226, v227
    v_lshlrev_b32 v208, 16, v212
    v_lshlrev_b32 v214, 16, v218
    v_lshlrev_b32 v220, 16, v224
    v_lshlrev_b32 v226, 16, v230
    v_and_b32 v209, s12, v212
    v_and_b32 v215, s12, v218
    v_and_b32 v221, s12, v224
    v_and_b32 v227, s12, v230
    v_fma_f32 v128, v128, v192, v208
    v_fma_f32 v130, v130, v194, v214
    v_fma_f32 v132, v132, v196, v220
    v_fma_f32 v134, v134, v198, v226
    v_fma_f32 v129, v129, v193, v209
    v_fma_f32 v131, v131, v195, v215
    v_fma_f32 v133, v133, v197, v221
    v_fma_f32 v135, v135, v199, v227
    v_lshlrev_b32 v72, 16, v72
    v_lshlrev_b32 v74, 16, v74
    v_lshlrev_b32 v76, 16, v76
    v_lshlrev_b32 v78, 16, v78
    v_lshlrev_b32 v73, 16, v73
    v_lshlrev_b32 v75, 16, v75
    v_lshlrev_b32 v77, 16, v77
    v_lshlrev_b32 v79, 16, v79
    v_lshlrev_b32 v208, 16, v164
    v_lshlrev_b32 v214, 16, v165
    v_lshlrev_b32 v220, 16, v166
    v_lshlrev_b32 v226, 16, v167
    v_and_b32 v209, s12, v164
    v_and_b32 v215, s12, v165
    v_and_b32 v221, s12, v166
    v_and_b32 v227, s12, v167
    v_mul_f32 v210, v72, v52
    v_mul_f32 v216, v74, v52
    v_mul_f32 v222, v76, v52
    v_mul_f32 v228, v78, v52
    v_mul_f32 v211, v73, v52
    v_mul_f32 v217, v75, v52
    v_mul_f32 v223, v77, v52
    v_mul_f32 v229, v79, v52
    v_mul_f32 v208, v72, v208
    v_mul_f32 v214, v74, v214
    v_mul_f32 v220, v76, v220
    v_mul_f32 v226, v78, v226
    v_mul_f32 v209, v73, v209
    v_mul_f32 v215, v75, v215
    v_mul_f32 v221, v77, v221
    v_mul_f32 v227, v79, v227
    v_cvt_pk_bf16_f32 v212, v210, v211
    v_cvt_pk_bf16_f32 v218, v216, v217
    v_cvt_pk_bf16_f32 v224, v222, v223
    v_cvt_pk_bf16_f32 v230, v228, v229
    v_cvt_pk_bf16_f32 v213, v208, v209
    v_cvt_pk_bf16_f32 v219, v214, v215
    v_cvt_pk_bf16_f32 v225, v220, v221
    v_cvt_pk_bf16_f32 v231, v226, v227
    v_lshlrev_b32 v210, 16, v212
    v_lshlrev_b32 v216, 16, v218
    v_lshlrev_b32 v222, 16, v224
    v_lshlrev_b32 v228, 16, v230
    v_and_b32 v211, s12, v212
    v_and_b32 v217, s12, v218
    v_and_b32 v223, s12, v224
    v_and_b32 v229, s12, v230
    v_lshlrev_b32 v208, 16, v213
    v_lshlrev_b32 v214, 16, v219
    v_lshlrev_b32 v220, 16, v225
    v_lshlrev_b32 v226, 16, v231
    v_and_b32 v209, s12, v213
    v_and_b32 v215, s12, v219
    v_and_b32 v221, s12, v225
    v_and_b32 v227, s12, v231
    v_add_f32 v136, v136, v210
    v_add_f32 v138, v138, v216
    v_add_f32 v140, v140, v222
    v_add_f32 v142, v142, v228
    v_add_f32 v137, v137, v211
    v_add_f32 v139, v139, v217
    v_add_f32 v141, v141, v223
    v_add_f32 v143, v143, v229
    v_mul_f32 v208, v208, v184
    v_mul_f32 v214, v214, v186
    v_mul_f32 v220, v220, v188
    v_mul_f32 v226, v226, v190
    v_mul_f32 v209, v209, v185
    v_mul_f32 v215, v215, v187
    v_mul_f32 v221, v221, v189
    v_mul_f32 v227, v227, v191
    v_cvt_pk_bf16_f32 v212, v208, v209
    v_cvt_pk_bf16_f32 v218, v214, v215
    v_cvt_pk_bf16_f32 v224, v220, v221
    v_cvt_pk_bf16_f32 v230, v226, v227
    v_lshlrev_b32 v208, 16, v212
    v_lshlrev_b32 v214, 16, v218
    v_lshlrev_b32 v220, 16, v224
    v_lshlrev_b32 v226, 16, v230
    v_and_b32 v209, s12, v212
    v_and_b32 v215, s12, v218
    v_and_b32 v221, s12, v224
    v_and_b32 v227, s12, v230
    v_fma_f32 v136, v136, v200, v208
    v_fma_f32 v138, v138, v202, v214
    v_fma_f32 v140, v140, v204, v220
    v_fma_f32 v142, v142, v206, v226
    v_fma_f32 v137, v137, v201, v209
    v_fma_f32 v139, v139, v203, v215
    v_fma_f32 v141, v141, v205, v221
    v_fma_f32 v143, v143, v207, v227
    s_waitcnt vmcnt(0)
    buffer_store_dword v23, v30, s[68:71], 0 offen sc1
    buffer_load_dword v19, v29, s[68:71], 0 offen sc1
    v_lshlrev_b32 v80, 16, v80
    v_lshlrev_b32 v82, 16, v82
    v_lshlrev_b32 v84, 16, v84
    v_lshlrev_b32 v86, 16, v86
    v_lshlrev_b32 v81, 16, v81
    v_lshlrev_b32 v83, 16, v83
    v_lshlrev_b32 v85, 16, v85
    v_lshlrev_b32 v87, 16, v87
    v_lshlrev_b32 v208, 16, v168
    v_lshlrev_b32 v214, 16, v169
    v_lshlrev_b32 v220, 16, v170
    v_lshlrev_b32 v226, 16, v171
    v_and_b32 v209, s12, v168
    v_and_b32 v215, s12, v169
    v_and_b32 v221, s12, v170
    v_and_b32 v227, s12, v171
    v_mul_f32 v210, v80, v53
    v_mul_f32 v216, v82, v53
    v_mul_f32 v222, v84, v53
    v_mul_f32 v228, v86, v53
    v_mul_f32 v211, v81, v53
    v_mul_f32 v217, v83, v53
    v_mul_f32 v223, v85, v53
    v_mul_f32 v229, v87, v53
    v_mul_f32 v208, v80, v208
    v_mul_f32 v214, v82, v214
    v_mul_f32 v220, v84, v220
    v_mul_f32 v226, v86, v226
    v_mul_f32 v209, v81, v209
    v_mul_f32 v215, v83, v215
    v_mul_f32 v221, v85, v221
    v_mul_f32 v227, v87, v227
    v_cvt_pk_bf16_f32 v212, v210, v211
    v_cvt_pk_bf16_f32 v218, v216, v217
    v_cvt_pk_bf16_f32 v224, v222, v223
    v_cvt_pk_bf16_f32 v230, v228, v229
    v_cvt_pk_bf16_f32 v213, v208, v209
    v_cvt_pk_bf16_f32 v219, v214, v215
    v_cvt_pk_bf16_f32 v225, v220, v221
    v_cvt_pk_bf16_f32 v231, v226, v227
    v_lshlrev_b32 v210, 16, v212
    v_lshlrev_b32 v216, 16, v218
    v_lshlrev_b32 v222, 16, v224
    v_lshlrev_b32 v228, 16, v230
    v_and_b32 v211, s12, v212
    v_and_b32 v217, s12, v218
    v_and_b32 v223, s12, v224
    v_and_b32 v229, s12, v230
    v_lshlrev_b32 v208, 16, v213
    v_lshlrev_b32 v214, 16, v219
    v_lshlrev_b32 v220, 16, v225
    v_lshlrev_b32 v226, 16, v231
    v_and_b32 v209, s12, v213
    v_and_b32 v215, s12, v219
    v_and_b32 v221, s12, v225
    v_and_b32 v227, s12, v231
    v_add_f32 v144, v144, v210
    v_add_f32 v146, v146, v216
    v_add_f32 v148, v148, v222
    v_add_f32 v150, v150, v228
    v_add_f32 v145, v145, v211
    v_add_f32 v147, v147, v217
    v_add_f32 v149, v149, v223
    v_add_f32 v151, v151, v229
    v_mul_f32 v208, v208, v176
    v_mul_f32 v214, v214, v178
    v_mul_f32 v220, v220, v180
    v_mul_f32 v226, v226, v182
    v_mul_f32 v209, v209, v177
    v_mul_f32 v215, v215, v179
    v_mul_f32 v221, v221, v181
    v_mul_f32 v227, v227, v183
    v_cvt_pk_bf16_f32 v212, v208, v209
    v_cvt_pk_bf16_f32 v218, v214, v215
    v_cvt_pk_bf16_f32 v224, v220, v221
    v_cvt_pk_bf16_f32 v230, v226, v227
    v_lshlrev_b32 v208, 16, v212
    v_lshlrev_b32 v214, 16, v218
    v_lshlrev_b32 v220, 16, v224
    v_lshlrev_b32 v226, 16, v230
    v_and_b32 v209, s12, v212
    v_and_b32 v215, s12, v218
    v_and_b32 v221, s12, v224
    v_and_b32 v227, s12, v230
    v_fma_f32 v144, v144, v192, v208
    v_fma_f32 v146, v146, v194, v214
    v_fma_f32 v148, v148, v196, v220
    v_fma_f32 v150, v150, v198, v226
    v_fma_f32 v145, v145, v193, v209
    v_fma_f32 v147, v147, v195, v215
    v_fma_f32 v149, v149, v197, v221
    v_fma_f32 v151, v151, v199, v227
    v_lshlrev_b32 v88, 16, v88
    v_lshlrev_b32 v90, 16, v90
    v_lshlrev_b32 v92, 16, v92
    v_lshlrev_b32 v94, 16, v94
    v_lshlrev_b32 v89, 16, v89
    v_lshlrev_b32 v91, 16, v91
    v_lshlrev_b32 v93, 16, v93
    v_lshlrev_b32 v95, 16, v95
    v_lshlrev_b32 v208, 16, v172
    v_lshlrev_b32 v214, 16, v173
    v_lshlrev_b32 v220, 16, v174
    v_lshlrev_b32 v226, 16, v175
    v_and_b32 v209, s12, v172
    v_and_b32 v215, s12, v173
    v_and_b32 v221, s12, v174
    v_and_b32 v227, s12, v175
    v_mul_f32 v210, v88, v53
    v_mul_f32 v216, v90, v53
    v_mul_f32 v222, v92, v53
    v_mul_f32 v228, v94, v53
    v_mul_f32 v211, v89, v53
    v_mul_f32 v217, v91, v53
    v_mul_f32 v223, v93, v53
    v_mul_f32 v229, v95, v53
    v_mul_f32 v208, v88, v208
    v_mul_f32 v214, v90, v214
    v_mul_f32 v220, v92, v220
    v_mul_f32 v226, v94, v226
    v_mul_f32 v209, v89, v209
    v_mul_f32 v215, v91, v215
    v_mul_f32 v221, v93, v221
    v_mul_f32 v227, v95, v227
    v_cvt_pk_bf16_f32 v212, v210, v211
    v_cvt_pk_bf16_f32 v218, v216, v217
    v_cvt_pk_bf16_f32 v224, v222, v223
    v_cvt_pk_bf16_f32 v230, v228, v229
    v_cvt_pk_bf16_f32 v213, v208, v209
    v_cvt_pk_bf16_f32 v219, v214, v215
    v_cvt_pk_bf16_f32 v225, v220, v221
    v_cvt_pk_bf16_f32 v231, v226, v227
    v_lshlrev_b32 v210, 16, v212
    v_lshlrev_b32 v216, 16, v218
    v_lshlrev_b32 v222, 16, v224
    v_lshlrev_b32 v228, 16, v230
    v_and_b32 v211, s12, v212
    v_and_b32 v217, s12, v218
    v_and_b32 v223, s12, v224
    v_and_b32 v229, s12, v230
    v_lshlrev_b32 v208, 16, v213
    v_lshlrev_b32 v214, 16, v219
    v_lshlrev_b32 v220, 16, v225
    v_lshlrev_b32 v226, 16, v231
    v_and_b32 v209, s12, v213
    v_and_b32 v215, s12, v219
    v_and_b32 v221, s12, v225
    v_and_b32 v227, s12, v231
    v_add_f32 v152, v152, v210
    v_add_f32 v154, v154, v216
    v_add_f32 v156, v156, v222
    v_add_f32 v158, v158, v228
    v_add_f32 v153, v153, v211
    v_add_f32 v155, v155, v217
    v_add_f32 v157, v157, v223
    v_add_f32 v159, v159, v229
    v_mul_f32 v208, v208, v184
    v_mul_f32 v214, v214, v186
    v_mul_f32 v220, v220, v188
    v_mul_f32 v226, v226, v190
    v_mul_f32 v209, v209, v185
    v_mul_f32 v215, v215, v187
    v_mul_f32 v221, v221, v189
    v_mul_f32 v227, v227, v191
    v_cvt_pk_bf16_f32 v212, v208, v209
    v_cvt_pk_bf16_f32 v218, v214, v215
    v_cvt_pk_bf16_f32 v224, v220, v221
    v_cvt_pk_bf16_f32 v230, v226, v227
    v_lshlrev_b32 v208, 16, v212
    v_lshlrev_b32 v214, 16, v218
    v_lshlrev_b32 v220, 16, v224
    v_lshlrev_b32 v226, 16, v230
    v_and_b32 v209, s12, v212
    v_and_b32 v215, s12, v218
    v_and_b32 v221, s12, v224
    v_and_b32 v227, s12, v230
    v_fma_f32 v152, v152, v200, v208
    v_fma_f32 v154, v154, v202, v214
    v_fma_f32 v156, v156, v204, v220
    v_fma_f32 v158, v158, v206, v226
    v_fma_f32 v153, v153, v201, v209
    v_fma_f32 v155, v155, v203, v215
    v_fma_f32 v157, v157, v205, v221
    v_fma_f32 v159, v159, v207, v227
    s_waitcnt vmcnt(0)
    s_mov_b32 s89, 65536
c_pf_chk:
    v_cmp_ne_u32 vcc, 1, v19
    s_nop 1
    s_cmp_eq_u64 vcc, 0
    s_cbranch_scc1 c_pf_ok
    s_sub_u32 s89, s89, 1
    s_cbranch_scc1 c_pf_ok
    s_sleep 4
    buffer_load_dword v19, v29, s[68:71], 0 offen sc1
    s_waitcnt vmcnt(0)
    s_branch c_pf_chk
c_pf_ok:
    s_lshl_b32 s12, s72, 6
    s_add_u32 s13, s12, 4096
    buffer_load_dwordx4 v[160:163], v28, s[92:95], s12 offen offset:0 sc1
    buffer_load_dwordx4 v[164:167], v28, s[92:95], s12 offen offset:1024 sc1
    buffer_load_dwordx4 v[168:171], v28, s[92:95], s12 offen offset:2048 sc1
    buffer_load_dwordx4 v[172:175], v28, s[92:95], s12 offen offset:3072 sc1
    buffer_load_dwordx4 v[176:179], v28, s[92:95], s13 offen offset:0 sc1
    buffer_load_dwordx4 v[180:183], v28, s[92:95], s13 offen offset:1024 sc1
    buffer_load_dwordx4 v[184:187], v28, s[92:95], s13 offen offset:2048 sc1
    buffer_load_dwordx4 v[188:191], v28, s[92:95], s13 offen offset:3072 sc1
    s_waitcnt vmcnt(7)
    v_fma_f32 v128, v160, v192, v128
    buffer_store_dword v128, v26, s[76:79], s80 offen offset:0 nt
    v_fma_f32 v129, v161, v193, v129
    buffer_store_dword v129, v26, s[76:79], s81 offen offset:0 nt
    v_fma_f32 v130, v162, v194, v130
    buffer_store_dword v130, v26, s[76:79], s82 offen offset:0 nt
    v_fma_f32 v131, v163, v195, v131
    buffer_store_dword v131, v26, s[76:79], s83 offen offset:0 nt
    s_waitcnt vmcnt(10)
    v_fma_f32 v132, v164, v196, v132
    buffer_store_dword v132, v26, s[76:79], s84 offen offset:0 nt
    v_fma_f32 v133, v165, v197, v133
    buffer_store_dword v133, v26, s[76:79], s85 offen offset:0 nt
    v_fma_f32 v134, v166, v198, v134
    buffer_store_dword v134, v26, s[76:79], s86 offen offset:0 nt
    v_fma_f32 v135, v167, v199, v135
    buffer_store_dword v135, v26, s[76:79], s87 offen offset:0 nt
    s_waitcnt vmcnt(13)
    v_fma_f32 v136, v168, v200, v136
    buffer_store_dword v136, v27, s[76:79], s80 offen offset:0 nt
    v_fma_f32 v137, v169, v201, v137
    buffer_store_dword v137, v27, s[76:79], s81 offen offset:0 nt
    v_fma_f32 v138, v170, v202, v138
    buffer_store_dword v138, v27, s[76:79], s82 offen offset:0 nt
    v_fma_f32 v139, v171, v203, v139
    buffer_store_dword v139, v27, s[76:79], s83 offen offset:0 nt
    s_waitcnt vmcnt(16)
    v_fma_f32 v140, v172, v204, v140
    buffer_store_dword v140, v27, s[76:79], s84 offen offset:0 nt
    v_fma_f32 v141, v173, v205, v141
    buffer_store_dword v141, v27, s[76:79], s85 offen offset:0 nt
    v_fma_f32 v142, v174, v206, v142
    buffer_store_dword v142, v27, s[76:79], s86 offen offset:0 nt
    v_fma_f32 v143, v175, v207, v143
    buffer_store_dword v143, v27, s[76:79], s87 offen offset:0 nt
    s_waitcnt vmcnt(19)
    v_fma_f32 v144, v176, v192, v144
    buffer_store_dword v144, v26, s[76:79], s80 offen offset:128 nt
    v_fma_f32 v145, v177, v193, v145
    buffer_store_dword v145, v26, s[76:79], s81 offen offset:128 nt
    v_fma_f32 v146, v178, v194, v146
    buffer_store_dword v146, v26, s[76:79], s82 offen offset:128 nt
    v_fma_f32 v147, v179, v195, v147
    buffer_store_dword v147, v26, s[76:79], s83 offen offset:128 nt
    s_waitcnt vmcnt(22)
    v_fma_f32 v148, v180, v196, v148
    buffer_store_dword v148, v26, s[76:79], s84 offen offset:128 nt
    v_fma_f32 v149, v181, v197, v149
    buffer_store_dword v149, v26, s[76:79], s85 offen offset:128 nt
    v_fma_f32 v150, v182, v198, v150
    buffer_store_dword v150, v26, s[76:79], s86 offen offset:128 nt
    v_fma_f32 v151, v183, v199, v151
    buffer_store_dword v151, v26, s[76:79], s87 offen offset:128 nt
    s_waitcnt vmcnt(25)
    v_fma_f32 v152, v184, v200, v152
    buffer_store_dword v152, v27, s[76:79], s80 offen offset:128 nt
    v_fma_f32 v153, v185, v201, v153
    buffer_store_dword v153, v27, s[76:79], s81 offen offset:128 nt
    v_fma_f32 v154, v186, v202, v154
    buffer_store_dword v154, v27, s[76:79], s82 offen offset:128 nt
    v_fma_f32 v155, v187, v203, v155
    buffer_store_dword v155, v27, s[76:79], s83 offen offset:128 nt
    s_waitcnt vmcnt(28)
    v_fma_f32 v156, v188, v204, v156
    buffer_store_dword v156, v27, s[76:79], s84 offen offset:128 nt
    v_fma_f32 v157, v189, v205, v157
    buffer_store_dword v157, v27, s[76:79], s85 offen offset:128 nt
    v_fma_f32 v158, v190, v206, v158
    buffer_store_dword v158, v27, s[76:79], s86 offen offset:128 nt
    v_fma_f32 v159, v191, v207, v159
    buffer_store_dword v159, v27, s[76:79], s87 offen offset:128 nt
    s_endpgm
c_n0_s:
    s_mov_b32 s89, 65536
c_n0_l:
    s_waitcnt vmcnt(0)
    buffer_load_dword v19, v22, s[68:71], 0 offen sc1
    s_waitcnt vmcnt(0)
    v_cmp_eq_u32 s[90:91], 1, v19
    s_nop 1
    s_and_b32 s88, s90, 0xc
    s_cmp_eq_u32 s88, 0xc
    s_cbranch_scc1 c_n0
    s_sub_u32 s89, s89, 1
    s_cbranch_scc1 c_n0
    s_branch c_n0_l
c_n1_s:
    s_mov_b32 s89, 65536
c_n1_l:
    s_waitcnt vmcnt(0)
    buffer_load_dword v19, v22, s[68:71], 0 offen sc1
    s_waitcnt vmcnt(0)
    v_cmp_eq_u32 s[90:91], 1, v19
    s_nop 1
    s_and_b32 s88, s90, 0x3c
    s_cmp_eq_u32 s88, 0x3c
    s_cbranch_scc1 c_n1
    s_sub_u32 s89, s89, 1
    s_cbranch_scc1 c_n1
    s_branch c_n1_l
c_n2_s:
    s_mov_b32 s89, 65536
c_n2_l:
    s_waitcnt vmcnt(0)
    buffer_load_dword v19, v22, s[68:71], 0 offen sc1
    s_waitcnt vmcnt(0)
    v_cmp_eq_u32 s[90:91], 1, v19
    s_nop 1
    s_and_b32 s88, s90, 0xfc
    s_cmp_eq_u32 s88, 0xfc
    s_cbranch_scc1 c_n2
    s_sub_u32 s89, s89, 1
    s_cbranch_scc1 c_n2
    s_branch c_n2_l
c_n3_s:
    s_mov_b32 s89, 65536
c_n3_l:
    s_waitcnt vmcnt(0)
    buffer_load_dword v19, v22, s[68:71], 0 offen sc1
    s_waitcnt vmcnt(0)
    v_cmp_eq_u32 s[90:91], 1, v19
    s_nop 1
    s_and_b32 s88, s90, 0x3fc
    s_cmp_eq_u32 s88, 0x3fc
    s_cbranch_scc1 c_n3
    s_sub_u32 s89, s89, 1
    s_cbranch_scc1 c_n3
    s_branch c_n3_l
c_n4_s:
    s_mov_b32 s89, 65536
c_n4_l:
    s_waitcnt vmcnt(0)
    buffer_load_dword v19, v22, s[68:71], 0 offen sc1
    s_waitcnt vmcnt(0)
    v_cmp_eq_u32 s[90:91], 1, v19
    s_nop 1
    s_and_b32 s88, s90, 0xffc
    s_cmp_eq_u32 s88, 0xffc
    s_cbranch_scc1 c_n4
    s_sub_u32 s89, s89, 1
    s_cbranch_scc1 c_n4
    s_branch c_n4_l
c_n5_s:
    s_mov_b32 s89, 65536
c_n5_l:
    s_waitcnt vmcnt(0)
    buffer_load_dword v19, v22, s[68:71], 0 offen sc1
    s_waitcnt vmcnt(0)
    v_cmp_eq_u32 s[90:91], 1, v19
    s_nop 1
    s_and_b32 s88, s90, 0x3ffc
    s_cmp_eq_u32 s88, 0x3ffc
    s_cbranch_scc1 c_n5
    s_sub_u32 s89, s89, 1
    s_cbranch_scc1 c_n5
    s_branch c_n5_l
c_n6_s:
    s_mov_b32 s89, 65536
c_n6_l:
    s_waitcnt vmcnt(0)
    buffer_load_dword v19, v22, s[68:71], 0 offen sc1
    s_waitcnt vmcnt(0)
    v_cmp_eq_u32 s[90:91], 1, v19
    s_nop 1
    s_and_b32 s88, s90, 0xfffc
    s_cmp_eq_u32 s88, 0xfffc
    s_cbranch_scc1 c_n6
    s_sub_u32 s89, s89, 1
    s_cbranch_scc1 c_n6
    s_branch c_n6_l
L_end:
    s_endpgm
.section .rodata,"a"
.p2align 6
.amdhsa_kernel gated_mix__ssm_conv_s5__ssm_conv_h3__prompt_kernel
  .amdhsa_next_free_vgpr 256
  .amdhsa_next_free_sgpr 102
  .amdhsa_accum_offset 256
  .amdhsa_group_segment_fixed_size 0
  .amdhsa_kernarg_size 152
  .amdhsa_user_sgpr_count 2
  .amdhsa_user_sgpr_kernarg_segment_ptr 1
  .amdhsa_system_sgpr_workgroup_id_x 1
  .amdhsa_float_denorm_mode_32 3
.end_amdhsa_kernel
```

```asm
; @launch grid=(256,1,1) block=(512,1,1) lds=163840
.amdgcn_target "amdgcn-amd-amdhsa--gfx950"
.text
.globl gated_mix__ssm_conv_s5__ssm_conv_h3__prompt_kernel
.p2align 8
.type gated_mix__ssm_conv_s5__ssm_conv_h3__prompt_kernel,@function
gated_mix__ssm_conv_s5__ssm_conv_h3__prompt_kernel:
    s_cmp_ge_u32 s2, 256
    s_cbranch_scc1 L_end
    s_load_dwordx16 s[16:31], s[0:1], 0
    s_load_dwordx16 s[32:47], s[0:1], 64
    s_load_dwordx4 s[48:51], s[0:1], 128
    s_load_dwordx2 s[52:53], s[0:1], 144
    s_and_b32 s54, s2, 7
    s_lshr_b32 s55, s2, 3
    s_lshr_b32 s4, s54, 1
    s_lshl_b32 s4, s4, 2
    s_and_b32 s6, s55, 3
    s_add_u32 s4, s4, s6
    s_and_b32 s5, s54, 1
    s_lshl_b32 s5, s5, 3
    s_lshr_b32 s6, s55, 2
    s_add_u32 s5, s5, s6
    v_and_b32 v1, 63, v0
    v_lshrrev_b32 v2, 6, v0
    s_and_b32 s15, s5, 7
    v_readfirstlane_b32 s3, v2
    s_nop 1
    s_cmp_ge_u32 s3, 4
    s_cbranch_scc0 L_consumer
    s_sub_u32 s3, s3, 4
    s_lshr_b32 s6, s3, 1
    s_and_b32 s7, s3, 1
    v_lshrrev_b32 v3, 5, v1
    v_lshlrev_b32 v3, 5, v3
    v_bfe_u32 v4, v1, 3, 1
    v_lshl_add_u32 v3, v4, 4, v3
    v_bfe_u32 v4, v1, 4, 1
    v_add_u32 v3, v3, v4
    s_lshl_b32 s8, s4, 7
    s_lshl_b32 s9, s6, 6
    s_add_u32 s8, s8, s9
    s_lshl_b32 s9, s7, 3
    s_add_u32 s8, s8, s9
    v_add_u32 v3, s8, v3
    v_lshlrev_b32 v3, 11, v3
    v_and_b32 v4, 7, v1
    v_lshrrev_b32 v5, 4, v1
    v_xor_b32 v4, v4, v5
    v_lshlrev_b32 v4, 4, v4
    v_xor_b32 v5, 64, v4
    s_lshl_b32 s8, s5, 6
    s_lshl_b32 s9, s7, 5
    s_add_u32 s8, s8, s9
    v_lshrrev_b32 v6, 3, v1
    v_add_u32 v7, s8, v6
    v_lshlrev_b32 v7, 11, v7
    v_add_u32 v8, v3, v4
    v_add_u32 v12, v7, v4
    v_add_u32 v9, v3, v5
    v_add_u32 v13, v7, v5
    v_add_u32 v9, 3072, v9
    v_add_u32 v13, 15360, v13
    v_add_u32 v10, v3, v4
    v_add_u32 v14, v7, v4
    v_add_u32 v10, 6144, v10
    v_add_u32 v14, 30720, v14
    v_add_u32 v11, v3, v5
    v_add_u32 v15, v7, v5
    v_add_u32 v11, 9216, v11
    v_add_u32 v15, 46080, v15
    s_lshl_b32 s10, s3, 12
    s_lshr_b32 s90, s55, 2
    s_lshl_b32 s90, s90, 1
    s_and_b32 s91, s55, 3
    s_lshl_b32 s91, s91, 2
    s_add_u32 s90, s90, s91
    s_waitcnt lgkmcnt(0)
    s_mov_b32 s56, s16
    s_mov_b32 s57, s17
    s_mov_b32 s58, 0x400000
    s_mov_b32 s59, 0x20000
    s_cmp_ge_u32 s3, 2
    s_cselect_b32 s60, s24, s22
    s_cselect_b32 s61, s25, s23
    s_mov_b32 s62, 0x200000
    s_mov_b32 s63, 0x20000
    s_add_u32 s11, s90, 0
    s_and_b32 s11, s11, 15
    s_lshl_b32 s11, s11, 7
    s_add_u32 m0, s10, 0x0
    s_nop 0
    buffer_load_dwordx4 v8, s[56:59], s11 offen offset:0 lds
    buffer_load_dwordx4 v9, s[56:59], s11 offen offset:1024 lds
    buffer_load_dwordx4 v10, s[56:59], s11 offen offset:2048 lds
    buffer_load_dwordx4 v11, s[56:59], s11 offen offset:3072 lds
    s_add_u32 m0, s10, 0x4000
    s_nop 0
    buffer_load_dwordx4 v12, s[60:63], s11 offen offset:0 lds
    buffer_load_dwordx4 v13, s[60:63], s11 offen offset:1024 lds
    buffer_load_dwordx4 v14, s[60:63], s11 offen offset:2048 lds
    buffer_load_dwordx4 v15, s[60:63], s11 offen offset:3072 lds
    s_and_b32 s8, s5, 7
    s_lshl_b32 s8, s8, 6
    s_lshl_b32 s9, s3, 4
    s_add_u32 s8, s8, s9
    v_add_u32 v7, s8, v6
    v_lshlrev_b32 v7, 11, v7
    v_add_u32 v28, v7, v4
    v_add_u32 v29, v7, v5
    v_add_u32 v29, 15360, v29
    s_and_b32 s12, s55, 1
    s_lshl_b32 s13, s54, 1
    s_add_u32 s12, s12, s13
    s_lshr_b32 s13, s55, 1
    s_lshl_b32 s8, s2, 7
    s_add_u32 s8, s8, 0x20000
    v_mov_b32 v30, s8
    s_lshl_b32 s88, s54, 5
    s_add_u32 s88, s88, s55
    s_lshl_b32 s8, s88, 7
    s_add_u32 s8, s8, 0x28000
    v_mov_b32 v31, s8
    s_lshl_b32 s88, s88, 2
    s_add_u32 s88, s88, s3
    v_mov_b32 v2, 0
    s_add_u32 s92, s52, 0x1200000
    s_addc_u32 s93, s53, 0
    s_mov_b32 s94, 0x50000
    s_mov_b32 s95, 0x20000
    s_lshl_b32 s8, s88, 12
    s_load_dword s100, s[42:43], s8
    s_lshr_b32 s8, s88, 1
    s_lshl_b32 s8, s8, 2
    s_load_dword s101, s[44:45], s8
    buffer_store_dword v2, v30, s[92:95], 0 offen sc1
    buffer_store_dword v2, v31, s[92:95], 0 offen sc1
    s_add_u32 s11, s90, 1
    s_and_b32 s11, s11, 15
    s_lshl_b32 s11, s11, 7
    s_add_u32 m0, s10, 0x8000
    s_nop 0
    buffer_load_dwordx4 v8, s[56:59], s11 offen offset:0 lds
    buffer_load_dwordx4 v9, s[56:59], s11 offen offset:1024 lds
    buffer_load_dwordx4 v10, s[56:59], s11 offen offset:2048 lds
    buffer_load_dwordx4 v11, s[56:59], s11 offen offset:3072 lds
    s_add_u32 m0, s10, 0xc000
    s_nop 0
    buffer_load_dwordx4 v12, s[60:63], s11 offen offset:0 lds
    buffer_load_dwordx4 v13, s[60:63], s11 offen offset:1024 lds
    buffer_load_dwordx4 v14, s[60:63], s11 offen offset:2048 lds
    buffer_load_dwordx4 v15, s[60:63], s11 offen offset:3072 lds
    s_lshl_b32 s13, s13, 7
    s_lshl_b32 s14, s3, 5
    s_add_u32 s13, s13, s14
    v_and_b32 v17, 31, v1
    s_lshl_b32 s14, s12, 5
    v_add_u32 v17, s14, v17
    v_lshlrev_b32 v22, 4, v17
    v_and_b32 v23, 31, v1
    v_mul_u32_u24 v23, 544, v23
    v_lshrrev_b32 v24, 5, v1
    v_lshlrev_b32 v24, 5, v24
    v_sub_u32 v23, v23, v24
    s_lshl_b32 s8, s3, 6
    s_sub_u32 s8, 131808, s8
    v_add_u32 v23, s8, v23
    v_lshrrev_b32 v24, 4, v1
    s_lshl_b32 s8, s3, 4
    v_add_u32 v24, s8, v24
    v_and_b32 v2, 15, v1
    v_lshlrev_b32 v2, 4, v2
    s_lshl_b32 s8, s12, 6
    v_add_u32 v27, s8, v24
    v_lshl_add_u32 v27, v27, 12, v2
    s_lshr_b32 s8, s55, 1
    s_lshl_b32 s8, s8, 8
    s_sub_u32 s8, 3840, s8
    v_add_u32 v27, s8, v27
    v_mul_u32_u24 v24, 272, v24
    v_add_u32 v24, v24, v2
    v_add_u32 v24, 0x20200, v24
    s_lshl_b32 s14, s4, 7
    s_lshl_b32 s8, s5, 3
    s_add_u32 s14, s14, s8
    s_lshl_b32 s8, s3, 1
    s_add_u32 s14, s14, s8
    s_lshl_b32 s8, s14, 11
    v_lshlrev_b32 v25, 4, v1
    v_add_u32 v26, s8, v25
    v_add_u32 v3, 0x8000, v27
    s_mov_b32 s64, s36
    s_mov_b32 s65, s37
    s_mov_b32 s66, 0x400000
    s_mov_b32 s67, 0x20000
    s_mov_b32 s68, s38
    s_mov_b32 s69, s39
    s_mov_b32 s70, 0x400000
    s_mov_b32 s71, 0x20000
    s_add_u32 s72, s52, 0x800000
    s_addc_u32 s73, s53, 0
    s_mov_b32 s74, 0x400000
    s_mov_b32 s75, 0x20000
    s_add_u32 s76, s52, 0x1000000
    s_addc_u32 s77, s53, 0
    s_mov_b32 s78, 0x2000
    s_mov_b32 s79, 0x20000
    s_mov_b32 s80, 0
    s_mov_b32 s81, 4096
    s_mov_b32 s82, 8192
    s_mov_b32 s83, 12288
    s_mov_b32 s84, 16384
    s_mov_b32 s85, 20480
    s_mov_b32 s86, 24576
    s_mov_b32 s87, 28672
    v_lshrrev_b32 v19, 3, v1
    v_add_u32 v19, s13, v19
    v_lshlrev_b32 v19, 11, v19
    v_and_b32 v20, 7, v1
    v_lshl_add_u32 v19, v20, 4, v19
    s_lshl_b32 s8, s12, 7
    v_add_u32 v19, s8, v19
    v_subrev_u32 v20, 16384, v19
    v_lshrrev_b32 v21, 5, v1
    v_lshlrev_b32 v21, 11, v21
    v_and_b32 v18, 31, v1
    v_lshl_add_u32 v21, v18, 2, v21
    s_lshl_b32 s8, s3, 12
    s_add_u32 s91, s8, 98304
    v_add_u32 v21, s91, v21
    v_mov_b32 v6, 0x24a00
    v_mov_b32 v7, 0
    ds_write_b32 v6, v7 offset:4
    ds_write_b32 v6, v7 offset:8
    ds_write_b32 v6, v7 offset:12
    ds_write_b32 v6, v7 offset:16
    s_waitcnt lgkmcnt(0)
    s_waitcnt vmcnt(8)
    s_barrier
    s_add_u32 s11, s90, 2
    s_and_b32 s11, s11, 15
    s_lshl_b32 s11, s11, 7
    s_add_u32 m0, s10, 0x10000
    s_nop 0
    buffer_load_dwordx4 v8, s[56:59], s11 offen offset:0 lds
    buffer_load_dwordx4 v9, s[56:59], s11 offen offset:1024 lds
    buffer_load_dwordx4 v10, s[56:59], s11 offen offset:2048 lds
    buffer_load_dwordx4 v11, s[56:59], s11 offen offset:3072 lds
    s_add_u32 m0, s10, 0x14000
    s_nop 0
    buffer_load_dwordx4 v12, s[60:63], s11 offen offset:0 lds
    buffer_load_dwordx4 v13, s[60:63], s11 offen offset:1024 lds
    buffer_load_dwordx4 v14, s[60:63], s11 offen offset:2048 lds
    buffer_load_dwordx4 v15, s[60:63], s11 offen offset:3072 lds
    buffer_load_dwordx4 v[72:75], v26, s[56:59], 0 offen offset:0
    buffer_load_dwordx4 v[76:79], v26, s[56:59], 0 offen offset:1024
    buffer_load_dwordx4 v[80:83], v26, s[56:59], 0 offen offset:2048
    buffer_load_dwordx4 v[84:87], v26, s[56:59], 0 offen offset:3072
    global_load_dwordx4 v[88:91], v25, s[46:47] offset:0
    global_load_dwordx4 v[92:95], v25, s[46:47] offset:1024
    s_waitcnt vmcnt(14)
    s_barrier
    s_add_u32 s11, s90, 3
    s_and_b32 s11, s11, 15
    s_lshl_b32 s11, s11, 7
    s_add_u32 m0, s10, 0x0
    s_nop 0
    buffer_load_dwordx4 v8, s[56:59], s11 offen offset:0 lds
    buffer_load_dwordx4 v9, s[56:59], s11 offen offset:1024 lds
    buffer_load_dwordx4 v10, s[56:59], s11 offen offset:2048 lds
    buffer_load_dwordx4 v11, s[56:59], s11 offen offset:3072 lds
    s_add_u32 m0, s10, 0x4000
    s_nop 0
    buffer_load_dwordx4 v12, s[60:63], s11 offen offset:0 lds
    buffer_load_dwordx4 v13, s[60:63], s11 offen offset:1024 lds
    buffer_load_dwordx4 v14, s[60:63], s11 offen offset:2048 lds
    buffer_load_dwordx4 v15, s[60:63], s11 offen offset:3072 lds
    s_waitcnt vmcnt(14)
    s_barrier
    s_add_u32 s11, s90, 4
    s_and_b32 s11, s11, 15
    s_lshl_b32 s11, s11, 7
    s_add_u32 m0, s10, 0x8000
    s_nop 0
    buffer_load_dwordx4 v8, s[56:59], s11 offen offset:0 lds
    s_mov_b32 s12, 0xffff0000
    s_waitcnt vmcnt(9)
    v_lshlrev_b32 v96, 16, v88
    v_and_b32 v97, s12, v88
    v_lshlrev_b32 v98, 16, v89
    v_and_b32 v99, s12, v89
    v_lshlrev_b32 v100, 16, v90
    v_and_b32 v101, s12, v90
    v_lshlrev_b32 v102, 16, v91
    v_and_b32 v103, s12, v91
    buffer_load_dwordx4 v9, s[56:59], s11 offen offset:1024 lds
    v_lshlrev_b32 v104, 16, v92
    v_and_b32 v105, s12, v92
    v_lshlrev_b32 v106, 16, v93
    v_and_b32 v107, s12, v93
    v_lshlrev_b32 v108, 16, v94
    v_and_b32 v109, s12, v94
    v_lshlrev_b32 v110, 16, v95
    v_and_b32 v111, s12, v95
    v_mov_b32 v112, 0
    v_lshlrev_b32 v116, 16, v72
    buffer_load_dwordx4 v10, s[56:59], s11 offen offset:2048 lds
    v_and_b32 v117, s12, v72
    v_mul_f32 v116, v116, v96
    v_mul_f32 v117, v117, v97
    v_cvt_pk_bf16_f32 v118, v116, v117
    v_lshlrev_b32 v116, 16, v118
    v_and_b32 v117, s12, v118
    v_add_f32 v112, v112, v116
    v_add_f32 v112, v112, v117
    v_lshlrev_b32 v116, 16, v73
    v_and_b32 v117, s12, v73
    buffer_load_dwordx4 v11, s[56:59], s11 offen offset:3072 lds
    v_mul_f32 v116, v116, v98
    v_mul_f32 v117, v117, v99
    v_cvt_pk_bf16_f32 v118, v116, v117
    v_lshlrev_b32 v116, 16, v118
    v_and_b32 v117, s12, v118
    v_add_f32 v112, v112, v116
    v_add_f32 v112, v112, v117
    v_lshlrev_b32 v116, 16, v74
    v_and_b32 v117, s12, v74
    v_mul_f32 v116, v116, v100
    s_add_u32 m0, s10, 0xc000
    s_nop 0
    buffer_load_dwordx4 v12, s[60:63], s11 offen offset:0 lds
    v_mul_f32 v117, v117, v101
    v_cvt_pk_bf16_f32 v118, v116, v117
    v_lshlrev_b32 v116, 16, v118
    v_and_b32 v117, s12, v118
    v_add_f32 v112, v112, v116
    v_add_f32 v112, v112, v117
    v_lshlrev_b32 v116, 16, v75
    v_and_b32 v117, s12, v75
    v_mul_f32 v116, v116, v102
    v_mul_f32 v117, v117, v103
    buffer_load_dwordx4 v13, s[60:63], s11 offen offset:1024 lds
    v_cvt_pk_bf16_f32 v118, v116, v117
    v_lshlrev_b32 v116, 16, v118
    v_and_b32 v117, s12, v118
    v_add_f32 v112, v112, v116
    v_add_f32 v112, v112, v117
    v_lshlrev_b32 v116, 16, v76
    v_and_b32 v117, s12, v76
    v_mul_f32 v116, v116, v104
    v_mul_f32 v117, v117, v105
    v_cvt_pk_bf16_f32 v118, v116, v117
    buffer_load_dwordx4 v14, s[60:63], s11 offen offset:2048 lds
    v_lshlrev_b32 v116, 16, v118
    v_and_b32 v117, s12, v118
    v_add_f32 v112, v112, v116
    v_add_f32 v112, v112, v117
    v_lshlrev_b32 v116, 16, v77
    v_and_b32 v117, s12, v77
    v_mul_f32 v116, v116, v106
    v_mul_f32 v117, v117, v107
    v_cvt_pk_bf16_f32 v118, v116, v117
    v_lshlrev_b32 v116, 16, v118
    buffer_load_dwordx4 v15, s[60:63], s11 offen offset:3072 lds
    v_and_b32 v117, s12, v118
    v_add_f32 v112, v112, v116
    v_add_f32 v112, v112, v117
    v_lshlrev_b32 v116, 16, v78
    v_and_b32 v117, s12, v78
    v_mul_f32 v116, v116, v108
    v_mul_f32 v117, v117, v109
    v_cvt_pk_bf16_f32 v118, v116, v117
    v_lshlrev_b32 v116, 16, v118
    v_and_b32 v117, s12, v118
    s_add_u32 m0, s91, 16384
    s_nop 0
    buffer_load_dwordx4 v20, s[64:67], 0 offen lds
    s_add_u32 m0, s91, 17408
    s_mov_b32 s99, 0
    buffer_load_dwordx4 v19, s[64:67], s99 offen lds
    s_add_u32 m0, s91, 18432
    s_mov_b32 s99, 16384
    buffer_load_dwordx4 v19, s[64:67], s99 offen lds
    s_add_u32 m0, s91, 19456
    s_mov_b32 s99, 32768
    buffer_load_dwordx4 v19, s[64:67], s99 offen lds
    s_add_u32 m0, s91, 20480
    s_mov_b32 s99, 49152
    buffer_load_dwordx4 v19, s[64:67], s99 offen lds
    global_load_dwordx4 v[68:71], v22, s[40:41]
    s_add_u32 m0, s91, 0
    s_mov_b32 s99, 0
    buffer_load_dwordx4 v19, s[68:71], s99 offen lds
    s_add_u32 m0, s91, 1024
    s_mov_b32 s99, 16384
    buffer_load_dwordx4 v19, s[68:71], s99 offen lds
    s_add_u32 m0, s91, 2048
    s_mov_b32 s99, 32768
    buffer_load_dwordx4 v19, s[68:71], s99 offen lds
    s_add_u32 m0, s91, 3072
    s_mov_b32 s99, 49152
    buffer_load_dwordx4 v19, s[68:71], s99 offen lds
    s_waitcnt vmcnt(18)
    s_barrier
    s_add_u32 s11, s90, 5
    s_and_b32 s11, s11, 15
    s_lshl_b32 s11, s11, 7
    s_add_u32 m0, s10, 0x10000
    s_nop 0
    buffer_load_dwordx4 v8, s[56:59], s11 offen offset:0 lds
    v_add_f32 v112, v112, v116
    v_add_f32 v112, v112, v117
    v_lshlrev_b32 v116, 16, v79
    v_and_b32 v117, s12, v79
    v_mul_f32 v116, v116, v110
    v_mul_f32 v117, v117, v111
    v_cvt_pk_bf16_f32 v118, v116, v117
    v_lshlrev_b32 v116, 16, v118
    v_and_b32 v117, s12, v118
    v_add_f32 v112, v112, v116
    buffer_load_dwordx4 v9, s[56:59], s11 offen offset:1024 lds
    v_add_f32 v112, v112, v117
    v_mov_b32 v113, 0
    v_lshlrev_b32 v116, 16, v80
    v_and_b32 v117, s12, v80
    v_mul_f32 v116, v116, v96
    v_mul_f32 v117, v117, v97
    v_cvt_pk_bf16_f32 v118, v116, v117
    v_lshlrev_b32 v116, 16, v118
    v_and_b32 v117, s12, v118
    v_add_f32 v113, v113, v116
    buffer_load_dwordx4 v10, s[56:59], s11 offen offset:2048 lds
    v_add_f32 v113, v113, v117
    v_lshlrev_b32 v116, 16, v81
    v_and_b32 v117, s12, v81
    v_mul_f32 v116, v116, v98
    v_mul_f32 v117, v117, v99
    v_cvt_pk_bf16_f32 v118, v116, v117
    v_lshlrev_b32 v116, 16, v118
    v_and_b32 v117, s12, v118
    v_add_f32 v113, v113, v116
    v_add_f32 v113, v113, v117
    buffer_load_dwordx4 v11, s[56:59], s11 offen offset:3072 lds
    v_lshlrev_b32 v116, 16, v82
    v_and_b32 v117, s12, v82
    v_mul_f32 v116, v116, v100
    v_mul_f32 v117, v117, v101
    v_cvt_pk_bf16_f32 v118, v116, v117
    v_lshlrev_b32 v116, 16, v118
    v_and_b32 v117, s12, v118
    v_add_f32 v113, v113, v116
    v_add_f32 v113, v113, v117
    v_lshlrev_b32 v116, 16, v83
    s_add_u32 m0, s10, 0x14000
    s_nop 0
    buffer_load_dwordx4 v12, s[60:63], s11 offen offset:0 lds
    v_and_b32 v117, s12, v83
    v_mul_f32 v116, v116, v102
    v_mul_f32 v117, v117, v103
    v_cvt_pk_bf16_f32 v118, v116, v117
    v_lshlrev_b32 v116, 16, v118
    v_and_b32 v117, s12, v118
    v_add_f32 v113, v113, v116
    v_add_f32 v113, v113, v117
    v_lshlrev_b32 v116, 16, v84
    v_and_b32 v117, s12, v84
    buffer_load_dwordx4 v13, s[60:63], s11 offen offset:1024 lds
    v_mul_f32 v116, v116, v104
    v_mul_f32 v117, v117, v105
    v_cvt_pk_bf16_f32 v118, v116, v117
    v_lshlrev_b32 v116, 16, v118
    v_and_b32 v117, s12, v118
    v_add_f32 v113, v113, v116
    v_add_f32 v113, v113, v117
    v_lshlrev_b32 v116, 16, v85
    v_and_b32 v117, s12, v85
    v_mul_f32 v116, v116, v106
    buffer_load_dwordx4 v14, s[60:63], s11 offen offset:2048 lds
    v_mul_f32 v117, v117, v107
    v_cvt_pk_bf16_f32 v118, v116, v117
    v_lshlrev_b32 v116, 16, v118
    v_and_b32 v117, s12, v118
    v_add_f32 v113, v113, v116
    v_add_f32 v113, v113, v117
    v_lshlrev_b32 v116, 16, v86
    v_and_b32 v117, s12, v86
    v_mul_f32 v116, v116, v108
    v_mul_f32 v117, v117, v109
    buffer_load_dwordx4 v15, s[60:63], s11 offen offset:3072 lds
    v_cvt_pk_bf16_f32 v118, v116, v117
    v_lshlrev_b32 v116, 16, v118
    v_and_b32 v117, s12, v118
    v_add_f32 v113, v113, v116
    v_add_f32 v113, v113, v117
    v_lshlrev_b32 v116, 16, v87
    v_and_b32 v117, s12, v87
    v_mul_f32 v116, v116, v110
    v_mul_f32 v117, v117, v111
    v_cvt_pk_bf16_f32 v118, v116, v117
    s_waitcnt vmcnt(18)
    s_barrier
    s_add_u32 s11, s90, 6
    s_and_b32 s11, s11, 15
    s_lshl_b32 s11, s11, 7
    s_add_u32 m0, s10, 0x0
    s_nop 0
    buffer_load_dwordx4 v8, s[56:59], s11 offen offset:0 lds
    v_lshlrev_b32 v116, 16, v118
    v_and_b32 v117, s12, v118
    v_add_f32 v113, v113, v116
    v_add_f32 v113, v113, v117
    v_add_f32_dpp v112, v112, v112 row_shr:1 row_mask:0xf bank_mask:0xf bound_ctrl:0
    s_nop 1
    v_add_f32_dpp v112, v112, v112 row_shr:2 row_mask:0xf bank_mask:0xf bound_ctrl:0
    s_nop 1
    v_add_f32_dpp v112, v112, v112 row_shr:4 row_mask:0xf bank_mask:0xf bound_ctrl:0
    s_nop 1
    v_add_f32_dpp v112, v112, v112 row_shr:8 row_mask:0xf bank_mask:0xf bound_ctrl:0
    s_nop 1
    v_add_f32_dpp v112, v112, v112 row_bcast:15 row_mask:0xa bank_mask:0xf
    s_nop 1
    v_add_f32_dpp v112, v112, v112 row_bcast:31 row_mask:0xc bank_mask:0xf
    buffer_load_dwordx4 v9, s[56:59], s11 offen offset:1024 lds
    v_add_f32_dpp v113, v113, v113 row_shr:1 row_mask:0xf bank_mask:0xf bound_ctrl:0
    s_nop 1
    v_add_f32_dpp v113, v113, v113 row_shr:2 row_mask:0xf bank_mask:0xf bound_ctrl:0
    s_nop 1
    v_add_f32_dpp v113, v113, v113 row_shr:4 row_mask:0xf bank_mask:0xf bound_ctrl:0
    s_nop 1
    v_add_f32_dpp v113, v113, v113 row_shr:8 row_mask:0xf bank_mask:0xf bound_ctrl:0
    s_nop 1
    v_add_f32_dpp v113, v113, v113 row_bcast:15 row_mask:0xa bank_mask:0xf
    s_nop 1
    v_add_f32_dpp v113, v113, v113 row_bcast:31 row_mask:0xc bank_mask:0xf
    v_readlane_b32 s8, v112, 63
    v_readlane_b32 s9, v113, 63
    s_nop 0
    v_mov_b32 v116, s8
    v_mov_b32 v117, s9
    buffer_load_dwordx4 v10, s[56:59], s11 offen offset:2048 lds
    v_cmp_eq_u32 vcc, 1, v1
    s_nop 1
    v_cndmask_b32 v116, v116, v117, vcc
    v_cvt_pk_bf16_f32 v116, v116, v116
    v_lshlrev_b32 v116, 16, v116
    v_mul_f32 v116, 0xbfb8aa3b, v116
    v_exp_f32 v116, v116
    s_nop 0
    v_add_f32 v116, 1.0, v116
    v_rcp_f32 v116, v116
    s_nop 0
    v_cvt_pk_bf16_f32 v117, v116, v116
    v_lshlrev_b32 v116, 16, v117
    buffer_load_dwordx4 v11, s[56:59], s11 offen offset:3072 lds
    v_sub_f32 v118, 1.0, v116
    v_cvt_pk_bf16_f32 v116, v116, v118
    s_lshl_b32 s14, s14, 2
    v_lshl_add_u32 v117, v1, 2, s14
    s_mov_b64 exec, 3
    buffer_store_dword v116, v117, s[76:79], 0 offen sc1
    s_mov_b64 exec, -1
    s_add_u32 m0, s10, 0x4000
    s_nop 0
    buffer_load_dwordx4 v12, s[60:63], s11 offen offset:0 lds
    buffer_load_dwordx4 v13, s[60:63], s11 offen offset:1024 lds
    buffer_load_dwordx4 v14, s[60:63], s11 offen offset:2048 lds
    buffer_load_dwordx4 v15, s[60:63], s11 offen offset:3072 lds
    s_waitcnt vmcnt(9)
    s_barrier
    s_add_u32 s11, s90, 7
    s_and_b32 s11, s11, 15
    s_lshl_b32 s11, s11, 7
    s_add_u32 m0, s10, 0x8000
    s_nop 0
    buffer_load_dwordx4 v8, s[56:59], s11 offen offset:0 lds
    ds_read_b32 v32, v21 offset:17024
    ds_read_b32 v33, v21 offset:17152
    ds_read_b32 v34, v21 offset:17280
    ds_read_b32 v35, v21 offset:17408
    ds_read_b32 v36, v21 offset:17536
    ds_read_b32 v37, v21 offset:17664
    ds_read_b32 v38, v21 offset:17792
    ds_read_b32 v39, v21 offset:17920
    ds_read_b32 v40, v21 offset:18048
    buffer_load_dwordx4 v9, s[56:59], s11 offen offset:1024 lds
    ds_read_b32 v41, v21 offset:18176
    s_waitcnt lgkmcnt(0)
    ds_read_b32 v42, v21 offset:18304
    ds_read_b32 v43, v21 offset:18432
    ds_read_b32 v44, v21 offset:18560
    ds_read_b32 v45, v21 offset:18688
    ds_read_b32 v46, v21 offset:18816
    ds_read_b32 v47, v21 offset:18944
    ds_read_b32 v48, v21 offset:19072
    ds_read_b32 v49, v21 offset:19200
    buffer_load_dwordx4 v10, s[56:59], s11 offen offset:2048 lds
    ds_read_b32 v50, v21 offset:19328
    s_waitcnt lgkmcnt(0)
    v_lshlrev_b32 v96, 16, v32
    v_and_b32 v97, s12, v32
    v_lshlrev_b32 v98, 16, v33
    v_and_b32 v99, s12, v33
    v_lshlrev_b32 v100, 16, v34
    v_and_b32 v101, s12, v34
    v_lshlrev_b32 v102, 16, v35
    v_and_b32 v103, s12, v35
    buffer_load_dwordx4 v11, s[56:59], s11 offen offset:3072 lds
    v_lshlrev_b32 v104, 16, v36
    v_and_b32 v105, s12, v36
    v_lshlrev_b32 v106, 16, v37
    v_and_b32 v107, s12, v37
    v_lshlrev_b32 v108, 16, v38
    v_and_b32 v109, s12, v38
    v_lshlrev_b32 v110, 16, v39
    v_and_b32 v111, s12, v39
    v_lshlrev_b32 v112, 16, v40
    v_and_b32 v113, s12, v40
    s_add_u32 m0, s10, 0xc000
    s_nop 0
    buffer_load_dwordx4 v12, s[60:63], s11 offen offset:0 lds
    v_lshlrev_b32 v114, 16, v41
    v_and_b32 v115, s12, v41
    v_lshlrev_b32 v116, 16, v42
    v_and_b32 v117, s12, v42
    v_lshlrev_b32 v118, 16, v43
    v_and_b32 v119, s12, v43
    v_lshlrev_b32 v120, 16, v44
    v_and_b32 v121, s12, v44
    v_lshlrev_b32 v122, 16, v45
    v_and_b32 v123, s12, v45
    buffer_load_dwordx4 v13, s[60:63], s11 offen offset:1024 lds
    v_lshlrev_b32 v124, 16, v46
    v_and_b32 v125, s12, v46
    v_lshlrev_b32 v126, 16, v47
    v_and_b32 v127, s12, v47
    v_lshlrev_b32 v128, 16, v48
    v_and_b32 v129, s12, v48
    v_lshlrev_b32 v130, 16, v49
    v_and_b32 v131, s12, v49
    v_lshlrev_b32 v132, 16, v50
    v_and_b32 v133, s12, v50
    buffer_load_dwordx4 v14, s[60:63], s11 offen offset:2048 lds
    v_lshlrev_b32 v136, 16, v68
    v_lshlrev_b32 v137, 16, v70
    v_and_b32 v138, s12, v68
    v_and_b32 v139, s12, v70
    v_lshlrev_b32 v140, 16, v69
    v_lshlrev_b32 v141, 16, v71
    v_and_b32 v142, s12, v69
    v_and_b32 v143, s12, v71
    ds_read_b32 v208, v21 offset:0
    buffer_load_dwordx4 v15, s[60:63], s11 offen offset:3072 lds
    ds_read_b32 v209, v21 offset:128
    ds_read_b32 v210, v21 offset:256
    ds_read_b32 v211, v21 offset:384
    ds_read_b32 v212, v21 offset:512
    ds_read_b32 v213, v21 offset:640
    ds_read_b32 v214, v21 offset:768
    ds_read_b32 v215, v21 offset:896
    s_waitcnt lgkmcnt(0)
    ds_read_b32 v216, v21 offset:1024
    ds_read_b32 v217, v21 offset:1152
    s_waitcnt vmcnt(8)
    s_barrier
    s_add_u32 s11, s90, 8
    s_and_b32 s11, s11, 15
    s_lshl_b32 s11, s11, 7
    s_add_u32 m0, s10, 0x10000
    s_nop 0
    buffer_load_dwordx4 v8, s[56:59], s11 offen offset:0 lds
    ds_read_b32 v218, v21 offset:1280
    ds_read_b32 v219, v21 offset:1408
    ds_read_b32 v220, v21 offset:1536
    ds_read_b32 v221, v21 offset:1664
    ds_read_b32 v222, v21 offset:1792
    ds_read_b32 v223, v21 offset:1920
    s_waitcnt lgkmcnt(0)
    v_lshlrev_b32 v176, 16, v208
    v_and_b32 v177, s12, v208
    v_mul_f32 v144, v96, v142
    buffer_load_dwordx4 v9, s[56:59], s11 offen offset:1024 lds
    v_mul_f32 v145, v97, v143
    v_fmac_f32 v144, v98, v140
    v_fmac_f32 v145, v99, v141
    v_fmac_f32 v144, v100, v138
    v_fmac_f32 v145, v101, v139
    v_fmac_f32 v144, v102, v136
    v_fmac_f32 v145, v103, v137
    v_mul_f32 v144, v144, v176
    v_mul_f32 v145, v145, v177
    v_lshlrev_b32 v178, 16, v209
    buffer_load_dwordx4 v10, s[56:59], s11 offen offset:2048 lds
    v_and_b32 v179, s12, v209
    v_mul_f32 v146, v98, v142
    v_mul_f32 v147, v99, v143
    v_fmac_f32 v146, v100, v140
    v_fmac_f32 v147, v101, v141
    v_fmac_f32 v146, v102, v138
    v_fmac_f32 v147, v103, v139
    v_fmac_f32 v146, v104, v136
    v_fmac_f32 v147, v105, v137
    v_mul_f32 v146, v146, v178
    buffer_load_dwordx4 v11, s[56:59], s11 offen offset:3072 lds
    v_mul_f32 v147, v147, v179
    v_lshlrev_b32 v176, 16, v210
    v_and_b32 v177, s12, v210
    v_mul_f32 v148, v100, v142
    v_mul_f32 v149, v101, v143
    v_fmac_f32 v148, v102, v140
    v_fmac_f32 v149, v103, v141
    v_fmac_f32 v148, v104, v138
    v_fmac_f32 v149, v105, v139
    v_fmac_f32 v148, v106, v136
    s_add_u32 m0, s10, 0x14000
    s_nop 0
    buffer_load_dwordx4 v12, s[60:63], s11 offen offset:0 lds
    v_fmac_f32 v149, v107, v137
    v_mul_f32 v148, v148, v176
    v_mul_f32 v149, v149, v177
    v_lshlrev_b32 v178, 16, v211
    v_and_b32 v179, s12, v211
    v_mul_f32 v150, v102, v142
    v_mul_f32 v151, v103, v143
    v_fmac_f32 v150, v104, v140
    v_fmac_f32 v151, v105, v141
    v_fmac_f32 v150, v106, v138
    buffer_load_dwordx4 v13, s[60:63], s11 offen offset:1024 lds
    v_fmac_f32 v151, v107, v139
    v_fmac_f32 v150, v108, v136
    v_fmac_f32 v151, v109, v137
    v_mul_f32 v150, v150, v178
    v_mul_f32 v151, v151, v179
    v_lshlrev_b32 v176, 16, v212
    v_and_b32 v177, s12, v212
    v_mul_f32 v152, v104, v142
    v_mul_f32 v153, v105, v143
    v_fmac_f32 v152, v106, v140
    buffer_load_dwordx4 v14, s[60:63], s11 offen offset:2048 lds
    v_fmac_f32 v153, v107, v141
    v_fmac_f32 v152, v108, v138
    v_fmac_f32 v153, v109, v139
    v_fmac_f32 v152, v110, v136
    v_fmac_f32 v153, v111, v137
    v_mul_f32 v152, v152, v176
    v_mul_f32 v153, v153, v177
    v_lshlrev_b32 v178, 16, v213
    v_and_b32 v179, s12, v213
    v_mul_f32 v154, v106, v142
    buffer_load_dwordx4 v15, s[60:63], s11 offen offset:3072 lds
    v_mul_f32 v155, v107, v143
    v_fmac_f32 v154, v108, v140
    v_fmac_f32 v155, v109, v141
    v_fmac_f32 v154, v110, v138
    v_fmac_f32 v155, v111, v139
    v_fmac_f32 v154, v112, v136
    v_fmac_f32 v155, v113, v137
    v_mul_f32 v154, v154, v178
    v_mul_f32 v155, v155, v179
    v_lshlrev_b32 v176, 16, v214
    s_waitcnt vmcnt(8)
    s_barrier
    s_add_u32 s11, s90, 9
    s_and_b32 s11, s11, 15
    s_lshl_b32 s11, s11, 7
    s_add_u32 m0, s10, 0x0
    s_nop 0
    buffer_load_dwordx4 v8, s[56:59], s11 offen offset:0 lds
    v_and_b32 v177, s12, v214
    v_mul_f32 v156, v108, v142
    v_mul_f32 v157, v109, v143
    v_fmac_f32 v156, v110, v140
    v_fmac_f32 v157, v111, v141
    v_fmac_f32 v156, v112, v138
    v_fmac_f32 v157, v113, v139
    v_fmac_f32 v156, v114, v136
    v_fmac_f32 v157, v115, v137
    v_mul_f32 v156, v156, v176
    buffer_load_dwordx4 v9, s[56:59], s11 offen offset:1024 lds
    v_mul_f32 v157, v157, v177
    v_lshlrev_b32 v178, 16, v215
    v_and_b32 v179, s12, v215
    v_mul_f32 v158, v110, v142
    v_mul_f32 v159, v111, v143
    v_fmac_f32 v158, v112, v140
    v_fmac_f32 v159, v113, v141
    v_fmac_f32 v158, v114, v138
    v_fmac_f32 v159, v115, v139
    v_fmac_f32 v158, v116, v136
    buffer_load_dwordx4 v10, s[56:59], s11 offen offset:2048 lds
    v_fmac_f32 v159, v117, v137
    v_mul_f32 v158, v158, v178
    v_mul_f32 v159, v159, v179
    v_lshlrev_b32 v176, 16, v216
    v_and_b32 v177, s12, v216
    v_mul_f32 v160, v112, v142
    v_mul_f32 v161, v113, v143
    v_fmac_f32 v160, v114, v140
    v_fmac_f32 v161, v115, v141
    v_fmac_f32 v160, v116, v138
    buffer_load_dwordx4 v11, s[56:59], s11 offen offset:3072 lds
    v_fmac_f32 v161, v117, v139
    v_fmac_f32 v160, v118, v136
    v_fmac_f32 v161, v119, v137
    v_mul_f32 v160, v160, v176
    v_mul_f32 v161, v161, v177
    v_lshlrev_b32 v178, 16, v217
    v_and_b32 v179, s12, v217
    v_mul_f32 v162, v114, v142
    v_mul_f32 v163, v115, v143
    v_fmac_f32 v162, v116, v140
    s_add_u32 m0, s10, 0x4000
    s_nop 0
    buffer_load_dwordx4 v12, s[60:63], s11 offen offset:0 lds
    v_fmac_f32 v163, v117, v141
    v_fmac_f32 v162, v118, v138
    v_fmac_f32 v163, v119, v139
    v_fmac_f32 v162, v120, v136
    v_fmac_f32 v163, v121, v137
    v_mul_f32 v162, v162, v178
    v_mul_f32 v163, v163, v179
    v_lshlrev_b32 v176, 16, v218
    v_and_b32 v177, s12, v218
    v_mul_f32 v164, v116, v142
    buffer_load_dwordx4 v13, s[60:63], s11 offen offset:1024 lds
    v_mul_f32 v165, v117, v143
    v_fmac_f32 v164, v118, v140
    v_fmac_f32 v165, v119, v141
    v_fmac_f32 v164, v120, v138
    v_fmac_f32 v165, v121, v139
    v_fmac_f32 v164, v122, v136
    v_fmac_f32 v165, v123, v137
    v_mul_f32 v164, v164, v176
    v_mul_f32 v165, v165, v177
    v_lshlrev_b32 v178, 16, v219
    buffer_load_dwordx4 v14, s[60:63], s11 offen offset:2048 lds
    v_and_b32 v179, s12, v219
    v_mul_f32 v166, v118, v142
    v_mul_f32 v167, v119, v143
    v_fmac_f32 v166, v120, v140
    v_fmac_f32 v167, v121, v141
    v_fmac_f32 v166, v122, v138
    v_fmac_f32 v167, v123, v139
    v_fmac_f32 v166, v124, v136
    v_fmac_f32 v167, v125, v137
    v_mul_f32 v166, v166, v178
    buffer_load_dwordx4 v15, s[60:63], s11 offen offset:3072 lds
    v_mul_f32 v167, v167, v179
    v_lshlrev_b32 v176, 16, v220
    v_and_b32 v177, s12, v220
    v_mul_f32 v168, v120, v142
    v_mul_f32 v169, v121, v143
    v_fmac_f32 v168, v122, v140
    v_fmac_f32 v169, v123, v141
    v_fmac_f32 v168, v124, v138
    v_fmac_f32 v169, v125, v139
    v_fmac_f32 v168, v126, v136
    s_cmp_ge_u32 s3, 2
    s_cselect_b32 s96, s28, s26
    s_cselect_b32 s97, s29, s27
    s_lshl_b32 s98, s2, 13
    s_and_b32 s99, s3, 1
    s_lshl_b32 s99, s99, 12
    s_add_u32 s98, s98, s99
    v_and_b32 v240, 31, v1
    v_lshl_add_u32 v240, v240, 7, s98
    global_load_dword v241, v240, s[96:97]
    v_lshlrev_b32 v246, 2, v1
    global_load_dword v247, v246, s[50:51] sc1
    s_waitcnt vmcnt(10)
    s_barrier
    s_add_u32 s11, s90, 10
    s_and_b32 s11, s11, 15
    s_lshl_b32 s11, s11, 7
    s_add_u32 m0, s10, 0x8000
    s_nop 0
    buffer_load_dwordx4 v8, s[56:59], s11 offen offset:0 lds
    v_fmac_f32 v169, v127, v137
    v_mul_f32 v168, v168, v176
    v_mul_f32 v169, v169, v177
    v_lshlrev_b32 v178, 16, v221
    v_and_b32 v179, s12, v221
    v_mul_f32 v170, v122, v142
    v_mul_f32 v171, v123, v143
    v_fmac_f32 v170, v124, v140
    v_fmac_f32 v171, v125, v141
    v_fmac_f32 v170, v126, v138
    buffer_load_dwordx4 v9, s[56:59], s11 offen offset:1024 lds
    v_fmac_f32 v171, v127, v139
    v_fmac_f32 v170, v128, v136
    v_fmac_f32 v171, v129, v137
    v_mul_f32 v170, v170, v178
    v_mul_f32 v171, v171, v179
    v_lshlrev_b32 v176, 16, v222
    v_and_b32 v177, s12, v222
    v_mul_f32 v172, v124, v142
    v_mul_f32 v173, v125, v143
    v_fmac_f32 v172, v126, v140
    buffer_load_dwordx4 v10, s[56:59], s11 offen offset:2048 lds
    v_fmac_f32 v173, v127, v141
    v_fmac_f32 v172, v128, v138
    v_fmac_f32 v173, v129, v139
    v_fmac_f32 v172, v130, v136
    v_fmac_f32 v173, v131, v137
    v_mul_f32 v172, v172, v176
    v_mul_f32 v173, v173, v177
    v_lshlrev_b32 v178, 16, v223
    v_and_b32 v179, s12, v223
    v_mul_f32 v174, v126, v142
    buffer_load_dwordx4 v11, s[56:59], s11 offen offset:3072 lds
    v_mul_f32 v175, v127, v143
    v_fmac_f32 v174, v128, v140
    v_fmac_f32 v175, v129, v141
    v_fmac_f32 v174, v130, v138
    v_fmac_f32 v175, v131, v139
    v_fmac_f32 v174, v132, v136
    v_fmac_f32 v175, v133, v137
    v_mul_f32 v174, v174, v178
    v_mul_f32 v175, v175, v179
    v_cvt_pk_bf16_f32 v192, v174, v172
    s_add_u32 m0, s10, 0xc000
    s_nop 0
    buffer_load_dwordx4 v12, s[60:63], s11 offen offset:0 lds
    v_cvt_pk_bf16_f32 v193, v170, v168
    v_cvt_pk_bf16_f32 v194, v166, v164
    v_cvt_pk_bf16_f32 v195, v162, v160
    ds_write_b128 v23, v[192:195] offset:0
    v_cvt_pk_bf16_f32 v196, v158, v156
    v_cvt_pk_bf16_f32 v197, v154, v152
    v_cvt_pk_bf16_f32 v198, v150, v148
    v_cvt_pk_bf16_f32 v199, v146, v144
    ds_write_b128 v23, v[196:199] offset:16
    v_cvt_pk_bf16_f32 v200, v175, v173
    buffer_load_dwordx4 v13, s[60:63], s11 offen offset:1024 lds
    v_cvt_pk_bf16_f32 v201, v171, v169
    v_cvt_pk_bf16_f32 v202, v167, v165
    v_cvt_pk_bf16_f32 v203, v163, v161
    ds_write_b128 v23, v[200:203] offset:272
    v_cvt_pk_bf16_f32 v204, v159, v157
    v_cvt_pk_bf16_f32 v205, v155, v153
    v_cvt_pk_bf16_f32 v206, v151, v149
    v_cvt_pk_bf16_f32 v207, v147, v145
    ds_write_b128 v23, v[204:207] offset:288
    s_waitcnt lgkmcnt(0)
    buffer_load_dwordx4 v14, s[60:63], s11 offen offset:2048 lds
    buffer_load_dwordx4 v15, s[60:63], s11 offen offset:3072 lds
    s_waitcnt vmcnt(10)
    s_barrier
    s_add_u32 s11, s90, 11
    s_and_b32 s11, s11, 15
    s_lshl_b32 s11, s11, 7
    s_add_u32 m0, s10, 0x10000
    s_nop 0
    buffer_load_dwordx4 v8, s[56:59], s11 offen offset:0 lds
    ds_read_b128 v[192:195], v24 offset:0
    ds_read_b128 v[196:199], v24 offset:1088
    ds_read_b128 v[200:203], v24 offset:2176
    ds_read_b128 v[204:207], v24 offset:3264
    s_waitcnt vmcnt(9)
    s_getreg_b32 s98, hwreg(HW_REG_XCC_ID, 0, 4)
    s_lshl_b32 s98, 0x100, s98
    s_or_b32 s98, s98, 15
    v_and_b32 v246, 7, v1
    v_cmp_eq_u32 s[96:97], s54, v246
    v_cmp_ne_u32 vcc, s98, v247
    s_nop 1
    s_and_b64 vcc, vcc, s[96:97]
    s_cbranch_scc0 h_kvl
    s_waitcnt lgkmcnt(3)
    buffer_store_dwordx4 v[192:195], v27, s[72:75], s80 offen sc1
    s_waitcnt lgkmcnt(2)
    buffer_store_dwordx4 v[196:199], v27, s[72:75], s84 offen sc1
    s_waitcnt lgkmcnt(1)
    buffer_store_dwordx4 v[200:203], v3, s[72:75], s80 offen sc1
    s_waitcnt lgkmcnt(0)
    buffer_store_dwordx4 v[204:207], v3, s[72:75], s84 offen sc1
    s_branch h_kve
h_kvl:
    s_waitcnt lgkmcnt(3)
    buffer_store_dwordx4 v[192:195], v27, s[72:75], s80 offen
    s_waitcnt lgkmcnt(2)
    buffer_store_dwordx4 v[196:199], v27, s[72:75], s84 offen
    s_waitcnt lgkmcnt(1)
    buffer_store_dwordx4 v[200:203], v3, s[72:75], s80 offen
    s_waitcnt lgkmcnt(0)
    buffer_store_dwordx4 v[204:207], v3, s[72:75], s84 offen
h_kve:
    s_lshl_b32 s12, s88, 12
    s_add_u32 s64, s42, s12
    s_addc_u32 s65, s43, 0
    s_mov_b32 s66, 0x1000
    s_mov_b32 s67, 0x20000
    buffer_load_dwordx4 v9, s[56:59], s11 offen offset:1024 lds
    s_add_u32 s68, s52, s12
    s_addc_u32 s69, s53, 0
    s_add_u32 s68, s68, 0x800000
    s_addc_u32 s69, s69, 0
    s_mov_b32 s70, 0x1000
    s_mov_b32 s71, 0x20000
    s_mov_b32 s80, s100
    s_mov_b32 s81, s101
    v_and_b32 v37, 15, v1
    s_lshr_b32 s8, s88, 6
    buffer_load_dwordx4 v10, s[56:59], s11 offen offset:2048 lds
    s_and_b32 s8, s8, 1
    s_lshl_b32 s8, s8, 3
    s_add_u32 s8, s8, s54
    v_lshl_add_u32 v32, v37, 4, s8
    s_lshr_b32 s8, s4, 2
    s_lshl_b32 s8, s8, 1
    s_and_b32 s9, s4, 3
    s_lshl_b32 s9, s9, 3
    s_add_u32 s8, s8, s9
    v_lshrrev_b32 v38, 3, v37
    buffer_load_dwordx4 v11, s[56:59], s11 offen offset:3072 lds
    v_and_b32 v39, 7, v37
    v_lshl_add_u32 v38, v39, 5, v38
    v_add_u32 v38, s8, v38
    v_and_b32 v39, 16, v1
    v_cmp_ne_u32 vcc, 0, v39
    s_nop 1
    v_cndmask_b32 v32, v32, v38, vcc
    v_lshlrev_b32 v32, 7, v32
    v_add_u32 v32, 0x20000, v32
    v_lshlrev_b32 v33, 2, v1
    s_mov_b32 s76, s50
    s_add_u32 m0, s10, 0x14000
    s_nop 0
    buffer_load_dwordx4 v12, s[60:63], s11 offen offset:0 lds
    s_mov_b32 s77, s51
    s_mov_b32 s78, 0x100
    s_mov_b32 s79, 0x20000
    s_mul_i32 s13, s3, 8320
    s_add_u32 s13, s13, 98304
    s_mul_i32 s82, s3, 4608
    s_add_u32 s82, s82, 131584
    v_add_u32 v36, 2, v25
    v_and_b32 v38, 7, v1
    v_lshlrev_b32 v38, 2, v38
    buffer_load_dwordx4 v13, s[60:63], s11 offen offset:1024 lds
    v_bfe_u32 v39, v1, 3, 1
    v_mul_u32_u24 v39, 4160, v39
    v_add3_u32 v38, v38, v39, s13
    s_lshl_b32 s80, s80, 16
    v_mov_b32 v56, s80
    v_cmp_eq_u32 vcc, 15, v37
    s_nop 1
    v_cndmask_b32 v56, 0, v56, vcc
    ds_write_b32 v38, v56
    s_and_b32 s14, s88, 1
    s_lshl_b32 s14, s14, 4
    buffer_load_dwordx4 v14, s[60:63], s11 offen offset:2048 lds
    s_lshr_b32 s81, s81, s14
    s_lshl_b32 s81, s81, 16
    v_mov_b32 v60, 0x24a00
    v_mov_b32 v61, 1
    buffer_load_dwordx4 v15, s[60:63], s11 offen offset:3072 lds
    s_waitcnt vmcnt(12)
    s_barrier
    s_add_u32 s11, s90, 12
    s_and_b32 s11, s11, 15
    s_lshl_b32 s11, s11, 7
    s_add_u32 m0, s10, 0x0
    s_nop 0
    buffer_load_dwordx4 v8, s[56:59], s11 offen offset:0 lds
    buffer_load_dwordx4 v9, s[56:59], s11 offen offset:1024 lds
    buffer_load_dwordx4 v10, s[56:59], s11 offen offset:2048 lds
    buffer_load_dwordx4 v11, s[56:59], s11 offen offset:3072 lds
    s_add_u32 m0, s10, 0x4000
    s_nop 0
    buffer_load_dwordx4 v12, s[60:63], s11 offen offset:0 lds
    buffer_load_dwordx4 v13, s[60:63], s11 offen offset:1024 lds
    buffer_load_dwordx4 v14, s[60:63], s11 offen offset:2048 lds
    buffer_load_dwordx4 v15, s[60:63], s11 offen offset:3072 lds
    s_waitcnt vmcnt(8)
    s_barrier
    s_cmp_lg_u32 s3, 0
    s_cbranch_scc1 h_kflag
    v_mov_b32 v6, 1
    buffer_store_dword v6, v30, s[92:95], 0 offen sc1
h_kflag:
    s_add_u32 s11, s90, 13
    s_and_b32 s11, s11, 15
    s_lshl_b32 s11, s11, 7
    s_add_u32 m0, s10, 0x8000
    s_nop 0
    buffer_load_dwordx4 v8, s[56:59], s11 offen offset:0 lds
    buffer_load_dwordx4 v9, s[56:59], s11 offen offset:1024 lds
    buffer_load_dwordx4 v10, s[56:59], s11 offen offset:2048 lds
    buffer_load_dwordx4 v11, s[56:59], s11 offen offset:3072 lds
    s_add_u32 m0, s10, 0xc000
    s_nop 0
    buffer_load_dwordx4 v12, s[60:63], s11 offen offset:0 lds
    buffer_load_dwordx4 v13, s[60:63], s11 offen offset:1024 lds
    buffer_load_dwordx4 v14, s[60:63], s11 offen offset:2048 lds
    buffer_load_dwordx4 v15, s[60:63], s11 offen offset:3072 lds
    s_waitcnt vmcnt(8)
    s_barrier
    s_add_u32 s11, s90, 14
    s_and_b32 s11, s11, 15
    s_lshl_b32 s11, s11, 7
    s_add_u32 m0, s10, 0x10000
    s_nop 0
    buffer_load_dwordx4 v8, s[56:59], s11 offen offset:0 lds
    buffer_load_dwordx4 v9, s[56:59], s11 offen offset:1024 lds
    buffer_load_dwordx4 v10, s[56:59], s11 offen offset:2048 lds
    buffer_load_dwordx4 v11, s[56:59], s11 offen offset:3072 lds
    s_add_u32 m0, s10, 0x14000
    s_nop 0
    buffer_load_dwordx4 v12, s[60:63], s11 offen offset:0 lds
    buffer_load_dwordx4 v13, s[60:63], s11 offen offset:1024 lds
    buffer_load_dwordx4 v14, s[60:63], s11 offen offset:2048 lds
    buffer_load_dwordx4 v15, s[60:63], s11 offen offset:3072 lds
    s_add_u32 m0, s13, 32
    s_nop 0
    buffer_load_dwordx4 v25, s[64:67], 0 offen offset:0 lds
    buffer_load_dwordx4 v25, s[64:67], 0 offen offset:1024 lds
    buffer_load_dwordx4 v25, s[64:67], 0 offen offset:2048 lds
    buffer_load_dwordx4 v25, s[64:67], 0 offen offset:3072 lds
    s_add_u32 m0, s13, 4192
    s_nop 0
    buffer_load_dwordx4 v36, s[64:67], 0 offen offset:0 lds
    buffer_load_dwordx4 v36, s[64:67], 0 offen offset:1024 lds
    buffer_load_dwordx4 v36, s[64:67], 0 offen offset:2048 lds
    buffer_load_dwordx4 v36, s[64:67], 0 offen offset:3072 lds
    s_waitcnt vmcnt(16)
    s_barrier
    s_add_u32 s11, s90, 15
    s_and_b32 s11, s11, 15
    s_lshl_b32 s11, s11, 7
    s_add_u32 m0, s10, 0x0
    s_nop 0
    buffer_load_dwordx4 v8, s[56:59], s11 offen offset:0 lds
    buffer_load_dwordx4 v9, s[56:59], s11 offen offset:1024 lds
    buffer_load_dwordx4 v10, s[56:59], s11 offen offset:2048 lds
    buffer_load_dwordx4 v11, s[56:59], s11 offen offset:3072 lds
    s_add_u32 m0, s10, 0x4000
    s_nop 0
    buffer_load_dwordx4 v12, s[60:63], s11 offen offset:0 lds
    buffer_load_dwordx4 v13, s[60:63], s11 offen offset:1024 lds
    buffer_load_dwordx4 v14, s[60:63], s11 offen offset:2048 lds
    buffer_load_dwordx4 v15, s[60:63], s11 offen offset:3072 lds
    buffer_load_dword v34, v33, s[76:79], 0 offen sc1
    buffer_load_dword v35, v32, s[92:95], 0 offen sc1
    s_waitcnt vmcnt(18)
    s_barrier
    s_mov_b32 s56, s26
    s_mov_b32 s57, s27
    s_mov_b32 s58, 0x200000
    s_mov_b32 s59, 0x20000
    s_mov_b32 s60, s28
    s_mov_b32 s61, s29
    s_mov_b32 s62, 0x200000
    s_mov_b32 s63, 0x20000
    s_lshl_b32 s10, s3, 11
    s_add_u32 s10, s10, 0x8000
    s_lshr_b32 s90, s5, 3
    s_xor_b32 s91, s90, 1
    s_lshl_b32 s91, s91, 20
    s_lshl_b32 s11, s90, 10
    s_add_u32 s91, s91, s11
    s_mul_i32 s90, s90, 0x100400
    v_mov_b32 v56, 0
    v_mov_b32 v57, 0
    v_lshlrev_b32 v38, 3, v1
    v_add_u32 v38, s82, v38
    ds_write_b64 v38, v[56:57] offset:4096
    s_waitcnt vmcnt(0)
    s_mov_b32 s83, 0
    v_and_b32 v34, 15, v34
    v_cmp_ne_u32 vcc, 15, v34
    v_cmp_ne_u32 s[84:85], 1, v35
    s_nop 1
    s_or_b64 vcc, vcc, s[84:85]
    s_cbranch_scc1 h_nou
    s_mov_b32 s83, 1
    buffer_load_dwordx4 v[40:43], v25, s[68:71], 0 offen offset:0 sc1
    buffer_load_dwordx4 v[44:47], v25, s[68:71], 0 offen offset:1024 sc1
    buffer_load_dwordx4 v[48:51], v25, s[68:71], 0 offen offset:2048 sc1
    buffer_load_dwordx4 v[52:55], v25, s[68:71], 0 offen offset:3072 sc1
h_nou:
    s_barrier
    v_lshrrev_b32 v5, 4, v1
    v_and_b32 v37, 15, v1
    v_lshl_add_u32 v38, v5, 3, v37
    v_lshlrev_b32 v38, 1, v38
    v_and_b32 v39, 1, v1
    v_mul_u32_u24 v39, 4158, v39
    v_sub_u32 v38, v38, v39
    s_add_u32 s14, s13, 4160
    v_add_u32 v16, s14, v38
    v_add_u32 v17, 1024, v16
    v_add_u32 v18, 2048, v16
    v_add_u32 v19, 3072, v16
    v_lshlrev_b32 v38, 5, v37
    v_lshlrev_b32 v39, 4, v5
    v_sub_u32 v20, v39, v38
    s_add_u32 s14, s82, 480
    v_add_u32 v20, s14, v20
    v_lshl_add_u32 v39, v5, 3, v38
    s_add_u32 s14, s82, 504
    v_sub_u32 v21, s14, v39
    v_and_b32 v39, 1, v5
    v_lshl_add_u32 v22, v39, 9, v38
    v_lshrrev_b32 v39, 1, v5
    v_lshl_add_u32 v22, v39, 4, v22
    v_add_u32 v23, s82, v25
    s_cmp_lg_u32 s83, 1
    s_cbranch_scc1 h_nouw
    s_waitcnt vmcnt(0)
    ds_write_b128 v23, v[40:43] offset:0
    ds_write_b128 v23, v[44:47] offset:1024
    ds_write_b128 v23, v[48:51] offset:2048
    ds_write_b128 v23, v[52:55] offset:3072
h_nouw:
    s_barrier
    s_mov_b32 s11, s15
    s_lshl_b32 s11, s11, 7
    s_add_u32 s99, s11, s91
    s_add_u32 m0, s10, 0x0
    s_nop 0
    buffer_load_dwordx4 v28, s[56:59], s99 offen offset:0 lds
    buffer_load_dwordx4 v29, s[56:59], s99 offen offset:1024 lds
    s_add_u32 s11, s11, s90
    s_add_u32 m0, s10, 0x2000
    s_nop 0
    buffer_load_dwordx4 v28, s[56:59], s11 offen offset:0 lds
    buffer_load_dwordx4 v29, s[56:59], s11 offen offset:1024 lds
    s_mov_b32 s11, s15
    s_lshl_b32 s11, s11, 7
    s_add_u32 s99, s11, s91
    s_add_u32 m0, s10, 0x4000
    s_nop 0
    buffer_load_dwordx4 v28, s[60:63], s99 offen offset:0 lds
    buffer_load_dwordx4 v29, s[60:63], s99 offen offset:1024 lds
    s_add_u32 s11, s11, s90
    s_add_u32 m0, s10, 0x6000
    s_nop 0
    buffer_load_dwordx4 v28, s[60:63], s11 offen offset:0 lds
    buffer_load_dwordx4 v29, s[60:63], s11 offen offset:1024 lds
    s_cmp_lg_u32 s83, 0
    s_cbranch_scc1 h_haveu
    s_mov_b32 s89, 65536
h_init_chk:
    v_and_b32 v34, 15, v34
    v_cmp_ne_u32 vcc, 15, v34
    s_nop 1
    s_cmp_eq_u64 vcc, 0
    s_cbranch_scc1 h_init_ok
    s_sub_u32 s89, s89, 1
    s_cbranch_scc1 h_init_ok
    s_sleep 4
    buffer_load_dword v34, v33, s[76:79], 0 offen sc1
    s_waitcnt vmcnt(0)
    s_branch h_init_chk
h_init_ok:
    s_mov_b32 s89, 65536
h_kf_chk:
    v_cmp_ne_u32 vcc, 1, v35
    s_nop 1
    s_cmp_eq_u64 vcc, 0
    s_cbranch_scc1 h_kf_ok
    s_sub_u32 s89, s89, 1
    s_cbranch_scc1 h_kf_ok
    s_sleep 4
    buffer_load_dword v35, v32, s[92:95], 0 offen sc1
    s_waitcnt vmcnt(0)
    s_branch h_kf_chk
h_kf_ok:
    buffer_load_dwordx4 v[40:43], v25, s[68:71], 0 offen offset:0 sc1
    buffer_load_dwordx4 v[44:47], v25, s[68:71], 0 offen offset:1024 sc1
    buffer_load_dwordx4 v[48:51], v25, s[68:71], 0 offen offset:2048 sc1
    buffer_load_dwordx4 v[52:55], v25, s[68:71], 0 offen offset:3072 sc1
    s_waitcnt vmcnt(0)
    ds_write_b128 v23, v[40:43] offset:0
    ds_write_b128 v23, v[44:47] offset:1024
    ds_write_b128 v23, v[48:51] offset:2048
    ds_write_b128 v23, v[52:55] offset:3072
h_haveu:
    s_mov_b64 exec, 1
    ds_add_u32 v60, v61 offset:8
    s_mov_b64 exec, -1
    s_mov_b32 s84, s68
    s_mov_b32 s85, s69
    s_mov_b32 s86, s70
    s_mov_b32 s87, s71
    s_add_u32 s68, s52, 0x800000
    s_addc_u32 s69, s53, 0
    s_mov_b32 s70, 0x400000
    s_mov_b32 s71, 0x20000
    s_waitcnt lgkmcnt(0)
    ds_read_b64 v[40:41], v21 offset:3584
    ds_read_b64 v[42:43], v21 offset:3072
    ds_read_b64 v[44:45], v21 offset:2560
    ds_read_b64 v[46:47], v21 offset:2048
    ds_read_b64 v[48:49], v21 offset:1536
    ds_read_b64 v[50:51], v21 offset:1024
    ds_read_b64 v[52:53], v21 offset:512
    ds_read_b64 v[54:55], v21 offset:0
    ds_read2_b32 v[160:161], v16 offset0:0 offset1:1
    ds_read2_b32 v[162:163], v16 offset0:2 offset1:3
    ds_read_b128 v[96:99], v20 offset:3584
    ds_read_b128 v[100:103], v20 offset:3072
    ds_read_b128 v[104:107], v20 offset:2560
    ds_read_b128 v[108:111], v20 offset:2048
    ds_read_b128 v[112:115], v20 offset:1536
    ds_read_b128 v[116:119], v20 offset:1024
    ds_read_b128 v[120:123], v20 offset:512
    ds_read_b128 v[124:127], v20 offset:0
    ds_read2_b32 v[164:165], v16 offset0:128 offset1:129
    ds_read2_b32 v[166:167], v16 offset0:130 offset1:131
    ds_read2_b32 v[168:169], v17 offset0:0 offset1:1
    ds_read2_b32 v[170:171], v17 offset0:2 offset1:3
    ds_read2_b32 v[172:173], v17 offset0:128 offset1:129
    ds_read2_b32 v[174:175], v17 offset0:130 offset1:131
    ds_read2_b32 v[176:177], v18 offset0:0 offset1:1
    ds_read2_b32 v[178:179], v18 offset0:2 offset1:3
    ds_read2_b32 v[180:181], v18 offset0:128 offset1:129
    ds_read2_b32 v[182:183], v18 offset0:130 offset1:131
    ds_read2_b32 v[184:185], v19 offset0:0 offset1:1
    ds_read2_b32 v[186:187], v19 offset0:2 offset1:3
    ds_read2_b32 v[188:189], v19 offset0:128 offset1:129
    ds_read2_b32 v[190:191], v19 offset0:130 offset1:131
    s_waitcnt lgkmcnt(15)
    v_mfma_f32_16x16x32_bf16 v[64:67], v[160:163], v[96:99], 0
    s_mov_b32 s12, 0xffff0000
    v_mov_b32 v26, s81
    v_mfma_f32_16x16x32_bf16 v[68:71], v[160:163], v[100:103], 0
    ds_read2_b32 v[192:193], v16 offset0:16 offset1:17
    v_mfma_f32_16x16x32_bf16 v[72:75], v[160:163], v[104:107], 0
    ds_read2_b32 v[194:195], v16 offset0:18 offset1:19
    v_mfma_f32_16x16x32_bf16 v[76:79], v[160:163], v[108:111], 0
    ds_read_b128 v[128:131], v20 offset:3648
    v_mfma_f32_16x16x32_bf16 v[80:83], v[160:163], v[112:115], 0
    ds_read_b128 v[132:135], v20 offset:3136
    v_mfma_f32_16x16x32_bf16 v[84:87], v[160:163], v[116:119], 0
    ds_read_b128 v[136:139], v20 offset:2624
    v_mfma_f32_16x16x32_bf16 v[88:91], v[160:163], v[120:123], 0
    ds_read_b128 v[140:143], v20 offset:2112
    s_waitcnt lgkmcnt(15)
    v_mfma_f32_16x16x32_bf16 v[92:95], v[160:163], v[124:127], 0
    ds_read_b128 v[144:147], v20 offset:1600
    v_mfma_f32_16x16x32_bf16 v[68:71], v[164:167], v[96:99], v[68:71]
    ds_read_b128 v[148:151], v20 offset:1088
    v_mfma_f32_16x16x32_bf16 v[72:75], v[164:167], v[100:103], v[72:75]
    ds_read_b128 v[152:155], v20 offset:576
    v_mfma_f32_16x16x32_bf16 v[76:79], v[164:167], v[104:107], v[76:79]
    ds_read_b128 v[156:159], v20 offset:64
    v_mfma_f32_16x16x32_bf16 v[80:83], v[164:167], v[108:111], v[80:83]
    ds_read2_b32 v[196:197], v16 offset0:144 offset1:145
    v_mfma_f32_16x16x32_bf16 v[84:87], v[164:167], v[112:115], v[84:87]
    ds_read2_b32 v[198:199], v16 offset0:146 offset1:147
    v_mfma_f32_16x16x32_bf16 v[88:91], v[164:167], v[116:119], v[88:91]
    ds_read2_b32 v[200:201], v17 offset0:16 offset1:17
    v_mfma_f32_16x16x32_bf16 v[92:95], v[164:167], v[120:123], v[92:95]
    ds_read2_b32 v[202:203], v17 offset0:18 offset1:19
    v_mfma_f32_16x16x32_bf16 v[72:75], v[168:171], v[96:99], v[72:75]
    ds_read2_b32 v[204:205], v17 offset0:144 offset1:145
    v_mfma_f32_16x16x32_bf16 v[76:79], v[168:171], v[100:103], v[76:79]
    ds_read2_b32 v[206:207], v17 offset0:146 offset1:147
    v_mfma_f32_16x16x32_bf16 v[80:83], v[168:171], v[104:107], v[80:83]
    ds_read2_b32 v[208:209], v18 offset0:16 offset1:17
    v_mfma_f32_16x16x32_bf16 v[84:87], v[168:171], v[108:111], v[84:87]
    ds_read2_b32 v[210:211], v18 offset0:18 offset1:19
    v_mfma_f32_16x16x32_bf16 v[88:91], v[168:171], v[112:115], v[88:91]
    ds_read2_b32 v[212:213], v18 offset0:144 offset1:145
    v_mfma_f32_16x16x32_bf16 v[92:95], v[168:171], v[116:119], v[92:95]
    ds_read2_b32 v[214:215], v18 offset0:146 offset1:147
    s_waitcnt lgkmcnt(15)
    v_mfma_f32_16x16x32_bf16 v[76:79], v[172:175], v[96:99], v[76:79]
    ds_read2_b32 v[216:217], v19 offset0:16 offset1:17
    v_mfma_f32_16x16x32_bf16 v[80:83], v[172:175], v[100:103], v[80:83]
    ds_read2_b32 v[218:219], v19 offset0:18 offset1:19
    v_mfma_f32_16x16x32_bf16 v[84:87], v[172:175], v[104:107], v[84:87]
    ds_read2_b32 v[220:221], v19 offset0:144 offset1:145
    v_mfma_f32_16x16x32_bf16 v[88:91], v[172:175], v[108:111], v[88:91]
    ds_read2_b32 v[222:223], v19 offset0:146 offset1:147
    v_mfma_f32_16x16x32_bf16 v[92:95], v[172:175], v[112:115], v[92:95]
    v_and_b32 v224, s12, v41
    v_lshlrev_b32 v225, 16, v41
    v_mfma_f32_16x16x32_bf16 v[80:83], v[176:179], v[96:99], v[80:83]
    v_and_b32 v226, s12, v40
    v_lshlrev_b32 v227, 16, v40
    v_mfma_f32_16x16x32_bf16 v[84:87], v[176:179], v[100:103], v[84:87]
    v_mul_f32 v224, v224, v26
    v_mul_f32 v225, v225, v26
    v_mfma_f32_16x16x32_bf16 v[88:91], v[176:179], v[104:107], v[88:91]
    v_mul_f32 v226, v226, v26
    v_mul_f32 v227, v227, v26
    v_mfma_f32_16x16x32_bf16 v[92:95], v[176:179], v[108:111], v[92:95]
    v_cvt_pk_bf16_f32 v56, v224, v225
    v_cvt_pk_bf16_f32 v57, v226, v227
    v_mfma_f32_16x16x32_bf16 v[84:87], v[180:183], v[96:99], v[84:87]
    v_lshlrev_b32 v224, 16, v56
    v_and_b32 v225, s12, v56
    v_mfma_f32_16x16x32_bf16 v[88:91], v[180:183], v[100:103], v[88:91]
    v_lshlrev_b32 v226, 16, v57
    v_and_b32 v227, s12, v57
    v_mfma_f32_16x16x32_bf16 v[92:95], v[180:183], v[104:107], v[92:95]
    v_and_b32 v228, s12, v43
    v_lshlrev_b32 v229, 16, v43
    v_mfma_f32_16x16x32_bf16 v[88:91], v[184:187], v[96:99], v[88:91]
    v_and_b32 v230, s12, v42
    v_lshlrev_b32 v231, 16, v42
    v_mfma_f32_16x16x32_bf16 v[92:95], v[184:187], v[100:103], v[92:95]
    v_mul_f32 v228, v228, v26
    v_mul_f32 v229, v229, v26
    v_mfma_f32_16x16x32_bf16 v[92:95], v[188:191], v[96:99], v[92:95]
    v_mul_f32 v230, v230, v26
    v_mul_f32 v231, v231, v26
    v_mfma_f32_16x16x32_bf16 v[64:67], v[192:195], v[128:131], v[64:67]
    v_cvt_pk_bf16_f32 v56, v228, v229
    v_cvt_pk_bf16_f32 v57, v230, v231
    v_mfma_f32_16x16x32_bf16 v[68:71], v[192:195], v[132:135], v[68:71]
    ds_read2_b32 v[160:161], v16 offset0:32 offset1:33
    v_mfma_f32_16x16x32_bf16 v[72:75], v[192:195], v[136:139], v[72:75]
    ds_read2_b32 v[162:163], v16 offset0:34 offset1:35
    s_waitcnt lgkmcnt(15)
    v_mfma_f32_16x16x32_bf16 v[76:79], v[192:195], v[140:143], v[76:79]
    ds_read_b128 v[96:99], v20 offset:3712
    v_mfma_f32_16x16x32_bf16 v[80:83], v[192:195], v[144:147], v[80:83]
    ds_read_b128 v[100:103], v20 offset:3200
    v_mfma_f32_16x16x32_bf16 v[84:87], v[192:195], v[148:151], v[84:87]
    ds_read_b128 v[104:107], v20 offset:2688
    v_mfma_f32_16x16x32_bf16 v[88:91], v[192:195], v[152:155], v[88:91]
    ds_read_b128 v[108:111], v20 offset:2176
    v_mfma_f32_16x16x32_bf16 v[92:95], v[192:195], v[156:159], v[92:95]
    ds_read_b128 v[112:115], v20 offset:1664
    s_waitcnt lgkmcnt(15)
    v_mfma_f32_16x16x32_bf16 v[68:71], v[196:199], v[128:131], v[68:71]
    ds_read_b128 v[116:119], v20 offset:1152
    v_mfma_f32_16x16x32_bf16 v[72:75], v[196:199], v[132:135], v[72:75]
    ds_read_b128 v[120:123], v20 offset:640
    v_mfma_f32_16x16x32_bf16 v[76:79], v[196:199], v[136:139], v[76:79]
    ds_read_b128 v[124:127], v20 offset:128
    v_mfma_f32_16x16x32_bf16 v[80:83], v[196:199], v[140:143], v[80:83]
    ds_read2_b32 v[164:165], v16 offset0:160 offset1:161
    v_mfma_f32_16x16x32_bf16 v[84:87], v[196:199], v[144:147], v[84:87]
    ds_read2_b32 v[166:167], v16 offset0:162 offset1:163
    v_mfma_f32_16x16x32_bf16 v[88:91], v[196:199], v[148:151], v[88:91]
    ds_read2_b32 v[168:169], v17 offset0:32 offset1:33
    v_mfma_f32_16x16x32_bf16 v[92:95], v[196:199], v[152:155], v[92:95]
    ds_read2_b32 v[170:171], v17 offset0:34 offset1:35
    v_mfma_f32_16x16x32_bf16 v[72:75], v[200:203], v[128:131], v[72:75]
    ds_read2_b32 v[172:173], v17 offset0:160 offset1:161
    v_mfma_f32_16x16x32_bf16 v[76:79], v[200:203], v[132:135], v[76:79]
    ds_read2_b32 v[174:175], v17 offset0:162 offset1:163
    v_mfma_f32_16x16x32_bf16 v[80:83], v[200:203], v[136:139], v[80:83]
    ds_read2_b32 v[176:177], v18 offset0:32 offset1:33
    v_mfma_f32_16x16x32_bf16 v[84:87], v[200:203], v[140:143], v[84:87]
    ds_read2_b32 v[178:179], v18 offset0:34 offset1:35
    v_mfma_f32_16x16x32_bf16 v[88:91], v[200:203], v[144:147], v[88:91]
    ds_read2_b32 v[180:181], v18 offset0:160 offset1:161
    v_mfma_f32_16x16x32_bf16 v[92:95], v[200:203], v[148:151], v[92:95]
    ds_read2_b32 v[182:183], v18 offset0:162 offset1:163
    v_mfma_f32_16x16x32_bf16 v[76:79], v[204:207], v[128:131], v[76:79]
    ds_read2_b32 v[184:185], v19 offset0:32 offset1:33
    v_mfma_f32_16x16x32_bf16 v[80:83], v[204:207], v[132:135], v[80:83]
    ds_read2_b32 v[186:187], v19 offset0:34 offset1:35
    v_mfma_f32_16x16x32_bf16 v[84:87], v[204:207], v[136:139], v[84:87]
    ds_read2_b32 v[188:189], v19 offset0:160 offset1:161
    v_mfma_f32_16x16x32_bf16 v[88:91], v[204:207], v[140:143], v[88:91]
    ds_read2_b32 v[190:191], v19 offset0:162 offset1:163
    v_mfma_f32_16x16x32_bf16 v[92:95], v[204:207], v[144:147], v[92:95]
    v_lshlrev_b32 v228, 16, v56
    v_and_b32 v229, s12, v56
    s_waitcnt lgkmcnt(15)
    v_mfma_f32_16x16x32_bf16 v[80:83], v[208:211], v[128:131], v[80:83]
    v_lshlrev_b32 v230, 16, v57
    v_and_b32 v231, s12, v57
    v_mfma_f32_16x16x32_bf16 v[84:87], v[208:211], v[132:135], v[84:87]
    v_and_b32 v232, s12, v45
    v_lshlrev_b32 v233, 16, v45
    v_mfma_f32_16x16x32_bf16 v[88:91], v[208:211], v[136:139], v[88:91]
    v_and_b32 v234, s12, v44
    v_lshlrev_b32 v235, 16, v44
    v_mfma_f32_16x16x32_bf16 v[92:95], v[208:211], v[140:143], v[92:95]
    v_mul_f32 v232, v232, v26
    v_mul_f32 v233, v233, v26
    v_mfma_f32_16x16x32_bf16 v[84:87], v[212:215], v[128:131], v[84:87]
    v_mul_f32 v234, v234, v26
    v_mul_f32 v235, v235, v26
    v_mfma_f32_16x16x32_bf16 v[88:91], v[212:215], v[132:135], v[88:91]
    v_cvt_pk_bf16_f32 v56, v232, v233
    v_cvt_pk_bf16_f32 v57, v234, v235
    v_mfma_f32_16x16x32_bf16 v[92:95], v[212:215], v[136:139], v[92:95]
    v_lshlrev_b32 v232, 16, v56
    v_and_b32 v233, s12, v56
    v_mfma_f32_16x16x32_bf16 v[88:91], v[216:219], v[128:131], v[88:91]
    v_lshlrev_b32 v234, 16, v57
    v_and_b32 v235, s12, v57
    v_mfma_f32_16x16x32_bf16 v[92:95], v[216:219], v[132:135], v[92:95]
    v_and_b32 v236, s12, v47
    v_lshlrev_b32 v237, 16, v47
    v_mfma_f32_16x16x32_bf16 v[92:95], v[220:223], v[128:131], v[92:95]
    v_and_b32 v238, s12, v46
    v_lshlrev_b32 v239, 16, v46
    v_mfma_f32_16x16x32_bf16 v[64:67], v[160:163], v[96:99], v[64:67]
    v_mul_f32 v236, v236, v26
    v_mul_f32 v237, v237, v26
    v_mfma_f32_16x16x32_bf16 v[68:71], v[160:163], v[100:103], v[68:71]
    ds_read2_b32 v[192:193], v16 offset0:48 offset1:49
    v_mfma_f32_16x16x32_bf16 v[72:75], v[160:163], v[104:107], v[72:75]
    ds_read2_b32 v[194:195], v16 offset0:50 offset1:51
    v_mfma_f32_16x16x32_bf16 v[76:79], v[160:163], v[108:111], v[76:79]
    ds_read_b128 v[128:131], v20 offset:3776
    v_mfma_f32_16x16x32_bf16 v[80:83], v[160:163], v[112:115], v[80:83]
    ds_read_b128 v[132:135], v20 offset:3264
    v_mfma_f32_16x16x32_bf16 v[84:87], v[160:163], v[116:119], v[84:87]
    ds_read_b128 v[136:139], v20 offset:2752
    v_mfma_f32_16x16x32_bf16 v[88:91], v[160:163], v[120:123], v[88:91]
    ds_read_b128 v[140:143], v20 offset:2240
    s_waitcnt lgkmcnt(15)
    v_mfma_f32_16x16x32_bf16 v[92:95], v[160:163], v[124:127], v[92:95]
    ds_read_b128 v[144:147], v20 offset:1728
    s_waitcnt vmcnt(0)
    s_mov_b64 exec, 1
    ds_add_u32 v60, v61 offset:16
    s_mov_b64 exec, -1
    v_mfma_f32_16x16x32_bf16 v[68:71], v[164:167], v[96:99], v[68:71]
    ds_read_b128 v[148:151], v20 offset:1216
    v_mfma_f32_16x16x32_bf16 v[72:75], v[164:167], v[100:103], v[72:75]
    ds_read_b128 v[152:155], v20 offset:704
    v_mfma_f32_16x16x32_bf16 v[76:79], v[164:167], v[104:107], v[76:79]
    ds_read_b128 v[156:159], v20 offset:192
    v_mfma_f32_16x16x32_bf16 v[80:83], v[164:167], v[108:111], v[80:83]
    ds_read2_b32 v[196:197], v16 offset0:176 offset1:177
    v_mfma_f32_16x16x32_bf16 v[84:87], v[164:167], v[112:115], v[84:87]
    ds_read2_b32 v[198:199], v16 offset0:178 offset1:179
    v_mfma_f32_16x16x32_bf16 v[88:91], v[164:167], v[116:119], v[88:91]
    ds_read2_b32 v[200:201], v17 offset0:48 offset1:49
    v_mfma_f32_16x16x32_bf16 v[92:95], v[164:167], v[120:123], v[92:95]
    ds_read2_b32 v[202:203], v17 offset0:50 offset1:51
    v_mfma_f32_16x16x32_bf16 v[72:75], v[168:171], v[96:99], v[72:75]
    ds_read2_b32 v[204:205], v17 offset0:176 offset1:177
    v_mfma_f32_16x16x32_bf16 v[76:79], v[168:171], v[100:103], v[76:79]
    ds_read2_b32 v[206:207], v17 offset0:178 offset1:179
    v_mfma_f32_16x16x32_bf16 v[80:83], v[168:171], v[104:107], v[80:83]
    ds_read2_b32 v[208:209], v18 offset0:48 offset1:49
    v_mfma_f32_16x16x32_bf16 v[84:87], v[168:171], v[108:111], v[84:87]
    ds_read2_b32 v[210:211], v18 offset0:50 offset1:51
    v_mfma_f32_16x16x32_bf16 v[88:91], v[168:171], v[112:115], v[88:91]
    ds_read2_b32 v[212:213], v18 offset0:176 offset1:177
    v_mfma_f32_16x16x32_bf16 v[92:95], v[168:171], v[116:119], v[92:95]
    ds_read2_b32 v[214:215], v18 offset0:178 offset1:179
    s_waitcnt lgkmcnt(15)
    v_mfma_f32_16x16x32_bf16 v[76:79], v[172:175], v[96:99], v[76:79]
    ds_read2_b32 v[216:217], v19 offset0:48 offset1:49
    v_mfma_f32_16x16x32_bf16 v[80:83], v[172:175], v[100:103], v[80:83]
    ds_read2_b32 v[218:219], v19 offset0:50 offset1:51
    v_mfma_f32_16x16x32_bf16 v[84:87], v[172:175], v[104:107], v[84:87]
    ds_read2_b32 v[220:221], v19 offset0:176 offset1:177
    v_mfma_f32_16x16x32_bf16 v[88:91], v[172:175], v[108:111], v[88:91]
    ds_read2_b32 v[222:223], v19 offset0:178 offset1:179
    v_mfma_f32_16x16x32_bf16 v[92:95], v[172:175], v[112:115], v[92:95]
    v_mul_f32 v238, v238, v26
    v_mul_f32 v239, v239, v26
    v_mfma_f32_16x16x32_bf16 v[80:83], v[176:179], v[96:99], v[80:83]
    v_cvt_pk_bf16_f32 v56, v236, v237
    v_cvt_pk_bf16_f32 v57, v238, v239
    v_mfma_f32_16x16x32_bf16 v[84:87], v[176:179], v[100:103], v[84:87]
    v_lshlrev_b32 v236, 16, v56
    v_and_b32 v237, s12, v56
    v_mfma_f32_16x16x32_bf16 v[88:91], v[176:179], v[104:107], v[88:91]
    v_lshlrev_b32 v238, 16, v57
    v_and_b32 v239, s12, v57
    v_mfma_f32_16x16x32_bf16 v[92:95], v[176:179], v[108:111], v[92:95]
    v_and_b32 v240, s12, v49
    v_lshlrev_b32 v241, 16, v49
    v_mfma_f32_16x16x32_bf16 v[84:87], v[180:183], v[96:99], v[84:87]
    v_and_b32 v242, s12, v48
    v_lshlrev_b32 v243, 16, v48
    v_mfma_f32_16x16x32_bf16 v[88:91], v[180:183], v[100:103], v[88:91]
    v_mul_f32 v240, v240, v26
    v_mul_f32 v241, v241, v26
    v_mfma_f32_16x16x32_bf16 v[92:95], v[180:183], v[104:107], v[92:95]
    v_mul_f32 v242, v242, v26
    v_mul_f32 v243, v243, v26
    v_mfma_f32_16x16x32_bf16 v[88:91], v[184:187], v[96:99], v[88:91]
    v_cvt_pk_bf16_f32 v56, v240, v241
    v_cvt_pk_bf16_f32 v57, v242, v243
    v_mfma_f32_16x16x32_bf16 v[92:95], v[184:187], v[100:103], v[92:95]
    v_lshlrev_b32 v240, 16, v56
    v_and_b32 v241, s12, v56
    v_mfma_f32_16x16x32_bf16 v[92:95], v[188:191], v[96:99], v[92:95]
    v_lshlrev_b32 v242, 16, v57
    v_and_b32 v243, s12, v57
    v_mfma_f32_16x16x32_bf16 v[64:67], v[192:195], v[128:131], v[64:67]
    v_and_b32 v244, s12, v51
    v_lshlrev_b32 v245, 16, v51
    v_mfma_f32_16x16x32_bf16 v[68:71], v[192:195], v[132:135], v[68:71]
    ds_read2_b32 v[160:161], v16 offset0:64 offset1:65
    v_mfma_f32_16x16x32_bf16 v[72:75], v[192:195], v[136:139], v[72:75]
    ds_read2_b32 v[162:163], v16 offset0:66 offset1:67
    v_mfma_f32_16x16x32_bf16 v[76:79], v[192:195], v[140:143], v[76:79]
    ds_read_b128 v[96:99], v20 offset:3840
    s_waitcnt lgkmcnt(15)
    v_mfma_f32_16x16x32_bf16 v[80:83], v[192:195], v[144:147], v[80:83]
    ds_read_b128 v[100:103], v20 offset:3328
    v_mfma_f32_16x16x32_bf16 v[84:87], v[192:195], v[148:151], v[84:87]
    ds_read_b128 v[104:107], v20 offset:2816
    v_mfma_f32_16x16x32_bf16 v[88:91], v[192:195], v[152:155], v[88:91]
    ds_read_b128 v[108:111], v20 offset:2304
    v_mfma_f32_16x16x32_bf16 v[92:95], v[192:195], v[156:159], v[92:95]
    ds_read_b128 v[112:115], v20 offset:1792
    v_mfma_f32_16x16x32_bf16 v[68:71], v[196:199], v[128:131], v[68:71]
    ds_read_b128 v[116:119], v20 offset:1280
    v_mfma_f32_16x16x32_bf16 v[72:75], v[196:199], v[132:135], v[72:75]
    ds_read_b128 v[120:123], v20 offset:768
    v_mfma_f32_16x16x32_bf16 v[76:79], v[196:199], v[136:139], v[76:79]
    ds_read_b128 v[124:127], v20 offset:256
    v_mfma_f32_16x16x32_bf16 v[80:83], v[196:199], v[140:143], v[80:83]
    ds_read2_b32 v[164:165], v16 offset0:192 offset1:193
    v_mfma_f32_16x16x32_bf16 v[84:87], v[196:199], v[144:147], v[84:87]
    ds_read2_b32 v[166:167], v16 offset0:194 offset1:195
    v_mfma_f32_16x16x32_bf16 v[88:91], v[196:199], v[148:151], v[88:91]
    ds_read2_b32 v[168:169], v17 offset0:64 offset1:65
    v_mfma_f32_16x16x32_bf16 v[92:95], v[196:199], v[152:155], v[92:95]
    ds_read2_b32 v[170:171], v17 offset0:66 offset1:67
    s_waitcnt lgkmcnt(15)
    v_mfma_f32_16x16x32_bf16 v[72:75], v[200:203], v[128:131], v[72:75]
    ds_read2_b32 v[172:173], v17 offset0:192 offset1:193
    v_mfma_f32_16x16x32_bf16 v[76:79], v[200:203], v[132:135], v[76:79]
    ds_read2_b32 v[174:175], v17 offset0:194 offset1:195
    v_mfma_f32_16x16x32_bf16 v[80:83], v[200:203], v[136:139], v[80:83]
    ds_read2_b32 v[176:177], v18 offset0:64 offset1:65
    v_mfma_f32_16x16x32_bf16 v[84:87], v[200:203], v[140:143], v[84:87]
    ds_read2_b32 v[178:179], v18 offset0:66 offset1:67
    v_mfma_f32_16x16x32_bf16 v[88:91], v[200:203], v[144:147], v[88:91]
    ds_read2_b32 v[180:181], v18 offset0:192 offset1:193
    v_mfma_f32_16x16x32_bf16 v[92:95], v[200:203], v[148:151], v[92:95]
    ds_read2_b32 v[182:183], v18 offset0:194 offset1:195
    v_mfma_f32_16x16x32_bf16 v[76:79], v[204:207], v[128:131], v[76:79]
    ds_read2_b32 v[184:185], v19 offset0:64 offset1:65
    v_mfma_f32_16x16x32_bf16 v[80:83], v[204:207], v[132:135], v[80:83]
    ds_read2_b32 v[186:187], v19 offset0:66 offset1:67
    v_mfma_f32_16x16x32_bf16 v[84:87], v[204:207], v[136:139], v[84:87]
    ds_read2_b32 v[188:189], v19 offset0:192 offset1:193
    v_mfma_f32_16x16x32_bf16 v[88:91], v[204:207], v[140:143], v[88:91]
    ds_read2_b32 v[190:191], v19 offset0:194 offset1:195
    v_mfma_f32_16x16x32_bf16 v[92:95], v[204:207], v[144:147], v[92:95]
    v_and_b32 v246, s12, v50
    v_lshlrev_b32 v247, 16, v50
    v_mfma_f32_16x16x32_bf16 v[80:83], v[208:211], v[128:131], v[80:83]
    v_mul_f32 v244, v244, v26
    v_mul_f32 v245, v245, v26
    v_mfma_f32_16x16x32_bf16 v[84:87], v[208:211], v[132:135], v[84:87]
    v_mul_f32 v246, v246, v26
    v_mul_f32 v247, v247, v26
    v_mfma_f32_16x16x32_bf16 v[88:91], v[208:211], v[136:139], v[88:91]
    v_cvt_pk_bf16_f32 v56, v244, v245
    v_cvt_pk_bf16_f32 v57, v246, v247
    v_mfma_f32_16x16x32_bf16 v[92:95], v[208:211], v[140:143], v[92:95]
    v_lshlrev_b32 v244, 16, v56
    v_and_b32 v245, s12, v56
    v_mfma_f32_16x16x32_bf16 v[84:87], v[212:215], v[128:131], v[84:87]
    v_lshlrev_b32 v246, 16, v57
    v_and_b32 v247, s12, v57
    v_mfma_f32_16x16x32_bf16 v[88:91], v[212:215], v[132:135], v[88:91]
    v_and_b32 v248, s12, v53
    v_lshlrev_b32 v249, 16, v53
    v_mfma_f32_16x16x32_bf16 v[92:95], v[212:215], v[136:139], v[92:95]
    v_and_b32 v250, s12, v52
    v_lshlrev_b32 v251, 16, v52
    v_mfma_f32_16x16x32_bf16 v[88:91], v[216:219], v[128:131], v[88:91]
    v_mul_f32 v248, v248, v26
    v_mul_f32 v249, v249, v26
    v_mfma_f32_16x16x32_bf16 v[92:95], v[216:219], v[132:135], v[92:95]
    v_mul_f32 v250, v250, v26
    v_mul_f32 v251, v251, v26
    s_waitcnt lgkmcnt(15)
    v_mfma_f32_16x16x32_bf16 v[92:95], v[220:223], v[128:131], v[92:95]
    v_cvt_pk_bf16_f32 v56, v248, v249
    v_cvt_pk_bf16_f32 v57, v250, v251
    v_mfma_f32_16x16x32_bf16 v[64:67], v[160:163], v[96:99], v[64:67]
    v_lshlrev_b32 v248, 16, v56
    v_and_b32 v249, s12, v56
    v_mfma_f32_16x16x32_bf16 v[68:71], v[160:163], v[100:103], v[68:71]
    ds_read2_b32 v[192:193], v16 offset0:80 offset1:81
    v_mfma_f32_16x16x32_bf16 v[72:75], v[160:163], v[104:107], v[72:75]
    ds_read2_b32 v[194:195], v16 offset0:82 offset1:83
    v_mfma_f32_16x16x32_bf16 v[76:79], v[160:163], v[108:111], v[76:79]
    ds_read_b128 v[128:131], v20 offset:3904
    v_mfma_f32_16x16x32_bf16 v[80:83], v[160:163], v[112:115], v[80:83]
    ds_read_b128 v[132:135], v20 offset:3392
    v_mfma_f32_16x16x32_bf16 v[84:87], v[160:163], v[116:119], v[84:87]
    ds_read_b128 v[136:139], v20 offset:2880
    v_mfma_f32_16x16x32_bf16 v[88:91], v[160:163], v[120:123], v[88:91]
    ds_read_b128 v[140:143], v20 offset:2368
    s_waitcnt lgkmcnt(15)
    v_mfma_f32_16x16x32_bf16 v[92:95], v[160:163], v[124:127], v[92:95]
    ds_read_b128 v[144:147], v20 offset:1856
    v_mfma_f32_16x16x32_bf16 v[68:71], v[164:167], v[96:99], v[68:71]
    ds_read_b128 v[148:151], v20 offset:1344
    v_mfma_f32_16x16x32_bf16 v[72:75], v[164:167], v[100:103], v[72:75]
    ds_read_b128 v[152:155], v20 offset:832
    v_mfma_f32_16x16x32_bf16 v[76:79], v[164:167], v[104:107], v[76:79]
    ds_read_b128 v[156:159], v20 offset:320
    v_mfma_f32_16x16x32_bf16 v[80:83], v[164:167], v[108:111], v[80:83]
    ds_read2_b32 v[196:197], v16 offset0:208 offset1:209
    v_mfma_f32_16x16x32_bf16 v[84:87], v[164:167], v[112:115], v[84:87]
    ds_read2_b32 v[198:199], v16 offset0:210 offset1:211
    v_mfma_f32_16x16x32_bf16 v[88:91], v[164:167], v[116:119], v[88:91]
    ds_read2_b32 v[200:201], v17 offset0:80 offset1:81
    v_mfma_f32_16x16x32_bf16 v[92:95], v[164:167], v[120:123], v[92:95]
    ds_read2_b32 v[202:203], v17 offset0:82 offset1:83
    v_mfma_f32_16x16x32_bf16 v[72:75], v[168:171], v[96:99], v[72:75]
    ds_read2_b32 v[204:205], v17 offset0:208 offset1:209
    v_mfma_f32_16x16x32_bf16 v[76:79], v[168:171], v[100:103], v[76:79]
    ds_read2_b32 v[206:207], v17 offset0:210 offset1:211
    v_mfma_f32_16x16x32_bf16 v[80:83], v[168:171], v[104:107], v[80:83]
    ds_read2_b32 v[208:209], v18 offset0:80 offset1:81
    v_mfma_f32_16x16x32_bf16 v[84:87], v[168:171], v[108:111], v[84:87]
    ds_read2_b32 v[210:211], v18 offset0:82 offset1:83
    v_mfma_f32_16x16x32_bf16 v[88:91], v[168:171], v[112:115], v[88:91]
    ds_read2_b32 v[212:213], v18 offset0:208 offset1:209
    v_mfma_f32_16x16x32_bf16 v[92:95], v[168:171], v[116:119], v[92:95]
    ds_read2_b32 v[214:215], v18 offset0:210 offset1:211
    s_waitcnt lgkmcnt(15)
    v_mfma_f32_16x16x32_bf16 v[76:79], v[172:175], v[96:99], v[76:79]
    ds_read2_b32 v[216:217], v19 offset0:80 offset1:81
    v_mfma_f32_16x16x32_bf16 v[80:83], v[172:175], v[100:103], v[80:83]
    ds_read2_b32 v[218:219], v19 offset0:82 offset1:83
    v_mfma_f32_16x16x32_bf16 v[84:87], v[172:175], v[104:107], v[84:87]
    ds_read2_b32 v[220:221], v19 offset0:208 offset1:209
    v_mfma_f32_16x16x32_bf16 v[88:91], v[172:175], v[108:111], v[88:91]
    ds_read2_b32 v[222:223], v19 offset0:210 offset1:211
    v_mfma_f32_16x16x32_bf16 v[92:95], v[172:175], v[112:115], v[92:95]
    v_lshlrev_b32 v250, 16, v57
    v_and_b32 v251, s12, v57
    v_mfma_f32_16x16x32_bf16 v[80:83], v[176:179], v[96:99], v[80:83]
    v_and_b32 v252, s12, v55
    v_lshlrev_b32 v253, 16, v55
    v_mfma_f32_16x16x32_bf16 v[84:87], v[176:179], v[100:103], v[84:87]
    v_and_b32 v254, s12, v54
    v_lshlrev_b32 v255, 16, v54
    v_mfma_f32_16x16x32_bf16 v[88:91], v[176:179], v[104:107], v[88:91]
    v_mul_f32 v252, v252, v26
    v_mul_f32 v253, v253, v26
    v_mfma_f32_16x16x32_bf16 v[92:95], v[176:179], v[108:111], v[92:95]
    v_mul_f32 v254, v254, v26
    v_mul_f32 v255, v255, v26
    v_mfma_f32_16x16x32_bf16 v[84:87], v[180:183], v[96:99], v[84:87]
    v_cvt_pk_bf16_f32 v56, v252, v253
    v_cvt_pk_bf16_f32 v57, v254, v255
    v_mfma_f32_16x16x32_bf16 v[88:91], v[180:183], v[100:103], v[88:91]
    v_lshlrev_b32 v252, 16, v56
    v_and_b32 v253, s12, v56
    v_mfma_f32_16x16x32_bf16 v[92:95], v[180:183], v[104:107], v[92:95]
    v_lshlrev_b32 v254, 16, v57
    v_and_b32 v255, s12, v57
    v_mfma_f32_16x16x32_bf16 v[88:91], v[184:187], v[96:99], v[88:91]
    v_mfma_f32_16x16x32_bf16 v[92:95], v[184:187], v[100:103], v[92:95]
    v_mfma_f32_16x16x32_bf16 v[92:95], v[188:191], v[96:99], v[92:95]
    v_mfma_f32_16x16x32_bf16 v[64:67], v[192:195], v[128:131], v[64:67]
    v_mfma_f32_16x16x32_bf16 v[68:71], v[192:195], v[132:135], v[68:71]
    ds_read2_b32 v[160:161], v16 offset0:96 offset1:97
    v_mfma_f32_16x16x32_bf16 v[72:75], v[192:195], v[136:139], v[72:75]
    ds_read2_b32 v[162:163], v16 offset0:98 offset1:99
    s_waitcnt lgkmcnt(15)
    v_mfma_f32_16x16x32_bf16 v[76:79], v[192:195], v[140:143], v[76:79]
    ds_read_b128 v[96:99], v20 offset:3968
    v_mfma_f32_16x16x32_bf16 v[80:83], v[192:195], v[144:147], v[80:83]
    ds_read_b128 v[100:103], v20 offset:3456
    v_mfma_f32_16x16x32_bf16 v[84:87], v[192:195], v[148:151], v[84:87]
    ds_read_b128 v[104:107], v20 offset:2944
    v_mfma_f32_16x16x32_bf16 v[88:91], v[192:195], v[152:155], v[88:91]
    ds_read_b128 v[108:111], v20 offset:2432
    v_mfma_f32_16x16x32_bf16 v[92:95], v[192:195], v[156:159], v[92:95]
    ds_read_b128 v[112:115], v20 offset:1920
    s_waitcnt lgkmcnt(15)
    v_mfma_f32_16x16x32_bf16 v[68:71], v[196:199], v[128:131], v[68:71]
    ds_read_b128 v[116:119], v20 offset:1408
    v_mfma_f32_16x16x32_bf16 v[72:75], v[196:199], v[132:135], v[72:75]
    ds_read_b128 v[120:123], v20 offset:896
    v_mfma_f32_16x16x32_bf16 v[76:79], v[196:199], v[136:139], v[76:79]
    ds_read_b128 v[124:127], v20 offset:384
    v_mfma_f32_16x16x32_bf16 v[80:83], v[196:199], v[140:143], v[80:83]
    ds_read2_b32 v[164:165], v16 offset0:224 offset1:225
    v_mfma_f32_16x16x32_bf16 v[84:87], v[196:199], v[144:147], v[84:87]
    ds_read2_b32 v[166:167], v16 offset0:226 offset1:227
    v_mfma_f32_16x16x32_bf16 v[88:91], v[196:199], v[148:151], v[88:91]
    ds_read2_b32 v[168:169], v17 offset0:96 offset1:97
    v_mfma_f32_16x16x32_bf16 v[92:95], v[196:199], v[152:155], v[92:95]
    ds_read2_b32 v[170:171], v17 offset0:98 offset1:99
    v_mfma_f32_16x16x32_bf16 v[72:75], v[200:203], v[128:131], v[72:75]
    ds_read2_b32 v[172:173], v17 offset0:224 offset1:225
    v_mfma_f32_16x16x32_bf16 v[76:79], v[200:203], v[132:135], v[76:79]
    ds_read2_b32 v[174:175], v17 offset0:226 offset1:227
    v_mfma_f32_16x16x32_bf16 v[80:83], v[200:203], v[136:139], v[80:83]
    ds_read2_b32 v[176:177], v18 offset0:96 offset1:97
    v_mfma_f32_16x16x32_bf16 v[84:87], v[200:203], v[140:143], v[84:87]
    ds_read2_b32 v[178:179], v18 offset0:98 offset1:99
    v_mfma_f32_16x16x32_bf16 v[88:91], v[200:203], v[144:147], v[88:91]
    ds_read2_b32 v[180:181], v18 offset0:224 offset1:225
    s_cmp_le_u32 s15, 0
    s_cselect_b32 s11, 1, 0
    s_lshl_b32 s11, s11, 7
    s_add_u32 s99, s11, s91
    s_add_u32 m0, s10, 0x8000
    s_nop 0
    buffer_load_dwordx4 v28, s[56:59], s99 offen offset:0 lds
    buffer_load_dwordx4 v29, s[56:59], s99 offen offset:1024 lds
    s_add_u32 s11, s11, s90
    s_add_u32 m0, s10, 0xa000
    s_nop 0
    buffer_load_dwordx4 v28, s[56:59], s11 offen offset:0 lds
    buffer_load_dwordx4 v29, s[56:59], s11 offen offset:1024 lds
    s_cmp_le_u32 s15, 0
    s_cselect_b32 s11, 1, 0
    s_lshl_b32 s11, s11, 7
    s_add_u32 s99, s11, s91
    s_add_u32 m0, s10, 0xc000
    s_nop 0
    buffer_load_dwordx4 v28, s[60:63], s99 offen offset:0 lds
    buffer_load_dwordx4 v29, s[60:63], s99 offen offset:1024 lds
    s_add_u32 s11, s11, s90
    s_add_u32 m0, s10, 0xe000
    s_nop 0
    buffer_load_dwordx4 v28, s[60:63], s11 offen offset:0 lds
    buffer_load_dwordx4 v29, s[60:63], s11 offen offset:1024 lds
    v_mfma_f32_16x16x32_bf16 v[92:95], v[200:203], v[148:151], v[92:95]
    ds_read2_b32 v[182:183], v18 offset0:226 offset1:227
    v_mfma_f32_16x16x32_bf16 v[76:79], v[204:207], v[128:131], v[76:79]
    ds_read2_b32 v[184:185], v19 offset0:96 offset1:97
    v_mfma_f32_16x16x32_bf16 v[80:83], v[204:207], v[132:135], v[80:83]
    ds_read2_b32 v[186:187], v19 offset0:98 offset1:99
    v_mfma_f32_16x16x32_bf16 v[84:87], v[204:207], v[136:139], v[84:87]
    ds_read2_b32 v[188:189], v19 offset0:224 offset1:225
    v_mfma_f32_16x16x32_bf16 v[88:91], v[204:207], v[140:143], v[88:91]
    ds_read2_b32 v[190:191], v19 offset0:226 offset1:227
    v_mfma_f32_16x16x32_bf16 v[92:95], v[204:207], v[144:147], v[92:95]
    s_waitcnt lgkmcnt(15)
    v_mfma_f32_16x16x32_bf16 v[80:83], v[208:211], v[128:131], v[80:83]
    v_mfma_f32_16x16x32_bf16 v[84:87], v[208:211], v[132:135], v[84:87]
    v_mfma_f32_16x16x32_bf16 v[88:91], v[208:211], v[136:139], v[88:91]
    v_mfma_f32_16x16x32_bf16 v[92:95], v[208:211], v[140:143], v[92:95]
    v_mfma_f32_16x16x32_bf16 v[84:87], v[212:215], v[128:131], v[84:87]
    v_mfma_f32_16x16x32_bf16 v[88:91], v[212:215], v[132:135], v[88:91]
    v_mfma_f32_16x16x32_bf16 v[92:95], v[212:215], v[136:139], v[92:95]
    v_mfma_f32_16x16x32_bf16 v[88:91], v[216:219], v[128:131], v[88:91]
    v_mfma_f32_16x16x32_bf16 v[92:95], v[216:219], v[132:135], v[92:95]
    v_mfma_f32_16x16x32_bf16 v[92:95], v[220:223], v[128:131], v[92:95]
    v_mfma_f32_16x16x32_bf16 v[64:67], v[160:163], v[96:99], v[64:67]
    v_mfma_f32_16x16x32_bf16 v[68:71], v[160:163], v[100:103], v[68:71]
    ds_read2_b32 v[192:193], v16 offset0:112 offset1:113
    v_mfma_f32_16x16x32_bf16 v[72:75], v[160:163], v[104:107], v[72:75]
    ds_read2_b32 v[194:195], v16 offset0:114 offset1:115
    v_mfma_f32_16x16x32_bf16 v[76:79], v[160:163], v[108:111], v[76:79]
    ds_read_b128 v[128:131], v20 offset:4032
    v_mfma_f32_16x16x32_bf16 v[80:83], v[160:163], v[112:115], v[80:83]
    ds_read_b128 v[132:135], v20 offset:3520
    v_mfma_f32_16x16x32_bf16 v[84:87], v[160:163], v[116:119], v[84:87]
    ds_read_b128 v[136:139], v20 offset:3008
    v_mfma_f32_16x16x32_bf16 v[88:91], v[160:163], v[120:123], v[88:91]
    ds_read_b128 v[140:143], v20 offset:2496
    s_waitcnt lgkmcnt(15)
    v_mfma_f32_16x16x32_bf16 v[92:95], v[160:163], v[124:127], v[92:95]
    ds_read_b128 v[144:147], v20 offset:1984
    v_mfma_f32_16x16x32_bf16 v[68:71], v[164:167], v[96:99], v[68:71]
    ds_read_b128 v[148:151], v20 offset:1472
    v_mfma_f32_16x16x32_bf16 v[72:75], v[164:167], v[100:103], v[72:75]
    ds_read_b128 v[152:155], v20 offset:960
    v_mfma_f32_16x16x32_bf16 v[76:79], v[164:167], v[104:107], v[76:79]
    ds_read_b128 v[156:159], v20 offset:448
    v_mfma_f32_16x16x32_bf16 v[80:83], v[164:167], v[108:111], v[80:83]
    ds_read2_b32 v[196:197], v16 offset0:240 offset1:241
    v_mfma_f32_16x16x32_bf16 v[84:87], v[164:167], v[112:115], v[84:87]
    ds_read2_b32 v[198:199], v16 offset0:242 offset1:243
    v_mfma_f32_16x16x32_bf16 v[88:91], v[164:167], v[116:119], v[88:91]
    ds_read2_b32 v[200:201], v17 offset0:112 offset1:113
    v_mfma_f32_16x16x32_bf16 v[92:95], v[164:167], v[120:123], v[92:95]
    ds_read2_b32 v[202:203], v17 offset0:114 offset1:115
    v_mfma_f32_16x16x32_bf16 v[72:75], v[168:171], v[96:99], v[72:75]
    ds_read2_b32 v[204:205], v17 offset0:240 offset1:241
    v_mfma_f32_16x16x32_bf16 v[76:79], v[168:171], v[100:103], v[76:79]
    ds_read2_b32 v[206:207], v17 offset0:242 offset1:243
    v_mfma_f32_16x16x32_bf16 v[80:83], v[168:171], v[104:107], v[80:83]
    ds_read2_b32 v[208:209], v18 offset0:112 offset1:113
    v_mfma_f32_16x16x32_bf16 v[84:87], v[168:171], v[108:111], v[84:87]
    ds_read2_b32 v[210:211], v18 offset0:114 offset1:115
    v_mfma_f32_16x16x32_bf16 v[88:91], v[168:171], v[112:115], v[88:91]
    ds_read2_b32 v[212:213], v18 offset0:240 offset1:241
    v_mfma_f32_16x16x32_bf16 v[92:95], v[168:171], v[116:119], v[92:95]
    ds_read2_b32 v[214:215], v18 offset0:242 offset1:243
    s_waitcnt lgkmcnt(15)
    v_mfma_f32_16x16x32_bf16 v[76:79], v[172:175], v[96:99], v[76:79]
    ds_read2_b32 v[216:217], v19 offset0:112 offset1:113
    v_mfma_f32_16x16x32_bf16 v[80:83], v[172:175], v[100:103], v[80:83]
    ds_read2_b32 v[218:219], v19 offset0:114 offset1:115
    v_mfma_f32_16x16x32_bf16 v[84:87], v[172:175], v[104:107], v[84:87]
    ds_read2_b32 v[220:221], v19 offset0:240 offset1:241
    v_mfma_f32_16x16x32_bf16 v[88:91], v[172:175], v[108:111], v[88:91]
    ds_read2_b32 v[222:223], v19 offset0:242 offset1:243
    v_mfma_f32_16x16x32_bf16 v[92:95], v[172:175], v[112:115], v[92:95]
    v_mfma_f32_16x16x32_bf16 v[80:83], v[176:179], v[96:99], v[80:83]
    v_mfma_f32_16x16x32_bf16 v[84:87], v[176:179], v[100:103], v[84:87]
    v_mfma_f32_16x16x32_bf16 v[88:91], v[176:179], v[104:107], v[88:91]
    v_mfma_f32_16x16x32_bf16 v[92:95], v[176:179], v[108:111], v[92:95]
    v_mfma_f32_16x16x32_bf16 v[84:87], v[180:183], v[96:99], v[84:87]
    v_mfma_f32_16x16x32_bf16 v[88:91], v[180:183], v[100:103], v[88:91]
    v_mfma_f32_16x16x32_bf16 v[92:95], v[180:183], v[104:107], v[92:95]
    v_mfma_f32_16x16x32_bf16 v[88:91], v[184:187], v[96:99], v[88:91]
    v_mfma_f32_16x16x32_bf16 v[92:95], v[184:187], v[100:103], v[92:95]
    v_mfma_f32_16x16x32_bf16 v[92:95], v[188:191], v[96:99], v[92:95]
    v_mfma_f32_16x16x32_bf16 v[64:67], v[192:195], v[128:131], v[64:67]
    v_mfma_f32_16x16x32_bf16 v[68:71], v[192:195], v[132:135], v[68:71]
    v_mfma_f32_16x16x32_bf16 v[72:75], v[192:195], v[136:139], v[72:75]
    s_waitcnt lgkmcnt(15)
    v_mfma_f32_16x16x32_bf16 v[76:79], v[192:195], v[140:143], v[76:79]
    s_nop 3
    v_cvt_pk_bf16_f32 v56, v64, v65
    v_cvt_pk_bf16_f32 v57, v66, v67
    v_lshlrev_b32 v64, 16, v56
    v_mfma_f32_16x16x32_bf16 v[80:83], v[192:195], v[144:147], v[80:83]
    v_and_b32 v65, s12, v56
    v_lshlrev_b32 v66, 16, v57
    v_and_b32 v67, s12, v57
    v_mfma_f32_16x16x32_bf16 v[84:87], v[192:195], v[148:151], v[84:87]
    v_add_f32 v224, v224, v64
    v_add_f32 v225, v225, v65
    v_add_f32 v226, v226, v66
    v_mfma_f32_16x16x32_bf16 v[88:91], v[192:195], v[152:155], v[88:91]
    v_add_f32 v227, v227, v67
    v_cvt_pk_bf16_f32 v40, v224, v225
    v_cvt_pk_bf16_f32 v41, v226, v227
    s_waitcnt lgkmcnt(14)
    v_mfma_f32_16x16x32_bf16 v[92:95], v[192:195], v[156:159], v[92:95]
    s_waitcnt lgkmcnt(12)
    v_mfma_f32_16x16x32_bf16 v[68:71], v[196:199], v[128:131], v[68:71]
    v_mfma_f32_16x16x32_bf16 v[72:75], v[196:199], v[132:135], v[72:75]
    v_mfma_f32_16x16x32_bf16 v[76:79], v[196:199], v[136:139], v[76:79]
    v_mfma_f32_16x16x32_bf16 v[80:83], v[196:199], v[140:143], v[80:83]
    s_nop 4
    v_cvt_pk_bf16_f32 v56, v68, v69
    v_cvt_pk_bf16_f32 v57, v70, v71
    v_lshlrev_b32 v68, 16, v56
    v_mfma_f32_16x16x32_bf16 v[84:87], v[196:199], v[144:147], v[84:87]
    v_and_b32 v69, s12, v56
    v_lshlrev_b32 v70, 16, v57
    v_and_b32 v71, s12, v57
    v_mfma_f32_16x16x32_bf16 v[88:91], v[196:199], v[148:151], v[88:91]
    v_add_f32 v228, v228, v68
    v_add_f32 v229, v229, v69
    v_add_f32 v230, v230, v70
    v_mfma_f32_16x16x32_bf16 v[92:95], v[196:199], v[152:155], v[92:95]
    v_add_f32 v231, v231, v71
    v_cvt_pk_bf16_f32 v42, v228, v229
    v_cvt_pk_bf16_f32 v43, v230, v231
    s_waitcnt lgkmcnt(10)
    v_mfma_f32_16x16x32_bf16 v[72:75], v[200:203], v[128:131], v[72:75]
    v_permlane16_swap_b32 v40, v42
    v_permlane16_swap_b32 v41, v43
    v_mfma_f32_16x16x32_bf16 v[76:79], v[200:203], v[132:135], v[76:79]
    v_mfma_f32_16x16x32_bf16 v[80:83], v[200:203], v[136:139], v[80:83]
    v_mfma_f32_16x16x32_bf16 v[84:87], v[200:203], v[140:143], v[84:87]
    s_nop 2
    v_cvt_pk_bf16_f32 v56, v72, v73
    v_cvt_pk_bf16_f32 v57, v74, v75
    v_lshlrev_b32 v72, 16, v56
    v_mfma_f32_16x16x32_bf16 v[88:91], v[200:203], v[144:147], v[88:91]
    v_and_b32 v73, s12, v56
    v_lshlrev_b32 v74, 16, v57
    v_and_b32 v75, s12, v57
    v_mfma_f32_16x16x32_bf16 v[92:95], v[200:203], v[148:151], v[92:95]
    v_add_f32 v232, v232, v72
    v_add_f32 v233, v233, v73
    v_add_f32 v234, v234, v74
    s_waitcnt lgkmcnt(8)
    v_mfma_f32_16x16x32_bf16 v[76:79], v[204:207], v[128:131], v[76:79]
    v_add_f32 v235, v235, v75
    v_cvt_pk_bf16_f32 v44, v232, v233
    v_cvt_pk_bf16_f32 v45, v234, v235
    v_mfma_f32_16x16x32_bf16 v[80:83], v[204:207], v[132:135], v[80:83]
    v_mfma_f32_16x16x32_bf16 v[84:87], v[204:207], v[136:139], v[84:87]
    v_mfma_f32_16x16x32_bf16 v[88:91], v[204:207], v[140:143], v[88:91]
    s_nop 1
    v_cvt_pk_bf16_f32 v56, v76, v77
    v_cvt_pk_bf16_f32 v57, v78, v79
    v_lshlrev_b32 v76, 16, v56
    v_mfma_f32_16x16x32_bf16 v[92:95], v[204:207], v[144:147], v[92:95]
    v_and_b32 v77, s12, v56
    v_lshlrev_b32 v78, 16, v57
    v_and_b32 v79, s12, v57
    s_waitcnt lgkmcnt(6)
    v_mfma_f32_16x16x32_bf16 v[80:83], v[208:211], v[128:131], v[80:83]
    v_add_f32 v236, v236, v76
    v_add_f32 v237, v237, v77
    v_add_f32 v238, v238, v78
    v_mfma_f32_16x16x32_bf16 v[84:87], v[208:211], v[132:135], v[84:87]
    v_add_f32 v239, v239, v79
    v_cvt_pk_bf16_f32 v46, v236, v237
    v_cvt_pk_bf16_f32 v47, v238, v239
    v_mfma_f32_16x16x32_bf16 v[88:91], v[208:211], v[136:139], v[88:91]
    v_permlane16_swap_b32 v44, v46
    v_permlane16_swap_b32 v45, v47
    v_mfma_f32_16x16x32_bf16 v[92:95], v[208:211], v[140:143], v[92:95]
    v_cvt_pk_bf16_f32 v56, v80, v81
    v_cvt_pk_bf16_f32 v57, v82, v83
    v_lshlrev_b32 v80, 16, v56
    s_waitcnt lgkmcnt(4)
    v_mfma_f32_16x16x32_bf16 v[84:87], v[212:215], v[128:131], v[84:87]
    v_and_b32 v81, s12, v56
    v_lshlrev_b32 v82, 16, v57
    v_and_b32 v83, s12, v57
    v_mfma_f32_16x16x32_bf16 v[88:91], v[212:215], v[132:135], v[88:91]
    v_add_f32 v240, v240, v80
    v_add_f32 v241, v241, v81
    v_add_f32 v242, v242, v82
    v_mfma_f32_16x16x32_bf16 v[92:95], v[212:215], v[136:139], v[92:95]
    v_add_f32 v243, v243, v83
    v_cvt_pk_bf16_f32 v48, v240, v241
    v_cvt_pk_bf16_f32 v49, v242, v243
    s_waitcnt lgkmcnt(2)
    v_mfma_f32_16x16x32_bf16 v[88:91], v[216:219], v[128:131], v[88:91]
    v_cvt_pk_bf16_f32 v56, v84, v85
    v_cvt_pk_bf16_f32 v57, v86, v87
    v_lshlrev_b32 v84, 16, v56
    v_mfma_f32_16x16x32_bf16 v[92:95], v[216:219], v[132:135], v[92:95]
    v_and_b32 v85, s12, v56
    v_lshlrev_b32 v86, 16, v57
    v_and_b32 v87, s12, v57
    s_waitcnt lgkmcnt(0)
    v_mfma_f32_16x16x32_bf16 v[92:95], v[220:223], v[128:131], v[92:95]
    v_add_f32 v244, v244, v84
    v_add_f32 v245, v245, v85
    v_add_f32 v246, v246, v86
    v_add_f32 v247, v247, v87
    v_cvt_pk_bf16_f32 v50, v244, v245
    v_cvt_pk_bf16_f32 v51, v246, v247
    s_nop 0
    v_permlane16_swap_b32 v48, v50
    v_permlane16_swap_b32 v49, v51
    v_cvt_pk_bf16_f32 v56, v88, v89
    v_cvt_pk_bf16_f32 v57, v90, v91
    v_lshlrev_b32 v88, 16, v56
    v_and_b32 v89, s12, v56
    v_lshlrev_b32 v90, 16, v57
    v_and_b32 v91, s12, v57
    v_add_f32 v248, v248, v88
    v_add_f32 v249, v249, v89
    v_add_f32 v250, v250, v90
    v_add_f32 v251, v251, v91
    v_cvt_pk_bf16_f32 v52, v248, v249
    v_cvt_pk_bf16_f32 v53, v250, v251
    v_cvt_pk_bf16_f32 v56, v92, v93
    v_cvt_pk_bf16_f32 v57, v94, v95
    v_lshlrev_b32 v92, 16, v56
    v_and_b32 v93, s12, v56
    v_lshlrev_b32 v94, 16, v57
    v_and_b32 v95, s12, v57
    v_add_f32 v252, v252, v92
    v_add_f32 v253, v253, v93
    v_add_f32 v254, v254, v94
    v_add_f32 v255, v255, v95
    v_cvt_pk_bf16_f32 v54, v252, v253
    v_cvt_pk_bf16_f32 v55, v254, v255
    s_nop 0
    v_permlane16_swap_b32 v52, v54
    v_permlane16_swap_b32 v53, v55
    buffer_store_dwordx4 v[40:43], v22, s[84:87], 0 offen offset:0 sc1
    buffer_store_dwordx4 v[44:47], v22, s[84:87], 0 offen offset:1024 sc1
    buffer_store_dwordx4 v[48:51], v22, s[84:87], 0 offen offset:2048 sc1
    buffer_store_dwordx4 v[52:55], v22, s[84:87], 0 offen offset:3072 sc1
    v_lshrrev_b32 v8, 4, v1
    s_lshl_b32 s8, s3, 4
    v_add_u32 v8, s8, v8
    v_and_b32 v11, 15, v1
    s_lshl_b32 s9, s5, 11
    s_add_u32 s9, s9, 0x28000
    v_lshl_add_u32 v10, v11, 7, s9
    v_lshlrev_b32 v11, 4, v11
    v_mul_u32_u24 v9, 272, v8
    v_add_u32 v9, v9, v11
    s_lshl_b32 s8, s5, 6
    v_add_u32 v8, s8, v8
    v_lshl_add_u32 v8, v8, 12, v11
    s_lshl_b32 s8, s4, 8
    v_add_u32 v8, s8, v8
    s_mov_b32 s64, s16
    s_mov_b32 s65, s17
    s_mov_b32 s66, 0x400000
    s_mov_b32 s67, 0x20000
    s_lshl_b32 s8, s4, 2
    s_add_u32 s8, s8, s3
    s_lshl_b32 s8, s8, 5
    v_lshrrev_b32 v12, 3, v1
    v_add_u32 v12, s8, v12
    v_lshlrev_b32 v12, 11, v12
    v_and_b32 v11, 7, v1
    v_lshl_add_u32 v12, v11, 4, v12
    s_lshl_b32 s8, s5, 7
    v_add_u32 v12, s8, v12
    s_waitcnt vmcnt(8)
    s_barrier
    s_cmp_le_u32 s15, 1
    s_cselect_b32 s11, 2, 1
    s_lshl_b32 s11, s11, 7
    s_add_u32 s99, s11, s91
    s_add_u32 m0, s10, 0x0
    s_nop 0
    buffer_load_dwordx4 v28, s[56:59], s99 offen offset:0 lds
    buffer_load_dwordx4 v29, s[56:59], s99 offen offset:1024 lds
    s_add_u32 s11, s11, s90
    s_add_u32 m0, s10, 0x2000
    s_nop 0
    buffer_load_dwordx4 v28, s[56:59], s11 offen offset:0 lds
    buffer_load_dwordx4 v29, s[56:59], s11 offen offset:1024 lds
    s_waitcnt vmcnt(8)
    s_barrier
    s_cmp_le_u32 s15, 1
    s_cselect_b32 s11, 2, 1
    s_lshl_b32 s11, s11, 7
    s_add_u32 s99, s11, s91
    s_add_u32 m0, s10, 0x4000
    s_nop 0
    buffer_load_dwordx4 v28, s[60:63], s99 offen offset:0 lds
    buffer_load_dwordx4 v29, s[60:63], s99 offen offset:1024 lds
    s_add_u32 s11, s11, s90
    s_add_u32 m0, s10, 0x6000
    s_nop 0
    buffer_load_dwordx4 v28, s[60:63], s11 offen offset:0 lds
    buffer_load_dwordx4 v29, s[60:63], s11 offen offset:1024 lds
    s_waitcnt vmcnt(4)
    s_barrier
    s_cmp_le_u32 s15, 2
    s_cselect_b32 s11, 3, 2
    s_lshl_b32 s11, s11, 7
    s_add_u32 s99, s11, s91
    s_add_u32 m0, s10, 0x8000
    s_nop 0
    buffer_load_dwordx4 v28, s[56:59], s99 offen offset:0 lds
    buffer_load_dwordx4 v29, s[56:59], s99 offen offset:1024 lds
    s_add_u32 s11, s11, s90
    s_add_u32 m0, s10, 0xa000
    s_nop 0
    buffer_load_dwordx4 v28, s[56:59], s11 offen offset:0 lds
    buffer_load_dwordx4 v29, s[56:59], s11 offen offset:1024 lds
    s_waitcnt vmcnt(4)
    s_barrier
    s_cmp_le_u32 s15, 2
    s_cselect_b32 s11, 3, 2
    s_lshl_b32 s11, s11, 7
    s_add_u32 s99, s11, s91
    s_add_u32 m0, s10, 0xc000
    s_nop 0
    buffer_load_dwordx4 v28, s[60:63], s99 offen offset:0 lds
    buffer_load_dwordx4 v29, s[60:63], s99 offen offset:1024 lds
    s_add_u32 s11, s11, s90
    s_add_u32 m0, s10, 0xe000
    s_nop 0
    buffer_load_dwordx4 v28, s[60:63], s11 offen offset:0 lds
    buffer_load_dwordx4 v29, s[60:63], s11 offen offset:1024 lds
    s_waitcnt vmcnt(4)
    s_barrier
    s_cmp_le_u32 s15, 3
    s_cselect_b32 s11, 4, 3
    s_lshl_b32 s11, s11, 7
    s_add_u32 s99, s11, s91
    s_add_u32 m0, s10, 0x0
    s_nop 0
    buffer_load_dwordx4 v28, s[56:59], s99 offen offset:0 lds
    buffer_load_dwordx4 v29, s[56:59], s99 offen offset:1024 lds
    s_add_u32 s11, s11, s90
    s_add_u32 m0, s10, 0x2000
    s_nop 0
    buffer_load_dwordx4 v28, s[56:59], s11 offen offset:0 lds
    buffer_load_dwordx4 v29, s[56:59], s11 offen offset:1024 lds
    s_mov_b64 exec, 1
    ds_add_rtn_u32 v62, v60, v61 offset:4
    s_mov_b64 exec, -1
    s_waitcnt lgkmcnt(0)
    v_readfirstlane_b32 s83, v62
    s_nop 1
    s_cmp_lg_u32 s83, 3
    s_cbranch_scc1 h_noy
    buffer_store_dword v61, v31, s[92:95], 0 offen sc1
h_noy:
    s_waitcnt vmcnt(4)
    s_barrier
    s_cmp_le_u32 s15, 3
    s_cselect_b32 s11, 4, 3
    s_lshl_b32 s11, s11, 7
    s_add_u32 s99, s11, s91
    s_add_u32 m0, s10, 0x4000
    s_nop 0
    buffer_load_dwordx4 v28, s[60:63], s99 offen offset:0 lds
    buffer_load_dwordx4 v29, s[60:63], s99 offen offset:1024 lds
    s_add_u32 s11, s11, s90
    s_add_u32 m0, s10, 0x6000
    s_nop 0
    buffer_load_dwordx4 v28, s[60:63], s11 offen offset:0 lds
    buffer_load_dwordx4 v29, s[60:63], s11 offen offset:1024 lds
    s_waitcnt vmcnt(4)
    s_barrier
    s_cmp_le_u32 s15, 4
    s_cselect_b32 s11, 5, 4
    s_lshl_b32 s11, s11, 7
    s_add_u32 s99, s11, s91
    s_add_u32 m0, s10, 0x8000
    s_nop 0
    buffer_load_dwordx4 v28, s[56:59], s99 offen offset:0 lds
    buffer_load_dwordx4 v29, s[56:59], s99 offen offset:1024 lds
    s_add_u32 s11, s11, s90
    s_add_u32 m0, s10, 0xa000
    s_nop 0
    buffer_load_dwordx4 v28, s[56:59], s11 offen offset:0 lds
    buffer_load_dwordx4 v29, s[56:59], s11 offen offset:1024 lds
    s_add_u32 m0, s82, 0
    s_mov_b32 s8, 0
    buffer_load_dwordx4 v12, s[64:67], s8 offen lds
    s_add_u32 m0, s82, 1024
    s_mov_b32 s8, 16384
    buffer_load_dwordx4 v12, s[64:67], s8 offen lds
    s_add_u32 m0, s82, 2048
    s_mov_b32 s8, 32768
    buffer_load_dwordx4 v12, s[64:67], s8 offen lds
    s_add_u32 m0, s82, 3072
    s_mov_b32 s8, 49152
    buffer_load_dwordx4 v12, s[64:67], s8 offen lds
    s_waitcnt vmcnt(8)
    s_barrier
    s_cmp_le_u32 s15, 4
    s_cselect_b32 s11, 5, 4
    s_lshl_b32 s11, s11, 7
    s_add_u32 s99, s11, s91
    s_add_u32 m0, s10, 0xc000
    s_nop 0
    buffer_load_dwordx4 v28, s[60:63], s99 offen offset:0 lds
    buffer_load_dwordx4 v29, s[60:63], s99 offen offset:1024 lds
    s_add_u32 s11, s11, s90
    s_add_u32 m0, s10, 0xe000
    s_nop 0
    buffer_load_dwordx4 v28, s[60:63], s11 offen offset:0 lds
    buffer_load_dwordx4 v29, s[60:63], s11 offen offset:1024 lds
    buffer_load_dword v19, v10, s[92:95], 0 offen sc1
    s_waitcnt vmcnt(9)
    s_barrier
    s_cmp_le_u32 s15, 5
    s_cselect_b32 s11, 6, 5
    s_lshl_b32 s11, s11, 7
    s_add_u32 s99, s11, s91
    s_add_u32 m0, s10, 0x0
    s_nop 0
    buffer_load_dwordx4 v28, s[56:59], s99 offen offset:0 lds
    buffer_load_dwordx4 v29, s[56:59], s99 offen offset:1024 lds
    s_add_u32 s11, s11, s90
    s_add_u32 m0, s10, 0x2000
    s_nop 0
    buffer_load_dwordx4 v28, s[56:59], s11 offen offset:0 lds
    buffer_load_dwordx4 v29, s[56:59], s11 offen offset:1024 lds
    s_waitcnt vmcnt(5)
    s_barrier
    s_cmp_le_u32 s15, 5
    s_cselect_b32 s11, 6, 5
    s_lshl_b32 s11, s11, 7
    s_add_u32 s99, s11, s91
    s_add_u32 m0, s10, 0x4000
    s_nop 0
    buffer_load_dwordx4 v28, s[60:63], s99 offen offset:0 lds
    buffer_load_dwordx4 v29, s[60:63], s99 offen offset:1024 lds
    s_add_u32 s11, s11, s90
    s_add_u32 m0, s10, 0x6000
    s_nop 0
    buffer_load_dwordx4 v28, s[60:63], s11 offen offset:0 lds
    buffer_load_dwordx4 v29, s[60:63], s11 offen offset:1024 lds
    s_waitcnt vmcnt(8)
    s_mov_b32 s89, 65536
h_yf_chk:
    v_cmp_ne_u32 vcc, 1, v19
    s_nop 1
    s_cmp_eq_u64 vcc, 0
    s_cbranch_scc1 h_yf_ok
    s_sub_u32 s89, s89, 1
    s_cbranch_scc1 h_yf_ok
    s_sleep 4
    buffer_load_dword v19, v10, s[92:95], 0 offen sc1
    s_waitcnt vmcnt(0)
    s_branch h_yf_chk
h_yf_ok:
    s_mov_b32 s8, 0
    buffer_load_dwordx4 v[116:119], v8, s[68:71], s8 offen sc1
    s_mov_b32 s8, 16384
    buffer_load_dwordx4 v[120:123], v8, s[68:71], s8 offen sc1
    s_mov_b32 s8, 32768
    buffer_load_dwordx4 v[124:127], v8, s[68:71], s8 offen sc1
    s_mov_b32 s8, 49152
    buffer_load_dwordx4 v[128:131], v8, s[68:71], s8 offen sc1
    s_waitcnt vmcnt(8)
    s_barrier
    s_cmp_le_u32 s15, 6
    s_cselect_b32 s11, 7, 6
    s_lshl_b32 s11, s11, 7
    s_add_u32 s99, s11, s91
    s_add_u32 m0, s10, 0x8000
    s_nop 0
    buffer_load_dwordx4 v28, s[56:59], s99 offen offset:0 lds
    buffer_load_dwordx4 v29, s[56:59], s99 offen offset:1024 lds
    s_add_u32 s11, s11, s90
    s_add_u32 m0, s10, 0xa000
    s_nop 0
    buffer_load_dwordx4 v28, s[56:59], s11 offen offset:0 lds
    buffer_load_dwordx4 v29, s[56:59], s11 offen offset:1024 lds
    s_waitcnt vmcnt(8)
    s_barrier
    s_cmp_le_u32 s15, 6
    s_cselect_b32 s11, 7, 6
    s_lshl_b32 s11, s11, 7
    s_add_u32 s99, s11, s91
    s_add_u32 m0, s10, 0xc000
    s_nop 0
    buffer_load_dwordx4 v28, s[60:63], s99 offen offset:0 lds
    buffer_load_dwordx4 v29, s[60:63], s99 offen offset:1024 lds
    s_add_u32 s11, s11, s90
    s_add_u32 m0, s10, 0xe000
    s_nop 0
    buffer_load_dwordx4 v28, s[60:63], s11 offen offset:0 lds
    buffer_load_dwordx4 v29, s[60:63], s11 offen offset:1024 lds
    s_waitcnt vmcnt(8)
    ds_write_b128 v9, v[116:119] offset:0
    ds_write_b128 v9, v[120:123] offset:1088
    ds_write_b128 v9, v[124:127] offset:2176
    ds_write_b128 v9, v[128:131] offset:3264
    s_waitcnt lgkmcnt(0)
    s_waitcnt vmcnt(4)
    s_barrier
    s_waitcnt vmcnt(0)
    s_barrier
    s_endpgm
L_consumer:
    s_setprio 2
    s_and_b32 s6, s3, 1
    s_lshr_b32 s7, s3, 1
    v_and_b32 v4, 31, v1
    s_lshl_b32 s8, s5, 6
    s_lshl_b32 s9, s7, 5
    s_add_u32 s8, s8, s9
    v_add_u32 v3, s8, v4
    v_lshlrev_b32 v5, 1, v3
    v_lshrrev_b32 v6, 5, v1
    s_lshl_b32 s10, s4, 1
    s_add_u32 s10, s10, s6
    s_getpc_b64 s[12:13]
c_pc:
    s_sub_u32 s12, s12, c_pc-gated_mix__ssm_conv_s5__ssm_conv_h3__prompt_kernel
    s_subb_u32 s13, s13, 0
    s_lshl_b32 s11, s3, 14
    v_lshl_add_u32 v24, v1, 7, s11
    v_min_u32 v24, 0x89c8, v24
    global_load_dword v25, v24, s[12:13]
    v_add_u32 v24, 0x2000, v24
    v_min_u32 v24, 0x89c8, v24
    global_load_dword v26, v24, s[12:13]
    s_waitcnt lgkmcnt(0)
    global_load_ushort v8, v5, s[18:19]
    global_load_ushort v9, v5, s[20:21]
    global_load_ushort v10, v5, s[30:31]
    s_add_u32 s56, s52, 0x1100000
    s_addc_u32 s57, s53, 0
    s_mov_b32 s58, 0x40000
    s_mov_b32 s59, 0x20000
    s_mov_b32 s60, s52
    s_mov_b32 s61, s53
    s_mov_b32 s62, 0x800000
    s_mov_b32 s63, 0x20000
    s_mov_b32 s64, s50
    s_mov_b32 s65, s51
    s_mov_b32 s66, 0x100
    s_mov_b32 s67, 0x20000
    s_add_u32 s68, s52, 0x1200000
    s_addc_u32 s69, s53, 0
    s_mov_b32 s70, 0x50000
    s_mov_b32 s71, 0x20000
    s_lshl_b32 s11, s10, 13
    v_lshl_add_u32 v7, v3, 3, s11
    v_mov_b32 v12, 0
    v_mov_b32 v13, 0
    buffer_store_dwordx2 v[12:13], v7, s[56:59], 0 offen sc1
    s_lshl_b32 s11, s10, 4
    s_add_u32 s11, s11, s5
    s_lshl_b32 s11, s11, 1
    s_add_u32 s11, s11, s7
    s_lshl_b32 s11, s11, 7
    v_mov_b32 v60, s11
    buffer_store_dword v12, v60, s[68:71], 0 offen sc1
    s_lshl_b32 s72, s4, 4
    s_add_u32 s72, s72, s5
    s_lshl_b32 s72, s72, 2
    s_add_u32 s72, s72, s3
    s_lshl_b32 s72, s72, 7
    s_add_u32 s11, s72, 0x30000
    v_mov_b32 v30, s11
    buffer_store_dword v12, v30, s[68:71], 0 offen sc1
    v_mov_b32 v23, 1
    v_bfe_u32 v11, v1, 1, 3
    v_xor_b32 v11, v11, v6
    s_lshl_b32 s11, s6, 13
    v_lshl_add_u32 v14, v4, 7, s11
    s_lshl_b32 s11, s7, 12
    s_add_u32 s11, s11, 16384
    v_lshl_add_u32 v15, v4, 7, s11
    v_xor_b32 v16, 0, v11
    v_lshl_add_u32 v160, v16, 4, v14
    v_lshl_add_u32 v168, v16, 4, v15
    v_add_u32 v164, 0x10000, v160
    v_add_u32 v172, 0x10000, v168
    v_xor_b32 v16, 2, v11
    v_lshl_add_u32 v161, v16, 4, v14
    v_lshl_add_u32 v169, v16, 4, v15
    v_add_u32 v165, 0x10000, v161
    v_add_u32 v173, 0x10000, v169
    v_xor_b32 v16, 4, v11
    v_lshl_add_u32 v162, v16, 4, v14
    v_lshl_add_u32 v170, v16, 4, v15
    v_add_u32 v166, 0x10000, v162
    v_add_u32 v174, 0x10000, v170
    v_xor_b32 v16, 6, v11
    v_lshl_add_u32 v163, v16, 4, v14
    v_lshl_add_u32 v171, v16, 4, v15
    v_add_u32 v167, 0x10000, v163
    v_add_u32 v175, 0x10000, v171
    v_lshlrev_b32 v21, 2, v1
    s_waitcnt vmcnt(0)
    v_lshlrev_b32 v8, 16, v8
    v_lshlrev_b32 v9, 16, v9
    v_lshlrev_b32 v10, 16, v10
    s_mov_b32 s12, 0x3fb8aa3b
    v_mul_f32 v10, s12, v10
    v_exp_f32 v10, v10
    s_nop 0
    v_cvt_pk_bf16_f32 v10, v10, v10
    v_lshlrev_b32 v10, 16, v10
    v_mul_f32 v16, v10, v8
    v_mul_f32 v17, v10, v9
    v_mul_f32 v16, s12, v16
    v_exp_f32 v16, v16
    v_mul_f32 v17, 0.15915494, v17
    v_rndne_f32 v18, v17
    v_sub_f32 v17, v17, v18
    v_cos_f32 v18, v17
    v_sin_f32 v19, v17
    v_mul_f32 v176, v16, v18
    v_mul_f32 v177, v16, v19
    v_add_f32 v16, -1.0, v176
    v_mul_f32 v17, v8, v8
    v_fma_f32 v17, v9, v9, v17
    v_rcp_f32 v17, v17
    v_mul_f32 v18, v16, v8
    v_fma_f32 v18, v177, v9, v18
    v_mul_f32 v19, v177, v8
    v_fma_f32 v19, -v16, v9, v19
    v_add_f32 v17, v17, v17
    v_mul_f32 v178, v18, v17
    v_mul_f32 v179, v19, v17
    v_mul_f32 v16, v176, v176
    v_mul_f32 v17, v176, v177
    v_fma_f32 v16, -v177, v177, v16
    v_fma_f32 v17, v177, v176, v17
    v_mul_f32 v18, v16, v16
    v_mul_f32 v19, v16, v17
    v_fma_f32 v18, -v17, v17, v18
    v_fma_f32 v19, v17, v16, v19
    v_mul_f32 v16, v18, v18
    v_mul_f32 v17, v18, v19
    v_fma_f32 v16, -v19, v19, v16
    v_fma_f32 v17, v19, v18, v17
    v_mul_f32 v180, v16, v16
    v_mul_f32 v181, v16, v17
    v_fma_f32 v180, -v17, v17, v180
    v_fma_f32 v181, v17, v16, v181
    v_mul_f32 v182, v180, v180
    v_mul_f32 v183, v180, v181
    v_fma_f32 v182, -v181, v181, v182
    v_fma_f32 v183, v181, v180, v183
    v_mul_f32 v184, v182, v182
    v_mul_f32 v185, v182, v183
    v_fma_f32 v184, -v183, v183, v184
    v_fma_f32 v185, v183, v182, v185
    v_mul_f32 v186, v184, v184
    v_mul_f32 v187, v184, v185
    v_fma_f32 v186, -v185, v185, v186
    v_fma_f32 v187, v185, v184, v187
    v_mul_f32 v48, v178, v182
    v_mul_f32 v49, v178, v183
    v_fma_f32 v48, -v179, v183, v48
    v_fma_f32 v49, v179, v182, v49
    v_cmp_lt_u32 vcc, 31, v1
    s_nop 1
    v_cndmask_b32 v48, v178, v48, vcc
    v_cndmask_b32 v49, v179, v49, vcc
    v_lshlrev_b32 v50, 13, v6
    v_sub_u32 v50, v7, v50
    s_add_u32 s11, s10, 1
    v_sub_u32 v51, s11, v6
    v_lshrrev_b32 v51, 1, v51
    s_barrier
    s_cmp_lg_u32 s3, 0
    s_cbranch_scc1 c_noflag
    s_lshr_b32 s11, s2, 6
    s_lshl_b32 s11, 1, s11
    s_getreg_b32 s12, hwreg(HW_REG_XCC_ID, 0, 4)
    s_lshl_b32 s12, 0x100, s12
    s_or_b32 s11, s11, s12
    v_mov_b32 v16, s11
    s_and_b32 s11, s2, 63
    s_lshl_b32 s11, s11, 2
    v_mov_b32 v17, s11
    s_mov_b64 exec, 1
    buffer_atomic_or v16, v17, s[64:67], 0 offen sc1
    s_mov_b64 exec, -1
c_noflag:
    ds_read_b128 v[128:131], v160 offset:0
    ds_read_b128 v[144:147], v168 offset:0
    ds_read_b128 v[132:135], v160 offset:4096
    ds_read_b128 v[148:151], v168 offset:8192
    s_waitcnt lgkmcnt(2)
    v_mfma_f32_32x32x16_bf16 v[64:79], v[128:131], v[144:147], 0
    ds_read_b128 v[136:139], v161 offset:0
    s_waitcnt lgkmcnt(2)
    v_mfma_f32_32x32x16_bf16 v[80:95], v[132:135], v[144:147], 0
    ds_read_b128 v[152:155], v169 offset:0
    s_waitcnt lgkmcnt(2)
    v_mfma_f32_32x32x16_bf16 v[112:127], v[132:135], v[148:151], 0
    ds_read_b128 v[140:143], v161 offset:4096
    v_mfma_f32_32x32x16_bf16 v[96:111], v[128:131], v[148:151], 0
    ds_read_b128 v[156:159], v169 offset:8192
    s_waitcnt lgkmcnt(2)
    v_mfma_f32_32x32x16_bf16 v[64:79], v[136:139], v[152:155], v[64:79]
    ds_read_b128 v[128:131], v162 offset:0
    s_waitcnt lgkmcnt(2)
    v_mfma_f32_32x32x16_bf16 v[80:95], v[140:143], v[152:155], v[80:95]
    ds_read_b128 v[144:147], v170 offset:0
    s_waitcnt lgkmcnt(2)
    v_mfma_f32_32x32x16_bf16 v[112:127], v[140:143], v[156:159], v[112:127]
    ds_read_b128 v[132:135], v162 offset:4096
    v_mfma_f32_32x32x16_bf16 v[96:111], v[136:139], v[156:159], v[96:111]
    ds_read_b128 v[148:151], v170 offset:8192
    s_waitcnt lgkmcnt(2)
    v_mfma_f32_32x32x16_bf16 v[64:79], v[128:131], v[144:147], v[64:79]
    ds_read_b128 v[136:139], v163 offset:0
    s_waitcnt lgkmcnt(2)
    v_mfma_f32_32x32x16_bf16 v[80:95], v[132:135], v[144:147], v[80:95]
    ds_read_b128 v[152:155], v171 offset:0
    s_waitcnt lgkmcnt(2)
    v_mfma_f32_32x32x16_bf16 v[112:127], v[132:135], v[148:151], v[112:127]
    ds_read_b128 v[140:143], v163 offset:4096
    v_mfma_f32_32x32x16_bf16 v[96:111], v[128:131], v[148:151], v[96:111]
    ds_read_b128 v[156:159], v171 offset:8192
    s_waitcnt lgkmcnt(0)
    s_barrier
    v_mfma_f32_32x32x16_bf16 v[64:79], v[136:139], v[152:155], v[64:79]
    ds_read_b128 v[128:131], v160 offset:32768
    v_mfma_f32_32x32x16_bf16 v[80:95], v[140:143], v[152:155], v[80:95]
    ds_read_b128 v[144:147], v168 offset:32768
    v_mfma_f32_32x32x16_bf16 v[112:127], v[140:143], v[156:159], v[112:127]
    ds_read_b128 v[132:135], v160 offset:36864
    v_mfma_f32_32x32x16_bf16 v[96:111], v[136:139], v[156:159], v[96:111]
    ds_read_b128 v[148:151], v168 offset:40960
    s_waitcnt lgkmcnt(2)
    v_mfma_f32_32x32x16_bf16 v[64:79], v[128:131], v[144:147], v[64:79]
    ds_read_b128 v[136:139], v161 offset:32768
    s_waitcnt lgkmcnt(2)
    v_mfma_f32_32x32x16_bf16 v[80:95], v[132:135], v[144:147], v[80:95]
    ds_read_b128 v[152:155], v169 offset:32768
    s_waitcnt lgkmcnt(2)
    v_mfma_f32_32x32x16_bf16 v[112:127], v[132:135], v[148:151], v[112:127]
    ds_read_b128 v[140:143], v161 offset:36864
    v_mfma_f32_32x32x16_bf16 v[96:111], v[128:131], v[148:151], v[96:111]
    ds_read_b128 v[156:159], v169 offset:40960
    s_waitcnt lgkmcnt(2)
    v_mfma_f32_32x32x16_bf16 v[64:79], v[136:139], v[152:155], v[64:79]
    ds_read_b128 v[128:131], v162 offset:32768
    s_waitcnt lgkmcnt(2)
    v_mfma_f32_32x32x16_bf16 v[80:95], v[140:143], v[152:155], v[80:95]
    ds_read_b128 v[144:147], v170 offset:32768
    s_waitcnt lgkmcnt(2)
    v_mfma_f32_32x32x16_bf16 v[112:127], v[140:143], v[156:159], v[112:127]
    ds_read_b128 v[132:135], v162 offset:36864
    v_mfma_f32_32x32x16_bf16 v[96:111], v[136:139], v[156:159], v[96:111]
    ds_read_b128 v[148:151], v170 offset:40960
    s_waitcnt lgkmcnt(2)
    v_mfma_f32_32x32x16_bf16 v[64:79], v[128:131], v[144:147], v[64:79]
    ds_read_b128 v[136:139], v163 offset:32768
    s_waitcnt lgkmcnt(2)
    v_mfma_f32_32x32x16_bf16 v[80:95], v[132:135], v[144:147], v[80:95]
    ds_read_b128 v[152:155], v171 offset:32768
    s_waitcnt lgkmcnt(2)
    v_mfma_f32_32x32x16_bf16 v[112:127], v[132:135], v[148:151], v[112:127]
    ds_read_b128 v[140:143], v163 offset:36864
    v_mfma_f32_32x32x16_bf16 v[96:111], v[128:131], v[148:151], v[96:111]
    ds_read_b128 v[156:159], v171 offset:40960
    s_waitcnt lgkmcnt(0)
    s_barrier
    v_mfma_f32_32x32x16_bf16 v[64:79], v[136:139], v[152:155], v[64:79]
    ds_read_b128 v[128:131], v164 offset:0
    v_mfma_f32_32x32x16_bf16 v[80:95], v[140:143], v[152:155], v[80:95]
    ds_read_b128 v[144:147], v172 offset:0
    v_mfma_f32_32x32x16_bf16 v[112:127], v[140:143], v[156:159], v[112:127]
    ds_read_b128 v[132:135], v164 offset:4096
    v_mfma_f32_32x32x16_bf16 v[96:111], v[136:139], v[156:159], v[96:111]
    ds_read_b128 v[148:151], v172 offset:8192
    s_waitcnt lgkmcnt(2)
    v_mfma_f32_32x32x16_bf16 v[64:79], v[128:131], v[144:147], v[64:79]
    ds_read_b128 v[136:139], v165 offset:0
    s_waitcnt lgkmcnt(2)
    v_mfma_f32_32x32x16_bf16 v[80:95], v[132:135], v[144:147], v[80:95]
    ds_read_b128 v[152:155], v173 offset:0
    s_waitcnt lgkmcnt(2)
    v_mfma_f32_32x32x16_bf16 v[112:127], v[132:135], v[148:151], v[112:127]
    ds_read_b128 v[140:143], v165 offset:4096
    v_mfma_f32_32x32x16_bf16 v[96:111], v[128:131], v[148:151], v[96:111]
    ds_read_b128 v[156:159], v173 offset:8192
    s_waitcnt lgkmcnt(2)
    v_mfma_f32_32x32x16_bf16 v[64:79], v[136:139], v[152:155], v[64:79]
    ds_read_b128 v[128:131], v166 offset:0
    s_waitcnt lgkmcnt(2)
    v_mfma_f32_32x32x16_bf16 v[80:95], v[140:143], v[152:155], v[80:95]
    ds_read_b128 v[144:147], v174 offset:0
    s_waitcnt lgkmcnt(2)
    v_mfma_f32_32x32x16_bf16 v[112:127], v[140:143], v[156:159], v[112:127]
    ds_read_b128 v[132:135], v166 offset:4096
    v_mfma_f32_32x32x16_bf16 v[96:111], v[136:139], v[156:159], v[96:111]
    ds_read_b128 v[148:151], v174 offset:8192
    s_waitcnt lgkmcnt(2)
    v_mfma_f32_32x32x16_bf16 v[64:79], v[128:131], v[144:147], v[64:79]
    ds_read_b128 v[136:139], v167 offset:0
    s_waitcnt lgkmcnt(2)
    v_mfma_f32_32x32x16_bf16 v[80:95], v[132:135], v[144:147], v[80:95]
    ds_read_b128 v[152:155], v175 offset:0
    s_waitcnt lgkmcnt(2)
    v_mfma_f32_32x32x16_bf16 v[112:127], v[132:135], v[148:151], v[112:127]
    ds_read_b128 v[140:143], v167 offset:4096
    v_mfma_f32_32x32x16_bf16 v[96:111], v[128:131], v[148:151], v[96:111]
    ds_read_b128 v[156:159], v175 offset:8192
    s_waitcnt lgkmcnt(0)
    s_barrier
    v_mfma_f32_32x32x16_bf16 v[64:79], v[136:139], v[152:155], v[64:79]
    ds_read_b128 v[128:131], v160 offset:0
    v_mfma_f32_32x32x16_bf16 v[80:95], v[140:143], v[152:155], v[80:95]
    ds_read_b128 v[144:147], v168 offset:0
    v_mfma_f32_32x32x16_bf16 v[112:127], v[140:143], v[156:159], v[112:127]
    ds_read_b128 v[132:135], v160 offset:4096
    v_mfma_f32_32x32x16_bf16 v[96:111], v[136:139], v[156:159], v[96:111]
    ds_read_b128 v[148:151], v168 offset:8192
    s_waitcnt lgkmcnt(2)
    v_mfma_f32_32x32x16_bf16 v[64:79], v[128:131], v[144:147], v[64:79]
    ds_read_b128 v[136:139], v161 offset:0
    s_waitcnt lgkmcnt(2)
    v_mfma_f32_32x32x16_bf16 v[80:95], v[132:135], v[144:147], v[80:95]
    ds_read_b128 v[152:155], v169 offset:0
    s_waitcnt lgkmcnt(2)
    v_mfma_f32_32x32x16_bf16 v[112:127], v[132:135], v[148:151], v[112:127]
    ds_read_b128 v[140:143], v161 offset:4096
    v_mfma_f32_32x32x16_bf16 v[96:111], v[128:131], v[148:151], v[96:111]
    ds_read_b128 v[156:159], v169 offset:8192
    s_waitcnt lgkmcnt(2)
    v_mfma_f32_32x32x16_bf16 v[64:79], v[136:139], v[152:155], v[64:79]
    ds_read_b128 v[128:131], v162 offset:0
    s_waitcnt lgkmcnt(2)
    v_mfma_f32_32x32x16_bf16 v[80:95], v[140:143], v[152:155], v[80:95]
    ds_read_b128 v[144:147], v170 offset:0
    s_waitcnt lgkmcnt(2)
    v_mfma_f32_32x32x16_bf16 v[112:127], v[140:143], v[156:159], v[112:127]
    ds_read_b128 v[132:135], v162 offset:4096
    v_mfma_f32_32x32x16_bf16 v[96:111], v[136:139], v[156:159], v[96:111]
    ds_read_b128 v[148:151], v170 offset:8192
    s_waitcnt lgkmcnt(2)
    v_mfma_f32_32x32x16_bf16 v[64:79], v[128:131], v[144:147], v[64:79]
    ds_read_b128 v[136:139], v163 offset:0
    s_waitcnt lgkmcnt(2)
    v_mfma_f32_32x32x16_bf16 v[80:95], v[132:135], v[144:147], v[80:95]
    ds_read_b128 v[152:155], v171 offset:0
    s_waitcnt lgkmcnt(2)
    v_mfma_f32_32x32x16_bf16 v[112:127], v[132:135], v[148:151], v[112:127]
    ds_read_b128 v[140:143], v163 offset:4096
    v_mfma_f32_32x32x16_bf16 v[96:111], v[128:131], v[148:151], v[96:111]
    ds_read_b128 v[156:159], v171 offset:8192
    s_waitcnt lgkmcnt(0)
    s_barrier
    v_mfma_f32_32x32x16_bf16 v[64:79], v[136:139], v[152:155], v[64:79]
    ds_read_b128 v[128:131], v160 offset:32768
    v_mfma_f32_32x32x16_bf16 v[80:95], v[140:143], v[152:155], v[80:95]
    ds_read_b128 v[144:147], v168 offset:32768
    v_mfma_f32_32x32x16_bf16 v[112:127], v[140:143], v[156:159], v[112:127]
    ds_read_b128 v[132:135], v160 offset:36864
    v_mfma_f32_32x32x16_bf16 v[96:111], v[136:139], v[156:159], v[96:111]
    ds_read_b128 v[148:151], v168 offset:40960
    s_waitcnt lgkmcnt(2)
    v_mfma_f32_32x32x16_bf16 v[64:79], v[128:131], v[144:147], v[64:79]
    ds_read_b128 v[136:139], v161 offset:32768
    s_waitcnt lgkmcnt(2)
    v_mfma_f32_32x32x16_bf16 v[80:95], v[132:135], v[144:147], v[80:95]
    ds_read_b128 v[152:155], v169 offset:32768
    s_waitcnt lgkmcnt(2)
    v_mfma_f32_32x32x16_bf16 v[112:127], v[132:135], v[148:151], v[112:127]
    ds_read_b128 v[140:143], v161 offset:36864
    v_mfma_f32_32x32x16_bf16 v[96:111], v[128:131], v[148:151], v[96:111]
    ds_read_b128 v[156:159], v169 offset:40960
    s_waitcnt lgkmcnt(2)
    v_mfma_f32_32x32x16_bf16 v[64:79], v[136:139], v[152:155], v[64:79]
    ds_read_b128 v[128:131], v162 offset:32768
    s_waitcnt lgkmcnt(2)
    v_mfma_f32_32x32x16_bf16 v[80:95], v[140:143], v[152:155], v[80:95]
    ds_read_b128 v[144:147], v170 offset:32768
    s_waitcnt lgkmcnt(2)
    v_mfma_f32_32x32x16_bf16 v[112:127], v[140:143], v[156:159], v[112:127]
    ds_read_b128 v[132:135], v162 offset:36864
    v_mfma_f32_32x32x16_bf16 v[96:111], v[136:139], v[156:159], v[96:111]
    ds_read_b128 v[148:151], v170 offset:40960
    s_waitcnt lgkmcnt(2)
    v_mfma_f32_32x32x16_bf16 v[64:79], v[128:131], v[144:147], v[64:79]
    ds_read_b128 v[136:139], v163 offset:32768
    s_waitcnt lgkmcnt(2)
    v_mfma_f32_32x32x16_bf16 v[80:95], v[132:135], v[144:147], v[80:95]
    ds_read_b128 v[152:155], v171 offset:32768
    s_waitcnt lgkmcnt(2)
    v_mfma_f32_32x32x16_bf16 v[112:127], v[132:135], v[148:151], v[112:127]
    ds_read_b128 v[140:143], v163 offset:36864
    v_mfma_f32_32x32x16_bf16 v[96:111], v[128:131], v[148:151], v[96:111]
    ds_read_b128 v[156:159], v171 offset:40960
    s_waitcnt lgkmcnt(0)
    s_barrier
    v_mfma_f32_32x32x16_bf16 v[64:79], v[136:139], v[152:155], v[64:79]
    ds_read_b128 v[128:131], v164 offset:0
    v_mfma_f32_32x32x16_bf16 v[80:95], v[140:143], v[152:155], v[80:95]
    ds_read_b128 v[144:147], v172 offset:0
    v_mfma_f32_32x32x16_bf16 v[112:127], v[140:143], v[156:159], v[112:127]
    ds_read_b128 v[132:135], v164 offset:4096
    v_mfma_f32_32x32x16_bf16 v[96:111], v[136:139], v[156:159], v[96:111]
    ds_read_b128 v[148:151], v172 offset:8192
    s_waitcnt lgkmcnt(2)
    v_mfma_f32_32x32x16_bf16 v[64:79], v[128:131], v[144:147], v[64:79]
    ds_read_b128 v[136:139], v165 offset:0
    s_waitcnt lgkmcnt(2)
    v_mfma_f32_32x32x16_bf16 v[80:95], v[132:135], v[144:147], v[80:95]
    ds_read_b128 v[152:155], v173 offset:0
    s_waitcnt lgkmcnt(2)
    v_mfma_f32_32x32x16_bf16 v[112:127], v[132:135], v[148:151], v[112:127]
    ds_read_b128 v[140:143], v165 offset:4096
    v_mfma_f32_32x32x16_bf16 v[96:111], v[128:131], v[148:151], v[96:111]
    ds_read_b128 v[156:159], v173 offset:8192
    s_waitcnt lgkmcnt(2)
    v_mfma_f32_32x32x16_bf16 v[64:79], v[136:139], v[152:155], v[64:79]
    ds_read_b128 v[128:131], v166 offset:0
    s_waitcnt lgkmcnt(2)
    v_mfma_f32_32x32x16_bf16 v[80:95], v[140:143], v[152:155], v[80:95]
    ds_read_b128 v[144:147], v174 offset:0
    s_waitcnt lgkmcnt(2)
    v_mfma_f32_32x32x16_bf16 v[112:127], v[140:143], v[156:159], v[112:127]
    ds_read_b128 v[132:135], v166 offset:4096
    v_mfma_f32_32x32x16_bf16 v[96:111], v[136:139], v[156:159], v[96:111]
    ds_read_b128 v[148:151], v174 offset:8192
    s_waitcnt lgkmcnt(2)
    v_mfma_f32_32x32x16_bf16 v[64:79], v[128:131], v[144:147], v[64:79]
    ds_read_b128 v[136:139], v167 offset:0
    s_waitcnt lgkmcnt(2)
    v_mfma_f32_32x32x16_bf16 v[80:95], v[132:135], v[144:147], v[80:95]
    ds_read_b128 v[152:155], v175 offset:0
    s_waitcnt lgkmcnt(2)
    v_mfma_f32_32x32x16_bf16 v[112:127], v[132:135], v[148:151], v[112:127]
    ds_read_b128 v[140:143], v167 offset:4096
    v_mfma_f32_32x32x16_bf16 v[96:111], v[128:131], v[148:151], v[96:111]
    ds_read_b128 v[156:159], v175 offset:8192
    s_waitcnt lgkmcnt(0)
    s_barrier
    v_mfma_f32_32x32x16_bf16 v[64:79], v[136:139], v[152:155], v[64:79]
    ds_read_b128 v[128:131], v160 offset:0
    v_mfma_f32_32x32x16_bf16 v[80:95], v[140:143], v[152:155], v[80:95]
    ds_read_b128 v[144:147], v168 offset:0
    v_mfma_f32_32x32x16_bf16 v[112:127], v[140:143], v[156:159], v[112:127]
    ds_read_b128 v[132:135], v160 offset:4096
    v_mfma_f32_32x32x16_bf16 v[96:111], v[136:139], v[156:159], v[96:111]
    ds_read_b128 v[148:151], v168 offset:8192
    s_waitcnt lgkmcnt(2)
    v_mfma_f32_32x32x16_bf16 v[64:79], v[128:131], v[144:147], v[64:79]
    ds_read_b128 v[136:139], v161 offset:0
    s_waitcnt lgkmcnt(2)
    v_mfma_f32_32x32x16_bf16 v[80:95], v[132:135], v[144:147], v[80:95]
    ds_read_b128 v[152:155], v169 offset:0
    s_waitcnt lgkmcnt(2)
    v_mfma_f32_32x32x16_bf16 v[112:127], v[132:135], v[148:151], v[112:127]
    ds_read_b128 v[140:143], v161 offset:4096
    v_mfma_f32_32x32x16_bf16 v[96:111], v[128:131], v[148:151], v[96:111]
    ds_read_b128 v[156:159], v169 offset:8192
    s_waitcnt lgkmcnt(2)
    v_mfma_f32_32x32x16_bf16 v[64:79], v[136:139], v[152:155], v[64:79]
    ds_read_b128 v[128:131], v162 offset:0
    s_waitcnt lgkmcnt(2)
    v_mfma_f32_32x32x16_bf16 v[80:95], v[140:143], v[152:155], v[80:95]
    ds_read_b128 v[144:147], v170 offset:0
    s_waitcnt lgkmcnt(2)
    v_mfma_f32_32x32x16_bf16 v[112:127], v[140:143], v[156:159], v[112:127]
    ds_read_b128 v[132:135], v162 offset:4096
    v_mfma_f32_32x32x16_bf16 v[96:111], v[136:139], v[156:159], v[96:111]
    ds_read_b128 v[148:151], v170 offset:8192
    s_waitcnt lgkmcnt(2)
    v_mfma_f32_32x32x16_bf16 v[64:79], v[128:131], v[144:147], v[64:79]
    ds_read_b128 v[136:139], v163 offset:0
    s_waitcnt lgkmcnt(2)
    v_mfma_f32_32x32x16_bf16 v[80:95], v[132:135], v[144:147], v[80:95]
    ds_read_b128 v[152:155], v171 offset:0
    s_waitcnt lgkmcnt(2)
    v_mfma_f32_32x32x16_bf16 v[112:127], v[132:135], v[148:151], v[112:127]
    ds_read_b128 v[140:143], v163 offset:4096
    v_mfma_f32_32x32x16_bf16 v[96:111], v[128:131], v[148:151], v[96:111]
    ds_read_b128 v[156:159], v171 offset:8192
    s_waitcnt lgkmcnt(0)
    s_barrier
    v_mfma_f32_32x32x16_bf16 v[64:79], v[136:139], v[152:155], v[64:79]
    ds_read_b128 v[128:131], v160 offset:32768
    v_mfma_f32_32x32x16_bf16 v[80:95], v[140:143], v[152:155], v[80:95]
    ds_read_b128 v[144:147], v168 offset:32768
    v_mfma_f32_32x32x16_bf16 v[112:127], v[140:143], v[156:159], v[112:127]
    ds_read_b128 v[132:135], v160 offset:36864
    v_mfma_f32_32x32x16_bf16 v[96:111], v[136:139], v[156:159], v[96:111]
    ds_read_b128 v[148:151], v168 offset:40960
    s_waitcnt lgkmcnt(2)
    v_mfma_f32_32x32x16_bf16 v[64:79], v[128:131], v[144:147], v[64:79]
    ds_read_b128 v[136:139], v161 offset:32768
    s_waitcnt lgkmcnt(2)
    v_mfma_f32_32x32x16_bf16 v[80:95], v[132:135], v[144:147], v[80:95]
    ds_read_b128 v[152:155], v169 offset:32768
    s_waitcnt lgkmcnt(2)
    v_mfma_f32_32x32x16_bf16 v[112:127], v[132:135], v[148:151], v[112:127]
    ds_read_b128 v[140:143], v161 offset:36864
    v_mfma_f32_32x32x16_bf16 v[96:111], v[128:131], v[148:151], v[96:111]
    ds_read_b128 v[156:159], v169 offset:40960
    s_waitcnt lgkmcnt(2)
    v_mfma_f32_32x32x16_bf16 v[64:79], v[136:139], v[152:155], v[64:79]
    ds_read_b128 v[128:131], v162 offset:32768
    s_waitcnt lgkmcnt(2)
    v_mfma_f32_32x32x16_bf16 v[80:95], v[140:143], v[152:155], v[80:95]
    ds_read_b128 v[144:147], v170 offset:32768
    s_waitcnt lgkmcnt(2)
    v_mfma_f32_32x32x16_bf16 v[112:127], v[140:143], v[156:159], v[112:127]
    ds_read_b128 v[132:135], v162 offset:36864
    v_mfma_f32_32x32x16_bf16 v[96:111], v[136:139], v[156:159], v[96:111]
    ds_read_b128 v[148:151], v170 offset:40960
    s_waitcnt lgkmcnt(2)
    v_mfma_f32_32x32x16_bf16 v[64:79], v[128:131], v[144:147], v[64:79]
    ds_read_b128 v[136:139], v163 offset:32768
    s_waitcnt lgkmcnt(2)
    v_mfma_f32_32x32x16_bf16 v[80:95], v[132:135], v[144:147], v[80:95]
    ds_read_b128 v[152:155], v171 offset:32768
    s_waitcnt lgkmcnt(2)
    v_mfma_f32_32x32x16_bf16 v[112:127], v[132:135], v[148:151], v[112:127]
    ds_read_b128 v[140:143], v163 offset:36864
    v_mfma_f32_32x32x16_bf16 v[96:111], v[128:131], v[148:151], v[96:111]
    ds_read_b128 v[156:159], v171 offset:40960
    s_waitcnt lgkmcnt(0)
    s_barrier
    v_mfma_f32_32x32x16_bf16 v[64:79], v[136:139], v[152:155], v[64:79]
    ds_read_b128 v[128:131], v164 offset:0
    v_mfma_f32_32x32x16_bf16 v[80:95], v[140:143], v[152:155], v[80:95]
    ds_read_b128 v[144:147], v172 offset:0
    v_mfma_f32_32x32x16_bf16 v[112:127], v[140:143], v[156:159], v[112:127]
    ds_read_b128 v[132:135], v164 offset:4096
    v_mfma_f32_32x32x16_bf16 v[96:111], v[136:139], v[156:159], v[96:111]
    ds_read_b128 v[148:151], v172 offset:8192
    s_waitcnt lgkmcnt(2)
    v_mfma_f32_32x32x16_bf16 v[64:79], v[128:131], v[144:147], v[64:79]
    ds_read_b128 v[136:139], v165 offset:0
    s_waitcnt lgkmcnt(2)
    v_mfma_f32_32x32x16_bf16 v[80:95], v[132:135], v[144:147], v[80:95]
    ds_read_b128 v[152:155], v173 offset:0
    s_waitcnt lgkmcnt(2)
    v_mfma_f32_32x32x16_bf16 v[112:127], v[132:135], v[148:151], v[112:127]
    ds_read_b128 v[140:143], v165 offset:4096
    v_mfma_f32_32x32x16_bf16 v[96:111], v[128:131], v[148:151], v[96:111]
    ds_read_b128 v[156:159], v173 offset:8192
    s_waitcnt lgkmcnt(2)
    v_mfma_f32_32x32x16_bf16 v[64:79], v[136:139], v[152:155], v[64:79]
    ds_read_b128 v[128:131], v166 offset:0
    s_waitcnt lgkmcnt(2)
    v_mfma_f32_32x32x16_bf16 v[80:95], v[140:143], v[152:155], v[80:95]
    ds_read_b128 v[144:147], v174 offset:0
    s_waitcnt lgkmcnt(2)
    v_mfma_f32_32x32x16_bf16 v[112:127], v[140:143], v[156:159], v[112:127]
    ds_read_b128 v[132:135], v166 offset:4096
    v_mfma_f32_32x32x16_bf16 v[96:111], v[136:139], v[156:159], v[96:111]
    ds_read_b128 v[148:151], v174 offset:8192
    s_waitcnt lgkmcnt(2)
    v_mfma_f32_32x32x16_bf16 v[64:79], v[128:131], v[144:147], v[64:79]
    ds_read_b128 v[136:139], v167 offset:0
    s_waitcnt lgkmcnt(2)
    v_mfma_f32_32x32x16_bf16 v[80:95], v[132:135], v[144:147], v[80:95]
    ds_read_b128 v[152:155], v175 offset:0
    s_waitcnt lgkmcnt(2)
    v_mfma_f32_32x32x16_bf16 v[112:127], v[132:135], v[148:151], v[112:127]
    ds_read_b128 v[140:143], v167 offset:4096
    v_mfma_f32_32x32x16_bf16 v[96:111], v[128:131], v[148:151], v[96:111]
    ds_read_b128 v[156:159], v175 offset:8192
    s_waitcnt lgkmcnt(0)
    s_barrier
    v_mfma_f32_32x32x16_bf16 v[64:79], v[136:139], v[152:155], v[64:79]
    ds_read_b128 v[128:131], v160 offset:0
    v_mfma_f32_32x32x16_bf16 v[80:95], v[140:143], v[152:155], v[80:95]
    ds_read_b128 v[144:147], v168 offset:0
    v_mfma_f32_32x32x16_bf16 v[112:127], v[140:143], v[156:159], v[112:127]
    ds_read_b128 v[132:135], v160 offset:4096
    v_mfma_f32_32x32x16_bf16 v[96:111], v[136:139], v[156:159], v[96:111]
    ds_read_b128 v[148:151], v168 offset:8192
    s_waitcnt lgkmcnt(2)
    v_mfma_f32_32x32x16_bf16 v[64:79], v[128:131], v[144:147], v[64:79]
    ds_read_b128 v[136:139], v161 offset:0
    s_waitcnt lgkmcnt(2)
    v_mfma_f32_32x32x16_bf16 v[80:95], v[132:135], v[144:147], v[80:95]
    ds_read_b128 v[152:155], v169 offset:0
    s_waitcnt lgkmcnt(2)
    v_mfma_f32_32x32x16_bf16 v[112:127], v[132:135], v[148:151], v[112:127]
    ds_read_b128 v[140:143], v161 offset:4096
    v_mfma_f32_32x32x16_bf16 v[96:111], v[128:131], v[148:151], v[96:111]
    ds_read_b128 v[156:159], v169 offset:8192
    s_waitcnt lgkmcnt(2)
    v_mfma_f32_32x32x16_bf16 v[64:79], v[136:139], v[152:155], v[64:79]
    ds_read_b128 v[128:131], v162 offset:0
    s_waitcnt lgkmcnt(2)
    v_mfma_f32_32x32x16_bf16 v[80:95], v[140:143], v[152:155], v[80:95]
    ds_read_b128 v[144:147], v170 offset:0
    s_waitcnt lgkmcnt(2)
    v_mfma_f32_32x32x16_bf16 v[112:127], v[140:143], v[156:159], v[112:127]
    ds_read_b128 v[132:135], v162 offset:4096
    v_mfma_f32_32x32x16_bf16 v[96:111], v[136:139], v[156:159], v[96:111]
    ds_read_b128 v[148:151], v170 offset:8192
    s_waitcnt lgkmcnt(2)
    v_mfma_f32_32x32x16_bf16 v[64:79], v[128:131], v[144:147], v[64:79]
    ds_read_b128 v[136:139], v163 offset:0
    s_waitcnt lgkmcnt(2)
    v_mfma_f32_32x32x16_bf16 v[80:95], v[132:135], v[144:147], v[80:95]
    ds_read_b128 v[152:155], v171 offset:0
    s_waitcnt lgkmcnt(2)
    v_mfma_f32_32x32x16_bf16 v[112:127], v[132:135], v[148:151], v[112:127]
    ds_read_b128 v[140:143], v163 offset:4096
    v_mfma_f32_32x32x16_bf16 v[96:111], v[128:131], v[148:151], v[96:111]
    ds_read_b128 v[156:159], v171 offset:8192
    s_waitcnt lgkmcnt(0)
    s_barrier
    v_mfma_f32_32x32x16_bf16 v[64:79], v[136:139], v[152:155], v[64:79]
    ds_read_b128 v[128:131], v160 offset:32768
    v_mfma_f32_32x32x16_bf16 v[80:95], v[140:143], v[152:155], v[80:95]
    ds_read_b128 v[144:147], v168 offset:32768
    v_mfma_f32_32x32x16_bf16 v[112:127], v[140:143], v[156:159], v[112:127]
    ds_read_b128 v[132:135], v160 offset:36864
    v_mfma_f32_32x32x16_bf16 v[96:111], v[136:139], v[156:159], v[96:111]
    ds_read_b128 v[148:151], v168 offset:40960
    s_waitcnt lgkmcnt(2)
    v_mfma_f32_32x32x16_bf16 v[64:79], v[128:131], v[144:147], v[64:79]
    ds_read_b128 v[136:139], v161 offset:32768
    s_waitcnt lgkmcnt(2)
    v_mfma_f32_32x32x16_bf16 v[80:95], v[132:135], v[144:147], v[80:95]
    ds_read_b128 v[152:155], v169 offset:32768
    s_waitcnt lgkmcnt(2)
    v_mfma_f32_32x32x16_bf16 v[112:127], v[132:135], v[148:151], v[112:127]
    ds_read_b128 v[140:143], v161 offset:36864
    v_mfma_f32_32x32x16_bf16 v[96:111], v[128:131], v[148:151], v[96:111]
    ds_read_b128 v[156:159], v169 offset:40960
    s_waitcnt lgkmcnt(2)
    v_mfma_f32_32x32x16_bf16 v[64:79], v[136:139], v[152:155], v[64:79]
    ds_read_b128 v[128:131], v162 offset:32768
    s_waitcnt lgkmcnt(2)
    v_mfma_f32_32x32x16_bf16 v[80:95], v[140:143], v[152:155], v[80:95]
    ds_read_b128 v[144:147], v170 offset:32768
    s_waitcnt lgkmcnt(2)
    v_mfma_f32_32x32x16_bf16 v[112:127], v[140:143], v[156:159], v[112:127]
    ds_read_b128 v[132:135], v162 offset:36864
    v_mfma_f32_32x32x16_bf16 v[96:111], v[136:139], v[156:159], v[96:111]
    ds_read_b128 v[148:151], v170 offset:40960
    s_waitcnt lgkmcnt(2)
    v_mfma_f32_32x32x16_bf16 v[64:79], v[128:131], v[144:147], v[64:79]
    ds_read_b128 v[136:139], v163 offset:32768
    s_waitcnt lgkmcnt(2)
    v_mfma_f32_32x32x16_bf16 v[80:95], v[132:135], v[144:147], v[80:95]
    ds_read_b128 v[152:155], v171 offset:32768
    s_waitcnt lgkmcnt(2)
    v_mfma_f32_32x32x16_bf16 v[112:127], v[132:135], v[148:151], v[112:127]
    ds_read_b128 v[140:143], v163 offset:36864
    v_mfma_f32_32x32x16_bf16 v[96:111], v[128:131], v[148:151], v[96:111]
    ds_read_b128 v[156:159], v171 offset:40960
    s_waitcnt lgkmcnt(0)
    s_barrier
    v_mfma_f32_32x32x16_bf16 v[64:79], v[136:139], v[152:155], v[64:79]
    ds_read_b128 v[128:131], v164 offset:0
    v_mfma_f32_32x32x16_bf16 v[80:95], v[140:143], v[152:155], v[80:95]
    ds_read_b128 v[144:147], v172 offset:0
    v_mfma_f32_32x32x16_bf16 v[112:127], v[140:143], v[156:159], v[112:127]
    ds_read_b128 v[132:135], v164 offset:4096
    v_mfma_f32_32x32x16_bf16 v[96:111], v[136:139], v[156:159], v[96:111]
    ds_read_b128 v[148:151], v172 offset:8192
    s_waitcnt lgkmcnt(2)
    v_mfma_f32_32x32x16_bf16 v[64:79], v[128:131], v[144:147], v[64:79]
    ds_read_b128 v[136:139], v165 offset:0
    s_waitcnt lgkmcnt(2)
    v_mfma_f32_32x32x16_bf16 v[80:95], v[132:135], v[144:147], v[80:95]
    ds_read_b128 v[152:155], v173 offset:0
    s_waitcnt lgkmcnt(2)
    v_mfma_f32_32x32x16_bf16 v[112:127], v[132:135], v[148:151], v[112:127]
    ds_read_b128 v[140:143], v165 offset:4096
    v_mfma_f32_32x32x16_bf16 v[96:111], v[128:131], v[148:151], v[96:111]
    ds_read_b128 v[156:159], v173 offset:8192
    s_waitcnt lgkmcnt(2)
    v_mfma_f32_32x32x16_bf16 v[64:79], v[136:139], v[152:155], v[64:79]
    ds_read_b128 v[128:131], v166 offset:0
    s_waitcnt lgkmcnt(2)
    v_mfma_f32_32x32x16_bf16 v[80:95], v[140:143], v[152:155], v[80:95]
    ds_read_b128 v[144:147], v174 offset:0
    s_waitcnt lgkmcnt(2)
    v_mfma_f32_32x32x16_bf16 v[112:127], v[140:143], v[156:159], v[112:127]
    ds_read_b128 v[132:135], v166 offset:4096
    v_mfma_f32_32x32x16_bf16 v[96:111], v[136:139], v[156:159], v[96:111]
    ds_read_b128 v[148:151], v174 offset:8192
    s_waitcnt lgkmcnt(2)
    v_mfma_f32_32x32x16_bf16 v[64:79], v[128:131], v[144:147], v[64:79]
    ds_read_b128 v[136:139], v167 offset:0
    s_waitcnt lgkmcnt(2)
    v_mfma_f32_32x32x16_bf16 v[80:95], v[132:135], v[144:147], v[80:95]
    ds_read_b128 v[152:155], v175 offset:0
    s_waitcnt lgkmcnt(2)
    v_mfma_f32_32x32x16_bf16 v[112:127], v[132:135], v[148:151], v[112:127]
    ds_read_b128 v[140:143], v167 offset:4096
    v_mfma_f32_32x32x16_bf16 v[96:111], v[128:131], v[148:151], v[96:111]
    ds_read_b128 v[156:159], v175 offset:8192
    s_waitcnt lgkmcnt(0)
    s_barrier
    v_mfma_f32_32x32x16_bf16 v[64:79], v[136:139], v[152:155], v[64:79]
    ds_read_b128 v[128:131], v160 offset:0
    v_mfma_f32_32x32x16_bf16 v[80:95], v[140:143], v[152:155], v[80:95]
    ds_read_b128 v[144:147], v168 offset:0
    v_mfma_f32_32x32x16_bf16 v[112:127], v[140:143], v[156:159], v[112:127]
    ds_read_b128 v[132:135], v160 offset:4096
    v_mfma_f32_32x32x16_bf16 v[96:111], v[136:139], v[156:159], v[96:111]
    ds_read_b128 v[148:151], v168 offset:8192
    s_waitcnt lgkmcnt(2)
    v_mfma_f32_32x32x16_bf16 v[64:79], v[128:131], v[144:147], v[64:79]
    ds_read_b128 v[136:139], v161 offset:0
    s_waitcnt lgkmcnt(2)
    v_mfma_f32_32x32x16_bf16 v[80:95], v[132:135], v[144:147], v[80:95]
    ds_read_b128 v[152:155], v169 offset:0
    s_waitcnt lgkmcnt(2)
    v_mfma_f32_32x32x16_bf16 v[112:127], v[132:135], v[148:151], v[112:127]
    ds_read_b128 v[140:143], v161 offset:4096
    v_mfma_f32_32x32x16_bf16 v[96:111], v[128:131], v[148:151], v[96:111]
    ds_read_b128 v[156:159], v169 offset:8192
    buffer_load_dword v20, v21, s[64:67], 0 offen sc1
    s_waitcnt lgkmcnt(2)
    v_mfma_f32_32x32x16_bf16 v[64:79], v[136:139], v[152:155], v[64:79]
    ds_read_b128 v[128:131], v162 offset:0
    s_waitcnt lgkmcnt(2)
    v_mfma_f32_32x32x16_bf16 v[80:95], v[140:143], v[152:155], v[80:95]
    ds_read_b128 v[144:147], v170 offset:0
    s_waitcnt lgkmcnt(2)
    v_mfma_f32_32x32x16_bf16 v[112:127], v[140:143], v[156:159], v[112:127]
    ds_read_b128 v[132:135], v162 offset:4096
    v_mfma_f32_32x32x16_bf16 v[96:111], v[136:139], v[156:159], v[96:111]
    ds_read_b128 v[148:151], v170 offset:8192
    s_waitcnt lgkmcnt(2)
    v_mfma_f32_32x32x16_bf16 v[64:79], v[128:131], v[144:147], v[64:79]
    ds_read_b128 v[136:139], v163 offset:0
    s_waitcnt lgkmcnt(2)
    v_mfma_f32_32x32x16_bf16 v[80:95], v[132:135], v[144:147], v[80:95]
    ds_read_b128 v[152:155], v171 offset:0
    s_waitcnt lgkmcnt(2)
    v_mfma_f32_32x32x16_bf16 v[112:127], v[132:135], v[148:151], v[112:127]
    ds_read_b128 v[140:143], v163 offset:4096
    v_mfma_f32_32x32x16_bf16 v[96:111], v[128:131], v[148:151], v[96:111]
    ds_read_b128 v[156:159], v171 offset:8192
    s_waitcnt lgkmcnt(0)
    s_barrier
    v_mfma_f32_32x32x16_bf16 v[64:79], v[136:139], v[152:155], v[64:79]
    ds_read_b128 v[128:131], v160 offset:32768
    v_mfma_f32_32x32x16_bf16 v[80:95], v[140:143], v[152:155], v[80:95]
    ds_read_b128 v[144:147], v168 offset:32768
    v_mfma_f32_32x32x16_bf16 v[112:127], v[140:143], v[156:159], v[112:127]
    ds_read_b128 v[132:135], v160 offset:36864
    v_mfma_f32_32x32x16_bf16 v[96:111], v[136:139], v[156:159], v[96:111]
    ds_read_b128 v[148:151], v168 offset:40960
    s_waitcnt lgkmcnt(2)
    v_mfma_f32_32x32x16_bf16 v[64:79], v[128:131], v[144:147], v[64:79]
    ds_read_b128 v[136:139], v161 offset:32768
    s_waitcnt lgkmcnt(2)
    v_mfma_f32_32x32x16_bf16 v[80:95], v[132:135], v[144:147], v[80:95]
    ds_read_b128 v[152:155], v169 offset:32768
    s_waitcnt lgkmcnt(2)
    v_mfma_f32_32x32x16_bf16 v[112:127], v[132:135], v[148:151], v[112:127]
    ds_read_b128 v[140:143], v161 offset:36864
    v_mfma_f32_32x32x16_bf16 v[96:111], v[128:131], v[148:151], v[96:111]
    ds_read_b128 v[156:159], v169 offset:40960
    s_waitcnt lgkmcnt(2)
    v_mfma_f32_32x32x16_bf16 v[64:79], v[136:139], v[152:155], v[64:79]
    ds_read_b128 v[128:131], v162 offset:32768
    s_waitcnt lgkmcnt(2)
    v_mfma_f32_32x32x16_bf16 v[80:95], v[140:143], v[152:155], v[80:95]
    ds_read_b128 v[144:147], v170 offset:32768
    s_waitcnt lgkmcnt(2)
    v_mfma_f32_32x32x16_bf16 v[112:127], v[140:143], v[156:159], v[112:127]
    ds_read_b128 v[132:135], v162 offset:36864
    v_mfma_f32_32x32x16_bf16 v[96:111], v[136:139], v[156:159], v[96:111]
    ds_read_b128 v[148:151], v170 offset:40960
    s_waitcnt lgkmcnt(2)
    v_mfma_f32_32x32x16_bf16 v[64:79], v[128:131], v[144:147], v[64:79]
    ds_read_b128 v[136:139], v163 offset:32768
    s_waitcnt lgkmcnt(2)
    v_mfma_f32_32x32x16_bf16 v[80:95], v[132:135], v[144:147], v[80:95]
    ds_read_b128 v[152:155], v171 offset:32768
    s_waitcnt lgkmcnt(2)
    v_mfma_f32_32x32x16_bf16 v[112:127], v[132:135], v[148:151], v[112:127]
    ds_read_b128 v[140:143], v163 offset:36864
    v_mfma_f32_32x32x16_bf16 v[96:111], v[128:131], v[148:151], v[96:111]
    ds_read_b128 v[156:159], v171 offset:40960
    s_waitcnt lgkmcnt(0)
    s_barrier
    v_mfma_f32_32x32x16_bf16 v[64:79], v[136:139], v[152:155], v[64:79]
    ds_read_b128 v[128:131], v164 offset:0
    v_mfma_f32_32x32x16_bf16 v[80:95], v[140:143], v[152:155], v[80:95]
    ds_read_b128 v[144:147], v172 offset:0
    v_mfma_f32_32x32x16_bf16 v[112:127], v[140:143], v[156:159], v[112:127]
    ds_read_b128 v[132:135], v164 offset:4096
    v_mfma_f32_32x32x16_bf16 v[96:111], v[136:139], v[156:159], v[96:111]
    ds_read_b128 v[148:151], v172 offset:8192
    s_waitcnt lgkmcnt(2)
    v_mfma_f32_32x32x16_bf16 v[64:79], v[128:131], v[144:147], v[64:79]
    ds_read_b128 v[136:139], v165 offset:0
    s_waitcnt lgkmcnt(2)
    v_mfma_f32_32x32x16_bf16 v[80:95], v[132:135], v[144:147], v[80:95]
    ds_read_b128 v[152:155], v173 offset:0
    s_waitcnt lgkmcnt(2)
    v_mfma_f32_32x32x16_bf16 v[112:127], v[132:135], v[148:151], v[112:127]
    ds_read_b128 v[140:143], v165 offset:4096
    v_mfma_f32_32x32x16_bf16 v[96:111], v[128:131], v[148:151], v[96:111]
    ds_read_b128 v[156:159], v173 offset:8192
    s_waitcnt lgkmcnt(2)
    v_mfma_f32_32x32x16_bf16 v[64:79], v[136:139], v[152:155], v[64:79]
    ds_read_b128 v[128:131], v166 offset:0
    s_waitcnt lgkmcnt(2)
    v_mfma_f32_32x32x16_bf16 v[80:95], v[140:143], v[152:155], v[80:95]
    ds_read_b128 v[144:147], v174 offset:0
    s_waitcnt lgkmcnt(2)
    v_mfma_f32_32x32x16_bf16 v[112:127], v[140:143], v[156:159], v[112:127]
    ds_read_b128 v[132:135], v166 offset:4096
    v_mfma_f32_32x32x16_bf16 v[96:111], v[136:139], v[156:159], v[96:111]
    ds_read_b128 v[148:151], v174 offset:8192
    s_waitcnt lgkmcnt(2)
    v_mfma_f32_32x32x16_bf16 v[64:79], v[128:131], v[144:147], v[64:79]
    ds_read_b128 v[136:139], v167 offset:0
    s_waitcnt lgkmcnt(2)
    v_mfma_f32_32x32x16_bf16 v[80:95], v[132:135], v[144:147], v[80:95]
    ds_read_b128 v[152:155], v175 offset:0
    s_waitcnt lgkmcnt(2)
    v_mfma_f32_32x32x16_bf16 v[112:127], v[132:135], v[148:151], v[112:127]
    ds_read_b128 v[140:143], v167 offset:4096
    v_mfma_f32_32x32x16_bf16 v[96:111], v[128:131], v[148:151], v[96:111]
    ds_read_b128 v[156:159], v175 offset:8192
    s_waitcnt lgkmcnt(0)
    s_barrier
    v_mfma_f32_32x32x16_bf16 v[64:79], v[136:139], v[152:155], v[64:79]
    ds_read_b128 v[128:131], v160 offset:0
    v_mfma_f32_32x32x16_bf16 v[80:95], v[140:143], v[152:155], v[80:95]
    ds_read_b128 v[144:147], v168 offset:0
    v_mfma_f32_32x32x16_bf16 v[112:127], v[140:143], v[156:159], v[112:127]
    ds_read_b128 v[132:135], v160 offset:4096
    v_mfma_f32_32x32x16_bf16 v[96:111], v[136:139], v[156:159], v[96:111]
    ds_read_b128 v[148:151], v168 offset:8192
    s_waitcnt lgkmcnt(2)
    v_mfma_f32_32x32x16_bf16 v[64:79], v[128:131], v[144:147], v[64:79]
    ds_read_b128 v[136:139], v161 offset:0
    s_waitcnt lgkmcnt(2)
    v_mfma_f32_32x32x16_bf16 v[80:95], v[132:135], v[144:147], v[80:95]
    ds_read_b128 v[152:155], v169 offset:0
    s_waitcnt lgkmcnt(2)
    v_mfma_f32_32x32x16_bf16 v[112:127], v[132:135], v[148:151], v[112:127]
    ds_read_b128 v[140:143], v161 offset:4096
    v_mfma_f32_32x32x16_bf16 v[96:111], v[128:131], v[148:151], v[96:111]
    ds_read_b128 v[156:159], v169 offset:8192
    s_waitcnt lgkmcnt(2)
    v_mfma_f32_32x32x16_bf16 v[64:79], v[136:139], v[152:155], v[64:79]
    ds_read_b128 v[128:131], v162 offset:0
    s_waitcnt lgkmcnt(2)
    v_mfma_f32_32x32x16_bf16 v[80:95], v[140:143], v[152:155], v[80:95]
    ds_read_b128 v[144:147], v170 offset:0
    s_waitcnt lgkmcnt(2)
    v_mfma_f32_32x32x16_bf16 v[112:127], v[140:143], v[156:159], v[112:127]
    ds_read_b128 v[132:135], v162 offset:4096
    v_mfma_f32_32x32x16_bf16 v[96:111], v[136:139], v[156:159], v[96:111]
    ds_read_b128 v[148:151], v170 offset:8192
    s_waitcnt lgkmcnt(2)
    v_mfma_f32_32x32x16_bf16 v[64:79], v[128:131], v[144:147], v[64:79]
    ds_read_b128 v[136:139], v163 offset:0
    s_waitcnt lgkmcnt(2)
    v_mfma_f32_32x32x16_bf16 v[80:95], v[132:135], v[144:147], v[80:95]
    ds_read_b128 v[152:155], v171 offset:0
    s_waitcnt lgkmcnt(2)
    v_mfma_f32_32x32x16_bf16 v[112:127], v[132:135], v[148:151], v[112:127]
    ds_read_b128 v[140:143], v163 offset:4096
    v_mfma_f32_32x32x16_bf16 v[96:111], v[128:131], v[148:151], v[96:111]
    ds_read_b128 v[156:159], v171 offset:8192
    s_waitcnt lgkmcnt(0)
    s_barrier
    v_mfma_f32_32x32x16_bf16 v[64:79], v[136:139], v[152:155], v[64:79]
    v_mfma_f32_32x32x16_bf16 v[80:95], v[140:143], v[152:155], v[80:95]
    v_mfma_f32_32x32x16_bf16 v[112:127], v[140:143], v[156:159], v[112:127]
    v_mfma_f32_32x32x16_bf16 v[96:111], v[136:139], v[156:159], v[96:111]
    s_nop 8
    v_fma_f32 v28, v64, v176, v66
    v_fma_f32 v29, v65, v176, v67
    s_nop 0
    v_fma_f32 v44, v96, v176, v98
    v_fma_f32 v45, v97, v176, v99
    v_fma_f32 v28, v96, -v177, v28
    v_fma_f32 v29, v97, -v177, v29
    v_fma_f32 v44, v64, v177, v44
    v_fma_f32 v45, v65, v177, v45
    v_fma_f32 v24, v28, v176, v68
    v_fma_f32 v25, v29, v176, v69
    v_fma_f32 v26, v44, v176, v100
    v_fma_f32 v27, v45, v176, v101
    v_fma_f32 v24, v44, -v177, v24
    v_fma_f32 v25, v45, -v177, v25
    v_fma_f32 v26, v28, v177, v26
    v_fma_f32 v27, v29, v177, v27
    v_fma_f32 v28, v24, v176, v70
    v_fma_f32 v29, v25, v176, v71
    v_fma_f32 v44, v26, v176, v102
    v_fma_f32 v45, v27, v176, v103
    v_fma_f32 v28, v26, -v177, v28
    v_fma_f32 v29, v27, -v177, v29
    v_fma_f32 v44, v24, v177, v44
    v_fma_f32 v45, v25, v177, v45
    v_fma_f32 v24, v28, v176, v72
    v_fma_f32 v25, v29, v176, v73
    v_fma_f32 v26, v44, v176, v104
    v_fma_f32 v27, v45, v176, v105
    v_fma_f32 v24, v44, -v177, v24
    v_fma_f32 v25, v45, -v177, v25
    v_fma_f32 v26, v28, v177, v26
    v_fma_f32 v27, v29, v177, v27
    v_fma_f32 v28, v24, v176, v74
    v_fma_f32 v29, v25, v176, v75
    v_fma_f32 v44, v26, v176, v106
    v_fma_f32 v45, v27, v176, v107
    v_fma_f32 v28, v26, -v177, v28
    v_fma_f32 v29, v27, -v177, v29
    v_fma_f32 v44, v24, v177, v44
    v_fma_f32 v45, v25, v177, v45
    v_fma_f32 v24, v28, v176, v76
    v_fma_f32 v25, v29, v176, v77
    v_fma_f32 v26, v44, v176, v108
    v_fma_f32 v27, v45, v176, v109
    v_fma_f32 v24, v44, -v177, v24
    v_fma_f32 v25, v45, -v177, v25
    v_fma_f32 v26, v28, v177, v26
    v_fma_f32 v27, v29, v177, v27
    v_fma_f32 v28, v24, v176, v78
    v_fma_f32 v29, v25, v176, v79
    v_fma_f32 v44, v26, v176, v110
    v_fma_f32 v45, v27, v176, v111
    v_fma_f32 v28, v26, -v177, v28
    v_fma_f32 v29, v27, -v177, v29
    v_fma_f32 v44, v24, v177, v44
    v_fma_f32 v45, v25, v177, v45
    v_fma_f32 v24, v28, v176, v80
    v_fma_f32 v25, v29, v176, v81
    v_fma_f32 v26, v44, v176, v112
    v_fma_f32 v27, v45, v176, v113
    v_fma_f32 v24, v44, -v177, v24
    v_fma_f32 v25, v45, -v177, v25
    v_fma_f32 v26, v28, v177, v26
    v_fma_f32 v27, v29, v177, v27
    v_fma_f32 v28, v24, v176, v82
    v_fma_f32 v29, v25, v176, v83
    v_fma_f32 v44, v26, v176, v114
    v_fma_f32 v45, v27, v176, v115
    v_fma_f32 v28, v26, -v177, v28
    v_fma_f32 v29, v27, -v177, v29
    v_fma_f32 v44, v24, v177, v44
    v_fma_f32 v45, v25, v177, v45
    v_fma_f32 v24, v28, v176, v84
    v_fma_f32 v25, v29, v176, v85
    v_fma_f32 v26, v44, v176, v116
    v_fma_f32 v27, v45, v176, v117
    v_fma_f32 v24, v44, -v177, v24
    v_fma_f32 v25, v45, -v177, v25
    v_fma_f32 v26, v28, v177, v26
    v_fma_f32 v27, v29, v177, v27
    v_fma_f32 v28, v24, v176, v86
    v_fma_f32 v29, v25, v176, v87
    v_fma_f32 v44, v26, v176, v118
    v_fma_f32 v45, v27, v176, v119
    v_fma_f32 v28, v26, -v177, v28
    v_fma_f32 v29, v27, -v177, v29
    v_fma_f32 v44, v24, v177, v44
    v_fma_f32 v45, v25, v177, v45
    v_fma_f32 v24, v28, v176, v88
    v_fma_f32 v25, v29, v176, v89
    v_fma_f32 v26, v44, v176, v120
    v_fma_f32 v27, v45, v176, v121
    v_fma_f32 v24, v44, -v177, v24
    v_fma_f32 v25, v45, -v177, v25
    v_fma_f32 v26, v28, v177, v26
    v_fma_f32 v27, v29, v177, v27
    v_fma_f32 v28, v24, v176, v90
    v_fma_f32 v29, v25, v176, v91
    v_fma_f32 v44, v26, v176, v122
    v_fma_f32 v45, v27, v176, v123
    v_fma_f32 v28, v26, -v177, v28
    v_fma_f32 v29, v27, -v177, v29
    v_fma_f32 v44, v24, v177, v44
    v_fma_f32 v45, v25, v177, v45
    v_fma_f32 v24, v28, v176, v92
    v_fma_f32 v25, v29, v176, v93
    v_fma_f32 v26, v44, v176, v124
    v_fma_f32 v27, v45, v176, v125
    v_fma_f32 v24, v44, -v177, v24
    v_fma_f32 v25, v45, -v177, v25
    v_fma_f32 v26, v28, v177, v26
    v_fma_f32 v27, v29, v177, v27
    v_fma_f32 v28, v24, v176, v94
    v_fma_f32 v29, v25, v176, v95
    v_fma_f32 v44, v26, v176, v126
    v_fma_f32 v45, v27, v176, v127
    v_fma_f32 v28, v26, -v177, v28
    v_fma_f32 v29, v27, -v177, v29
    v_fma_f32 v44, v24, v177, v44
    v_fma_f32 v45, v25, v177, v45
    v_mov_b32 v32, v28
    v_mov_b32 v33, v44
    v_mov_b32 v34, v29
    v_mov_b32 v35, v45
    v_fma_f32 v36, v180, v32, v34
    v_fma_f32 v37, v180, v33, v35
    v_fma_f32 v36, -v181, v33, v36
    v_fma_f32 v37, v181, v32, v37
    v_mov_b32 v38, v36
    v_mov_b32 v39, v37
    v_mov_b32 v40, 0
    v_mov_b32 v41, 0
    s_nop 0
    v_permlane32_swap_b32 v40, v38
    v_permlane32_swap_b32 v41, v39
    v_fma_f32 v42, v182, v40, v36
    v_fma_f32 v43, v182, v41, v37
    v_fma_f32 v42, -v183, v41, v42
    v_fma_f32 v43, v183, v40, v43
    v_or_b32 v42, 1, v42
    s_mov_b32 s12, 0
    s_mov_b32 s13, -1
    s_mov_b64 exec, s[12:13]
    buffer_store_dwordx2 v[42:43], v7, s[56:59], 0 offen sc1
    s_mov_b64 exec, -1
    v_mul_f32 v224, v64, v178
    v_mul_f32 v225, v65, v178
    v_fma_f32 v224, v96, -v179, v224
    v_fma_f32 v225, v97, -v179, v225
    v_mul_f32 v96, v96, v178
    v_mul_f32 v97, v97, v178
    v_fma_f32 v96, v64, v179, v96
    v_fma_f32 v97, v65, v179, v97
    v_mul_f32 v226, v66, v178
    v_mul_f32 v227, v67, v178
    v_fma_f32 v226, v98, -v179, v226
    v_fma_f32 v227, v99, -v179, v227
    v_mul_f32 v98, v98, v178
    v_mul_f32 v99, v99, v178
    v_fma_f32 v98, v66, v179, v98
    v_fma_f32 v99, v67, v179, v99
    v_mul_f32 v228, v68, v178
    v_mul_f32 v229, v69, v178
    v_fma_f32 v228, v100, -v179, v228
    v_fma_f32 v229, v101, -v179, v229
    v_mul_f32 v100, v100, v178
    v_mul_f32 v101, v101, v178
    v_fma_f32 v100, v68, v179, v100
    v_fma_f32 v101, v69, v179, v101
    v_mul_f32 v230, v70, v178
    v_mul_f32 v231, v71, v178
    v_fma_f32 v230, v102, -v179, v230
    v_fma_f32 v231, v103, -v179, v231
    v_mul_f32 v102, v102, v178
    v_mul_f32 v103, v103, v178
    v_fma_f32 v102, v70, v179, v102
    v_fma_f32 v103, v71, v179, v103
    v_mul_f32 v232, v72, v178
    v_mul_f32 v233, v73, v178
    v_fma_f32 v232, v104, -v179, v232
    v_fma_f32 v233, v105, -v179, v233
    v_mul_f32 v104, v104, v178
    v_mul_f32 v105, v105, v178
    v_fma_f32 v104, v72, v179, v104
    v_fma_f32 v105, v73, v179, v105
    v_mul_f32 v234, v74, v178
    v_mul_f32 v235, v75, v178
    v_fma_f32 v234, v106, -v179, v234
    v_fma_f32 v235, v107, -v179, v235
    v_mul_f32 v106, v106, v178
    v_mul_f32 v107, v107, v178
    v_fma_f32 v106, v74, v179, v106
    v_fma_f32 v107, v75, v179, v107
    v_mul_f32 v236, v76, v178
    v_mul_f32 v237, v77, v178
    v_fma_f32 v236, v108, -v179, v236
    v_fma_f32 v237, v109, -v179, v237
    v_mul_f32 v108, v108, v178
    v_mul_f32 v109, v109, v178
    v_fma_f32 v108, v76, v179, v108
    v_fma_f32 v109, v77, v179, v109
    v_mul_f32 v238, v78, v178
    v_mul_f32 v239, v79, v178
    v_fma_f32 v238, v110, -v179, v238
    v_fma_f32 v239, v111, -v179, v239
    v_mul_f32 v110, v110, v178
    v_mul_f32 v111, v111, v178
    v_fma_f32 v110, v78, v179, v110
    v_fma_f32 v111, v79, v179, v111
    v_mul_f32 v240, v80, v178
    v_mul_f32 v241, v81, v178
    v_fma_f32 v240, v112, -v179, v240
    v_fma_f32 v241, v113, -v179, v241
    v_mul_f32 v112, v112, v178
    v_mul_f32 v113, v113, v178
    v_fma_f32 v112, v80, v179, v112
    v_fma_f32 v113, v81, v179, v113
    v_mul_f32 v242, v82, v178
    v_mul_f32 v243, v83, v178
    v_fma_f32 v242, v114, -v179, v242
    v_fma_f32 v243, v115, -v179, v243
    v_mul_f32 v114, v114, v178
    v_mul_f32 v115, v115, v178
    v_fma_f32 v114, v82, v179, v114
    v_fma_f32 v115, v83, v179, v115
    v_mul_f32 v244, v84, v178
    v_mul_f32 v245, v85, v178
    v_fma_f32 v244, v116, -v179, v244
    v_fma_f32 v245, v117, -v179, v245
    v_mul_f32 v116, v116, v178
    v_mul_f32 v117, v117, v178
    v_fma_f32 v116, v84, v179, v116
    v_fma_f32 v117, v85, v179, v117
    v_mul_f32 v246, v86, v178
    v_mul_f32 v247, v87, v178
    v_fma_f32 v246, v118, -v179, v246
    v_fma_f32 v247, v119, -v179, v247
    v_mul_f32 v118, v118, v178
    v_mul_f32 v119, v119, v178
    v_fma_f32 v118, v86, v179, v118
    v_fma_f32 v119, v87, v179, v119
    v_mul_f32 v248, v88, v178
    v_mul_f32 v249, v89, v178
    v_fma_f32 v248, v120, -v179, v248
    v_fma_f32 v249, v121, -v179, v249
    v_mul_f32 v120, v120, v178
    v_mul_f32 v121, v121, v178
    v_fma_f32 v120, v88, v179, v120
    v_fma_f32 v121, v89, v179, v121
    v_mul_f32 v250, v90, v178
    v_mul_f32 v251, v91, v178
    v_fma_f32 v250, v122, -v179, v250
    v_fma_f32 v251, v123, -v179, v251
    v_mul_f32 v122, v122, v178
    v_mul_f32 v123, v123, v178
    v_fma_f32 v122, v90, v179, v122
    v_fma_f32 v123, v91, v179, v123
    v_mul_f32 v252, v92, v178
    v_mul_f32 v253, v93, v178
    v_fma_f32 v252, v124, -v179, v252
    v_fma_f32 v253, v125, -v179, v253
    v_mul_f32 v124, v124, v178
    v_mul_f32 v125, v125, v178
    v_fma_f32 v124, v92, v179, v124
    v_fma_f32 v125, v93, v179, v125
    v_mul_f32 v254, v94, v178
    v_mul_f32 v255, v95, v178
    v_fma_f32 v254, v126, -v179, v254
    v_fma_f32 v255, v127, -v179, v255
    v_mul_f32 v126, v126, v178
    v_mul_f32 v127, v127, v178
    v_fma_f32 v126, v94, v179, v126
    v_fma_f32 v127, v95, v179, v127
    v_mul_f32 v44, v178, v40
    v_mul_f32 v45, v178, v41
    v_fma_f32 v44, -v179, v41, v44
    v_fma_f32 v45, v179, v40, v45
    v_mul_f32 v46, v178, v32
    v_mul_f32 v47, v178, v33
    v_fma_f32 v46, -v179, v33, v46
    v_fma_f32 v47, v179, v32, v47
    v_subrev_u32 v128, 0x2000, v50
    v_subrev_u32 v129, 0x6000, v50
    v_subrev_u32 v130, 0xa000, v50
    v_subrev_u32 v131, 0xe000, v50
    v_subrev_u32 v132, 0x12000, v50
    v_subrev_u32 v133, 0x16000, v50
    v_subrev_u32 v134, 0x1a000, v50
    v_subrev_u32 v135, 0x1e000, v50
    v_subrev_u32 v136, 0x22000, v50
    v_subrev_u32 v137, 0x26000, v50
    v_subrev_u32 v138, 0x2a000, v50
    v_subrev_u32 v139, 0x2e000, v50
    v_subrev_u32 v140, 0x32000, v50
    v_subrev_u32 v141, 0x36000, v50
    v_subrev_u32 v142, 0x3a000, v50
    v_subrev_u32 v143, 0x3e000, v50
    s_waitcnt vmcnt(1)
    s_mov_b32 s89, 65536
c_init_chk:
    v_and_b32 v52, 15, v20
    v_cmp_ne_u32 vcc, 15, v52
    s_nop 1
    s_cmp_eq_u64 vcc, 0
    s_cbranch_scc1 c_init_ok
    s_sub_u32 s89, s89, 1
    s_cbranch_scc1 c_init_ok
    s_sleep 4
    buffer_load_dword v20, v21, s[64:67], 0 offen sc1
    s_waitcnt vmcnt(0)
    s_branch c_init_chk
c_init_ok:
    s_getreg_b32 s11, hwreg(HW_REG_XCC_ID, 0, 4)
    s_lshl_b32 s11, 0x100, s11
    s_or_b32 s11, s11, 15
    v_and_b32 v52, 7, v1
    v_cmp_eq_u32 s[12:13], s54, v52
    v_cmp_ne_u32 vcc, s11, v20
    s_nop 1
    s_and_b64 vcc, vcc, s[12:13]
    s_cselect_b32 s14, 0, 1
    buffer_load_dwordx2 v[192:193], v128, s[56:59], 0 offen sc1
    buffer_load_dwordx2 v[194:195], v129, s[56:59], 0 offen sc1
    buffer_load_dwordx2 v[196:197], v130, s[56:59], 0 offen sc1
    buffer_load_dwordx2 v[198:199], v131, s[56:59], 0 offen sc1
    buffer_load_dwordx2 v[200:201], v132, s[56:59], 0 offen sc1
    buffer_load_dwordx2 v[202:203], v133, s[56:59], 0 offen sc1
    buffer_load_dwordx2 v[204:205], v134, s[56:59], 0 offen sc1
    buffer_load_dwordx2 v[206:207], v135, s[56:59], 0 offen sc1
    buffer_load_dwordx2 v[208:209], v136, s[56:59], 0 offen sc1
    buffer_load_dwordx2 v[210:211], v137, s[56:59], 0 offen sc1
    buffer_load_dwordx2 v[212:213], v138, s[56:59], 0 offen sc1
    buffer_load_dwordx2 v[214:215], v139, s[56:59], 0 offen sc1
    buffer_load_dwordx2 v[216:217], v140, s[56:59], 0 offen sc1
    buffer_load_dwordx2 v[218:219], v141, s[56:59], 0 offen sc1
    buffer_load_dwordx2 v[220:221], v142, s[56:59], 0 offen sc1
    buffer_load_dwordx2 v[222:223], v143, s[56:59], 0 offen sc1
    s_lshl_b32 s11, s3, 13
    v_lshl_add_u32 v16, v6, 11, s11
    v_lshl_add_u32 v16, v4, 6, v16
    v_bfe_u32 v17, v1, 1, 2
    v_xor_b32 v18, 0, v17
    v_lshl_add_u32 v64, v18, 4, v16
    v_xor_b32 v18, 1, v17
    v_lshl_add_u32 v65, v18, 4, v16
    v_xor_b32 v18, 2, v17
    v_lshl_add_u32 v66, v18, 4, v16
    v_xor_b32 v18, 3, v17
    v_lshl_add_u32 v67, v18, 4, v16
    v_mov_b32 v31, 1
    v_bfe_u32 v16, v1, 2, 2
    v_lshl_add_u32 v16, v6, 3, v16
    v_and_b32 v24, 1, v1
    v_bfe_u32 v18, v1, 4, 1
    v_lshl_add_u32 v24, v24, 1, v18
    v_bfe_u32 v18, v16, 1, 2
    v_xor_b32 v24, v24, v18
    v_lshlrev_b32 v24, 4, v24
    v_lshl_add_u32 v24, v16, 6, v24
    v_bfe_u32 v18, v1, 1, 1
    v_lshl_add_u32 v24, v18, 3, v24
    v_xor_b32 v25, 32, v24
    v_add_u32 v25, 256, v25
    v_add_u32 v68, s11, v24
    v_add_u32 v69, s11, v25
    s_lshl_b32 s11, s4, 7
    s_lshl_b32 s12, s6, 6
    s_add_u32 s11, s11, s12
    s_and_b32 s12, s5, 7
    s_lshl_b32 s12, s12, 2
    s_add_u32 s11, s11, s12
    s_add_u32 s11, s11, s7
    s_lshl_b32 s11, s11, 12
    s_lshr_b32 s13, s5, 3
    s_lshl_b32 s13, s13, 11
    s_add_u32 s11, s11, s13
    v_lshl_add_u32 v72, v1, 4, s11
    v_mov_b32 v20, 0x24a00
    s_lshl_b32 s6, s4, 2
    s_add_u32 s6, s6, s3
    s_lshr_b32 s7, s3, 1
    s_lshl_b32 s7, s7, 13
    s_and_b32 s8, s3, 1
    s_lshl_b32 s8, s8, 11
    s_add_u32 s7, s7, s8
    v_add_u32 v70, s7, v24
    v_add_u32 v71, s7, v25
    s_lshl_b32 s7, s6, 17
    s_add_u32 s7, s7, s13
    v_lshl_add_u32 v3, v1, 4, s7
    v_add_u32 v2, 0x1000, v3
    v_lshlrev_b32 v14, 7, v4
    v_add_u32 v14, 0x8000, v14
    v_xor_b32 v16, 0, v11
    v_lshl_add_u32 v32, v16, 4, v14
    v_xor_b32 v16, 2, v11
    v_lshl_add_u32 v33, v16, 4, v14
    v_xor_b32 v16, 4, v11
    v_lshl_add_u32 v34, v16, 4, v14
    v_xor_b32 v16, 6, v11
    v_lshl_add_u32 v35, v16, 4, v14
    s_lshr_b32 s7, s6, 1
    s_lshl_b32 s7, s7, 12
    s_add_u32 s7, s7, s13
    v_bfe_u32 v16, v1, 1, 3
    v_subrev_u32 v14, 1, v16
    v_cmp_le_u32 vcc, s15, v14
    s_nop 1
    v_cndmask_b32 v14, v14, v16, vcc
    v_mov_b32 v19, s15
    v_cmp_eq_u32 vcc, 0, v16
    s_nop 1
    v_cndmask_b32 v16, v14, v19, vcc
    v_and_b32 v14, 1, v1
    v_lshl_add_u32 v16, v16, 1, v14
    v_lshl_add_u32 v22, v16, 7, s7
    s_add_u32 s64, s52, 0x1000000
    s_addc_u32 s65, s53, 0
    s_mov_b32 s66, 0x2000
    s_mov_b32 s67, 0x20000
    s_mov_b32 s76, s48
    s_mov_b32 s77, s49
    s_mov_b32 s78, 0x800000
    s_mov_b32 s79, 0x20000
    s_add_u32 s92, s52, 0x1800000
    s_addc_u32 s93, s53, 0
    s_mov_b32 s94, 0x800000
    s_mov_b32 s95, 0x20000
    s_mov_b32 s80, 0
    s_mov_b32 s81, 4096
    s_mov_b32 s82, 8192
    s_mov_b32 s83, 12288
    s_mov_b32 s84, 16384
    s_mov_b32 s85, 20480
    s_mov_b32 s86, 24576
    s_mov_b32 s87, 28672
    s_lshl_b32 s7, s6, 5
    v_lshl_add_u32 v7, v6, 4, s7
    s_lshl_b32 s8, s5, 6
    v_add_u32 v8, s8, v4
    v_lshlrev_b32 v26, 12, v7
    v_lshl_add_u32 v26, v8, 2, v26
    v_add_u32 v27, 0x8000, v26
    v_lshlrev_b32 v7, 2, v7
    v_lshlrev_b32 v8, 1, v8
    s_mul_i32 s8, s3, 4608
    s_add_u32 s8, s8, 131584
    v_lshlrev_b32 v61, 11, v6
    v_lshl_add_u32 v61, v4, 1, v61
    v_add_u32 v61, s8, v61
    v_mul_u32_u24 v21, 272, v4
    v_lshl_add_u32 v21, v6, 5, v21
    s_lshl_b32 s8, s3, 6
    v_add_u32 v21, s8, v21
    s_xor_b32 s73, s72, 4096
    s_lshl_b32 s74, s73, 6
    s_add_u32 s75, s74, 4096
    s_add_u32 s8, s73, 0x30000
    v_mov_b32 v29, s8
    v_lshlrev_b32 v28, 4, v1
    v_mov_b32 v23, 1
    s_mov_b32 s88, 65536
c_poll:
    s_waitcnt vmcnt(0)
    v_mov_b32 v52, 0
    v_and_b32 v144, 1, v192
    v_and_b32 v145, 1, v194
    v_and_b32 v146, 1, v196
    v_and_b32 v147, 1, v198
    v_and_b32 v148, 1, v200
    v_and_b32 v149, 1, v202
    v_and_b32 v150, 1, v204
    v_and_b32 v151, 1, v206
    v_and_b32 v152, 1, v208
    v_and_b32 v153, 1, v210
    v_and_b32 v154, 1, v212
    v_and_b32 v155, 1, v214
    v_and_b32 v156, 1, v216
    v_and_b32 v157, 1, v218
    v_and_b32 v158, 1, v220
    v_and_b32 v159, 1, v222
    v_add3_u32 v52, v52, v144, v145
    v_add3_u32 v52, v52, v146, v147
    v_add3_u32 v52, v52, v148, v149
    v_add3_u32 v52, v52, v150, v151
    v_add3_u32 v52, v52, v152, v153
    v_add3_u32 v52, v52, v154, v155
    v_add3_u32 v52, v52, v156, v157
    v_add3_u32 v52, v52, v158, v159
    v_cmp_ne_u32 vcc, v52, v51
    s_nop 1
    s_cmp_eq_u64 vcc, 0
    s_cbranch_scc1 c_polled
    s_sub_u32 s88, s88, 1
    s_cbranch_scc1 c_polled
    s_sleep 4
    v_cmp_eq_u32 vcc, 0, v144
    s_nop 1
    s_mov_b64 exec, vcc
    buffer_load_dwordx2 v[192:193], v128, s[56:59], 0 offen sc1
    s_mov_b64 exec, -1
    v_cmp_eq_u32 vcc, 0, v145
    s_nop 1
    s_mov_b64 exec, vcc
    buffer_load_dwordx2 v[194:195], v129, s[56:59], 0 offen sc1
    s_mov_b64 exec, -1
    v_cmp_eq_u32 vcc, 0, v146
    s_nop 1
    s_mov_b64 exec, vcc
    buffer_load_dwordx2 v[196:197], v130, s[56:59], 0 offen sc1
    s_mov_b64 exec, -1
    v_cmp_eq_u32 vcc, 0, v147
    s_nop 1
    s_mov_b64 exec, vcc
    buffer_load_dwordx2 v[198:199], v131, s[56:59], 0 offen sc1
    s_mov_b64 exec, -1
    v_cmp_eq_u32 vcc, 0, v148
    s_nop 1
    s_mov_b64 exec, vcc
    buffer_load_dwordx2 v[200:201], v132, s[56:59], 0 offen sc1
    s_mov_b64 exec, -1
    v_cmp_eq_u32 vcc, 0, v149
    s_nop 1
    s_mov_b64 exec, vcc
    buffer_load_dwordx2 v[202:203], v133, s[56:59], 0 offen sc1
    s_mov_b64 exec, -1
    v_cmp_eq_u32 vcc, 0, v150
    s_nop 1
    s_mov_b64 exec, vcc
    buffer_load_dwordx2 v[204:205], v134, s[56:59], 0 offen sc1
    s_mov_b64 exec, -1
    v_cmp_eq_u32 vcc, 0, v151
    s_nop 1
    s_mov_b64 exec, vcc
    buffer_load_dwordx2 v[206:207], v135, s[56:59], 0 offen sc1
    s_mov_b64 exec, -1
    v_cmp_eq_u32 vcc, 0, v152
    s_nop 1
    s_mov_b64 exec, vcc
    buffer_load_dwordx2 v[208:209], v136, s[56:59], 0 offen sc1
    s_mov_b64 exec, -1
    v_cmp_eq_u32 vcc, 0, v153
    s_nop 1
    s_mov_b64 exec, vcc
    buffer_load_dwordx2 v[210:211], v137, s[56:59], 0 offen sc1
    s_mov_b64 exec, -1
    v_cmp_eq_u32 vcc, 0, v154
    s_nop 1
    s_mov_b64 exec, vcc
    buffer_load_dwordx2 v[212:213], v138, s[56:59], 0 offen sc1
    s_mov_b64 exec, -1
    v_cmp_eq_u32 vcc, 0, v155
    s_nop 1
    s_mov_b64 exec, vcc
    buffer_load_dwordx2 v[214:215], v139, s[56:59], 0 offen sc1
    s_mov_b64 exec, -1
    v_cmp_eq_u32 vcc, 0, v156
    s_nop 1
    s_mov_b64 exec, vcc
    buffer_load_dwordx2 v[216:217], v140, s[56:59], 0 offen sc1
    s_mov_b64 exec, -1
    v_cmp_eq_u32 vcc, 0, v157
    s_nop 1
    s_mov_b64 exec, vcc
    buffer_load_dwordx2 v[218:219], v141, s[56:59], 0 offen sc1
    s_mov_b64 exec, -1
    v_cmp_eq_u32 vcc, 0, v158
    s_nop 1
    s_mov_b64 exec, vcc
    buffer_load_dwordx2 v[220:221], v142, s[56:59], 0 offen sc1
    s_mov_b64 exec, -1
    v_cmp_eq_u32 vcc, 0, v159
    s_nop 1
    s_mov_b64 exec, vcc
    buffer_load_dwordx2 v[222:223], v143, s[56:59], 0 offen sc1
    s_mov_b64 exec, -1
    s_branch c_poll
c_polled:
    v_fma_f32 v52, v222, v186, v220
    v_fma_f32 v53, v223, v186, v221
    v_fma_f32 v52, -v223, v187, v52
    v_fma_f32 v53, v222, v187, v53
    v_fma_f32 v54, v52, v186, v218
    v_fma_f32 v55, v53, v186, v219
    v_fma_f32 v54, -v53, v187, v54
    v_fma_f32 v55, v52, v187, v55
    v_fma_f32 v52, v54, v186, v216
    v_fma_f32 v53, v55, v186, v217
    v_fma_f32 v52, -v55, v187, v52
    v_fma_f32 v53, v54, v187, v53
    v_fma_f32 v54, v52, v186, v214
    v_fma_f32 v55, v53, v186, v215
    v_fma_f32 v54, -v53, v187, v54
    v_fma_f32 v55, v52, v187, v55
    v_fma_f32 v52, v54, v186, v212
    v_fma_f32 v53, v55, v186, v213
    v_fma_f32 v52, -v55, v187, v52
    v_fma_f32 v53, v54, v187, v53
    v_fma_f32 v54, v52, v186, v210
    v_fma_f32 v55, v53, v186, v211
    v_fma_f32 v54, -v53, v187, v54
    v_fma_f32 v55, v52, v187, v55
    v_fma_f32 v52, v54, v186, v208
    v_fma_f32 v53, v55, v186, v209
    v_fma_f32 v52, -v55, v187, v52
    v_fma_f32 v53, v54, v187, v53
    v_fma_f32 v54, v52, v186, v206
    v_fma_f32 v55, v53, v186, v207
    v_fma_f32 v54, -v53, v187, v54
    v_fma_f32 v55, v52, v187, v55
    v_fma_f32 v52, v54, v186, v204
    v_fma_f32 v53, v55, v186, v205
    v_fma_f32 v52, -v55, v187, v52
    v_fma_f32 v53, v54, v187, v53
    v_fma_f32 v54, v52, v186, v202
    v_fma_f32 v55, v53, v186, v203
    v_fma_f32 v54, -v53, v187, v54
    v_fma_f32 v55, v52, v187, v55
    v_fma_f32 v52, v54, v186, v200
    v_fma_f32 v53, v55, v186, v201
    v_fma_f32 v52, -v55, v187, v52
    v_fma_f32 v53, v54, v187, v53
    v_fma_f32 v54, v52, v186, v198
    v_fma_f32 v55, v53, v186, v199
    v_fma_f32 v54, -v53, v187, v54
    v_fma_f32 v55, v52, v187, v55
    v_fma_f32 v52, v54, v186, v196
    v_fma_f32 v53, v55, v186, v197
    v_fma_f32 v52, -v55, v187, v52
    v_fma_f32 v53, v54, v187, v53
    v_fma_f32 v54, v52, v186, v194
    v_fma_f32 v55, v53, v186, v195
    v_fma_f32 v54, -v53, v187, v54
    v_fma_f32 v55, v52, v187, v55
    v_fma_f32 v52, v54, v186, v192
    v_fma_f32 v53, v55, v186, v193
    v_fma_f32 v52, -v55, v187, v52
    v_fma_f32 v53, v54, v187, v53
    v_mov_b32 v54, v52
    v_mov_b32 v55, v53
    v_mov_b32 v56, v52
    v_mov_b32 v57, v53
    s_nop 0
    v_permlane32_swap_b32 v54, v56
    v_permlane32_swap_b32 v55, v57
    v_fma_f32 v58, v184, v56, v54
    v_fma_f32 v59, v184, v57, v55
    v_fma_f32 v58, -v185, v57, v58
    v_fma_f32 v59, v185, v56, v59
    v_fma_f32 v52, v48, v58, v44
    v_fma_f32 v53, v48, v59, v45
    v_fma_f32 v52, -v49, v59, v52
    v_fma_f32 v53, v49, v58, v53
    v_fma_f32 v54, v180, v52, v46
    v_fma_f32 v55, v180, v53, v47
    v_fma_f32 v54, -v181, v53, v54
    v_fma_f32 v55, v181, v52, v55
    v_mov_b32 v56, v52
    v_mov_b32 v57, v54
    v_mov_b32 v58, v53
    v_mov_b32 v59, v55
    v_fma_f32 v224, v56, v176, v224
    v_fma_f32 v225, v57, v176, v225
    v_fma_f32 v96, v58, v176, v96
    v_fma_f32 v97, v59, v176, v97
    v_fma_f32 v224, v58, -v177, v224
    v_fma_f32 v225, v59, -v177, v225
    v_fma_f32 v96, v56, v177, v96
    v_fma_f32 v97, v57, v177, v97
    v_fma_f32 v226, v224, v176, v226
    v_fma_f32 v227, v225, v176, v227
    v_fma_f32 v98, v96, v176, v98
    v_fma_f32 v99, v97, v176, v99
    v_fma_f32 v226, v96, -v177, v226
    v_fma_f32 v227, v97, -v177, v227
    v_fma_f32 v98, v224, v177, v98
    v_fma_f32 v99, v225, v177, v99
    v_fma_f32 v228, v226, v176, v228
    v_fma_f32 v229, v227, v176, v229
    v_fma_f32 v100, v98, v176, v100
    v_fma_f32 v101, v99, v176, v101
    v_fma_f32 v228, v98, -v177, v228
    v_fma_f32 v229, v99, -v177, v229
    v_fma_f32 v100, v226, v177, v100
    v_fma_f32 v101, v227, v177, v101
    v_fma_f32 v230, v228, v176, v230
    v_fma_f32 v231, v229, v176, v231
    v_fma_f32 v102, v100, v176, v102
    v_fma_f32 v103, v101, v176, v103
    v_fma_f32 v230, v100, -v177, v230
    v_fma_f32 v231, v101, -v177, v231
    v_fma_f32 v102, v228, v177, v102
    v_fma_f32 v103, v229, v177, v103
    v_fma_f32 v232, v230, v176, v232
    v_fma_f32 v233, v231, v176, v233
    v_fma_f32 v104, v102, v176, v104
    v_fma_f32 v105, v103, v176, v105
    v_fma_f32 v232, v102, -v177, v232
    v_fma_f32 v233, v103, -v177, v233
    v_fma_f32 v104, v230, v177, v104
    v_fma_f32 v105, v231, v177, v105
    v_fma_f32 v234, v232, v176, v234
    v_fma_f32 v235, v233, v176, v235
    v_fma_f32 v106, v104, v176, v106
    v_fma_f32 v107, v105, v176, v107
    v_fma_f32 v234, v104, -v177, v234
    v_fma_f32 v235, v105, -v177, v235
    v_fma_f32 v106, v232, v177, v106
    v_fma_f32 v107, v233, v177, v107
    v_fma_f32 v236, v234, v176, v236
    v_fma_f32 v237, v235, v176, v237
    v_fma_f32 v108, v106, v176, v108
    v_fma_f32 v109, v107, v176, v109
    v_fma_f32 v236, v106, -v177, v236
    v_fma_f32 v237, v107, -v177, v237
    v_fma_f32 v108, v234, v177, v108
    v_fma_f32 v109, v235, v177, v109
    v_fma_f32 v238, v236, v176, v238
    v_fma_f32 v239, v237, v176, v239
    v_fma_f32 v110, v108, v176, v110
    v_fma_f32 v111, v109, v176, v111
    v_fma_f32 v238, v108, -v177, v238
    v_fma_f32 v239, v109, -v177, v239
    v_fma_f32 v110, v236, v177, v110
    v_fma_f32 v111, v237, v177, v111
    v_cvt_pk_bf16_f32 v128, v224, v226
    v_cvt_pk_bf16_f32 v129, v228, v230
    v_cvt_pk_bf16_f32 v130, v232, v234
    v_cvt_pk_bf16_f32 v131, v236, v238
    ds_write_b128 v64, v[128:131] offset:0
    v_cvt_pk_bf16_f32 v136, v225, v227
    v_cvt_pk_bf16_f32 v137, v229, v231
    v_cvt_pk_bf16_f32 v138, v233, v235
    v_cvt_pk_bf16_f32 v139, v237, v239
    ds_write_b128 v66, v[136:139] offset:0
    v_cvt_pk_bf16_f32 v144, -v96, -v98
    v_cvt_pk_bf16_f32 v145, -v100, -v102
    v_cvt_pk_bf16_f32 v146, -v104, -v106
    v_cvt_pk_bf16_f32 v147, -v108, -v110
    ds_write_b128 v64, v[144:147] offset:4096
    v_cvt_pk_bf16_f32 v152, -v97, -v99
    v_cvt_pk_bf16_f32 v153, -v101, -v103
    v_cvt_pk_bf16_f32 v154, -v105, -v107
    v_cvt_pk_bf16_f32 v155, -v109, -v111
    ds_write_b128 v66, v[152:155] offset:4096
    v_fma_f32 v240, v238, v176, v240
    v_fma_f32 v241, v239, v176, v241
    v_fma_f32 v112, v110, v176, v112
    v_fma_f32 v113, v111, v176, v113
    v_fma_f32 v240, v110, -v177, v240
    v_fma_f32 v241, v111, -v177, v241
    v_fma_f32 v112, v238, v177, v112
    v_fma_f32 v113, v239, v177, v113
    v_fma_f32 v242, v240, v176, v242
    v_fma_f32 v243, v241, v176, v243
    v_fma_f32 v114, v112, v176, v114
    v_fma_f32 v115, v113, v176, v115
    v_fma_f32 v242, v112, -v177, v242
    v_fma_f32 v243, v113, -v177, v243
    v_fma_f32 v114, v240, v177, v114
    v_fma_f32 v115, v241, v177, v115
    v_fma_f32 v244, v242, v176, v244
    v_fma_f32 v245, v243, v176, v245
    v_fma_f32 v116, v114, v176, v116
    v_fma_f32 v117, v115, v176, v117
    v_fma_f32 v244, v114, -v177, v244
    v_fma_f32 v245, v115, -v177, v245
    v_fma_f32 v116, v242, v177, v116
    v_fma_f32 v117, v243, v177, v117
    v_fma_f32 v246, v244, v176, v246
    v_fma_f32 v247, v245, v176, v247
    v_fma_f32 v118, v116, v176, v118
    v_fma_f32 v119, v117, v176, v119
    v_fma_f32 v246, v116, -v177, v246
    v_fma_f32 v247, v117, -v177, v247
    v_fma_f32 v118, v244, v177, v118
    v_fma_f32 v119, v245, v177, v119
    v_fma_f32 v248, v246, v176, v248
    v_fma_f32 v249, v247, v176, v249
    v_fma_f32 v120, v118, v176, v120
    v_fma_f32 v121, v119, v176, v121
    v_fma_f32 v248, v118, -v177, v248
    v_fma_f32 v249, v119, -v177, v249
    v_fma_f32 v120, v246, v177, v120
    v_fma_f32 v121, v247, v177, v121
    v_fma_f32 v250, v248, v176, v250
    v_fma_f32 v251, v249, v176, v251
    v_fma_f32 v122, v120, v176, v122
    v_fma_f32 v123, v121, v176, v123
    v_fma_f32 v250, v120, -v177, v250
    v_fma_f32 v251, v121, -v177, v251
    v_fma_f32 v122, v248, v177, v122
    v_fma_f32 v123, v249, v177, v123
    v_fma_f32 v252, v250, v176, v252
    v_fma_f32 v253, v251, v176, v253
    v_fma_f32 v124, v122, v176, v124
    v_fma_f32 v125, v123, v176, v125
    v_fma_f32 v252, v122, -v177, v252
    v_fma_f32 v253, v123, -v177, v253
    v_fma_f32 v124, v250, v177, v124
    v_fma_f32 v125, v251, v177, v125
    v_fma_f32 v254, v252, v176, v254
    v_fma_f32 v255, v253, v176, v255
    v_fma_f32 v126, v124, v176, v126
    v_fma_f32 v127, v125, v176, v127
    v_fma_f32 v254, v124, -v177, v254
    v_fma_f32 v255, v125, -v177, v255
    v_fma_f32 v126, v252, v177, v126
    v_fma_f32 v127, v253, v177, v127
    v_cvt_pk_bf16_f32 v132, v240, v242
    v_cvt_pk_bf16_f32 v133, v244, v246
    v_cvt_pk_bf16_f32 v134, v248, v250
    v_cvt_pk_bf16_f32 v135, v252, v254
    ds_write_b128 v65, v[132:135] offset:0
    v_cvt_pk_bf16_f32 v140, v241, v243
    v_cvt_pk_bf16_f32 v141, v245, v247
    v_cvt_pk_bf16_f32 v142, v249, v251
    v_cvt_pk_bf16_f32 v143, v253, v255
    ds_write_b128 v67, v[140:143] offset:0
    v_cvt_pk_bf16_f32 v148, -v112, -v114
    v_cvt_pk_bf16_f32 v149, -v116, -v118
    v_cvt_pk_bf16_f32 v150, -v120, -v122
    v_cvt_pk_bf16_f32 v151, -v124, -v126
    ds_write_b128 v65, v[148:151] offset:4096
    v_cvt_pk_bf16_f32 v156, -v113, -v115
    v_cvt_pk_bf16_f32 v157, -v117, -v119
    v_cvt_pk_bf16_f32 v158, -v121, -v123
    v_cvt_pk_bf16_f32 v159, -v125, -v127
    ds_write_b128 v67, v[156:159] offset:4096
    s_waitcnt lgkmcnt(0)
    s_mov_b64 exec, 1
    ds_add_u32 v20, v31 offset:12
    s_mov_b64 exec, -1
    ds_read_b64_tr_b16 v[160:161], v68 offset:0
    ds_read_b64_tr_b16 v[162:163], v69 offset:0
    ds_read_b64_tr_b16 v[164:165], v68 offset:1024
    ds_read_b64_tr_b16 v[166:167], v69 offset:1024
    ds_read_b64_tr_b16 v[168:169], v68 offset:4096
    ds_read_b64_tr_b16 v[170:171], v69 offset:4096
    ds_read_b64_tr_b16 v[172:173], v68 offset:5120
    ds_read_b64_tr_b16 v[174:175], v69 offset:5120
    ds_read_b64_tr_b16 v[176:177], v68 offset:2048
    ds_read_b64_tr_b16 v[178:179], v69 offset:2048
    ds_read_b64_tr_b16 v[180:181], v68 offset:3072
    ds_read_b64_tr_b16 v[182:183], v69 offset:3072
    ds_read_b64_tr_b16 v[184:185], v68 offset:6144
    ds_read_b64_tr_b16 v[186:187], v69 offset:6144
    ds_read_b64_tr_b16 v[188:189], v68 offset:7168
    ds_read_b64_tr_b16 v[190:191], v69 offset:7168
    s_mov_b32 s12, 0x0
    s_waitcnt lgkmcnt(14)
    buffer_store_dwordx4 v[160:163], v72, s[60:63], s12 offen offset:0 sc1
    s_waitcnt lgkmcnt(12)
    buffer_store_dwordx4 v[164:167], v72, s[60:63], s12 offen offset:1024 sc1
    s_mov_b32 s12, 0x2000
    s_waitcnt lgkmcnt(10)
    buffer_store_dwordx4 v[168:171], v72, s[60:63], s12 offen offset:0 sc1
    s_waitcnt lgkmcnt(8)
    buffer_store_dwordx4 v[172:175], v72, s[60:63], s12 offen offset:1024 sc1
    s_mov_b32 s12, 0x20000
    s_waitcnt lgkmcnt(6)
    buffer_store_dwordx4 v[176:179], v72, s[60:63], s12 offen offset:0 sc1
    s_waitcnt lgkmcnt(4)
    buffer_store_dwordx4 v[180:183], v72, s[60:63], s12 offen offset:1024 sc1
    s_mov_b32 s12, 0x22000
    s_waitcnt lgkmcnt(2)
    buffer_store_dwordx4 v[184:187], v72, s[60:63], s12 offen offset:0 sc1
    s_waitcnt lgkmcnt(0)
    buffer_store_dwordx4 v[188:191], v72, s[60:63], s12 offen offset:1024 sc1
    s_mov_b32 s89, 262144
c_lw:
    ds_read_b128 v[52:55], v20 offset:4
    s_waitcnt lgkmcnt(0)
    v_min_u32 v54, v54, v55
    v_min_u32 v53, 1, v53
    v_readfirstlane_b32 s8, v54
    v_readfirstlane_b32 s9, v53
    s_nop 1
    s_add_u32 s8, s8, s9
    s_cmp_ge_u32 s8, 5
    s_cbranch_scc1 c_lwok
    s_sub_u32 s89, s89, 1
    s_cbranch_scc0 c_lw
c_lwok:
    ds_read_b64_tr_b16 v[160:161], v70 offset:0
    ds_read_b64_tr_b16 v[162:163], v71 offset:0
    ds_read_b64_tr_b16 v[164:165], v70 offset:1024
    ds_read_b64_tr_b16 v[166:167], v71 offset:1024
    ds_read_b64_tr_b16 v[168:169], v70 offset:16384
    ds_read_b64_tr_b16 v[170:171], v71 offset:16384
    ds_read_b64_tr_b16 v[172:173], v70 offset:17408
    ds_read_b64_tr_b16 v[174:175], v71 offset:17408
    ds_read_b64_tr_b16 v[176:177], v70 offset:4096
    ds_read_b64_tr_b16 v[178:179], v71 offset:4096
    ds_read_b64_tr_b16 v[180:181], v70 offset:5120
    ds_read_b64_tr_b16 v[182:183], v71 offset:5120
    ds_read_b64_tr_b16 v[184:185], v70 offset:20480
    ds_read_b64_tr_b16 v[186:187], v71 offset:20480
    ds_read_b64_tr_b16 v[188:189], v70 offset:21504
    ds_read_b64_tr_b16 v[190:191], v71 offset:21504
    buffer_load_dwordx4 v[36:39], v7, s[64:67], 0 offen offset:0 sc1
    buffer_load_dwordx4 v[40:43], v7, s[64:67], 0 offen offset:16 sc1
    buffer_load_dwordx4 v[44:47], v7, s[64:67], 0 offen offset:32 sc1
    buffer_load_dwordx4 v[48:51], v7, s[64:67], 0 offen offset:48 sc1
    global_load_ushort v52, v8, s[32:33] offset:0
    global_load_ushort v53, v8, s[32:33] offset:64
    ds_read_b128 v[224:227], v32 offset:0
    ds_read_b128 v[228:231], v32 offset:4096
    ds_read_b128 v[232:235], v32 offset:8192
    ds_read_b128 v[236:239], v32 offset:12288
    s_waitcnt lgkmcnt(15)
    s_waitcnt lgkmcnt(3)
    v_mfma_f32_32x32x16_bf16 v[96:111], v[160:163], v[224:227], 0
    ds_read_b128 v[240:243], v33 offset:0
    s_waitcnt lgkmcnt(3)
    v_mfma_f32_32x32x16_bf16 v[112:127], v[160:163], v[228:231], 0
    ds_read_b128 v[244:247], v33 offset:4096
    s_waitcnt lgkmcnt(3)
    v_mfma_f32_32x32x16_bf16 v[128:143], v[160:163], v[232:235], 0
    ds_read_b128 v[248:251], v33 offset:8192
    s_waitcnt lgkmcnt(3)
    v_mfma_f32_32x32x16_bf16 v[144:159], v[160:163], v[236:239], 0
    ds_read_b128 v[252:255], v33 offset:12288
    s_waitcnt lgkmcnt(3)
    v_mfma_f32_32x32x16_bf16 v[96:111], v[164:167], v[240:243], v[96:111]
    ds_read_b128 v[224:227], v34 offset:0
    s_waitcnt lgkmcnt(3)
    v_mfma_f32_32x32x16_bf16 v[112:127], v[164:167], v[244:247], v[112:127]
    ds_read_b128 v[228:231], v34 offset:4096
    s_waitcnt lgkmcnt(3)
    v_mfma_f32_32x32x16_bf16 v[128:143], v[164:167], v[248:251], v[128:143]
    ds_read_b128 v[232:235], v34 offset:8192
    s_waitcnt lgkmcnt(3)
    v_mfma_f32_32x32x16_bf16 v[144:159], v[164:167], v[252:255], v[144:159]
    ds_read_b128 v[236:239], v34 offset:12288
    s_waitcnt lgkmcnt(3)
    v_mfma_f32_32x32x16_bf16 v[96:111], v[168:171], v[224:227], v[96:111]
    ds_read_b128 v[240:243], v35 offset:0
    s_waitcnt lgkmcnt(3)
    v_mfma_f32_32x32x16_bf16 v[112:127], v[168:171], v[228:231], v[112:127]
    ds_read_b128 v[244:247], v35 offset:4096
    s_waitcnt lgkmcnt(3)
    v_mfma_f32_32x32x16_bf16 v[128:143], v[168:171], v[232:235], v[128:143]
    ds_read_b128 v[248:251], v35 offset:8192
    s_waitcnt lgkmcnt(3)
    v_mfma_f32_32x32x16_bf16 v[144:159], v[168:171], v[236:239], v[144:159]
    ds_read_b128 v[252:255], v35 offset:12288
    s_waitcnt lgkmcnt(3)
    v_mfma_f32_32x32x16_bf16 v[96:111], v[172:175], v[240:243], v[96:111]
    ds_read_b128 v[224:227], v32 offset:16384
    s_waitcnt lgkmcnt(3)
    v_mfma_f32_32x32x16_bf16 v[112:127], v[172:175], v[244:247], v[112:127]
    ds_read_b128 v[228:231], v32 offset:20480
    s_waitcnt lgkmcnt(3)
    v_mfma_f32_32x32x16_bf16 v[128:143], v[172:175], v[248:251], v[128:143]
    ds_read_b128 v[232:235], v32 offset:24576
    s_waitcnt lgkmcnt(3)
    v_mfma_f32_32x32x16_bf16 v[144:159], v[172:175], v[252:255], v[144:159]
    ds_read_b128 v[236:239], v32 offset:28672
    s_waitcnt vmcnt(6)
    s_cmp_eq_u32 s14, 1
    s_cbranch_scc1 c_hfs_l
    buffer_store_dword v23, v60, s[68:71], 0 offen sc1
    s_branch c_hfs_e
c_hfs_l:
    buffer_store_dword v23, v60, s[68:71], 0 offen
c_hfs_e:
    buffer_load_dword v19, v22, s[68:71], 0 offen sc1
    s_waitcnt lgkmcnt(3)
    v_mfma_f32_32x32x16_bf16 v[96:111], v[176:179], v[224:227], v[96:111]
    ds_read_b128 v[240:243], v33 offset:16384
    s_waitcnt lgkmcnt(3)
    v_mfma_f32_32x32x16_bf16 v[112:127], v[176:179], v[228:231], v[112:127]
    ds_read_b128 v[244:247], v33 offset:20480
    s_waitcnt lgkmcnt(3)
    v_mfma_f32_32x32x16_bf16 v[128:143], v[176:179], v[232:235], v[128:143]
    ds_read_b128 v[248:251], v33 offset:24576
    s_waitcnt lgkmcnt(3)
    v_mfma_f32_32x32x16_bf16 v[144:159], v[176:179], v[236:239], v[144:159]
    ds_read_b128 v[252:255], v33 offset:28672
    s_waitcnt lgkmcnt(3)
    v_mfma_f32_32x32x16_bf16 v[96:111], v[180:183], v[240:243], v[96:111]
    ds_read_b128 v[224:227], v34 offset:16384
    s_waitcnt lgkmcnt(3)
    v_mfma_f32_32x32x16_bf16 v[112:127], v[180:183], v[244:247], v[112:127]
    ds_read_b128 v[228:231], v34 offset:20480
    s_waitcnt lgkmcnt(3)
    v_mfma_f32_32x32x16_bf16 v[128:143], v[180:183], v[248:251], v[128:143]
    ds_read_b128 v[232:235], v34 offset:24576
    s_waitcnt lgkmcnt(3)
    v_mfma_f32_32x32x16_bf16 v[144:159], v[180:183], v[252:255], v[144:159]
    ds_read_b128 v[236:239], v34 offset:28672
    s_waitcnt lgkmcnt(3)
    v_mfma_f32_32x32x16_bf16 v[96:111], v[184:187], v[224:227], v[96:111]
    ds_read_b128 v[240:243], v35 offset:16384
    s_waitcnt lgkmcnt(3)
    v_mfma_f32_32x32x16_bf16 v[112:127], v[184:187], v[228:231], v[112:127]
    ds_read_b128 v[244:247], v35 offset:20480
    s_waitcnt lgkmcnt(3)
    v_mfma_f32_32x32x16_bf16 v[128:143], v[184:187], v[232:235], v[128:143]
    ds_read_b128 v[248:251], v35 offset:24576
    s_waitcnt lgkmcnt(3)
    v_mfma_f32_32x32x16_bf16 v[144:159], v[184:187], v[236:239], v[144:159]
    ds_read_b128 v[252:255], v35 offset:28672
    s_waitcnt vmcnt(0)
    v_cmp_eq_u32 s[90:91], 1, v19
    s_nop 1
    s_and_b32 s88, s90, 0xc
    s_cmp_eq_u32 s88, 0xc
    s_cbranch_scc0 c_n0_s
c_n0:
    s_cmp_le_u32 s15, 0
    s_cselect_b32 s11, 1, 0
    s_lshl_b32 s11, s11, 14
    buffer_load_dwordx4 v[192:195], v3, s[60:63], s11 offen offset:0 sc1
    buffer_load_dwordx4 v[196:199], v3, s[60:63], s11 offen offset:1024 sc1
    buffer_load_dwordx4 v[200:203], v2, s[60:63], s11 offen offset:0 sc1
    buffer_load_dwordx4 v[204:207], v2, s[60:63], s11 offen offset:1024 sc1
    s_cmp_le_u32 s15, 0
    s_cselect_b32 s11, 1, 0
    s_lshl_b32 s11, s11, 14
    s_add_u32 s11, s11, 8192
    buffer_load_dwordx4 v[208:211], v3, s[60:63], s11 offen offset:0 sc1
    buffer_load_dwordx4 v[212:215], v3, s[60:63], s11 offen offset:1024 sc1
    buffer_load_dwordx4 v[216:219], v2, s[60:63], s11 offen offset:0 sc1
    buffer_load_dwordx4 v[220:223], v2, s[60:63], s11 offen offset:1024 sc1
    buffer_load_dword v19, v22, s[68:71], 0 offen sc1
    s_barrier
    s_waitcnt lgkmcnt(3)
    v_mfma_f32_32x32x16_bf16 v[96:111], v[188:191], v[240:243], v[96:111]
    ds_read_b128 v[224:227], v32 offset:32768
    s_waitcnt lgkmcnt(3)
    v_mfma_f32_32x32x16_bf16 v[112:127], v[188:191], v[244:247], v[112:127]
    ds_read_b128 v[228:231], v32 offset:36864
    s_waitcnt lgkmcnt(3)
    v_mfma_f32_32x32x16_bf16 v[128:143], v[188:191], v[248:251], v[128:143]
    ds_read_b128 v[232:235], v32 offset:40960
    s_waitcnt lgkmcnt(3)
    v_mfma_f32_32x32x16_bf16 v[144:159], v[188:191], v[252:255], v[144:159]
    ds_read_b128 v[236:239], v32 offset:45056
    s_waitcnt vmcnt(8)
    s_waitcnt lgkmcnt(3)
    v_mfma_f32_32x32x16_bf16 v[96:111], v[192:195], v[224:227], v[96:111]
    ds_read_b128 v[240:243], v33 offset:32768
    s_waitcnt lgkmcnt(3)
    v_mfma_f32_32x32x16_bf16 v[112:127], v[192:195], v[228:231], v[112:127]
    ds_read_b128 v[244:247], v33 offset:36864
    s_waitcnt lgkmcnt(3)
    v_mfma_f32_32x32x16_bf16 v[128:143], v[192:195], v[232:235], v[128:143]
    ds_read_b128 v[248:251], v33 offset:40960
    s_waitcnt lgkmcnt(3)
    v_mfma_f32_32x32x16_bf16 v[144:159], v[192:195], v[236:239], v[144:159]
    ds_read_b128 v[252:255], v33 offset:45056
    s_waitcnt vmcnt(0)
    v_cmp_eq_u32 s[90:91], 1, v19
    s_nop 1
    s_and_b32 s88, s90, 0x3c
    s_cmp_eq_u32 s88, 0x3c
    s_cbranch_scc0 c_n1_s
c_n1:
    s_cmp_le_u32 s15, 1
    s_cselect_b32 s11, 2, 1
    s_lshl_b32 s11, s11, 14
    buffer_load_dwordx4 v[160:163], v3, s[60:63], s11 offen offset:0 sc1
    buffer_load_dwordx4 v[164:167], v3, s[60:63], s11 offen offset:1024 sc1
    buffer_load_dwordx4 v[168:171], v2, s[60:63], s11 offen offset:0 sc1
    buffer_load_dwordx4 v[172:175], v2, s[60:63], s11 offen offset:1024 sc1
    buffer_load_dword v19, v22, s[68:71], 0 offen sc1
    s_cmp_le_u32 s15, 1
    s_cselect_b32 s11, 2, 1
    s_lshl_b32 s11, s11, 14
    s_add_u32 s11, s11, 8192
    buffer_load_dwordx4 v[176:179], v3, s[60:63], s11 offen offset:0 sc1
    s_waitcnt lgkmcnt(3)
    v_mfma_f32_32x32x16_bf16 v[96:111], v[196:199], v[240:243], v[96:111]
    ds_read_b128 v[224:227], v34 offset:32768
    s_waitcnt lgkmcnt(3)
    v_mfma_f32_32x32x16_bf16 v[112:127], v[196:199], v[244:247], v[112:127]
    ds_read_b128 v[228:231], v34 offset:36864
    s_waitcnt lgkmcnt(3)
    v_mfma_f32_32x32x16_bf16 v[128:143], v[196:199], v[248:251], v[128:143]
    ds_read_b128 v[232:235], v34 offset:40960
    s_waitcnt lgkmcnt(3)
    v_mfma_f32_32x32x16_bf16 v[144:159], v[196:199], v[252:255], v[144:159]
    ds_read_b128 v[236:239], v34 offset:45056
    buffer_load_dwordx4 v[180:183], v3, s[60:63], s11 offen offset:1024 sc1
    s_waitcnt lgkmcnt(3)
    v_mfma_f32_32x32x16_bf16 v[96:111], v[200:203], v[224:227], v[96:111]
    ds_read_b128 v[240:243], v35 offset:32768
    s_waitcnt lgkmcnt(3)
    v_mfma_f32_32x32x16_bf16 v[112:127], v[200:203], v[228:231], v[112:127]
    ds_read_b128 v[244:247], v35 offset:36864
    s_waitcnt lgkmcnt(3)
    v_mfma_f32_32x32x16_bf16 v[128:143], v[200:203], v[232:235], v[128:143]
    ds_read_b128 v[248:251], v35 offset:40960
    s_waitcnt lgkmcnt(3)
    v_mfma_f32_32x32x16_bf16 v[144:159], v[200:203], v[236:239], v[144:159]
    ds_read_b128 v[252:255], v35 offset:45056
    buffer_load_dwordx4 v[184:187], v2, s[60:63], s11 offen offset:0 sc1
    s_barrier
    s_waitcnt lgkmcnt(3)
    v_mfma_f32_32x32x16_bf16 v[96:111], v[204:207], v[240:243], v[96:111]
    ds_read_b128 v[224:227], v32 offset:49152
    s_waitcnt lgkmcnt(3)
    v_mfma_f32_32x32x16_bf16 v[112:127], v[204:207], v[244:247], v[112:127]
    ds_read_b128 v[228:231], v32 offset:53248
    s_waitcnt lgkmcnt(3)
    v_mfma_f32_32x32x16_bf16 v[128:143], v[204:207], v[248:251], v[128:143]
    ds_read_b128 v[232:235], v32 offset:57344
    s_waitcnt lgkmcnt(3)
    v_mfma_f32_32x32x16_bf16 v[144:159], v[204:207], v[252:255], v[144:159]
    ds_read_b128 v[236:239], v32 offset:61440
    buffer_load_dwordx4 v[188:191], v2, s[60:63], s11 offen offset:1024 sc1
    s_waitcnt lgkmcnt(3)
    v_mfma_f32_32x32x16_bf16 v[96:111], v[208:211], v[224:227], v[96:111]
    ds_read_b128 v[240:243], v33 offset:49152
    s_waitcnt lgkmcnt(3)
    v_mfma_f32_32x32x16_bf16 v[112:127], v[208:211], v[228:231], v[112:127]
    ds_read_b128 v[244:247], v33 offset:53248
    s_waitcnt lgkmcnt(3)
    v_mfma_f32_32x32x16_bf16 v[128:143], v[208:211], v[232:235], v[128:143]
    ds_read_b128 v[248:251], v33 offset:57344
    s_waitcnt lgkmcnt(3)
    v_mfma_f32_32x32x16_bf16 v[144:159], v[208:211], v[236:239], v[144:159]
    ds_read_b128 v[252:255], v33 offset:61440
    s_waitcnt vmcnt(4)
    v_cmp_eq_u32 s[90:91], 1, v19
    s_nop 1
    s_and_b32 s88, s90, 0xfc
    s_cmp_eq_u32 s88, 0xfc
    s_cbranch_scc0 c_n2_s
c_n2:
    s_cmp_le_u32 s15, 2
    s_cselect_b32 s11, 3, 2
    s_lshl_b32 s11, s11, 14
    buffer_load_dwordx4 v[192:195], v3, s[60:63], s11 offen offset:0 sc1
    s_waitcnt lgkmcnt(3)
    v_mfma_f32_32x32x16_bf16 v[96:111], v[212:215], v[240:243], v[96:111]
    ds_read_b128 v[224:227], v34 offset:49152
    s_waitcnt lgkmcnt(3)
    v_mfma_f32_32x32x16_bf16 v[112:127], v[212:215], v[244:247], v[112:127]
    ds_read_b128 v[228:231], v34 offset:53248
    s_waitcnt lgkmcnt(3)
    v_mfma_f32_32x32x16_bf16 v[128:143], v[212:215], v[248:251], v[128:143]
    ds_read_b128 v[232:235], v34 offset:57344
    s_waitcnt lgkmcnt(3)
    v_mfma_f32_32x32x16_bf16 v[144:159], v[212:215], v[252:255], v[144:159]
    ds_read_b128 v[236:239], v34 offset:61440
    buffer_load_dwordx4 v[196:199], v3, s[60:63], s11 offen offset:1024 sc1
    s_waitcnt lgkmcnt(3)
    v_mfma_f32_32x32x16_bf16 v[96:111], v[216:219], v[224:227], v[96:111]
    ds_read_b128 v[240:243], v35 offset:49152
    s_waitcnt lgkmcnt(3)
    v_mfma_f32_32x32x16_bf16 v[112:127], v[216:219], v[228:231], v[112:127]
    ds_read_b128 v[244:247], v35 offset:53248
    s_waitcnt lgkmcnt(3)
    v_mfma_f32_32x32x16_bf16 v[128:143], v[216:219], v[232:235], v[128:143]
    ds_read_b128 v[248:251], v35 offset:57344
    s_waitcnt lgkmcnt(3)
    v_mfma_f32_32x32x16_bf16 v[144:159], v[216:219], v[236:239], v[144:159]
    ds_read_b128 v[252:255], v35 offset:61440
    buffer_load_dwordx4 v[200:203], v2, s[60:63], s11 offen offset:0 sc1
    s_barrier
    s_waitcnt lgkmcnt(3)
    v_mfma_f32_32x32x16_bf16 v[96:111], v[220:223], v[240:243], v[96:111]
    ds_read_b128 v[224:227], v32 offset:0
    s_waitcnt lgkmcnt(3)
    v_mfma_f32_32x32x16_bf16 v[112:127], v[220:223], v[244:247], v[112:127]
    ds_read_b128 v[228:231], v32 offset:4096
    s_waitcnt lgkmcnt(3)
    v_mfma_f32_32x32x16_bf16 v[128:143], v[220:223], v[248:251], v[128:143]
    ds_read_b128 v[232:235], v32 offset:8192
    s_waitcnt lgkmcnt(3)
    v_mfma_f32_32x32x16_bf16 v[144:159], v[220:223], v[252:255], v[144:159]
    ds_read_b128 v[236:239], v32 offset:12288
    buffer_load_dwordx4 v[204:207], v2, s[60:63], s11 offen offset:1024 sc1
    s_waitcnt lgkmcnt(3)
    v_mfma_f32_32x32x16_bf16 v[96:111], v[160:163], v[224:227], v[96:111]
    ds_read_b128 v[240:243], v33 offset:0
    s_waitcnt lgkmcnt(3)
    v_mfma_f32_32x32x16_bf16 v[112:127], v[160:163], v[228:231], v[112:127]
    ds_read_b128 v[244:247], v33 offset:4096
    s_waitcnt lgkmcnt(3)
    v_mfma_f32_32x32x16_bf16 v[128:143], v[160:163], v[232:235], v[128:143]
    ds_read_b128 v[248:251], v33 offset:8192
    s_waitcnt lgkmcnt(3)
    v_mfma_f32_32x32x16_bf16 v[144:159], v[160:163], v[236:239], v[144:159]
    ds_read_b128 v[252:255], v33 offset:12288
    s_cmp_le_u32 s15, 2
    s_cselect_b32 s11, 3, 2
    s_lshl_b32 s11, s11, 14
    s_add_u32 s11, s11, 8192
    buffer_load_dwordx4 v[208:211], v3, s[60:63], s11 offen offset:0 sc1
    s_waitcnt lgkmcnt(3)
    v_mfma_f32_32x32x16_bf16 v[96:111], v[164:167], v[240:243], v[96:111]
    ds_read_b128 v[224:227], v34 offset:0
    s_waitcnt lgkmcnt(3)
    v_mfma_f32_32x32x16_bf16 v[112:127], v[164:167], v[244:247], v[112:127]
    ds_read_b128 v[228:231], v34 offset:4096
    s_waitcnt lgkmcnt(3)
    v_mfma_f32_32x32x16_bf16 v[128:143], v[164:167], v[248:251], v[128:143]
    ds_read_b128 v[232:235], v34 offset:8192
    s_waitcnt lgkmcnt(3)
    v_mfma_f32_32x32x16_bf16 v[144:159], v[164:167], v[252:255], v[144:159]
    ds_read_b128 v[236:239], v34 offset:12288
    buffer_load_dwordx4 v[212:215], v3, s[60:63], s11 offen offset:1024 sc1
    s_waitcnt lgkmcnt(3)
    v_mfma_f32_32x32x16_bf16 v[96:111], v[168:171], v[224:227], v[96:111]
    ds_read_b128 v[240:243], v35 offset:0
    s_waitcnt lgkmcnt(3)
    v_mfma_f32_32x32x16_bf16 v[112:127], v[168:171], v[228:231], v[112:127]
    ds_read_b128 v[244:247], v35 offset:4096
    s_waitcnt lgkmcnt(3)
    v_mfma_f32_32x32x16_bf16 v[128:143], v[168:171], v[232:235], v[128:143]
    ds_read_b128 v[248:251], v35 offset:8192
    s_waitcnt lgkmcnt(3)
    v_mfma_f32_32x32x16_bf16 v[144:159], v[168:171], v[236:239], v[144:159]
    ds_read_b128 v[252:255], v35 offset:12288
    buffer_load_dwordx4 v[216:219], v2, s[60:63], s11 offen offset:0 sc1
    s_barrier
    s_waitcnt lgkmcnt(3)
    v_mfma_f32_32x32x16_bf16 v[96:111], v[172:175], v[240:243], v[96:111]
    ds_read_b128 v[224:227], v32 offset:16384
    s_waitcnt lgkmcnt(3)
    v_mfma_f32_32x32x16_bf16 v[112:127], v[172:175], v[244:247], v[112:127]
    ds_read_b128 v[228:231], v32 offset:20480
    s_waitcnt lgkmcnt(3)
    v_mfma_f32_32x32x16_bf16 v[128:143], v[172:175], v[248:251], v[128:143]
    ds_read_b128 v[232:235], v32 offset:24576
    s_waitcnt lgkmcnt(3)
    v_mfma_f32_32x32x16_bf16 v[144:159], v[172:175], v[252:255], v[144:159]
    ds_read_b128 v[236:239], v32 offset:28672
    buffer_load_dwordx4 v[220:223], v2, s[60:63], s11 offen offset:1024 sc1
    s_waitcnt vmcnt(11)
    s_waitcnt lgkmcnt(3)
    v_mfma_f32_32x32x16_bf16 v[96:111], v[176:179], v[224:227], v[96:111]
    ds_read_b128 v[240:243], v33 offset:16384
    s_waitcnt lgkmcnt(3)
    v_mfma_f32_32x32x16_bf16 v[112:127], v[176:179], v[228:231], v[112:127]
    ds_read_b128 v[244:247], v33 offset:20480
    s_waitcnt lgkmcnt(3)
    v_mfma_f32_32x32x16_bf16 v[128:143], v[176:179], v[232:235], v[128:143]
    ds_read_b128 v[248:251], v33 offset:24576
    s_waitcnt lgkmcnt(3)
    v_mfma_f32_32x32x16_bf16 v[144:159], v[176:179], v[236:239], v[144:159]
    ds_read_b128 v[252:255], v33 offset:28672
    s_and_b32 s88, s90, 0x3fc
    s_cmp_eq_u32 s88, 0x3fc
    s_cbranch_scc0 c_n3_s
c_n3:
    s_cmp_le_u32 s15, 3
    s_cselect_b32 s11, 4, 3
    s_lshl_b32 s11, s11, 14
    buffer_load_dwordx4 v[160:163], v3, s[60:63], s11 offen offset:0 sc1
    s_waitcnt vmcnt(11)
    s_waitcnt lgkmcnt(3)
    v_mfma_f32_32x32x16_bf16 v[96:111], v[180:183], v[240:243], v[96:111]
    ds_read_b128 v[224:227], v34 offset:16384
    s_waitcnt lgkmcnt(3)
    v_mfma_f32_32x32x16_bf16 v[112:127], v[180:183], v[244:247], v[112:127]
    ds_read_b128 v[228:231], v34 offset:20480
    s_waitcnt lgkmcnt(3)
    v_mfma_f32_32x32x16_bf16 v[128:143], v[180:183], v[248:251], v[128:143]
    ds_read_b128 v[232:235], v34 offset:24576
    s_waitcnt lgkmcnt(3)
    v_mfma_f32_32x32x16_bf16 v[144:159], v[180:183], v[252:255], v[144:159]
    ds_read_b128 v[236:239], v34 offset:28672
    buffer_load_dwordx4 v[164:167], v3, s[60:63], s11 offen offset:1024 sc1
    s_waitcnt vmcnt(11)
    s_waitcnt lgkmcnt(3)
    v_mfma_f32_32x32x16_bf16 v[96:111], v[184:187], v[224:227], v[96:111]
    ds_read_b128 v[240:243], v35 offset:16384
    s_waitcnt lgkmcnt(3)
    v_mfma_f32_32x32x16_bf16 v[112:127], v[184:187], v[228:231], v[112:127]
    ds_read_b128 v[244:247], v35 offset:20480
    s_waitcnt lgkmcnt(3)
    v_mfma_f32_32x32x16_bf16 v[128:143], v[184:187], v[232:235], v[128:143]
    ds_read_b128 v[248:251], v35 offset:24576
    s_waitcnt lgkmcnt(3)
    v_mfma_f32_32x32x16_bf16 v[144:159], v[184:187], v[236:239], v[144:159]
    ds_read_b128 v[252:255], v35 offset:28672
    buffer_load_dwordx4 v[168:171], v2, s[60:63], s11 offen offset:0 sc1
    s_barrier
    s_waitcnt vmcnt(11)
    s_waitcnt lgkmcnt(3)
    v_mfma_f32_32x32x16_bf16 v[96:111], v[188:191], v[240:243], v[96:111]
    ds_read_b128 v[224:227], v32 offset:32768
    s_waitcnt lgkmcnt(3)
    v_mfma_f32_32x32x16_bf16 v[112:127], v[188:191], v[244:247], v[112:127]
    ds_read_b128 v[228:231], v32 offset:36864
    s_waitcnt lgkmcnt(3)
    v_mfma_f32_32x32x16_bf16 v[128:143], v[188:191], v[248:251], v[128:143]
    ds_read_b128 v[232:235], v32 offset:40960
    s_waitcnt lgkmcnt(3)
    v_mfma_f32_32x32x16_bf16 v[144:159], v[188:191], v[252:255], v[144:159]
    ds_read_b128 v[236:239], v32 offset:45056
    buffer_load_dwordx4 v[172:175], v2, s[60:63], s11 offen offset:1024 sc1
    s_waitcnt vmcnt(11)
    s_waitcnt lgkmcnt(3)
    v_mfma_f32_32x32x16_bf16 v[96:111], v[192:195], v[224:227], v[96:111]
    ds_read_b128 v[240:243], v33 offset:32768
    s_waitcnt lgkmcnt(3)
    v_mfma_f32_32x32x16_bf16 v[112:127], v[192:195], v[228:231], v[112:127]
    ds_read_b128 v[244:247], v33 offset:36864
    s_waitcnt lgkmcnt(3)
    v_mfma_f32_32x32x16_bf16 v[128:143], v[192:195], v[232:235], v[128:143]
    ds_read_b128 v[248:251], v33 offset:40960
    s_waitcnt lgkmcnt(3)
    v_mfma_f32_32x32x16_bf16 v[144:159], v[192:195], v[236:239], v[144:159]
    ds_read_b128 v[252:255], v33 offset:45056
    s_cmp_le_u32 s15, 3
    s_cselect_b32 s11, 4, 3
    s_lshl_b32 s11, s11, 14
    s_add_u32 s11, s11, 8192
    buffer_load_dwordx4 v[176:179], v3, s[60:63], s11 offen offset:0 sc1
    s_waitcnt vmcnt(11)
    s_waitcnt lgkmcnt(3)
    v_mfma_f32_32x32x16_bf16 v[96:111], v[196:199], v[240:243], v[96:111]
    ds_read_b128 v[224:227], v34 offset:32768
    s_waitcnt lgkmcnt(3)
    v_mfma_f32_32x32x16_bf16 v[112:127], v[196:199], v[244:247], v[112:127]
    ds_read_b128 v[228:231], v34 offset:36864
    s_waitcnt lgkmcnt(3)
    v_mfma_f32_32x32x16_bf16 v[128:143], v[196:199], v[248:251], v[128:143]
    ds_read_b128 v[232:235], v34 offset:40960
    s_waitcnt lgkmcnt(3)
    v_mfma_f32_32x32x16_bf16 v[144:159], v[196:199], v[252:255], v[144:159]
    ds_read_b128 v[236:239], v34 offset:45056
    buffer_load_dwordx4 v[180:183], v3, s[60:63], s11 offen offset:1024 sc1
    s_waitcnt vmcnt(11)
    s_waitcnt lgkmcnt(3)
    v_mfma_f32_32x32x16_bf16 v[96:111], v[200:203], v[224:227], v[96:111]
    ds_read_b128 v[240:243], v35 offset:32768
    s_waitcnt lgkmcnt(3)
    v_mfma_f32_32x32x16_bf16 v[112:127], v[200:203], v[228:231], v[112:127]
    ds_read_b128 v[244:247], v35 offset:36864
    s_waitcnt lgkmcnt(3)
    v_mfma_f32_32x32x16_bf16 v[128:143], v[200:203], v[232:235], v[128:143]
    ds_read_b128 v[248:251], v35 offset:40960
    s_waitcnt lgkmcnt(3)
    v_mfma_f32_32x32x16_bf16 v[144:159], v[200:203], v[236:239], v[144:159]
    ds_read_b128 v[252:255], v35 offset:45056
    buffer_load_dwordx4 v[184:187], v2, s[60:63], s11 offen offset:0 sc1
    s_barrier
    s_waitcnt vmcnt(11)
    s_waitcnt lgkmcnt(3)
    v_mfma_f32_32x32x16_bf16 v[96:111], v[204:207], v[240:243], v[96:111]
    ds_read_b128 v[224:227], v32 offset:49152
    s_waitcnt lgkmcnt(3)
    v_mfma_f32_32x32x16_bf16 v[112:127], v[204:207], v[244:247], v[112:127]
    ds_read_b128 v[228:231], v32 offset:53248
    s_waitcnt lgkmcnt(3)
    v_mfma_f32_32x32x16_bf16 v[128:143], v[204:207], v[248:251], v[128:143]
    ds_read_b128 v[232:235], v32 offset:57344
    s_waitcnt lgkmcnt(3)
    v_mfma_f32_32x32x16_bf16 v[144:159], v[204:207], v[252:255], v[144:159]
    ds_read_b128 v[236:239], v32 offset:61440
    buffer_load_dwordx4 v[188:191], v2, s[60:63], s11 offen offset:1024 sc1
    s_waitcnt vmcnt(11)
    s_waitcnt lgkmcnt(3)
    v_mfma_f32_32x32x16_bf16 v[96:111], v[208:211], v[224:227], v[96:111]
    ds_read_b128 v[240:243], v33 offset:49152
    s_waitcnt lgkmcnt(3)
    v_mfma_f32_32x32x16_bf16 v[112:127], v[208:211], v[228:231], v[112:127]
    ds_read_b128 v[244:247], v33 offset:53248
    s_waitcnt lgkmcnt(3)
    v_mfma_f32_32x32x16_bf16 v[128:143], v[208:211], v[232:235], v[128:143]
    ds_read_b128 v[248:251], v33 offset:57344
    s_waitcnt lgkmcnt(3)
    v_mfma_f32_32x32x16_bf16 v[144:159], v[208:211], v[236:239], v[144:159]
    ds_read_b128 v[252:255], v33 offset:61440
    s_and_b32 s88, s90, 0xffc
    s_cmp_eq_u32 s88, 0xffc
    s_cbranch_scc0 c_n4_s
c_n4:
    s_cmp_le_u32 s15, 4
    s_cselect_b32 s11, 5, 4
    s_lshl_b32 s11, s11, 14
    buffer_load_dwordx4 v[192:195], v3, s[60:63], s11 offen offset:0 sc1
    s_waitcnt vmcnt(11)
    s_waitcnt lgkmcnt(3)
    v_mfma_f32_32x32x16_bf16 v[96:111], v[212:215], v[240:243], v[96:111]
    ds_read_b128 v[224:227], v34 offset:49152
    s_waitcnt lgkmcnt(3)
    v_mfma_f32_32x32x16_bf16 v[112:127], v[212:215], v[244:247], v[112:127]
    ds_read_b128 v[228:231], v34 offset:53248
    s_waitcnt lgkmcnt(3)
    v_mfma_f32_32x32x16_bf16 v[128:143], v[212:215], v[248:251], v[128:143]
    ds_read_b128 v[232:235], v34 offset:57344
    s_waitcnt lgkmcnt(3)
    v_mfma_f32_32x32x16_bf16 v[144:159], v[212:215], v[252:255], v[144:159]
    ds_read_b128 v[236:239], v34 offset:61440
    buffer_load_dwordx4 v[196:199], v3, s[60:63], s11 offen offset:1024 sc1
    s_waitcnt vmcnt(11)
    s_waitcnt lgkmcnt(3)
    v_mfma_f32_32x32x16_bf16 v[96:111], v[216:219], v[224:227], v[96:111]
    ds_read_b128 v[240:243], v35 offset:49152
    s_waitcnt lgkmcnt(3)
    v_mfma_f32_32x32x16_bf16 v[112:127], v[216:219], v[228:231], v[112:127]
    ds_read_b128 v[244:247], v35 offset:53248
    s_waitcnt lgkmcnt(3)
    v_mfma_f32_32x32x16_bf16 v[128:143], v[216:219], v[232:235], v[128:143]
    ds_read_b128 v[248:251], v35 offset:57344
    s_waitcnt lgkmcnt(3)
    v_mfma_f32_32x32x16_bf16 v[144:159], v[216:219], v[236:239], v[144:159]
    ds_read_b128 v[252:255], v35 offset:61440
    buffer_load_dwordx4 v[200:203], v2, s[60:63], s11 offen offset:0 sc1
    s_barrier
    s_waitcnt vmcnt(11)
    s_waitcnt lgkmcnt(3)
    v_mfma_f32_32x32x16_bf16 v[96:111], v[220:223], v[240:243], v[96:111]
    ds_read_b128 v[224:227], v32 offset:0
    s_waitcnt lgkmcnt(3)
    v_mfma_f32_32x32x16_bf16 v[112:127], v[220:223], v[244:247], v[112:127]
    ds_read_b128 v[228:231], v32 offset:4096
    s_waitcnt lgkmcnt(3)
    v_mfma_f32_32x32x16_bf16 v[128:143], v[220:223], v[248:251], v[128:143]
    ds_read_b128 v[232:235], v32 offset:8192
    s_waitcnt lgkmcnt(3)
    v_mfma_f32_32x32x16_bf16 v[144:159], v[220:223], v[252:255], v[144:159]
    ds_read_b128 v[236:239], v32 offset:12288
    buffer_load_dwordx4 v[204:207], v2, s[60:63], s11 offen offset:1024 sc1
    s_waitcnt vmcnt(11)
    s_waitcnt lgkmcnt(3)
    v_mfma_f32_32x32x16_bf16 v[96:111], v[160:163], v[224:227], v[96:111]
    ds_read_b128 v[240:243], v33 offset:0
    s_waitcnt lgkmcnt(3)
    v_mfma_f32_32x32x16_bf16 v[112:127], v[160:163], v[228:231], v[112:127]
    ds_read_b128 v[244:247], v33 offset:4096
    s_waitcnt lgkmcnt(3)
    v_mfma_f32_32x32x16_bf16 v[128:143], v[160:163], v[232:235], v[128:143]
    ds_read_b128 v[248:251], v33 offset:8192
    s_waitcnt lgkmcnt(3)
    v_mfma_f32_32x32x16_bf16 v[144:159], v[160:163], v[236:239], v[144:159]
    ds_read_b128 v[252:255], v33 offset:12288
    s_cmp_le_u32 s15, 4
    s_cselect_b32 s11, 5, 4
    s_lshl_b32 s11, s11, 14
    s_add_u32 s11, s11, 8192
    buffer_load_dwordx4 v[208:211], v3, s[60:63], s11 offen offset:0 sc1
    s_waitcnt vmcnt(11)
    s_waitcnt lgkmcnt(3)
    v_mfma_f32_32x32x16_bf16 v[96:111], v[164:167], v[240:243], v[96:111]
    ds_read_b128 v[224:227], v34 offset:0
    s_waitcnt lgkmcnt(3)
    v_mfma_f32_32x32x16_bf16 v[112:127], v[164:167], v[244:247], v[112:127]
    ds_read_b128 v[228:231], v34 offset:4096
    s_waitcnt lgkmcnt(3)
    v_mfma_f32_32x32x16_bf16 v[128:143], v[164:167], v[248:251], v[128:143]
    ds_read_b128 v[232:235], v34 offset:8192
    s_waitcnt lgkmcnt(3)
    v_mfma_f32_32x32x16_bf16 v[144:159], v[164:167], v[252:255], v[144:159]
    ds_read_b128 v[236:239], v34 offset:12288
    buffer_load_dwordx4 v[212:215], v3, s[60:63], s11 offen offset:1024 sc1
    s_waitcnt vmcnt(11)
    s_waitcnt lgkmcnt(3)
    v_mfma_f32_32x32x16_bf16 v[96:111], v[168:171], v[224:227], v[96:111]
    ds_read_b128 v[240:243], v35 offset:0
    s_waitcnt lgkmcnt(3)
    v_mfma_f32_32x32x16_bf16 v[112:127], v[168:171], v[228:231], v[112:127]
    ds_read_b128 v[244:247], v35 offset:4096
    s_waitcnt lgkmcnt(3)
    v_mfma_f32_32x32x16_bf16 v[128:143], v[168:171], v[232:235], v[128:143]
    ds_read_b128 v[248:251], v35 offset:8192
    s_waitcnt lgkmcnt(3)
    v_mfma_f32_32x32x16_bf16 v[144:159], v[168:171], v[236:239], v[144:159]
    ds_read_b128 v[252:255], v35 offset:12288
    buffer_load_dwordx4 v[216:219], v2, s[60:63], s11 offen offset:0 sc1
    s_barrier
    s_waitcnt vmcnt(11)
    s_waitcnt lgkmcnt(3)
    v_mfma_f32_32x32x16_bf16 v[96:111], v[172:175], v[240:243], v[96:111]
    ds_read_b128 v[224:227], v32 offset:16384
    s_waitcnt lgkmcnt(3)
    v_mfma_f32_32x32x16_bf16 v[112:127], v[172:175], v[244:247], v[112:127]
    ds_read_b128 v[228:231], v32 offset:20480
    s_waitcnt lgkmcnt(3)
    v_mfma_f32_32x32x16_bf16 v[128:143], v[172:175], v[248:251], v[128:143]
    ds_read_b128 v[232:235], v32 offset:24576
    s_waitcnt lgkmcnt(3)
    v_mfma_f32_32x32x16_bf16 v[144:159], v[172:175], v[252:255], v[144:159]
    ds_read_b128 v[236:239], v32 offset:28672
    buffer_load_dwordx4 v[220:223], v2, s[60:63], s11 offen offset:1024 sc1
    s_waitcnt vmcnt(11)
    s_waitcnt lgkmcnt(3)
    v_mfma_f32_32x32x16_bf16 v[96:111], v[176:179], v[224:227], v[96:111]
    ds_read_b128 v[240:243], v33 offset:16384
    s_waitcnt lgkmcnt(3)
    v_mfma_f32_32x32x16_bf16 v[112:127], v[176:179], v[228:231], v[112:127]
    ds_read_b128 v[244:247], v33 offset:20480
    s_waitcnt lgkmcnt(3)
    v_mfma_f32_32x32x16_bf16 v[128:143], v[176:179], v[232:235], v[128:143]
    ds_read_b128 v[248:251], v33 offset:24576
    s_waitcnt lgkmcnt(3)
    v_mfma_f32_32x32x16_bf16 v[144:159], v[176:179], v[236:239], v[144:159]
    ds_read_b128 v[252:255], v33 offset:28672
    s_and_b32 s88, s90, 0x3ffc
    s_cmp_eq_u32 s88, 0x3ffc
    s_cbranch_scc0 c_n5_s
c_n5:
    s_cmp_le_u32 s15, 5
    s_cselect_b32 s11, 6, 5
    s_lshl_b32 s11, s11, 14
    buffer_load_dwordx4 v[160:163], v3, s[60:63], s11 offen offset:0 sc1
    s_waitcnt vmcnt(11)
    s_waitcnt lgkmcnt(3)
    v_mfma_f32_32x32x16_bf16 v[96:111], v[180:183], v[240:243], v[96:111]
    ds_read_b128 v[224:227], v34 offset:16384
    s_waitcnt lgkmcnt(3)
    v_mfma_f32_32x32x16_bf16 v[112:127], v[180:183], v[244:247], v[112:127]
    ds_read_b128 v[228:231], v34 offset:20480
    s_waitcnt lgkmcnt(3)
    v_mfma_f32_32x32x16_bf16 v[128:143], v[180:183], v[248:251], v[128:143]
    ds_read_b128 v[232:235], v34 offset:24576
    s_waitcnt lgkmcnt(3)
    v_mfma_f32_32x32x16_bf16 v[144:159], v[180:183], v[252:255], v[144:159]
    ds_read_b128 v[236:239], v34 offset:28672
    buffer_load_dwordx4 v[164:167], v3, s[60:63], s11 offen offset:1024 sc1
    s_waitcnt vmcnt(11)
    s_waitcnt lgkmcnt(3)
    v_mfma_f32_32x32x16_bf16 v[96:111], v[184:187], v[224:227], v[96:111]
    ds_read_b128 v[240:243], v35 offset:16384
    s_waitcnt lgkmcnt(3)
    v_mfma_f32_32x32x16_bf16 v[112:127], v[184:187], v[228:231], v[112:127]
    ds_read_b128 v[244:247], v35 offset:20480
    s_waitcnt lgkmcnt(3)
    v_mfma_f32_32x32x16_bf16 v[128:143], v[184:187], v[232:235], v[128:143]
    ds_read_b128 v[248:251], v35 offset:24576
    s_waitcnt lgkmcnt(3)
    v_mfma_f32_32x32x16_bf16 v[144:159], v[184:187], v[236:239], v[144:159]
    ds_read_b128 v[252:255], v35 offset:28672
    buffer_load_dwordx4 v[168:171], v2, s[60:63], s11 offen offset:0 sc1
    s_barrier
    s_waitcnt vmcnt(11)
    s_waitcnt lgkmcnt(3)
    v_mfma_f32_32x32x16_bf16 v[96:111], v[188:191], v[240:243], v[96:111]
    ds_read_b128 v[224:227], v32 offset:32768
    s_waitcnt lgkmcnt(3)
    v_mfma_f32_32x32x16_bf16 v[112:127], v[188:191], v[244:247], v[112:127]
    ds_read_b128 v[228:231], v32 offset:36864
    s_waitcnt lgkmcnt(3)
    v_mfma_f32_32x32x16_bf16 v[128:143], v[188:191], v[248:251], v[128:143]
    ds_read_b128 v[232:235], v32 offset:40960
    s_waitcnt lgkmcnt(3)
    v_mfma_f32_32x32x16_bf16 v[144:159], v[188:191], v[252:255], v[144:159]
    ds_read_b128 v[236:239], v32 offset:45056
    buffer_load_dwordx4 v[172:175], v2, s[60:63], s11 offen offset:1024 sc1
    s_waitcnt vmcnt(11)
    s_waitcnt lgkmcnt(3)
    v_mfma_f32_32x32x16_bf16 v[96:111], v[192:195], v[224:227], v[96:111]
    ds_read_b128 v[240:243], v33 offset:32768
    s_waitcnt lgkmcnt(3)
    v_mfma_f32_32x32x16_bf16 v[112:127], v[192:195], v[228:231], v[112:127]
    ds_read_b128 v[244:247], v33 offset:36864
    s_waitcnt lgkmcnt(3)
    v_mfma_f32_32x32x16_bf16 v[128:143], v[192:195], v[232:235], v[128:143]
    ds_read_b128 v[248:251], v33 offset:40960
    s_waitcnt lgkmcnt(3)
    v_mfma_f32_32x32x16_bf16 v[144:159], v[192:195], v[236:239], v[144:159]
    ds_read_b128 v[252:255], v33 offset:45056
    s_cmp_le_u32 s15, 5
    s_cselect_b32 s11, 6, 5
    s_lshl_b32 s11, s11, 14
    s_add_u32 s11, s11, 8192
    buffer_load_dwordx4 v[176:179], v3, s[60:63], s11 offen offset:0 sc1
    s_waitcnt vmcnt(11)
    s_waitcnt lgkmcnt(3)
    v_mfma_f32_32x32x16_bf16 v[96:111], v[196:199], v[240:243], v[96:111]
    ds_read_b128 v[224:227], v34 offset:32768
    s_waitcnt lgkmcnt(3)
    v_mfma_f32_32x32x16_bf16 v[112:127], v[196:199], v[244:247], v[112:127]
    ds_read_b128 v[228:231], v34 offset:36864
    s_waitcnt lgkmcnt(3)
    v_mfma_f32_32x32x16_bf16 v[128:143], v[196:199], v[248:251], v[128:143]
    ds_read_b128 v[232:235], v34 offset:40960
    s_waitcnt lgkmcnt(3)
    v_mfma_f32_32x32x16_bf16 v[144:159], v[196:199], v[252:255], v[144:159]
    ds_read_b128 v[236:239], v34 offset:45056
    buffer_load_dwordx4 v[180:183], v3, s[60:63], s11 offen offset:1024 sc1
    s_waitcnt vmcnt(11)
    s_waitcnt lgkmcnt(3)
    v_mfma_f32_32x32x16_bf16 v[96:111], v[200:203], v[224:227], v[96:111]
    ds_read_b128 v[240:243], v35 offset:32768
    s_waitcnt lgkmcnt(3)
    v_mfma_f32_32x32x16_bf16 v[112:127], v[200:203], v[228:231], v[112:127]
    ds_read_b128 v[244:247], v35 offset:36864
    s_waitcnt lgkmcnt(3)
    v_mfma_f32_32x32x16_bf16 v[128:143], v[200:203], v[232:235], v[128:143]
    ds_read_b128 v[248:251], v35 offset:40960
    s_waitcnt lgkmcnt(3)
    v_mfma_f32_32x32x16_bf16 v[144:159], v[200:203], v[236:239], v[144:159]
    ds_read_b128 v[252:255], v35 offset:45056
    buffer_load_dwordx4 v[184:187], v2, s[60:63], s11 offen offset:0 sc1
    s_barrier
    s_waitcnt vmcnt(11)
    s_waitcnt lgkmcnt(3)
    v_mfma_f32_32x32x16_bf16 v[96:111], v[204:207], v[240:243], v[96:111]
    ds_read_b128 v[224:227], v32 offset:49152
    s_waitcnt lgkmcnt(3)
    v_mfma_f32_32x32x16_bf16 v[112:127], v[204:207], v[244:247], v[112:127]
    ds_read_b128 v[228:231], v32 offset:53248
    s_waitcnt lgkmcnt(3)
    v_mfma_f32_32x32x16_bf16 v[128:143], v[204:207], v[248:251], v[128:143]
    ds_read_b128 v[232:235], v32 offset:57344
    s_waitcnt lgkmcnt(3)
    v_mfma_f32_32x32x16_bf16 v[144:159], v[204:207], v[252:255], v[144:159]
    ds_read_b128 v[236:239], v32 offset:61440
    buffer_load_dwordx4 v[188:191], v2, s[60:63], s11 offen offset:1024 sc1
    s_waitcnt vmcnt(11)
    s_waitcnt lgkmcnt(3)
    v_mfma_f32_32x32x16_bf16 v[96:111], v[208:211], v[224:227], v[96:111]
    ds_read_b128 v[240:243], v33 offset:49152
    s_waitcnt lgkmcnt(3)
    v_mfma_f32_32x32x16_bf16 v[112:127], v[208:211], v[228:231], v[112:127]
    ds_read_b128 v[244:247], v33 offset:53248
    s_waitcnt lgkmcnt(3)
    v_mfma_f32_32x32x16_bf16 v[128:143], v[208:211], v[232:235], v[128:143]
    ds_read_b128 v[248:251], v33 offset:57344
    s_waitcnt lgkmcnt(3)
    v_mfma_f32_32x32x16_bf16 v[144:159], v[208:211], v[236:239], v[144:159]
    ds_read_b128 v[252:255], v33 offset:61440
    s_and_b32 s88, s90, 0xfffc
    s_cmp_eq_u32 s88, 0xfffc
    s_cbranch_scc0 c_n6_s
c_n6:
    s_cmp_le_u32 s15, 6
    s_cselect_b32 s11, 7, 6
    s_lshl_b32 s11, s11, 14
    buffer_load_dwordx4 v[192:195], v3, s[60:63], s11 offen offset:0 sc1
    s_waitcnt vmcnt(11)
    s_waitcnt lgkmcnt(3)
    v_mfma_f32_32x32x16_bf16 v[96:111], v[212:215], v[240:243], v[96:111]
    ds_read_b128 v[224:227], v34 offset:49152
    s_waitcnt lgkmcnt(3)
    v_mfma_f32_32x32x16_bf16 v[112:127], v[212:215], v[244:247], v[112:127]
    ds_read_b128 v[228:231], v34 offset:53248
    s_waitcnt lgkmcnt(3)
    v_mfma_f32_32x32x16_bf16 v[128:143], v[212:215], v[248:251], v[128:143]
    ds_read_b128 v[232:235], v34 offset:57344
    s_waitcnt lgkmcnt(3)
    v_mfma_f32_32x32x16_bf16 v[144:159], v[212:215], v[252:255], v[144:159]
    ds_read_b128 v[236:239], v34 offset:61440
    buffer_load_dwordx4 v[196:199], v3, s[60:63], s11 offen offset:1024 sc1
    s_waitcnt vmcnt(11)
    s_waitcnt lgkmcnt(3)
    v_mfma_f32_32x32x16_bf16 v[96:111], v[216:219], v[224:227], v[96:111]
    ds_read_b128 v[240:243], v35 offset:49152
    s_waitcnt lgkmcnt(3)
    v_mfma_f32_32x32x16_bf16 v[112:127], v[216:219], v[228:231], v[112:127]
    ds_read_b128 v[244:247], v35 offset:53248
    s_waitcnt lgkmcnt(3)
    v_mfma_f32_32x32x16_bf16 v[128:143], v[216:219], v[232:235], v[128:143]
    ds_read_b128 v[248:251], v35 offset:57344
    s_waitcnt lgkmcnt(3)
    v_mfma_f32_32x32x16_bf16 v[144:159], v[216:219], v[236:239], v[144:159]
    ds_read_b128 v[252:255], v35 offset:61440
    buffer_load_dwordx4 v[200:203], v2, s[60:63], s11 offen offset:0 sc1
    s_barrier
    s_waitcnt vmcnt(11)
    s_waitcnt lgkmcnt(3)
    v_mfma_f32_32x32x16_bf16 v[96:111], v[220:223], v[240:243], v[96:111]
    ds_read_b128 v[224:227], v32 offset:0
    s_waitcnt lgkmcnt(3)
    v_mfma_f32_32x32x16_bf16 v[112:127], v[220:223], v[244:247], v[112:127]
    ds_read_b128 v[228:231], v32 offset:4096
    s_waitcnt lgkmcnt(3)
    v_mfma_f32_32x32x16_bf16 v[128:143], v[220:223], v[248:251], v[128:143]
    ds_read_b128 v[232:235], v32 offset:8192
    s_waitcnt lgkmcnt(3)
    v_mfma_f32_32x32x16_bf16 v[144:159], v[220:223], v[252:255], v[144:159]
    ds_read_b128 v[236:239], v32 offset:12288
    buffer_load_dwordx4 v[204:207], v2, s[60:63], s11 offen offset:1024 sc1
    s_waitcnt vmcnt(11)
    s_waitcnt lgkmcnt(3)
    v_mfma_f32_32x32x16_bf16 v[96:111], v[160:163], v[224:227], v[96:111]
    ds_read_b128 v[240:243], v33 offset:0
    s_waitcnt lgkmcnt(3)
    v_mfma_f32_32x32x16_bf16 v[112:127], v[160:163], v[228:231], v[112:127]
    ds_read_b128 v[244:247], v33 offset:4096
    s_waitcnt lgkmcnt(3)
    v_mfma_f32_32x32x16_bf16 v[128:143], v[160:163], v[232:235], v[128:143]
    ds_read_b128 v[248:251], v33 offset:8192
    s_waitcnt lgkmcnt(3)
    v_mfma_f32_32x32x16_bf16 v[144:159], v[160:163], v[236:239], v[144:159]
    ds_read_b128 v[252:255], v33 offset:12288
    s_cmp_le_u32 s15, 6
    s_cselect_b32 s11, 7, 6
    s_lshl_b32 s11, s11, 14
    s_add_u32 s11, s11, 8192
    buffer_load_dwordx4 v[208:211], v3, s[60:63], s11 offen offset:0 sc1
    s_waitcnt vmcnt(11)
    s_waitcnt lgkmcnt(3)
    v_mfma_f32_32x32x16_bf16 v[96:111], v[164:167], v[240:243], v[96:111]
    ds_read_b128 v[224:227], v34 offset:0
    s_waitcnt lgkmcnt(3)
    v_mfma_f32_32x32x16_bf16 v[112:127], v[164:167], v[244:247], v[112:127]
    ds_read_b128 v[228:231], v34 offset:4096
    s_waitcnt lgkmcnt(3)
    v_mfma_f32_32x32x16_bf16 v[128:143], v[164:167], v[248:251], v[128:143]
    ds_read_b128 v[232:235], v34 offset:8192
    s_waitcnt lgkmcnt(3)
    v_mfma_f32_32x32x16_bf16 v[144:159], v[164:167], v[252:255], v[144:159]
    ds_read_b128 v[236:239], v34 offset:12288
    buffer_load_dwordx4 v[212:215], v3, s[60:63], s11 offen offset:1024 sc1
    s_waitcnt vmcnt(11)
    s_waitcnt lgkmcnt(3)
    v_mfma_f32_32x32x16_bf16 v[96:111], v[168:171], v[224:227], v[96:111]
    ds_read_b128 v[240:243], v35 offset:0
    s_waitcnt lgkmcnt(3)
    v_mfma_f32_32x32x16_bf16 v[112:127], v[168:171], v[228:231], v[112:127]
    ds_read_b128 v[244:247], v35 offset:4096
    s_waitcnt lgkmcnt(3)
    v_mfma_f32_32x32x16_bf16 v[128:143], v[168:171], v[232:235], v[128:143]
    ds_read_b128 v[248:251], v35 offset:8192
    s_waitcnt lgkmcnt(3)
    v_mfma_f32_32x32x16_bf16 v[144:159], v[168:171], v[236:239], v[144:159]
    ds_read_b128 v[252:255], v35 offset:12288
    buffer_load_dwordx4 v[216:219], v2, s[60:63], s11 offen offset:0 sc1
    s_barrier
    s_waitcnt vmcnt(11)
    s_waitcnt lgkmcnt(3)
    v_mfma_f32_32x32x16_bf16 v[96:111], v[172:175], v[240:243], v[96:111]
    ds_read_b128 v[224:227], v32 offset:16384
    s_waitcnt lgkmcnt(3)
    v_mfma_f32_32x32x16_bf16 v[112:127], v[172:175], v[244:247], v[112:127]
    ds_read_b128 v[228:231], v32 offset:20480
    s_waitcnt lgkmcnt(3)
    v_mfma_f32_32x32x16_bf16 v[128:143], v[172:175], v[248:251], v[128:143]
    ds_read_b128 v[232:235], v32 offset:24576
    s_waitcnt lgkmcnt(3)
    v_mfma_f32_32x32x16_bf16 v[144:159], v[172:175], v[252:255], v[144:159]
    ds_read_b128 v[236:239], v32 offset:28672
    buffer_load_dwordx4 v[220:223], v2, s[60:63], s11 offen offset:1024 sc1
    ds_read_b128 v[240:243], v33 offset:16384
    ds_read_b128 v[244:247], v33 offset:20480
    ds_read_b128 v[248:251], v34 offset:16384
    s_waitcnt vmcnt(11)
    s_waitcnt lgkmcnt(6)
    v_mfma_f32_32x32x16_bf16 v[96:111], v[176:179], v[224:227], v[96:111]
    ds_read_b128 v[252:255], v34 offset:20480
    s_waitcnt lgkmcnt(6)
    v_mfma_f32_32x32x16_bf16 v[112:127], v[176:179], v[228:231], v[112:127]
    ds_read_b128 v[224:227], v35 offset:16384
    s_waitcnt vmcnt(10)
    s_waitcnt lgkmcnt(4)
    v_mfma_f32_32x32x16_bf16 v[96:111], v[180:183], v[240:243], v[96:111]
    ds_read_b128 v[228:231], v35 offset:20480
    s_waitcnt lgkmcnt(4)
    v_mfma_f32_32x32x16_bf16 v[112:127], v[180:183], v[244:247], v[112:127]
    s_waitcnt vmcnt(9)
    s_waitcnt lgkmcnt(3)
    v_mfma_f32_32x32x16_bf16 v[96:111], v[184:187], v[248:251], v[96:111]
    s_waitcnt lgkmcnt(2)
    v_mfma_f32_32x32x16_bf16 v[112:127], v[184:187], v[252:255], v[112:127]
    s_waitcnt vmcnt(8)
    s_waitcnt lgkmcnt(1)
    v_mfma_f32_32x32x16_bf16 v[96:111], v[188:191], v[224:227], v[96:111]
    s_waitcnt lgkmcnt(0)
    v_mfma_f32_32x32x16_bf16 v[112:127], v[188:191], v[228:231], v[112:127]
    s_barrier
    ds_read_b128 v[240:243], v32 offset:32768
    ds_read_b128 v[244:247], v32 offset:36864
    ds_read_b128 v[248:251], v33 offset:32768
    ds_read_b128 v[252:255], v33 offset:36864
    ds_read_b128 v[224:227], v34 offset:32768
    s_waitcnt vmcnt(7)
    s_waitcnt lgkmcnt(4)
    v_mfma_f32_32x32x16_bf16 v[96:111], v[192:195], v[240:243], v[96:111]
    ds_read_b128 v[228:231], v34 offset:36864
    s_waitcnt lgkmcnt(4)
    v_mfma_f32_32x32x16_bf16 v[112:127], v[192:195], v[244:247], v[112:127]
    ds_read_b128 v[240:243], v35 offset:32768
    s_waitcnt vmcnt(6)
    s_waitcnt lgkmcnt(4)
    v_mfma_f32_32x32x16_bf16 v[96:111], v[196:199], v[248:251], v[96:111]
    ds_read_b128 v[244:247], v35 offset:36864
    s_waitcnt lgkmcnt(4)
    v_mfma_f32_32x32x16_bf16 v[112:127], v[196:199], v[252:255], v[112:127]
    ds_read_b128 v[248:251], v33 offset:24576
    s_waitcnt vmcnt(5)
    s_waitcnt lgkmcnt(4)
    v_mfma_f32_32x32x16_bf16 v[96:111], v[200:203], v[224:227], v[96:111]
    ds_read_b128 v[252:255], v33 offset:28672
    s_waitcnt lgkmcnt(4)
    v_mfma_f32_32x32x16_bf16 v[112:127], v[200:203], v[228:231], v[112:127]
    ds_read_b128 v[224:227], v34 offset:24576
    s_waitcnt vmcnt(4)
    s_waitcnt lgkmcnt(4)
    v_mfma_f32_32x32x16_bf16 v[96:111], v[204:207], v[240:243], v[96:111]
    ds_read_b128 v[228:231], v34 offset:28672
    s_waitcnt lgkmcnt(4)
    v_mfma_f32_32x32x16_bf16 v[112:127], v[204:207], v[244:247], v[112:127]
    ds_read_b128 v[240:243], v35 offset:24576
    v_mfma_f32_32x32x16_bf16 v[128:143], v[176:179], v[232:235], v[128:143]
    ds_read_b128 v[244:247], v35 offset:28672
    v_mfma_f32_32x32x16_bf16 v[144:159], v[176:179], v[236:239], v[144:159]
    s_waitcnt lgkmcnt(5)
    v_mfma_f32_32x32x16_bf16 v[128:143], v[180:183], v[248:251], v[128:143]
    s_waitcnt lgkmcnt(4)
    v_mfma_f32_32x32x16_bf16 v[144:159], v[180:183], v[252:255], v[144:159]
    s_waitcnt lgkmcnt(3)
    v_mfma_f32_32x32x16_bf16 v[128:143], v[184:187], v[224:227], v[128:143]
    s_waitcnt lgkmcnt(2)
    v_mfma_f32_32x32x16_bf16 v[144:159], v[184:187], v[228:231], v[144:159]
    s_waitcnt lgkmcnt(1)
    v_mfma_f32_32x32x16_bf16 v[128:143], v[188:191], v[240:243], v[128:143]
    s_waitcnt lgkmcnt(0)
    v_mfma_f32_32x32x16_bf16 v[144:159], v[188:191], v[244:247], v[144:159]
    s_barrier
    ds_read_b128 v[232:235], v32 offset:49152
    ds_read_b128 v[236:239], v32 offset:53248
    ds_read_b128 v[248:251], v33 offset:49152
    ds_read_b128 v[252:255], v33 offset:53248
    ds_read_b128 v[224:227], v34 offset:49152
    ds_read_b128 v[228:231], v34 offset:53248
    ds_read_b128 v[240:243], v35 offset:49152
    s_waitcnt vmcnt(3)
    s_waitcnt lgkmcnt(6)
    v_mfma_f32_32x32x16_bf16 v[96:111], v[208:211], v[232:235], v[96:111]
    ds_read_b128 v[244:247], v35 offset:53248
    s_waitcnt lgkmcnt(6)
    v_mfma_f32_32x32x16_bf16 v[112:127], v[208:211], v[236:239], v[112:127]
    ds_read_b128 v[232:235], v32 offset:40960
    s_waitcnt vmcnt(2)
    s_waitcnt lgkmcnt(6)
    v_mfma_f32_32x32x16_bf16 v[96:111], v[212:215], v[248:251], v[96:111]
    ds_read_b128 v[236:239], v32 offset:45056
    s_waitcnt lgkmcnt(6)
    v_mfma_f32_32x32x16_bf16 v[112:127], v[212:215], v[252:255], v[112:127]
    ds_read_b128 v[248:251], v33 offset:40960
    s_waitcnt vmcnt(1)
    s_waitcnt lgkmcnt(6)
    v_mfma_f32_32x32x16_bf16 v[96:111], v[216:219], v[224:227], v[96:111]
    ds_read_b128 v[252:255], v33 offset:45056
    s_waitcnt lgkmcnt(6)
    v_mfma_f32_32x32x16_bf16 v[112:127], v[216:219], v[228:231], v[112:127]
    ds_read_b128 v[224:227], v34 offset:40960
    s_waitcnt vmcnt(0)
    s_waitcnt lgkmcnt(6)
    v_mfma_f32_32x32x16_bf16 v[96:111], v[220:223], v[240:243], v[96:111]
    ds_read_b128 v[228:231], v34 offset:45056
    s_waitcnt lgkmcnt(6)
    v_mfma_f32_32x32x16_bf16 v[112:127], v[220:223], v[244:247], v[112:127]
    ds_read_b128 v[240:243], v35 offset:40960
    s_waitcnt lgkmcnt(6)
    v_mfma_f32_32x32x16_bf16 v[128:143], v[192:195], v[232:235], v[128:143]
    ds_read_b128 v[244:247], v35 offset:45056
    s_waitcnt lgkmcnt(6)
    v_mfma_f32_32x32x16_bf16 v[144:159], v[192:195], v[236:239], v[144:159]
    ds_read_b128 v[232:235], v32 offset:57344
    s_waitcnt lgkmcnt(6)
    v_mfma_f32_32x32x16_bf16 v[128:143], v[196:199], v[248:251], v[128:143]
    ds_read_b128 v[236:239], v32 offset:61440
    buffer_store_dwordx4 v[96:99], v28, s[92:95], s74 offen offset:0 sc1
    buffer_store_dwordx4 v[100:103], v28, s[92:95], s74 offen offset:1024 sc1
    s_waitcnt lgkmcnt(6)
    v_mfma_f32_32x32x16_bf16 v[144:159], v[196:199], v[252:255], v[144:159]
    ds_read_b128 v[248:251], v33 offset:57344
    buffer_store_dwordx4 v[104:107], v28, s[92:95], s74 offen offset:2048 sc1
    buffer_store_dwordx4 v[108:111], v28, s[92:95], s74 offen offset:3072 sc1
    s_waitcnt lgkmcnt(6)
    v_mfma_f32_32x32x16_bf16 v[128:143], v[200:203], v[224:227], v[128:143]
    ds_read_b128 v[252:255], v33 offset:61440
    buffer_store_dwordx4 v[112:115], v28, s[92:95], s75 offen offset:0 sc1
    buffer_store_dwordx4 v[116:119], v28, s[92:95], s75 offen offset:1024 sc1
    s_waitcnt lgkmcnt(6)
    v_mfma_f32_32x32x16_bf16 v[144:159], v[200:203], v[228:231], v[144:159]
    ds_read_b128 v[224:227], v34 offset:57344
    buffer_store_dwordx4 v[120:123], v28, s[92:95], s75 offen offset:2048 sc1
    buffer_store_dwordx4 v[124:127], v28, s[92:95], s75 offen offset:3072 sc1
    s_waitcnt lgkmcnt(6)
    v_mfma_f32_32x32x16_bf16 v[128:143], v[204:207], v[240:243], v[128:143]
    ds_read_b128 v[228:231], v34 offset:61440
    s_waitcnt lgkmcnt(6)
    v_mfma_f32_32x32x16_bf16 v[144:159], v[204:207], v[244:247], v[144:159]
    ds_read_b128 v[240:243], v35 offset:57344
    s_waitcnt lgkmcnt(6)
    v_mfma_f32_32x32x16_bf16 v[128:143], v[208:211], v[232:235], v[128:143]
    ds_read_b128 v[244:247], v35 offset:61440
    s_waitcnt lgkmcnt(6)
    v_mfma_f32_32x32x16_bf16 v[144:159], v[208:211], v[236:239], v[144:159]
    s_waitcnt lgkmcnt(5)
    v_mfma_f32_32x32x16_bf16 v[128:143], v[212:215], v[248:251], v[128:143]
    s_waitcnt lgkmcnt(4)
    v_mfma_f32_32x32x16_bf16 v[144:159], v[212:215], v[252:255], v[144:159]
    s_waitcnt lgkmcnt(3)
    v_mfma_f32_32x32x16_bf16 v[128:143], v[216:219], v[224:227], v[128:143]
    s_waitcnt lgkmcnt(2)
    v_mfma_f32_32x32x16_bf16 v[144:159], v[216:219], v[228:231], v[144:159]
    s_waitcnt lgkmcnt(1)
    v_mfma_f32_32x32x16_bf16 v[128:143], v[220:223], v[240:243], v[128:143]
    s_waitcnt lgkmcnt(0)
    v_mfma_f32_32x32x16_bf16 v[144:159], v[220:223], v[244:247], v[144:159]
    s_mov_b32 s12, 0xffff0000
    ds_read_u16 v64, v61 offset:0
    ds_read_u16 v65, v61 offset:128
    ds_read_u16 v66, v61 offset:256
    ds_read_u16 v67, v61 offset:384
    ds_read_u16 v68, v61 offset:512
    ds_read_u16 v69, v61 offset:640
    ds_read_u16 v70, v61 offset:768
    ds_read_u16 v71, v61 offset:896
    ds_read_u16 v72, v61 offset:1024
    ds_read_u16 v73, v61 offset:1152
    ds_read_u16 v74, v61 offset:1280
    ds_read_u16 v75, v61 offset:1408
    ds_read_u16 v76, v61 offset:1536
    ds_read_u16 v77, v61 offset:1664
    ds_read_u16 v78, v61 offset:1792
    ds_read_u16 v79, v61 offset:1920
    ds_read_u16 v80, v61 offset:64
    ds_read_u16 v81, v61 offset:192
    ds_read_u16 v82, v61 offset:320
    ds_read_u16 v83, v61 offset:448
    ds_read_u16 v84, v61 offset:576
    ds_read_u16 v85, v61 offset:704
    ds_read_u16 v86, v61 offset:832
    ds_read_u16 v87, v61 offset:960
    ds_read_u16 v88, v61 offset:1088
    ds_read_u16 v89, v61 offset:1216
    ds_read_u16 v90, v61 offset:1344
    ds_read_u16 v91, v61 offset:1472
    ds_read_u16 v92, v61 offset:1600
    ds_read_u16 v93, v61 offset:1728
    ds_read_u16 v94, v61 offset:1856
    ds_read_u16 v95, v61 offset:1984
    ds_read_b128 v[160:163], v21 offset:0
    ds_read_b128 v[164:167], v21 offset:16
    ds_read_b128 v[168:171], v21 offset:8704
    ds_read_b128 v[172:175], v21 offset:8720
    v_lshlrev_b32 v192, 16, v36
    v_and_b32 v176, s12, v36
    v_lshlrev_b32 v193, 16, v37
    v_and_b32 v177, s12, v37
    v_lshlrev_b32 v194, 16, v38
    v_and_b32 v178, s12, v38
    v_lshlrev_b32 v195, 16, v39
    v_and_b32 v179, s12, v39
    v_lshlrev_b32 v196, 16, v40
    v_and_b32 v180, s12, v40
    v_lshlrev_b32 v197, 16, v41
    v_and_b32 v181, s12, v41
    v_lshlrev_b32 v198, 16, v42
    v_and_b32 v182, s12, v42
    v_lshlrev_b32 v199, 16, v43
    v_and_b32 v183, s12, v43
    v_lshlrev_b32 v200, 16, v44
    v_and_b32 v184, s12, v44
    v_lshlrev_b32 v201, 16, v45
    v_and_b32 v185, s12, v45
    v_lshlrev_b32 v202, 16, v46
    v_and_b32 v186, s12, v46
    v_lshlrev_b32 v203, 16, v47
    v_and_b32 v187, s12, v47
    v_lshlrev_b32 v204, 16, v48
    v_and_b32 v188, s12, v48
    v_lshlrev_b32 v205, 16, v49
    v_and_b32 v189, s12, v49
    v_lshlrev_b32 v206, 16, v50
    v_and_b32 v190, s12, v50
    v_lshlrev_b32 v207, 16, v51
    v_and_b32 v191, s12, v51
    v_lshlrev_b32 v52, 16, v52
    v_lshlrev_b32 v53, 16, v53
    s_waitcnt lgkmcnt(0)
    s_mov_b32 s90, 0
    v_lshlrev_b32 v64, 16, v64
    v_lshlrev_b32 v66, 16, v66
    v_lshlrev_b32 v68, 16, v68
    v_lshlrev_b32 v70, 16, v70
    v_lshlrev_b32 v65, 16, v65
    v_lshlrev_b32 v67, 16, v67
    v_lshlrev_b32 v69, 16, v69
    v_lshlrev_b32 v71, 16, v71
    v_lshlrev_b32 v208, 16, v160
    v_lshlrev_b32 v214, 16, v161
    v_lshlrev_b32 v220, 16, v162
    v_lshlrev_b32 v226, 16, v163
    v_and_b32 v209, s12, v160
    v_and_b32 v215, s12, v161
    v_and_b32 v221, s12, v162
    v_and_b32 v227, s12, v163
    v_mul_f32 v210, v64, v52
    v_mul_f32 v216, v66, v52
    v_mul_f32 v222, v68, v52
    v_mul_f32 v228, v70, v52
    v_mul_f32 v211, v65, v52
    v_mul_f32 v217, v67, v52
    v_mul_f32 v223, v69, v52
    v_mul_f32 v229, v71, v52
    v_mul_f32 v208, v64, v208
    v_mul_f32 v214, v66, v214
    v_mul_f32 v220, v68, v220
    v_mul_f32 v226, v70, v226
    v_mul_f32 v209, v65, v209
    v_mul_f32 v215, v67, v215
    v_mul_f32 v221, v69, v221
    v_mul_f32 v227, v71, v227
    v_cvt_pk_bf16_f32 v212, v210, v211
    v_cvt_pk_bf16_f32 v218, v216, v217
    v_cvt_pk_bf16_f32 v224, v222, v223
    v_cvt_pk_bf16_f32 v230, v228, v229
    v_cvt_pk_bf16_f32 v213, v208, v209
    v_cvt_pk_bf16_f32 v219, v214, v215
    v_cvt_pk_bf16_f32 v225, v220, v221
    v_cvt_pk_bf16_f32 v231, v226, v227
    v_lshlrev_b32 v210, 16, v212
    v_lshlrev_b32 v216, 16, v218
    v_lshlrev_b32 v222, 16, v224
    v_lshlrev_b32 v228, 16, v230
    v_and_b32 v211, s12, v212
    v_and_b32 v217, s12, v218
    v_and_b32 v223, s12, v224
    v_and_b32 v229, s12, v230
    v_lshlrev_b32 v208, 16, v213
    v_lshlrev_b32 v214, 16, v219
    v_lshlrev_b32 v220, 16, v225
    v_lshlrev_b32 v226, 16, v231
    v_and_b32 v209, s12, v213
    v_and_b32 v215, s12, v219
    v_and_b32 v221, s12, v225
    v_and_b32 v227, s12, v231
    v_add_f32 v128, v128, v210
    v_add_f32 v130, v130, v216
    v_add_f32 v132, v132, v222
    v_add_f32 v134, v134, v228
    v_add_f32 v129, v129, v211
    v_add_f32 v131, v131, v217
    v_add_f32 v133, v133, v223
    v_add_f32 v135, v135, v229
    v_mul_f32 v208, v208, v176
    v_mul_f32 v214, v214, v178
    v_mul_f32 v220, v220, v180
    v_mul_f32 v226, v226, v182
    v_mul_f32 v209, v209, v177
    v_mul_f32 v215, v215, v179
    v_mul_f32 v221, v221, v181
    v_mul_f32 v227, v227, v183
    v_cvt_pk_bf16_f32 v212, v208, v209
    v_cvt_pk_bf16_f32 v218, v214, v215
    v_cvt_pk_bf16_f32 v224, v220, v221
    v_cvt_pk_bf16_f32 v230, v226, v227
    v_lshlrev_b32 v208, 16, v212
    v_lshlrev_b32 v214, 16, v218
    v_lshlrev_b32 v220, 16, v224
    v_lshlrev_b32 v226, 16, v230
    v_and_b32 v209, s12, v212
    v_and_b32 v215, s12, v218
    v_and_b32 v221, s12, v224
    v_and_b32 v227, s12, v230
    v_fma_f32 v128, v128, v192, v208
    v_fma_f32 v130, v130, v194, v214
    v_fma_f32 v132, v132, v196, v220
    v_fma_f32 v134, v134, v198, v226
    v_fma_f32 v129, v129, v193, v209
    v_fma_f32 v131, v131, v195, v215
    v_fma_f32 v133, v133, v197, v221
    v_fma_f32 v135, v135, v199, v227
    v_lshlrev_b32 v72, 16, v72
    v_lshlrev_b32 v74, 16, v74
    v_lshlrev_b32 v76, 16, v76
    v_lshlrev_b32 v78, 16, v78
    v_lshlrev_b32 v73, 16, v73
    v_lshlrev_b32 v75, 16, v75
    v_lshlrev_b32 v77, 16, v77
    v_lshlrev_b32 v79, 16, v79
    v_lshlrev_b32 v208, 16, v164
    v_lshlrev_b32 v214, 16, v165
    v_lshlrev_b32 v220, 16, v166
    v_lshlrev_b32 v226, 16, v167
    v_and_b32 v209, s12, v164
    v_and_b32 v215, s12, v165
    v_and_b32 v221, s12, v166
    v_and_b32 v227, s12, v167
    v_mul_f32 v210, v72, v52
    v_mul_f32 v216, v74, v52
    v_mul_f32 v222, v76, v52
    v_mul_f32 v228, v78, v52
    v_mul_f32 v211, v73, v52
    v_mul_f32 v217, v75, v52
    v_mul_f32 v223, v77, v52
    v_mul_f32 v229, v79, v52
    v_mul_f32 v208, v72, v208
    v_mul_f32 v214, v74, v214
    v_mul_f32 v220, v76, v220
    v_mul_f32 v226, v78, v226
    v_mul_f32 v209, v73, v209
    v_mul_f32 v215, v75, v215
    v_mul_f32 v221, v77, v221
    v_mul_f32 v227, v79, v227
    v_cvt_pk_bf16_f32 v212, v210, v211
    v_cvt_pk_bf16_f32 v218, v216, v217
    v_cvt_pk_bf16_f32 v224, v222, v223
    v_cvt_pk_bf16_f32 v230, v228, v229
    v_cvt_pk_bf16_f32 v213, v208, v209
    v_cvt_pk_bf16_f32 v219, v214, v215
    v_cvt_pk_bf16_f32 v225, v220, v221
    v_cvt_pk_bf16_f32 v231, v226, v227
    v_lshlrev_b32 v210, 16, v212
    v_lshlrev_b32 v216, 16, v218
    v_lshlrev_b32 v222, 16, v224
    v_lshlrev_b32 v228, 16, v230
    v_and_b32 v211, s12, v212
    v_and_b32 v217, s12, v218
    v_and_b32 v223, s12, v224
    v_and_b32 v229, s12, v230
    v_lshlrev_b32 v208, 16, v213
    v_lshlrev_b32 v214, 16, v219
    v_lshlrev_b32 v220, 16, v225
    v_lshlrev_b32 v226, 16, v231
    v_and_b32 v209, s12, v213
    v_and_b32 v215, s12, v219
    v_and_b32 v221, s12, v225
    v_and_b32 v227, s12, v231
    v_add_f32 v136, v136, v210
    v_add_f32 v138, v138, v216
    v_add_f32 v140, v140, v222
    v_add_f32 v142, v142, v228
    v_add_f32 v137, v137, v211
    v_add_f32 v139, v139, v217
    v_add_f32 v141, v141, v223
    v_add_f32 v143, v143, v229
    v_mul_f32 v208, v208, v184
    v_mul_f32 v214, v214, v186
    v_mul_f32 v220, v220, v188
    v_mul_f32 v226, v226, v190
    v_mul_f32 v209, v209, v185
    v_mul_f32 v215, v215, v187
    v_mul_f32 v221, v221, v189
    v_mul_f32 v227, v227, v191
    v_cvt_pk_bf16_f32 v212, v208, v209
    v_cvt_pk_bf16_f32 v218, v214, v215
    v_cvt_pk_bf16_f32 v224, v220, v221
    v_cvt_pk_bf16_f32 v230, v226, v227
    v_lshlrev_b32 v208, 16, v212
    v_lshlrev_b32 v214, 16, v218
    v_lshlrev_b32 v220, 16, v224
    v_lshlrev_b32 v226, 16, v230
    v_and_b32 v209, s12, v212
    v_and_b32 v215, s12, v218
    v_and_b32 v221, s12, v224
    v_and_b32 v227, s12, v230
    v_fma_f32 v136, v136, v200, v208
    v_fma_f32 v138, v138, v202, v214
    v_fma_f32 v140, v140, v204, v220
    v_fma_f32 v142, v142, v206, v226
    v_fma_f32 v137, v137, v201, v209
    v_fma_f32 v139, v139, v203, v215
    v_fma_f32 v141, v141, v205, v221
    v_fma_f32 v143, v143, v207, v227
    s_waitcnt vmcnt(0)
    buffer_store_dword v23, v30, s[68:71], 0 offen sc1
    buffer_load_dword v19, v29, s[68:71], 0 offen sc1
    v_lshlrev_b32 v80, 16, v80
    v_lshlrev_b32 v82, 16, v82
    v_lshlrev_b32 v84, 16, v84
    v_lshlrev_b32 v86, 16, v86
    v_lshlrev_b32 v81, 16, v81
    v_lshlrev_b32 v83, 16, v83
    v_lshlrev_b32 v85, 16, v85
    v_lshlrev_b32 v87, 16, v87
    v_lshlrev_b32 v208, 16, v168
    v_lshlrev_b32 v214, 16, v169
    v_lshlrev_b32 v220, 16, v170
    v_lshlrev_b32 v226, 16, v171
    v_and_b32 v209, s12, v168
    v_and_b32 v215, s12, v169
    v_and_b32 v221, s12, v170
    v_and_b32 v227, s12, v171
    v_mul_f32 v210, v80, v53
    v_mul_f32 v216, v82, v53
    v_mul_f32 v222, v84, v53
    v_mul_f32 v228, v86, v53
    v_mul_f32 v211, v81, v53
    v_mul_f32 v217, v83, v53
    v_mul_f32 v223, v85, v53
    v_mul_f32 v229, v87, v53
    v_mul_f32 v208, v80, v208
    v_mul_f32 v214, v82, v214
    v_mul_f32 v220, v84, v220
    v_mul_f32 v226, v86, v226
    v_mul_f32 v209, v81, v209
    v_mul_f32 v215, v83, v215
    v_mul_f32 v221, v85, v221
    v_mul_f32 v227, v87, v227
    v_cvt_pk_bf16_f32 v212, v210, v211
    v_cvt_pk_bf16_f32 v218, v216, v217
    v_cvt_pk_bf16_f32 v224, v222, v223
    v_cvt_pk_bf16_f32 v230, v228, v229
    v_cvt_pk_bf16_f32 v213, v208, v209
    v_cvt_pk_bf16_f32 v219, v214, v215
    v_cvt_pk_bf16_f32 v225, v220, v221
    v_cvt_pk_bf16_f32 v231, v226, v227
    v_lshlrev_b32 v210, 16, v212
    v_lshlrev_b32 v216, 16, v218
    v_lshlrev_b32 v222, 16, v224
    v_lshlrev_b32 v228, 16, v230
    v_and_b32 v211, s12, v212
    v_and_b32 v217, s12, v218
    v_and_b32 v223, s12, v224
    v_and_b32 v229, s12, v230
    v_lshlrev_b32 v208, 16, v213
    v_lshlrev_b32 v214, 16, v219
    v_lshlrev_b32 v220, 16, v225
    v_lshlrev_b32 v226, 16, v231
    v_and_b32 v209, s12, v213
    v_and_b32 v215, s12, v219
    v_and_b32 v221, s12, v225
    v_and_b32 v227, s12, v231
    v_add_f32 v144, v144, v210
    v_add_f32 v146, v146, v216
    v_add_f32 v148, v148, v222
    v_add_f32 v150, v150, v228
    v_add_f32 v145, v145, v211
    v_add_f32 v147, v147, v217
    v_add_f32 v149, v149, v223
    v_add_f32 v151, v151, v229
    v_mul_f32 v208, v208, v176
    v_mul_f32 v214, v214, v178
    v_mul_f32 v220, v220, v180
    v_mul_f32 v226, v226, v182
    v_mul_f32 v209, v209, v177
    v_mul_f32 v215, v215, v179
    v_mul_f32 v221, v221, v181
    v_mul_f32 v227, v227, v183
    v_cvt_pk_bf16_f32 v212, v208, v209
    v_cvt_pk_bf16_f32 v218, v214, v215
    v_cvt_pk_bf16_f32 v224, v220, v221
    v_cvt_pk_bf16_f32 v230, v226, v227
    v_lshlrev_b32 v208, 16, v212
    v_lshlrev_b32 v214, 16, v218
    v_lshlrev_b32 v220, 16, v224
    v_lshlrev_b32 v226, 16, v230
    v_and_b32 v209, s12, v212
    v_and_b32 v215, s12, v218
    v_and_b32 v221, s12, v224
    v_and_b32 v227, s12, v230
    v_fma_f32 v144, v144, v192, v208
    v_fma_f32 v146, v146, v194, v214
    v_fma_f32 v148, v148, v196, v220
    v_fma_f32 v150, v150, v198, v226
    v_fma_f32 v145, v145, v193, v209
    v_fma_f32 v147, v147, v195, v215
    v_fma_f32 v149, v149, v197, v221
    v_fma_f32 v151, v151, v199, v227
    s_waitcnt vmcnt(0)
    v_cmp_ne_u32 vcc, 1, v19
    s_nop 1
    s_cmp_eq_u64 vcc, 0
    s_cbranch_scc0 c_norc
    s_lshl_b32 s12, s72, 6
    s_add_u32 s13, s12, 4096
    buffer_load_dwordx4 v[96:99], v28, s[92:95], s12 offen offset:0 sc1
    buffer_load_dwordx4 v[100:103], v28, s[92:95], s12 offen offset:1024 sc1
    buffer_load_dwordx4 v[104:107], v28, s[92:95], s12 offen offset:2048 sc1
    buffer_load_dwordx4 v[108:111], v28, s[92:95], s12 offen offset:3072 sc1
    buffer_load_dwordx4 v[112:115], v28, s[92:95], s13 offen offset:0 sc1
    buffer_load_dwordx4 v[116:119], v28, s[92:95], s13 offen offset:1024 sc1
    buffer_load_dwordx4 v[120:123], v28, s[92:95], s13 offen offset:2048 sc1
    buffer_load_dwordx4 v[124:127], v28, s[92:95], s13 offen offset:3072 sc1
    s_mov_b32 s12, 0xffff0000
    s_mov_b32 s90, 1
c_norc:
    v_lshlrev_b32 v88, 16, v88
    v_lshlrev_b32 v90, 16, v90
    v_lshlrev_b32 v92, 16, v92
    v_lshlrev_b32 v94, 16, v94
    v_lshlrev_b32 v89, 16, v89
    v_lshlrev_b32 v91, 16, v91
    v_lshlrev_b32 v93, 16, v93
    v_lshlrev_b32 v95, 16, v95
    v_lshlrev_b32 v208, 16, v172
    v_lshlrev_b32 v214, 16, v173
    v_lshlrev_b32 v220, 16, v174
    v_lshlrev_b32 v226, 16, v175
    v_and_b32 v209, s12, v172
    v_and_b32 v215, s12, v173
    v_and_b32 v221, s12, v174
    v_and_b32 v227, s12, v175
    v_mul_f32 v210, v88, v53
    v_mul_f32 v216, v90, v53
    v_mul_f32 v222, v92, v53
    v_mul_f32 v228, v94, v53
    v_mul_f32 v211, v89, v53
    v_mul_f32 v217, v91, v53
    v_mul_f32 v223, v93, v53
    v_mul_f32 v229, v95, v53
    v_mul_f32 v208, v88, v208
    v_mul_f32 v214, v90, v214
    v_mul_f32 v220, v92, v220
    v_mul_f32 v226, v94, v226
    v_mul_f32 v209, v89, v209
    v_mul_f32 v215, v91, v215
    v_mul_f32 v221, v93, v221
    v_mul_f32 v227, v95, v227
    v_cvt_pk_bf16_f32 v212, v210, v211
    v_cvt_pk_bf16_f32 v218, v216, v217
    v_cvt_pk_bf16_f32 v224, v222, v223
    v_cvt_pk_bf16_f32 v230, v228, v229
    v_cvt_pk_bf16_f32 v213, v208, v209
    v_cvt_pk_bf16_f32 v219, v214, v215
    v_cvt_pk_bf16_f32 v225, v220, v221
    v_cvt_pk_bf16_f32 v231, v226, v227
    v_lshlrev_b32 v210, 16, v212
    v_lshlrev_b32 v216, 16, v218
    v_lshlrev_b32 v222, 16, v224
    v_lshlrev_b32 v228, 16, v230
    v_and_b32 v211, s12, v212
    v_and_b32 v217, s12, v218
    v_and_b32 v223, s12, v224
    v_and_b32 v229, s12, v230
    v_lshlrev_b32 v208, 16, v213
    v_lshlrev_b32 v214, 16, v219
    v_lshlrev_b32 v220, 16, v225
    v_lshlrev_b32 v226, 16, v231
    v_and_b32 v209, s12, v213
    v_and_b32 v215, s12, v219
    v_and_b32 v221, s12, v225
    v_and_b32 v227, s12, v231
    v_add_f32 v152, v152, v210
    v_add_f32 v154, v154, v216
    v_add_f32 v156, v156, v222
    v_add_f32 v158, v158, v228
    v_add_f32 v153, v153, v211
    v_add_f32 v155, v155, v217
    v_add_f32 v157, v157, v223
    v_add_f32 v159, v159, v229
    v_mul_f32 v208, v208, v184
    v_mul_f32 v214, v214, v186
    v_mul_f32 v220, v220, v188
    v_mul_f32 v226, v226, v190
    v_mul_f32 v209, v209, v185
    v_mul_f32 v215, v215, v187
    v_mul_f32 v221, v221, v189
    v_mul_f32 v227, v227, v191
    v_cvt_pk_bf16_f32 v212, v208, v209
    v_cvt_pk_bf16_f32 v218, v214, v215
    v_cvt_pk_bf16_f32 v224, v220, v221
    v_cvt_pk_bf16_f32 v230, v226, v227
    v_lshlrev_b32 v208, 16, v212
    v_lshlrev_b32 v214, 16, v218
    v_lshlrev_b32 v220, 16, v224
    v_lshlrev_b32 v226, 16, v230
    v_and_b32 v209, s12, v212
    v_and_b32 v215, s12, v218
    v_and_b32 v221, s12, v224
    v_and_b32 v227, s12, v230
    v_fma_f32 v152, v152, v200, v208
    v_fma_f32 v154, v154, v202, v214
    v_fma_f32 v156, v156, v204, v220
    v_fma_f32 v158, v158, v206, v226
    v_fma_f32 v153, v153, v201, v209
    v_fma_f32 v155, v155, v203, v215
    v_fma_f32 v157, v157, v205, v221
    v_fma_f32 v159, v159, v207, v227
    s_cmp_eq_u32 s90, 1
    s_cbranch_scc1 c_havercv
    buffer_load_dword v19, v29, s[68:71], 0 offen sc1
    s_waitcnt vmcnt(0)
    s_mov_b32 s89, 65536
c_pf_chk:
    v_cmp_ne_u32 vcc, 1, v19
    s_nop 1
    s_cmp_eq_u64 vcc, 0
    s_cbranch_scc1 c_pf_ok
    s_sub_u32 s89, s89, 1
    s_cbranch_scc1 c_pf_ok
    s_sleep 4
    buffer_load_dword v19, v29, s[68:71], 0 offen sc1
    s_waitcnt vmcnt(0)
    s_branch c_pf_chk
c_pf_ok:
    s_lshl_b32 s12, s72, 6
    s_add_u32 s13, s12, 4096
    buffer_load_dwordx4 v[96:99], v28, s[92:95], s12 offen offset:0 sc1
    buffer_load_dwordx4 v[100:103], v28, s[92:95], s12 offen offset:1024 sc1
    buffer_load_dwordx4 v[104:107], v28, s[92:95], s12 offen offset:2048 sc1
    buffer_load_dwordx4 v[108:111], v28, s[92:95], s12 offen offset:3072 sc1
    buffer_load_dwordx4 v[112:115], v28, s[92:95], s13 offen offset:0 sc1
    buffer_load_dwordx4 v[116:119], v28, s[92:95], s13 offen offset:1024 sc1
    buffer_load_dwordx4 v[120:123], v28, s[92:95], s13 offen offset:2048 sc1
    buffer_load_dwordx4 v[124:127], v28, s[92:95], s13 offen offset:3072 sc1
    s_mov_b32 s12, 0xffff0000
c_havercv:
    s_waitcnt vmcnt(7)
    v_fma_f32 v128, v96, v192, v128
    buffer_store_dword v128, v26, s[76:79], s80 offen offset:0 nt
    v_fma_f32 v129, v97, v193, v129
    buffer_store_dword v129, v26, s[76:79], s81 offen offset:0 nt
    v_fma_f32 v130, v98, v194, v130
    buffer_store_dword v130, v26, s[76:79], s82 offen offset:0 nt
    v_fma_f32 v131, v99, v195, v131
    buffer_store_dword v131, v26, s[76:79], s83 offen offset:0 nt
    s_waitcnt vmcnt(10)
    v_fma_f32 v132, v100, v196, v132
    buffer_store_dword v132, v26, s[76:79], s84 offen offset:0 nt
    v_fma_f32 v133, v101, v197, v133
    buffer_store_dword v133, v26, s[76:79], s85 offen offset:0 nt
    v_fma_f32 v134, v102, v198, v134
    buffer_store_dword v134, v26, s[76:79], s86 offen offset:0 nt
    v_fma_f32 v135, v103, v199, v135
    buffer_store_dword v135, v26, s[76:79], s87 offen offset:0 nt
    s_waitcnt vmcnt(13)
    v_fma_f32 v136, v104, v200, v136
    buffer_store_dword v136, v27, s[76:79], s80 offen offset:0 nt
    v_fma_f32 v137, v105, v201, v137
    buffer_store_dword v137, v27, s[76:79], s81 offen offset:0 nt
    v_fma_f32 v138, v106, v202, v138
    buffer_store_dword v138, v27, s[76:79], s82 offen offset:0 nt
    v_fma_f32 v139, v107, v203, v139
    buffer_store_dword v139, v27, s[76:79], s83 offen offset:0 nt
    s_waitcnt vmcnt(16)
    v_fma_f32 v140, v108, v204, v140
    buffer_store_dword v140, v27, s[76:79], s84 offen offset:0 nt
    v_fma_f32 v141, v109, v205, v141
    buffer_store_dword v141, v27, s[76:79], s85 offen offset:0 nt
    v_fma_f32 v142, v110, v206, v142
    buffer_store_dword v142, v27, s[76:79], s86 offen offset:0 nt
    v_fma_f32 v143, v111, v207, v143
    buffer_store_dword v143, v27, s[76:79], s87 offen offset:0 nt
    s_waitcnt vmcnt(19)
    v_fma_f32 v144, v112, v192, v144
    buffer_store_dword v144, v26, s[76:79], s80 offen offset:128 nt
    v_fma_f32 v145, v113, v193, v145
    buffer_store_dword v145, v26, s[76:79], s81 offen offset:128 nt
    v_fma_f32 v146, v114, v194, v146
    buffer_store_dword v146, v26, s[76:79], s82 offen offset:128 nt
    v_fma_f32 v147, v115, v195, v147
    buffer_store_dword v147, v26, s[76:79], s83 offen offset:128 nt
    s_waitcnt vmcnt(22)
    v_fma_f32 v148, v116, v196, v148
    buffer_store_dword v148, v26, s[76:79], s84 offen offset:128 nt
    v_fma_f32 v149, v117, v197, v149
    buffer_store_dword v149, v26, s[76:79], s85 offen offset:128 nt
    v_fma_f32 v150, v118, v198, v150
    buffer_store_dword v150, v26, s[76:79], s86 offen offset:128 nt
    v_fma_f32 v151, v119, v199, v151
    buffer_store_dword v151, v26, s[76:79], s87 offen offset:128 nt
    s_waitcnt vmcnt(25)
    v_fma_f32 v152, v120, v200, v152
    buffer_store_dword v152, v27, s[76:79], s80 offen offset:128 nt
    v_fma_f32 v153, v121, v201, v153
    buffer_store_dword v153, v27, s[76:79], s81 offen offset:128 nt
    v_fma_f32 v154, v122, v202, v154
    buffer_store_dword v154, v27, s[76:79], s82 offen offset:128 nt
    v_fma_f32 v155, v123, v203, v155
    buffer_store_dword v155, v27, s[76:79], s83 offen offset:128 nt
    s_waitcnt vmcnt(28)
    v_fma_f32 v156, v124, v204, v156
    buffer_store_dword v156, v27, s[76:79], s84 offen offset:128 nt
    v_fma_f32 v157, v125, v205, v157
    buffer_store_dword v157, v27, s[76:79], s85 offen offset:128 nt
    v_fma_f32 v158, v126, v206, v158
    buffer_store_dword v158, v27, s[76:79], s86 offen offset:128 nt
    v_fma_f32 v159, v127, v207, v159
    buffer_store_dword v159, v27, s[76:79], s87 offen offset:128 nt
    s_endpgm
c_n0_s:
    s_mov_b32 s89, 65536
c_n0_l:
    s_waitcnt vmcnt(0)
    buffer_load_dword v19, v22, s[68:71], 0 offen sc1
    s_waitcnt vmcnt(0)
    v_cmp_eq_u32 s[90:91], 1, v19
    s_nop 1
    s_and_b32 s88, s90, 0xc
    s_cmp_eq_u32 s88, 0xc
    s_cbranch_scc1 c_n0
    s_sub_u32 s89, s89, 1
    s_cbranch_scc1 c_n0
    s_branch c_n0_l
c_n1_s:
    s_mov_b32 s89, 65536
c_n1_l:
    s_waitcnt vmcnt(0)
    buffer_load_dword v19, v22, s[68:71], 0 offen sc1
    s_waitcnt vmcnt(0)
    v_cmp_eq_u32 s[90:91], 1, v19
    s_nop 1
    s_and_b32 s88, s90, 0x3c
    s_cmp_eq_u32 s88, 0x3c
    s_cbranch_scc1 c_n1
    s_sub_u32 s89, s89, 1
    s_cbranch_scc1 c_n1
    s_branch c_n1_l
c_n2_s:
    s_mov_b32 s89, 65536
c_n2_l:
    s_waitcnt vmcnt(0)
    buffer_load_dword v19, v22, s[68:71], 0 offen sc1
    s_waitcnt vmcnt(0)
    v_cmp_eq_u32 s[90:91], 1, v19
    s_nop 1
    s_and_b32 s88, s90, 0xfc
    s_cmp_eq_u32 s88, 0xfc
    s_cbranch_scc1 c_n2
    s_sub_u32 s89, s89, 1
    s_cbranch_scc1 c_n2
    s_branch c_n2_l
c_n3_s:
    s_mov_b32 s89, 65536
c_n3_l:
    s_waitcnt vmcnt(0)
    buffer_load_dword v19, v22, s[68:71], 0 offen sc1
    s_waitcnt vmcnt(0)
    v_cmp_eq_u32 s[90:91], 1, v19
    s_nop 1
    s_and_b32 s88, s90, 0x3fc
    s_cmp_eq_u32 s88, 0x3fc
    s_cbranch_scc1 c_n3
    s_sub_u32 s89, s89, 1
    s_cbranch_scc1 c_n3
    s_branch c_n3_l
c_n4_s:
    s_mov_b32 s89, 65536
c_n4_l:
    s_waitcnt vmcnt(0)
    buffer_load_dword v19, v22, s[68:71], 0 offen sc1
    s_waitcnt vmcnt(0)
    v_cmp_eq_u32 s[90:91], 1, v19
    s_nop 1
    s_and_b32 s88, s90, 0xffc
    s_cmp_eq_u32 s88, 0xffc
    s_cbranch_scc1 c_n4
    s_sub_u32 s89, s89, 1
    s_cbranch_scc1 c_n4
    s_branch c_n4_l
c_n5_s:
    s_mov_b32 s89, 65536
c_n5_l:
    s_waitcnt vmcnt(0)
    buffer_load_dword v19, v22, s[68:71], 0 offen sc1
    s_waitcnt vmcnt(0)
    v_cmp_eq_u32 s[90:91], 1, v19
    s_nop 1
    s_and_b32 s88, s90, 0x3ffc
    s_cmp_eq_u32 s88, 0x3ffc
    s_cbranch_scc1 c_n5
    s_sub_u32 s89, s89, 1
    s_cbranch_scc1 c_n5
    s_branch c_n5_l
c_n6_s:
    s_mov_b32 s89, 65536
c_n6_l:
    s_waitcnt vmcnt(0)
    buffer_load_dword v19, v22, s[68:71], 0 offen sc1
    s_waitcnt vmcnt(0)
    v_cmp_eq_u32 s[90:91], 1, v19
    s_nop 1
    s_and_b32 s88, s90, 0xfffc
    s_cmp_eq_u32 s88, 0xfffc
    s_cbranch_scc1 c_n6
    s_sub_u32 s89, s89, 1
    s_cbranch_scc1 c_n6
    s_branch c_n6_l
L_end:
    s_endpgm
.section .rodata,"a"
.p2align 6
.amdhsa_kernel gated_mix__ssm_conv_s5__ssm_conv_h3__prompt_kernel
  .amdhsa_next_free_vgpr 256
  .amdhsa_next_free_sgpr 102
  .amdhsa_accum_offset 256
  .amdhsa_group_segment_fixed_size 0
  .amdhsa_kernarg_size 152
  .amdhsa_user_sgpr_count 2
  .amdhsa_user_sgpr_kernarg_segment_ptr 1
  .amdhsa_system_sgpr_workgroup_id_x 1
  .amdhsa_float_denorm_mode_32 3
.end_amdhsa_kernel
```

```asm
; @launch grid=(256,1,1) block=(512,1,1) lds=163840
.amdgcn_target "amdgcn-amd-amdhsa--gfx950"
.text
.globl gated_mix__ssm_conv_s5__ssm_conv_h3__prompt_kernel
.p2align 8
.type gated_mix__ssm_conv_s5__ssm_conv_h3__prompt_kernel,@function
gated_mix__ssm_conv_s5__ssm_conv_h3__prompt_kernel:
    s_cmp_ge_u32 s2, 256
    s_cbranch_scc1 L_end
    s_load_dwordx16 s[16:31], s[0:1], 0
    s_load_dwordx16 s[32:47], s[0:1], 64
    s_load_dwordx4 s[48:51], s[0:1], 128
    s_load_dwordx2 s[52:53], s[0:1], 144
    s_and_b32 s54, s2, 7
    s_lshr_b32 s55, s2, 3
    s_lshr_b32 s4, s54, 1
    s_lshl_b32 s4, s4, 2
    s_and_b32 s6, s55, 3
    s_add_u32 s4, s4, s6
    s_and_b32 s5, s54, 1
    s_lshl_b32 s5, s5, 3
    s_lshr_b32 s6, s55, 2
    s_add_u32 s5, s5, s6
    v_and_b32 v1, 63, v0
    v_lshrrev_b32 v2, 6, v0
    s_and_b32 s15, s5, 7
    v_readfirstlane_b32 s3, v2
    s_nop 1
    s_cmp_ge_u32 s3, 4
    s_cbranch_scc0 L_consumer
    s_sub_u32 s3, s3, 4
    s_lshr_b32 s6, s3, 1
    s_and_b32 s7, s3, 1
    v_lshrrev_b32 v3, 5, v1
    v_lshlrev_b32 v3, 5, v3
    v_bfe_u32 v4, v1, 3, 1
    v_lshl_add_u32 v3, v4, 4, v3
    v_bfe_u32 v4, v1, 4, 1
    v_add_u32 v3, v3, v4
    s_lshl_b32 s8, s4, 7
    s_lshl_b32 s9, s6, 6
    s_add_u32 s8, s8, s9
    s_lshl_b32 s9, s7, 3
    s_add_u32 s8, s8, s9
    v_add_u32 v3, s8, v3
    v_lshlrev_b32 v3, 11, v3
    v_and_b32 v4, 7, v1
    v_lshrrev_b32 v5, 4, v1
    v_xor_b32 v4, v4, v5
    v_lshlrev_b32 v4, 4, v4
    v_add_u32 v8, v3, v4
    s_lshl_b32 s10, s3, 12
    s_lshr_b32 s90, s55, 2
    s_lshl_b32 s90, s90, 1
    s_and_b32 s91, s55, 3
    s_lshl_b32 s91, s91, 2
    s_add_u32 s90, s90, s91
    s_and_b32 s11, s90, 15
    s_lshl_b32 s11, s11, 7
    s_mov_b32 m0, s10
    s_mov_b32 s58, 0x400000
    s_mov_b32 s59, 0x20000
    s_waitcnt lgkmcnt(0)
    s_mov_b32 s56, s16
    s_mov_b32 s57, s17
    buffer_load_dwordx4 v8, s[56:59], s11 offen lds
    v_xor_b32 v5, 64, v4
    v_add_u32 v9, v3, v5
    v_add_u32 v9, 3072, v9
    buffer_load_dwordx4 v9, s[56:59], s11 offen offset:1024 lds
    v_add_u32 v10, 6144, v8
    buffer_load_dwordx4 v10, s[56:59], s11 offen offset:2048 lds
    v_add_u32 v11, 6144, v9
    buffer_load_dwordx4 v11, s[56:59], s11 offen offset:3072 lds
    s_lshl_b32 s8, s5, 6
    s_lshl_b32 s9, s7, 5
    s_add_u32 s8, s8, s9
    v_lshrrev_b32 v6, 3, v1
    v_add_u32 v7, s8, v6
    v_lshlrev_b32 v7, 11, v7
    v_add_u32 v12, v7, v4
    s_cmp_ge_u32 s3, 2
    s_cselect_b32 s60, s24, s22
    s_cselect_b32 s61, s25, s23
    s_mov_b32 s62, 0x200000
    s_mov_b32 s63, 0x20000
    s_add_u32 m0, s10, 16384
    v_add_u32 v13, v7, v5
    buffer_load_dwordx4 v12, s[60:63], s11 offen lds
    v_add_u32 v13, 15360, v13
    buffer_load_dwordx4 v13, s[60:63], s11 offen offset:1024 lds
    v_add_u32 v14, 30720, v12
    buffer_load_dwordx4 v14, s[60:63], s11 offen offset:2048 lds
    v_add_u32 v15, 30720, v13
    buffer_load_dwordx4 v15, s[60:63], s11 offen offset:3072 lds
    s_and_b32 s8, s5, 7
    s_lshl_b32 s8, s8, 6
    s_lshl_b32 s9, s3, 4
    s_add_u32 s8, s8, s9
    v_add_u32 v7, s8, v6
    v_lshlrev_b32 v7, 11, v7
    v_add_u32 v28, v7, v4
    v_add_u32 v29, v7, v5
    v_add_u32 v29, 15360, v29
    s_and_b32 s12, s55, 1
    s_lshl_b32 s13, s54, 1
    s_add_u32 s12, s12, s13
    s_lshr_b32 s13, s55, 1
    s_lshl_b32 s8, s2, 7
    s_add_u32 s8, s8, 0x20000
    v_mov_b32 v30, s8
    s_lshl_b32 s88, s54, 5
    s_add_u32 s88, s88, s55
    s_lshl_b32 s8, s88, 7
    s_add_u32 s8, s8, 0x28000
    v_mov_b32 v31, s8
    s_lshl_b32 s88, s88, 2
    s_add_u32 s88, s88, s3
    v_mov_b32 v2, 0
    s_add_u32 s92, s52, 0x1200000
    s_addc_u32 s93, s53, 0
    s_mov_b32 s94, 0x50000
    s_mov_b32 s95, 0x20000
    s_lshl_b32 s8, s88, 12
    s_load_dword s100, s[42:43], s8
    s_lshr_b32 s8, s88, 1
    s_lshl_b32 s8, s8, 2
    s_load_dword s101, s[44:45], s8
    buffer_store_dword v2, v30, s[92:95], 0 offen sc1
    buffer_store_dword v2, v31, s[92:95], 0 offen sc1
    s_add_u32 s11, s90, 1
    s_and_b32 s11, s11, 15
    s_lshl_b32 s11, s11, 7
    s_add_u32 m0, s10, 0x8000
    s_nop 0
    buffer_load_dwordx4 v8, s[56:59], s11 offen offset:0 lds
    buffer_load_dwordx4 v9, s[56:59], s11 offen offset:1024 lds
    buffer_load_dwordx4 v10, s[56:59], s11 offen offset:2048 lds
    buffer_load_dwordx4 v11, s[56:59], s11 offen offset:3072 lds
    s_add_u32 m0, s10, 0xc000
    s_nop 0
    buffer_load_dwordx4 v12, s[60:63], s11 offen offset:0 lds
    buffer_load_dwordx4 v13, s[60:63], s11 offen offset:1024 lds
    buffer_load_dwordx4 v14, s[60:63], s11 offen offset:2048 lds
    buffer_load_dwordx4 v15, s[60:63], s11 offen offset:3072 lds
    s_lshl_b32 s13, s13, 7
    s_lshl_b32 s14, s3, 5
    s_add_u32 s13, s13, s14
    v_and_b32 v17, 31, v1
    s_lshl_b32 s14, s12, 5
    v_add_u32 v17, s14, v17
    v_lshlrev_b32 v22, 4, v17
    v_and_b32 v23, 31, v1
    v_mul_u32_u24 v23, 544, v23
    v_lshrrev_b32 v24, 5, v1
    v_lshlrev_b32 v24, 5, v24
    v_sub_u32 v23, v23, v24
    s_lshl_b32 s8, s3, 6
    s_sub_u32 s8, 131808, s8
    v_add_u32 v23, s8, v23
    v_lshrrev_b32 v24, 4, v1
    s_lshl_b32 s8, s3, 4
    v_add_u32 v24, s8, v24
    v_and_b32 v2, 15, v1
    v_lshlrev_b32 v2, 4, v2
    s_lshl_b32 s8, s12, 6
    v_add_u32 v27, s8, v24
    v_lshl_add_u32 v27, v27, 12, v2
    s_lshr_b32 s8, s55, 1
    s_lshl_b32 s8, s8, 8
    s_sub_u32 s8, 3840, s8
    v_add_u32 v27, s8, v27
    v_mul_u32_u24 v24, 272, v24
    v_add_u32 v24, v24, v2
    v_add_u32 v24, 0x20200, v24
    s_lshl_b32 s14, s4, 7
    s_lshl_b32 s8, s5, 3
    s_add_u32 s14, s14, s8
    s_lshl_b32 s8, s3, 1
    s_add_u32 s14, s14, s8
    s_lshl_b32 s8, s14, 11
    v_lshlrev_b32 v25, 4, v1
    v_add_u32 v26, s8, v25
    v_add_u32 v3, 0x8000, v27
    s_mov_b32 s64, s36
    s_mov_b32 s65, s37
    s_mov_b32 s66, 0x400000
    s_mov_b32 s67, 0x20000
    s_mov_b32 s68, s38
    s_mov_b32 s69, s39
    s_mov_b32 s70, 0x400000
    s_mov_b32 s71, 0x20000
    s_add_u32 s72, s52, 0x800000
    s_addc_u32 s73, s53, 0
    s_mov_b32 s74, 0x400000
    s_mov_b32 s75, 0x20000
    s_add_u32 s76, s52, 0x1000000
    s_addc_u32 s77, s53, 0
    s_mov_b32 s78, 0x2000
    s_mov_b32 s79, 0x20000
    s_mov_b32 s80, 0
    s_mov_b32 s81, 4096
    s_mov_b32 s82, 8192
    s_mov_b32 s83, 12288
    s_mov_b32 s84, 16384
    s_mov_b32 s85, 20480
    s_mov_b32 s86, 24576
    s_mov_b32 s87, 28672
    v_lshrrev_b32 v19, 3, v1
    v_add_u32 v19, s13, v19
    v_lshlrev_b32 v19, 11, v19
    v_and_b32 v20, 7, v1
    v_lshl_add_u32 v19, v20, 4, v19
    s_lshl_b32 s8, s12, 7
    v_add_u32 v19, s8, v19
    v_subrev_u32 v20, 16384, v19
    v_lshrrev_b32 v21, 5, v1
    v_lshlrev_b32 v21, 11, v21
    v_and_b32 v18, 31, v1
    v_lshl_add_u32 v21, v18, 2, v21
    s_lshl_b32 s8, s3, 12
    s_add_u32 s91, s8, 98304
    v_add_u32 v21, s91, v21
    v_mov_b32 v6, 0x24a00
    v_mov_b32 v7, 0
    ds_write_b32 v6, v7 offset:4
    ds_write_b32 v6, v7 offset:8
    ds_write_b32 v6, v7 offset:12
    ds_write_b32 v6, v7 offset:16
    s_waitcnt lgkmcnt(0)
    s_waitcnt vmcnt(8)
    s_barrier
    s_add_u32 s11, s90, 2
    s_and_b32 s11, s11, 15
    s_lshl_b32 s11, s11, 7
    s_add_u32 m0, s10, 0x10000
    s_nop 0
    buffer_load_dwordx4 v8, s[56:59], s11 offen offset:0 lds
    buffer_load_dwordx4 v9, s[56:59], s11 offen offset:1024 lds
    buffer_load_dwordx4 v10, s[56:59], s11 offen offset:2048 lds
    buffer_load_dwordx4 v11, s[56:59], s11 offen offset:3072 lds
    s_add_u32 m0, s10, 0x14000
    s_nop 0
    buffer_load_dwordx4 v12, s[60:63], s11 offen offset:0 lds
    buffer_load_dwordx4 v13, s[60:63], s11 offen offset:1024 lds
    buffer_load_dwordx4 v14, s[60:63], s11 offen offset:2048 lds
    buffer_load_dwordx4 v15, s[60:63], s11 offen offset:3072 lds
    buffer_load_dwordx4 v[72:75], v26, s[56:59], 0 offen offset:0
    buffer_load_dwordx4 v[76:79], v26, s[56:59], 0 offen offset:1024
    buffer_load_dwordx4 v[80:83], v26, s[56:59], 0 offen offset:2048
    buffer_load_dwordx4 v[84:87], v26, s[56:59], 0 offen offset:3072
    global_load_dwordx4 v[88:91], v25, s[46:47] offset:0
    global_load_dwordx4 v[92:95], v25, s[46:47] offset:1024
    s_waitcnt vmcnt(14)
    s_barrier
    s_add_u32 s11, s90, 3
    s_and_b32 s11, s11, 15
    s_lshl_b32 s11, s11, 7
    s_add_u32 m0, s10, 0x0
    s_nop 0
    buffer_load_dwordx4 v8, s[56:59], s11 offen offset:0 lds
    buffer_load_dwordx4 v9, s[56:59], s11 offen offset:1024 lds
    buffer_load_dwordx4 v10, s[56:59], s11 offen offset:2048 lds
    buffer_load_dwordx4 v11, s[56:59], s11 offen offset:3072 lds
    s_add_u32 m0, s10, 0x4000
    s_nop 0
    buffer_load_dwordx4 v12, s[60:63], s11 offen offset:0 lds
    buffer_load_dwordx4 v13, s[60:63], s11 offen offset:1024 lds
    buffer_load_dwordx4 v14, s[60:63], s11 offen offset:2048 lds
    buffer_load_dwordx4 v15, s[60:63], s11 offen offset:3072 lds
    s_waitcnt vmcnt(14)
    s_barrier
    s_add_u32 s11, s90, 4
    s_and_b32 s11, s11, 15
    s_lshl_b32 s11, s11, 7
    s_add_u32 m0, s10, 0x8000
    s_nop 0
    buffer_load_dwordx4 v8, s[56:59], s11 offen offset:0 lds
    s_mov_b32 s12, 0xffff0000
    s_waitcnt vmcnt(9)
    v_lshlrev_b32 v96, 16, v88
    v_and_b32 v97, s12, v88
    v_lshlrev_b32 v98, 16, v89
    v_and_b32 v99, s12, v89
    v_lshlrev_b32 v100, 16, v90
    v_and_b32 v101, s12, v90
    v_lshlrev_b32 v102, 16, v91
    v_and_b32 v103, s12, v91
    buffer_load_dwordx4 v9, s[56:59], s11 offen offset:1024 lds
    v_lshlrev_b32 v104, 16, v92
    v_and_b32 v105, s12, v92
    v_lshlrev_b32 v106, 16, v93
    v_and_b32 v107, s12, v93
    v_lshlrev_b32 v108, 16, v94
    v_and_b32 v109, s12, v94
    v_lshlrev_b32 v110, 16, v95
    v_and_b32 v111, s12, v95
    v_mov_b32 v112, 0
    v_lshlrev_b32 v116, 16, v72
    buffer_load_dwordx4 v10, s[56:59], s11 offen offset:2048 lds
    v_and_b32 v117, s12, v72
    v_mul_f32 v116, v116, v96
    v_mul_f32 v117, v117, v97
    v_cvt_pk_bf16_f32 v118, v116, v117
    v_lshlrev_b32 v116, 16, v118
    v_and_b32 v117, s12, v118
    v_add_f32 v112, v112, v116
    v_add_f32 v112, v112, v117
    v_lshlrev_b32 v116, 16, v73
    v_and_b32 v117, s12, v73
    buffer_load_dwordx4 v11, s[56:59], s11 offen offset:3072 lds
    v_mul_f32 v116, v116, v98
    v_mul_f32 v117, v117, v99
    v_cvt_pk_bf16_f32 v118, v116, v117
    v_lshlrev_b32 v116, 16, v118
    v_and_b32 v117, s12, v118
    v_add_f32 v112, v112, v116
    v_add_f32 v112, v112, v117
    v_lshlrev_b32 v116, 16, v74
    v_and_b32 v117, s12, v74
    v_mul_f32 v116, v116, v100
    s_add_u32 m0, s10, 0xc000
    s_nop 0
    buffer_load_dwordx4 v12, s[60:63], s11 offen offset:0 lds
    v_mul_f32 v117, v117, v101
    v_cvt_pk_bf16_f32 v118, v116, v117
    v_lshlrev_b32 v116, 16, v118
    v_and_b32 v117, s12, v118
    v_add_f32 v112, v112, v116
    v_add_f32 v112, v112, v117
    v_lshlrev_b32 v116, 16, v75
    v_and_b32 v117, s12, v75
    v_mul_f32 v116, v116, v102
    v_mul_f32 v117, v117, v103
    buffer_load_dwordx4 v13, s[60:63], s11 offen offset:1024 lds
    v_cvt_pk_bf16_f32 v118, v116, v117
    v_lshlrev_b32 v116, 16, v118
    v_and_b32 v117, s12, v118
    v_add_f32 v112, v112, v116
    v_add_f32 v112, v112, v117
    v_lshlrev_b32 v116, 16, v76
    v_and_b32 v117, s12, v76
    v_mul_f32 v116, v116, v104
    v_mul_f32 v117, v117, v105
    v_cvt_pk_bf16_f32 v118, v116, v117
    buffer_load_dwordx4 v14, s[60:63], s11 offen offset:2048 lds
    v_lshlrev_b32 v116, 16, v118
    v_and_b32 v117, s12, v118
    v_add_f32 v112, v112, v116
    v_add_f32 v112, v112, v117
    v_lshlrev_b32 v116, 16, v77
    v_and_b32 v117, s12, v77
    v_mul_f32 v116, v116, v106
    v_mul_f32 v117, v117, v107
    v_cvt_pk_bf16_f32 v118, v116, v117
    v_lshlrev_b32 v116, 16, v118
    buffer_load_dwordx4 v15, s[60:63], s11 offen offset:3072 lds
    v_and_b32 v117, s12, v118
    v_add_f32 v112, v112, v116
    v_add_f32 v112, v112, v117
    v_lshlrev_b32 v116, 16, v78
    v_and_b32 v117, s12, v78
    v_mul_f32 v116, v116, v108
    v_mul_f32 v117, v117, v109
    v_cvt_pk_bf16_f32 v118, v116, v117
    v_lshlrev_b32 v116, 16, v118
    v_and_b32 v117, s12, v118
    s_add_u32 m0, s91, 16384
    s_nop 0
    buffer_load_dwordx4 v20, s[64:67], 0 offen lds
    s_add_u32 m0, s91, 17408
    s_mov_b32 s99, 0
    buffer_load_dwordx4 v19, s[64:67], s99 offen lds
    s_add_u32 m0, s91, 18432
    s_mov_b32 s99, 16384
    buffer_load_dwordx4 v19, s[64:67], s99 offen lds
    s_add_u32 m0, s91, 19456
    s_mov_b32 s99, 32768
    buffer_load_dwordx4 v19, s[64:67], s99 offen lds
    s_add_u32 m0, s91, 20480
    s_mov_b32 s99, 49152
    buffer_load_dwordx4 v19, s[64:67], s99 offen lds
    global_load_dwordx4 v[68:71], v22, s[40:41]
    s_add_u32 m0, s91, 0
    s_mov_b32 s99, 0
    buffer_load_dwordx4 v19, s[68:71], s99 offen lds
    s_add_u32 m0, s91, 1024
    s_mov_b32 s99, 16384
    buffer_load_dwordx4 v19, s[68:71], s99 offen lds
    s_add_u32 m0, s91, 2048
    s_mov_b32 s99, 32768
    buffer_load_dwordx4 v19, s[68:71], s99 offen lds
    s_add_u32 m0, s91, 3072
    s_mov_b32 s99, 49152
    buffer_load_dwordx4 v19, s[68:71], s99 offen lds
    s_waitcnt vmcnt(18)
    s_barrier
    s_add_u32 s11, s90, 5
    s_and_b32 s11, s11, 15
    s_lshl_b32 s11, s11, 7
    s_add_u32 m0, s10, 0x10000
    s_nop 0
    buffer_load_dwordx4 v8, s[56:59], s11 offen offset:0 lds
    v_add_f32 v112, v112, v116
    v_add_f32 v112, v112, v117
    v_lshlrev_b32 v116, 16, v79
    v_and_b32 v117, s12, v79
    v_mul_f32 v116, v116, v110
    v_mul_f32 v117, v117, v111
    v_cvt_pk_bf16_f32 v118, v116, v117
    v_lshlrev_b32 v116, 16, v118
    v_and_b32 v117, s12, v118
    v_add_f32 v112, v112, v116
    buffer_load_dwordx4 v9, s[56:59], s11 offen offset:1024 lds
    v_add_f32 v112, v112, v117
    v_mov_b32 v113, 0
    v_lshlrev_b32 v116, 16, v80
    v_and_b32 v117, s12, v80
    v_mul_f32 v116, v116, v96
    v_mul_f32 v117, v117, v97
    v_cvt_pk_bf16_f32 v118, v116, v117
    v_lshlrev_b32 v116, 16, v118
    v_and_b32 v117, s12, v118
    v_add_f32 v113, v113, v116
    buffer_load_dwordx4 v10, s[56:59], s11 offen offset:2048 lds
    v_add_f32 v113, v113, v117
    v_lshlrev_b32 v116, 16, v81
    v_and_b32 v117, s12, v81
    v_mul_f32 v116, v116, v98
    v_mul_f32 v117, v117, v99
    v_cvt_pk_bf16_f32 v118, v116, v117
    v_lshlrev_b32 v116, 16, v118
    v_and_b32 v117, s12, v118
    v_add_f32 v113, v113, v116
    v_add_f32 v113, v113, v117
    buffer_load_dwordx4 v11, s[56:59], s11 offen offset:3072 lds
    v_lshlrev_b32 v116, 16, v82
    v_and_b32 v117, s12, v82
    v_mul_f32 v116, v116, v100
    v_mul_f32 v117, v117, v101
    v_cvt_pk_bf16_f32 v118, v116, v117
    v_lshlrev_b32 v116, 16, v118
    v_and_b32 v117, s12, v118
    v_add_f32 v113, v113, v116
    v_add_f32 v113, v113, v117
    v_lshlrev_b32 v116, 16, v83
    s_add_u32 m0, s10, 0x14000
    s_nop 0
    buffer_load_dwordx4 v12, s[60:63], s11 offen offset:0 lds
    v_and_b32 v117, s12, v83
    v_mul_f32 v116, v116, v102
    v_mul_f32 v117, v117, v103
    v_cvt_pk_bf16_f32 v118, v116, v117
    v_lshlrev_b32 v116, 16, v118
    v_and_b32 v117, s12, v118
    v_add_f32 v113, v113, v116
    v_add_f32 v113, v113, v117
    v_lshlrev_b32 v116, 16, v84
    v_and_b32 v117, s12, v84
    buffer_load_dwordx4 v13, s[60:63], s11 offen offset:1024 lds
    v_mul_f32 v116, v116, v104
    v_mul_f32 v117, v117, v105
    v_cvt_pk_bf16_f32 v118, v116, v117
    v_lshlrev_b32 v116, 16, v118
    v_and_b32 v117, s12, v118
    v_add_f32 v113, v113, v116
    v_add_f32 v113, v113, v117
    v_lshlrev_b32 v116, 16, v85
    v_and_b32 v117, s12, v85
    v_mul_f32 v116, v116, v106
    buffer_load_dwordx4 v14, s[60:63], s11 offen offset:2048 lds
    v_mul_f32 v117, v117, v107
    v_cvt_pk_bf16_f32 v118, v116, v117
    v_lshlrev_b32 v116, 16, v118
    v_and_b32 v117, s12, v118
    v_add_f32 v113, v113, v116
    v_add_f32 v113, v113, v117
    v_lshlrev_b32 v116, 16, v86
    v_and_b32 v117, s12, v86
    v_mul_f32 v116, v116, v108
    v_mul_f32 v117, v117, v109
    buffer_load_dwordx4 v15, s[60:63], s11 offen offset:3072 lds
    v_cvt_pk_bf16_f32 v118, v116, v117
    v_lshlrev_b32 v116, 16, v118
    v_and_b32 v117, s12, v118
    v_add_f32 v113, v113, v116
    v_add_f32 v113, v113, v117
    v_lshlrev_b32 v116, 16, v87
    v_and_b32 v117, s12, v87
    v_mul_f32 v116, v116, v110
    v_mul_f32 v117, v117, v111
    v_cvt_pk_bf16_f32 v118, v116, v117
    s_waitcnt vmcnt(18)
    s_barrier
    s_add_u32 s11, s90, 6
    s_and_b32 s11, s11, 15
    s_lshl_b32 s11, s11, 7
    s_add_u32 m0, s10, 0x0
    s_nop 0
    buffer_load_dwordx4 v8, s[56:59], s11 offen offset:0 lds
    v_lshlrev_b32 v116, 16, v118
    v_and_b32 v117, s12, v118
    v_add_f32 v113, v113, v116
    v_add_f32 v113, v113, v117
    v_add_f32_dpp v112, v112, v112 row_shr:1 row_mask:0xf bank_mask:0xf bound_ctrl:0
    s_nop 1
    v_add_f32_dpp v112, v112, v112 row_shr:2 row_mask:0xf bank_mask:0xf bound_ctrl:0
    s_nop 1
    v_add_f32_dpp v112, v112, v112 row_shr:4 row_mask:0xf bank_mask:0xf bound_ctrl:0
    s_nop 1
    v_add_f32_dpp v112, v112, v112 row_shr:8 row_mask:0xf bank_mask:0xf bound_ctrl:0
    s_nop 1
    v_add_f32_dpp v112, v112, v112 row_bcast:15 row_mask:0xa bank_mask:0xf
    s_nop 1
    v_add_f32_dpp v112, v112, v112 row_bcast:31 row_mask:0xc bank_mask:0xf
    buffer_load_dwordx4 v9, s[56:59], s11 offen offset:1024 lds
    v_add_f32_dpp v113, v113, v113 row_shr:1 row_mask:0xf bank_mask:0xf bound_ctrl:0
    s_nop 1
    v_add_f32_dpp v113, v113, v113 row_shr:2 row_mask:0xf bank_mask:0xf bound_ctrl:0
    s_nop 1
    v_add_f32_dpp v113, v113, v113 row_shr:4 row_mask:0xf bank_mask:0xf bound_ctrl:0
    s_nop 1
    v_add_f32_dpp v113, v113, v113 row_shr:8 row_mask:0xf bank_mask:0xf bound_ctrl:0
    s_nop 1
    v_add_f32_dpp v113, v113, v113 row_bcast:15 row_mask:0xa bank_mask:0xf
    s_nop 1
    v_add_f32_dpp v113, v113, v113 row_bcast:31 row_mask:0xc bank_mask:0xf
    v_readlane_b32 s8, v112, 63
    v_readlane_b32 s9, v113, 63
    s_nop 0
    v_mov_b32 v116, s8
    v_mov_b32 v117, s9
    buffer_load_dwordx4 v10, s[56:59], s11 offen offset:2048 lds
    v_cmp_eq_u32 vcc, 1, v1
    s_nop 1
    v_cndmask_b32 v116, v116, v117, vcc
    v_cvt_pk_bf16_f32 v116, v116, v116
    v_lshlrev_b32 v116, 16, v116
    v_mul_f32 v116, 0xbfb8aa3b, v116
    v_exp_f32 v116, v116
    s_nop 0
    v_add_f32 v116, 1.0, v116
    v_rcp_f32 v116, v116
    s_nop 0
    v_cvt_pk_bf16_f32 v117, v116, v116
    v_lshlrev_b32 v116, 16, v117
    buffer_load_dwordx4 v11, s[56:59], s11 offen offset:3072 lds
    v_sub_f32 v118, 1.0, v116
    v_cvt_pk_bf16_f32 v116, v116, v118
    s_lshl_b32 s14, s14, 2
    v_lshl_add_u32 v117, v1, 2, s14
    s_mov_b64 exec, 3
    buffer_store_dword v116, v117, s[76:79], 0 offen sc1
    s_mov_b64 exec, -1
    s_add_u32 m0, s10, 0x4000
    s_nop 0
    buffer_load_dwordx4 v12, s[60:63], s11 offen offset:0 lds
    buffer_load_dwordx4 v13, s[60:63], s11 offen offset:1024 lds
    buffer_load_dwordx4 v14, s[60:63], s11 offen offset:2048 lds
    buffer_load_dwordx4 v15, s[60:63], s11 offen offset:3072 lds
    s_waitcnt vmcnt(9)
    s_barrier
    s_add_u32 s11, s90, 7
    s_and_b32 s11, s11, 15
    s_lshl_b32 s11, s11, 7
    s_add_u32 m0, s10, 0x8000
    s_nop 0
    buffer_load_dwordx4 v8, s[56:59], s11 offen offset:0 lds
    ds_read_b32 v32, v21 offset:17024
    ds_read_b32 v33, v21 offset:17152
    ds_read_b32 v34, v21 offset:17280
    ds_read_b32 v35, v21 offset:17408
    ds_read_b32 v36, v21 offset:17536
    ds_read_b32 v37, v21 offset:17664
    ds_read_b32 v38, v21 offset:17792
    ds_read_b32 v39, v21 offset:17920
    ds_read_b32 v40, v21 offset:18048
    buffer_load_dwordx4 v9, s[56:59], s11 offen offset:1024 lds
    ds_read_b32 v41, v21 offset:18176
    s_waitcnt lgkmcnt(0)
    ds_read_b32 v42, v21 offset:18304
    ds_read_b32 v43, v21 offset:18432
    ds_read_b32 v44, v21 offset:18560
    ds_read_b32 v45, v21 offset:18688
    ds_read_b32 v46, v21 offset:18816
    ds_read_b32 v47, v21 offset:18944
    ds_read_b32 v48, v21 offset:19072
    ds_read_b32 v49, v21 offset:19200
    buffer_load_dwordx4 v10, s[56:59], s11 offen offset:2048 lds
    ds_read_b32 v50, v21 offset:19328
    s_waitcnt lgkmcnt(0)
    v_lshlrev_b32 v96, 16, v32
    v_and_b32 v97, s12, v32
    v_lshlrev_b32 v98, 16, v33
    v_and_b32 v99, s12, v33
    v_lshlrev_b32 v100, 16, v34
    v_and_b32 v101, s12, v34
    v_lshlrev_b32 v102, 16, v35
    v_and_b32 v103, s12, v35
    buffer_load_dwordx4 v11, s[56:59], s11 offen offset:3072 lds
    v_lshlrev_b32 v104, 16, v36
    v_and_b32 v105, s12, v36
    v_lshlrev_b32 v106, 16, v37
    v_and_b32 v107, s12, v37
    v_lshlrev_b32 v108, 16, v38
    v_and_b32 v109, s12, v38
    v_lshlrev_b32 v110, 16, v39
    v_and_b32 v111, s12, v39
    v_lshlrev_b32 v112, 16, v40
    v_and_b32 v113, s12, v40
    s_add_u32 m0, s10, 0xc000
    s_nop 0
    buffer_load_dwordx4 v12, s[60:63], s11 offen offset:0 lds
    v_lshlrev_b32 v114, 16, v41
    v_and_b32 v115, s12, v41
    v_lshlrev_b32 v116, 16, v42
    v_and_b32 v117, s12, v42
    v_lshlrev_b32 v118, 16, v43
    v_and_b32 v119, s12, v43
    v_lshlrev_b32 v120, 16, v44
    v_and_b32 v121, s12, v44
    v_lshlrev_b32 v122, 16, v45
    v_and_b32 v123, s12, v45
    buffer_load_dwordx4 v13, s[60:63], s11 offen offset:1024 lds
    v_lshlrev_b32 v124, 16, v46
    v_and_b32 v125, s12, v46
    v_lshlrev_b32 v126, 16, v47
    v_and_b32 v127, s12, v47
    v_lshlrev_b32 v128, 16, v48
    v_and_b32 v129, s12, v48
    v_lshlrev_b32 v130, 16, v49
    v_and_b32 v131, s12, v49
    v_lshlrev_b32 v132, 16, v50
    v_and_b32 v133, s12, v50
    buffer_load_dwordx4 v14, s[60:63], s11 offen offset:2048 lds
    v_lshlrev_b32 v136, 16, v68
    v_lshlrev_b32 v137, 16, v70
    v_and_b32 v138, s12, v68
    v_and_b32 v139, s12, v70
    v_lshlrev_b32 v140, 16, v69
    v_lshlrev_b32 v141, 16, v71
    v_and_b32 v142, s12, v69
    v_and_b32 v143, s12, v71
    ds_read_b32 v208, v21 offset:0
    buffer_load_dwordx4 v15, s[60:63], s11 offen offset:3072 lds
    ds_read_b32 v209, v21 offset:128
    ds_read_b32 v210, v21 offset:256
    ds_read_b32 v211, v21 offset:384
    ds_read_b32 v212, v21 offset:512
    ds_read_b32 v213, v21 offset:640
    ds_read_b32 v214, v21 offset:768
    ds_read_b32 v215, v21 offset:896
    s_waitcnt lgkmcnt(0)
    ds_read_b32 v216, v21 offset:1024
    ds_read_b32 v217, v21 offset:1152
    s_waitcnt vmcnt(8)
    s_barrier
    s_add_u32 s11, s90, 8
    s_and_b32 s11, s11, 15
    s_lshl_b32 s11, s11, 7
    s_add_u32 m0, s10, 0x10000
    s_nop 0
    buffer_load_dwordx4 v8, s[56:59], s11 offen offset:0 lds
    ds_read_b32 v218, v21 offset:1280
    ds_read_b32 v219, v21 offset:1408
    ds_read_b32 v220, v21 offset:1536
    ds_read_b32 v221, v21 offset:1664
    ds_read_b32 v222, v21 offset:1792
    ds_read_b32 v223, v21 offset:1920
    s_waitcnt lgkmcnt(0)
    v_lshlrev_b32 v176, 16, v208
    v_and_b32 v177, s12, v208
    v_mul_f32 v144, v96, v142
    buffer_load_dwordx4 v9, s[56:59], s11 offen offset:1024 lds
    v_mul_f32 v145, v97, v143
    v_fmac_f32 v144, v98, v140
    v_fmac_f32 v145, v99, v141
    v_fmac_f32 v144, v100, v138
    v_fmac_f32 v145, v101, v139
    v_fmac_f32 v144, v102, v136
    v_fmac_f32 v145, v103, v137
    v_mul_f32 v144, v144, v176
    v_mul_f32 v145, v145, v177
    v_lshlrev_b32 v178, 16, v209
    buffer_load_dwordx4 v10, s[56:59], s11 offen offset:2048 lds
    v_and_b32 v179, s12, v209
    v_mul_f32 v146, v98, v142
    v_mul_f32 v147, v99, v143
    v_fmac_f32 v146, v100, v140
    v_fmac_f32 v147, v101, v141
    v_fmac_f32 v146, v102, v138
    v_fmac_f32 v147, v103, v139
    v_fmac_f32 v146, v104, v136
    v_fmac_f32 v147, v105, v137
    v_mul_f32 v146, v146, v178
    buffer_load_dwordx4 v11, s[56:59], s11 offen offset:3072 lds
    v_mul_f32 v147, v147, v179
    v_lshlrev_b32 v176, 16, v210
    v_and_b32 v177, s12, v210
    v_mul_f32 v148, v100, v142
    v_mul_f32 v149, v101, v143
    v_fmac_f32 v148, v102, v140
    v_fmac_f32 v149, v103, v141
    v_fmac_f32 v148, v104, v138
    v_fmac_f32 v149, v105, v139
    v_fmac_f32 v148, v106, v136
    s_add_u32 m0, s10, 0x14000
    s_nop 0
    buffer_load_dwordx4 v12, s[60:63], s11 offen offset:0 lds
    v_fmac_f32 v149, v107, v137
    v_mul_f32 v148, v148, v176
    v_mul_f32 v149, v149, v177
    v_lshlrev_b32 v178, 16, v211
    v_and_b32 v179, s12, v211
    v_mul_f32 v150, v102, v142
    v_mul_f32 v151, v103, v143
    v_fmac_f32 v150, v104, v140
    v_fmac_f32 v151, v105, v141
    v_fmac_f32 v150, v106, v138
    buffer_load_dwordx4 v13, s[60:63], s11 offen offset:1024 lds
    v_fmac_f32 v151, v107, v139
    v_fmac_f32 v150, v108, v136
    v_fmac_f32 v151, v109, v137
    v_mul_f32 v150, v150, v178
    v_mul_f32 v151, v151, v179
    v_lshlrev_b32 v176, 16, v212
    v_and_b32 v177, s12, v212
    v_mul_f32 v152, v104, v142
    v_mul_f32 v153, v105, v143
    v_fmac_f32 v152, v106, v140
    buffer_load_dwordx4 v14, s[60:63], s11 offen offset:2048 lds
    v_fmac_f32 v153, v107, v141
    v_fmac_f32 v152, v108, v138
    v_fmac_f32 v153, v109, v139
    v_fmac_f32 v152, v110, v136
    v_fmac_f32 v153, v111, v137
    v_mul_f32 v152, v152, v176
    v_mul_f32 v153, v153, v177
    v_lshlrev_b32 v178, 16, v213
    v_and_b32 v179, s12, v213
    v_mul_f32 v154, v106, v142
    buffer_load_dwordx4 v15, s[60:63], s11 offen offset:3072 lds
    v_mul_f32 v155, v107, v143
    v_fmac_f32 v154, v108, v140
    v_fmac_f32 v155, v109, v141
    v_fmac_f32 v154, v110, v138
    v_fmac_f32 v155, v111, v139
    v_fmac_f32 v154, v112, v136
    v_fmac_f32 v155, v113, v137
    v_mul_f32 v154, v154, v178
    v_mul_f32 v155, v155, v179
    v_lshlrev_b32 v176, 16, v214
    s_waitcnt vmcnt(8)
    s_barrier
    s_add_u32 s11, s90, 9
    s_and_b32 s11, s11, 15
    s_lshl_b32 s11, s11, 7
    s_add_u32 m0, s10, 0x0
    s_nop 0
    buffer_load_dwordx4 v8, s[56:59], s11 offen offset:0 lds
    v_and_b32 v177, s12, v214
    v_mul_f32 v156, v108, v142
    v_mul_f32 v157, v109, v143
    v_fmac_f32 v156, v110, v140
    v_fmac_f32 v157, v111, v141
    v_fmac_f32 v156, v112, v138
    v_fmac_f32 v157, v113, v139
    v_fmac_f32 v156, v114, v136
    v_fmac_f32 v157, v115, v137
    v_mul_f32 v156, v156, v176
    buffer_load_dwordx4 v9, s[56:59], s11 offen offset:1024 lds
    v_mul_f32 v157, v157, v177
    v_lshlrev_b32 v178, 16, v215
    v_and_b32 v179, s12, v215
    v_mul_f32 v158, v110, v142
    v_mul_f32 v159, v111, v143
    v_fmac_f32 v158, v112, v140
    v_fmac_f32 v159, v113, v141
    v_fmac_f32 v158, v114, v138
    v_fmac_f32 v159, v115, v139
    v_fmac_f32 v158, v116, v136
    buffer_load_dwordx4 v10, s[56:59], s11 offen offset:2048 lds
    v_fmac_f32 v159, v117, v137
    v_mul_f32 v158, v158, v178
    v_mul_f32 v159, v159, v179
    v_lshlrev_b32 v176, 16, v216
    v_and_b32 v177, s12, v216
    v_mul_f32 v160, v112, v142
    v_mul_f32 v161, v113, v143
    v_fmac_f32 v160, v114, v140
    v_fmac_f32 v161, v115, v141
    v_fmac_f32 v160, v116, v138
    buffer_load_dwordx4 v11, s[56:59], s11 offen offset:3072 lds
    v_fmac_f32 v161, v117, v139
    v_fmac_f32 v160, v118, v136
    v_fmac_f32 v161, v119, v137
    v_mul_f32 v160, v160, v176
    v_mul_f32 v161, v161, v177
    v_lshlrev_b32 v178, 16, v217
    v_and_b32 v179, s12, v217
    v_mul_f32 v162, v114, v142
    v_mul_f32 v163, v115, v143
    v_fmac_f32 v162, v116, v140
    s_add_u32 m0, s10, 0x4000
    s_nop 0
    buffer_load_dwordx4 v12, s[60:63], s11 offen offset:0 lds
    v_fmac_f32 v163, v117, v141
    v_fmac_f32 v162, v118, v138
    v_fmac_f32 v163, v119, v139
    v_fmac_f32 v162, v120, v136
    v_fmac_f32 v163, v121, v137
    v_mul_f32 v162, v162, v178
    v_mul_f32 v163, v163, v179
    v_lshlrev_b32 v176, 16, v218
    v_and_b32 v177, s12, v218
    v_mul_f32 v164, v116, v142
    buffer_load_dwordx4 v13, s[60:63], s11 offen offset:1024 lds
    v_mul_f32 v165, v117, v143
    v_fmac_f32 v164, v118, v140
    v_fmac_f32 v165, v119, v141
    v_fmac_f32 v164, v120, v138
    v_fmac_f32 v165, v121, v139
    v_fmac_f32 v164, v122, v136
    v_fmac_f32 v165, v123, v137
    v_mul_f32 v164, v164, v176
    v_mul_f32 v165, v165, v177
    v_lshlrev_b32 v178, 16, v219
    buffer_load_dwordx4 v14, s[60:63], s11 offen offset:2048 lds
    v_and_b32 v179, s12, v219
    v_mul_f32 v166, v118, v142
    v_mul_f32 v167, v119, v143
    v_fmac_f32 v166, v120, v140
    v_fmac_f32 v167, v121, v141
    v_fmac_f32 v166, v122, v138
    v_fmac_f32 v167, v123, v139
    v_fmac_f32 v166, v124, v136
    v_fmac_f32 v167, v125, v137
    v_mul_f32 v166, v166, v178
    buffer_load_dwordx4 v15, s[60:63], s11 offen offset:3072 lds
    v_mul_f32 v167, v167, v179
    v_lshlrev_b32 v176, 16, v220
    v_and_b32 v177, s12, v220
    v_mul_f32 v168, v120, v142
    v_mul_f32 v169, v121, v143
    v_fmac_f32 v168, v122, v140
    v_fmac_f32 v169, v123, v141
    v_fmac_f32 v168, v124, v138
    v_fmac_f32 v169, v125, v139
    v_fmac_f32 v168, v126, v136
    s_cmp_ge_u32 s3, 2
    s_cselect_b32 s96, s28, s26
    s_cselect_b32 s97, s29, s27
    s_lshl_b32 s98, s2, 13
    s_and_b32 s99, s3, 1
    s_lshl_b32 s99, s99, 12
    s_add_u32 s98, s98, s99
    v_and_b32 v240, 31, v1
    v_lshl_add_u32 v240, v240, 7, s98
    global_load_dword v241, v240, s[96:97]
    v_lshlrev_b32 v246, 2, v1
    global_load_dword v247, v246, s[50:51] sc1
    s_waitcnt vmcnt(10)
    s_barrier
    s_add_u32 s11, s90, 10
    s_and_b32 s11, s11, 15
    s_lshl_b32 s11, s11, 7
    s_add_u32 m0, s10, 0x8000
    s_nop 0
    buffer_load_dwordx4 v8, s[56:59], s11 offen offset:0 lds
    v_fmac_f32 v169, v127, v137
    v_mul_f32 v168, v168, v176
    v_mul_f32 v169, v169, v177
    v_lshlrev_b32 v178, 16, v221
    v_and_b32 v179, s12, v221
    v_mul_f32 v170, v122, v142
    v_mul_f32 v171, v123, v143
    v_fmac_f32 v170, v124, v140
    v_fmac_f32 v171, v125, v141
    v_fmac_f32 v170, v126, v138
    buffer_load_dwordx4 v9, s[56:59], s11 offen offset:1024 lds
    v_fmac_f32 v171, v127, v139
    v_fmac_f32 v170, v128, v136
    v_fmac_f32 v171, v129, v137
    v_mul_f32 v170, v170, v178
    v_mul_f32 v171, v171, v179
    v_lshlrev_b32 v176, 16, v222
    v_and_b32 v177, s12, v222
    v_mul_f32 v172, v124, v142
    v_mul_f32 v173, v125, v143
    v_fmac_f32 v172, v126, v140
    buffer_load_dwordx4 v10, s[56:59], s11 offen offset:2048 lds
    v_fmac_f32 v173, v127, v141
    v_fmac_f32 v172, v128, v138
    v_fmac_f32 v173, v129, v139
    v_fmac_f32 v172, v130, v136
    v_fmac_f32 v173, v131, v137
    v_mul_f32 v172, v172, v176
    v_mul_f32 v173, v173, v177
    v_lshlrev_b32 v178, 16, v223
    v_and_b32 v179, s12, v223
    v_mul_f32 v174, v126, v142
    buffer_load_dwordx4 v11, s[56:59], s11 offen offset:3072 lds
    v_mul_f32 v175, v127, v143
    v_fmac_f32 v174, v128, v140
    v_fmac_f32 v175, v129, v141
    v_fmac_f32 v174, v130, v138
    v_fmac_f32 v175, v131, v139
    v_fmac_f32 v174, v132, v136
    v_fmac_f32 v175, v133, v137
    v_mul_f32 v174, v174, v178
    v_mul_f32 v175, v175, v179
    v_cvt_pk_bf16_f32 v192, v174, v172
    s_add_u32 m0, s10, 0xc000
    s_nop 0
    buffer_load_dwordx4 v12, s[60:63], s11 offen offset:0 lds
    v_cvt_pk_bf16_f32 v193, v170, v168
    v_cvt_pk_bf16_f32 v194, v166, v164
    v_cvt_pk_bf16_f32 v195, v162, v160
    ds_write_b128 v23, v[192:195] offset:0
    v_cvt_pk_bf16_f32 v196, v158, v156
    v_cvt_pk_bf16_f32 v197, v154, v152
    v_cvt_pk_bf16_f32 v198, v150, v148
    v_cvt_pk_bf16_f32 v199, v146, v144
    ds_write_b128 v23, v[196:199] offset:16
    v_cvt_pk_bf16_f32 v200, v175, v173
    buffer_load_dwordx4 v13, s[60:63], s11 offen offset:1024 lds
    v_cvt_pk_bf16_f32 v201, v171, v169
    v_cvt_pk_bf16_f32 v202, v167, v165
    v_cvt_pk_bf16_f32 v203, v163, v161
    ds_write_b128 v23, v[200:203] offset:272
    v_cvt_pk_bf16_f32 v204, v159, v157
    v_cvt_pk_bf16_f32 v205, v155, v153
    v_cvt_pk_bf16_f32 v206, v151, v149
    v_cvt_pk_bf16_f32 v207, v147, v145
    ds_write_b128 v23, v[204:207] offset:288
    s_waitcnt lgkmcnt(0)
    buffer_load_dwordx4 v14, s[60:63], s11 offen offset:2048 lds
    buffer_load_dwordx4 v15, s[60:63], s11 offen offset:3072 lds
    s_waitcnt vmcnt(10)
    s_barrier
    s_add_u32 s11, s90, 11
    s_and_b32 s11, s11, 15
    s_lshl_b32 s11, s11, 7
    s_add_u32 m0, s10, 0x10000
    s_nop 0
    buffer_load_dwordx4 v8, s[56:59], s11 offen offset:0 lds
    ds_read_b128 v[192:195], v24 offset:0
    ds_read_b128 v[196:199], v24 offset:1088
    ds_read_b128 v[200:203], v24 offset:2176
    ds_read_b128 v[204:207], v24 offset:3264
    s_waitcnt vmcnt(9)
    s_getreg_b32 s98, hwreg(HW_REG_XCC_ID, 0, 4)
    s_lshl_b32 s98, 0x100, s98
    s_or_b32 s98, s98, 15
    v_and_b32 v246, 7, v1
    v_cmp_eq_u32 s[96:97], s54, v246
    v_cmp_ne_u32 vcc, s98, v247
    s_nop 1
    s_and_b64 vcc, vcc, s[96:97]
    s_cbranch_scc0 h_kvl
    s_waitcnt lgkmcnt(3)
    buffer_store_dwordx4 v[192:195], v27, s[72:75], s80 offen sc1
    s_waitcnt lgkmcnt(2)
    buffer_store_dwordx4 v[196:199], v27, s[72:75], s84 offen sc1
    s_waitcnt lgkmcnt(1)
    buffer_store_dwordx4 v[200:203], v3, s[72:75], s80 offen sc1
    s_waitcnt lgkmcnt(0)
    buffer_store_dwordx4 v[204:207], v3, s[72:75], s84 offen sc1
    s_branch h_kve
h_kvl:
    s_waitcnt lgkmcnt(3)
    buffer_store_dwordx4 v[192:195], v27, s[72:75], s80 offen
    s_waitcnt lgkmcnt(2)
    buffer_store_dwordx4 v[196:199], v27, s[72:75], s84 offen
    s_waitcnt lgkmcnt(1)
    buffer_store_dwordx4 v[200:203], v3, s[72:75], s80 offen
    s_waitcnt lgkmcnt(0)
    buffer_store_dwordx4 v[204:207], v3, s[72:75], s84 offen
h_kve:
    s_lshl_b32 s12, s88, 12
    s_add_u32 s64, s42, s12
    s_addc_u32 s65, s43, 0
    s_mov_b32 s66, 0x1000
    s_mov_b32 s67, 0x20000
    buffer_load_dwordx4 v9, s[56:59], s11 offen offset:1024 lds
    s_add_u32 s68, s52, s12
    s_addc_u32 s69, s53, 0
    s_add_u32 s68, s68, 0x800000
    s_addc_u32 s69, s69, 0
    s_mov_b32 s70, 0x1000
    s_mov_b32 s71, 0x20000
    s_mov_b32 s80, s100
    s_mov_b32 s81, s101
    v_and_b32 v37, 15, v1
    s_lshr_b32 s8, s88, 6
    buffer_load_dwordx4 v10, s[56:59], s11 offen offset:2048 lds
    s_and_b32 s8, s8, 1
    s_lshl_b32 s8, s8, 3
    s_add_u32 s8, s8, s54
    v_lshl_add_u32 v32, v37, 4, s8
    s_lshr_b32 s8, s4, 2
    s_lshl_b32 s8, s8, 1
    s_and_b32 s9, s4, 3
    s_lshl_b32 s9, s9, 3
    s_add_u32 s8, s8, s9
    v_lshrrev_b32 v38, 3, v37
    buffer_load_dwordx4 v11, s[56:59], s11 offen offset:3072 lds
    v_and_b32 v39, 7, v37
    v_lshl_add_u32 v38, v39, 5, v38
    v_add_u32 v38, s8, v38
    v_and_b32 v39, 16, v1
    v_cmp_ne_u32 vcc, 0, v39
    s_nop 1
    v_cndmask_b32 v32, v32, v38, vcc
    v_lshlrev_b32 v32, 7, v32
    v_add_u32 v32, 0x20000, v32
    v_lshlrev_b32 v33, 2, v1
    s_mov_b32 s76, s50
    s_add_u32 m0, s10, 0x14000
    s_nop 0
    buffer_load_dwordx4 v12, s[60:63], s11 offen offset:0 lds
    s_mov_b32 s77, s51
    s_mov_b32 s78, 0x100
    s_mov_b32 s79, 0x20000
    s_mul_i32 s13, s3, 8320
    s_add_u32 s13, s13, 98304
    s_mul_i32 s82, s3, 4608
    s_add_u32 s82, s82, 131584
    v_add_u32 v36, 2, v25
    v_and_b32 v38, 7, v1
    v_lshlrev_b32 v38, 2, v38
    buffer_load_dwordx4 v13, s[60:63], s11 offen offset:1024 lds
    v_bfe_u32 v39, v1, 3, 1
    v_mul_u32_u24 v39, 4160, v39
    v_add3_u32 v38, v38, v39, s13
    s_lshl_b32 s80, s80, 16
    v_mov_b32 v56, s80
    v_cmp_eq_u32 vcc, 15, v37
    s_nop 1
    v_cndmask_b32 v56, 0, v56, vcc
    ds_write_b32 v38, v56
    s_and_b32 s14, s88, 1
    s_lshl_b32 s14, s14, 4
    buffer_load_dwordx4 v14, s[60:63], s11 offen offset:2048 lds
    s_lshr_b32 s81, s81, s14
    s_lshl_b32 s81, s81, 16
    v_mov_b32 v60, 0x24a00
    v_mov_b32 v61, 1
    buffer_load_dwordx4 v15, s[60:63], s11 offen offset:3072 lds
    s_waitcnt vmcnt(12)
    s_barrier
    s_add_u32 s11, s90, 12
    s_and_b32 s11, s11, 15
    s_lshl_b32 s11, s11, 7
    s_add_u32 m0, s10, 0x0
    s_nop 0
    buffer_load_dwordx4 v8, s[56:59], s11 offen offset:0 lds
    buffer_load_dwordx4 v9, s[56:59], s11 offen offset:1024 lds
    buffer_load_dwordx4 v10, s[56:59], s11 offen offset:2048 lds
    buffer_load_dwordx4 v11, s[56:59], s11 offen offset:3072 lds
    s_add_u32 m0, s10, 0x4000
    s_nop 0
    buffer_load_dwordx4 v12, s[60:63], s11 offen offset:0 lds
    buffer_load_dwordx4 v13, s[60:63], s11 offen offset:1024 lds
    buffer_load_dwordx4 v14, s[60:63], s11 offen offset:2048 lds
    buffer_load_dwordx4 v15, s[60:63], s11 offen offset:3072 lds
    s_waitcnt vmcnt(8)
    s_barrier
    s_cmp_lg_u32 s3, 0
    s_cbranch_scc1 h_kflag
    v_mov_b32 v6, 1
    buffer_store_dword v6, v30, s[92:95], 0 offen sc1
h_kflag:
    s_add_u32 s11, s90, 13
    s_and_b32 s11, s11, 15
    s_lshl_b32 s11, s11, 7
    s_add_u32 m0, s10, 0x8000
    s_nop 0
    buffer_load_dwordx4 v8, s[56:59], s11 offen offset:0 lds
    buffer_load_dwordx4 v9, s[56:59], s11 offen offset:1024 lds
    buffer_load_dwordx4 v10, s[56:59], s11 offen offset:2048 lds
    buffer_load_dwordx4 v11, s[56:59], s11 offen offset:3072 lds
    s_add_u32 m0, s10, 0xc000
    s_nop 0
    buffer_load_dwordx4 v12, s[60:63], s11 offen offset:0 lds
    buffer_load_dwordx4 v13, s[60:63], s11 offen offset:1024 lds
    buffer_load_dwordx4 v14, s[60:63], s11 offen offset:2048 lds
    buffer_load_dwordx4 v15, s[60:63], s11 offen offset:3072 lds
    s_waitcnt vmcnt(8)
    s_barrier
    s_add_u32 s11, s90, 14
    s_and_b32 s11, s11, 15
    s_lshl_b32 s11, s11, 7
    s_add_u32 m0, s10, 0x10000
    s_nop 0
    buffer_load_dwordx4 v8, s[56:59], s11 offen offset:0 lds
    buffer_load_dwordx4 v9, s[56:59], s11 offen offset:1024 lds
    buffer_load_dwordx4 v10, s[56:59], s11 offen offset:2048 lds
    buffer_load_dwordx4 v11, s[56:59], s11 offen offset:3072 lds
    s_add_u32 m0, s10, 0x14000
    s_nop 0
    buffer_load_dwordx4 v12, s[60:63], s11 offen offset:0 lds
    buffer_load_dwordx4 v13, s[60:63], s11 offen offset:1024 lds
    buffer_load_dwordx4 v14, s[60:63], s11 offen offset:2048 lds
    buffer_load_dwordx4 v15, s[60:63], s11 offen offset:3072 lds
    s_add_u32 m0, s13, 32
    s_nop 0
    buffer_load_dwordx4 v25, s[64:67], 0 offen offset:0 lds
    buffer_load_dwordx4 v25, s[64:67], 0 offen offset:1024 lds
    buffer_load_dwordx4 v25, s[64:67], 0 offen offset:2048 lds
    buffer_load_dwordx4 v25, s[64:67], 0 offen offset:3072 lds
    s_add_u32 m0, s13, 4192
    s_nop 0
    buffer_load_dwordx4 v36, s[64:67], 0 offen offset:0 lds
    buffer_load_dwordx4 v36, s[64:67], 0 offen offset:1024 lds
    buffer_load_dwordx4 v36, s[64:67], 0 offen offset:2048 lds
    buffer_load_dwordx4 v36, s[64:67], 0 offen offset:3072 lds
    s_waitcnt vmcnt(16)
    s_barrier
    s_add_u32 s11, s90, 15
    s_and_b32 s11, s11, 15
    s_lshl_b32 s11, s11, 7
    s_add_u32 m0, s10, 0x0
    s_nop 0
    buffer_load_dwordx4 v8, s[56:59], s11 offen offset:0 lds
    buffer_load_dwordx4 v9, s[56:59], s11 offen offset:1024 lds
    buffer_load_dwordx4 v10, s[56:59], s11 offen offset:2048 lds
    buffer_load_dwordx4 v11, s[56:59], s11 offen offset:3072 lds
    s_add_u32 m0, s10, 0x4000
    s_nop 0
    buffer_load_dwordx4 v12, s[60:63], s11 offen offset:0 lds
    buffer_load_dwordx4 v13, s[60:63], s11 offen offset:1024 lds
    buffer_load_dwordx4 v14, s[60:63], s11 offen offset:2048 lds
    buffer_load_dwordx4 v15, s[60:63], s11 offen offset:3072 lds
    buffer_load_dword v34, v33, s[76:79], 0 offen sc1
    buffer_load_dword v35, v32, s[92:95], 0 offen sc1
    s_waitcnt vmcnt(18)
    s_barrier
    s_mov_b32 s56, s26
    s_mov_b32 s57, s27
    s_mov_b32 s58, 0x200000
    s_mov_b32 s59, 0x20000
    s_mov_b32 s60, s28
    s_mov_b32 s61, s29
    s_mov_b32 s62, 0x200000
    s_mov_b32 s63, 0x20000
    s_lshl_b32 s10, s3, 11
    s_add_u32 s10, s10, 0x8000
    s_lshr_b32 s90, s5, 3
    s_xor_b32 s91, s90, 1
    s_lshl_b32 s91, s91, 20
    s_lshl_b32 s11, s90, 10
    s_add_u32 s91, s91, s11
    s_mul_i32 s90, s90, 0x100400
    v_mov_b32 v56, 0
    v_mov_b32 v57, 0
    v_lshlrev_b32 v38, 3, v1
    v_add_u32 v38, s82, v38
    ds_write_b64 v38, v[56:57] offset:4096
    s_waitcnt vmcnt(0)
    s_mov_b32 s83, 0
    v_and_b32 v34, 15, v34
    v_cmp_ne_u32 vcc, 15, v34
    v_cmp_ne_u32 s[84:85], 1, v35
    s_nop 1
    s_or_b64 vcc, vcc, s[84:85]
    s_cbranch_scc1 h_nou
    s_mov_b32 s83, 1
    buffer_load_dwordx4 v[40:43], v25, s[68:71], 0 offen offset:0 sc1
    buffer_load_dwordx4 v[44:47], v25, s[68:71], 0 offen offset:1024 sc1
    buffer_load_dwordx4 v[48:51], v25, s[68:71], 0 offen offset:2048 sc1
    buffer_load_dwordx4 v[52:55], v25, s[68:71], 0 offen offset:3072 sc1
h_nou:
    s_barrier
    v_lshrrev_b32 v5, 4, v1
    v_and_b32 v37, 15, v1
    v_lshl_add_u32 v38, v5, 3, v37
    v_lshlrev_b32 v38, 1, v38
    v_and_b32 v39, 1, v1
    v_mul_u32_u24 v39, 4158, v39
    v_sub_u32 v38, v38, v39
    s_add_u32 s14, s13, 4160
    v_add_u32 v16, s14, v38
    v_add_u32 v17, 1024, v16
    v_add_u32 v18, 2048, v16
    v_add_u32 v19, 3072, v16
    v_lshlrev_b32 v38, 5, v37
    v_lshlrev_b32 v39, 4, v5
    v_sub_u32 v20, v39, v38
    s_add_u32 s14, s82, 480
    v_add_u32 v20, s14, v20
    v_lshl_add_u32 v39, v5, 3, v38
    s_add_u32 s14, s82, 504
    v_sub_u32 v21, s14, v39
    v_and_b32 v39, 1, v5
    v_lshl_add_u32 v22, v39, 9, v38
    v_lshrrev_b32 v39, 1, v5
    v_lshl_add_u32 v22, v39, 4, v22
    v_add_u32 v23, s82, v25
    s_cmp_lg_u32 s83, 1
    s_cbranch_scc1 h_nouw
    s_waitcnt vmcnt(0)
    ds_write_b128 v23, v[40:43] offset:0
    ds_write_b128 v23, v[44:47] offset:1024
    ds_write_b128 v23, v[48:51] offset:2048
    ds_write_b128 v23, v[52:55] offset:3072
h_nouw:
    s_barrier
    s_mov_b32 s11, s15
    s_lshl_b32 s11, s11, 7
    s_add_u32 s99, s11, s91
    s_add_u32 m0, s10, 0x0
    s_nop 0
    buffer_load_dwordx4 v28, s[56:59], s99 offen offset:0 lds
    buffer_load_dwordx4 v29, s[56:59], s99 offen offset:1024 lds
    s_add_u32 s11, s11, s90
    s_add_u32 m0, s10, 0x2000
    s_nop 0
    buffer_load_dwordx4 v28, s[56:59], s11 offen offset:0 lds
    buffer_load_dwordx4 v29, s[56:59], s11 offen offset:1024 lds
    s_mov_b32 s11, s15
    s_lshl_b32 s11, s11, 7
    s_add_u32 s99, s11, s91
    s_add_u32 m0, s10, 0x4000
    s_nop 0
    buffer_load_dwordx4 v28, s[60:63], s99 offen offset:0 lds
    buffer_load_dwordx4 v29, s[60:63], s99 offen offset:1024 lds
    s_add_u32 s11, s11, s90
    s_add_u32 m0, s10, 0x6000
    s_nop 0
    buffer_load_dwordx4 v28, s[60:63], s11 offen offset:0 lds
    buffer_load_dwordx4 v29, s[60:63], s11 offen offset:1024 lds
    s_cmp_lg_u32 s83, 0
    s_cbranch_scc1 h_haveu
    s_mov_b32 s89, 65536
h_init_chk:
    v_and_b32 v34, 15, v34
    v_cmp_ne_u32 vcc, 15, v34
    s_nop 1
    s_cmp_eq_u64 vcc, 0
    s_cbranch_scc1 h_init_ok
    s_sub_u32 s89, s89, 1
    s_cbranch_scc1 h_init_ok
    s_sleep 4
    buffer_load_dword v34, v33, s[76:79], 0 offen sc1
    s_waitcnt vmcnt(0)
    s_branch h_init_chk
h_init_ok:
    s_mov_b32 s89, 65536
h_kf_chk:
    v_cmp_ne_u32 vcc, 1, v35
    s_nop 1
    s_cmp_eq_u64 vcc, 0
    s_cbranch_scc1 h_kf_ok
    s_sub_u32 s89, s89, 1
    s_cbranch_scc1 h_kf_ok
    s_sleep 4
    buffer_load_dword v35, v32, s[92:95], 0 offen sc1
    s_waitcnt vmcnt(0)
    s_branch h_kf_chk
h_kf_ok:
    buffer_load_dwordx4 v[40:43], v25, s[68:71], 0 offen offset:0 sc1
    buffer_load_dwordx4 v[44:47], v25, s[68:71], 0 offen offset:1024 sc1
    buffer_load_dwordx4 v[48:51], v25, s[68:71], 0 offen offset:2048 sc1
    buffer_load_dwordx4 v[52:55], v25, s[68:71], 0 offen offset:3072 sc1
    s_waitcnt vmcnt(0)
    ds_write_b128 v23, v[40:43] offset:0
    ds_write_b128 v23, v[44:47] offset:1024
    ds_write_b128 v23, v[48:51] offset:2048
    ds_write_b128 v23, v[52:55] offset:3072
h_haveu:
    s_mov_b64 exec, 1
    ds_add_u32 v60, v61 offset:8
    s_mov_b64 exec, -1
    s_mov_b32 s84, s68
    s_mov_b32 s85, s69
    s_mov_b32 s86, s70
    s_mov_b32 s87, s71
    s_add_u32 s68, s52, 0x800000
    s_addc_u32 s69, s53, 0
    s_mov_b32 s70, 0x400000
    s_mov_b32 s71, 0x20000
    s_waitcnt lgkmcnt(0)
    ds_read_b64 v[40:41], v21 offset:3584
    ds_read_b64 v[42:43], v21 offset:3072
    ds_read_b64 v[44:45], v21 offset:2560
    ds_read_b64 v[46:47], v21 offset:2048
    ds_read_b64 v[48:49], v21 offset:1536
    ds_read_b64 v[50:51], v21 offset:1024
    ds_read_b64 v[52:53], v21 offset:512
    ds_read_b64 v[54:55], v21 offset:0
    ds_read2_b32 v[160:161], v16 offset0:0 offset1:1
    ds_read2_b32 v[162:163], v16 offset0:2 offset1:3
    ds_read_b128 v[96:99], v20 offset:3584
    ds_read_b128 v[100:103], v20 offset:3072
    ds_read_b128 v[104:107], v20 offset:2560
    ds_read_b128 v[108:111], v20 offset:2048
    ds_read_b128 v[112:115], v20 offset:1536
    ds_read_b128 v[116:119], v20 offset:1024
    ds_read_b128 v[120:123], v20 offset:512
    ds_read_b128 v[124:127], v20 offset:0
    ds_read2_b32 v[164:165], v16 offset0:128 offset1:129
    ds_read2_b32 v[166:167], v16 offset0:130 offset1:131
    ds_read2_b32 v[168:169], v17 offset0:0 offset1:1
    ds_read2_b32 v[170:171], v17 offset0:2 offset1:3
    ds_read2_b32 v[172:173], v17 offset0:128 offset1:129
    ds_read2_b32 v[174:175], v17 offset0:130 offset1:131
    ds_read2_b32 v[176:177], v18 offset0:0 offset1:1
    ds_read2_b32 v[178:179], v18 offset0:2 offset1:3
    ds_read2_b32 v[180:181], v18 offset0:128 offset1:129
    ds_read2_b32 v[182:183], v18 offset0:130 offset1:131
    ds_read2_b32 v[184:185], v19 offset0:0 offset1:1
    ds_read2_b32 v[186:187], v19 offset0:2 offset1:3
    ds_read2_b32 v[188:189], v19 offset0:128 offset1:129
    ds_read2_b32 v[190:191], v19 offset0:130 offset1:131
    s_waitcnt lgkmcnt(15)
    v_mfma_f32_16x16x32_bf16 v[64:67], v[160:163], v[96:99], 0
    s_mov_b32 s12, 0xffff0000
    v_mov_b32 v26, s81
    v_mfma_f32_16x16x32_bf16 v[68:71], v[160:163], v[100:103], 0
    ds_read2_b32 v[192:193], v16 offset0:16 offset1:17
    v_mfma_f32_16x16x32_bf16 v[72:75], v[160:163], v[104:107], 0
    ds_read2_b32 v[194:195], v16 offset0:18 offset1:19
    v_mfma_f32_16x16x32_bf16 v[76:79], v[160:163], v[108:111], 0
    ds_read_b128 v[128:131], v20 offset:3648
    v_mfma_f32_16x16x32_bf16 v[80:83], v[160:163], v[112:115], 0
    ds_read_b128 v[132:135], v20 offset:3136
    v_mfma_f32_16x16x32_bf16 v[84:87], v[160:163], v[116:119], 0
    ds_read_b128 v[136:139], v20 offset:2624
    v_mfma_f32_16x16x32_bf16 v[88:91], v[160:163], v[120:123], 0
    ds_read_b128 v[140:143], v20 offset:2112
    s_waitcnt lgkmcnt(15)
    v_mfma_f32_16x16x32_bf16 v[92:95], v[160:163], v[124:127], 0
    ds_read_b128 v[144:147], v20 offset:1600
    v_mfma_f32_16x16x32_bf16 v[68:71], v[164:167], v[96:99], v[68:71]
    ds_read_b128 v[148:151], v20 offset:1088
    v_mfma_f32_16x16x32_bf16 v[72:75], v[164:167], v[100:103], v[72:75]
    ds_read_b128 v[152:155], v20 offset:576
    v_mfma_f32_16x16x32_bf16 v[76:79], v[164:167], v[104:107], v[76:79]
    ds_read_b128 v[156:159], v20 offset:64
    v_mfma_f32_16x16x32_bf16 v[80:83], v[164:167], v[108:111], v[80:83]
    ds_read2_b32 v[196:197], v16 offset0:144 offset1:145
    v_mfma_f32_16x16x32_bf16 v[84:87], v[164:167], v[112:115], v[84:87]
    ds_read2_b32 v[198:199], v16 offset0:146 offset1:147
    v_mfma_f32_16x16x32_bf16 v[88:91], v[164:167], v[116:119], v[88:91]
    ds_read2_b32 v[200:201], v17 offset0:16 offset1:17
    v_mfma_f32_16x16x32_bf16 v[92:95], v[164:167], v[120:123], v[92:95]
    ds_read2_b32 v[202:203], v17 offset0:18 offset1:19
    v_mfma_f32_16x16x32_bf16 v[72:75], v[168:171], v[96:99], v[72:75]
    ds_read2_b32 v[204:205], v17 offset0:144 offset1:145
    v_mfma_f32_16x16x32_bf16 v[76:79], v[168:171], v[100:103], v[76:79]
    ds_read2_b32 v[206:207], v17 offset0:146 offset1:147
    v_mfma_f32_16x16x32_bf16 v[80:83], v[168:171], v[104:107], v[80:83]
    ds_read2_b32 v[208:209], v18 offset0:16 offset1:17
    v_mfma_f32_16x16x32_bf16 v[84:87], v[168:171], v[108:111], v[84:87]
    ds_read2_b32 v[210:211], v18 offset0:18 offset1:19
    v_mfma_f32_16x16x32_bf16 v[88:91], v[168:171], v[112:115], v[88:91]
    ds_read2_b32 v[212:213], v18 offset0:144 offset1:145
    v_mfma_f32_16x16x32_bf16 v[92:95], v[168:171], v[116:119], v[92:95]
    ds_read2_b32 v[214:215], v18 offset0:146 offset1:147
    s_waitcnt lgkmcnt(15)
    v_mfma_f32_16x16x32_bf16 v[76:79], v[172:175], v[96:99], v[76:79]
    ds_read2_b32 v[216:217], v19 offset0:16 offset1:17
    v_mfma_f32_16x16x32_bf16 v[80:83], v[172:175], v[100:103], v[80:83]
    ds_read2_b32 v[218:219], v19 offset0:18 offset1:19
    v_mfma_f32_16x16x32_bf16 v[84:87], v[172:175], v[104:107], v[84:87]
    ds_read2_b32 v[220:221], v19 offset0:144 offset1:145
    v_mfma_f32_16x16x32_bf16 v[88:91], v[172:175], v[108:111], v[88:91]
    ds_read2_b32 v[222:223], v19 offset0:146 offset1:147
    v_mfma_f32_16x16x32_bf16 v[92:95], v[172:175], v[112:115], v[92:95]
    v_and_b32 v224, s12, v41
    v_lshlrev_b32 v225, 16, v41
    v_mfma_f32_16x16x32_bf16 v[80:83], v[176:179], v[96:99], v[80:83]
    v_and_b32 v226, s12, v40
    v_lshlrev_b32 v227, 16, v40
    v_mfma_f32_16x16x32_bf16 v[84:87], v[176:179], v[100:103], v[84:87]
    v_mul_f32 v224, v224, v26
    v_mul_f32 v225, v225, v26
    v_mfma_f32_16x16x32_bf16 v[88:91], v[176:179], v[104:107], v[88:91]
    v_mul_f32 v226, v226, v26
    v_mul_f32 v227, v227, v26
    v_mfma_f32_16x16x32_bf16 v[92:95], v[176:179], v[108:111], v[92:95]
    v_cvt_pk_bf16_f32 v56, v224, v225
    v_cvt_pk_bf16_f32 v57, v226, v227
    v_mfma_f32_16x16x32_bf16 v[84:87], v[180:183], v[96:99], v[84:87]
    v_lshlrev_b32 v224, 16, v56
    v_and_b32 v225, s12, v56
    v_mfma_f32_16x16x32_bf16 v[88:91], v[180:183], v[100:103], v[88:91]
    v_lshlrev_b32 v226, 16, v57
    v_and_b32 v227, s12, v57
    v_mfma_f32_16x16x32_bf16 v[92:95], v[180:183], v[104:107], v[92:95]
    v_and_b32 v228, s12, v43
    v_lshlrev_b32 v229, 16, v43
    v_mfma_f32_16x16x32_bf16 v[88:91], v[184:187], v[96:99], v[88:91]
    v_and_b32 v230, s12, v42
    v_lshlrev_b32 v231, 16, v42
    v_mfma_f32_16x16x32_bf16 v[92:95], v[184:187], v[100:103], v[92:95]
    v_mul_f32 v228, v228, v26
    v_mul_f32 v229, v229, v26
    v_mfma_f32_16x16x32_bf16 v[92:95], v[188:191], v[96:99], v[92:95]
    v_mul_f32 v230, v230, v26
    v_mul_f32 v231, v231, v26
    v_mfma_f32_16x16x32_bf16 v[64:67], v[192:195], v[128:131], v[64:67]
    v_cvt_pk_bf16_f32 v56, v228, v229
    v_cvt_pk_bf16_f32 v57, v230, v231
    v_mfma_f32_16x16x32_bf16 v[68:71], v[192:195], v[132:135], v[68:71]
    ds_read2_b32 v[160:161], v16 offset0:32 offset1:33
    v_mfma_f32_16x16x32_bf16 v[72:75], v[192:195], v[136:139], v[72:75]
    ds_read2_b32 v[162:163], v16 offset0:34 offset1:35
    s_waitcnt lgkmcnt(15)
    v_mfma_f32_16x16x32_bf16 v[76:79], v[192:195], v[140:143], v[76:79]
    ds_read_b128 v[96:99], v20 offset:3712
    v_mfma_f32_16x16x32_bf16 v[80:83], v[192:195], v[144:147], v[80:83]
    ds_read_b128 v[100:103], v20 offset:3200
    v_mfma_f32_16x16x32_bf16 v[84:87], v[192:195], v[148:151], v[84:87]
    ds_read_b128 v[104:107], v20 offset:2688
    v_mfma_f32_16x16x32_bf16 v[88:91], v[192:195], v[152:155], v[88:91]
    ds_read_b128 v[108:111], v20 offset:2176
    v_mfma_f32_16x16x32_bf16 v[92:95], v[192:195], v[156:159], v[92:95]
    ds_read_b128 v[112:115], v20 offset:1664
    s_waitcnt lgkmcnt(15)
    v_mfma_f32_16x16x32_bf16 v[68:71], v[196:199], v[128:131], v[68:71]
    ds_read_b128 v[116:119], v20 offset:1152
    v_mfma_f32_16x16x32_bf16 v[72:75], v[196:199], v[132:135], v[72:75]
    ds_read_b128 v[120:123], v20 offset:640
    v_mfma_f32_16x16x32_bf16 v[76:79], v[196:199], v[136:139], v[76:79]
    ds_read_b128 v[124:127], v20 offset:128
    v_mfma_f32_16x16x32_bf16 v[80:83], v[196:199], v[140:143], v[80:83]
    ds_read2_b32 v[164:165], v16 offset0:160 offset1:161
    v_mfma_f32_16x16x32_bf16 v[84:87], v[196:199], v[144:147], v[84:87]
    ds_read2_b32 v[166:167], v16 offset0:162 offset1:163
    v_mfma_f32_16x16x32_bf16 v[88:91], v[196:199], v[148:151], v[88:91]
    ds_read2_b32 v[168:169], v17 offset0:32 offset1:33
    v_mfma_f32_16x16x32_bf16 v[92:95], v[196:199], v[152:155], v[92:95]
    ds_read2_b32 v[170:171], v17 offset0:34 offset1:35
    v_mfma_f32_16x16x32_bf16 v[72:75], v[200:203], v[128:131], v[72:75]
    ds_read2_b32 v[172:173], v17 offset0:160 offset1:161
    v_mfma_f32_16x16x32_bf16 v[76:79], v[200:203], v[132:135], v[76:79]
    ds_read2_b32 v[174:175], v17 offset0:162 offset1:163
    v_mfma_f32_16x16x32_bf16 v[80:83], v[200:203], v[136:139], v[80:83]
    ds_read2_b32 v[176:177], v18 offset0:32 offset1:33
    v_mfma_f32_16x16x32_bf16 v[84:87], v[200:203], v[140:143], v[84:87]
    ds_read2_b32 v[178:179], v18 offset0:34 offset1:35
    v_mfma_f32_16x16x32_bf16 v[88:91], v[200:203], v[144:147], v[88:91]
    ds_read2_b32 v[180:181], v18 offset0:160 offset1:161
    v_mfma_f32_16x16x32_bf16 v[92:95], v[200:203], v[148:151], v[92:95]
    ds_read2_b32 v[182:183], v18 offset0:162 offset1:163
    v_mfma_f32_16x16x32_bf16 v[76:79], v[204:207], v[128:131], v[76:79]
    ds_read2_b32 v[184:185], v19 offset0:32 offset1:33
    v_mfma_f32_16x16x32_bf16 v[80:83], v[204:207], v[132:135], v[80:83]
    ds_read2_b32 v[186:187], v19 offset0:34 offset1:35
    v_mfma_f32_16x16x32_bf16 v[84:87], v[204:207], v[136:139], v[84:87]
    ds_read2_b32 v[188:189], v19 offset0:160 offset1:161
    v_mfma_f32_16x16x32_bf16 v[88:91], v[204:207], v[140:143], v[88:91]
    ds_read2_b32 v[190:191], v19 offset0:162 offset1:163
    v_mfma_f32_16x16x32_bf16 v[92:95], v[204:207], v[144:147], v[92:95]
    v_lshlrev_b32 v228, 16, v56
    v_and_b32 v229, s12, v56
    s_waitcnt lgkmcnt(15)
    v_mfma_f32_16x16x32_bf16 v[80:83], v[208:211], v[128:131], v[80:83]
    v_lshlrev_b32 v230, 16, v57
    v_and_b32 v231, s12, v57
    v_mfma_f32_16x16x32_bf16 v[84:87], v[208:211], v[132:135], v[84:87]
    v_and_b32 v232, s12, v45
    v_lshlrev_b32 v233, 16, v45
    v_mfma_f32_16x16x32_bf16 v[88:91], v[208:211], v[136:139], v[88:91]
    v_and_b32 v234, s12, v44
    v_lshlrev_b32 v235, 16, v44
    v_mfma_f32_16x16x32_bf16 v[92:95], v[208:211], v[140:143], v[92:95]
    v_mul_f32 v232, v232, v26
    v_mul_f32 v233, v233, v26
    v_mfma_f32_16x16x32_bf16 v[84:87], v[212:215], v[128:131], v[84:87]
    v_mul_f32 v234, v234, v26
    v_mul_f32 v235, v235, v26
    v_mfma_f32_16x16x32_bf16 v[88:91], v[212:215], v[132:135], v[88:91]
    v_cvt_pk_bf16_f32 v56, v232, v233
    v_cvt_pk_bf16_f32 v57, v234, v235
    v_mfma_f32_16x16x32_bf16 v[92:95], v[212:215], v[136:139], v[92:95]
    v_lshlrev_b32 v232, 16, v56
    v_and_b32 v233, s12, v56
    v_mfma_f32_16x16x32_bf16 v[88:91], v[216:219], v[128:131], v[88:91]
    v_lshlrev_b32 v234, 16, v57
    v_and_b32 v235, s12, v57
    v_mfma_f32_16x16x32_bf16 v[92:95], v[216:219], v[132:135], v[92:95]
    v_and_b32 v236, s12, v47
    v_lshlrev_b32 v237, 16, v47
    v_mfma_f32_16x16x32_bf16 v[92:95], v[220:223], v[128:131], v[92:95]
    v_and_b32 v238, s12, v46
    v_lshlrev_b32 v239, 16, v46
    v_mfma_f32_16x16x32_bf16 v[64:67], v[160:163], v[96:99], v[64:67]
    v_mul_f32 v236, v236, v26
    v_mul_f32 v237, v237, v26
    v_mfma_f32_16x16x32_bf16 v[68:71], v[160:163], v[100:103], v[68:71]
    ds_read2_b32 v[192:193], v16 offset0:48 offset1:49
    v_mfma_f32_16x16x32_bf16 v[72:75], v[160:163], v[104:107], v[72:75]
    ds_read2_b32 v[194:195], v16 offset0:50 offset1:51
    v_mfma_f32_16x16x32_bf16 v[76:79], v[160:163], v[108:111], v[76:79]
    ds_read_b128 v[128:131], v20 offset:3776
    v_mfma_f32_16x16x32_bf16 v[80:83], v[160:163], v[112:115], v[80:83]
    ds_read_b128 v[132:135], v20 offset:3264
    v_mfma_f32_16x16x32_bf16 v[84:87], v[160:163], v[116:119], v[84:87]
    ds_read_b128 v[136:139], v20 offset:2752
    v_mfma_f32_16x16x32_bf16 v[88:91], v[160:163], v[120:123], v[88:91]
    ds_read_b128 v[140:143], v20 offset:2240
    s_waitcnt lgkmcnt(15)
    v_mfma_f32_16x16x32_bf16 v[92:95], v[160:163], v[124:127], v[92:95]
    ds_read_b128 v[144:147], v20 offset:1728
    s_waitcnt vmcnt(0)
    s_mov_b64 exec, 1
    ds_add_u32 v60, v61 offset:16
    s_mov_b64 exec, -1
    v_mfma_f32_16x16x32_bf16 v[68:71], v[164:167], v[96:99], v[68:71]
    ds_read_b128 v[148:151], v20 offset:1216
    v_mfma_f32_16x16x32_bf16 v[72:75], v[164:167], v[100:103], v[72:75]
    ds_read_b128 v[152:155], v20 offset:704
    v_mfma_f32_16x16x32_bf16 v[76:79], v[164:167], v[104:107], v[76:79]
    ds_read_b128 v[156:159], v20 offset:192
    v_mfma_f32_16x16x32_bf16 v[80:83], v[164:167], v[108:111], v[80:83]
    ds_read2_b32 v[196:197], v16 offset0:176 offset1:177
    v_mfma_f32_16x16x32_bf16 v[84:87], v[164:167], v[112:115], v[84:87]
    ds_read2_b32 v[198:199], v16 offset0:178 offset1:179
    v_mfma_f32_16x16x32_bf16 v[88:91], v[164:167], v[116:119], v[88:91]
    ds_read2_b32 v[200:201], v17 offset0:48 offset1:49
    v_mfma_f32_16x16x32_bf16 v[92:95], v[164:167], v[120:123], v[92:95]
    ds_read2_b32 v[202:203], v17 offset0:50 offset1:51
    v_mfma_f32_16x16x32_bf16 v[72:75], v[168:171], v[96:99], v[72:75]
    ds_read2_b32 v[204:205], v17 offset0:176 offset1:177
    v_mfma_f32_16x16x32_bf16 v[76:79], v[168:171], v[100:103], v[76:79]
    ds_read2_b32 v[206:207], v17 offset0:178 offset1:179
    v_mfma_f32_16x16x32_bf16 v[80:83], v[168:171], v[104:107], v[80:83]
    ds_read2_b32 v[208:209], v18 offset0:48 offset1:49
    v_mfma_f32_16x16x32_bf16 v[84:87], v[168:171], v[108:111], v[84:87]
    ds_read2_b32 v[210:211], v18 offset0:50 offset1:51
    v_mfma_f32_16x16x32_bf16 v[88:91], v[168:171], v[112:115], v[88:91]
    ds_read2_b32 v[212:213], v18 offset0:176 offset1:177
    v_mfma_f32_16x16x32_bf16 v[92:95], v[168:171], v[116:119], v[92:95]
    ds_read2_b32 v[214:215], v18 offset0:178 offset1:179
    s_waitcnt lgkmcnt(15)
    v_mfma_f32_16x16x32_bf16 v[76:79], v[172:175], v[96:99], v[76:79]
    ds_read2_b32 v[216:217], v19 offset0:48 offset1:49
    v_mfma_f32_16x16x32_bf16 v[80:83], v[172:175], v[100:103], v[80:83]
    ds_read2_b32 v[218:219], v19 offset0:50 offset1:51
    v_mfma_f32_16x16x32_bf16 v[84:87], v[172:175], v[104:107], v[84:87]
    ds_read2_b32 v[220:221], v19 offset0:176 offset1:177
    v_mfma_f32_16x16x32_bf16 v[88:91], v[172:175], v[108:111], v[88:91]
    ds_read2_b32 v[222:223], v19 offset0:178 offset1:179
    v_mfma_f32_16x16x32_bf16 v[92:95], v[172:175], v[112:115], v[92:95]
    v_mul_f32 v238, v238, v26
    v_mul_f32 v239, v239, v26
    v_mfma_f32_16x16x32_bf16 v[80:83], v[176:179], v[96:99], v[80:83]
    v_cvt_pk_bf16_f32 v56, v236, v237
    v_cvt_pk_bf16_f32 v57, v238, v239
    v_mfma_f32_16x16x32_bf16 v[84:87], v[176:179], v[100:103], v[84:87]
    v_lshlrev_b32 v236, 16, v56
    v_and_b32 v237, s12, v56
    v_mfma_f32_16x16x32_bf16 v[88:91], v[176:179], v[104:107], v[88:91]
    v_lshlrev_b32 v238, 16, v57
    v_and_b32 v239, s12, v57
    v_mfma_f32_16x16x32_bf16 v[92:95], v[176:179], v[108:111], v[92:95]
    v_and_b32 v240, s12, v49
    v_lshlrev_b32 v241, 16, v49
    v_mfma_f32_16x16x32_bf16 v[84:87], v[180:183], v[96:99], v[84:87]
    v_and_b32 v242, s12, v48
    v_lshlrev_b32 v243, 16, v48
    v_mfma_f32_16x16x32_bf16 v[88:91], v[180:183], v[100:103], v[88:91]
    v_mul_f32 v240, v240, v26
    v_mul_f32 v241, v241, v26
    v_mfma_f32_16x16x32_bf16 v[92:95], v[180:183], v[104:107], v[92:95]
    v_mul_f32 v242, v242, v26
    v_mul_f32 v243, v243, v26
    v_mfma_f32_16x16x32_bf16 v[88:91], v[184:187], v[96:99], v[88:91]
    v_cvt_pk_bf16_f32 v56, v240, v241
    v_cvt_pk_bf16_f32 v57, v242, v243
    v_mfma_f32_16x16x32_bf16 v[92:95], v[184:187], v[100:103], v[92:95]
    v_lshlrev_b32 v240, 16, v56
    v_and_b32 v241, s12, v56
    v_mfma_f32_16x16x32_bf16 v[92:95], v[188:191], v[96:99], v[92:95]
    v_lshlrev_b32 v242, 16, v57
    v_and_b32 v243, s12, v57
    v_mfma_f32_16x16x32_bf16 v[64:67], v[192:195], v[128:131], v[64:67]
    v_and_b32 v244, s12, v51
    v_lshlrev_b32 v245, 16, v51
    v_mfma_f32_16x16x32_bf16 v[68:71], v[192:195], v[132:135], v[68:71]
    ds_read2_b32 v[160:161], v16 offset0:64 offset1:65
    v_mfma_f32_16x16x32_bf16 v[72:75], v[192:195], v[136:139], v[72:75]
    ds_read2_b32 v[162:163], v16 offset0:66 offset1:67
    v_mfma_f32_16x16x32_bf16 v[76:79], v[192:195], v[140:143], v[76:79]
    ds_read_b128 v[96:99], v20 offset:3840
    s_waitcnt lgkmcnt(15)
    v_mfma_f32_16x16x32_bf16 v[80:83], v[192:195], v[144:147], v[80:83]
    ds_read_b128 v[100:103], v20 offset:3328
    v_mfma_f32_16x16x32_bf16 v[84:87], v[192:195], v[148:151], v[84:87]
    ds_read_b128 v[104:107], v20 offset:2816
    v_mfma_f32_16x16x32_bf16 v[88:91], v[192:195], v[152:155], v[88:91]
    ds_read_b128 v[108:111], v20 offset:2304
    v_mfma_f32_16x16x32_bf16 v[92:95], v[192:195], v[156:159], v[92:95]
    ds_read_b128 v[112:115], v20 offset:1792
    v_mfma_f32_16x16x32_bf16 v[68:71], v[196:199], v[128:131], v[68:71]
    ds_read_b128 v[116:119], v20 offset:1280
    v_mfma_f32_16x16x32_bf16 v[72:75], v[196:199], v[132:135], v[72:75]
    ds_read_b128 v[120:123], v20 offset:768
    v_mfma_f32_16x16x32_bf16 v[76:79], v[196:199], v[136:139], v[76:79]
    ds_read_b128 v[124:127], v20 offset:256
    v_mfma_f32_16x16x32_bf16 v[80:83], v[196:199], v[140:143], v[80:83]
    ds_read2_b32 v[164:165], v16 offset0:192 offset1:193
    v_mfma_f32_16x16x32_bf16 v[84:87], v[196:199], v[144:147], v[84:87]
    ds_read2_b32 v[166:167], v16 offset0:194 offset1:195
    v_mfma_f32_16x16x32_bf16 v[88:91], v[196:199], v[148:151], v[88:91]
    ds_read2_b32 v[168:169], v17 offset0:64 offset1:65
    v_mfma_f32_16x16x32_bf16 v[92:95], v[196:199], v[152:155], v[92:95]
    ds_read2_b32 v[170:171], v17 offset0:66 offset1:67
    s_waitcnt lgkmcnt(15)
    v_mfma_f32_16x16x32_bf16 v[72:75], v[200:203], v[128:131], v[72:75]
    ds_read2_b32 v[172:173], v17 offset0:192 offset1:193
    v_mfma_f32_16x16x32_bf16 v[76:79], v[200:203], v[132:135], v[76:79]
    ds_read2_b32 v[174:175], v17 offset0:194 offset1:195
    v_mfma_f32_16x16x32_bf16 v[80:83], v[200:203], v[136:139], v[80:83]
    ds_read2_b32 v[176:177], v18 offset0:64 offset1:65
    v_mfma_f32_16x16x32_bf16 v[84:87], v[200:203], v[140:143], v[84:87]
    ds_read2_b32 v[178:179], v18 offset0:66 offset1:67
    v_mfma_f32_16x16x32_bf16 v[88:91], v[200:203], v[144:147], v[88:91]
    ds_read2_b32 v[180:181], v18 offset0:192 offset1:193
    v_mfma_f32_16x16x32_bf16 v[92:95], v[200:203], v[148:151], v[92:95]
    ds_read2_b32 v[182:183], v18 offset0:194 offset1:195
    v_mfma_f32_16x16x32_bf16 v[76:79], v[204:207], v[128:131], v[76:79]
    ds_read2_b32 v[184:185], v19 offset0:64 offset1:65
    v_mfma_f32_16x16x32_bf16 v[80:83], v[204:207], v[132:135], v[80:83]
    ds_read2_b32 v[186:187], v19 offset0:66 offset1:67
    v_mfma_f32_16x16x32_bf16 v[84:87], v[204:207], v[136:139], v[84:87]
    ds_read2_b32 v[188:189], v19 offset0:192 offset1:193
    v_mfma_f32_16x16x32_bf16 v[88:91], v[204:207], v[140:143], v[88:91]
    ds_read2_b32 v[190:191], v19 offset0:194 offset1:195
    v_mfma_f32_16x16x32_bf16 v[92:95], v[204:207], v[144:147], v[92:95]
    v_and_b32 v246, s12, v50
    v_lshlrev_b32 v247, 16, v50
    v_mfma_f32_16x16x32_bf16 v[80:83], v[208:211], v[128:131], v[80:83]
    v_mul_f32 v244, v244, v26
    v_mul_f32 v245, v245, v26
    v_mfma_f32_16x16x32_bf16 v[84:87], v[208:211], v[132:135], v[84:87]
    v_mul_f32 v246, v246, v26
    v_mul_f32 v247, v247, v26
    v_mfma_f32_16x16x32_bf16 v[88:91], v[208:211], v[136:139], v[88:91]
    v_cvt_pk_bf16_f32 v56, v244, v245
    v_cvt_pk_bf16_f32 v57, v246, v247
    v_mfma_f32_16x16x32_bf16 v[92:95], v[208:211], v[140:143], v[92:95]
    v_lshlrev_b32 v244, 16, v56
    v_and_b32 v245, s12, v56
    v_mfma_f32_16x16x32_bf16 v[84:87], v[212:215], v[128:131], v[84:87]
    v_lshlrev_b32 v246, 16, v57
    v_and_b32 v247, s12, v57
    v_mfma_f32_16x16x32_bf16 v[88:91], v[212:215], v[132:135], v[88:91]
    v_and_b32 v248, s12, v53
    v_lshlrev_b32 v249, 16, v53
    v_mfma_f32_16x16x32_bf16 v[92:95], v[212:215], v[136:139], v[92:95]
    v_and_b32 v250, s12, v52
    v_lshlrev_b32 v251, 16, v52
    v_mfma_f32_16x16x32_bf16 v[88:91], v[216:219], v[128:131], v[88:91]
    v_mul_f32 v248, v248, v26
    v_mul_f32 v249, v249, v26
    v_mfma_f32_16x16x32_bf16 v[92:95], v[216:219], v[132:135], v[92:95]
    v_mul_f32 v250, v250, v26
    v_mul_f32 v251, v251, v26
    s_waitcnt lgkmcnt(15)
    v_mfma_f32_16x16x32_bf16 v[92:95], v[220:223], v[128:131], v[92:95]
    v_cvt_pk_bf16_f32 v56, v248, v249
    v_cvt_pk_bf16_f32 v57, v250, v251
    v_mfma_f32_16x16x32_bf16 v[64:67], v[160:163], v[96:99], v[64:67]
    v_lshlrev_b32 v248, 16, v56
    v_and_b32 v249, s12, v56
    v_mfma_f32_16x16x32_bf16 v[68:71], v[160:163], v[100:103], v[68:71]
    ds_read2_b32 v[192:193], v16 offset0:80 offset1:81
    v_mfma_f32_16x16x32_bf16 v[72:75], v[160:163], v[104:107], v[72:75]
    ds_read2_b32 v[194:195], v16 offset0:82 offset1:83
    v_mfma_f32_16x16x32_bf16 v[76:79], v[160:163], v[108:111], v[76:79]
    ds_read_b128 v[128:131], v20 offset:3904
    v_mfma_f32_16x16x32_bf16 v[80:83], v[160:163], v[112:115], v[80:83]
    ds_read_b128 v[132:135], v20 offset:3392
    v_mfma_f32_16x16x32_bf16 v[84:87], v[160:163], v[116:119], v[84:87]
    ds_read_b128 v[136:139], v20 offset:2880
    v_mfma_f32_16x16x32_bf16 v[88:91], v[160:163], v[120:123], v[88:91]
    ds_read_b128 v[140:143], v20 offset:2368
    s_waitcnt lgkmcnt(15)
    v_mfma_f32_16x16x32_bf16 v[92:95], v[160:163], v[124:127], v[92:95]
    ds_read_b128 v[144:147], v20 offset:1856
    v_mfma_f32_16x16x32_bf16 v[68:71], v[164:167], v[96:99], v[68:71]
    ds_read_b128 v[148:151], v20 offset:1344
    v_mfma_f32_16x16x32_bf16 v[72:75], v[164:167], v[100:103], v[72:75]
    ds_read_b128 v[152:155], v20 offset:832
    v_mfma_f32_16x16x32_bf16 v[76:79], v[164:167], v[104:107], v[76:79]
    ds_read_b128 v[156:159], v20 offset:320
    v_mfma_f32_16x16x32_bf16 v[80:83], v[164:167], v[108:111], v[80:83]
    ds_read2_b32 v[196:197], v16 offset0:208 offset1:209
    v_mfma_f32_16x16x32_bf16 v[84:87], v[164:167], v[112:115], v[84:87]
    ds_read2_b32 v[198:199], v16 offset0:210 offset1:211
    v_mfma_f32_16x16x32_bf16 v[88:91], v[164:167], v[116:119], v[88:91]
    ds_read2_b32 v[200:201], v17 offset0:80 offset1:81
    v_mfma_f32_16x16x32_bf16 v[92:95], v[164:167], v[120:123], v[92:95]
    ds_read2_b32 v[202:203], v17 offset0:82 offset1:83
    v_mfma_f32_16x16x32_bf16 v[72:75], v[168:171], v[96:99], v[72:75]
    ds_read2_b32 v[204:205], v17 offset0:208 offset1:209
    v_mfma_f32_16x16x32_bf16 v[76:79], v[168:171], v[100:103], v[76:79]
    ds_read2_b32 v[206:207], v17 offset0:210 offset1:211
    v_mfma_f32_16x16x32_bf16 v[80:83], v[168:171], v[104:107], v[80:83]
    ds_read2_b32 v[208:209], v18 offset0:80 offset1:81
    v_mfma_f32_16x16x32_bf16 v[84:87], v[168:171], v[108:111], v[84:87]
    ds_read2_b32 v[210:211], v18 offset0:82 offset1:83
    v_mfma_f32_16x16x32_bf16 v[88:91], v[168:171], v[112:115], v[88:91]
    ds_read2_b32 v[212:213], v18 offset0:208 offset1:209
    v_mfma_f32_16x16x32_bf16 v[92:95], v[168:171], v[116:119], v[92:95]
    ds_read2_b32 v[214:215], v18 offset0:210 offset1:211
    s_waitcnt lgkmcnt(15)
    v_mfma_f32_16x16x32_bf16 v[76:79], v[172:175], v[96:99], v[76:79]
    ds_read2_b32 v[216:217], v19 offset0:80 offset1:81
    v_mfma_f32_16x16x32_bf16 v[80:83], v[172:175], v[100:103], v[80:83]
    ds_read2_b32 v[218:219], v19 offset0:82 offset1:83
    v_mfma_f32_16x16x32_bf16 v[84:87], v[172:175], v[104:107], v[84:87]
    ds_read2_b32 v[220:221], v19 offset0:208 offset1:209
    v_mfma_f32_16x16x32_bf16 v[88:91], v[172:175], v[108:111], v[88:91]
    ds_read2_b32 v[222:223], v19 offset0:210 offset1:211
    v_mfma_f32_16x16x32_bf16 v[92:95], v[172:175], v[112:115], v[92:95]
    v_lshlrev_b32 v250, 16, v57
    v_and_b32 v251, s12, v57
    v_mfma_f32_16x16x32_bf16 v[80:83], v[176:179], v[96:99], v[80:83]
    v_and_b32 v252, s12, v55
    v_lshlrev_b32 v253, 16, v55
    v_mfma_f32_16x16x32_bf16 v[84:87], v[176:179], v[100:103], v[84:87]
    v_and_b32 v254, s12, v54
    v_lshlrev_b32 v255, 16, v54
    v_mfma_f32_16x16x32_bf16 v[88:91], v[176:179], v[104:107], v[88:91]
    v_mul_f32 v252, v252, v26
    v_mul_f32 v253, v253, v26
    v_mfma_f32_16x16x32_bf16 v[92:95], v[176:179], v[108:111], v[92:95]
    v_mul_f32 v254, v254, v26
    v_mul_f32 v255, v255, v26
    v_mfma_f32_16x16x32_bf16 v[84:87], v[180:183], v[96:99], v[84:87]
    v_cvt_pk_bf16_f32 v56, v252, v253
    v_cvt_pk_bf16_f32 v57, v254, v255
    v_mfma_f32_16x16x32_bf16 v[88:91], v[180:183], v[100:103], v[88:91]
    v_lshlrev_b32 v252, 16, v56
    v_and_b32 v253, s12, v56
    v_mfma_f32_16x16x32_bf16 v[92:95], v[180:183], v[104:107], v[92:95]
    v_lshlrev_b32 v254, 16, v57
    v_and_b32 v255, s12, v57
    v_mfma_f32_16x16x32_bf16 v[88:91], v[184:187], v[96:99], v[88:91]
    v_mfma_f32_16x16x32_bf16 v[92:95], v[184:187], v[100:103], v[92:95]
    v_mfma_f32_16x16x32_bf16 v[92:95], v[188:191], v[96:99], v[92:95]
    v_mfma_f32_16x16x32_bf16 v[64:67], v[192:195], v[128:131], v[64:67]
    v_mfma_f32_16x16x32_bf16 v[68:71], v[192:195], v[132:135], v[68:71]
    ds_read2_b32 v[160:161], v16 offset0:96 offset1:97
    v_mfma_f32_16x16x32_bf16 v[72:75], v[192:195], v[136:139], v[72:75]
    ds_read2_b32 v[162:163], v16 offset0:98 offset1:99
    s_waitcnt lgkmcnt(15)
    v_mfma_f32_16x16x32_bf16 v[76:79], v[192:195], v[140:143], v[76:79]
    ds_read_b128 v[96:99], v20 offset:3968
    v_mfma_f32_16x16x32_bf16 v[80:83], v[192:195], v[144:147], v[80:83]
    ds_read_b128 v[100:103], v20 offset:3456
    v_mfma_f32_16x16x32_bf16 v[84:87], v[192:195], v[148:151], v[84:87]
    ds_read_b128 v[104:107], v20 offset:2944
    v_mfma_f32_16x16x32_bf16 v[88:91], v[192:195], v[152:155], v[88:91]
    ds_read_b128 v[108:111], v20 offset:2432
    v_mfma_f32_16x16x32_bf16 v[92:95], v[192:195], v[156:159], v[92:95]
    ds_read_b128 v[112:115], v20 offset:1920
    s_waitcnt lgkmcnt(15)
    v_mfma_f32_16x16x32_bf16 v[68:71], v[196:199], v[128:131], v[68:71]
    ds_read_b128 v[116:119], v20 offset:1408
    v_mfma_f32_16x16x32_bf16 v[72:75], v[196:199], v[132:135], v[72:75]
    ds_read_b128 v[120:123], v20 offset:896
    v_mfma_f32_16x16x32_bf16 v[76:79], v[196:199], v[136:139], v[76:79]
    ds_read_b128 v[124:127], v20 offset:384
    v_mfma_f32_16x16x32_bf16 v[80:83], v[196:199], v[140:143], v[80:83]
    ds_read2_b32 v[164:165], v16 offset0:224 offset1:225
    v_mfma_f32_16x16x32_bf16 v[84:87], v[196:199], v[144:147], v[84:87]
    ds_read2_b32 v[166:167], v16 offset0:226 offset1:227
    v_mfma_f32_16x16x32_bf16 v[88:91], v[196:199], v[148:151], v[88:91]
    ds_read2_b32 v[168:169], v17 offset0:96 offset1:97
    v_mfma_f32_16x16x32_bf16 v[92:95], v[196:199], v[152:155], v[92:95]
    ds_read2_b32 v[170:171], v17 offset0:98 offset1:99
    v_mfma_f32_16x16x32_bf16 v[72:75], v[200:203], v[128:131], v[72:75]
    ds_read2_b32 v[172:173], v17 offset0:224 offset1:225
    v_mfma_f32_16x16x32_bf16 v[76:79], v[200:203], v[132:135], v[76:79]
    ds_read2_b32 v[174:175], v17 offset0:226 offset1:227
    v_mfma_f32_16x16x32_bf16 v[80:83], v[200:203], v[136:139], v[80:83]
    ds_read2_b32 v[176:177], v18 offset0:96 offset1:97
    v_mfma_f32_16x16x32_bf16 v[84:87], v[200:203], v[140:143], v[84:87]
    ds_read2_b32 v[178:179], v18 offset0:98 offset1:99
    v_mfma_f32_16x16x32_bf16 v[88:91], v[200:203], v[144:147], v[88:91]
    ds_read2_b32 v[180:181], v18 offset0:224 offset1:225
    s_cmp_le_u32 s15, 0
    s_cselect_b32 s11, 1, 0
    s_lshl_b32 s11, s11, 7
    s_add_u32 s99, s11, s91
    s_add_u32 m0, s10, 0x8000
    s_nop 0
    buffer_load_dwordx4 v28, s[56:59], s99 offen offset:0 lds
    buffer_load_dwordx4 v29, s[56:59], s99 offen offset:1024 lds
    s_add_u32 s11, s11, s90
    s_add_u32 m0, s10, 0xa000
    s_nop 0
    buffer_load_dwordx4 v28, s[56:59], s11 offen offset:0 lds
    buffer_load_dwordx4 v29, s[56:59], s11 offen offset:1024 lds
    s_cmp_le_u32 s15, 0
    s_cselect_b32 s11, 1, 0
    s_lshl_b32 s11, s11, 7
    s_add_u32 s99, s11, s91
    s_add_u32 m0, s10, 0xc000
    s_nop 0
    buffer_load_dwordx4 v28, s[60:63], s99 offen offset:0 lds
    buffer_load_dwordx4 v29, s[60:63], s99 offen offset:1024 lds
    s_add_u32 s11, s11, s90
    s_add_u32 m0, s10, 0xe000
    s_nop 0
    buffer_load_dwordx4 v28, s[60:63], s11 offen offset:0 lds
    buffer_load_dwordx4 v29, s[60:63], s11 offen offset:1024 lds
    v_mfma_f32_16x16x32_bf16 v[92:95], v[200:203], v[148:151], v[92:95]
    ds_read2_b32 v[182:183], v18 offset0:226 offset1:227
    v_mfma_f32_16x16x32_bf16 v[76:79], v[204:207], v[128:131], v[76:79]
    ds_read2_b32 v[184:185], v19 offset0:96 offset1:97
    v_mfma_f32_16x16x32_bf16 v[80:83], v[204:207], v[132:135], v[80:83]
    ds_read2_b32 v[186:187], v19 offset0:98 offset1:99
    v_mfma_f32_16x16x32_bf16 v[84:87], v[204:207], v[136:139], v[84:87]
    ds_read2_b32 v[188:189], v19 offset0:224 offset1:225
    v_mfma_f32_16x16x32_bf16 v[88:91], v[204:207], v[140:143], v[88:91]
    ds_read2_b32 v[190:191], v19 offset0:226 offset1:227
    v_mfma_f32_16x16x32_bf16 v[92:95], v[204:207], v[144:147], v[92:95]
    s_waitcnt lgkmcnt(15)
    v_mfma_f32_16x16x32_bf16 v[80:83], v[208:211], v[128:131], v[80:83]
    v_mfma_f32_16x16x32_bf16 v[84:87], v[208:211], v[132:135], v[84:87]
    v_mfma_f32_16x16x32_bf16 v[88:91], v[208:211], v[136:139], v[88:91]
    v_mfma_f32_16x16x32_bf16 v[92:95], v[208:211], v[140:143], v[92:95]
    v_mfma_f32_16x16x32_bf16 v[84:87], v[212:215], v[128:131], v[84:87]
    v_mfma_f32_16x16x32_bf16 v[88:91], v[212:215], v[132:135], v[88:91]
    v_mfma_f32_16x16x32_bf16 v[92:95], v[212:215], v[136:139], v[92:95]
    v_mfma_f32_16x16x32_bf16 v[88:91], v[216:219], v[128:131], v[88:91]
    v_mfma_f32_16x16x32_bf16 v[92:95], v[216:219], v[132:135], v[92:95]
    v_mfma_f32_16x16x32_bf16 v[92:95], v[220:223], v[128:131], v[92:95]
    v_mfma_f32_16x16x32_bf16 v[64:67], v[160:163], v[96:99], v[64:67]
    v_mfma_f32_16x16x32_bf16 v[68:71], v[160:163], v[100:103], v[68:71]
    ds_read2_b32 v[192:193], v16 offset0:112 offset1:113
    v_mfma_f32_16x16x32_bf16 v[72:75], v[160:163], v[104:107], v[72:75]
    ds_read2_b32 v[194:195], v16 offset0:114 offset1:115
    v_mfma_f32_16x16x32_bf16 v[76:79], v[160:163], v[108:111], v[76:79]
    ds_read_b128 v[128:131], v20 offset:4032
    v_mfma_f32_16x16x32_bf16 v[80:83], v[160:163], v[112:115], v[80:83]
    ds_read_b128 v[132:135], v20 offset:3520
    v_mfma_f32_16x16x32_bf16 v[84:87], v[160:163], v[116:119], v[84:87]
    ds_read_b128 v[136:139], v20 offset:3008
    v_mfma_f32_16x16x32_bf16 v[88:91], v[160:163], v[120:123], v[88:91]
    ds_read_b128 v[140:143], v20 offset:2496
    s_waitcnt lgkmcnt(15)
    v_mfma_f32_16x16x32_bf16 v[92:95], v[160:163], v[124:127], v[92:95]
    ds_read_b128 v[144:147], v20 offset:1984
    v_mfma_f32_16x16x32_bf16 v[68:71], v[164:167], v[96:99], v[68:71]
    ds_read_b128 v[148:151], v20 offset:1472
    v_mfma_f32_16x16x32_bf16 v[72:75], v[164:167], v[100:103], v[72:75]
    ds_read_b128 v[152:155], v20 offset:960
    v_mfma_f32_16x16x32_bf16 v[76:79], v[164:167], v[104:107], v[76:79]
    ds_read_b128 v[156:159], v20 offset:448
    v_mfma_f32_16x16x32_bf16 v[80:83], v[164:167], v[108:111], v[80:83]
    ds_read2_b32 v[196:197], v16 offset0:240 offset1:241
    v_mfma_f32_16x16x32_bf16 v[84:87], v[164:167], v[112:115], v[84:87]
    ds_read2_b32 v[198:199], v16 offset0:242 offset1:243
    v_mfma_f32_16x16x32_bf16 v[88:91], v[164:167], v[116:119], v[88:91]
    ds_read2_b32 v[200:201], v17 offset0:112 offset1:113
    v_mfma_f32_16x16x32_bf16 v[92:95], v[164:167], v[120:123], v[92:95]
    ds_read2_b32 v[202:203], v17 offset0:114 offset1:115
    v_mfma_f32_16x16x32_bf16 v[72:75], v[168:171], v[96:99], v[72:75]
    ds_read2_b32 v[204:205], v17 offset0:240 offset1:241
    v_mfma_f32_16x16x32_bf16 v[76:79], v[168:171], v[100:103], v[76:79]
    ds_read2_b32 v[206:207], v17 offset0:242 offset1:243
    v_mfma_f32_16x16x32_bf16 v[80:83], v[168:171], v[104:107], v[80:83]
    ds_read2_b32 v[208:209], v18 offset0:112 offset1:113
    v_mfma_f32_16x16x32_bf16 v[84:87], v[168:171], v[108:111], v[84:87]
    ds_read2_b32 v[210:211], v18 offset0:114 offset1:115
    v_mfma_f32_16x16x32_bf16 v[88:91], v[168:171], v[112:115], v[88:91]
    ds_read2_b32 v[212:213], v18 offset0:240 offset1:241
    v_mfma_f32_16x16x32_bf16 v[92:95], v[168:171], v[116:119], v[92:95]
    ds_read2_b32 v[214:215], v18 offset0:242 offset1:243
    s_waitcnt lgkmcnt(15)
    v_mfma_f32_16x16x32_bf16 v[76:79], v[172:175], v[96:99], v[76:79]
    ds_read2_b32 v[216:217], v19 offset0:112 offset1:113
    v_mfma_f32_16x16x32_bf16 v[80:83], v[172:175], v[100:103], v[80:83]
    ds_read2_b32 v[218:219], v19 offset0:114 offset1:115
    v_mfma_f32_16x16x32_bf16 v[84:87], v[172:175], v[104:107], v[84:87]
    ds_read2_b32 v[220:221], v19 offset0:240 offset1:241
    v_mfma_f32_16x16x32_bf16 v[88:91], v[172:175], v[108:111], v[88:91]
    ds_read2_b32 v[222:223], v19 offset0:242 offset1:243
    v_mfma_f32_16x16x32_bf16 v[92:95], v[172:175], v[112:115], v[92:95]
    v_mfma_f32_16x16x32_bf16 v[80:83], v[176:179], v[96:99], v[80:83]
    v_mfma_f32_16x16x32_bf16 v[84:87], v[176:179], v[100:103], v[84:87]
    v_mfma_f32_16x16x32_bf16 v[88:91], v[176:179], v[104:107], v[88:91]
    v_mfma_f32_16x16x32_bf16 v[92:95], v[176:179], v[108:111], v[92:95]
    v_mfma_f32_16x16x32_bf16 v[84:87], v[180:183], v[96:99], v[84:87]
    v_mfma_f32_16x16x32_bf16 v[88:91], v[180:183], v[100:103], v[88:91]
    v_mfma_f32_16x16x32_bf16 v[92:95], v[180:183], v[104:107], v[92:95]
    v_mfma_f32_16x16x32_bf16 v[88:91], v[184:187], v[96:99], v[88:91]
    v_mfma_f32_16x16x32_bf16 v[92:95], v[184:187], v[100:103], v[92:95]
    v_mfma_f32_16x16x32_bf16 v[92:95], v[188:191], v[96:99], v[92:95]
    v_mfma_f32_16x16x32_bf16 v[64:67], v[192:195], v[128:131], v[64:67]
    v_mfma_f32_16x16x32_bf16 v[68:71], v[192:195], v[132:135], v[68:71]
    v_mfma_f32_16x16x32_bf16 v[72:75], v[192:195], v[136:139], v[72:75]
    s_waitcnt lgkmcnt(15)
    v_mfma_f32_16x16x32_bf16 v[76:79], v[192:195], v[140:143], v[76:79]
    s_nop 3
    v_cvt_pk_bf16_f32 v56, v64, v65
    v_cvt_pk_bf16_f32 v57, v66, v67
    v_lshlrev_b32 v64, 16, v56
    v_mfma_f32_16x16x32_bf16 v[80:83], v[192:195], v[144:147], v[80:83]
    v_and_b32 v65, s12, v56
    v_lshlrev_b32 v66, 16, v57
    v_and_b32 v67, s12, v57
    v_mfma_f32_16x16x32_bf16 v[84:87], v[192:195], v[148:151], v[84:87]
    v_add_f32 v224, v224, v64
    v_add_f32 v225, v225, v65
    v_add_f32 v226, v226, v66
    v_mfma_f32_16x16x32_bf16 v[88:91], v[192:195], v[152:155], v[88:91]
    v_add_f32 v227, v227, v67
    v_cvt_pk_bf16_f32 v40, v224, v225
    v_cvt_pk_bf16_f32 v41, v226, v227
    s_waitcnt lgkmcnt(14)
    v_mfma_f32_16x16x32_bf16 v[92:95], v[192:195], v[156:159], v[92:95]
    s_waitcnt lgkmcnt(12)
    v_mfma_f32_16x16x32_bf16 v[68:71], v[196:199], v[128:131], v[68:71]
    v_mfma_f32_16x16x32_bf16 v[72:75], v[196:199], v[132:135], v[72:75]
    v_mfma_f32_16x16x32_bf16 v[76:79], v[196:199], v[136:139], v[76:79]
    v_mfma_f32_16x16x32_bf16 v[80:83], v[196:199], v[140:143], v[80:83]
    s_nop 4
    v_cvt_pk_bf16_f32 v56, v68, v69
    v_cvt_pk_bf16_f32 v57, v70, v71
    v_lshlrev_b32 v68, 16, v56
    v_mfma_f32_16x16x32_bf16 v[84:87], v[196:199], v[144:147], v[84:87]
    v_and_b32 v69, s12, v56
    v_lshlrev_b32 v70, 16, v57
    v_and_b32 v71, s12, v57
    v_mfma_f32_16x16x32_bf16 v[88:91], v[196:199], v[148:151], v[88:91]
    v_add_f32 v228, v228, v68
    v_add_f32 v229, v229, v69
    v_add_f32 v230, v230, v70
    v_mfma_f32_16x16x32_bf16 v[92:95], v[196:199], v[152:155], v[92:95]
    v_add_f32 v231, v231, v71
    v_cvt_pk_bf16_f32 v42, v228, v229
    v_cvt_pk_bf16_f32 v43, v230, v231
    s_waitcnt lgkmcnt(10)
    v_mfma_f32_16x16x32_bf16 v[72:75], v[200:203], v[128:131], v[72:75]
    v_permlane16_swap_b32 v40, v42
    v_permlane16_swap_b32 v41, v43
    v_mfma_f32_16x16x32_bf16 v[76:79], v[200:203], v[132:135], v[76:79]
    v_mfma_f32_16x16x32_bf16 v[80:83], v[200:203], v[136:139], v[80:83]
    v_mfma_f32_16x16x32_bf16 v[84:87], v[200:203], v[140:143], v[84:87]
    s_nop 2
    v_cvt_pk_bf16_f32 v56, v72, v73
    v_cvt_pk_bf16_f32 v57, v74, v75
    v_lshlrev_b32 v72, 16, v56
    v_mfma_f32_16x16x32_bf16 v[88:91], v[200:203], v[144:147], v[88:91]
    v_and_b32 v73, s12, v56
    v_lshlrev_b32 v74, 16, v57
    v_and_b32 v75, s12, v57
    v_mfma_f32_16x16x32_bf16 v[92:95], v[200:203], v[148:151], v[92:95]
    v_add_f32 v232, v232, v72
    v_add_f32 v233, v233, v73
    v_add_f32 v234, v234, v74
    s_waitcnt lgkmcnt(8)
    v_mfma_f32_16x16x32_bf16 v[76:79], v[204:207], v[128:131], v[76:79]
    v_add_f32 v235, v235, v75
    v_cvt_pk_bf16_f32 v44, v232, v233
    v_cvt_pk_bf16_f32 v45, v234, v235
    v_mfma_f32_16x16x32_bf16 v[80:83], v[204:207], v[132:135], v[80:83]
    v_mfma_f32_16x16x32_bf16 v[84:87], v[204:207], v[136:139], v[84:87]
    v_mfma_f32_16x16x32_bf16 v[88:91], v[204:207], v[140:143], v[88:91]
    s_nop 1
    v_cvt_pk_bf16_f32 v56, v76, v77
    v_cvt_pk_bf16_f32 v57, v78, v79
    v_lshlrev_b32 v76, 16, v56
    v_mfma_f32_16x16x32_bf16 v[92:95], v[204:207], v[144:147], v[92:95]
    v_and_b32 v77, s12, v56
    v_lshlrev_b32 v78, 16, v57
    v_and_b32 v79, s12, v57
    s_waitcnt lgkmcnt(6)
    v_mfma_f32_16x16x32_bf16 v[80:83], v[208:211], v[128:131], v[80:83]
    v_add_f32 v236, v236, v76
    v_add_f32 v237, v237, v77
    v_add_f32 v238, v238, v78
    v_mfma_f32_16x16x32_bf16 v[84:87], v[208:211], v[132:135], v[84:87]
    v_add_f32 v239, v239, v79
    v_cvt_pk_bf16_f32 v46, v236, v237
    v_cvt_pk_bf16_f32 v47, v238, v239
    v_mfma_f32_16x16x32_bf16 v[88:91], v[208:211], v[136:139], v[88:91]
    v_permlane16_swap_b32 v44, v46
    v_permlane16_swap_b32 v45, v47
    v_mfma_f32_16x16x32_bf16 v[92:95], v[208:211], v[140:143], v[92:95]
    v_cvt_pk_bf16_f32 v56, v80, v81
    v_cvt_pk_bf16_f32 v57, v82, v83
    v_lshlrev_b32 v80, 16, v56
    s_waitcnt lgkmcnt(4)
    v_mfma_f32_16x16x32_bf16 v[84:87], v[212:215], v[128:131], v[84:87]
    v_and_b32 v81, s12, v56
    v_lshlrev_b32 v82, 16, v57
    v_and_b32 v83, s12, v57
    v_mfma_f32_16x16x32_bf16 v[88:91], v[212:215], v[132:135], v[88:91]
    v_add_f32 v240, v240, v80
    v_add_f32 v241, v241, v81
    v_add_f32 v242, v242, v82
    v_mfma_f32_16x16x32_bf16 v[92:95], v[212:215], v[136:139], v[92:95]
    v_add_f32 v243, v243, v83
    v_cvt_pk_bf16_f32 v48, v240, v241
    v_cvt_pk_bf16_f32 v49, v242, v243
    s_waitcnt lgkmcnt(2)
    v_mfma_f32_16x16x32_bf16 v[88:91], v[216:219], v[128:131], v[88:91]
    v_cvt_pk_bf16_f32 v56, v84, v85
    v_cvt_pk_bf16_f32 v57, v86, v87
    v_lshlrev_b32 v84, 16, v56
    v_mfma_f32_16x16x32_bf16 v[92:95], v[216:219], v[132:135], v[92:95]
    v_and_b32 v85, s12, v56
    v_lshlrev_b32 v86, 16, v57
    v_and_b32 v87, s12, v57
    s_waitcnt lgkmcnt(0)
    v_mfma_f32_16x16x32_bf16 v[92:95], v[220:223], v[128:131], v[92:95]
    v_add_f32 v244, v244, v84
    v_add_f32 v245, v245, v85
    v_add_f32 v246, v246, v86
    v_add_f32 v247, v247, v87
    v_cvt_pk_bf16_f32 v50, v244, v245
    v_cvt_pk_bf16_f32 v51, v246, v247
    s_nop 0
    v_permlane16_swap_b32 v48, v50
    v_permlane16_swap_b32 v49, v51
    v_cvt_pk_bf16_f32 v56, v88, v89
    v_cvt_pk_bf16_f32 v57, v90, v91
    v_lshlrev_b32 v88, 16, v56
    v_and_b32 v89, s12, v56
    v_lshlrev_b32 v90, 16, v57
    v_and_b32 v91, s12, v57
    v_add_f32 v248, v248, v88
    v_add_f32 v249, v249, v89
    v_add_f32 v250, v250, v90
    v_add_f32 v251, v251, v91
    v_cvt_pk_bf16_f32 v52, v248, v249
    v_cvt_pk_bf16_f32 v53, v250, v251
    v_cvt_pk_bf16_f32 v56, v92, v93
    v_cvt_pk_bf16_f32 v57, v94, v95
    v_lshlrev_b32 v92, 16, v56
    v_and_b32 v93, s12, v56
    v_lshlrev_b32 v94, 16, v57
    v_and_b32 v95, s12, v57
    v_add_f32 v252, v252, v92
    v_add_f32 v253, v253, v93
    v_add_f32 v254, v254, v94
    v_add_f32 v255, v255, v95
    v_cvt_pk_bf16_f32 v54, v252, v253
    v_cvt_pk_bf16_f32 v55, v254, v255
    s_nop 0
    v_permlane16_swap_b32 v52, v54
    v_permlane16_swap_b32 v53, v55
    buffer_store_dwordx4 v[40:43], v22, s[84:87], 0 offen offset:0 sc1
    buffer_store_dwordx4 v[44:47], v22, s[84:87], 0 offen offset:1024 sc1
    buffer_store_dwordx4 v[48:51], v22, s[84:87], 0 offen offset:2048 sc1
    buffer_store_dwordx4 v[52:55], v22, s[84:87], 0 offen offset:3072 sc1
    v_lshrrev_b32 v8, 4, v1
    s_lshl_b32 s8, s3, 4
    v_add_u32 v8, s8, v8
    v_and_b32 v11, 15, v1
    s_lshl_b32 s9, s5, 11
    s_add_u32 s9, s9, 0x28000
    v_lshl_add_u32 v10, v11, 7, s9
    v_lshlrev_b32 v11, 4, v11
    v_mul_u32_u24 v9, 272, v8
    v_add_u32 v9, v9, v11
    s_lshl_b32 s8, s5, 6
    v_add_u32 v8, s8, v8
    v_lshl_add_u32 v8, v8, 12, v11
    s_lshl_b32 s8, s4, 8
    v_add_u32 v8, s8, v8
    s_waitcnt vmcnt(8)
    s_barrier
    s_cmp_le_u32 s15, 1
    s_cselect_b32 s11, 2, 1
    s_lshl_b32 s11, s11, 7
    s_add_u32 s99, s11, s91
    s_add_u32 m0, s10, 0x0
    s_nop 0
    buffer_load_dwordx4 v28, s[56:59], s99 offen offset:0 lds
    buffer_load_dwordx4 v29, s[56:59], s99 offen offset:1024 lds
    s_add_u32 s11, s11, s90
    s_add_u32 m0, s10, 0x2000
    s_nop 0
    buffer_load_dwordx4 v28, s[56:59], s11 offen offset:0 lds
    buffer_load_dwordx4 v29, s[56:59], s11 offen offset:1024 lds
    s_waitcnt vmcnt(8)
    s_barrier
    s_cmp_le_u32 s15, 1
    s_cselect_b32 s11, 2, 1
    s_lshl_b32 s11, s11, 7
    s_add_u32 s99, s11, s91
    s_add_u32 m0, s10, 0x4000
    s_nop 0
    buffer_load_dwordx4 v28, s[60:63], s99 offen offset:0 lds
    buffer_load_dwordx4 v29, s[60:63], s99 offen offset:1024 lds
    s_add_u32 s11, s11, s90
    s_add_u32 m0, s10, 0x6000
    s_nop 0
    buffer_load_dwordx4 v28, s[60:63], s11 offen offset:0 lds
    buffer_load_dwordx4 v29, s[60:63], s11 offen offset:1024 lds
    s_waitcnt vmcnt(4)
    s_barrier
    s_cmp_le_u32 s15, 2
    s_cselect_b32 s11, 3, 2
    s_lshl_b32 s11, s11, 7
    s_add_u32 s99, s11, s91
    s_add_u32 m0, s10, 0x8000
    s_nop 0
    buffer_load_dwordx4 v28, s[56:59], s99 offen offset:0 lds
    buffer_load_dwordx4 v29, s[56:59], s99 offen offset:1024 lds
    s_add_u32 s11, s11, s90
    s_add_u32 m0, s10, 0xa000
    s_nop 0
    buffer_load_dwordx4 v28, s[56:59], s11 offen offset:0 lds
    buffer_load_dwordx4 v29, s[56:59], s11 offen offset:1024 lds
    s_waitcnt vmcnt(4)
    s_barrier
    s_cmp_le_u32 s15, 2
    s_cselect_b32 s11, 3, 2
    s_lshl_b32 s11, s11, 7
    s_add_u32 s99, s11, s91
    s_add_u32 m0, s10, 0xc000
    s_nop 0
    buffer_load_dwordx4 v28, s[60:63], s99 offen offset:0 lds
    buffer_load_dwordx4 v29, s[60:63], s99 offen offset:1024 lds
    s_add_u32 s11, s11, s90
    s_add_u32 m0, s10, 0xe000
    s_nop 0
    buffer_load_dwordx4 v28, s[60:63], s11 offen offset:0 lds
    buffer_load_dwordx4 v29, s[60:63], s11 offen offset:1024 lds
    s_waitcnt vmcnt(4)
    s_barrier
    s_cmp_le_u32 s15, 3
    s_cselect_b32 s11, 4, 3
    s_lshl_b32 s11, s11, 7
    s_add_u32 s99, s11, s91
    s_add_u32 m0, s10, 0x0
    s_nop 0
    buffer_load_dwordx4 v28, s[56:59], s99 offen offset:0 lds
    buffer_load_dwordx4 v29, s[56:59], s99 offen offset:1024 lds
    s_add_u32 s11, s11, s90
    s_add_u32 m0, s10, 0x2000
    s_nop 0
    buffer_load_dwordx4 v28, s[56:59], s11 offen offset:0 lds
    buffer_load_dwordx4 v29, s[56:59], s11 offen offset:1024 lds
    s_mov_b64 exec, 1
    ds_add_rtn_u32 v62, v60, v61 offset:4
    s_mov_b64 exec, -1
    s_waitcnt lgkmcnt(0)
    v_readfirstlane_b32 s83, v62
    s_nop 1
    s_cmp_lg_u32 s83, 3
    s_cbranch_scc1 h_noy
    buffer_store_dword v61, v31, s[92:95], 0 offen sc1
h_noy:
    s_waitcnt vmcnt(4)
    s_barrier
    s_cmp_le_u32 s15, 3
    s_cselect_b32 s11, 4, 3
    s_lshl_b32 s11, s11, 7
    s_add_u32 s99, s11, s91
    s_add_u32 m0, s10, 0x4000
    s_nop 0
    buffer_load_dwordx4 v28, s[60:63], s99 offen offset:0 lds
    buffer_load_dwordx4 v29, s[60:63], s99 offen offset:1024 lds
    s_add_u32 s11, s11, s90
    s_add_u32 m0, s10, 0x6000
    s_nop 0
    buffer_load_dwordx4 v28, s[60:63], s11 offen offset:0 lds
    buffer_load_dwordx4 v29, s[60:63], s11 offen offset:1024 lds
    s_waitcnt vmcnt(4)
    s_barrier
    s_cmp_le_u32 s15, 4
    s_cselect_b32 s11, 5, 4
    s_lshl_b32 s11, s11, 7
    s_add_u32 s99, s11, s91
    s_add_u32 m0, s10, 0x8000
    s_nop 0
    buffer_load_dwordx4 v28, s[56:59], s99 offen offset:0 lds
    buffer_load_dwordx4 v29, s[56:59], s99 offen offset:1024 lds
    s_add_u32 s11, s11, s90
    s_add_u32 m0, s10, 0xa000
    s_nop 0
    buffer_load_dwordx4 v28, s[56:59], s11 offen offset:0 lds
    buffer_load_dwordx4 v29, s[56:59], s11 offen offset:1024 lds
    s_waitcnt vmcnt(4)
    s_barrier
    s_cmp_le_u32 s15, 4
    s_cselect_b32 s11, 5, 4
    s_lshl_b32 s11, s11, 7
    s_add_u32 s99, s11, s91
    s_add_u32 m0, s10, 0xc000
    s_nop 0
    buffer_load_dwordx4 v28, s[60:63], s99 offen offset:0 lds
    buffer_load_dwordx4 v29, s[60:63], s99 offen offset:1024 lds
    s_add_u32 s11, s11, s90
    s_add_u32 m0, s10, 0xe000
    s_nop 0
    buffer_load_dwordx4 v28, s[60:63], s11 offen offset:0 lds
    buffer_load_dwordx4 v29, s[60:63], s11 offen offset:1024 lds
    buffer_load_dword v19, v10, s[92:95], 0 offen sc1
    s_waitcnt vmcnt(5)
    s_barrier
    s_cmp_le_u32 s15, 5
    s_cselect_b32 s11, 6, 5
    s_lshl_b32 s11, s11, 7
    s_add_u32 s99, s11, s91
    s_add_u32 m0, s10, 0x0
    s_nop 0
    buffer_load_dwordx4 v28, s[56:59], s99 offen offset:0 lds
    buffer_load_dwordx4 v29, s[56:59], s99 offen offset:1024 lds
    s_add_u32 s11, s11, s90
    s_add_u32 m0, s10, 0x2000
    s_nop 0
    buffer_load_dwordx4 v28, s[56:59], s11 offen offset:0 lds
    buffer_load_dwordx4 v29, s[56:59], s11 offen offset:1024 lds
    s_waitcnt vmcnt(5)
    s_barrier
    s_cmp_le_u32 s15, 5
    s_cselect_b32 s11, 6, 5
    s_lshl_b32 s11, s11, 7
    s_add_u32 s99, s11, s91
    s_add_u32 m0, s10, 0x4000
    s_nop 0
    buffer_load_dwordx4 v28, s[60:63], s99 offen offset:0 lds
    buffer_load_dwordx4 v29, s[60:63], s99 offen offset:1024 lds
    s_add_u32 s11, s11, s90
    s_add_u32 m0, s10, 0x6000
    s_nop 0
    buffer_load_dwordx4 v28, s[60:63], s11 offen offset:0 lds
    buffer_load_dwordx4 v29, s[60:63], s11 offen offset:1024 lds
    s_waitcnt vmcnt(8)
    s_mov_b32 s89, 65536
h_yf_chk:
    v_cmp_ne_u32 vcc, 1, v19
    s_nop 1
    s_cmp_eq_u64 vcc, 0
    s_cbranch_scc1 h_yf_ok
    s_sub_u32 s89, s89, 1
    s_cbranch_scc1 h_yf_ok
    s_sleep 4
    buffer_load_dword v19, v10, s[92:95], 0 offen sc1
    s_waitcnt vmcnt(0)
    s_branch h_yf_chk
h_yf_ok:
    s_mov_b32 s8, 0
    buffer_load_dwordx4 v[116:119], v8, s[68:71], s8 offen sc1
    s_mov_b32 s8, 16384
    buffer_load_dwordx4 v[120:123], v8, s[68:71], s8 offen sc1
    s_mov_b32 s8, 32768
    buffer_load_dwordx4 v[124:127], v8, s[68:71], s8 offen sc1
    s_mov_b32 s8, 49152
    buffer_load_dwordx4 v[128:131], v8, s[68:71], s8 offen sc1
    s_waitcnt vmcnt(8)
    s_barrier
    s_cmp_le_u32 s15, 6
    s_cselect_b32 s11, 7, 6
    s_lshl_b32 s11, s11, 7
    s_add_u32 s99, s11, s91
    s_add_u32 m0, s10, 0x8000
    s_nop 0
    buffer_load_dwordx4 v28, s[56:59], s99 offen offset:0 lds
    buffer_load_dwordx4 v29, s[56:59], s99 offen offset:1024 lds
    s_add_u32 s11, s11, s90
    s_add_u32 m0, s10, 0xa000
    s_nop 0
    buffer_load_dwordx4 v28, s[56:59], s11 offen offset:0 lds
    buffer_load_dwordx4 v29, s[56:59], s11 offen offset:1024 lds
    s_waitcnt vmcnt(8)
    s_barrier
    s_cmp_le_u32 s15, 6
    s_cselect_b32 s11, 7, 6
    s_lshl_b32 s11, s11, 7
    s_add_u32 s99, s11, s91
    s_add_u32 m0, s10, 0xc000
    s_nop 0
    buffer_load_dwordx4 v28, s[60:63], s99 offen offset:0 lds
    buffer_load_dwordx4 v29, s[60:63], s99 offen offset:1024 lds
    s_add_u32 s11, s11, s90
    s_add_u32 m0, s10, 0xe000
    s_nop 0
    buffer_load_dwordx4 v28, s[60:63], s11 offen offset:0 lds
    buffer_load_dwordx4 v29, s[60:63], s11 offen offset:1024 lds
    s_waitcnt vmcnt(8)
    ds_write_b128 v9, v[116:119] offset:0
    ds_write_b128 v9, v[120:123] offset:1088
    ds_write_b128 v9, v[124:127] offset:2176
    ds_write_b128 v9, v[128:131] offset:3264
    s_waitcnt lgkmcnt(0)
    s_waitcnt vmcnt(4)
    s_barrier
    s_waitcnt vmcnt(0)
    s_barrier
    s_endpgm
L_consumer:
    s_setprio 2
    s_and_b32 s6, s3, 1
    s_lshr_b32 s7, s3, 1
    v_and_b32 v4, 31, v1
    s_lshl_b32 s8, s5, 6
    s_lshl_b32 s9, s7, 5
    s_add_u32 s8, s8, s9
    v_add_u32 v3, s8, v4
    v_lshlrev_b32 v5, 1, v3
    v_lshrrev_b32 v6, 5, v1
    s_lshl_b32 s10, s4, 1
    s_add_u32 s10, s10, s6
    s_getpc_b64 s[12:13]
c_pc:
    s_sub_u32 s12, s12, c_pc-gated_mix__ssm_conv_s5__ssm_conv_h3__prompt_kernel
    s_subb_u32 s13, s13, 0
    s_lshl_b32 s11, s3, 14
    v_lshl_add_u32 v24, v1, 7, s11
    v_min_u32 v24, 0x8bb8, v24
    global_load_dword v25, v24, s[12:13]
    v_add_u32 v24, 0x2000, v24
    v_min_u32 v24, 0x8bb8, v24
    global_load_dword v26, v24, s[12:13]
    s_waitcnt lgkmcnt(0)
    global_load_ushort v8, v5, s[18:19]
    global_load_ushort v9, v5, s[20:21]
    global_load_ushort v10, v5, s[30:31]
    s_add_u32 s56, s52, 0x1100000
    s_addc_u32 s57, s53, 0
    s_mov_b32 s58, 0x40000
    s_mov_b32 s59, 0x20000
    s_mov_b32 s60, s52
    s_mov_b32 s61, s53
    s_mov_b32 s62, 0x800000
    s_mov_b32 s63, 0x20000
    s_mov_b32 s64, s50
    s_mov_b32 s65, s51
    s_mov_b32 s66, 0x100
    s_mov_b32 s67, 0x20000
    s_add_u32 s68, s52, 0x1200000
    s_addc_u32 s69, s53, 0
    s_mov_b32 s70, 0x50000
    s_mov_b32 s71, 0x20000
    s_lshl_b32 s11, s10, 13
    v_lshl_add_u32 v7, v3, 3, s11
    v_mov_b32 v12, 0
    v_mov_b32 v13, 0
    buffer_store_dwordx2 v[12:13], v7, s[56:59], 0 offen sc1
    s_lshl_b32 s11, s10, 4
    s_add_u32 s11, s11, s5
    s_lshl_b32 s11, s11, 1
    s_add_u32 s11, s11, s7
    s_lshl_b32 s11, s11, 7
    v_mov_b32 v60, s11
    buffer_store_dword v12, v60, s[68:71], 0 offen sc1
    s_lshl_b32 s72, s4, 4
    s_add_u32 s72, s72, s5
    s_lshl_b32 s72, s72, 2
    s_add_u32 s72, s72, s3
    s_lshl_b32 s72, s72, 7
    s_add_u32 s11, s72, 0x30000
    v_mov_b32 v30, s11
    buffer_store_dword v12, v30, s[68:71], 0 offen sc1
    v_mov_b32 v23, 1
    v_bfe_u32 v11, v1, 1, 3
    v_xor_b32 v11, v11, v6
    s_lshl_b32 s11, s6, 13
    v_lshl_add_u32 v14, v4, 7, s11
    s_lshl_b32 s11, s7, 12
    s_add_u32 s11, s11, 16384
    v_lshl_add_u32 v15, v4, 7, s11
    v_xor_b32 v16, 0, v11
    v_lshl_add_u32 v160, v16, 4, v14
    v_lshl_add_u32 v168, v16, 4, v15
    v_add_u32 v164, 0x10000, v160
    v_add_u32 v172, 0x10000, v168
    v_xor_b32 v16, 2, v11
    v_lshl_add_u32 v161, v16, 4, v14
    v_lshl_add_u32 v169, v16, 4, v15
    v_add_u32 v165, 0x10000, v161
    v_add_u32 v173, 0x10000, v169
    v_xor_b32 v16, 4, v11
    v_lshl_add_u32 v162, v16, 4, v14
    v_lshl_add_u32 v170, v16, 4, v15
    v_add_u32 v166, 0x10000, v162
    v_add_u32 v174, 0x10000, v170
    v_xor_b32 v16, 6, v11
    v_lshl_add_u32 v163, v16, 4, v14
    v_lshl_add_u32 v171, v16, 4, v15
    v_add_u32 v167, 0x10000, v163
    v_add_u32 v175, 0x10000, v171
    v_lshlrev_b32 v21, 2, v1
    s_waitcnt vmcnt(0)
    v_lshlrev_b32 v8, 16, v8
    v_lshlrev_b32 v9, 16, v9
    v_lshlrev_b32 v10, 16, v10
    s_mov_b32 s12, 0x3fb8aa3b
    v_mul_f32 v10, s12, v10
    v_exp_f32 v10, v10
    s_nop 0
    v_cvt_pk_bf16_f32 v10, v10, v10
    v_lshlrev_b32 v10, 16, v10
    v_mul_f32 v16, v10, v8
    v_mul_f32 v17, v10, v9
    v_mul_f32 v16, s12, v16
    v_exp_f32 v16, v16
    v_mul_f32 v17, 0.15915494, v17
    v_rndne_f32 v18, v17
    v_sub_f32 v17, v17, v18
    v_cos_f32 v18, v17
    v_sin_f32 v19, v17
    v_mul_f32 v176, v16, v18
    v_mul_f32 v177, v16, v19
    v_add_f32 v16, -1.0, v176
    v_mul_f32 v17, v8, v8
    v_fma_f32 v17, v9, v9, v17
    v_rcp_f32 v17, v17
    v_mul_f32 v18, v16, v8
    v_fma_f32 v18, v177, v9, v18
    v_mul_f32 v19, v177, v8
    v_fma_f32 v19, -v16, v9, v19
    v_add_f32 v17, v17, v17
    v_mul_f32 v178, v18, v17
    v_mul_f32 v179, v19, v17
    v_mul_f32 v16, v176, v176
    v_mul_f32 v17, v176, v177
    v_fma_f32 v16, -v177, v177, v16
    v_fma_f32 v17, v177, v176, v17
    v_mul_f32 v18, v16, v16
    v_mul_f32 v19, v16, v17
    v_fma_f32 v18, -v17, v17, v18
    v_fma_f32 v19, v17, v16, v19
    v_mul_f32 v16, v18, v18
    v_mul_f32 v17, v18, v19
    v_fma_f32 v16, -v19, v19, v16
    v_fma_f32 v17, v19, v18, v17
    v_mul_f32 v180, v16, v16
    v_mul_f32 v181, v16, v17
    v_fma_f32 v180, -v17, v17, v180
    v_fma_f32 v181, v17, v16, v181
    v_mul_f32 v182, v180, v180
    v_mul_f32 v183, v180, v181
    v_fma_f32 v182, -v181, v181, v182
    v_fma_f32 v183, v181, v180, v183
    v_mul_f32 v184, v182, v182
    v_mul_f32 v185, v182, v183
    v_fma_f32 v184, -v183, v183, v184
    v_fma_f32 v185, v183, v182, v185
    v_mul_f32 v186, v184, v184
    v_mul_f32 v187, v184, v185
    v_fma_f32 v186, -v185, v185, v186
    v_fma_f32 v187, v185, v184, v187
    v_mul_f32 v48, v178, v182
    v_mul_f32 v49, v178, v183
    v_fma_f32 v48, -v179, v183, v48
    v_fma_f32 v49, v179, v182, v49
    v_cmp_lt_u32 vcc, 31, v1
    s_nop 1
    v_cndmask_b32 v48, v178, v48, vcc
    v_cndmask_b32 v49, v179, v49, vcc
    v_lshlrev_b32 v50, 13, v6
    v_sub_u32 v50, v7, v50
    s_add_u32 s11, s10, 1
    v_sub_u32 v51, s11, v6
    v_lshrrev_b32 v51, 1, v51
    s_lshl_b32 s11, s4, 2
    s_add_u32 s11, s11, s3
    s_lshl_b32 s11, s11, 5
    v_lshrrev_b32 v52, 3, v1
    v_add_u32 v52, s11, v52
    v_lshlrev_b32 v52, 11, v52
    v_and_b32 v16, 7, v1
    v_lshl_add_u32 v52, v16, 4, v52
    s_lshl_b32 s11, s5, 7
    v_add_u32 v52, s11, v52
    s_lshl_b32 s11, s3, 13
    v_lshlrev_b32 v53, 11, v6
    v_lshl_add_u32 v53, v4, 1, v53
    v_add_u32 v53, s11, v53
    s_lshl_b32 s11, s5, 6
    v_add_u32 v54, s11, v4
    v_lshlrev_b32 v54, 1, v54
    s_mov_b32 s76, s16
    s_mov_b32 s77, s17
    s_mov_b32 s78, 0x400000
    s_mov_b32 s79, 0x20000
    s_add_u32 s92, s52, 0x1800000
    s_addc_u32 s93, s53, 0
    s_mov_b32 s94, 0x800000
    s_mov_b32 s95, 0x20000
    s_xor_b32 s73, s72, 4096
    s_lshl_b32 s74, s73, 6
    s_add_u32 s75, s74, 4096
    v_lshlrev_b32 v59, 4, v1
    s_barrier
    s_cmp_lg_u32 s3, 0
    s_cbranch_scc1 c_noflag
    s_lshr_b32 s11, s2, 6
    s_lshl_b32 s11, 1, s11
    s_getreg_b32 s12, hwreg(HW_REG_XCC_ID, 0, 4)
    s_lshl_b32 s12, 0x100, s12
    s_or_b32 s11, s11, s12
    v_mov_b32 v16, s11
    s_and_b32 s11, s2, 63
    s_lshl_b32 s11, s11, 2
    v_mov_b32 v17, s11
    s_mov_b64 exec, 1
    buffer_atomic_or v16, v17, s[64:67], 0 offen sc1
    s_mov_b64 exec, -1
c_noflag:
    ds_read_b128 v[128:131], v160 offset:0
    ds_read_b128 v[144:147], v168 offset:0
    ds_read_b128 v[132:135], v160 offset:4096
    ds_read_b128 v[148:151], v168 offset:8192
    s_waitcnt lgkmcnt(2)
    v_mfma_f32_32x32x16_bf16 v[64:79], v[128:131], v[144:147], 0
    ds_read_b128 v[136:139], v161 offset:0
    s_waitcnt lgkmcnt(2)
    v_mfma_f32_32x32x16_bf16 v[80:95], v[132:135], v[144:147], 0
    ds_read_b128 v[152:155], v169 offset:0
    s_waitcnt lgkmcnt(2)
    v_mfma_f32_32x32x16_bf16 v[112:127], v[132:135], v[148:151], 0
    ds_read_b128 v[140:143], v161 offset:4096
    v_mfma_f32_32x32x16_bf16 v[96:111], v[128:131], v[148:151], 0
    ds_read_b128 v[156:159], v169 offset:8192
    s_waitcnt lgkmcnt(2)
    v_mfma_f32_32x32x16_bf16 v[64:79], v[136:139], v[152:155], v[64:79]
    ds_read_b128 v[128:131], v162 offset:0
    s_waitcnt lgkmcnt(2)
    v_mfma_f32_32x32x16_bf16 v[80:95], v[140:143], v[152:155], v[80:95]
    ds_read_b128 v[144:147], v170 offset:0
    s_waitcnt lgkmcnt(2)
    v_mfma_f32_32x32x16_bf16 v[112:127], v[140:143], v[156:159], v[112:127]
    ds_read_b128 v[132:135], v162 offset:4096
    v_mfma_f32_32x32x16_bf16 v[96:111], v[136:139], v[156:159], v[96:111]
    ds_read_b128 v[148:151], v170 offset:8192
    s_waitcnt lgkmcnt(2)
    v_mfma_f32_32x32x16_bf16 v[64:79], v[128:131], v[144:147], v[64:79]
    ds_read_b128 v[136:139], v163 offset:0
    s_waitcnt lgkmcnt(2)
    v_mfma_f32_32x32x16_bf16 v[80:95], v[132:135], v[144:147], v[80:95]
    ds_read_b128 v[152:155], v171 offset:0
    s_waitcnt lgkmcnt(2)
    v_mfma_f32_32x32x16_bf16 v[112:127], v[132:135], v[148:151], v[112:127]
    ds_read_b128 v[140:143], v163 offset:4096
    v_mfma_f32_32x32x16_bf16 v[96:111], v[128:131], v[148:151], v[96:111]
    ds_read_b128 v[156:159], v171 offset:8192
    s_waitcnt lgkmcnt(0)
    s_barrier
    v_mfma_f32_32x32x16_bf16 v[64:79], v[136:139], v[152:155], v[64:79]
    ds_read_b128 v[128:131], v160 offset:32768
    v_mfma_f32_32x32x16_bf16 v[80:95], v[140:143], v[152:155], v[80:95]
    ds_read_b128 v[144:147], v168 offset:32768
    v_mfma_f32_32x32x16_bf16 v[112:127], v[140:143], v[156:159], v[112:127]
    ds_read_b128 v[132:135], v160 offset:36864
    v_mfma_f32_32x32x16_bf16 v[96:111], v[136:139], v[156:159], v[96:111]
    ds_read_b128 v[148:151], v168 offset:40960
    s_waitcnt lgkmcnt(2)
    v_mfma_f32_32x32x16_bf16 v[64:79], v[128:131], v[144:147], v[64:79]
    ds_read_b128 v[136:139], v161 offset:32768
    s_waitcnt lgkmcnt(2)
    v_mfma_f32_32x32x16_bf16 v[80:95], v[132:135], v[144:147], v[80:95]
    ds_read_b128 v[152:155], v169 offset:32768
    s_waitcnt lgkmcnt(2)
    v_mfma_f32_32x32x16_bf16 v[112:127], v[132:135], v[148:151], v[112:127]
    ds_read_b128 v[140:143], v161 offset:36864
    v_mfma_f32_32x32x16_bf16 v[96:111], v[128:131], v[148:151], v[96:111]
    ds_read_b128 v[156:159], v169 offset:40960
    s_waitcnt lgkmcnt(2)
    v_mfma_f32_32x32x16_bf16 v[64:79], v[136:139], v[152:155], v[64:79]
    ds_read_b128 v[128:131], v162 offset:32768
    s_waitcnt lgkmcnt(2)
    v_mfma_f32_32x32x16_bf16 v[80:95], v[140:143], v[152:155], v[80:95]
    ds_read_b128 v[144:147], v170 offset:32768
    s_waitcnt lgkmcnt(2)
    v_mfma_f32_32x32x16_bf16 v[112:127], v[140:143], v[156:159], v[112:127]
    ds_read_b128 v[132:135], v162 offset:36864
    v_mfma_f32_32x32x16_bf16 v[96:111], v[136:139], v[156:159], v[96:111]
    ds_read_b128 v[148:151], v170 offset:40960
    s_waitcnt lgkmcnt(2)
    v_mfma_f32_32x32x16_bf16 v[64:79], v[128:131], v[144:147], v[64:79]
    ds_read_b128 v[136:139], v163 offset:32768
    s_waitcnt lgkmcnt(2)
    v_mfma_f32_32x32x16_bf16 v[80:95], v[132:135], v[144:147], v[80:95]
    ds_read_b128 v[152:155], v171 offset:32768
    s_waitcnt lgkmcnt(2)
    v_mfma_f32_32x32x16_bf16 v[112:127], v[132:135], v[148:151], v[112:127]
    ds_read_b128 v[140:143], v163 offset:36864
    v_mfma_f32_32x32x16_bf16 v[96:111], v[128:131], v[148:151], v[96:111]
    ds_read_b128 v[156:159], v171 offset:40960
    s_waitcnt lgkmcnt(0)
    s_barrier
    v_mfma_f32_32x32x16_bf16 v[64:79], v[136:139], v[152:155], v[64:79]
    ds_read_b128 v[128:131], v164 offset:0
    v_mfma_f32_32x32x16_bf16 v[80:95], v[140:143], v[152:155], v[80:95]
    ds_read_b128 v[144:147], v172 offset:0
    v_mfma_f32_32x32x16_bf16 v[112:127], v[140:143], v[156:159], v[112:127]
    ds_read_b128 v[132:135], v164 offset:4096
    v_mfma_f32_32x32x16_bf16 v[96:111], v[136:139], v[156:159], v[96:111]
    ds_read_b128 v[148:151], v172 offset:8192
    s_waitcnt lgkmcnt(2)
    v_mfma_f32_32x32x16_bf16 v[64:79], v[128:131], v[144:147], v[64:79]
    ds_read_b128 v[136:139], v165 offset:0
    s_waitcnt lgkmcnt(2)
    v_mfma_f32_32x32x16_bf16 v[80:95], v[132:135], v[144:147], v[80:95]
    ds_read_b128 v[152:155], v173 offset:0
    s_waitcnt lgkmcnt(2)
    v_mfma_f32_32x32x16_bf16 v[112:127], v[132:135], v[148:151], v[112:127]
    ds_read_b128 v[140:143], v165 offset:4096
    v_mfma_f32_32x32x16_bf16 v[96:111], v[128:131], v[148:151], v[96:111]
    ds_read_b128 v[156:159], v173 offset:8192
    s_waitcnt lgkmcnt(2)
    v_mfma_f32_32x32x16_bf16 v[64:79], v[136:139], v[152:155], v[64:79]
    ds_read_b128 v[128:131], v166 offset:0
    s_waitcnt lgkmcnt(2)
    v_mfma_f32_32x32x16_bf16 v[80:95], v[140:143], v[152:155], v[80:95]
    ds_read_b128 v[144:147], v174 offset:0
    s_waitcnt lgkmcnt(2)
    v_mfma_f32_32x32x16_bf16 v[112:127], v[140:143], v[156:159], v[112:127]
    ds_read_b128 v[132:135], v166 offset:4096
    v_mfma_f32_32x32x16_bf16 v[96:111], v[136:139], v[156:159], v[96:111]
    ds_read_b128 v[148:151], v174 offset:8192
    s_waitcnt lgkmcnt(2)
    v_mfma_f32_32x32x16_bf16 v[64:79], v[128:131], v[144:147], v[64:79]
    ds_read_b128 v[136:139], v167 offset:0
    s_waitcnt lgkmcnt(2)
    v_mfma_f32_32x32x16_bf16 v[80:95], v[132:135], v[144:147], v[80:95]
    ds_read_b128 v[152:155], v175 offset:0
    s_waitcnt lgkmcnt(2)
    v_mfma_f32_32x32x16_bf16 v[112:127], v[132:135], v[148:151], v[112:127]
    ds_read_b128 v[140:143], v167 offset:4096
    v_mfma_f32_32x32x16_bf16 v[96:111], v[128:131], v[148:151], v[96:111]
    ds_read_b128 v[156:159], v175 offset:8192
    s_waitcnt lgkmcnt(0)
    s_barrier
    v_mfma_f32_32x32x16_bf16 v[64:79], v[136:139], v[152:155], v[64:79]
    ds_read_b128 v[128:131], v160 offset:0
    v_mfma_f32_32x32x16_bf16 v[80:95], v[140:143], v[152:155], v[80:95]
    ds_read_b128 v[144:147], v168 offset:0
    v_mfma_f32_32x32x16_bf16 v[112:127], v[140:143], v[156:159], v[112:127]
    ds_read_b128 v[132:135], v160 offset:4096
    v_mfma_f32_32x32x16_bf16 v[96:111], v[136:139], v[156:159], v[96:111]
    ds_read_b128 v[148:151], v168 offset:8192
    s_waitcnt lgkmcnt(2)
    v_mfma_f32_32x32x16_bf16 v[64:79], v[128:131], v[144:147], v[64:79]
    ds_read_b128 v[136:139], v161 offset:0
    s_waitcnt lgkmcnt(2)
    v_mfma_f32_32x32x16_bf16 v[80:95], v[132:135], v[144:147], v[80:95]
    ds_read_b128 v[152:155], v169 offset:0
    s_waitcnt lgkmcnt(2)
    v_mfma_f32_32x32x16_bf16 v[112:127], v[132:135], v[148:151], v[112:127]
    ds_read_b128 v[140:143], v161 offset:4096
    v_mfma_f32_32x32x16_bf16 v[96:111], v[128:131], v[148:151], v[96:111]
    ds_read_b128 v[156:159], v169 offset:8192
    s_waitcnt lgkmcnt(2)
    v_mfma_f32_32x32x16_bf16 v[64:79], v[136:139], v[152:155], v[64:79]
    ds_read_b128 v[128:131], v162 offset:0
    s_waitcnt lgkmcnt(2)
    v_mfma_f32_32x32x16_bf16 v[80:95], v[140:143], v[152:155], v[80:95]
    ds_read_b128 v[144:147], v170 offset:0
    s_waitcnt lgkmcnt(2)
    v_mfma_f32_32x32x16_bf16 v[112:127], v[140:143], v[156:159], v[112:127]
    ds_read_b128 v[132:135], v162 offset:4096
    v_mfma_f32_32x32x16_bf16 v[96:111], v[136:139], v[156:159], v[96:111]
    ds_read_b128 v[148:151], v170 offset:8192
    s_waitcnt lgkmcnt(2)
    v_mfma_f32_32x32x16_bf16 v[64:79], v[128:131], v[144:147], v[64:79]
    ds_read_b128 v[136:139], v163 offset:0
    s_waitcnt lgkmcnt(2)
    v_mfma_f32_32x32x16_bf16 v[80:95], v[132:135], v[144:147], v[80:95]
    ds_read_b128 v[152:155], v171 offset:0
    s_waitcnt lgkmcnt(2)
    v_mfma_f32_32x32x16_bf16 v[112:127], v[132:135], v[148:151], v[112:127]
    ds_read_b128 v[140:143], v163 offset:4096
    v_mfma_f32_32x32x16_bf16 v[96:111], v[128:131], v[148:151], v[96:111]
    ds_read_b128 v[156:159], v171 offset:8192
    s_waitcnt lgkmcnt(0)
    s_barrier
    v_mfma_f32_32x32x16_bf16 v[64:79], v[136:139], v[152:155], v[64:79]
    ds_read_b128 v[128:131], v160 offset:32768
    v_mfma_f32_32x32x16_bf16 v[80:95], v[140:143], v[152:155], v[80:95]
    ds_read_b128 v[144:147], v168 offset:32768
    v_mfma_f32_32x32x16_bf16 v[112:127], v[140:143], v[156:159], v[112:127]
    ds_read_b128 v[132:135], v160 offset:36864
    v_mfma_f32_32x32x16_bf16 v[96:111], v[136:139], v[156:159], v[96:111]
    ds_read_b128 v[148:151], v168 offset:40960
    s_waitcnt lgkmcnt(2)
    v_mfma_f32_32x32x16_bf16 v[64:79], v[128:131], v[144:147], v[64:79]
    ds_read_b128 v[136:139], v161 offset:32768
    s_waitcnt lgkmcnt(2)
    v_mfma_f32_32x32x16_bf16 v[80:95], v[132:135], v[144:147], v[80:95]
    ds_read_b128 v[152:155], v169 offset:32768
    s_waitcnt lgkmcnt(2)
    v_mfma_f32_32x32x16_bf16 v[112:127], v[132:135], v[148:151], v[112:127]
    ds_read_b128 v[140:143], v161 offset:36864
    v_mfma_f32_32x32x16_bf16 v[96:111], v[128:131], v[148:151], v[96:111]
    ds_read_b128 v[156:159], v169 offset:40960
    s_waitcnt lgkmcnt(2)
    v_mfma_f32_32x32x16_bf16 v[64:79], v[136:139], v[152:155], v[64:79]
    ds_read_b128 v[128:131], v162 offset:32768
    s_waitcnt lgkmcnt(2)
    v_mfma_f32_32x32x16_bf16 v[80:95], v[140:143], v[152:155], v[80:95]
    ds_read_b128 v[144:147], v170 offset:32768
    s_waitcnt lgkmcnt(2)
    v_mfma_f32_32x32x16_bf16 v[112:127], v[140:143], v[156:159], v[112:127]
    ds_read_b128 v[132:135], v162 offset:36864
    v_mfma_f32_32x32x16_bf16 v[96:111], v[136:139], v[156:159], v[96:111]
    ds_read_b128 v[148:151], v170 offset:40960
    s_waitcnt lgkmcnt(2)
    v_mfma_f32_32x32x16_bf16 v[64:79], v[128:131], v[144:147], v[64:79]
    ds_read_b128 v[136:139], v163 offset:32768
    s_waitcnt lgkmcnt(2)
    v_mfma_f32_32x32x16_bf16 v[80:95], v[132:135], v[144:147], v[80:95]
    ds_read_b128 v[152:155], v171 offset:32768
    s_waitcnt lgkmcnt(2)
    v_mfma_f32_32x32x16_bf16 v[112:127], v[132:135], v[148:151], v[112:127]
    ds_read_b128 v[140:143], v163 offset:36864
    v_mfma_f32_32x32x16_bf16 v[96:111], v[128:131], v[148:151], v[96:111]
    ds_read_b128 v[156:159], v171 offset:40960
    s_waitcnt lgkmcnt(0)
    s_barrier
    v_mfma_f32_32x32x16_bf16 v[64:79], v[136:139], v[152:155], v[64:79]
    ds_read_b128 v[128:131], v164 offset:0
    v_mfma_f32_32x32x16_bf16 v[80:95], v[140:143], v[152:155], v[80:95]
    ds_read_b128 v[144:147], v172 offset:0
    v_mfma_f32_32x32x16_bf16 v[112:127], v[140:143], v[156:159], v[112:127]
    ds_read_b128 v[132:135], v164 offset:4096
    v_mfma_f32_32x32x16_bf16 v[96:111], v[136:139], v[156:159], v[96:111]
    ds_read_b128 v[148:151], v172 offset:8192
    s_waitcnt lgkmcnt(2)
    v_mfma_f32_32x32x16_bf16 v[64:79], v[128:131], v[144:147], v[64:79]
    ds_read_b128 v[136:139], v165 offset:0
    s_waitcnt lgkmcnt(2)
    v_mfma_f32_32x32x16_bf16 v[80:95], v[132:135], v[144:147], v[80:95]
    ds_read_b128 v[152:155], v173 offset:0
    s_waitcnt lgkmcnt(2)
    v_mfma_f32_32x32x16_bf16 v[112:127], v[132:135], v[148:151], v[112:127]
    ds_read_b128 v[140:143], v165 offset:4096
    v_mfma_f32_32x32x16_bf16 v[96:111], v[128:131], v[148:151], v[96:111]
    ds_read_b128 v[156:159], v173 offset:8192
    s_waitcnt lgkmcnt(2)
    v_mfma_f32_32x32x16_bf16 v[64:79], v[136:139], v[152:155], v[64:79]
    ds_read_b128 v[128:131], v166 offset:0
    s_waitcnt lgkmcnt(2)
    v_mfma_f32_32x32x16_bf16 v[80:95], v[140:143], v[152:155], v[80:95]
    ds_read_b128 v[144:147], v174 offset:0
    s_waitcnt lgkmcnt(2)
    v_mfma_f32_32x32x16_bf16 v[112:127], v[140:143], v[156:159], v[112:127]
    ds_read_b128 v[132:135], v166 offset:4096
    v_mfma_f32_32x32x16_bf16 v[96:111], v[136:139], v[156:159], v[96:111]
    ds_read_b128 v[148:151], v174 offset:8192
    s_waitcnt lgkmcnt(2)
    v_mfma_f32_32x32x16_bf16 v[64:79], v[128:131], v[144:147], v[64:79]
    ds_read_b128 v[136:139], v167 offset:0
    s_waitcnt lgkmcnt(2)
    v_mfma_f32_32x32x16_bf16 v[80:95], v[132:135], v[144:147], v[80:95]
    ds_read_b128 v[152:155], v175 offset:0
    s_waitcnt lgkmcnt(2)
    v_mfma_f32_32x32x16_bf16 v[112:127], v[132:135], v[148:151], v[112:127]
    ds_read_b128 v[140:143], v167 offset:4096
    v_mfma_f32_32x32x16_bf16 v[96:111], v[128:131], v[148:151], v[96:111]
    ds_read_b128 v[156:159], v175 offset:8192
    s_waitcnt lgkmcnt(0)
    s_barrier
    v_mfma_f32_32x32x16_bf16 v[64:79], v[136:139], v[152:155], v[64:79]
    ds_read_b128 v[128:131], v160 offset:0
    v_mfma_f32_32x32x16_bf16 v[80:95], v[140:143], v[152:155], v[80:95]
    ds_read_b128 v[144:147], v168 offset:0
    v_mfma_f32_32x32x16_bf16 v[112:127], v[140:143], v[156:159], v[112:127]
    ds_read_b128 v[132:135], v160 offset:4096
    v_mfma_f32_32x32x16_bf16 v[96:111], v[136:139], v[156:159], v[96:111]
    ds_read_b128 v[148:151], v168 offset:8192
    s_waitcnt lgkmcnt(2)
    v_mfma_f32_32x32x16_bf16 v[64:79], v[128:131], v[144:147], v[64:79]
    ds_read_b128 v[136:139], v161 offset:0
    s_waitcnt lgkmcnt(2)
    v_mfma_f32_32x32x16_bf16 v[80:95], v[132:135], v[144:147], v[80:95]
    ds_read_b128 v[152:155], v169 offset:0
    s_waitcnt lgkmcnt(2)
    v_mfma_f32_32x32x16_bf16 v[112:127], v[132:135], v[148:151], v[112:127]
    ds_read_b128 v[140:143], v161 offset:4096
    v_mfma_f32_32x32x16_bf16 v[96:111], v[128:131], v[148:151], v[96:111]
    ds_read_b128 v[156:159], v169 offset:8192
    s_waitcnt lgkmcnt(2)
    v_mfma_f32_32x32x16_bf16 v[64:79], v[136:139], v[152:155], v[64:79]
    ds_read_b128 v[128:131], v162 offset:0
    s_waitcnt lgkmcnt(2)
    v_mfma_f32_32x32x16_bf16 v[80:95], v[140:143], v[152:155], v[80:95]
    ds_read_b128 v[144:147], v170 offset:0
    s_waitcnt lgkmcnt(2)
    v_mfma_f32_32x32x16_bf16 v[112:127], v[140:143], v[156:159], v[112:127]
    ds_read_b128 v[132:135], v162 offset:4096
    v_mfma_f32_32x32x16_bf16 v[96:111], v[136:139], v[156:159], v[96:111]
    ds_read_b128 v[148:151], v170 offset:8192
    s_waitcnt lgkmcnt(2)
    v_mfma_f32_32x32x16_bf16 v[64:79], v[128:131], v[144:147], v[64:79]
    ds_read_b128 v[136:139], v163 offset:0
    s_waitcnt lgkmcnt(2)
    v_mfma_f32_32x32x16_bf16 v[80:95], v[132:135], v[144:147], v[80:95]
    ds_read_b128 v[152:155], v171 offset:0
    s_waitcnt lgkmcnt(2)
    v_mfma_f32_32x32x16_bf16 v[112:127], v[132:135], v[148:151], v[112:127]
    ds_read_b128 v[140:143], v163 offset:4096
    v_mfma_f32_32x32x16_bf16 v[96:111], v[128:131], v[148:151], v[96:111]
    ds_read_b128 v[156:159], v171 offset:8192
    s_waitcnt lgkmcnt(0)
    s_barrier
    v_mfma_f32_32x32x16_bf16 v[64:79], v[136:139], v[152:155], v[64:79]
    ds_read_b128 v[128:131], v160 offset:32768
    v_mfma_f32_32x32x16_bf16 v[80:95], v[140:143], v[152:155], v[80:95]
    ds_read_b128 v[144:147], v168 offset:32768
    v_mfma_f32_32x32x16_bf16 v[112:127], v[140:143], v[156:159], v[112:127]
    ds_read_b128 v[132:135], v160 offset:36864
    v_mfma_f32_32x32x16_bf16 v[96:111], v[136:139], v[156:159], v[96:111]
    ds_read_b128 v[148:151], v168 offset:40960
    s_waitcnt lgkmcnt(2)
    v_mfma_f32_32x32x16_bf16 v[64:79], v[128:131], v[144:147], v[64:79]
    ds_read_b128 v[136:139], v161 offset:32768
    s_waitcnt lgkmcnt(2)
    v_mfma_f32_32x32x16_bf16 v[80:95], v[132:135], v[144:147], v[80:95]
    ds_read_b128 v[152:155], v169 offset:32768
    s_waitcnt lgkmcnt(2)
    v_mfma_f32_32x32x16_bf16 v[112:127], v[132:135], v[148:151], v[112:127]
    ds_read_b128 v[140:143], v161 offset:36864
    v_mfma_f32_32x32x16_bf16 v[96:111], v[128:131], v[148:151], v[96:111]
    ds_read_b128 v[156:159], v169 offset:40960
    s_waitcnt lgkmcnt(2)
    v_mfma_f32_32x32x16_bf16 v[64:79], v[136:139], v[152:155], v[64:79]
    ds_read_b128 v[128:131], v162 offset:32768
    s_waitcnt lgkmcnt(2)
    v_mfma_f32_32x32x16_bf16 v[80:95], v[140:143], v[152:155], v[80:95]
    ds_read_b128 v[144:147], v170 offset:32768
    s_waitcnt lgkmcnt(2)
    v_mfma_f32_32x32x16_bf16 v[112:127], v[140:143], v[156:159], v[112:127]
    ds_read_b128 v[132:135], v162 offset:36864
    v_mfma_f32_32x32x16_bf16 v[96:111], v[136:139], v[156:159], v[96:111]
    ds_read_b128 v[148:151], v170 offset:40960
    s_waitcnt lgkmcnt(2)
    v_mfma_f32_32x32x16_bf16 v[64:79], v[128:131], v[144:147], v[64:79]
    ds_read_b128 v[136:139], v163 offset:32768
    s_waitcnt lgkmcnt(2)
    v_mfma_f32_32x32x16_bf16 v[80:95], v[132:135], v[144:147], v[80:95]
    ds_read_b128 v[152:155], v171 offset:32768
    s_waitcnt lgkmcnt(2)
    v_mfma_f32_32x32x16_bf16 v[112:127], v[132:135], v[148:151], v[112:127]
    ds_read_b128 v[140:143], v163 offset:36864
    v_mfma_f32_32x32x16_bf16 v[96:111], v[128:131], v[148:151], v[96:111]
    ds_read_b128 v[156:159], v171 offset:40960
    s_waitcnt lgkmcnt(0)
    s_barrier
    v_mfma_f32_32x32x16_bf16 v[64:79], v[136:139], v[152:155], v[64:79]
    ds_read_b128 v[128:131], v164 offset:0
    v_mfma_f32_32x32x16_bf16 v[80:95], v[140:143], v[152:155], v[80:95]
    ds_read_b128 v[144:147], v172 offset:0
    v_mfma_f32_32x32x16_bf16 v[112:127], v[140:143], v[156:159], v[112:127]
    ds_read_b128 v[132:135], v164 offset:4096
    v_mfma_f32_32x32x16_bf16 v[96:111], v[136:139], v[156:159], v[96:111]
    ds_read_b128 v[148:151], v172 offset:8192
    s_waitcnt lgkmcnt(2)
    v_mfma_f32_32x32x16_bf16 v[64:79], v[128:131], v[144:147], v[64:79]
    ds_read_b128 v[136:139], v165 offset:0
    s_waitcnt lgkmcnt(2)
    v_mfma_f32_32x32x16_bf16 v[80:95], v[132:135], v[144:147], v[80:95]
    ds_read_b128 v[152:155], v173 offset:0
    s_waitcnt lgkmcnt(2)
    v_mfma_f32_32x32x16_bf16 v[112:127], v[132:135], v[148:151], v[112:127]
    ds_read_b128 v[140:143], v165 offset:4096
    v_mfma_f32_32x32x16_bf16 v[96:111], v[128:131], v[148:151], v[96:111]
    ds_read_b128 v[156:159], v173 offset:8192
    s_waitcnt lgkmcnt(2)
    v_mfma_f32_32x32x16_bf16 v[64:79], v[136:139], v[152:155], v[64:79]
    ds_read_b128 v[128:131], v166 offset:0
    s_waitcnt lgkmcnt(2)
    v_mfma_f32_32x32x16_bf16 v[80:95], v[140:143], v[152:155], v[80:95]
    ds_read_b128 v[144:147], v174 offset:0
    s_waitcnt lgkmcnt(2)
    v_mfma_f32_32x32x16_bf16 v[112:127], v[140:143], v[156:159], v[112:127]
    ds_read_b128 v[132:135], v166 offset:4096
    v_mfma_f32_32x32x16_bf16 v[96:111], v[136:139], v[156:159], v[96:111]
    ds_read_b128 v[148:151], v174 offset:8192
    s_waitcnt lgkmcnt(2)
    v_mfma_f32_32x32x16_bf16 v[64:79], v[128:131], v[144:147], v[64:79]
    ds_read_b128 v[136:139], v167 offset:0
    s_waitcnt lgkmcnt(2)
    v_mfma_f32_32x32x16_bf16 v[80:95], v[132:135], v[144:147], v[80:95]
    ds_read_b128 v[152:155], v175 offset:0
    s_waitcnt lgkmcnt(2)
    v_mfma_f32_32x32x16_bf16 v[112:127], v[132:135], v[148:151], v[112:127]
    ds_read_b128 v[140:143], v167 offset:4096
    v_mfma_f32_32x32x16_bf16 v[96:111], v[128:131], v[148:151], v[96:111]
    ds_read_b128 v[156:159], v175 offset:8192
    s_waitcnt lgkmcnt(0)
    s_barrier
    v_mfma_f32_32x32x16_bf16 v[64:79], v[136:139], v[152:155], v[64:79]
    ds_read_b128 v[128:131], v160 offset:0
    v_mfma_f32_32x32x16_bf16 v[80:95], v[140:143], v[152:155], v[80:95]
    ds_read_b128 v[144:147], v168 offset:0
    v_mfma_f32_32x32x16_bf16 v[112:127], v[140:143], v[156:159], v[112:127]
    ds_read_b128 v[132:135], v160 offset:4096
    v_mfma_f32_32x32x16_bf16 v[96:111], v[136:139], v[156:159], v[96:111]
    ds_read_b128 v[148:151], v168 offset:8192
    s_waitcnt lgkmcnt(2)
    v_mfma_f32_32x32x16_bf16 v[64:79], v[128:131], v[144:147], v[64:79]
    ds_read_b128 v[136:139], v161 offset:0
    s_waitcnt lgkmcnt(2)
    v_mfma_f32_32x32x16_bf16 v[80:95], v[132:135], v[144:147], v[80:95]
    ds_read_b128 v[152:155], v169 offset:0
    s_waitcnt lgkmcnt(2)
    v_mfma_f32_32x32x16_bf16 v[112:127], v[132:135], v[148:151], v[112:127]
    ds_read_b128 v[140:143], v161 offset:4096
    v_mfma_f32_32x32x16_bf16 v[96:111], v[128:131], v[148:151], v[96:111]
    ds_read_b128 v[156:159], v169 offset:8192
    s_waitcnt lgkmcnt(2)
    v_mfma_f32_32x32x16_bf16 v[64:79], v[136:139], v[152:155], v[64:79]
    ds_read_b128 v[128:131], v162 offset:0
    s_waitcnt lgkmcnt(2)
    v_mfma_f32_32x32x16_bf16 v[80:95], v[140:143], v[152:155], v[80:95]
    ds_read_b128 v[144:147], v170 offset:0
    s_waitcnt lgkmcnt(2)
    v_mfma_f32_32x32x16_bf16 v[112:127], v[140:143], v[156:159], v[112:127]
    ds_read_b128 v[132:135], v162 offset:4096
    v_mfma_f32_32x32x16_bf16 v[96:111], v[136:139], v[156:159], v[96:111]
    ds_read_b128 v[148:151], v170 offset:8192
    s_waitcnt lgkmcnt(2)
    v_mfma_f32_32x32x16_bf16 v[64:79], v[128:131], v[144:147], v[64:79]
    ds_read_b128 v[136:139], v163 offset:0
    s_waitcnt lgkmcnt(2)
    v_mfma_f32_32x32x16_bf16 v[80:95], v[132:135], v[144:147], v[80:95]
    ds_read_b128 v[152:155], v171 offset:0
    s_waitcnt lgkmcnt(2)
    v_mfma_f32_32x32x16_bf16 v[112:127], v[132:135], v[148:151], v[112:127]
    ds_read_b128 v[140:143], v163 offset:4096
    v_mfma_f32_32x32x16_bf16 v[96:111], v[128:131], v[148:151], v[96:111]
    ds_read_b128 v[156:159], v171 offset:8192
    s_waitcnt lgkmcnt(0)
    s_barrier
    v_mfma_f32_32x32x16_bf16 v[64:79], v[136:139], v[152:155], v[64:79]
    ds_read_b128 v[128:131], v160 offset:32768
    v_mfma_f32_32x32x16_bf16 v[80:95], v[140:143], v[152:155], v[80:95]
    ds_read_b128 v[144:147], v168 offset:32768
    v_mfma_f32_32x32x16_bf16 v[112:127], v[140:143], v[156:159], v[112:127]
    ds_read_b128 v[132:135], v160 offset:36864
    v_mfma_f32_32x32x16_bf16 v[96:111], v[136:139], v[156:159], v[96:111]
    ds_read_b128 v[148:151], v168 offset:40960
    s_waitcnt lgkmcnt(2)
    v_mfma_f32_32x32x16_bf16 v[64:79], v[128:131], v[144:147], v[64:79]
    ds_read_b128 v[136:139], v161 offset:32768
    s_waitcnt lgkmcnt(2)
    v_mfma_f32_32x32x16_bf16 v[80:95], v[132:135], v[144:147], v[80:95]
    ds_read_b128 v[152:155], v169 offset:32768
    s_waitcnt lgkmcnt(2)
    v_mfma_f32_32x32x16_bf16 v[112:127], v[132:135], v[148:151], v[112:127]
    ds_read_b128 v[140:143], v161 offset:36864
    v_mfma_f32_32x32x16_bf16 v[96:111], v[128:131], v[148:151], v[96:111]
    ds_read_b128 v[156:159], v169 offset:40960
    s_waitcnt lgkmcnt(2)
    v_mfma_f32_32x32x16_bf16 v[64:79], v[136:139], v[152:155], v[64:79]
    ds_read_b128 v[128:131], v162 offset:32768
    s_waitcnt lgkmcnt(2)
    v_mfma_f32_32x32x16_bf16 v[80:95], v[140:143], v[152:155], v[80:95]
    ds_read_b128 v[144:147], v170 offset:32768
    s_waitcnt lgkmcnt(2)
    v_mfma_f32_32x32x16_bf16 v[112:127], v[140:143], v[156:159], v[112:127]
    ds_read_b128 v[132:135], v162 offset:36864
    v_mfma_f32_32x32x16_bf16 v[96:111], v[136:139], v[156:159], v[96:111]
    ds_read_b128 v[148:151], v170 offset:40960
    s_waitcnt lgkmcnt(2)
    v_mfma_f32_32x32x16_bf16 v[64:79], v[128:131], v[144:147], v[64:79]
    ds_read_b128 v[136:139], v163 offset:32768
    s_waitcnt lgkmcnt(2)
    v_mfma_f32_32x32x16_bf16 v[80:95], v[132:135], v[144:147], v[80:95]
    ds_read_b128 v[152:155], v171 offset:32768
    s_waitcnt lgkmcnt(2)
    v_mfma_f32_32x32x16_bf16 v[112:127], v[132:135], v[148:151], v[112:127]
    ds_read_b128 v[140:143], v163 offset:36864
    v_mfma_f32_32x32x16_bf16 v[96:111], v[128:131], v[148:151], v[96:111]
    ds_read_b128 v[156:159], v171 offset:40960
    s_waitcnt lgkmcnt(0)
    s_barrier
    v_mfma_f32_32x32x16_bf16 v[64:79], v[136:139], v[152:155], v[64:79]
    ds_read_b128 v[128:131], v164 offset:0
    v_mfma_f32_32x32x16_bf16 v[80:95], v[140:143], v[152:155], v[80:95]
    ds_read_b128 v[144:147], v172 offset:0
    v_mfma_f32_32x32x16_bf16 v[112:127], v[140:143], v[156:159], v[112:127]
    ds_read_b128 v[132:135], v164 offset:4096
    v_mfma_f32_32x32x16_bf16 v[96:111], v[136:139], v[156:159], v[96:111]
    ds_read_b128 v[148:151], v172 offset:8192
    s_waitcnt lgkmcnt(2)
    v_mfma_f32_32x32x16_bf16 v[64:79], v[128:131], v[144:147], v[64:79]
    ds_read_b128 v[136:139], v165 offset:0
    s_waitcnt lgkmcnt(2)
    v_mfma_f32_32x32x16_bf16 v[80:95], v[132:135], v[144:147], v[80:95]
    ds_read_b128 v[152:155], v173 offset:0
    s_waitcnt lgkmcnt(2)
    v_mfma_f32_32x32x16_bf16 v[112:127], v[132:135], v[148:151], v[112:127]
    ds_read_b128 v[140:143], v165 offset:4096
    v_mfma_f32_32x32x16_bf16 v[96:111], v[128:131], v[148:151], v[96:111]
    ds_read_b128 v[156:159], v173 offset:8192
    s_waitcnt lgkmcnt(2)
    v_mfma_f32_32x32x16_bf16 v[64:79], v[136:139], v[152:155], v[64:79]
    ds_read_b128 v[128:131], v166 offset:0
    s_waitcnt lgkmcnt(2)
    v_mfma_f32_32x32x16_bf16 v[80:95], v[140:143], v[152:155], v[80:95]
    ds_read_b128 v[144:147], v174 offset:0
    s_waitcnt lgkmcnt(2)
    v_mfma_f32_32x32x16_bf16 v[112:127], v[140:143], v[156:159], v[112:127]
    ds_read_b128 v[132:135], v166 offset:4096
    v_mfma_f32_32x32x16_bf16 v[96:111], v[136:139], v[156:159], v[96:111]
    ds_read_b128 v[148:151], v174 offset:8192
    s_waitcnt lgkmcnt(2)
    v_mfma_f32_32x32x16_bf16 v[64:79], v[128:131], v[144:147], v[64:79]
    ds_read_b128 v[136:139], v167 offset:0
    s_waitcnt lgkmcnt(2)
    v_mfma_f32_32x32x16_bf16 v[80:95], v[132:135], v[144:147], v[80:95]
    ds_read_b128 v[152:155], v175 offset:0
    s_waitcnt lgkmcnt(2)
    v_mfma_f32_32x32x16_bf16 v[112:127], v[132:135], v[148:151], v[112:127]
    ds_read_b128 v[140:143], v167 offset:4096
    v_mfma_f32_32x32x16_bf16 v[96:111], v[128:131], v[148:151], v[96:111]
    ds_read_b128 v[156:159], v175 offset:8192
    s_waitcnt lgkmcnt(0)
    s_barrier
    v_mfma_f32_32x32x16_bf16 v[64:79], v[136:139], v[152:155], v[64:79]
    ds_read_b128 v[128:131], v160 offset:0
    v_mfma_f32_32x32x16_bf16 v[80:95], v[140:143], v[152:155], v[80:95]
    ds_read_b128 v[144:147], v168 offset:0
    v_mfma_f32_32x32x16_bf16 v[112:127], v[140:143], v[156:159], v[112:127]
    ds_read_b128 v[132:135], v160 offset:4096
    v_mfma_f32_32x32x16_bf16 v[96:111], v[136:139], v[156:159], v[96:111]
    ds_read_b128 v[148:151], v168 offset:8192
    s_waitcnt lgkmcnt(2)
    v_mfma_f32_32x32x16_bf16 v[64:79], v[128:131], v[144:147], v[64:79]
    ds_read_b128 v[136:139], v161 offset:0
    s_waitcnt lgkmcnt(2)
    v_mfma_f32_32x32x16_bf16 v[80:95], v[132:135], v[144:147], v[80:95]
    ds_read_b128 v[152:155], v169 offset:0
    s_waitcnt lgkmcnt(2)
    v_mfma_f32_32x32x16_bf16 v[112:127], v[132:135], v[148:151], v[112:127]
    ds_read_b128 v[140:143], v161 offset:4096
    v_mfma_f32_32x32x16_bf16 v[96:111], v[128:131], v[148:151], v[96:111]
    ds_read_b128 v[156:159], v169 offset:8192
    buffer_load_dword v20, v21, s[64:67], 0 offen sc1
    s_waitcnt lgkmcnt(2)
    v_mfma_f32_32x32x16_bf16 v[64:79], v[136:139], v[152:155], v[64:79]
    ds_read_b128 v[128:131], v162 offset:0
    s_waitcnt lgkmcnt(2)
    v_mfma_f32_32x32x16_bf16 v[80:95], v[140:143], v[152:155], v[80:95]
    ds_read_b128 v[144:147], v170 offset:0
    s_waitcnt lgkmcnt(2)
    v_mfma_f32_32x32x16_bf16 v[112:127], v[140:143], v[156:159], v[112:127]
    ds_read_b128 v[132:135], v162 offset:4096
    v_mfma_f32_32x32x16_bf16 v[96:111], v[136:139], v[156:159], v[96:111]
    ds_read_b128 v[148:151], v170 offset:8192
    s_waitcnt lgkmcnt(2)
    v_mfma_f32_32x32x16_bf16 v[64:79], v[128:131], v[144:147], v[64:79]
    ds_read_b128 v[136:139], v163 offset:0
    s_waitcnt lgkmcnt(2)
    v_mfma_f32_32x32x16_bf16 v[80:95], v[132:135], v[144:147], v[80:95]
    ds_read_b128 v[152:155], v171 offset:0
    s_waitcnt lgkmcnt(2)
    v_mfma_f32_32x32x16_bf16 v[112:127], v[132:135], v[148:151], v[112:127]
    ds_read_b128 v[140:143], v163 offset:4096
    v_mfma_f32_32x32x16_bf16 v[96:111], v[128:131], v[148:151], v[96:111]
    ds_read_b128 v[156:159], v171 offset:8192
    s_waitcnt lgkmcnt(0)
    s_barrier
    v_mfma_f32_32x32x16_bf16 v[64:79], v[136:139], v[152:155], v[64:79]
    ds_read_b128 v[128:131], v160 offset:32768
    v_mfma_f32_32x32x16_bf16 v[80:95], v[140:143], v[152:155], v[80:95]
    ds_read_b128 v[144:147], v168 offset:32768
    v_mfma_f32_32x32x16_bf16 v[112:127], v[140:143], v[156:159], v[112:127]
    ds_read_b128 v[132:135], v160 offset:36864
    v_mfma_f32_32x32x16_bf16 v[96:111], v[136:139], v[156:159], v[96:111]
    ds_read_b128 v[148:151], v168 offset:40960
    s_waitcnt lgkmcnt(2)
    v_mfma_f32_32x32x16_bf16 v[64:79], v[128:131], v[144:147], v[64:79]
    ds_read_b128 v[136:139], v161 offset:32768
    s_waitcnt lgkmcnt(2)
    v_mfma_f32_32x32x16_bf16 v[80:95], v[132:135], v[144:147], v[80:95]
    ds_read_b128 v[152:155], v169 offset:32768
    s_waitcnt lgkmcnt(2)
    v_mfma_f32_32x32x16_bf16 v[112:127], v[132:135], v[148:151], v[112:127]
    ds_read_b128 v[140:143], v161 offset:36864
    v_mfma_f32_32x32x16_bf16 v[96:111], v[128:131], v[148:151], v[96:111]
    ds_read_b128 v[156:159], v169 offset:40960
    s_waitcnt lgkmcnt(2)
    v_mfma_f32_32x32x16_bf16 v[64:79], v[136:139], v[152:155], v[64:79]
    ds_read_b128 v[128:131], v162 offset:32768
    s_waitcnt lgkmcnt(2)
    v_mfma_f32_32x32x16_bf16 v[80:95], v[140:143], v[152:155], v[80:95]
    ds_read_b128 v[144:147], v170 offset:32768
    s_waitcnt lgkmcnt(2)
    v_mfma_f32_32x32x16_bf16 v[112:127], v[140:143], v[156:159], v[112:127]
    ds_read_b128 v[132:135], v162 offset:36864
    v_mfma_f32_32x32x16_bf16 v[96:111], v[136:139], v[156:159], v[96:111]
    ds_read_b128 v[148:151], v170 offset:40960
    s_waitcnt lgkmcnt(2)
    v_mfma_f32_32x32x16_bf16 v[64:79], v[128:131], v[144:147], v[64:79]
    ds_read_b128 v[136:139], v163 offset:32768
    s_waitcnt lgkmcnt(2)
    v_mfma_f32_32x32x16_bf16 v[80:95], v[132:135], v[144:147], v[80:95]
    ds_read_b128 v[152:155], v171 offset:32768
    s_waitcnt lgkmcnt(2)
    v_mfma_f32_32x32x16_bf16 v[112:127], v[132:135], v[148:151], v[112:127]
    ds_read_b128 v[140:143], v163 offset:36864
    v_mfma_f32_32x32x16_bf16 v[96:111], v[128:131], v[148:151], v[96:111]
    ds_read_b128 v[156:159], v171 offset:40960
    s_waitcnt lgkmcnt(0)
    s_barrier
    v_mfma_f32_32x32x16_bf16 v[64:79], v[136:139], v[152:155], v[64:79]
    ds_read_b128 v[128:131], v164 offset:0
    v_mfma_f32_32x32x16_bf16 v[80:95], v[140:143], v[152:155], v[80:95]
    ds_read_b128 v[144:147], v172 offset:0
    v_mfma_f32_32x32x16_bf16 v[112:127], v[140:143], v[156:159], v[112:127]
    ds_read_b128 v[132:135], v164 offset:4096
    v_mfma_f32_32x32x16_bf16 v[96:111], v[136:139], v[156:159], v[96:111]
    ds_read_b128 v[148:151], v172 offset:8192
    s_waitcnt lgkmcnt(2)
    v_mfma_f32_32x32x16_bf16 v[64:79], v[128:131], v[144:147], v[64:79]
    ds_read_b128 v[136:139], v165 offset:0
    s_waitcnt lgkmcnt(2)
    v_mfma_f32_32x32x16_bf16 v[80:95], v[132:135], v[144:147], v[80:95]
    ds_read_b128 v[152:155], v173 offset:0
    s_waitcnt lgkmcnt(2)
    v_mfma_f32_32x32x16_bf16 v[112:127], v[132:135], v[148:151], v[112:127]
    ds_read_b128 v[140:143], v165 offset:4096
    v_mfma_f32_32x32x16_bf16 v[96:111], v[128:131], v[148:151], v[96:111]
    ds_read_b128 v[156:159], v173 offset:8192
    s_waitcnt lgkmcnt(2)
    v_mfma_f32_32x32x16_bf16 v[64:79], v[136:139], v[152:155], v[64:79]
    ds_read_b128 v[128:131], v166 offset:0
    s_waitcnt lgkmcnt(2)
    v_mfma_f32_32x32x16_bf16 v[80:95], v[140:143], v[152:155], v[80:95]
    ds_read_b128 v[144:147], v174 offset:0
    s_waitcnt lgkmcnt(2)
    v_mfma_f32_32x32x16_bf16 v[112:127], v[140:143], v[156:159], v[112:127]
    ds_read_b128 v[132:135], v166 offset:4096
    v_mfma_f32_32x32x16_bf16 v[96:111], v[136:139], v[156:159], v[96:111]
    ds_read_b128 v[148:151], v174 offset:8192
    s_waitcnt lgkmcnt(2)
    v_mfma_f32_32x32x16_bf16 v[64:79], v[128:131], v[144:147], v[64:79]
    ds_read_b128 v[136:139], v167 offset:0
    s_waitcnt lgkmcnt(2)
    v_mfma_f32_32x32x16_bf16 v[80:95], v[132:135], v[144:147], v[80:95]
    ds_read_b128 v[152:155], v175 offset:0
    s_waitcnt lgkmcnt(2)
    v_mfma_f32_32x32x16_bf16 v[112:127], v[132:135], v[148:151], v[112:127]
    ds_read_b128 v[140:143], v167 offset:4096
    v_mfma_f32_32x32x16_bf16 v[96:111], v[128:131], v[148:151], v[96:111]
    ds_read_b128 v[156:159], v175 offset:8192
    s_waitcnt lgkmcnt(0)
    s_barrier
    v_mfma_f32_32x32x16_bf16 v[64:79], v[136:139], v[152:155], v[64:79]
    ds_read_b128 v[128:131], v160 offset:0
    v_mfma_f32_32x32x16_bf16 v[80:95], v[140:143], v[152:155], v[80:95]
    ds_read_b128 v[144:147], v168 offset:0
    v_mfma_f32_32x32x16_bf16 v[112:127], v[140:143], v[156:159], v[112:127]
    ds_read_b128 v[132:135], v160 offset:4096
    v_mfma_f32_32x32x16_bf16 v[96:111], v[136:139], v[156:159], v[96:111]
    ds_read_b128 v[148:151], v168 offset:8192
    s_waitcnt lgkmcnt(2)
    v_mfma_f32_32x32x16_bf16 v[64:79], v[128:131], v[144:147], v[64:79]
    ds_read_b128 v[136:139], v161 offset:0
    s_waitcnt lgkmcnt(2)
    v_mfma_f32_32x32x16_bf16 v[80:95], v[132:135], v[144:147], v[80:95]
    ds_read_b128 v[152:155], v169 offset:0
    s_waitcnt lgkmcnt(2)
    v_mfma_f32_32x32x16_bf16 v[112:127], v[132:135], v[148:151], v[112:127]
    ds_read_b128 v[140:143], v161 offset:4096
    v_mfma_f32_32x32x16_bf16 v[96:111], v[128:131], v[148:151], v[96:111]
    ds_read_b128 v[156:159], v169 offset:8192
    s_waitcnt lgkmcnt(2)
    v_mfma_f32_32x32x16_bf16 v[64:79], v[136:139], v[152:155], v[64:79]
    ds_read_b128 v[128:131], v162 offset:0
    s_waitcnt lgkmcnt(2)
    v_mfma_f32_32x32x16_bf16 v[80:95], v[140:143], v[152:155], v[80:95]
    ds_read_b128 v[144:147], v170 offset:0
    s_waitcnt lgkmcnt(2)
    v_mfma_f32_32x32x16_bf16 v[112:127], v[140:143], v[156:159], v[112:127]
    ds_read_b128 v[132:135], v162 offset:4096
    v_mfma_f32_32x32x16_bf16 v[96:111], v[136:139], v[156:159], v[96:111]
    ds_read_b128 v[148:151], v170 offset:8192
    s_waitcnt lgkmcnt(2)
    v_mfma_f32_32x32x16_bf16 v[64:79], v[128:131], v[144:147], v[64:79]
    ds_read_b128 v[136:139], v163 offset:0
    s_waitcnt lgkmcnt(2)
    v_mfma_f32_32x32x16_bf16 v[80:95], v[132:135], v[144:147], v[80:95]
    ds_read_b128 v[152:155], v171 offset:0
    s_waitcnt lgkmcnt(2)
    v_mfma_f32_32x32x16_bf16 v[112:127], v[132:135], v[148:151], v[112:127]
    ds_read_b128 v[140:143], v163 offset:4096
    v_mfma_f32_32x32x16_bf16 v[96:111], v[128:131], v[148:151], v[96:111]
    ds_read_b128 v[156:159], v171 offset:8192
    s_waitcnt lgkmcnt(0)
    s_barrier
    v_mfma_f32_32x32x16_bf16 v[64:79], v[136:139], v[152:155], v[64:79]
    v_mfma_f32_32x32x16_bf16 v[80:95], v[140:143], v[152:155], v[80:95]
    v_mfma_f32_32x32x16_bf16 v[112:127], v[140:143], v[156:159], v[112:127]
    v_mfma_f32_32x32x16_bf16 v[96:111], v[136:139], v[156:159], v[96:111]
    s_nop 8
    v_fma_f32 v28, v64, v176, v66
    v_fma_f32 v29, v65, v176, v67
    s_nop 0
    v_fma_f32 v44, v96, v176, v98
    v_fma_f32 v45, v97, v176, v99
    v_fma_f32 v28, v96, -v177, v28
    v_fma_f32 v29, v97, -v177, v29
    v_fma_f32 v44, v64, v177, v44
    v_fma_f32 v45, v65, v177, v45
    v_fma_f32 v24, v28, v176, v68
    v_fma_f32 v25, v29, v176, v69
    v_fma_f32 v26, v44, v176, v100
    v_fma_f32 v27, v45, v176, v101
    v_fma_f32 v24, v44, -v177, v24
    v_fma_f32 v25, v45, -v177, v25
    v_fma_f32 v26, v28, v177, v26
    v_fma_f32 v27, v29, v177, v27
    v_fma_f32 v28, v24, v176, v70
    v_fma_f32 v29, v25, v176, v71
    v_fma_f32 v44, v26, v176, v102
    v_fma_f32 v45, v27, v176, v103
    v_fma_f32 v28, v26, -v177, v28
    v_fma_f32 v29, v27, -v177, v29
    v_fma_f32 v44, v24, v177, v44
    v_fma_f32 v45, v25, v177, v45
    v_fma_f32 v24, v28, v176, v72
    v_fma_f32 v25, v29, v176, v73
    v_fma_f32 v26, v44, v176, v104
    v_fma_f32 v27, v45, v176, v105
    v_fma_f32 v24, v44, -v177, v24
    v_fma_f32 v25, v45, -v177, v25
    v_fma_f32 v26, v28, v177, v26
    v_fma_f32 v27, v29, v177, v27
    v_fma_f32 v28, v24, v176, v74
    v_fma_f32 v29, v25, v176, v75
    v_fma_f32 v44, v26, v176, v106
    v_fma_f32 v45, v27, v176, v107
    v_fma_f32 v28, v26, -v177, v28
    v_fma_f32 v29, v27, -v177, v29
    v_fma_f32 v44, v24, v177, v44
    v_fma_f32 v45, v25, v177, v45
    v_fma_f32 v24, v28, v176, v76
    v_fma_f32 v25, v29, v176, v77
    v_fma_f32 v26, v44, v176, v108
    v_fma_f32 v27, v45, v176, v109
    v_fma_f32 v24, v44, -v177, v24
    v_fma_f32 v25, v45, -v177, v25
    v_fma_f32 v26, v28, v177, v26
    v_fma_f32 v27, v29, v177, v27
    v_fma_f32 v28, v24, v176, v78
    v_fma_f32 v29, v25, v176, v79
    v_fma_f32 v44, v26, v176, v110
    v_fma_f32 v45, v27, v176, v111
    v_fma_f32 v28, v26, -v177, v28
    v_fma_f32 v29, v27, -v177, v29
    v_fma_f32 v44, v24, v177, v44
    v_fma_f32 v45, v25, v177, v45
    v_fma_f32 v24, v28, v176, v80
    v_fma_f32 v25, v29, v176, v81
    v_fma_f32 v26, v44, v176, v112
    v_fma_f32 v27, v45, v176, v113
    v_fma_f32 v24, v44, -v177, v24
    v_fma_f32 v25, v45, -v177, v25
    v_fma_f32 v26, v28, v177, v26
    v_fma_f32 v27, v29, v177, v27
    v_fma_f32 v28, v24, v176, v82
    v_fma_f32 v29, v25, v176, v83
    v_fma_f32 v44, v26, v176, v114
    v_fma_f32 v45, v27, v176, v115
    v_fma_f32 v28, v26, -v177, v28
    v_fma_f32 v29, v27, -v177, v29
    v_fma_f32 v44, v24, v177, v44
    v_fma_f32 v45, v25, v177, v45
    v_fma_f32 v24, v28, v176, v84
    v_fma_f32 v25, v29, v176, v85
    v_fma_f32 v26, v44, v176, v116
    v_fma_f32 v27, v45, v176, v117
    v_fma_f32 v24, v44, -v177, v24
    v_fma_f32 v25, v45, -v177, v25
    v_fma_f32 v26, v28, v177, v26
    v_fma_f32 v27, v29, v177, v27
    v_fma_f32 v28, v24, v176, v86
    v_fma_f32 v29, v25, v176, v87
    v_fma_f32 v44, v26, v176, v118
    v_fma_f32 v45, v27, v176, v119
    v_fma_f32 v28, v26, -v177, v28
    v_fma_f32 v29, v27, -v177, v29
    v_fma_f32 v44, v24, v177, v44
    v_fma_f32 v45, v25, v177, v45
    v_fma_f32 v24, v28, v176, v88
    v_fma_f32 v25, v29, v176, v89
    v_fma_f32 v26, v44, v176, v120
    v_fma_f32 v27, v45, v176, v121
    v_fma_f32 v24, v44, -v177, v24
    v_fma_f32 v25, v45, -v177, v25
    v_fma_f32 v26, v28, v177, v26
    v_fma_f32 v27, v29, v177, v27
    v_fma_f32 v28, v24, v176, v90
    v_fma_f32 v29, v25, v176, v91
    v_fma_f32 v44, v26, v176, v122
    v_fma_f32 v45, v27, v176, v123
    v_fma_f32 v28, v26, -v177, v28
    v_fma_f32 v29, v27, -v177, v29
    v_fma_f32 v44, v24, v177, v44
    v_fma_f32 v45, v25, v177, v45
    v_fma_f32 v24, v28, v176, v92
    v_fma_f32 v25, v29, v176, v93
    v_fma_f32 v26, v44, v176, v124
    v_fma_f32 v27, v45, v176, v125
    v_fma_f32 v24, v44, -v177, v24
    v_fma_f32 v25, v45, -v177, v25
    v_fma_f32 v26, v28, v177, v26
    v_fma_f32 v27, v29, v177, v27
    v_fma_f32 v28, v24, v176, v94
    v_fma_f32 v29, v25, v176, v95
    v_fma_f32 v44, v26, v176, v126
    v_fma_f32 v45, v27, v176, v127
    v_fma_f32 v28, v26, -v177, v28
    v_fma_f32 v29, v27, -v177, v29
    v_fma_f32 v44, v24, v177, v44
    v_fma_f32 v45, v25, v177, v45
    v_mov_b32 v32, v28
    v_mov_b32 v33, v44
    v_mov_b32 v34, v29
    v_mov_b32 v35, v45
    v_fma_f32 v36, v180, v32, v34
    v_fma_f32 v37, v180, v33, v35
    v_fma_f32 v36, -v181, v33, v36
    v_fma_f32 v37, v181, v32, v37
    v_mov_b32 v38, v36
    v_mov_b32 v39, v37
    v_mov_b32 v40, 0
    v_mov_b32 v41, 0
    s_nop 0
    v_permlane32_swap_b32 v40, v38
    v_permlane32_swap_b32 v41, v39
    v_fma_f32 v42, v182, v40, v36
    v_fma_f32 v43, v182, v41, v37
    v_fma_f32 v42, -v183, v41, v42
    v_fma_f32 v43, v183, v40, v43
    v_or_b32 v42, 1, v42
    s_mov_b32 s12, 0
    s_mov_b32 s13, -1
    s_mov_b64 exec, s[12:13]
    buffer_store_dwordx2 v[42:43], v7, s[56:59], 0 offen sc1
    s_mov_b64 exec, -1
    s_lshl_b32 s9, s3, 13
    s_add_u32 m0, s9, 0
    s_mov_b32 s8, 0
    buffer_load_dwordx4 v52, s[76:79], s8 offen lds
    s_add_u32 m0, s9, 1024
    s_mov_b32 s8, 16384
    buffer_load_dwordx4 v52, s[76:79], s8 offen lds
    s_add_u32 m0, s9, 2048
    s_mov_b32 s8, 32768
    buffer_load_dwordx4 v52, s[76:79], s8 offen lds
    s_add_u32 m0, s9, 3072
    s_mov_b32 s8, 49152
    buffer_load_dwordx4 v52, s[76:79], s8 offen lds
    global_load_ushort v9, v54, s[32:33] offset:0
    global_load_ushort v10, v54, s[32:33] offset:64
    v_mov_b32 v24, -1
    v_mov_b32 v25, -1
    v_mov_b32 v26, -1
    v_mov_b32 v27, -1
    buffer_store_dwordx4 v[24:27], v59, s[92:95], s74 offen offset:0 sc1
    buffer_store_dwordx4 v[24:27], v59, s[92:95], s74 offen offset:1024 sc1
    buffer_store_dwordx4 v[24:27], v59, s[92:95], s74 offen offset:2048 sc1
    buffer_store_dwordx4 v[24:27], v59, s[92:95], s74 offen offset:3072 sc1
    v_mul_f32 v224, v64, v178
    v_mul_f32 v225, v65, v178
    v_fma_f32 v224, v96, -v179, v224
    v_fma_f32 v225, v97, -v179, v225
    v_mul_f32 v96, v96, v178
    v_mul_f32 v97, v97, v178
    v_fma_f32 v96, v64, v179, v96
    v_fma_f32 v97, v65, v179, v97
    v_mul_f32 v226, v66, v178
    v_mul_f32 v227, v67, v178
    v_fma_f32 v226, v98, -v179, v226
    v_fma_f32 v227, v99, -v179, v227
    v_mul_f32 v98, v98, v178
    v_mul_f32 v99, v99, v178
    v_fma_f32 v98, v66, v179, v98
    v_fma_f32 v99, v67, v179, v99
    v_mul_f32 v228, v68, v178
    v_mul_f32 v229, v69, v178
    v_fma_f32 v228, v100, -v179, v228
    v_fma_f32 v229, v101, -v179, v229
    v_mul_f32 v100, v100, v178
    v_mul_f32 v101, v101, v178
    v_fma_f32 v100, v68, v179, v100
    v_fma_f32 v101, v69, v179, v101
    v_mul_f32 v230, v70, v178
    v_mul_f32 v231, v71, v178
    v_fma_f32 v230, v102, -v179, v230
    v_fma_f32 v231, v103, -v179, v231
    v_mul_f32 v102, v102, v178
    v_mul_f32 v103, v103, v178
    v_fma_f32 v102, v70, v179, v102
    v_fma_f32 v103, v71, v179, v103
    v_mul_f32 v232, v72, v178
    v_mul_f32 v233, v73, v178
    v_fma_f32 v232, v104, -v179, v232
    v_fma_f32 v233, v105, -v179, v233
    v_mul_f32 v104, v104, v178
    v_mul_f32 v105, v105, v178
    v_fma_f32 v104, v72, v179, v104
    v_fma_f32 v105, v73, v179, v105
    v_mul_f32 v234, v74, v178
    v_mul_f32 v235, v75, v178
    v_fma_f32 v234, v106, -v179, v234
    v_fma_f32 v235, v107, -v179, v235
    v_mul_f32 v106, v106, v178
    v_mul_f32 v107, v107, v178
    v_fma_f32 v106, v74, v179, v106
    v_fma_f32 v107, v75, v179, v107
    v_mul_f32 v236, v76, v178
    v_mul_f32 v237, v77, v178
    v_fma_f32 v236, v108, -v179, v236
    v_fma_f32 v237, v109, -v179, v237
    v_mul_f32 v108, v108, v178
    v_mul_f32 v109, v109, v178
    v_fma_f32 v108, v76, v179, v108
    v_fma_f32 v109, v77, v179, v109
    v_mul_f32 v238, v78, v178
    v_mul_f32 v239, v79, v178
    v_fma_f32 v238, v110, -v179, v238
    v_fma_f32 v239, v111, -v179, v239
    v_mul_f32 v110, v110, v178
    v_mul_f32 v111, v111, v178
    v_fma_f32 v110, v78, v179, v110
    v_fma_f32 v111, v79, v179, v111
    v_mul_f32 v240, v80, v178
    v_mul_f32 v241, v81, v178
    v_fma_f32 v240, v112, -v179, v240
    v_fma_f32 v241, v113, -v179, v241
    v_mul_f32 v112, v112, v178
    v_mul_f32 v113, v113, v178
    v_fma_f32 v112, v80, v179, v112
    v_fma_f32 v113, v81, v179, v113
    v_mul_f32 v242, v82, v178
    v_mul_f32 v243, v83, v178
    v_fma_f32 v242, v114, -v179, v242
    v_fma_f32 v243, v115, -v179, v243
    v_mul_f32 v114, v114, v178
    v_mul_f32 v115, v115, v178
    v_fma_f32 v114, v82, v179, v114
    v_fma_f32 v115, v83, v179, v115
    v_mul_f32 v244, v84, v178
    v_mul_f32 v245, v85, v178
    v_fma_f32 v244, v116, -v179, v244
    v_fma_f32 v245, v117, -v179, v245
    v_mul_f32 v116, v116, v178
    v_mul_f32 v117, v117, v178
    v_fma_f32 v116, v84, v179, v116
    v_fma_f32 v117, v85, v179, v117
    v_mul_f32 v246, v86, v178
    v_mul_f32 v247, v87, v178
    v_fma_f32 v246, v118, -v179, v246
    v_fma_f32 v247, v119, -v179, v247
    v_mul_f32 v118, v118, v178
    v_mul_f32 v119, v119, v178
    v_fma_f32 v118, v86, v179, v118
    v_fma_f32 v119, v87, v179, v119
    v_mul_f32 v248, v88, v178
    v_mul_f32 v249, v89, v178
    v_fma_f32 v248, v120, -v179, v248
    v_fma_f32 v249, v121, -v179, v249
    v_mul_f32 v120, v120, v178
    v_mul_f32 v121, v121, v178
    v_fma_f32 v120, v88, v179, v120
    v_fma_f32 v121, v89, v179, v121
    v_mul_f32 v250, v90, v178
    v_mul_f32 v251, v91, v178
    v_fma_f32 v250, v122, -v179, v250
    v_fma_f32 v251, v123, -v179, v251
    v_mul_f32 v122, v122, v178
    v_mul_f32 v123, v123, v178
    v_fma_f32 v122, v90, v179, v122
    v_fma_f32 v123, v91, v179, v123
    v_mul_f32 v252, v92, v178
    v_mul_f32 v253, v93, v178
    v_fma_f32 v252, v124, -v179, v252
    v_fma_f32 v253, v125, -v179, v253
    v_mul_f32 v124, v124, v178
    v_mul_f32 v125, v125, v178
    v_fma_f32 v124, v92, v179, v124
    v_fma_f32 v125, v93, v179, v125
    v_mul_f32 v254, v94, v178
    v_mul_f32 v255, v95, v178
    v_fma_f32 v254, v126, -v179, v254
    v_fma_f32 v255, v127, -v179, v255
    v_mul_f32 v126, v126, v178
    v_mul_f32 v127, v127, v178
    v_fma_f32 v126, v94, v179, v126
    v_fma_f32 v127, v95, v179, v127
    v_mul_f32 v44, v178, v40
    v_mul_f32 v45, v178, v41
    v_fma_f32 v44, -v179, v41, v44
    v_fma_f32 v45, v179, v40, v45
    v_mul_f32 v46, v178, v32
    v_mul_f32 v47, v178, v33
    v_fma_f32 v46, -v179, v33, v46
    v_fma_f32 v47, v179, v32, v47
    v_subrev_u32 v128, 0x2000, v50
    v_subrev_u32 v129, 0x6000, v50
    v_subrev_u32 v130, 0xa000, v50
    v_subrev_u32 v131, 0xe000, v50
    v_subrev_u32 v132, 0x12000, v50
    v_subrev_u32 v133, 0x16000, v50
    v_subrev_u32 v134, 0x1a000, v50
    v_subrev_u32 v135, 0x1e000, v50
    v_subrev_u32 v136, 0x22000, v50
    v_subrev_u32 v137, 0x26000, v50
    v_subrev_u32 v138, 0x2a000, v50
    v_subrev_u32 v139, 0x2e000, v50
    v_subrev_u32 v140, 0x32000, v50
    v_subrev_u32 v141, 0x36000, v50
    v_subrev_u32 v142, 0x3a000, v50
    v_subrev_u32 v143, 0x3e000, v50
    s_waitcnt vmcnt(11)
    s_mov_b32 s89, 65536
c_init_chk:
    v_and_b32 v52, 15, v20
    v_cmp_ne_u32 vcc, 15, v52
    s_nop 1
    s_cmp_eq_u64 vcc, 0
    s_cbranch_scc1 c_init_ok
    s_sub_u32 s89, s89, 1
    s_cbranch_scc1 c_init_ok
    s_sleep 4
    buffer_load_dword v20, v21, s[64:67], 0 offen sc1
    s_waitcnt vmcnt(0)
    s_branch c_init_chk
c_init_ok:
    s_getreg_b32 s11, hwreg(HW_REG_XCC_ID, 0, 4)
    s_lshl_b32 s11, 0x100, s11
    s_or_b32 s11, s11, 15
    v_and_b32 v52, 7, v1
    v_cmp_eq_u32 s[12:13], s54, v52
    v_cmp_ne_u32 vcc, s11, v20
    s_nop 1
    s_and_b64 vcc, vcc, s[12:13]
    s_cselect_b32 s14, 0, 1
    buffer_load_dwordx2 v[192:193], v128, s[56:59], 0 offen sc1
    buffer_load_dwordx2 v[194:195], v129, s[56:59], 0 offen sc1
    buffer_load_dwordx2 v[196:197], v130, s[56:59], 0 offen sc1
    buffer_load_dwordx2 v[198:199], v131, s[56:59], 0 offen sc1
    buffer_load_dwordx2 v[200:201], v132, s[56:59], 0 offen sc1
    buffer_load_dwordx2 v[202:203], v133, s[56:59], 0 offen sc1
    buffer_load_dwordx2 v[204:205], v134, s[56:59], 0 offen sc1
    buffer_load_dwordx2 v[206:207], v135, s[56:59], 0 offen sc1
    buffer_load_dwordx2 v[208:209], v136, s[56:59], 0 offen sc1
    buffer_load_dwordx2 v[210:211], v137, s[56:59], 0 offen sc1
    buffer_load_dwordx2 v[212:213], v138, s[56:59], 0 offen sc1
    buffer_load_dwordx2 v[214:215], v139, s[56:59], 0 offen sc1
    buffer_load_dwordx2 v[216:217], v140, s[56:59], 0 offen sc1
    buffer_load_dwordx2 v[218:219], v141, s[56:59], 0 offen sc1
    buffer_load_dwordx2 v[220:221], v142, s[56:59], 0 offen sc1
    buffer_load_dwordx2 v[222:223], v143, s[56:59], 0 offen sc1
    s_waitcnt vmcnt(20)
    ds_read_u16 v160, v53 offset:0
    ds_read_u16 v161, v53 offset:128
    ds_read_u16 v162, v53 offset:256
    ds_read_u16 v163, v53 offset:384
    ds_read_u16 v164, v53 offset:512
    ds_read_u16 v165, v53 offset:640
    ds_read_u16 v166, v53 offset:768
    ds_read_u16 v167, v53 offset:896
    ds_read_u16 v168, v53 offset:1024
    ds_read_u16 v169, v53 offset:1152
    ds_read_u16 v170, v53 offset:1280
    ds_read_u16 v171, v53 offset:1408
    ds_read_u16 v172, v53 offset:1536
    ds_read_u16 v173, v53 offset:1664
    ds_read_u16 v174, v53 offset:1792
    ds_read_u16 v175, v53 offset:1920
    ds_read_u16 v73, v53 offset:64
    ds_read_u16 v74, v53 offset:192
    ds_read_u16 v75, v53 offset:320
    ds_read_u16 v76, v53 offset:448
    ds_read_u16 v77, v53 offset:576
    ds_read_u16 v78, v53 offset:704
    ds_read_u16 v79, v53 offset:832
    ds_read_u16 v80, v53 offset:960
    ds_read_u16 v81, v53 offset:1088
    ds_read_u16 v82, v53 offset:1216
    ds_read_u16 v83, v53 offset:1344
    ds_read_u16 v84, v53 offset:1472
    ds_read_u16 v85, v53 offset:1600
    ds_read_u16 v86, v53 offset:1728
    ds_read_u16 v87, v53 offset:1856
    ds_read_u16 v88, v53 offset:1984
    s_waitcnt lgkmcnt(0)
    v_lshl_or_b32 v64, v74, 16, v73
    v_lshl_or_b32 v65, v76, 16, v75
    v_lshl_or_b32 v66, v78, 16, v77
    v_lshl_or_b32 v67, v80, 16, v79
    v_lshl_or_b32 v68, v82, 16, v81
    v_lshl_or_b32 v69, v84, 16, v83
    v_lshl_or_b32 v70, v86, 16, v85
    v_lshl_or_b32 v71, v88, 16, v87
    v_lshl_or_b32 v73, v161, 16, v160
    v_lshl_or_b32 v74, v163, 16, v162
    v_lshl_or_b32 v75, v165, 16, v164
    v_lshl_or_b32 v76, v167, 16, v166
    v_lshl_or_b32 v77, v169, 16, v168
    v_lshl_or_b32 v78, v171, 16, v170
    v_lshl_or_b32 v79, v173, 16, v172
    v_lshl_or_b32 v80, v175, 16, v174
    v_mov_b32 v81, v64
    v_mov_b32 v82, v65
    v_mov_b32 v83, v66
    v_mov_b32 v84, v67
    v_mov_b32 v85, v68
    v_mov_b32 v86, v69
    v_mov_b32 v87, v70
    v_mov_b32 v88, v71
    s_lshl_b32 s11, s3, 13
    v_lshl_add_u32 v16, v6, 11, s11
    v_lshl_add_u32 v16, v4, 6, v16
    v_bfe_u32 v17, v1, 1, 2
    v_xor_b32 v18, 0, v17
    v_lshl_add_u32 v64, v18, 4, v16
    v_xor_b32 v18, 1, v17
    v_lshl_add_u32 v65, v18, 4, v16
    v_xor_b32 v18, 2, v17
    v_lshl_add_u32 v66, v18, 4, v16
    v_xor_b32 v18, 3, v17
    v_lshl_add_u32 v67, v18, 4, v16
    v_mov_b32 v31, 1
    v_bfe_u32 v16, v1, 2, 2
    v_lshl_add_u32 v16, v6, 3, v16
    v_and_b32 v24, 1, v1
    v_bfe_u32 v18, v1, 4, 1
    v_lshl_add_u32 v24, v24, 1, v18
    v_bfe_u32 v18, v16, 1, 2
    v_xor_b32 v24, v24, v18
    v_lshlrev_b32 v24, 4, v24
    v_lshl_add_u32 v24, v16, 6, v24
    v_bfe_u32 v18, v1, 1, 1
    v_lshl_add_u32 v24, v18, 3, v24
    v_xor_b32 v25, 32, v24
    v_add_u32 v25, 256, v25
    v_add_u32 v68, s11, v24
    v_add_u32 v69, s11, v25
    s_lshl_b32 s11, s4, 7
    s_lshl_b32 s12, s6, 6
    s_add_u32 s11, s11, s12
    s_and_b32 s12, s5, 7
    s_lshl_b32 s12, s12, 2
    s_add_u32 s11, s11, s12
    s_add_u32 s11, s11, s7
    s_lshl_b32 s11, s11, 12
    s_lshr_b32 s13, s5, 3
    s_lshl_b32 s13, s13, 11
    s_add_u32 s11, s11, s13
    v_lshl_add_u32 v72, v1, 4, s11
    v_mov_b32 v20, 0x24a00
    s_lshl_b32 s6, s4, 2
    s_add_u32 s6, s6, s3
    s_lshr_b32 s7, s3, 1
    s_lshl_b32 s7, s7, 13
    s_and_b32 s8, s3, 1
    s_lshl_b32 s8, s8, 11
    s_add_u32 s7, s7, s8
    v_add_u32 v70, s7, v24
    v_add_u32 v71, s7, v25
    s_lshl_b32 s7, s6, 17
    s_add_u32 s7, s7, s13
    v_lshl_add_u32 v3, v1, 4, s7
    v_add_u32 v2, 0x1000, v3
    v_lshlrev_b32 v14, 7, v4
    v_add_u32 v14, 0x8000, v14
    v_xor_b32 v16, 0, v11
    v_lshl_add_u32 v32, v16, 4, v14
    v_xor_b32 v16, 2, v11
    v_lshl_add_u32 v33, v16, 4, v14
    v_xor_b32 v16, 4, v11
    v_lshl_add_u32 v34, v16, 4, v14
    v_xor_b32 v16, 6, v11
    v_lshl_add_u32 v35, v16, 4, v14
    s_lshr_b32 s7, s6, 1
    s_lshl_b32 s7, s7, 12
    s_add_u32 s7, s7, s13
    v_bfe_u32 v16, v1, 1, 3
    v_subrev_u32 v14, 1, v16
    v_cmp_le_u32 vcc, s15, v14
    s_nop 1
    v_cndmask_b32 v14, v14, v16, vcc
    v_mov_b32 v19, s15
    v_cmp_eq_u32 vcc, 0, v16
    s_nop 1
    v_cndmask_b32 v16, v14, v19, vcc
    v_and_b32 v14, 1, v1
    v_lshl_add_u32 v16, v16, 1, v14
    v_lshl_add_u32 v22, v16, 7, s7
    s_add_u32 s64, s52, 0x1000000
    s_addc_u32 s65, s53, 0
    s_mov_b32 s66, 0x2000
    s_mov_b32 s67, 0x20000
    s_mov_b32 s76, s48
    s_mov_b32 s77, s49
    s_mov_b32 s78, 0x800000
    s_mov_b32 s79, 0x20000
    s_mov_b32 s80, 0
    s_mov_b32 s81, 4096
    s_mov_b32 s82, 8192
    s_mov_b32 s83, 12288
    s_mov_b32 s84, 16384
    s_mov_b32 s85, 20480
    s_mov_b32 s86, 24576
    s_mov_b32 s87, 28672
    s_lshl_b32 s7, s6, 5
    v_lshl_add_u32 v7, v6, 4, s7
    s_lshl_b32 s8, s5, 6
    v_add_u32 v8, s8, v4
    v_lshlrev_b32 v26, 12, v7
    v_lshl_add_u32 v26, v8, 2, v26
    v_add_u32 v27, 0x8000, v26
    v_lshlrev_b32 v7, 2, v7
    v_mul_u32_u24 v21, 272, v4
    v_lshl_add_u32 v21, v6, 5, v21
    s_lshl_b32 s8, s3, 6
    v_add_u32 v21, s8, v21
    s_add_u32 s8, s73, 0x30000
    v_mov_b32 v29, s8
    v_lshlrev_b32 v28, 4, v1
    v_mov_b32 v23, 1
    s_mov_b32 s88, 65536
c_poll:
    s_waitcnt vmcnt(0)
    v_mov_b32 v52, 0
    v_and_b32 v144, 1, v192
    v_and_b32 v145, 1, v194
    v_and_b32 v146, 1, v196
    v_and_b32 v147, 1, v198
    v_and_b32 v148, 1, v200
    v_and_b32 v149, 1, v202
    v_and_b32 v150, 1, v204
    v_and_b32 v151, 1, v206
    v_and_b32 v152, 1, v208
    v_and_b32 v153, 1, v210
    v_and_b32 v154, 1, v212
    v_and_b32 v155, 1, v214
    v_and_b32 v156, 1, v216
    v_and_b32 v157, 1, v218
    v_and_b32 v158, 1, v220
    v_and_b32 v159, 1, v222
    v_add3_u32 v52, v52, v144, v145
    v_add3_u32 v52, v52, v146, v147
    v_add3_u32 v52, v52, v148, v149
    v_add3_u32 v52, v52, v150, v151
    v_add3_u32 v52, v52, v152, v153
    v_add3_u32 v52, v52, v154, v155
    v_add3_u32 v52, v52, v156, v157
    v_add3_u32 v52, v52, v158, v159
    v_cmp_ne_u32 vcc, v52, v51
    s_nop 1
    s_cmp_eq_u64 vcc, 0
    s_cbranch_scc1 c_polled
    s_sub_u32 s88, s88, 1
    s_cbranch_scc1 c_polled
    s_sleep 4
    v_cmp_eq_u32 vcc, 0, v144
    s_nop 1
    s_mov_b64 exec, vcc
    buffer_load_dwordx2 v[192:193], v128, s[56:59], 0 offen sc1
    s_mov_b64 exec, -1
    v_cmp_eq_u32 vcc, 0, v145
    s_nop 1
    s_mov_b64 exec, vcc
    buffer_load_dwordx2 v[194:195], v129, s[56:59], 0 offen sc1
    s_mov_b64 exec, -1
    v_cmp_eq_u32 vcc, 0, v146
    s_nop 1
    s_mov_b64 exec, vcc
    buffer_load_dwordx2 v[196:197], v130, s[56:59], 0 offen sc1
    s_mov_b64 exec, -1
    v_cmp_eq_u32 vcc, 0, v147
    s_nop 1
    s_mov_b64 exec, vcc
    buffer_load_dwordx2 v[198:199], v131, s[56:59], 0 offen sc1
    s_mov_b64 exec, -1
    v_cmp_eq_u32 vcc, 0, v148
    s_nop 1
    s_mov_b64 exec, vcc
    buffer_load_dwordx2 v[200:201], v132, s[56:59], 0 offen sc1
    s_mov_b64 exec, -1
    v_cmp_eq_u32 vcc, 0, v149
    s_nop 1
    s_mov_b64 exec, vcc
    buffer_load_dwordx2 v[202:203], v133, s[56:59], 0 offen sc1
    s_mov_b64 exec, -1
    v_cmp_eq_u32 vcc, 0, v150
    s_nop 1
    s_mov_b64 exec, vcc
    buffer_load_dwordx2 v[204:205], v134, s[56:59], 0 offen sc1
    s_mov_b64 exec, -1
    v_cmp_eq_u32 vcc, 0, v151
    s_nop 1
    s_mov_b64 exec, vcc
    buffer_load_dwordx2 v[206:207], v135, s[56:59], 0 offen sc1
    s_mov_b64 exec, -1
    v_cmp_eq_u32 vcc, 0, v152
    s_nop 1
    s_mov_b64 exec, vcc
    buffer_load_dwordx2 v[208:209], v136, s[56:59], 0 offen sc1
    s_mov_b64 exec, -1
    v_cmp_eq_u32 vcc, 0, v153
    s_nop 1
    s_mov_b64 exec, vcc
    buffer_load_dwordx2 v[210:211], v137, s[56:59], 0 offen sc1
    s_mov_b64 exec, -1
    v_cmp_eq_u32 vcc, 0, v154
    s_nop 1
    s_mov_b64 exec, vcc
    buffer_load_dwordx2 v[212:213], v138, s[56:59], 0 offen sc1
    s_mov_b64 exec, -1
    v_cmp_eq_u32 vcc, 0, v155
    s_nop 1
    s_mov_b64 exec, vcc
    buffer_load_dwordx2 v[214:215], v139, s[56:59], 0 offen sc1
    s_mov_b64 exec, -1
    v_cmp_eq_u32 vcc, 0, v156
    s_nop 1
    s_mov_b64 exec, vcc
    buffer_load_dwordx2 v[216:217], v140, s[56:59], 0 offen sc1
    s_mov_b64 exec, -1
    v_cmp_eq_u32 vcc, 0, v157
    s_nop 1
    s_mov_b64 exec, vcc
    buffer_load_dwordx2 v[218:219], v141, s[56:59], 0 offen sc1
    s_mov_b64 exec, -1
    v_cmp_eq_u32 vcc, 0, v158
    s_nop 1
    s_mov_b64 exec, vcc
    buffer_load_dwordx2 v[220:221], v142, s[56:59], 0 offen sc1
    s_mov_b64 exec, -1
    v_cmp_eq_u32 vcc, 0, v159
    s_nop 1
    s_mov_b64 exec, vcc
    buffer_load_dwordx2 v[222:223], v143, s[56:59], 0 offen sc1
    s_mov_b64 exec, -1
    s_branch c_poll
c_polled:
    v_fma_f32 v52, v222, v186, v220
    v_fma_f32 v53, v223, v186, v221
    v_fma_f32 v52, -v223, v187, v52
    v_fma_f32 v53, v222, v187, v53
    v_fma_f32 v54, v52, v186, v218
    v_fma_f32 v55, v53, v186, v219
    v_fma_f32 v54, -v53, v187, v54
    v_fma_f32 v55, v52, v187, v55
    v_fma_f32 v52, v54, v186, v216
    v_fma_f32 v53, v55, v186, v217
    v_fma_f32 v52, -v55, v187, v52
    v_fma_f32 v53, v54, v187, v53
    v_fma_f32 v54, v52, v186, v214
    v_fma_f32 v55, v53, v186, v215
    v_fma_f32 v54, -v53, v187, v54
    v_fma_f32 v55, v52, v187, v55
    v_fma_f32 v52, v54, v186, v212
    v_fma_f32 v53, v55, v186, v213
    v_fma_f32 v52, -v55, v187, v52
    v_fma_f32 v53, v54, v187, v53
    v_fma_f32 v54, v52, v186, v210
    v_fma_f32 v55, v53, v186, v211
    v_fma_f32 v54, -v53, v187, v54
    v_fma_f32 v55, v52, v187, v55
    v_fma_f32 v52, v54, v186, v208
    v_fma_f32 v53, v55, v186, v209
    v_fma_f32 v52, -v55, v187, v52
    v_fma_f32 v53, v54, v187, v53
    v_fma_f32 v54, v52, v186, v206
    v_fma_f32 v55, v53, v186, v207
    v_fma_f32 v54, -v53, v187, v54
    v_fma_f32 v55, v52, v187, v55
    v_fma_f32 v52, v54, v186, v204
    v_fma_f32 v53, v55, v186, v205
    v_fma_f32 v52, -v55, v187, v52
    v_fma_f32 v53, v54, v187, v53
    v_fma_f32 v54, v52, v186, v202
    v_fma_f32 v55, v53, v186, v203
    v_fma_f32 v54, -v53, v187, v54
    v_fma_f32 v55, v52, v187, v55
    v_fma_f32 v52, v54, v186, v200
    v_fma_f32 v53, v55, v186, v201
    v_fma_f32 v52, -v55, v187, v52
    v_fma_f32 v53, v54, v187, v53
    v_fma_f32 v54, v52, v186, v198
    v_fma_f32 v55, v53, v186, v199
    v_fma_f32 v54, -v53, v187, v54
    v_fma_f32 v55, v52, v187, v55
    v_fma_f32 v52, v54, v186, v196
    v_fma_f32 v53, v55, v186, v197
    v_fma_f32 v52, -v55, v187, v52
    v_fma_f32 v53, v54, v187, v53
    v_fma_f32 v54, v52, v186, v194
    v_fma_f32 v55, v53, v186, v195
    v_fma_f32 v54, -v53, v187, v54
    v_fma_f32 v55, v52, v187, v55
    v_fma_f32 v52, v54, v186, v192
    v_fma_f32 v53, v55, v186, v193
    v_fma_f32 v52, -v55, v187, v52
    v_fma_f32 v53, v54, v187, v53
    v_mov_b32 v54, v52
    v_mov_b32 v55, v53
    v_mov_b32 v56, v52
    v_mov_b32 v57, v53
    s_nop 0
    v_permlane32_swap_b32 v54, v56
    v_permlane32_swap_b32 v55, v57
    v_fma_f32 v58, v184, v56, v54
    v_fma_f32 v59, v184, v57, v55
    v_fma_f32 v58, -v185, v57, v58
    v_fma_f32 v59, v185, v56, v59
    v_fma_f32 v52, v48, v58, v44
    v_fma_f32 v53, v48, v59, v45
    v_fma_f32 v52, -v49, v59, v52
    v_fma_f32 v53, v49, v58, v53
    v_fma_f32 v54, v180, v52, v46
    v_fma_f32 v55, v180, v53, v47
    v_fma_f32 v54, -v181, v53, v54
    v_fma_f32 v55, v181, v52, v55
    v_mov_b32 v56, v52
    v_mov_b32 v57, v54
    v_mov_b32 v58, v53
    v_mov_b32 v59, v55
    v_fma_f32 v224, v56, v176, v224
    v_fma_f32 v225, v57, v176, v225
    v_fma_f32 v96, v58, v176, v96
    v_fma_f32 v97, v59, v176, v97
    v_fma_f32 v224, v58, -v177, v224
    v_fma_f32 v225, v59, -v177, v225
    v_fma_f32 v96, v56, v177, v96
    v_fma_f32 v97, v57, v177, v97
    v_fma_f32 v226, v224, v176, v226
    v_fma_f32 v227, v225, v176, v227
    v_fma_f32 v98, v96, v176, v98
    v_fma_f32 v99, v97, v176, v99
    v_fma_f32 v226, v96, -v177, v226
    v_fma_f32 v227, v97, -v177, v227
    v_fma_f32 v98, v224, v177, v98
    v_fma_f32 v99, v225, v177, v99
    v_fma_f32 v228, v226, v176, v228
    v_fma_f32 v229, v227, v176, v229
    v_fma_f32 v100, v98, v176, v100
    v_fma_f32 v101, v99, v176, v101
    v_fma_f32 v228, v98, -v177, v228
    v_fma_f32 v229, v99, -v177, v229
    v_fma_f32 v100, v226, v177, v100
    v_fma_f32 v101, v227, v177, v101
    v_fma_f32 v230, v228, v176, v230
    v_fma_f32 v231, v229, v176, v231
    v_fma_f32 v102, v100, v176, v102
    v_fma_f32 v103, v101, v176, v103
    v_fma_f32 v230, v100, -v177, v230
    v_fma_f32 v231, v101, -v177, v231
    v_fma_f32 v102, v228, v177, v102
    v_fma_f32 v103, v229, v177, v103
    v_fma_f32 v232, v230, v176, v232
    v_fma_f32 v233, v231, v176, v233
    v_fma_f32 v104, v102, v176, v104
    v_fma_f32 v105, v103, v176, v105
    v_fma_f32 v232, v102, -v177, v232
    v_fma_f32 v233, v103, -v177, v233
    v_fma_f32 v104, v230, v177, v104
    v_fma_f32 v105, v231, v177, v105
    v_fma_f32 v234, v232, v176, v234
    v_fma_f32 v235, v233, v176, v235
    v_fma_f32 v106, v104, v176, v106
    v_fma_f32 v107, v105, v176, v107
    v_fma_f32 v234, v104, -v177, v234
    v_fma_f32 v235, v105, -v177, v235
    v_fma_f32 v106, v232, v177, v106
    v_fma_f32 v107, v233, v177, v107
    v_fma_f32 v236, v234, v176, v236
    v_fma_f32 v237, v235, v176, v237
    v_fma_f32 v108, v106, v176, v108
    v_fma_f32 v109, v107, v176, v109
    v_fma_f32 v236, v106, -v177, v236
    v_fma_f32 v237, v107, -v177, v237
    v_fma_f32 v108, v234, v177, v108
    v_fma_f32 v109, v235, v177, v109
    v_fma_f32 v238, v236, v176, v238
    v_fma_f32 v239, v237, v176, v239
    v_fma_f32 v110, v108, v176, v110
    v_fma_f32 v111, v109, v176, v111
    v_fma_f32 v238, v108, -v177, v238
    v_fma_f32 v239, v109, -v177, v239
    v_fma_f32 v110, v236, v177, v110
    v_fma_f32 v111, v237, v177, v111
    v_cvt_pk_bf16_f32 v128, v224, v226
    v_cvt_pk_bf16_f32 v129, v228, v230
    v_cvt_pk_bf16_f32 v130, v232, v234
    v_cvt_pk_bf16_f32 v131, v236, v238
    ds_write_b128 v64, v[128:131] offset:0
    v_cvt_pk_bf16_f32 v136, v225, v227
    v_cvt_pk_bf16_f32 v137, v229, v231
    v_cvt_pk_bf16_f32 v138, v233, v235
    v_cvt_pk_bf16_f32 v139, v237, v239
    ds_write_b128 v66, v[136:139] offset:0
    v_cvt_pk_bf16_f32 v144, -v96, -v98
    v_cvt_pk_bf16_f32 v145, -v100, -v102
    v_cvt_pk_bf16_f32 v146, -v104, -v106
    v_cvt_pk_bf16_f32 v147, -v108, -v110
    ds_write_b128 v64, v[144:147] offset:4096
    v_cvt_pk_bf16_f32 v152, -v97, -v99
    v_cvt_pk_bf16_f32 v153, -v101, -v103
    v_cvt_pk_bf16_f32 v154, -v105, -v107
    v_cvt_pk_bf16_f32 v155, -v109, -v111
    ds_write_b128 v66, v[152:155] offset:4096
    v_fma_f32 v240, v238, v176, v240
    v_fma_f32 v241, v239, v176, v241
    v_fma_f32 v112, v110, v176, v112
    v_fma_f32 v113, v111, v176, v113
    v_fma_f32 v240, v110, -v177, v240
    v_fma_f32 v241, v111, -v177, v241
    v_fma_f32 v112, v238, v177, v112
    v_fma_f32 v113, v239, v177, v113
    v_fma_f32 v242, v240, v176, v242
    v_fma_f32 v243, v241, v176, v243
    v_fma_f32 v114, v112, v176, v114
    v_fma_f32 v115, v113, v176, v115
    v_fma_f32 v242, v112, -v177, v242
    v_fma_f32 v243, v113, -v177, v243
    v_fma_f32 v114, v240, v177, v114
    v_fma_f32 v115, v241, v177, v115
    v_fma_f32 v244, v242, v176, v244
    v_fma_f32 v245, v243, v176, v245
    v_fma_f32 v116, v114, v176, v116
    v_fma_f32 v117, v115, v176, v117
    v_fma_f32 v244, v114, -v177, v244
    v_fma_f32 v245, v115, -v177, v245
    v_fma_f32 v116, v242, v177, v116
    v_fma_f32 v117, v243, v177, v117
    v_fma_f32 v246, v244, v176, v246
    v_fma_f32 v247, v245, v176, v247
    v_fma_f32 v118, v116, v176, v118
    v_fma_f32 v119, v117, v176, v119
    v_fma_f32 v246, v116, -v177, v246
    v_fma_f32 v247, v117, -v177, v247
    v_fma_f32 v118, v244, v177, v118
    v_fma_f32 v119, v245, v177, v119
    v_fma_f32 v248, v246, v176, v248
    v_fma_f32 v249, v247, v176, v249
    v_fma_f32 v120, v118, v176, v120
    v_fma_f32 v121, v119, v176, v121
    v_fma_f32 v248, v118, -v177, v248
    v_fma_f32 v249, v119, -v177, v249
    v_fma_f32 v120, v246, v177, v120
    v_fma_f32 v121, v247, v177, v121
    v_fma_f32 v250, v248, v176, v250
    v_fma_f32 v251, v249, v176, v251
    v_fma_f32 v122, v120, v176, v122
    v_fma_f32 v123, v121, v176, v123
    v_fma_f32 v250, v120, -v177, v250
    v_fma_f32 v251, v121, -v177, v251
    v_fma_f32 v122, v248, v177, v122
    v_fma_f32 v123, v249, v177, v123
    v_fma_f32 v252, v250, v176, v252
    v_fma_f32 v253, v251, v176, v253
    v_fma_f32 v124, v122, v176, v124
    v_fma_f32 v125, v123, v176, v125
    v_fma_f32 v252, v122, -v177, v252
    v_fma_f32 v253, v123, -v177, v253
    v_fma_f32 v124, v250, v177, v124
    v_fma_f32 v125, v251, v177, v125
    v_fma_f32 v254, v252, v176, v254
    v_fma_f32 v255, v253, v176, v255
    v_fma_f32 v126, v124, v176, v126
    v_fma_f32 v127, v125, v176, v127
    v_fma_f32 v254, v124, -v177, v254
    v_fma_f32 v255, v125, -v177, v255
    v_fma_f32 v126, v252, v177, v126
    v_fma_f32 v127, v253, v177, v127
    v_cvt_pk_bf16_f32 v132, v240, v242
    v_cvt_pk_bf16_f32 v133, v244, v246
    v_cvt_pk_bf16_f32 v134, v248, v250
    v_cvt_pk_bf16_f32 v135, v252, v254
    ds_write_b128 v65, v[132:135] offset:0
    v_cvt_pk_bf16_f32 v140, v241, v243
    v_cvt_pk_bf16_f32 v141, v245, v247
    v_cvt_pk_bf16_f32 v142, v249, v251
    v_cvt_pk_bf16_f32 v143, v253, v255
    ds_write_b128 v67, v[140:143] offset:0
    v_cvt_pk_bf16_f32 v148, -v112, -v114
    v_cvt_pk_bf16_f32 v149, -v116, -v118
    v_cvt_pk_bf16_f32 v150, -v120, -v122
    v_cvt_pk_bf16_f32 v151, -v124, -v126
    ds_write_b128 v65, v[148:151] offset:4096
    v_cvt_pk_bf16_f32 v156, -v113, -v115
    v_cvt_pk_bf16_f32 v157, -v117, -v119
    v_cvt_pk_bf16_f32 v158, -v121, -v123
    v_cvt_pk_bf16_f32 v159, -v125, -v127
    ds_write_b128 v67, v[156:159] offset:4096
    s_waitcnt lgkmcnt(0)
    s_mov_b64 exec, 1
    ds_add_u32 v20, v31 offset:12
    s_mov_b64 exec, -1
    ds_read_b64_tr_b16 v[160:161], v68 offset:0
    ds_read_b64_tr_b16 v[162:163], v69 offset:0
    ds_read_b64_tr_b16 v[164:165], v68 offset:1024
    ds_read_b64_tr_b16 v[166:167], v69 offset:1024
    ds_read_b64_tr_b16 v[168:169], v68 offset:4096
    ds_read_b64_tr_b16 v[170:171], v69 offset:4096
    ds_read_b64_tr_b16 v[172:173], v68 offset:5120
    ds_read_b64_tr_b16 v[174:175], v69 offset:5120
    ds_read_b64_tr_b16 v[176:177], v68 offset:2048
    ds_read_b64_tr_b16 v[178:179], v69 offset:2048
    ds_read_b64_tr_b16 v[180:181], v68 offset:3072
    ds_read_b64_tr_b16 v[182:183], v69 offset:3072
    ds_read_b64_tr_b16 v[184:185], v68 offset:6144
    ds_read_b64_tr_b16 v[186:187], v69 offset:6144
    ds_read_b64_tr_b16 v[188:189], v68 offset:7168
    ds_read_b64_tr_b16 v[190:191], v69 offset:7168
    s_mov_b32 s12, 0x0
    s_waitcnt lgkmcnt(14)
    buffer_store_dwordx4 v[160:163], v72, s[60:63], s12 offen offset:0 sc1
    s_waitcnt lgkmcnt(12)
    buffer_store_dwordx4 v[164:167], v72, s[60:63], s12 offen offset:1024 sc1
    s_mov_b32 s12, 0x2000
    s_waitcnt lgkmcnt(10)
    buffer_store_dwordx4 v[168:171], v72, s[60:63], s12 offen offset:0 sc1
    s_waitcnt lgkmcnt(8)
    buffer_store_dwordx4 v[172:175], v72, s[60:63], s12 offen offset:1024 sc1
    s_mov_b32 s12, 0x20000
    s_waitcnt lgkmcnt(6)
    buffer_store_dwordx4 v[176:179], v72, s[60:63], s12 offen offset:0 sc1
    s_waitcnt lgkmcnt(4)
    buffer_store_dwordx4 v[180:183], v72, s[60:63], s12 offen offset:1024 sc1
    s_mov_b32 s12, 0x22000
    s_waitcnt lgkmcnt(2)
    buffer_store_dwordx4 v[184:187], v72, s[60:63], s12 offen offset:0 sc1
    s_waitcnt lgkmcnt(0)
    buffer_store_dwordx4 v[188:191], v72, s[60:63], s12 offen offset:1024 sc1
    s_mov_b32 s89, 262144
c_lw:
    ds_read_b128 v[52:55], v20 offset:4
    s_waitcnt lgkmcnt(0)
    v_min_u32 v54, v54, v55
    v_min_u32 v53, 1, v53
    v_readfirstlane_b32 s8, v54
    v_readfirstlane_b32 s9, v53
    s_nop 1
    s_add_u32 s8, s8, s9
    s_cmp_ge_u32 s8, 5
    s_cbranch_scc1 c_lwok
    s_sub_u32 s89, s89, 1
    s_cbranch_scc0 c_lw
c_lwok:
    ds_read_b64_tr_b16 v[160:161], v70 offset:0
    ds_read_b64_tr_b16 v[162:163], v71 offset:0
    ds_read_b64_tr_b16 v[164:165], v70 offset:1024
    ds_read_b64_tr_b16 v[166:167], v71 offset:1024
    ds_read_b64_tr_b16 v[168:169], v70 offset:16384
    ds_read_b64_tr_b16 v[170:171], v71 offset:16384
    ds_read_b64_tr_b16 v[172:173], v70 offset:17408
    ds_read_b64_tr_b16 v[174:175], v71 offset:17408
    ds_read_b64_tr_b16 v[176:177], v70 offset:4096
    ds_read_b64_tr_b16 v[178:179], v71 offset:4096
    ds_read_b64_tr_b16 v[180:181], v70 offset:5120
    ds_read_b64_tr_b16 v[182:183], v71 offset:5120
    ds_read_b64_tr_b16 v[184:185], v70 offset:20480
    ds_read_b64_tr_b16 v[186:187], v71 offset:20480
    ds_read_b64_tr_b16 v[188:189], v70 offset:21504
    ds_read_b64_tr_b16 v[190:191], v71 offset:21504
    buffer_load_dwordx4 v[36:39], v7, s[64:67], 0 offen offset:0 sc1
    buffer_load_dwordx4 v[40:43], v7, s[64:67], 0 offen offset:16 sc1
    buffer_load_dwordx4 v[44:47], v7, s[64:67], 0 offen offset:32 sc1
    buffer_load_dwordx4 v[48:51], v7, s[64:67], 0 offen offset:48 sc1
    ds_read_b128 v[224:227], v32 offset:0
    ds_read_b128 v[228:231], v32 offset:4096
    ds_read_b128 v[232:235], v32 offset:8192
    ds_read_b128 v[236:239], v32 offset:12288
    s_waitcnt lgkmcnt(15)
    s_waitcnt lgkmcnt(3)
    v_mfma_f32_32x32x16_bf16 v[96:111], v[160:163], v[224:227], 0
    ds_read_b128 v[240:243], v33 offset:0
    s_waitcnt lgkmcnt(3)
    v_mfma_f32_32x32x16_bf16 v[112:127], v[160:163], v[228:231], 0
    ds_read_b128 v[244:247], v33 offset:4096
    s_waitcnt lgkmcnt(3)
    v_mfma_f32_32x32x16_bf16 v[128:143], v[160:163], v[232:235], 0
    ds_read_b128 v[248:251], v33 offset:8192
    s_waitcnt lgkmcnt(3)
    v_mfma_f32_32x32x16_bf16 v[144:159], v[160:163], v[236:239], 0
    ds_read_b128 v[252:255], v33 offset:12288
    s_waitcnt lgkmcnt(3)
    v_mfma_f32_32x32x16_bf16 v[96:111], v[164:167], v[240:243], v[96:111]
    ds_read_b128 v[224:227], v34 offset:0
    s_waitcnt lgkmcnt(3)
    v_mfma_f32_32x32x16_bf16 v[112:127], v[164:167], v[244:247], v[112:127]
    ds_read_b128 v[228:231], v34 offset:4096
    s_waitcnt lgkmcnt(3)
    v_mfma_f32_32x32x16_bf16 v[128:143], v[164:167], v[248:251], v[128:143]
    ds_read_b128 v[232:235], v34 offset:8192
    s_waitcnt lgkmcnt(3)
    v_mfma_f32_32x32x16_bf16 v[144:159], v[164:167], v[252:255], v[144:159]
    ds_read_b128 v[236:239], v34 offset:12288
    s_waitcnt lgkmcnt(3)
    v_mfma_f32_32x32x16_bf16 v[96:111], v[168:171], v[224:227], v[96:111]
    ds_read_b128 v[240:243], v35 offset:0
    s_waitcnt lgkmcnt(3)
    v_mfma_f32_32x32x16_bf16 v[112:127], v[168:171], v[228:231], v[112:127]
    ds_read_b128 v[244:247], v35 offset:4096
    s_waitcnt lgkmcnt(3)
    v_mfma_f32_32x32x16_bf16 v[128:143], v[168:171], v[232:235], v[128:143]
    ds_read_b128 v[248:251], v35 offset:8192
    s_waitcnt lgkmcnt(3)
    v_mfma_f32_32x32x16_bf16 v[144:159], v[168:171], v[236:239], v[144:159]
    ds_read_b128 v[252:255], v35 offset:12288
    s_waitcnt lgkmcnt(3)
    v_mfma_f32_32x32x16_bf16 v[96:111], v[172:175], v[240:243], v[96:111]
    ds_read_b128 v[224:227], v32 offset:16384
    s_waitcnt lgkmcnt(3)
    v_mfma_f32_32x32x16_bf16 v[112:127], v[172:175], v[244:247], v[112:127]
    ds_read_b128 v[228:231], v32 offset:20480
    s_waitcnt lgkmcnt(3)
    v_mfma_f32_32x32x16_bf16 v[128:143], v[172:175], v[248:251], v[128:143]
    ds_read_b128 v[232:235], v32 offset:24576
    s_waitcnt lgkmcnt(3)
    v_mfma_f32_32x32x16_bf16 v[144:159], v[172:175], v[252:255], v[144:159]
    ds_read_b128 v[236:239], v32 offset:28672
    s_waitcnt vmcnt(4)
    s_cmp_eq_u32 s14, 1
    s_cbranch_scc1 c_hfs_l
    buffer_store_dword v23, v60, s[68:71], 0 offen sc1
    s_branch c_hfs_e
c_hfs_l:
    buffer_store_dword v23, v60, s[68:71], 0 offen
c_hfs_e:
    buffer_store_dword v23, v30, s[68:71], 0 offen sc1
    buffer_load_dword v19, v22, s[68:71], 0 offen sc1
    s_waitcnt lgkmcnt(3)
    v_mfma_f32_32x32x16_bf16 v[96:111], v[176:179], v[224:227], v[96:111]
    ds_read_b128 v[240:243], v33 offset:16384
    s_waitcnt lgkmcnt(3)
    v_mfma_f32_32x32x16_bf16 v[112:127], v[176:179], v[228:231], v[112:127]
    ds_read_b128 v[244:247], v33 offset:20480
    s_waitcnt lgkmcnt(3)
    v_mfma_f32_32x32x16_bf16 v[128:143], v[176:179], v[232:235], v[128:143]
    ds_read_b128 v[248:251], v33 offset:24576
    s_waitcnt lgkmcnt(3)
    v_mfma_f32_32x32x16_bf16 v[144:159], v[176:179], v[236:239], v[144:159]
    ds_read_b128 v[252:255], v33 offset:28672
    s_waitcnt lgkmcnt(3)
    v_mfma_f32_32x32x16_bf16 v[96:111], v[180:183], v[240:243], v[96:111]
    ds_read_b128 v[224:227], v34 offset:16384
    s_waitcnt lgkmcnt(3)
    v_mfma_f32_32x32x16_bf16 v[112:127], v[180:183], v[244:247], v[112:127]
    ds_read_b128 v[228:231], v34 offset:20480
    s_waitcnt lgkmcnt(3)
    v_mfma_f32_32x32x16_bf16 v[128:143], v[180:183], v[248:251], v[128:143]
    ds_read_b128 v[232:235], v34 offset:24576
    s_waitcnt lgkmcnt(3)
    v_mfma_f32_32x32x16_bf16 v[144:159], v[180:183], v[252:255], v[144:159]
    ds_read_b128 v[236:239], v34 offset:28672
    s_waitcnt lgkmcnt(3)
    v_mfma_f32_32x32x16_bf16 v[96:111], v[184:187], v[224:227], v[96:111]
    ds_read_b128 v[240:243], v35 offset:16384
    s_waitcnt lgkmcnt(3)
    v_mfma_f32_32x32x16_bf16 v[112:127], v[184:187], v[228:231], v[112:127]
    ds_read_b128 v[244:247], v35 offset:20480
    s_waitcnt lgkmcnt(3)
    v_mfma_f32_32x32x16_bf16 v[128:143], v[184:187], v[232:235], v[128:143]
    ds_read_b128 v[248:251], v35 offset:24576
    s_waitcnt lgkmcnt(3)
    v_mfma_f32_32x32x16_bf16 v[144:159], v[184:187], v[236:239], v[144:159]
    ds_read_b128 v[252:255], v35 offset:28672
    s_waitcnt vmcnt(0)
    v_cmp_eq_u32 s[90:91], 1, v19
    s_nop 1
    s_and_b32 s88, s90, 0xc
    s_cmp_eq_u32 s88, 0xc
    s_cbranch_scc0 c_n0_s
c_n0:
    s_cmp_le_u32 s15, 0
    s_cselect_b32 s11, 1, 0
    s_lshl_b32 s11, s11, 14
    buffer_load_dwordx4 v[192:195], v3, s[60:63], s11 offen offset:0 sc1
    buffer_load_dwordx4 v[196:199], v3, s[60:63], s11 offen offset:1024 sc1
    buffer_load_dwordx4 v[200:203], v2, s[60:63], s11 offen offset:0 sc1
    buffer_load_dwordx4 v[204:207], v2, s[60:63], s11 offen offset:1024 sc1
    s_cmp_le_u32 s15, 0
    s_cselect_b32 s11, 1, 0
    s_lshl_b32 s11, s11, 14
    s_add_u32 s11, s11, 8192
    buffer_load_dwordx4 v[208:211], v3, s[60:63], s11 offen offset:0 sc1
    buffer_load_dwordx4 v[212:215], v3, s[60:63], s11 offen offset:1024 sc1
    buffer_load_dwordx4 v[216:219], v2, s[60:63], s11 offen offset:0 sc1
    buffer_load_dwordx4 v[220:223], v2, s[60:63], s11 offen offset:1024 sc1
    buffer_load_dword v19, v22, s[68:71], 0 offen sc1
    s_barrier
    s_waitcnt lgkmcnt(3)
    v_mfma_f32_32x32x16_bf16 v[96:111], v[188:191], v[240:243], v[96:111]
    ds_read_b128 v[224:227], v32 offset:32768
    s_waitcnt lgkmcnt(3)
    v_mfma_f32_32x32x16_bf16 v[112:127], v[188:191], v[244:247], v[112:127]
    ds_read_b128 v[228:231], v32 offset:36864
    s_waitcnt lgkmcnt(3)
    v_mfma_f32_32x32x16_bf16 v[128:143], v[188:191], v[248:251], v[128:143]
    ds_read_b128 v[232:235], v32 offset:40960
    s_waitcnt lgkmcnt(3)
    v_mfma_f32_32x32x16_bf16 v[144:159], v[188:191], v[252:255], v[144:159]
    ds_read_b128 v[236:239], v32 offset:45056
    v_lshlrev_b32 v9, 16, v9
    v_lshlrev_b32 v10, 16, v10
    s_mov_b32 s12, 0xffff0000
    v_lshlrev_b32 v13, 16, v73
    v_lshlrev_b32 v16, 16, v74
    v_lshlrev_b32 v18, 16, v75
    v_lshlrev_b32 v25, 16, v76
    v_and_b32 v15, s12, v73
    v_and_b32 v17, s12, v74
    v_and_b32 v24, s12, v75
    v_and_b32 v8, s12, v76
    v_mul_f32 v13, v13, v9
    v_mul_f32 v16, v16, v9
    v_mul_f32 v18, v18, v9
    v_mul_f32 v25, v25, v9
    v_mul_f32 v15, v15, v9
    v_mul_f32 v17, v17, v9
    v_mul_f32 v24, v24, v9
    v_mul_f32 v8, v8, v9
    v_cvt_pk_bf16_f32 v89, v13, v15
    v_cvt_pk_bf16_f32 v90, v16, v17
    v_cvt_pk_bf16_f32 v91, v18, v24
    v_cvt_pk_bf16_f32 v92, v25, v8
    v_lshlrev_b32 v13, 16, v77
    v_lshlrev_b32 v16, 16, v78
    v_lshlrev_b32 v18, 16, v79
    v_lshlrev_b32 v25, 16, v80
    v_and_b32 v15, s12, v77
    v_and_b32 v17, s12, v78
    v_and_b32 v24, s12, v79
    v_and_b32 v8, s12, v80
    v_mul_f32 v13, v13, v9
    v_mul_f32 v16, v16, v9
    v_mul_f32 v18, v18, v9
    v_mul_f32 v25, v25, v9
    v_mul_f32 v15, v15, v9
    v_mul_f32 v17, v17, v9
    v_mul_f32 v24, v24, v9
    v_mul_f32 v8, v8, v9
    v_cvt_pk_bf16_f32 v93, v13, v15
    v_cvt_pk_bf16_f32 v94, v16, v17
    v_cvt_pk_bf16_f32 v95, v18, v24
    v_cvt_pk_bf16_f32 v54, v25, v8
    v_lshlrev_b32 v13, 16, v81
    v_lshlrev_b32 v16, 16, v82
    v_lshlrev_b32 v18, 16, v83
    v_lshlrev_b32 v25, 16, v84
    v_and_b32 v15, s12, v81
    v_and_b32 v17, s12, v82
    v_and_b32 v24, s12, v83
    v_and_b32 v8, s12, v84
    v_mul_f32 v13, v13, v10
    v_mul_f32 v16, v16, v10
    v_mul_f32 v18, v18, v10
    v_mul_f32 v25, v25, v10
    v_mul_f32 v15, v15, v10
    v_mul_f32 v17, v17, v10
    v_mul_f32 v24, v24, v10
    v_mul_f32 v8, v8, v10
    v_cvt_pk_bf16_f32 v55, v13, v15
    v_cvt_pk_bf16_f32 v56, v16, v17
    v_cvt_pk_bf16_f32 v57, v18, v24
    v_cvt_pk_bf16_f32 v58, v25, v8
    v_lshlrev_b32 v13, 16, v85
    v_lshlrev_b32 v16, 16, v86
    v_lshlrev_b32 v18, 16, v87
    v_lshlrev_b32 v25, 16, v88
    v_and_b32 v15, s12, v85
    v_and_b32 v17, s12, v86
    v_and_b32 v24, s12, v87
    v_and_b32 v8, s12, v88
    v_mul_f32 v13, v13, v10
    v_mul_f32 v16, v16, v10
    v_mul_f32 v18, v18, v10
    v_mul_f32 v25, v25, v10
    v_mul_f32 v15, v15, v10
    v_mul_f32 v17, v17, v10
    v_mul_f32 v24, v24, v10
    v_mul_f32 v8, v8, v10
    v_cvt_pk_bf16_f32 v59, v13, v15
    v_cvt_pk_bf16_f32 v61, v16, v17
    v_cvt_pk_bf16_f32 v5, v18, v24
    v_cvt_pk_bf16_f32 v12, v25, v8
    s_waitcnt vmcnt(8)
    s_waitcnt lgkmcnt(3)
    v_mfma_f32_32x32x16_bf16 v[96:111], v[192:195], v[224:227], v[96:111]
    ds_read_b128 v[240:243], v33 offset:32768
    s_waitcnt lgkmcnt(3)
    v_mfma_f32_32x32x16_bf16 v[112:127], v[192:195], v[228:231], v[112:127]
    ds_read_b128 v[244:247], v33 offset:36864
    s_waitcnt lgkmcnt(3)
    v_mfma_f32_32x32x16_bf16 v[128:143], v[192:195], v[232:235], v[128:143]
    ds_read_b128 v[248:251], v33 offset:40960
    s_waitcnt lgkmcnt(3)
    v_mfma_f32_32x32x16_bf16 v[144:159], v[192:195], v[236:239], v[144:159]
    ds_read_b128 v[252:255], v33 offset:45056
    s_waitcnt vmcnt(0)
    v_cmp_eq_u32 s[90:91], 1, v19
    s_nop 1
    s_and_b32 s88, s90, 0x3c
    s_cmp_eq_u32 s88, 0x3c
    s_cbranch_scc0 c_n1_s
c_n1:
    s_cmp_le_u32 s15, 1
    s_cselect_b32 s11, 2, 1
    s_lshl_b32 s11, s11, 14
    buffer_load_dwordx4 v[160:163], v3, s[60:63], s11 offen offset:0 sc1
    buffer_load_dwordx4 v[164:167], v3, s[60:63], s11 offen offset:1024 sc1
    buffer_load_dwordx4 v[168:171], v2, s[60:63], s11 offen offset:0 sc1
    buffer_load_dwordx4 v[172:175], v2, s[60:63], s11 offen offset:1024 sc1
    buffer_load_dword v19, v22, s[68:71], 0 offen sc1
    s_cmp_le_u32 s15, 1
    s_cselect_b32 s11, 2, 1
    s_lshl_b32 s11, s11, 14
    s_add_u32 s11, s11, 8192
    buffer_load_dwordx4 v[176:179], v3, s[60:63], s11 offen offset:0 sc1
    s_waitcnt lgkmcnt(3)
    v_mfma_f32_32x32x16_bf16 v[96:111], v[196:199], v[240:243], v[96:111]
    ds_read_b128 v[224:227], v34 offset:32768
    s_waitcnt lgkmcnt(3)
    v_mfma_f32_32x32x16_bf16 v[112:127], v[196:199], v[244:247], v[112:127]
    ds_read_b128 v[228:231], v34 offset:36864
    s_waitcnt lgkmcnt(3)
    v_mfma_f32_32x32x16_bf16 v[128:143], v[196:199], v[248:251], v[128:143]
    ds_read_b128 v[232:235], v34 offset:40960
    s_waitcnt lgkmcnt(3)
    v_mfma_f32_32x32x16_bf16 v[144:159], v[196:199], v[252:255], v[144:159]
    ds_read_b128 v[236:239], v34 offset:45056
    buffer_load_dwordx4 v[180:183], v3, s[60:63], s11 offen offset:1024 sc1
    s_waitcnt lgkmcnt(3)
    v_mfma_f32_32x32x16_bf16 v[96:111], v[200:203], v[224:227], v[96:111]
    ds_read_b128 v[240:243], v35 offset:32768
    s_waitcnt lgkmcnt(3)
    v_mfma_f32_32x32x16_bf16 v[112:127], v[200:203], v[228:231], v[112:127]
    ds_read_b128 v[244:247], v35 offset:36864
    s_waitcnt lgkmcnt(3)
    v_mfma_f32_32x32x16_bf16 v[128:143], v[200:203], v[232:235], v[128:143]
    ds_read_b128 v[248:251], v35 offset:40960
    s_waitcnt lgkmcnt(3)
    v_mfma_f32_32x32x16_bf16 v[144:159], v[200:203], v[236:239], v[144:159]
    ds_read_b128 v[252:255], v35 offset:45056
    buffer_load_dwordx4 v[184:187], v2, s[60:63], s11 offen offset:0 sc1
    s_barrier
    s_waitcnt lgkmcnt(3)
    v_mfma_f32_32x32x16_bf16 v[96:111], v[204:207], v[240:243], v[96:111]
    ds_read_b128 v[224:227], v32 offset:49152
    s_waitcnt lgkmcnt(3)
    v_mfma_f32_32x32x16_bf16 v[112:127], v[204:207], v[244:247], v[112:127]
    ds_read_b128 v[228:231], v32 offset:53248
    s_waitcnt lgkmcnt(3)
    v_mfma_f32_32x32x16_bf16 v[128:143], v[204:207], v[248:251], v[128:143]
    ds_read_b128 v[232:235], v32 offset:57344
    s_waitcnt lgkmcnt(3)
    v_mfma_f32_32x32x16_bf16 v[144:159], v[204:207], v[252:255], v[144:159]
    ds_read_b128 v[236:239], v32 offset:61440
    buffer_load_dwordx4 v[188:191], v2, s[60:63], s11 offen offset:1024 sc1
    s_waitcnt lgkmcnt(3)
    v_mfma_f32_32x32x16_bf16 v[96:111], v[208:211], v[224:227], v[96:111]
    ds_read_b128 v[240:243], v33 offset:49152
    s_waitcnt lgkmcnt(3)
    v_mfma_f32_32x32x16_bf16 v[112:127], v[208:211], v[228:231], v[112:127]
    ds_read_b128 v[244:247], v33 offset:53248
    s_waitcnt lgkmcnt(3)
    v_mfma_f32_32x32x16_bf16 v[128:143], v[208:211], v[232:235], v[128:143]
    ds_read_b128 v[248:251], v33 offset:57344
    s_waitcnt lgkmcnt(3)
    v_mfma_f32_32x32x16_bf16 v[144:159], v[208:211], v[236:239], v[144:159]
    ds_read_b128 v[252:255], v33 offset:61440
    s_waitcnt vmcnt(4)
    v_cmp_eq_u32 s[90:91], 1, v19
    s_nop 1
    s_and_b32 s88, s90, 0xfc
    s_cmp_eq_u32 s88, 0xfc
    s_cbranch_scc0 c_n2_s
c_n2:
    s_cmp_le_u32 s15, 2
    s_cselect_b32 s11, 3, 2
    s_lshl_b32 s11, s11, 14
    buffer_load_dwordx4 v[192:195], v3, s[60:63], s11 offen offset:0 sc1
    s_waitcnt lgkmcnt(3)
    v_mfma_f32_32x32x16_bf16 v[96:111], v[212:215], v[240:243], v[96:111]
    ds_read_b128 v[224:227], v34 offset:49152
    s_waitcnt lgkmcnt(3)
    v_mfma_f32_32x32x16_bf16 v[112:127], v[212:215], v[244:247], v[112:127]
    ds_read_b128 v[228:231], v34 offset:53248
    s_waitcnt lgkmcnt(3)
    v_mfma_f32_32x32x16_bf16 v[128:143], v[212:215], v[248:251], v[128:143]
    ds_read_b128 v[232:235], v34 offset:57344
    s_waitcnt lgkmcnt(3)
    v_mfma_f32_32x32x16_bf16 v[144:159], v[212:215], v[252:255], v[144:159]
    ds_read_b128 v[236:239], v34 offset:61440
    buffer_load_dwordx4 v[196:199], v3, s[60:63], s11 offen offset:1024 sc1
    s_waitcnt lgkmcnt(3)
    v_mfma_f32_32x32x16_bf16 v[96:111], v[216:219], v[224:227], v[96:111]
    ds_read_b128 v[240:243], v35 offset:49152
    s_waitcnt lgkmcnt(3)
    v_mfma_f32_32x32x16_bf16 v[112:127], v[216:219], v[228:231], v[112:127]
    ds_read_b128 v[244:247], v35 offset:53248
    s_waitcnt lgkmcnt(3)
    v_mfma_f32_32x32x16_bf16 v[128:143], v[216:219], v[232:235], v[128:143]
    ds_read_b128 v[248:251], v35 offset:57344
    s_waitcnt lgkmcnt(3)
    v_mfma_f32_32x32x16_bf16 v[144:159], v[216:219], v[236:239], v[144:159]
    ds_read_b128 v[252:255], v35 offset:61440
    buffer_load_dwordx4 v[200:203], v2, s[60:63], s11 offen offset:0 sc1
    s_barrier
    s_waitcnt lgkmcnt(3)
    v_mfma_f32_32x32x16_bf16 v[96:111], v[220:223], v[240:243], v[96:111]
    ds_read_b128 v[224:227], v32 offset:0
    s_waitcnt lgkmcnt(3)
    v_mfma_f32_32x32x16_bf16 v[112:127], v[220:223], v[244:247], v[112:127]
    ds_read_b128 v[228:231], v32 offset:4096
    s_waitcnt lgkmcnt(3)
    v_mfma_f32_32x32x16_bf16 v[128:143], v[220:223], v[248:251], v[128:143]
    ds_read_b128 v[232:235], v32 offset:8192
    s_waitcnt lgkmcnt(3)
    v_mfma_f32_32x32x16_bf16 v[144:159], v[220:223], v[252:255], v[144:159]
    ds_read_b128 v[236:239], v32 offset:12288
    buffer_load_dwordx4 v[204:207], v2, s[60:63], s11 offen offset:1024 sc1
    s_waitcnt lgkmcnt(3)
    v_mfma_f32_32x32x16_bf16 v[96:111], v[160:163], v[224:227], v[96:111]
    ds_read_b128 v[240:243], v33 offset:0
    s_waitcnt lgkmcnt(3)
    v_mfma_f32_32x32x16_bf16 v[112:127], v[160:163], v[228:231], v[112:127]
    ds_read_b128 v[244:247], v33 offset:4096
    s_waitcnt lgkmcnt(3)
    v_mfma_f32_32x32x16_bf16 v[128:143], v[160:163], v[232:235], v[128:143]
    ds_read_b128 v[248:251], v33 offset:8192
    s_waitcnt lgkmcnt(3)
    v_mfma_f32_32x32x16_bf16 v[144:159], v[160:163], v[236:239], v[144:159]
    ds_read_b128 v[252:255], v33 offset:12288
    s_cmp_le_u32 s15, 2
    s_cselect_b32 s11, 3, 2
    s_lshl_b32 s11, s11, 14
    s_add_u32 s11, s11, 8192
    buffer_load_dwordx4 v[208:211], v3, s[60:63], s11 offen offset:0 sc1
    s_waitcnt lgkmcnt(3)
    v_mfma_f32_32x32x16_bf16 v[96:111], v[164:167], v[240:243], v[96:111]
    ds_read_b128 v[224:227], v34 offset:0
    s_waitcnt lgkmcnt(3)
    v_mfma_f32_32x32x16_bf16 v[112:127], v[164:167], v[244:247], v[112:127]
    ds_read_b128 v[228:231], v34 offset:4096
    s_waitcnt lgkmcnt(3)
    v_mfma_f32_32x32x16_bf16 v[128:143], v[164:167], v[248:251], v[128:143]
    ds_read_b128 v[232:235], v34 offset:8192
    s_waitcnt lgkmcnt(3)
    v_mfma_f32_32x32x16_bf16 v[144:159], v[164:167], v[252:255], v[144:159]
    ds_read_b128 v[236:239], v34 offset:12288
    buffer_load_dwordx4 v[212:215], v3, s[60:63], s11 offen offset:1024 sc1
    s_waitcnt lgkmcnt(3)
    v_mfma_f32_32x32x16_bf16 v[96:111], v[168:171], v[224:227], v[96:111]
    ds_read_b128 v[240:243], v35 offset:0
    s_waitcnt lgkmcnt(3)
    v_mfma_f32_32x32x16_bf16 v[112:127], v[168:171], v[228:231], v[112:127]
    ds_read_b128 v[244:247], v35 offset:4096
    s_waitcnt lgkmcnt(3)
    v_mfma_f32_32x32x16_bf16 v[128:143], v[168:171], v[232:235], v[128:143]
    ds_read_b128 v[248:251], v35 offset:8192
    s_waitcnt lgkmcnt(3)
    v_mfma_f32_32x32x16_bf16 v[144:159], v[168:171], v[236:239], v[144:159]
    ds_read_b128 v[252:255], v35 offset:12288
    buffer_load_dwordx4 v[216:219], v2, s[60:63], s11 offen offset:0 sc1
    s_barrier
    s_waitcnt lgkmcnt(3)
    v_mfma_f32_32x32x16_bf16 v[96:111], v[172:175], v[240:243], v[96:111]
    ds_read_b128 v[224:227], v32 offset:16384
    s_waitcnt lgkmcnt(3)
    v_mfma_f32_32x32x16_bf16 v[112:127], v[172:175], v[244:247], v[112:127]
    ds_read_b128 v[228:231], v32 offset:20480
    s_waitcnt lgkmcnt(3)
    v_mfma_f32_32x32x16_bf16 v[128:143], v[172:175], v[248:251], v[128:143]
    ds_read_b128 v[232:235], v32 offset:24576
    s_waitcnt lgkmcnt(3)
    v_mfma_f32_32x32x16_bf16 v[144:159], v[172:175], v[252:255], v[144:159]
    ds_read_b128 v[236:239], v32 offset:28672
    buffer_load_dwordx4 v[220:223], v2, s[60:63], s11 offen offset:1024 sc1
    s_waitcnt vmcnt(11)
    s_waitcnt lgkmcnt(3)
    v_mfma_f32_32x32x16_bf16 v[96:111], v[176:179], v[224:227], v[96:111]
    ds_read_b128 v[240:243], v33 offset:16384
    s_waitcnt lgkmcnt(3)
    v_mfma_f32_32x32x16_bf16 v[112:127], v[176:179], v[228:231], v[112:127]
    ds_read_b128 v[244:247], v33 offset:20480
    s_waitcnt lgkmcnt(3)
    v_mfma_f32_32x32x16_bf16 v[128:143], v[176:179], v[232:235], v[128:143]
    ds_read_b128 v[248:251], v33 offset:24576
    s_waitcnt lgkmcnt(3)
    v_mfma_f32_32x32x16_bf16 v[144:159], v[176:179], v[236:239], v[144:159]
    ds_read_b128 v[252:255], v33 offset:28672
    s_and_b32 s88, s90, 0x3fc
    s_cmp_eq_u32 s88, 0x3fc
    s_cbranch_scc0 c_n3_s
c_n3:
    s_cmp_le_u32 s15, 3
    s_cselect_b32 s11, 4, 3
    s_lshl_b32 s11, s11, 14
    buffer_load_dwordx4 v[160:163], v3, s[60:63], s11 offen offset:0 sc1
    buffer_load_dword v14, v29, s[68:71], 0 offen sc1
    s_waitcnt vmcnt(12)
    s_waitcnt lgkmcnt(3)
    v_mfma_f32_32x32x16_bf16 v[96:111], v[180:183], v[240:243], v[96:111]
    ds_read_b128 v[224:227], v34 offset:16384
    s_waitcnt lgkmcnt(3)
    v_mfma_f32_32x32x16_bf16 v[112:127], v[180:183], v[244:247], v[112:127]
    ds_read_b128 v[228:231], v34 offset:20480
    s_waitcnt lgkmcnt(3)
    v_mfma_f32_32x32x16_bf16 v[128:143], v[180:183], v[248:251], v[128:143]
    ds_read_b128 v[232:235], v34 offset:24576
    s_waitcnt lgkmcnt(3)
    v_mfma_f32_32x32x16_bf16 v[144:159], v[180:183], v[252:255], v[144:159]
    ds_read_b128 v[236:239], v34 offset:28672
    buffer_load_dwordx4 v[164:167], v3, s[60:63], s11 offen offset:1024 sc1
    s_waitcnt vmcnt(12)
    s_waitcnt lgkmcnt(3)
    v_mfma_f32_32x32x16_bf16 v[96:111], v[184:187], v[224:227], v[96:111]
    ds_read_b128 v[240:243], v35 offset:16384
    s_waitcnt lgkmcnt(3)
    v_mfma_f32_32x32x16_bf16 v[112:127], v[184:187], v[228:231], v[112:127]
    ds_read_b128 v[244:247], v35 offset:20480
    s_waitcnt lgkmcnt(3)
    v_mfma_f32_32x32x16_bf16 v[128:143], v[184:187], v[232:235], v[128:143]
    ds_read_b128 v[248:251], v35 offset:24576
    s_waitcnt lgkmcnt(3)
    v_mfma_f32_32x32x16_bf16 v[144:159], v[184:187], v[236:239], v[144:159]
    ds_read_b128 v[252:255], v35 offset:28672
    buffer_load_dwordx4 v[168:171], v2, s[60:63], s11 offen offset:0 sc1
    s_barrier
    s_waitcnt vmcnt(12)
    s_waitcnt lgkmcnt(3)
    v_mfma_f32_32x32x16_bf16 v[96:111], v[188:191], v[240:243], v[96:111]
    ds_read_b128 v[224:227], v32 offset:32768
    s_waitcnt lgkmcnt(3)
    v_mfma_f32_32x32x16_bf16 v[112:127], v[188:191], v[244:247], v[112:127]
    ds_read_b128 v[228:231], v32 offset:36864
    s_waitcnt lgkmcnt(3)
    v_mfma_f32_32x32x16_bf16 v[128:143], v[188:191], v[248:251], v[128:143]
    ds_read_b128 v[232:235], v32 offset:40960
    s_waitcnt lgkmcnt(3)
    v_mfma_f32_32x32x16_bf16 v[144:159], v[188:191], v[252:255], v[144:159]
    ds_read_b128 v[236:239], v32 offset:45056
    buffer_load_dwordx4 v[172:175], v2, s[60:63], s11 offen offset:1024 sc1
    s_waitcnt vmcnt(12)
    s_waitcnt lgkmcnt(3)
    v_mfma_f32_32x32x16_bf16 v[96:111], v[192:195], v[224:227], v[96:111]
    ds_read_b128 v[240:243], v33 offset:32768
    s_waitcnt lgkmcnt(3)
    v_mfma_f32_32x32x16_bf16 v[112:127], v[192:195], v[228:231], v[112:127]
    ds_read_b128 v[244:247], v33 offset:36864
    s_waitcnt lgkmcnt(3)
    v_mfma_f32_32x32x16_bf16 v[128:143], v[192:195], v[232:235], v[128:143]
    ds_read_b128 v[248:251], v33 offset:40960
    s_waitcnt lgkmcnt(3)
    v_mfma_f32_32x32x16_bf16 v[144:159], v[192:195], v[236:239], v[144:159]
    ds_read_b128 v[252:255], v33 offset:45056
    s_cmp_le_u32 s15, 3
    s_cselect_b32 s11, 4, 3
    s_lshl_b32 s11, s11, 14
    s_add_u32 s11, s11, 8192
    buffer_load_dwordx4 v[176:179], v3, s[60:63], s11 offen offset:0 sc1
    s_waitcnt vmcnt(12)
    s_waitcnt lgkmcnt(3)
    v_mfma_f32_32x32x16_bf16 v[96:111], v[196:199], v[240:243], v[96:111]
    ds_read_b128 v[224:227], v34 offset:32768
    s_waitcnt lgkmcnt(3)
    v_mfma_f32_32x32x16_bf16 v[112:127], v[196:199], v[244:247], v[112:127]
    ds_read_b128 v[228:231], v34 offset:36864
    s_waitcnt lgkmcnt(3)
    v_mfma_f32_32x32x16_bf16 v[128:143], v[196:199], v[248:251], v[128:143]
    ds_read_b128 v[232:235], v34 offset:40960
    s_waitcnt lgkmcnt(3)
    v_mfma_f32_32x32x16_bf16 v[144:159], v[196:199], v[252:255], v[144:159]
    ds_read_b128 v[236:239], v34 offset:45056
    buffer_load_dwordx4 v[180:183], v3, s[60:63], s11 offen offset:1024 sc1
    s_waitcnt vmcnt(12)
    s_waitcnt lgkmcnt(3)
    v_mfma_f32_32x32x16_bf16 v[96:111], v[200:203], v[224:227], v[96:111]
    ds_read_b128 v[240:243], v35 offset:32768
    s_waitcnt lgkmcnt(3)
    v_mfma_f32_32x32x16_bf16 v[112:127], v[200:203], v[228:231], v[112:127]
    ds_read_b128 v[244:247], v35 offset:36864
    s_waitcnt lgkmcnt(3)
    v_mfma_f32_32x32x16_bf16 v[128:143], v[200:203], v[232:235], v[128:143]
    ds_read_b128 v[248:251], v35 offset:40960
    s_waitcnt lgkmcnt(3)
    v_mfma_f32_32x32x16_bf16 v[144:159], v[200:203], v[236:239], v[144:159]
    ds_read_b128 v[252:255], v35 offset:45056
    buffer_load_dwordx4 v[184:187], v2, s[60:63], s11 offen offset:0 sc1
    s_barrier
    s_waitcnt vmcnt(12)
    s_waitcnt lgkmcnt(3)
    v_mfma_f32_32x32x16_bf16 v[96:111], v[204:207], v[240:243], v[96:111]
    ds_read_b128 v[224:227], v32 offset:49152
    s_waitcnt lgkmcnt(3)
    v_mfma_f32_32x32x16_bf16 v[112:127], v[204:207], v[244:247], v[112:127]
    ds_read_b128 v[228:231], v32 offset:53248
    s_waitcnt lgkmcnt(3)
    v_mfma_f32_32x32x16_bf16 v[128:143], v[204:207], v[248:251], v[128:143]
    ds_read_b128 v[232:235], v32 offset:57344
    s_waitcnt lgkmcnt(3)
    v_mfma_f32_32x32x16_bf16 v[144:159], v[204:207], v[252:255], v[144:159]
    ds_read_b128 v[236:239], v32 offset:61440
    buffer_load_dwordx4 v[188:191], v2, s[60:63], s11 offen offset:1024 sc1
    s_waitcnt vmcnt(12)
    s_waitcnt lgkmcnt(3)
    v_mfma_f32_32x32x16_bf16 v[96:111], v[208:211], v[224:227], v[96:111]
    ds_read_b128 v[240:243], v33 offset:49152
    s_waitcnt lgkmcnt(3)
    v_mfma_f32_32x32x16_bf16 v[112:127], v[208:211], v[228:231], v[112:127]
    ds_read_b128 v[244:247], v33 offset:53248
    s_waitcnt lgkmcnt(3)
    v_mfma_f32_32x32x16_bf16 v[128:143], v[208:211], v[232:235], v[128:143]
    ds_read_b128 v[248:251], v33 offset:57344
    s_waitcnt lgkmcnt(3)
    v_mfma_f32_32x32x16_bf16 v[144:159], v[208:211], v[236:239], v[144:159]
    ds_read_b128 v[252:255], v33 offset:61440
    s_and_b32 s88, s90, 0xffc
    s_cmp_eq_u32 s88, 0xffc
    s_cbranch_scc0 c_n4_s
c_n4:
    s_cmp_le_u32 s15, 4
    s_cselect_b32 s11, 5, 4
    s_lshl_b32 s11, s11, 14
    buffer_load_dwordx4 v[192:195], v3, s[60:63], s11 offen offset:0 sc1
    s_waitcnt vmcnt(12)
    s_waitcnt lgkmcnt(3)
    v_mfma_f32_32x32x16_bf16 v[96:111], v[212:215], v[240:243], v[96:111]
    ds_read_b128 v[224:227], v34 offset:49152
    s_waitcnt lgkmcnt(3)
    v_mfma_f32_32x32x16_bf16 v[112:127], v[212:215], v[244:247], v[112:127]
    ds_read_b128 v[228:231], v34 offset:53248
    s_waitcnt lgkmcnt(3)
    v_mfma_f32_32x32x16_bf16 v[128:143], v[212:215], v[248:251], v[128:143]
    ds_read_b128 v[232:235], v34 offset:57344
    s_waitcnt lgkmcnt(3)
    v_mfma_f32_32x32x16_bf16 v[144:159], v[212:215], v[252:255], v[144:159]
    ds_read_b128 v[236:239], v34 offset:61440
    buffer_load_dwordx4 v[196:199], v3, s[60:63], s11 offen offset:1024 sc1
    s_waitcnt vmcnt(12)
    s_waitcnt lgkmcnt(3)
    v_mfma_f32_32x32x16_bf16 v[96:111], v[216:219], v[224:227], v[96:111]
    ds_read_b128 v[240:243], v35 offset:49152
    s_waitcnt lgkmcnt(3)
    v_mfma_f32_32x32x16_bf16 v[112:127], v[216:219], v[228:231], v[112:127]
    ds_read_b128 v[244:247], v35 offset:53248
    s_waitcnt lgkmcnt(3)
    v_mfma_f32_32x32x16_bf16 v[128:143], v[216:219], v[232:235], v[128:143]
    ds_read_b128 v[248:251], v35 offset:57344
    s_waitcnt lgkmcnt(3)
    v_mfma_f32_32x32x16_bf16 v[144:159], v[216:219], v[236:239], v[144:159]
    ds_read_b128 v[252:255], v35 offset:61440
    buffer_load_dwordx4 v[200:203], v2, s[60:63], s11 offen offset:0 sc1
    s_barrier
    s_waitcnt vmcnt(12)
    s_waitcnt lgkmcnt(3)
    v_mfma_f32_32x32x16_bf16 v[96:111], v[220:223], v[240:243], v[96:111]
    ds_read_b128 v[224:227], v32 offset:0
    s_waitcnt lgkmcnt(3)
    v_mfma_f32_32x32x16_bf16 v[112:127], v[220:223], v[244:247], v[112:127]
    ds_read_b128 v[228:231], v32 offset:4096
    s_waitcnt lgkmcnt(3)
    v_mfma_f32_32x32x16_bf16 v[128:143], v[220:223], v[248:251], v[128:143]
    ds_read_b128 v[232:235], v32 offset:8192
    s_waitcnt lgkmcnt(3)
    v_mfma_f32_32x32x16_bf16 v[144:159], v[220:223], v[252:255], v[144:159]
    ds_read_b128 v[236:239], v32 offset:12288
    buffer_load_dwordx4 v[204:207], v2, s[60:63], s11 offen offset:1024 sc1
    s_waitcnt vmcnt(12)
    s_waitcnt lgkmcnt(3)
    v_mfma_f32_32x32x16_bf16 v[96:111], v[160:163], v[224:227], v[96:111]
    ds_read_b128 v[240:243], v33 offset:0
    s_waitcnt lgkmcnt(3)
    v_mfma_f32_32x32x16_bf16 v[112:127], v[160:163], v[228:231], v[112:127]
    ds_read_b128 v[244:247], v33 offset:4096
    s_waitcnt lgkmcnt(3)
    v_mfma_f32_32x32x16_bf16 v[128:143], v[160:163], v[232:235], v[128:143]
    ds_read_b128 v[248:251], v33 offset:8192
    s_waitcnt lgkmcnt(3)
    v_mfma_f32_32x32x16_bf16 v[144:159], v[160:163], v[236:239], v[144:159]
    ds_read_b128 v[252:255], v33 offset:12288
    s_cmp_le_u32 s15, 4
    s_cselect_b32 s11, 5, 4
    s_lshl_b32 s11, s11, 14
    s_add_u32 s11, s11, 8192
    buffer_load_dwordx4 v[208:211], v3, s[60:63], s11 offen offset:0 sc1
    s_waitcnt vmcnt(12)
    v_cmp_ne_u32 vcc, 1, v14
    s_nop 1
    s_cmp_eq_u64 vcc, 0
    s_cbranch_scc0 c_pfs
c_pfr:
    s_waitcnt vmcnt(11)
    s_waitcnt lgkmcnt(3)
    v_mfma_f32_32x32x16_bf16 v[96:111], v[164:167], v[240:243], v[96:111]
    ds_read_b128 v[224:227], v34 offset:0
    s_waitcnt lgkmcnt(3)
    v_mfma_f32_32x32x16_bf16 v[112:127], v[164:167], v[244:247], v[112:127]
    ds_read_b128 v[228:231], v34 offset:4096
    s_waitcnt lgkmcnt(3)
    v_mfma_f32_32x32x16_bf16 v[128:143], v[164:167], v[248:251], v[128:143]
    ds_read_b128 v[232:235], v34 offset:8192
    s_waitcnt lgkmcnt(3)
    v_mfma_f32_32x32x16_bf16 v[144:159], v[164:167], v[252:255], v[144:159]
    ds_read_b128 v[236:239], v34 offset:12288
    buffer_load_dwordx4 v[212:215], v3, s[60:63], s11 offen offset:1024 sc1
    s_waitcnt vmcnt(11)
    s_waitcnt lgkmcnt(3)
    v_mfma_f32_32x32x16_bf16 v[96:111], v[168:171], v[224:227], v[96:111]
    ds_read_b128 v[240:243], v35 offset:0
    s_waitcnt lgkmcnt(3)
    v_mfma_f32_32x32x16_bf16 v[112:127], v[168:171], v[228:231], v[112:127]
    ds_read_b128 v[244:247], v35 offset:4096
    s_waitcnt lgkmcnt(3)
    v_mfma_f32_32x32x16_bf16 v[128:143], v[168:171], v[232:235], v[128:143]
    ds_read_b128 v[248:251], v35 offset:8192
    s_waitcnt lgkmcnt(3)
    v_mfma_f32_32x32x16_bf16 v[144:159], v[168:171], v[236:239], v[144:159]
    ds_read_b128 v[252:255], v35 offset:12288
    buffer_load_dwordx4 v[216:219], v2, s[60:63], s11 offen offset:0 sc1
    s_barrier
    s_waitcnt vmcnt(11)
    s_waitcnt lgkmcnt(3)
    v_mfma_f32_32x32x16_bf16 v[96:111], v[172:175], v[240:243], v[96:111]
    ds_read_b128 v[224:227], v32 offset:16384
    s_waitcnt lgkmcnt(3)
    v_mfma_f32_32x32x16_bf16 v[112:127], v[172:175], v[244:247], v[112:127]
    ds_read_b128 v[228:231], v32 offset:20480
    s_waitcnt lgkmcnt(3)
    v_mfma_f32_32x32x16_bf16 v[128:143], v[172:175], v[248:251], v[128:143]
    ds_read_b128 v[232:235], v32 offset:24576
    s_waitcnt lgkmcnt(3)
    v_mfma_f32_32x32x16_bf16 v[144:159], v[172:175], v[252:255], v[144:159]
    ds_read_b128 v[236:239], v32 offset:28672
    buffer_load_dwordx4 v[220:223], v2, s[60:63], s11 offen offset:1024 sc1
    s_waitcnt vmcnt(11)
    s_waitcnt lgkmcnt(3)
    v_mfma_f32_32x32x16_bf16 v[96:111], v[176:179], v[224:227], v[96:111]
    ds_read_b128 v[240:243], v33 offset:16384
    s_waitcnt lgkmcnt(3)
    v_mfma_f32_32x32x16_bf16 v[112:127], v[176:179], v[228:231], v[112:127]
    ds_read_b128 v[244:247], v33 offset:20480
    s_waitcnt lgkmcnt(3)
    v_mfma_f32_32x32x16_bf16 v[128:143], v[176:179], v[232:235], v[128:143]
    ds_read_b128 v[248:251], v33 offset:24576
    s_waitcnt lgkmcnt(3)
    v_mfma_f32_32x32x16_bf16 v[144:159], v[176:179], v[236:239], v[144:159]
    ds_read_b128 v[252:255], v33 offset:28672
    s_and_b32 s88, s90, 0x3ffc
    s_cmp_eq_u32 s88, 0x3ffc
    s_cbranch_scc0 c_n5_s
c_n5:
    s_cmp_le_u32 s15, 5
    s_cselect_b32 s11, 6, 5
    s_lshl_b32 s11, s11, 14
    buffer_load_dwordx4 v[160:163], v3, s[60:63], s11 offen offset:0 sc1
    s_waitcnt vmcnt(11)
    s_waitcnt lgkmcnt(3)
    v_mfma_f32_32x32x16_bf16 v[96:111], v[180:183], v[240:243], v[96:111]
    ds_read_b128 v[224:227], v34 offset:16384
    s_waitcnt lgkmcnt(3)
    v_mfma_f32_32x32x16_bf16 v[112:127], v[180:183], v[244:247], v[112:127]
    ds_read_b128 v[228:231], v34 offset:20480
    s_waitcnt lgkmcnt(3)
    v_mfma_f32_32x32x16_bf16 v[128:143], v[180:183], v[248:251], v[128:143]
    ds_read_b128 v[232:235], v34 offset:24576
    s_waitcnt lgkmcnt(3)
    v_mfma_f32_32x32x16_bf16 v[144:159], v[180:183], v[252:255], v[144:159]
    ds_read_b128 v[236:239], v34 offset:28672
    buffer_load_dwordx4 v[164:167], v3, s[60:63], s11 offen offset:1024 sc1
    s_waitcnt vmcnt(11)
    s_waitcnt lgkmcnt(3)
    v_mfma_f32_32x32x16_bf16 v[96:111], v[184:187], v[224:227], v[96:111]
    ds_read_b128 v[240:243], v35 offset:16384
    s_waitcnt lgkmcnt(3)
    v_mfma_f32_32x32x16_bf16 v[112:127], v[184:187], v[228:231], v[112:127]
    ds_read_b128 v[244:247], v35 offset:20480
    s_waitcnt lgkmcnt(3)
    v_mfma_f32_32x32x16_bf16 v[128:143], v[184:187], v[232:235], v[128:143]
    ds_read_b128 v[248:251], v35 offset:24576
    s_waitcnt lgkmcnt(3)
    v_mfma_f32_32x32x16_bf16 v[144:159], v[184:187], v[236:239], v[144:159]
    ds_read_b128 v[252:255], v35 offset:28672
    buffer_load_dwordx4 v[168:171], v2, s[60:63], s11 offen offset:0 sc1
    s_barrier
    s_waitcnt vmcnt(11)
    s_waitcnt lgkmcnt(3)
    v_mfma_f32_32x32x16_bf16 v[96:111], v[188:191], v[240:243], v[96:111]
    ds_read_b128 v[224:227], v32 offset:32768
    s_waitcnt lgkmcnt(3)
    v_mfma_f32_32x32x16_bf16 v[112:127], v[188:191], v[244:247], v[112:127]
    ds_read_b128 v[228:231], v32 offset:36864
    s_waitcnt lgkmcnt(3)
    v_mfma_f32_32x32x16_bf16 v[128:143], v[188:191], v[248:251], v[128:143]
    ds_read_b128 v[232:235], v32 offset:40960
    s_waitcnt lgkmcnt(3)
    v_mfma_f32_32x32x16_bf16 v[144:159], v[188:191], v[252:255], v[144:159]
    ds_read_b128 v[236:239], v32 offset:45056
    buffer_load_dwordx4 v[172:175], v2, s[60:63], s11 offen offset:1024 sc1
    s_waitcnt vmcnt(11)
    s_waitcnt lgkmcnt(3)
    v_mfma_f32_32x32x16_bf16 v[96:111], v[192:195], v[224:227], v[96:111]
    ds_read_b128 v[240:243], v33 offset:32768
    s_waitcnt lgkmcnt(3)
    v_mfma_f32_32x32x16_bf16 v[112:127], v[192:195], v[228:231], v[112:127]
    ds_read_b128 v[244:247], v33 offset:36864
    s_waitcnt lgkmcnt(3)
    v_mfma_f32_32x32x16_bf16 v[128:143], v[192:195], v[232:235], v[128:143]
    ds_read_b128 v[248:251], v33 offset:40960
    s_waitcnt lgkmcnt(3)
    v_mfma_f32_32x32x16_bf16 v[144:159], v[192:195], v[236:239], v[144:159]
    ds_read_b128 v[252:255], v33 offset:45056
    s_cmp_le_u32 s15, 5
    s_cselect_b32 s11, 6, 5
    s_lshl_b32 s11, s11, 14
    s_add_u32 s11, s11, 8192
    buffer_load_dwordx4 v[176:179], v3, s[60:63], s11 offen offset:0 sc1
    s_waitcnt vmcnt(11)
    s_waitcnt lgkmcnt(3)
    v_mfma_f32_32x32x16_bf16 v[96:111], v[196:199], v[240:243], v[96:111]
    ds_read_b128 v[224:227], v34 offset:32768
    s_waitcnt lgkmcnt(3)
    v_mfma_f32_32x32x16_bf16 v[112:127], v[196:199], v[244:247], v[112:127]
    ds_read_b128 v[228:231], v34 offset:36864
    s_waitcnt lgkmcnt(3)
    v_mfma_f32_32x32x16_bf16 v[128:143], v[196:199], v[248:251], v[128:143]
    ds_read_b128 v[232:235], v34 offset:40960
    s_waitcnt lgkmcnt(3)
    v_mfma_f32_32x32x16_bf16 v[144:159], v[196:199], v[252:255], v[144:159]
    ds_read_b128 v[236:239], v34 offset:45056
    buffer_load_dwordx4 v[180:183], v3, s[60:63], s11 offen offset:1024 sc1
    s_waitcnt vmcnt(11)
    s_waitcnt lgkmcnt(3)
    v_mfma_f32_32x32x16_bf16 v[96:111], v[200:203], v[224:227], v[96:111]
    ds_read_b128 v[240:243], v35 offset:32768
    s_waitcnt lgkmcnt(3)
    v_mfma_f32_32x32x16_bf16 v[112:127], v[200:203], v[228:231], v[112:127]
    ds_read_b128 v[244:247], v35 offset:36864
    s_waitcnt lgkmcnt(3)
    v_mfma_f32_32x32x16_bf16 v[128:143], v[200:203], v[232:235], v[128:143]
    ds_read_b128 v[248:251], v35 offset:40960
    s_waitcnt lgkmcnt(3)
    v_mfma_f32_32x32x16_bf16 v[144:159], v[200:203], v[236:239], v[144:159]
    ds_read_b128 v[252:255], v35 offset:45056
    buffer_load_dwordx4 v[184:187], v2, s[60:63], s11 offen offset:0 sc1
    s_barrier
    s_waitcnt vmcnt(11)
    s_waitcnt lgkmcnt(3)
    v_mfma_f32_32x32x16_bf16 v[96:111], v[204:207], v[240:243], v[96:111]
    ds_read_b128 v[224:227], v32 offset:49152
    s_waitcnt lgkmcnt(3)
    v_mfma_f32_32x32x16_bf16 v[112:127], v[204:207], v[244:247], v[112:127]
    ds_read_b128 v[228:231], v32 offset:53248
    s_waitcnt lgkmcnt(3)
    v_mfma_f32_32x32x16_bf16 v[128:143], v[204:207], v[248:251], v[128:143]
    ds_read_b128 v[232:235], v32 offset:57344
    s_waitcnt lgkmcnt(3)
    v_mfma_f32_32x32x16_bf16 v[144:159], v[204:207], v[252:255], v[144:159]
    ds_read_b128 v[236:239], v32 offset:61440
    buffer_load_dwordx4 v[188:191], v2, s[60:63], s11 offen offset:1024 sc1
    s_waitcnt vmcnt(11)
    s_waitcnt lgkmcnt(3)
    v_mfma_f32_32x32x16_bf16 v[96:111], v[208:211], v[224:227], v[96:111]
    ds_read_b128 v[240:243], v33 offset:49152
    s_waitcnt lgkmcnt(3)
    v_mfma_f32_32x32x16_bf16 v[112:127], v[208:211], v[228:231], v[112:127]
    ds_read_b128 v[244:247], v33 offset:53248
    s_waitcnt lgkmcnt(3)
    v_mfma_f32_32x32x16_bf16 v[128:143], v[208:211], v[232:235], v[128:143]
    ds_read_b128 v[248:251], v33 offset:57344
    s_waitcnt lgkmcnt(3)
    v_mfma_f32_32x32x16_bf16 v[144:159], v[208:211], v[236:239], v[144:159]
    ds_read_b128 v[252:255], v33 offset:61440
    s_and_b32 s88, s90, 0xfffc
    s_cmp_eq_u32 s88, 0xfffc
    s_cbranch_scc0 c_n6_s
c_n6:
    s_cmp_le_u32 s15, 6
    s_cselect_b32 s11, 7, 6
    s_lshl_b32 s11, s11, 14
    buffer_load_dwordx4 v[192:195], v3, s[60:63], s11 offen offset:0 sc1
    s_waitcnt vmcnt(11)
    s_waitcnt lgkmcnt(3)
    v_mfma_f32_32x32x16_bf16 v[96:111], v[212:215], v[240:243], v[96:111]
    ds_read_b128 v[224:227], v34 offset:49152
    s_waitcnt lgkmcnt(3)
    v_mfma_f32_32x32x16_bf16 v[112:127], v[212:215], v[244:247], v[112:127]
    ds_read_b128 v[228:231], v34 offset:53248
    s_waitcnt lgkmcnt(3)
    v_mfma_f32_32x32x16_bf16 v[128:143], v[212:215], v[248:251], v[128:143]
    ds_read_b128 v[232:235], v34 offset:57344
    s_waitcnt lgkmcnt(3)
    v_mfma_f32_32x32x16_bf16 v[144:159], v[212:215], v[252:255], v[144:159]
    ds_read_b128 v[236:239], v34 offset:61440
    buffer_load_dwordx4 v[196:199], v3, s[60:63], s11 offen offset:1024 sc1
    s_waitcnt vmcnt(11)
    s_waitcnt lgkmcnt(3)
    v_mfma_f32_32x32x16_bf16 v[96:111], v[216:219], v[224:227], v[96:111]
    ds_read_b128 v[240:243], v35 offset:49152
    s_waitcnt lgkmcnt(3)
    v_mfma_f32_32x32x16_bf16 v[112:127], v[216:219], v[228:231], v[112:127]
    ds_read_b128 v[244:247], v35 offset:53248
    s_waitcnt lgkmcnt(3)
    v_mfma_f32_32x32x16_bf16 v[128:143], v[216:219], v[232:235], v[128:143]
    ds_read_b128 v[248:251], v35 offset:57344
    s_waitcnt lgkmcnt(3)
    v_mfma_f32_32x32x16_bf16 v[144:159], v[216:219], v[236:239], v[144:159]
    ds_read_b128 v[252:255], v35 offset:61440
    buffer_load_dwordx4 v[200:203], v2, s[60:63], s11 offen offset:0 sc1
    s_barrier
    s_waitcnt vmcnt(11)
    s_waitcnt lgkmcnt(3)
    v_mfma_f32_32x32x16_bf16 v[96:111], v[220:223], v[240:243], v[96:111]
    ds_read_b128 v[224:227], v32 offset:0
    s_waitcnt lgkmcnt(3)
    v_mfma_f32_32x32x16_bf16 v[112:127], v[220:223], v[244:247], v[112:127]
    ds_read_b128 v[228:231], v32 offset:4096
    s_waitcnt lgkmcnt(3)
    v_mfma_f32_32x32x16_bf16 v[128:143], v[220:223], v[248:251], v[128:143]
    ds_read_b128 v[232:235], v32 offset:8192
    s_waitcnt lgkmcnt(3)
    v_mfma_f32_32x32x16_bf16 v[144:159], v[220:223], v[252:255], v[144:159]
    ds_read_b128 v[236:239], v32 offset:12288
    buffer_load_dwordx4 v[204:207], v2, s[60:63], s11 offen offset:1024 sc1
    s_cmp_le_u32 s15, 6
    s_cselect_b32 s11, 7, 6
    s_lshl_b32 s11, s11, 14
    s_add_u32 s11, s11, 8192
    buffer_load_dwordx4 v[208:211], v3, s[60:63], s11 offen offset:0 sc1
    buffer_load_dwordx4 v[212:215], v3, s[60:63], s11 offen offset:1024 sc1
    buffer_load_dwordx4 v[216:219], v2, s[60:63], s11 offen offset:0 sc1
    buffer_load_dwordx4 v[220:223], v2, s[60:63], s11 offen offset:1024 sc1
    ds_read_b128 v[240:243], v33 offset:0
    ds_read_b128 v[244:247], v33 offset:4096
    ds_read_b128 v[248:251], v34 offset:0
    s_waitcnt vmcnt(15)
    s_waitcnt lgkmcnt(6)
    v_mfma_f32_32x32x16_bf16 v[96:111], v[160:163], v[224:227], v[96:111]
    ds_read_b128 v[252:255], v34 offset:4096
    s_waitcnt lgkmcnt(6)
    v_mfma_f32_32x32x16_bf16 v[112:127], v[160:163], v[228:231], v[112:127]
    ds_read_b128 v[224:227], v35 offset:0
    s_waitcnt vmcnt(14)
    s_waitcnt lgkmcnt(4)
    v_mfma_f32_32x32x16_bf16 v[96:111], v[164:167], v[240:243], v[96:111]
    ds_read_b128 v[228:231], v35 offset:4096
    s_waitcnt lgkmcnt(4)
    v_mfma_f32_32x32x16_bf16 v[112:127], v[164:167], v[244:247], v[112:127]
    s_barrier
    ds_read_b128 v[240:243], v32 offset:16384
    s_waitcnt vmcnt(13)
    s_waitcnt lgkmcnt(4)
    v_mfma_f32_32x32x16_bf16 v[96:111], v[168:171], v[248:251], v[96:111]
    ds_read_b128 v[244:247], v32 offset:20480
    s_waitcnt lgkmcnt(4)
    v_mfma_f32_32x32x16_bf16 v[112:127], v[168:171], v[252:255], v[112:127]
    ds_read_b128 v[248:251], v33 offset:16384
    s_waitcnt vmcnt(12)
    s_waitcnt lgkmcnt(4)
    v_mfma_f32_32x32x16_bf16 v[96:111], v[172:175], v[224:227], v[96:111]
    ds_read_b128 v[252:255], v33 offset:20480
    s_waitcnt lgkmcnt(4)
    v_mfma_f32_32x32x16_bf16 v[112:127], v[172:175], v[228:231], v[112:127]
    ds_read_b128 v[224:227], v34 offset:16384
    s_waitcnt vmcnt(11)
    s_waitcnt lgkmcnt(4)
    v_mfma_f32_32x32x16_bf16 v[96:111], v[176:179], v[240:243], v[96:111]
    ds_read_b128 v[228:231], v34 offset:20480
    s_waitcnt lgkmcnt(4)
    v_mfma_f32_32x32x16_bf16 v[112:127], v[176:179], v[244:247], v[112:127]
    ds_read_b128 v[240:243], v35 offset:16384
    s_waitcnt vmcnt(10)
    s_waitcnt lgkmcnt(4)
    v_mfma_f32_32x32x16_bf16 v[96:111], v[180:183], v[248:251], v[96:111]
    ds_read_b128 v[244:247], v35 offset:20480
    s_waitcnt lgkmcnt(4)
    v_mfma_f32_32x32x16_bf16 v[112:127], v[180:183], v[252:255], v[112:127]
    ds_read_b128 v[248:251], v33 offset:8192
    s_waitcnt vmcnt(9)
    s_waitcnt lgkmcnt(4)
    v_mfma_f32_32x32x16_bf16 v[96:111], v[184:187], v[224:227], v[96:111]
    ds_read_b128 v[252:255], v33 offset:12288
    s_waitcnt lgkmcnt(4)
    v_mfma_f32_32x32x16_bf16 v[112:127], v[184:187], v[228:231], v[112:127]
    ds_read_b128 v[224:227], v34 offset:8192
    s_waitcnt vmcnt(8)
    s_waitcnt lgkmcnt(4)
    v_mfma_f32_32x32x16_bf16 v[96:111], v[188:191], v[240:243], v[96:111]
    ds_read_b128 v[228:231], v34 offset:12288
    s_waitcnt lgkmcnt(4)
    v_mfma_f32_32x32x16_bf16 v[112:127], v[188:191], v[244:247], v[112:127]
    ds_read_b128 v[240:243], v35 offset:8192
    v_mfma_f32_32x32x16_bf16 v[128:143], v[160:163], v[232:235], v[128:143]
    ds_read_b128 v[244:247], v35 offset:12288
    v_mfma_f32_32x32x16_bf16 v[144:159], v[160:163], v[236:239], v[144:159]
    s_waitcnt lgkmcnt(5)
    v_mfma_f32_32x32x16_bf16 v[128:143], v[164:167], v[248:251], v[128:143]
    s_waitcnt lgkmcnt(4)
    v_mfma_f32_32x32x16_bf16 v[144:159], v[164:167], v[252:255], v[144:159]
    s_barrier
    ds_read_b128 v[232:235], v32 offset:32768
    ds_read_b128 v[236:239], v32 offset:36864
    ds_read_b128 v[248:251], v33 offset:32768
    s_waitcnt lgkmcnt(6)
    v_mfma_f32_32x32x16_bf16 v[128:143], v[168:171], v[224:227], v[128:143]
    ds_read_b128 v[252:255], v33 offset:36864
    s_waitcnt lgkmcnt(6)
    v_mfma_f32_32x32x16_bf16 v[144:159], v[168:171], v[228:231], v[144:159]
    ds_read_b128 v[224:227], v34 offset:32768
    s_waitcnt lgkmcnt(6)
    v_mfma_f32_32x32x16_bf16 v[128:143], v[172:175], v[240:243], v[128:143]
    ds_read_b128 v[228:231], v34 offset:36864
    s_waitcnt lgkmcnt(6)
    v_mfma_f32_32x32x16_bf16 v[144:159], v[172:175], v[244:247], v[144:159]
    ds_read_b128 v[240:243], v35 offset:32768
    s_waitcnt vmcnt(7)
    s_waitcnt lgkmcnt(6)
    v_mfma_f32_32x32x16_bf16 v[96:111], v[192:195], v[232:235], v[96:111]
    ds_read_b128 v[244:247], v35 offset:36864
    s_waitcnt lgkmcnt(6)
    v_mfma_f32_32x32x16_bf16 v[112:127], v[192:195], v[236:239], v[112:127]
    s_waitcnt vmcnt(6)
    s_waitcnt lgkmcnt(5)
    v_mfma_f32_32x32x16_bf16 v[96:111], v[196:199], v[248:251], v[96:111]
    s_waitcnt lgkmcnt(4)
    v_mfma_f32_32x32x16_bf16 v[112:127], v[196:199], v[252:255], v[112:127]
    s_barrier
    ds_read_b128 v[232:235], v32 offset:49152
    ds_read_b128 v[236:239], v32 offset:53248
    ds_read_b128 v[248:251], v33 offset:49152
    s_waitcnt vmcnt(5)
    s_waitcnt lgkmcnt(6)
    v_mfma_f32_32x32x16_bf16 v[96:111], v[200:203], v[224:227], v[96:111]
    ds_read_b128 v[252:255], v33 offset:53248
    s_waitcnt lgkmcnt(6)
    v_mfma_f32_32x32x16_bf16 v[112:127], v[200:203], v[228:231], v[112:127]
    ds_read_b128 v[224:227], v34 offset:49152
    s_waitcnt vmcnt(4)
    s_waitcnt lgkmcnt(6)
    v_mfma_f32_32x32x16_bf16 v[96:111], v[204:207], v[240:243], v[96:111]
    ds_read_b128 v[228:231], v34 offset:53248
    s_waitcnt lgkmcnt(6)
    v_mfma_f32_32x32x16_bf16 v[112:127], v[204:207], v[244:247], v[112:127]
    ds_read_b128 v[240:243], v35 offset:49152
    s_waitcnt vmcnt(3)
    s_waitcnt lgkmcnt(6)
    v_mfma_f32_32x32x16_bf16 v[96:111], v[208:211], v[232:235], v[96:111]
    ds_read_b128 v[244:247], v35 offset:53248
    s_waitcnt lgkmcnt(6)
    v_mfma_f32_32x32x16_bf16 v[112:127], v[208:211], v[236:239], v[112:127]
    ds_read_b128 v[232:235], v32 offset:24576
    s_waitcnt vmcnt(2)
    s_waitcnt lgkmcnt(6)
    v_mfma_f32_32x32x16_bf16 v[96:111], v[212:215], v[248:251], v[96:111]
    ds_read_b128 v[236:239], v32 offset:28672
    s_waitcnt lgkmcnt(6)
    v_mfma_f32_32x32x16_bf16 v[112:127], v[212:215], v[252:255], v[112:127]
    ds_read_b128 v[248:251], v33 offset:24576
    s_waitcnt vmcnt(1)
    s_waitcnt lgkmcnt(6)
    v_mfma_f32_32x32x16_bf16 v[96:111], v[216:219], v[224:227], v[96:111]
    ds_read_b128 v[252:255], v33 offset:28672
    s_waitcnt lgkmcnt(6)
    v_mfma_f32_32x32x16_bf16 v[112:127], v[216:219], v[228:231], v[112:127]
    ds_read_b128 v[224:227], v34 offset:24576
    s_waitcnt vmcnt(0)
    s_waitcnt lgkmcnt(6)
    v_mfma_f32_32x32x16_bf16 v[96:111], v[220:223], v[240:243], v[96:111]
    ds_read_b128 v[228:231], v34 offset:28672
    s_waitcnt lgkmcnt(6)
    v_mfma_f32_32x32x16_bf16 v[112:127], v[220:223], v[244:247], v[112:127]
    ds_read_b128 v[240:243], v35 offset:24576
    s_waitcnt lgkmcnt(6)
    v_mfma_f32_32x32x16_bf16 v[128:143], v[176:179], v[232:235], v[128:143]
    ds_read_b128 v[244:247], v35 offset:28672
    s_waitcnt lgkmcnt(6)
    v_mfma_f32_32x32x16_bf16 v[144:159], v[176:179], v[236:239], v[144:159]
    ds_read_b128 v[232:235], v32 offset:40960
    s_waitcnt lgkmcnt(6)
    v_mfma_f32_32x32x16_bf16 v[128:143], v[180:183], v[248:251], v[128:143]
    ds_read_b128 v[236:239], v32 offset:45056
    v_cvt_pk_bf16_f32 v96, v96, v97
    v_cvt_pk_bf16_f32 v97, v98, v99
    v_cvt_pk_bf16_f32 v98, v100, v101
    v_cvt_pk_bf16_f32 v99, v102, v103
    buffer_store_dwordx4 v[96:99], v28, s[92:95], s74 offen offset:0 sc1
    s_waitcnt lgkmcnt(6)
    v_mfma_f32_32x32x16_bf16 v[144:159], v[180:183], v[252:255], v[144:159]
    ds_read_b128 v[248:251], v33 offset:40960
    v_cvt_pk_bf16_f32 v100, v104, v105
    v_cvt_pk_bf16_f32 v101, v106, v107
    v_cvt_pk_bf16_f32 v102, v108, v109
    v_cvt_pk_bf16_f32 v103, v110, v111
    buffer_store_dwordx4 v[100:103], v28, s[92:95], s74 offen offset:1024 sc1
    s_waitcnt lgkmcnt(6)
    v_mfma_f32_32x32x16_bf16 v[128:143], v[184:187], v[224:227], v[128:143]
    ds_read_b128 v[252:255], v33 offset:45056
    v_cvt_pk_bf16_f32 v104, v112, v113
    v_cvt_pk_bf16_f32 v105, v114, v115
    v_cvt_pk_bf16_f32 v106, v116, v117
    v_cvt_pk_bf16_f32 v107, v118, v119
    buffer_store_dwordx4 v[104:107], v28, s[92:95], s74 offen offset:2048 sc1
    s_waitcnt lgkmcnt(6)
    v_mfma_f32_32x32x16_bf16 v[144:159], v[184:187], v[228:231], v[144:159]
    ds_read_b128 v[224:227], v34 offset:40960
    v_cvt_pk_bf16_f32 v108, v120, v121
    v_cvt_pk_bf16_f32 v109, v122, v123
    v_cvt_pk_bf16_f32 v110, v124, v125
    v_cvt_pk_bf16_f32 v111, v126, v127
    buffer_store_dwordx4 v[108:111], v28, s[92:95], s74 offen offset:3072 sc1
    s_waitcnt lgkmcnt(6)
    v_mfma_f32_32x32x16_bf16 v[128:143], v[188:191], v[240:243], v[128:143]
    ds_read_b128 v[228:231], v34 offset:45056
    s_waitcnt lgkmcnt(6)
    v_mfma_f32_32x32x16_bf16 v[144:159], v[188:191], v[244:247], v[144:159]
    ds_read_b128 v[240:243], v35 offset:40960
    s_waitcnt lgkmcnt(6)
    v_mfma_f32_32x32x16_bf16 v[128:143], v[192:195], v[232:235], v[128:143]
    ds_read_b128 v[244:247], v35 offset:45056
    s_waitcnt lgkmcnt(6)
    v_mfma_f32_32x32x16_bf16 v[144:159], v[192:195], v[236:239], v[144:159]
    ds_read_b128 v[232:235], v32 offset:57344
    s_waitcnt lgkmcnt(6)
    v_mfma_f32_32x32x16_bf16 v[128:143], v[196:199], v[248:251], v[128:143]
    ds_read_b128 v[236:239], v32 offset:61440
    s_waitcnt lgkmcnt(6)
    v_mfma_f32_32x32x16_bf16 v[144:159], v[196:199], v[252:255], v[144:159]
    ds_read_b128 v[248:251], v33 offset:57344
    s_waitcnt lgkmcnt(6)
    v_mfma_f32_32x32x16_bf16 v[128:143], v[200:203], v[224:227], v[128:143]
    ds_read_b128 v[252:255], v33 offset:61440
    s_waitcnt lgkmcnt(6)
    v_mfma_f32_32x32x16_bf16 v[144:159], v[200:203], v[228:231], v[144:159]
    ds_read_b128 v[224:227], v34 offset:57344
    s_waitcnt lgkmcnt(6)
    v_mfma_f32_32x32x16_bf16 v[128:143], v[204:207], v[240:243], v[128:143]
    ds_read_b128 v[228:231], v34 offset:61440
    s_waitcnt lgkmcnt(6)
    v_mfma_f32_32x32x16_bf16 v[144:159], v[204:207], v[244:247], v[144:159]
    ds_read_b128 v[240:243], v35 offset:57344
    s_waitcnt lgkmcnt(6)
    v_mfma_f32_32x32x16_bf16 v[128:143], v[208:211], v[232:235], v[128:143]
    ds_read_b128 v[244:247], v35 offset:61440
    s_waitcnt lgkmcnt(6)
    v_mfma_f32_32x32x16_bf16 v[144:159], v[208:211], v[236:239], v[144:159]
    s_waitcnt lgkmcnt(5)
    v_mfma_f32_32x32x16_bf16 v[128:143], v[212:215], v[248:251], v[128:143]
    s_waitcnt lgkmcnt(4)
    v_mfma_f32_32x32x16_bf16 v[144:159], v[212:215], v[252:255], v[144:159]
    s_waitcnt lgkmcnt(3)
    v_mfma_f32_32x32x16_bf16 v[128:143], v[216:219], v[224:227], v[128:143]
    s_waitcnt lgkmcnt(2)
    v_mfma_f32_32x32x16_bf16 v[144:159], v[216:219], v[228:231], v[144:159]
    s_waitcnt lgkmcnt(1)
    v_mfma_f32_32x32x16_bf16 v[128:143], v[220:223], v[240:243], v[128:143]
    s_waitcnt lgkmcnt(0)
    v_mfma_f32_32x32x16_bf16 v[144:159], v[220:223], v[244:247], v[144:159]
    s_mov_b32 s12, 0xffff0000
    ds_read_b128 v[160:163], v21 offset:0
    ds_read_b128 v[164:167], v21 offset:16
    ds_read_b128 v[168:171], v21 offset:8704
    ds_read_b128 v[172:175], v21 offset:8720
    v_lshlrev_b32 v192, 16, v36
    v_and_b32 v176, s12, v36
    v_lshlrev_b32 v193, 16, v37
    v_and_b32 v177, s12, v37
    v_lshlrev_b32 v194, 16, v38
    v_and_b32 v178, s12, v38
    v_lshlrev_b32 v195, 16, v39
    v_and_b32 v179, s12, v39
    v_lshlrev_b32 v196, 16, v40
    v_and_b32 v180, s12, v40
    v_lshlrev_b32 v197, 16, v41
    v_and_b32 v181, s12, v41
    v_lshlrev_b32 v198, 16, v42
    v_and_b32 v182, s12, v42
    v_lshlrev_b32 v199, 16, v43
    v_and_b32 v183, s12, v43
    v_lshlrev_b32 v200, 16, v44
    v_and_b32 v184, s12, v44
    v_lshlrev_b32 v201, 16, v45
    v_and_b32 v185, s12, v45
    v_lshlrev_b32 v202, 16, v46
    v_and_b32 v186, s12, v46
    v_lshlrev_b32 v203, 16, v47
    v_and_b32 v187, s12, v47
    v_lshlrev_b32 v204, 16, v48
    v_and_b32 v188, s12, v48
    v_lshlrev_b32 v205, 16, v49
    v_and_b32 v189, s12, v49
    v_lshlrev_b32 v206, 16, v50
    v_and_b32 v190, s12, v50
    v_lshlrev_b32 v207, 16, v51
    v_and_b32 v191, s12, v51
    s_waitcnt lgkmcnt(0)
    s_lshl_b32 s90, s72, 6
    s_add_u32 s91, s90, 4096
    v_lshlrev_b32 v208, 16, v160
    v_lshlrev_b32 v214, 16, v161
    v_lshlrev_b32 v220, 16, v162
    v_lshlrev_b32 v226, 16, v163
    v_and_b32 v209, s12, v160
    v_and_b32 v215, s12, v161
    v_and_b32 v221, s12, v162
    v_and_b32 v227, s12, v163
    v_lshlrev_b32 v210, 16, v73
    v_lshlrev_b32 v216, 16, v74
    v_lshlrev_b32 v222, 16, v75
    v_lshlrev_b32 v228, 16, v76
    v_and_b32 v211, s12, v73
    v_and_b32 v217, s12, v74
    v_and_b32 v223, s12, v75
    v_and_b32 v229, s12, v76
    v_mul_f32 v208, v210, v208
    v_mul_f32 v214, v216, v214
    v_mul_f32 v220, v222, v220
    v_mul_f32 v226, v228, v226
    v_mul_f32 v209, v211, v209
    v_mul_f32 v215, v217, v215
    v_mul_f32 v221, v223, v221
    v_mul_f32 v227, v229, v227
    v_lshlrev_b32 v210, 16, v89
    v_lshlrev_b32 v216, 16, v90
    v_lshlrev_b32 v222, 16, v91
    v_lshlrev_b32 v228, 16, v92
    v_and_b32 v211, s12, v89
    v_and_b32 v217, s12, v90
    v_and_b32 v223, s12, v91
    v_and_b32 v229, s12, v92
    v_cvt_pk_bf16_f32 v212, v208, v209
    v_cvt_pk_bf16_f32 v218, v214, v215
    v_cvt_pk_bf16_f32 v224, v220, v221
    v_cvt_pk_bf16_f32 v230, v226, v227
    v_add_f32 v128, v128, v210
    v_add_f32 v130, v130, v216
    v_add_f32 v132, v132, v222
    v_add_f32 v134, v134, v228
    v_add_f32 v129, v129, v211
    v_add_f32 v131, v131, v217
    v_add_f32 v133, v133, v223
    v_add_f32 v135, v135, v229
    v_lshlrev_b32 v208, 16, v212
    v_lshlrev_b32 v214, 16, v218
    v_lshlrev_b32 v220, 16, v224
    v_lshlrev_b32 v226, 16, v230
    v_and_b32 v209, s12, v212
    v_and_b32 v215, s12, v218
    v_and_b32 v221, s12, v224
    v_and_b32 v227, s12, v230
    v_mul_f32 v208, v208, v176
    v_mul_f32 v214, v214, v178
    v_mul_f32 v220, v220, v180
    v_mul_f32 v226, v226, v182
    v_mul_f32 v209, v209, v177
    v_mul_f32 v215, v215, v179
    v_mul_f32 v221, v221, v181
    v_mul_f32 v227, v227, v183
    v_cvt_pk_bf16_f32 v212, v208, v209
    v_cvt_pk_bf16_f32 v218, v214, v215
    v_cvt_pk_bf16_f32 v224, v220, v221
    v_cvt_pk_bf16_f32 v230, v226, v227
    v_lshlrev_b32 v208, 16, v212
    v_lshlrev_b32 v214, 16, v218
    v_lshlrev_b32 v220, 16, v224
    v_lshlrev_b32 v226, 16, v230
    v_and_b32 v209, s12, v212
    v_and_b32 v215, s12, v218
    v_and_b32 v221, s12, v224
    v_and_b32 v227, s12, v230
    v_fma_f32 v128, v128, v192, v208
    v_fma_f32 v130, v130, v194, v214
    v_fma_f32 v132, v132, v196, v220
    v_fma_f32 v134, v134, v198, v226
    v_fma_f32 v129, v129, v193, v209
    v_fma_f32 v131, v131, v195, v215
    v_fma_f32 v133, v133, v197, v221
    v_fma_f32 v135, v135, v199, v227
    v_lshlrev_b32 v208, 16, v164
    v_lshlrev_b32 v214, 16, v165
    v_lshlrev_b32 v220, 16, v166
    v_lshlrev_b32 v226, 16, v167
    v_and_b32 v209, s12, v164
    v_and_b32 v215, s12, v165
    v_and_b32 v221, s12, v166
    v_and_b32 v227, s12, v167
    v_lshlrev_b32 v210, 16, v77
    v_lshlrev_b32 v216, 16, v78
    v_lshlrev_b32 v222, 16, v79
    v_lshlrev_b32 v228, 16, v80
    v_and_b32 v211, s12, v77
    v_and_b32 v217, s12, v78
    v_and_b32 v223, s12, v79
    v_and_b32 v229, s12, v80
    v_mul_f32 v208, v210, v208
    v_mul_f32 v214, v216, v214
    v_mul_f32 v220, v222, v220
    v_mul_f32 v226, v228, v226
    v_mul_f32 v209, v211, v209
    v_mul_f32 v215, v217, v215
    v_mul_f32 v221, v223, v221
    v_mul_f32 v227, v229, v227
    v_lshlrev_b32 v210, 16, v93
    v_lshlrev_b32 v216, 16, v94
    v_lshlrev_b32 v222, 16, v95
    v_lshlrev_b32 v228, 16, v54
    v_and_b32 v211, s12, v93
    v_and_b32 v217, s12, v94
    v_and_b32 v223, s12, v95
    v_and_b32 v229, s12, v54
    v_cvt_pk_bf16_f32 v212, v208, v209
    v_cvt_pk_bf16_f32 v218, v214, v215
    v_cvt_pk_bf16_f32 v224, v220, v221
    v_cvt_pk_bf16_f32 v230, v226, v227
    v_add_f32 v136, v136, v210
    v_add_f32 v138, v138, v216
    v_add_f32 v140, v140, v222
    v_add_f32 v142, v142, v228
    v_add_f32 v137, v137, v211
    v_add_f32 v139, v139, v217
    v_add_f32 v141, v141, v223
    v_add_f32 v143, v143, v229
    v_lshlrev_b32 v208, 16, v212
    v_lshlrev_b32 v214, 16, v218
    v_lshlrev_b32 v220, 16, v224
    v_lshlrev_b32 v226, 16, v230
    v_and_b32 v209, s12, v212
    v_and_b32 v215, s12, v218
    v_and_b32 v221, s12, v224
    v_and_b32 v227, s12, v230
    v_mul_f32 v208, v208, v184
    v_mul_f32 v214, v214, v186
    v_mul_f32 v220, v220, v188
    v_mul_f32 v226, v226, v190
    v_mul_f32 v209, v209, v185
    v_mul_f32 v215, v215, v187
    v_mul_f32 v221, v221, v189
    v_mul_f32 v227, v227, v191
    v_cvt_pk_bf16_f32 v212, v208, v209
    v_cvt_pk_bf16_f32 v218, v214, v215
    v_cvt_pk_bf16_f32 v224, v220, v221
    v_cvt_pk_bf16_f32 v230, v226, v227
    v_lshlrev_b32 v208, 16, v212
    v_lshlrev_b32 v214, 16, v218
    v_lshlrev_b32 v220, 16, v224
    v_lshlrev_b32 v226, 16, v230
    v_and_b32 v209, s12, v212
    v_and_b32 v215, s12, v218
    v_and_b32 v221, s12, v224
    v_and_b32 v227, s12, v230
    v_fma_f32 v136, v136, v200, v208
    v_fma_f32 v138, v138, v202, v214
    v_fma_f32 v140, v140, v204, v220
    v_fma_f32 v142, v142, v206, v226
    v_fma_f32 v137, v137, v201, v209
    v_fma_f32 v139, v139, v203, v215
    v_fma_f32 v141, v141, v205, v221
    v_fma_f32 v143, v143, v207, v227
    buffer_load_dwordx4 v[96:99], v28, s[92:95], s90 offen offset:0 sc1
    buffer_load_dwordx4 v[100:103], v28, s[92:95], s90 offen offset:1024 sc1
    buffer_load_dwordx4 v[104:107], v28, s[92:95], s90 offen offset:2048 sc1
    buffer_load_dwordx4 v[108:111], v28, s[92:95], s90 offen offset:3072 sc1
    v_lshlrev_b32 v208, 16, v168
    v_lshlrev_b32 v214, 16, v169
    v_lshlrev_b32 v220, 16, v170
    v_lshlrev_b32 v226, 16, v171
    v_and_b32 v209, s12, v168
    v_and_b32 v215, s12, v169
    v_and_b32 v221, s12, v170
    v_and_b32 v227, s12, v171
    v_lshlrev_b32 v210, 16, v81
    v_lshlrev_b32 v216, 16, v82
    v_lshlrev_b32 v222, 16, v83
    v_lshlrev_b32 v228, 16, v84
    v_and_b32 v211, s12, v81
    v_and_b32 v217, s12, v82
    v_and_b32 v223, s12, v83
    v_and_b32 v229, s12, v84
    v_mul_f32 v208, v210, v208
    v_mul_f32 v214, v216, v214
    v_mul_f32 v220, v222, v220
    v_mul_f32 v226, v228, v226
    v_mul_f32 v209, v211, v209
    v_mul_f32 v215, v217, v215
    v_mul_f32 v221, v223, v221
    v_mul_f32 v227, v229, v227
    v_lshlrev_b32 v210, 16, v55
    v_lshlrev_b32 v216, 16, v56
    v_lshlrev_b32 v222, 16, v57
    v_lshlrev_b32 v228, 16, v58
    v_and_b32 v211, s12, v55
    v_and_b32 v217, s12, v56
    v_and_b32 v223, s12, v57
    v_and_b32 v229, s12, v58
    v_cvt_pk_bf16_f32 v212, v208, v209
    v_cvt_pk_bf16_f32 v218, v214, v215
    v_cvt_pk_bf16_f32 v224, v220, v221
    v_cvt_pk_bf16_f32 v230, v226, v227
    v_add_f32 v144, v144, v210
    v_add_f32 v146, v146, v216
    v_add_f32 v148, v148, v222
    v_add_f32 v150, v150, v228
    v_add_f32 v145, v145, v211
    v_add_f32 v147, v147, v217
    v_add_f32 v149, v149, v223
    v_add_f32 v151, v151, v229
    v_lshlrev_b32 v208, 16, v212
    v_lshlrev_b32 v214, 16, v218
    v_lshlrev_b32 v220, 16, v224
    v_lshlrev_b32 v226, 16, v230
    v_and_b32 v209, s12, v212
    v_and_b32 v215, s12, v218
    v_and_b32 v221, s12, v224
    v_and_b32 v227, s12, v230
    v_mul_f32 v208, v208, v176
    v_mul_f32 v214, v214, v178
    v_mul_f32 v220, v220, v180
    v_mul_f32 v226, v226, v182
    v_mul_f32 v209, v209, v177
    v_mul_f32 v215, v215, v179
    v_mul_f32 v221, v221, v181
    v_mul_f32 v227, v227, v183
    v_cvt_pk_bf16_f32 v212, v208, v209
    v_cvt_pk_bf16_f32 v218, v214, v215
    v_cvt_pk_bf16_f32 v224, v220, v221
    v_cvt_pk_bf16_f32 v230, v226, v227
    v_lshlrev_b32 v208, 16, v212
    v_lshlrev_b32 v214, 16, v218
    v_lshlrev_b32 v220, 16, v224
    v_lshlrev_b32 v226, 16, v230
    v_and_b32 v209, s12, v212
    v_and_b32 v215, s12, v218
    v_and_b32 v221, s12, v224
    v_and_b32 v227, s12, v230
    v_fma_f32 v144, v144, v192, v208
    v_fma_f32 v146, v146, v194, v214
    v_fma_f32 v148, v148, v196, v220
    v_fma_f32 v150, v150, v198, v226
    v_fma_f32 v145, v145, v193, v209
    v_fma_f32 v147, v147, v195, v215
    v_fma_f32 v149, v149, v197, v221
    v_fma_f32 v151, v151, v199, v227
    v_lshlrev_b32 v208, 16, v172
    v_lshlrev_b32 v214, 16, v173
    v_lshlrev_b32 v220, 16, v174
    v_lshlrev_b32 v226, 16, v175
    v_and_b32 v209, s12, v172
    v_and_b32 v215, s12, v173
    v_and_b32 v221, s12, v174
    v_and_b32 v227, s12, v175
    v_lshlrev_b32 v210, 16, v85
    v_lshlrev_b32 v216, 16, v86
    v_lshlrev_b32 v222, 16, v87
    v_lshlrev_b32 v228, 16, v88
    v_and_b32 v211, s12, v85
    v_and_b32 v217, s12, v86
    v_and_b32 v223, s12, v87
    v_and_b32 v229, s12, v88
    v_mul_f32 v208, v210, v208
    v_mul_f32 v214, v216, v214
    v_mul_f32 v220, v222, v220
    v_mul_f32 v226, v228, v226
    v_mul_f32 v209, v211, v209
    v_mul_f32 v215, v217, v215
    v_mul_f32 v221, v223, v221
    v_mul_f32 v227, v229, v227
    v_lshlrev_b32 v210, 16, v59
    v_lshlrev_b32 v216, 16, v61
    v_lshlrev_b32 v222, 16, v5
    v_lshlrev_b32 v228, 16, v12
    v_and_b32 v211, s12, v59
    v_and_b32 v217, s12, v61
    v_and_b32 v223, s12, v5
    v_and_b32 v229, s12, v12
    v_cvt_pk_bf16_f32 v212, v208, v209
    v_cvt_pk_bf16_f32 v218, v214, v215
    v_cvt_pk_bf16_f32 v224, v220, v221
    v_cvt_pk_bf16_f32 v230, v226, v227
    v_add_f32 v152, v152, v210
    v_add_f32 v154, v154, v216
    v_add_f32 v156, v156, v222
    v_add_f32 v158, v158, v228
    v_add_f32 v153, v153, v211
    v_add_f32 v155, v155, v217
    v_add_f32 v157, v157, v223
    v_add_f32 v159, v159, v229
    v_lshlrev_b32 v208, 16, v212
    v_lshlrev_b32 v214, 16, v218
    v_lshlrev_b32 v220, 16, v224
    v_lshlrev_b32 v226, 16, v230
    v_and_b32 v209, s12, v212
    v_and_b32 v215, s12, v218
    v_and_b32 v221, s12, v224
    v_and_b32 v227, s12, v230
    v_mul_f32 v208, v208, v184
    v_mul_f32 v214, v214, v186
    v_mul_f32 v220, v220, v188
    v_mul_f32 v226, v226, v190
    v_mul_f32 v209, v209, v185
    v_mul_f32 v215, v215, v187
    v_mul_f32 v221, v221, v189
    v_mul_f32 v227, v227, v191
    v_cvt_pk_bf16_f32 v212, v208, v209
    v_cvt_pk_bf16_f32 v218, v214, v215
    v_cvt_pk_bf16_f32 v224, v220, v221
    v_cvt_pk_bf16_f32 v230, v226, v227
    v_lshlrev_b32 v208, 16, v212
    v_lshlrev_b32 v214, 16, v218
    v_lshlrev_b32 v220, 16, v224
    v_lshlrev_b32 v226, 16, v230
    v_and_b32 v209, s12, v212
    v_and_b32 v215, s12, v218
    v_and_b32 v221, s12, v224
    v_and_b32 v227, s12, v230
    v_fma_f32 v152, v152, v200, v208
    v_fma_f32 v154, v154, v202, v214
    v_fma_f32 v156, v156, v204, v220
    v_fma_f32 v158, v158, v206, v226
    v_fma_f32 v153, v153, v201, v209
    v_fma_f32 v155, v155, v203, v215
    v_fma_f32 v157, v157, v205, v221
    v_fma_f32 v159, v159, v207, v227
    s_mov_b32 s89, 65536
c_rc:
    s_waitcnt vmcnt(0)
    v_max3_u32 v19, v96, v97, v98
    v_max3_u32 v19, v19, v99, v100
    v_max3_u32 v19, v19, v101, v102
    v_max3_u32 v19, v19, v103, v104
    v_max3_u32 v19, v19, v105, v106
    v_max3_u32 v19, v19, v107, v108
    v_max3_u32 v19, v19, v109, v110
    v_max_u32 v19, v19, v111
    v_cmp_eq_u32 vcc, -1, v19
    s_nop 1
    s_cmp_eq_u64 vcc, 0
    s_cbranch_scc1 c_rcok
    s_sub_u32 s89, s89, 1
    s_cbranch_scc1 c_rcok
    buffer_load_dwordx4 v[96:99], v28, s[92:95], s90 offen offset:0 sc1
    buffer_load_dwordx4 v[100:103], v28, s[92:95], s90 offen offset:1024 sc1
    buffer_load_dwordx4 v[104:107], v28, s[92:95], s90 offen offset:2048 sc1
    buffer_load_dwordx4 v[108:111], v28, s[92:95], s90 offen offset:3072 sc1
    s_branch c_rc
c_rcok:
    v_lshlrev_b32 v208, 16, v96
    v_fma_f32 v128, v208, v192, v128
    buffer_store_dword v128, v26, s[76:79], s80 offen offset:0 nt
    v_and_b32 v209, s12, v96
    v_fma_f32 v129, v209, v193, v129
    buffer_store_dword v129, v26, s[76:79], s81 offen offset:0 nt
    v_lshlrev_b32 v210, 16, v97
    v_fma_f32 v130, v210, v194, v130
    buffer_store_dword v130, v26, s[76:79], s82 offen offset:0 nt
    v_and_b32 v211, s12, v97
    v_fma_f32 v131, v211, v195, v131
    buffer_store_dword v131, v26, s[76:79], s83 offen offset:0 nt
    v_lshlrev_b32 v208, 16, v98
    v_fma_f32 v132, v208, v196, v132
    buffer_store_dword v132, v26, s[76:79], s84 offen offset:0 nt
    v_and_b32 v209, s12, v98
    v_fma_f32 v133, v209, v197, v133
    buffer_store_dword v133, v26, s[76:79], s85 offen offset:0 nt
    v_lshlrev_b32 v210, 16, v99
    v_fma_f32 v134, v210, v198, v134
    buffer_store_dword v134, v26, s[76:79], s86 offen offset:0 nt
    v_and_b32 v211, s12, v99
    v_fma_f32 v135, v211, v199, v135
    buffer_store_dword v135, v26, s[76:79], s87 offen offset:0 nt
    v_lshlrev_b32 v208, 16, v100
    v_fma_f32 v136, v208, v200, v136
    buffer_store_dword v136, v27, s[76:79], s80 offen offset:0 nt
    v_and_b32 v209, s12, v100
    v_fma_f32 v137, v209, v201, v137
    buffer_store_dword v137, v27, s[76:79], s81 offen offset:0 nt
    v_lshlrev_b32 v210, 16, v101
    v_fma_f32 v138, v210, v202, v138
    buffer_store_dword v138, v27, s[76:79], s82 offen offset:0 nt
    v_and_b32 v211, s12, v101
    v_fma_f32 v139, v211, v203, v139
    buffer_store_dword v139, v27, s[76:79], s83 offen offset:0 nt
    v_lshlrev_b32 v208, 16, v102
    v_fma_f32 v140, v208, v204, v140
    buffer_store_dword v140, v27, s[76:79], s84 offen offset:0 nt
    v_and_b32 v209, s12, v102
    v_fma_f32 v141, v209, v205, v141
    buffer_store_dword v141, v27, s[76:79], s85 offen offset:0 nt
    v_lshlrev_b32 v210, 16, v103
    v_fma_f32 v142, v210, v206, v142
    buffer_store_dword v142, v27, s[76:79], s86 offen offset:0 nt
    v_and_b32 v211, s12, v103
    v_fma_f32 v143, v211, v207, v143
    buffer_store_dword v143, v27, s[76:79], s87 offen offset:0 nt
    v_lshlrev_b32 v208, 16, v104
    v_fma_f32 v144, v208, v192, v144
    buffer_store_dword v144, v26, s[76:79], s80 offen offset:128 nt
    v_and_b32 v209, s12, v104
    v_fma_f32 v145, v209, v193, v145
    buffer_store_dword v145, v26, s[76:79], s81 offen offset:128 nt
    v_lshlrev_b32 v210, 16, v105
    v_fma_f32 v146, v210, v194, v146
    buffer_store_dword v146, v26, s[76:79], s82 offen offset:128 nt
    v_and_b32 v211, s12, v105
    v_fma_f32 v147, v211, v195, v147
    buffer_store_dword v147, v26, s[76:79], s83 offen offset:128 nt
    v_lshlrev_b32 v208, 16, v106
    v_fma_f32 v148, v208, v196, v148
    buffer_store_dword v148, v26, s[76:79], s84 offen offset:128 nt
    v_and_b32 v209, s12, v106
    v_fma_f32 v149, v209, v197, v149
    buffer_store_dword v149, v26, s[76:79], s85 offen offset:128 nt
    v_lshlrev_b32 v210, 16, v107
    v_fma_f32 v150, v210, v198, v150
    buffer_store_dword v150, v26, s[76:79], s86 offen offset:128 nt
    v_and_b32 v211, s12, v107
    v_fma_f32 v151, v211, v199, v151
    buffer_store_dword v151, v26, s[76:79], s87 offen offset:128 nt
    v_lshlrev_b32 v208, 16, v108
    v_fma_f32 v152, v208, v200, v152
    buffer_store_dword v152, v27, s[76:79], s80 offen offset:128 nt
    v_and_b32 v209, s12, v108
    v_fma_f32 v153, v209, v201, v153
    buffer_store_dword v153, v27, s[76:79], s81 offen offset:128 nt
    v_lshlrev_b32 v210, 16, v109
    v_fma_f32 v154, v210, v202, v154
    buffer_store_dword v154, v27, s[76:79], s82 offen offset:128 nt
    v_and_b32 v211, s12, v109
    v_fma_f32 v155, v211, v203, v155
    buffer_store_dword v155, v27, s[76:79], s83 offen offset:128 nt
    v_lshlrev_b32 v208, 16, v110
    v_fma_f32 v156, v208, v204, v156
    buffer_store_dword v156, v27, s[76:79], s84 offen offset:128 nt
    v_and_b32 v209, s12, v110
    v_fma_f32 v157, v209, v205, v157
    buffer_store_dword v157, v27, s[76:79], s85 offen offset:128 nt
    v_lshlrev_b32 v210, 16, v111
    v_fma_f32 v158, v210, v206, v158
    buffer_store_dword v158, v27, s[76:79], s86 offen offset:128 nt
    v_and_b32 v211, s12, v111
    v_fma_f32 v159, v211, v207, v159
    buffer_store_dword v159, v27, s[76:79], s87 offen offset:128 nt
    s_endpgm
c_pfs:
    s_mov_b32 s89, 65536
c_pfs_l:
    s_waitcnt vmcnt(0)
    buffer_load_dword v14, v29, s[68:71], 0 offen sc1
    s_waitcnt vmcnt(0)
    v_cmp_ne_u32 vcc, 1, v14
    s_nop 1
    s_cmp_eq_u64 vcc, 0
    s_cbranch_scc1 c_pfr
    s_sub_u32 s89, s89, 1
    s_cbranch_scc1 c_pfr
    s_branch c_pfs_l
c_n0_s:
    s_mov_b32 s89, 65536
c_n0_l:
    s_waitcnt vmcnt(0)
    buffer_load_dword v19, v22, s[68:71], 0 offen sc1
    s_waitcnt vmcnt(0)
    v_cmp_eq_u32 s[90:91], 1, v19
    s_nop 1
    s_and_b32 s88, s90, 0xc
    s_cmp_eq_u32 s88, 0xc
    s_cbranch_scc1 c_n0
    s_sub_u32 s89, s89, 1
    s_cbranch_scc1 c_n0
    s_branch c_n0_l
c_n1_s:
    s_mov_b32 s89, 65536
c_n1_l:
    s_waitcnt vmcnt(0)
    buffer_load_dword v19, v22, s[68:71], 0 offen sc1
    s_waitcnt vmcnt(0)
    v_cmp_eq_u32 s[90:91], 1, v19
    s_nop 1
    s_and_b32 s88, s90, 0x3c
    s_cmp_eq_u32 s88, 0x3c
    s_cbranch_scc1 c_n1
    s_sub_u32 s89, s89, 1
    s_cbranch_scc1 c_n1
    s_branch c_n1_l
c_n2_s:
    s_mov_b32 s89, 65536
c_n2_l:
    s_waitcnt vmcnt(0)
    buffer_load_dword v19, v22, s[68:71], 0 offen sc1
    s_waitcnt vmcnt(0)
    v_cmp_eq_u32 s[90:91], 1, v19
    s_nop 1
    s_and_b32 s88, s90, 0xfc
    s_cmp_eq_u32 s88, 0xfc
    s_cbranch_scc1 c_n2
    s_sub_u32 s89, s89, 1
    s_cbranch_scc1 c_n2
    s_branch c_n2_l
c_n3_s:
    s_mov_b32 s89, 65536
c_n3_l:
    s_waitcnt vmcnt(0)
    buffer_load_dword v19, v22, s[68:71], 0 offen sc1
    s_waitcnt vmcnt(0)
    v_cmp_eq_u32 s[90:91], 1, v19
    s_nop 1
    s_and_b32 s88, s90, 0x3fc
    s_cmp_eq_u32 s88, 0x3fc
    s_cbranch_scc1 c_n3
    s_sub_u32 s89, s89, 1
    s_cbranch_scc1 c_n3
    s_branch c_n3_l
c_n4_s:
    s_mov_b32 s89, 65536
c_n4_l:
    s_waitcnt vmcnt(0)
    buffer_load_dword v19, v22, s[68:71], 0 offen sc1
    s_waitcnt vmcnt(0)
    v_cmp_eq_u32 s[90:91], 1, v19
    s_nop 1
    s_and_b32 s88, s90, 0xffc
    s_cmp_eq_u32 s88, 0xffc
    s_cbranch_scc1 c_n4
    s_sub_u32 s89, s89, 1
    s_cbranch_scc1 c_n4
    s_branch c_n4_l
c_n5_s:
    s_mov_b32 s89, 65536
c_n5_l:
    s_waitcnt vmcnt(0)
    buffer_load_dword v19, v22, s[68:71], 0 offen sc1
    s_waitcnt vmcnt(0)
    v_cmp_eq_u32 s[90:91], 1, v19
    s_nop 1
    s_and_b32 s88, s90, 0x3ffc
    s_cmp_eq_u32 s88, 0x3ffc
    s_cbranch_scc1 c_n5
    s_sub_u32 s89, s89, 1
    s_cbranch_scc1 c_n5
    s_branch c_n5_l
c_n6_s:
    s_mov_b32 s89, 65536
c_n6_l:
    s_waitcnt vmcnt(0)
    buffer_load_dword v19, v22, s[68:71], 0 offen sc1
    s_waitcnt vmcnt(0)
    v_cmp_eq_u32 s[90:91], 1, v19
    s_nop 1
    s_and_b32 s88, s90, 0xfffc
    s_cmp_eq_u32 s88, 0xfffc
    s_cbranch_scc1 c_n6
    s_sub_u32 s89, s89, 1
    s_cbranch_scc1 c_n6
    s_branch c_n6_l
L_end:
    s_endpgm
.section .rodata,"a"
.p2align 6
.amdhsa_kernel gated_mix__ssm_conv_s5__ssm_conv_h3__prompt_kernel
  .amdhsa_next_free_vgpr 256
  .amdhsa_next_free_sgpr 102
  .amdhsa_accum_offset 256
  .amdhsa_group_segment_fixed_size 0
  .amdhsa_kernarg_size 152
  .amdhsa_user_sgpr_count 2
  .amdhsa_user_sgpr_kernarg_segment_ptr 1
  .amdhsa_system_sgpr_workgroup_id_x 1
  .amdhsa_float_denorm_mode_32 3
.end_amdhsa_kernel
```

```asm
; @launch grid=(256,1,1) block=(512,1,1) lds=163840
.amdgcn_target "amdgcn-amd-amdhsa--gfx950"
.text
.globl gated_mix__ssm_conv_s5__ssm_conv_h3__prompt_kernel
.p2align 8
.type gated_mix__ssm_conv_s5__ssm_conv_h3__prompt_kernel,@function
gated_mix__ssm_conv_s5__ssm_conv_h3__prompt_kernel:
    s_cmp_ge_u32 s2, 256
    s_cbranch_scc1 L_end
    s_load_dwordx16 s[16:31], s[0:1], 0
    s_load_dwordx16 s[32:47], s[0:1], 64
    s_load_dwordx4 s[48:51], s[0:1], 128
    s_load_dwordx2 s[52:53], s[0:1], 144
    s_and_b32 s54, s2, 7
    s_lshr_b32 s55, s2, 3
    s_lshr_b32 s4, s54, 1
    s_lshl_b32 s4, s4, 2
    s_and_b32 s6, s55, 3
    s_add_u32 s4, s4, s6
    s_and_b32 s5, s54, 1
    s_lshl_b32 s5, s5, 3
    s_lshr_b32 s6, s55, 2
    s_add_u32 s5, s5, s6
    v_and_b32 v1, 63, v0
    v_lshrrev_b32 v2, 6, v0
    s_and_b32 s15, s5, 7
    v_readfirstlane_b32 s3, v2
    s_nop 1
    s_cmp_ge_u32 s3, 4
    s_cbranch_scc0 L_consumer
    s_sub_u32 s3, s3, 4
    s_lshr_b32 s6, s3, 1
    s_and_b32 s7, s3, 1
    v_lshrrev_b32 v3, 5, v1
    v_lshlrev_b32 v3, 5, v3
    v_bfe_u32 v4, v1, 3, 1
    v_lshl_add_u32 v3, v4, 4, v3
    v_bfe_u32 v4, v1, 4, 1
    v_add_u32 v3, v3, v4
    s_lshl_b32 s8, s4, 7
    s_lshl_b32 s9, s6, 6
    s_add_u32 s8, s8, s9
    s_lshl_b32 s9, s7, 3
    s_add_u32 s8, s8, s9
    v_add_u32 v3, s8, v3
    v_lshlrev_b32 v3, 11, v3
    v_and_b32 v4, 7, v1
    v_lshrrev_b32 v5, 4, v1
    v_xor_b32 v4, v4, v5
    v_lshlrev_b32 v4, 4, v4
    v_add_u32 v8, v3, v4
    s_lshl_b32 s10, s3, 12
    s_lshr_b32 s90, s55, 2
    s_lshl_b32 s90, s90, 1
    s_and_b32 s91, s55, 3
    s_lshl_b32 s91, s91, 2
    s_add_u32 s90, s90, s91
    s_and_b32 s11, s90, 15
    s_lshl_b32 s11, s11, 7
    s_mov_b32 m0, s10
    s_mov_b32 s58, 0x400000
    s_mov_b32 s59, 0x20000
    s_waitcnt lgkmcnt(0)
    s_mov_b32 s56, s16
    s_mov_b32 s57, s17
    buffer_load_dwordx4 v8, s[56:59], s11 offen lds
    v_xor_b32 v5, 64, v4
    v_add_u32 v9, v3, v5
    v_add_u32 v9, 3072, v9
    buffer_load_dwordx4 v9, s[56:59], s11 offen offset:1024 lds
    v_add_u32 v10, 6144, v8
    buffer_load_dwordx4 v10, s[56:59], s11 offen offset:2048 lds
    v_add_u32 v11, 6144, v9
    buffer_load_dwordx4 v11, s[56:59], s11 offen offset:3072 lds
    s_lshl_b32 s8, s5, 6
    s_lshl_b32 s9, s7, 5
    s_add_u32 s8, s8, s9
    v_lshrrev_b32 v6, 3, v1
    v_add_u32 v7, s8, v6
    v_lshlrev_b32 v7, 11, v7
    v_add_u32 v12, v7, v4
    s_cmp_ge_u32 s3, 2
    s_cselect_b32 s60, s24, s22
    s_cselect_b32 s61, s25, s23
    s_mov_b32 s62, 0x200000
    s_mov_b32 s63, 0x20000
    s_add_u32 m0, s10, 16384
    v_add_u32 v13, v7, v5
    buffer_load_dwordx4 v12, s[60:63], s11 offen lds
    v_add_u32 v13, 15360, v13
    buffer_load_dwordx4 v13, s[60:63], s11 offen offset:1024 lds
    v_add_u32 v14, 30720, v12
    buffer_load_dwordx4 v14, s[60:63], s11 offen offset:2048 lds
    v_add_u32 v15, 30720, v13
    buffer_load_dwordx4 v15, s[60:63], s11 offen offset:3072 lds
    s_and_b32 s8, s5, 7
    s_lshl_b32 s8, s8, 6
    s_lshl_b32 s9, s3, 4
    s_add_u32 s8, s8, s9
    v_add_u32 v7, s8, v6
    v_lshlrev_b32 v7, 11, v7
    v_add_u32 v28, v7, v4
    v_add_u32 v29, v7, v5
    v_add_u32 v29, 15360, v29
    s_and_b32 s12, s55, 1
    s_lshl_b32 s13, s54, 1
    s_add_u32 s12, s12, s13
    s_lshr_b32 s13, s55, 1
    s_lshl_b32 s8, s2, 7
    s_add_u32 s8, s8, 0x20000
    v_mov_b32 v30, s8
    s_lshl_b32 s88, s54, 5
    s_add_u32 s88, s88, s55
    s_lshl_b32 s8, s88, 7
    s_add_u32 s8, s8, 0x28000
    v_mov_b32 v31, s8
    s_lshl_b32 s88, s88, 2
    s_add_u32 s88, s88, s3
    v_mov_b32 v2, 0
    s_add_u32 s92, s52, 0x1200000
    s_addc_u32 s93, s53, 0
    s_mov_b32 s94, 0x50000
    s_mov_b32 s95, 0x20000
    s_lshl_b32 s8, s88, 12
    s_load_dword s100, s[42:43], s8
    s_lshr_b32 s8, s88, 1
    s_lshl_b32 s8, s8, 2
    s_load_dword s101, s[44:45], s8
    buffer_store_dword v2, v30, s[92:95], 0 offen sc1
    buffer_store_dword v2, v31, s[92:95], 0 offen sc1
    s_add_u32 s11, s90, 1
    s_and_b32 s11, s11, 15
    s_lshl_b32 s11, s11, 7
    s_add_u32 m0, s10, 0x8000
    s_nop 0
    buffer_load_dwordx4 v8, s[56:59], s11 offen offset:0 lds
    buffer_load_dwordx4 v9, s[56:59], s11 offen offset:1024 lds
    buffer_load_dwordx4 v10, s[56:59], s11 offen offset:2048 lds
    buffer_load_dwordx4 v11, s[56:59], s11 offen offset:3072 lds
    s_add_u32 m0, s10, 0xc000
    s_nop 0
    buffer_load_dwordx4 v12, s[60:63], s11 offen offset:0 lds
    buffer_load_dwordx4 v13, s[60:63], s11 offen offset:1024 lds
    buffer_load_dwordx4 v14, s[60:63], s11 offen offset:2048 lds
    buffer_load_dwordx4 v15, s[60:63], s11 offen offset:3072 lds
    s_lshl_b32 s13, s13, 7
    s_lshl_b32 s14, s3, 5
    s_add_u32 s13, s13, s14
    v_and_b32 v17, 31, v1
    s_lshl_b32 s14, s12, 5
    v_add_u32 v17, s14, v17
    v_lshlrev_b32 v22, 4, v17
    v_and_b32 v23, 31, v1
    v_mul_u32_u24 v23, 544, v23
    v_lshrrev_b32 v24, 5, v1
    v_lshlrev_b32 v24, 5, v24
    v_sub_u32 v23, v23, v24
    s_lshl_b32 s8, s3, 6
    s_sub_u32 s8, 131808, s8
    v_add_u32 v23, s8, v23
    v_lshrrev_b32 v24, 4, v1
    s_lshl_b32 s8, s3, 4
    v_add_u32 v24, s8, v24
    v_and_b32 v2, 15, v1
    v_lshlrev_b32 v2, 4, v2
    s_lshl_b32 s8, s12, 6
    v_add_u32 v27, s8, v24
    v_lshl_add_u32 v27, v27, 12, v2
    s_lshr_b32 s8, s55, 1
    s_lshl_b32 s8, s8, 8
    s_sub_u32 s8, 3840, s8
    v_add_u32 v27, s8, v27
    v_mul_u32_u24 v24, 272, v24
    v_add_u32 v24, v24, v2
    v_add_u32 v24, 0x20200, v24
    s_lshl_b32 s14, s4, 7
    s_lshl_b32 s8, s5, 3
    s_add_u32 s14, s14, s8
    s_lshl_b32 s8, s3, 1
    s_add_u32 s14, s14, s8
    s_lshl_b32 s8, s14, 11
    v_lshlrev_b32 v25, 4, v1
    v_add_u32 v26, s8, v25
    v_add_u32 v3, 0x8000, v27
    s_mov_b32 s64, s36
    s_mov_b32 s65, s37
    s_mov_b32 s66, 0x400000
    s_mov_b32 s67, 0x20000
    s_mov_b32 s68, s38
    s_mov_b32 s69, s39
    s_mov_b32 s70, 0x400000
    s_mov_b32 s71, 0x20000
    s_add_u32 s72, s52, 0x800000
    s_addc_u32 s73, s53, 0
    s_mov_b32 s74, 0x400000
    s_mov_b32 s75, 0x20000
    s_add_u32 s76, s52, 0x1000000
    s_addc_u32 s77, s53, 0
    s_mov_b32 s78, 0x2000
    s_mov_b32 s79, 0x20000
    s_mov_b32 s80, 0
    s_mov_b32 s81, 4096
    s_mov_b32 s82, 8192
    s_mov_b32 s83, 12288
    s_mov_b32 s84, 16384
    s_mov_b32 s85, 20480
    s_mov_b32 s86, 24576
    s_mov_b32 s87, 28672
    v_lshrrev_b32 v19, 3, v1
    v_add_u32 v19, s13, v19
    v_lshlrev_b32 v19, 11, v19
    v_and_b32 v20, 7, v1
    v_lshl_add_u32 v19, v20, 4, v19
    s_lshl_b32 s8, s12, 7
    v_add_u32 v19, s8, v19
    v_subrev_u32 v20, 16384, v19
    v_lshrrev_b32 v21, 5, v1
    v_lshlrev_b32 v21, 11, v21
    v_and_b32 v18, 31, v1
    v_lshl_add_u32 v21, v18, 2, v21
    s_lshl_b32 s8, s3, 12
    s_add_u32 s91, s8, 98304
    v_add_u32 v21, s91, v21
    v_mov_b32 v6, 0x24a00
    v_mov_b32 v7, 0
    ds_write_b32 v6, v7 offset:4
    ds_write_b32 v6, v7 offset:8
    ds_write_b32 v6, v7 offset:12
    ds_write_b32 v6, v7 offset:16
    ds_write_b32 v6, v7 offset:20
    s_waitcnt lgkmcnt(0)
    s_waitcnt vmcnt(8)
    s_barrier
    s_add_u32 s11, s90, 2
    s_and_b32 s11, s11, 15
    s_lshl_b32 s11, s11, 7
    s_add_u32 m0, s10, 0x10000
    s_nop 0
    buffer_load_dwordx4 v8, s[56:59], s11 offen offset:0 lds
    buffer_load_dwordx4 v9, s[56:59], s11 offen offset:1024 lds
    buffer_load_dwordx4 v10, s[56:59], s11 offen offset:2048 lds
    buffer_load_dwordx4 v11, s[56:59], s11 offen offset:3072 lds
    s_add_u32 m0, s10, 0x14000
    s_nop 0
    buffer_load_dwordx4 v12, s[60:63], s11 offen offset:0 lds
    buffer_load_dwordx4 v13, s[60:63], s11 offen offset:1024 lds
    buffer_load_dwordx4 v14, s[60:63], s11 offen offset:2048 lds
    buffer_load_dwordx4 v15, s[60:63], s11 offen offset:3072 lds
    buffer_load_dwordx4 v[72:75], v26, s[56:59], 0 offen offset:0
    buffer_load_dwordx4 v[76:79], v26, s[56:59], 0 offen offset:1024
    buffer_load_dwordx4 v[80:83], v26, s[56:59], 0 offen offset:2048
    buffer_load_dwordx4 v[84:87], v26, s[56:59], 0 offen offset:3072
    global_load_dwordx4 v[88:91], v25, s[46:47] offset:0
    global_load_dwordx4 v[92:95], v25, s[46:47] offset:1024
    s_waitcnt vmcnt(14)
    s_barrier
    s_add_u32 s11, s90, 3
    s_and_b32 s11, s11, 15
    s_lshl_b32 s11, s11, 7
    s_add_u32 m0, s10, 0x0
    s_nop 0
    buffer_load_dwordx4 v8, s[56:59], s11 offen offset:0 lds
    buffer_load_dwordx4 v9, s[56:59], s11 offen offset:1024 lds
    buffer_load_dwordx4 v10, s[56:59], s11 offen offset:2048 lds
    buffer_load_dwordx4 v11, s[56:59], s11 offen offset:3072 lds
    s_add_u32 m0, s10, 0x4000
    s_nop 0
    buffer_load_dwordx4 v12, s[60:63], s11 offen offset:0 lds
    buffer_load_dwordx4 v13, s[60:63], s11 offen offset:1024 lds
    buffer_load_dwordx4 v14, s[60:63], s11 offen offset:2048 lds
    buffer_load_dwordx4 v15, s[60:63], s11 offen offset:3072 lds
    s_waitcnt vmcnt(14)
    s_barrier
    s_add_u32 s11, s90, 4
    s_and_b32 s11, s11, 15
    s_lshl_b32 s11, s11, 7
    s_add_u32 m0, s10, 0x8000
    s_nop 0
    buffer_load_dwordx4 v8, s[56:59], s11 offen offset:0 lds
    s_mov_b32 s12, 0xffff0000
    s_waitcnt vmcnt(9)
    v_lshlrev_b32 v96, 16, v88
    v_and_b32 v97, s12, v88
    v_lshlrev_b32 v98, 16, v89
    v_and_b32 v99, s12, v89
    v_lshlrev_b32 v100, 16, v90
    v_and_b32 v101, s12, v90
    v_lshlrev_b32 v102, 16, v91
    v_and_b32 v103, s12, v91
    buffer_load_dwordx4 v9, s[56:59], s11 offen offset:1024 lds
    v_lshlrev_b32 v104, 16, v92
    v_and_b32 v105, s12, v92
    v_lshlrev_b32 v106, 16, v93
    v_and_b32 v107, s12, v93
    v_lshlrev_b32 v108, 16, v94
    v_and_b32 v109, s12, v94
    v_lshlrev_b32 v110, 16, v95
    v_and_b32 v111, s12, v95
    v_mov_b32 v112, 0
    v_lshlrev_b32 v116, 16, v72
    buffer_load_dwordx4 v10, s[56:59], s11 offen offset:2048 lds
    v_and_b32 v117, s12, v72
    v_mul_f32 v116, v116, v96
    v_mul_f32 v117, v117, v97
    v_cvt_pk_bf16_f32 v118, v116, v117
    v_lshlrev_b32 v116, 16, v118
    v_and_b32 v117, s12, v118
    v_add_f32 v112, v112, v116
    v_add_f32 v112, v112, v117
    v_lshlrev_b32 v116, 16, v73
    v_and_b32 v117, s12, v73
    buffer_load_dwordx4 v11, s[56:59], s11 offen offset:3072 lds
    v_mul_f32 v116, v116, v98
    v_mul_f32 v117, v117, v99
    v_cvt_pk_bf16_f32 v118, v116, v117
    v_lshlrev_b32 v116, 16, v118
    v_and_b32 v117, s12, v118
    v_add_f32 v112, v112, v116
    v_add_f32 v112, v112, v117
    v_lshlrev_b32 v116, 16, v74
    v_and_b32 v117, s12, v74
    v_mul_f32 v116, v116, v100
    s_add_u32 m0, s10, 0xc000
    s_nop 0
    buffer_load_dwordx4 v12, s[60:63], s11 offen offset:0 lds
    v_mul_f32 v117, v117, v101
    v_cvt_pk_bf16_f32 v118, v116, v117
    v_lshlrev_b32 v116, 16, v118
    v_and_b32 v117, s12, v118
    v_add_f32 v112, v112, v116
    v_add_f32 v112, v112, v117
    v_lshlrev_b32 v116, 16, v75
    v_and_b32 v117, s12, v75
    v_mul_f32 v116, v116, v102
    v_mul_f32 v117, v117, v103
    buffer_load_dwordx4 v13, s[60:63], s11 offen offset:1024 lds
    v_cvt_pk_bf16_f32 v118, v116, v117
    v_lshlrev_b32 v116, 16, v118
    v_and_b32 v117, s12, v118
    v_add_f32 v112, v112, v116
    v_add_f32 v112, v112, v117
    v_lshlrev_b32 v116, 16, v76
    v_and_b32 v117, s12, v76
    v_mul_f32 v116, v116, v104
    v_mul_f32 v117, v117, v105
    v_cvt_pk_bf16_f32 v118, v116, v117
    buffer_load_dwordx4 v14, s[60:63], s11 offen offset:2048 lds
    v_lshlrev_b32 v116, 16, v118
    v_and_b32 v117, s12, v118
    v_add_f32 v112, v112, v116
    v_add_f32 v112, v112, v117
    v_lshlrev_b32 v116, 16, v77
    v_and_b32 v117, s12, v77
    v_mul_f32 v116, v116, v106
    v_mul_f32 v117, v117, v107
    v_cvt_pk_bf16_f32 v118, v116, v117
    v_lshlrev_b32 v116, 16, v118
    buffer_load_dwordx4 v15, s[60:63], s11 offen offset:3072 lds
    v_and_b32 v117, s12, v118
    v_add_f32 v112, v112, v116
    v_add_f32 v112, v112, v117
    v_lshlrev_b32 v116, 16, v78
    v_and_b32 v117, s12, v78
    v_mul_f32 v116, v116, v108
    v_mul_f32 v117, v117, v109
    v_cvt_pk_bf16_f32 v118, v116, v117
    v_lshlrev_b32 v116, 16, v118
    v_and_b32 v117, s12, v118
    s_add_u32 m0, s91, 16384
    s_nop 0
    buffer_load_dwordx4 v20, s[64:67], 0 offen lds
    s_add_u32 m0, s91, 17408
    s_mov_b32 s99, 0
    buffer_load_dwordx4 v19, s[64:67], s99 offen lds
    s_add_u32 m0, s91, 18432
    s_mov_b32 s99, 16384
    buffer_load_dwordx4 v19, s[64:67], s99 offen lds
    s_add_u32 m0, s91, 19456
    s_mov_b32 s99, 32768
    buffer_load_dwordx4 v19, s[64:67], s99 offen lds
    s_add_u32 m0, s91, 20480
    s_mov_b32 s99, 49152
    buffer_load_dwordx4 v19, s[64:67], s99 offen lds
    global_load_dwordx4 v[68:71], v22, s[40:41]
    s_add_u32 m0, s91, 0
    s_mov_b32 s99, 0
    buffer_load_dwordx4 v19, s[68:71], s99 offen lds
    s_add_u32 m0, s91, 1024
    s_mov_b32 s99, 16384
    buffer_load_dwordx4 v19, s[68:71], s99 offen lds
    s_add_u32 m0, s91, 2048
    s_mov_b32 s99, 32768
    buffer_load_dwordx4 v19, s[68:71], s99 offen lds
    s_add_u32 m0, s91, 3072
    s_mov_b32 s99, 49152
    buffer_load_dwordx4 v19, s[68:71], s99 offen lds
    s_waitcnt vmcnt(18)
    s_barrier
    s_add_u32 s11, s90, 5
    s_and_b32 s11, s11, 15
    s_lshl_b32 s11, s11, 7
    s_add_u32 m0, s10, 0x10000
    s_nop 0
    buffer_load_dwordx4 v8, s[56:59], s11 offen offset:0 lds
    v_add_f32 v112, v112, v116
    v_add_f32 v112, v112, v117
    v_lshlrev_b32 v116, 16, v79
    v_and_b32 v117, s12, v79
    v_mul_f32 v116, v116, v110
    v_mul_f32 v117, v117, v111
    v_cvt_pk_bf16_f32 v118, v116, v117
    v_lshlrev_b32 v116, 16, v118
    v_and_b32 v117, s12, v118
    v_add_f32 v112, v112, v116
    buffer_load_dwordx4 v9, s[56:59], s11 offen offset:1024 lds
    v_add_f32 v112, v112, v117
    v_mov_b32 v113, 0
    v_lshlrev_b32 v116, 16, v80
    v_and_b32 v117, s12, v80
    v_mul_f32 v116, v116, v96
    v_mul_f32 v117, v117, v97
    v_cvt_pk_bf16_f32 v118, v116, v117
    v_lshlrev_b32 v116, 16, v118
    v_and_b32 v117, s12, v118
    v_add_f32 v113, v113, v116
    buffer_load_dwordx4 v10, s[56:59], s11 offen offset:2048 lds
    v_add_f32 v113, v113, v117
    v_lshlrev_b32 v116, 16, v81
    v_and_b32 v117, s12, v81
    v_mul_f32 v116, v116, v98
    v_mul_f32 v117, v117, v99
    v_cvt_pk_bf16_f32 v118, v116, v117
    v_lshlrev_b32 v116, 16, v118
    v_and_b32 v117, s12, v118
    v_add_f32 v113, v113, v116
    v_add_f32 v113, v113, v117
    buffer_load_dwordx4 v11, s[56:59], s11 offen offset:3072 lds
    v_lshlrev_b32 v116, 16, v82
    v_and_b32 v117, s12, v82
    v_mul_f32 v116, v116, v100
    v_mul_f32 v117, v117, v101
    v_cvt_pk_bf16_f32 v118, v116, v117
    v_lshlrev_b32 v116, 16, v118
    v_and_b32 v117, s12, v118
    v_add_f32 v113, v113, v116
    v_add_f32 v113, v113, v117
    v_lshlrev_b32 v116, 16, v83
    s_add_u32 m0, s10, 0x14000
    s_nop 0
    buffer_load_dwordx4 v12, s[60:63], s11 offen offset:0 lds
    v_and_b32 v117, s12, v83
    v_mul_f32 v116, v116, v102
    v_mul_f32 v117, v117, v103
    v_cvt_pk_bf16_f32 v118, v116, v117
    v_lshlrev_b32 v116, 16, v118
    v_and_b32 v117, s12, v118
    v_add_f32 v113, v113, v116
    v_add_f32 v113, v113, v117
    v_lshlrev_b32 v116, 16, v84
    v_and_b32 v117, s12, v84
    buffer_load_dwordx4 v13, s[60:63], s11 offen offset:1024 lds
    v_mul_f32 v116, v116, v104
    v_mul_f32 v117, v117, v105
    v_cvt_pk_bf16_f32 v118, v116, v117
    v_lshlrev_b32 v116, 16, v118
    v_and_b32 v117, s12, v118
    v_add_f32 v113, v113, v116
    v_add_f32 v113, v113, v117
    v_lshlrev_b32 v116, 16, v85
    v_and_b32 v117, s12, v85
    v_mul_f32 v116, v116, v106
    buffer_load_dwordx4 v14, s[60:63], s11 offen offset:2048 lds
    v_mul_f32 v117, v117, v107
    v_cvt_pk_bf16_f32 v118, v116, v117
    v_lshlrev_b32 v116, 16, v118
    v_and_b32 v117, s12, v118
    v_add_f32 v113, v113, v116
    v_add_f32 v113, v113, v117
    v_lshlrev_b32 v116, 16, v86
    v_and_b32 v117, s12, v86
    v_mul_f32 v116, v116, v108
    v_mul_f32 v117, v117, v109
    buffer_load_dwordx4 v15, s[60:63], s11 offen offset:3072 lds
    v_cvt_pk_bf16_f32 v118, v116, v117
    v_lshlrev_b32 v116, 16, v118
    v_and_b32 v117, s12, v118
    v_add_f32 v113, v113, v116
    v_add_f32 v113, v113, v117
    v_lshlrev_b32 v116, 16, v87
    v_and_b32 v117, s12, v87
    v_mul_f32 v116, v116, v110
    v_mul_f32 v117, v117, v111
    v_cvt_pk_bf16_f32 v118, v116, v117
    s_waitcnt vmcnt(18)
    s_barrier
    s_add_u32 s11, s90, 6
    s_and_b32 s11, s11, 15
    s_lshl_b32 s11, s11, 7
    s_add_u32 m0, s10, 0x0
    s_nop 0
    buffer_load_dwordx4 v8, s[56:59], s11 offen offset:0 lds
    v_lshlrev_b32 v116, 16, v118
    v_and_b32 v117, s12, v118
    v_add_f32 v113, v113, v116
    v_add_f32 v113, v113, v117
    v_add_f32_dpp v112, v112, v112 row_shr:1 row_mask:0xf bank_mask:0xf bound_ctrl:0
    s_nop 1
    v_add_f32_dpp v112, v112, v112 row_shr:2 row_mask:0xf bank_mask:0xf bound_ctrl:0
    s_nop 1
    v_add_f32_dpp v112, v112, v112 row_shr:4 row_mask:0xf bank_mask:0xf bound_ctrl:0
    s_nop 1
    v_add_f32_dpp v112, v112, v112 row_shr:8 row_mask:0xf bank_mask:0xf bound_ctrl:0
    s_nop 1
    v_add_f32_dpp v112, v112, v112 row_bcast:15 row_mask:0xa bank_mask:0xf
    s_nop 1
    v_add_f32_dpp v112, v112, v112 row_bcast:31 row_mask:0xc bank_mask:0xf
    buffer_load_dwordx4 v9, s[56:59], s11 offen offset:1024 lds
    v_add_f32_dpp v113, v113, v113 row_shr:1 row_mask:0xf bank_mask:0xf bound_ctrl:0
    s_nop 1
    v_add_f32_dpp v113, v113, v113 row_shr:2 row_mask:0xf bank_mask:0xf bound_ctrl:0
    s_nop 1
    v_add_f32_dpp v113, v113, v113 row_shr:4 row_mask:0xf bank_mask:0xf bound_ctrl:0
    s_nop 1
    v_add_f32_dpp v113, v113, v113 row_shr:8 row_mask:0xf bank_mask:0xf bound_ctrl:0
    s_nop 1
    v_add_f32_dpp v113, v113, v113 row_bcast:15 row_mask:0xa bank_mask:0xf
    s_nop 1
    v_add_f32_dpp v113, v113, v113 row_bcast:31 row_mask:0xc bank_mask:0xf
    v_readlane_b32 s8, v112, 63
    v_readlane_b32 s9, v113, 63
    s_nop 0
    v_mov_b32 v116, s8
    v_mov_b32 v117, s9
    buffer_load_dwordx4 v10, s[56:59], s11 offen offset:2048 lds
    v_cmp_eq_u32 vcc, 1, v1
    s_nop 1
    v_cndmask_b32 v116, v116, v117, vcc
    v_cvt_pk_bf16_f32 v116, v116, v116
    v_lshlrev_b32 v116, 16, v116
    v_mul_f32 v116, 0xbfb8aa3b, v116
    v_exp_f32 v116, v116
    s_nop 0
    v_add_f32 v116, 1.0, v116
    v_rcp_f32 v116, v116
    s_nop 0
    v_cvt_pk_bf16_f32 v117, v116, v116
    v_lshlrev_b32 v116, 16, v117
    buffer_load_dwordx4 v11, s[56:59], s11 offen offset:3072 lds
    v_sub_f32 v118, 1.0, v116
    v_cvt_pk_bf16_f32 v116, v116, v118
    s_lshl_b32 s14, s14, 2
    v_lshl_add_u32 v117, v1, 2, s14
    s_mov_b64 exec, 3
    buffer_store_dword v116, v117, s[76:79], 0 offen sc1
    s_mov_b64 exec, -1
    s_add_u32 m0, s10, 0x4000
    s_nop 0
    buffer_load_dwordx4 v12, s[60:63], s11 offen offset:0 lds
    buffer_load_dwordx4 v13, s[60:63], s11 offen offset:1024 lds
    buffer_load_dwordx4 v14, s[60:63], s11 offen offset:2048 lds
    buffer_load_dwordx4 v15, s[60:63], s11 offen offset:3072 lds
    s_waitcnt vmcnt(9)
    s_barrier
    s_add_u32 s11, s90, 7
    s_and_b32 s11, s11, 15
    s_lshl_b32 s11, s11, 7
    s_add_u32 m0, s10, 0x8000
    s_nop 0
    buffer_load_dwordx4 v8, s[56:59], s11 offen offset:0 lds
    ds_read_b32 v32, v21 offset:17024
    ds_read_b32 v33, v21 offset:17152
    ds_read_b32 v34, v21 offset:17280
    ds_read_b32 v35, v21 offset:17408
    ds_read_b32 v36, v21 offset:17536
    ds_read_b32 v37, v21 offset:17664
    ds_read_b32 v38, v21 offset:17792
    ds_read_b32 v39, v21 offset:17920
    ds_read_b32 v40, v21 offset:18048
    buffer_load_dwordx4 v9, s[56:59], s11 offen offset:1024 lds
    ds_read_b32 v41, v21 offset:18176
    s_waitcnt lgkmcnt(0)
    ds_read_b32 v42, v21 offset:18304
    ds_read_b32 v43, v21 offset:18432
    ds_read_b32 v44, v21 offset:18560
    ds_read_b32 v45, v21 offset:18688
    ds_read_b32 v46, v21 offset:18816
    ds_read_b32 v47, v21 offset:18944
    ds_read_b32 v48, v21 offset:19072
    ds_read_b32 v49, v21 offset:19200
    buffer_load_dwordx4 v10, s[56:59], s11 offen offset:2048 lds
    ds_read_b32 v50, v21 offset:19328
    s_waitcnt lgkmcnt(0)
    v_lshlrev_b32 v96, 16, v32
    v_and_b32 v97, s12, v32
    v_lshlrev_b32 v98, 16, v33
    v_and_b32 v99, s12, v33
    v_lshlrev_b32 v100, 16, v34
    v_and_b32 v101, s12, v34
    v_lshlrev_b32 v102, 16, v35
    v_and_b32 v103, s12, v35
    buffer_load_dwordx4 v11, s[56:59], s11 offen offset:3072 lds
    v_lshlrev_b32 v104, 16, v36
    v_and_b32 v105, s12, v36
    v_lshlrev_b32 v106, 16, v37
    v_and_b32 v107, s12, v37
    v_lshlrev_b32 v108, 16, v38
    v_and_b32 v109, s12, v38
    v_lshlrev_b32 v110, 16, v39
    v_and_b32 v111, s12, v39
    v_lshlrev_b32 v112, 16, v40
    v_and_b32 v113, s12, v40
    s_add_u32 m0, s10, 0xc000
    s_nop 0
    buffer_load_dwordx4 v12, s[60:63], s11 offen offset:0 lds
    v_lshlrev_b32 v114, 16, v41
    v_and_b32 v115, s12, v41
    v_lshlrev_b32 v116, 16, v42
    v_and_b32 v117, s12, v42
    v_lshlrev_b32 v118, 16, v43
    v_and_b32 v119, s12, v43
    v_lshlrev_b32 v120, 16, v44
    v_and_b32 v121, s12, v44
    v_lshlrev_b32 v122, 16, v45
    v_and_b32 v123, s12, v45
    buffer_load_dwordx4 v13, s[60:63], s11 offen offset:1024 lds
    v_lshlrev_b32 v124, 16, v46
    v_and_b32 v125, s12, v46
    v_lshlrev_b32 v126, 16, v47
    v_and_b32 v127, s12, v47
    v_lshlrev_b32 v128, 16, v48
    v_and_b32 v129, s12, v48
    v_lshlrev_b32 v130, 16, v49
    v_and_b32 v131, s12, v49
    v_lshlrev_b32 v132, 16, v50
    v_and_b32 v133, s12, v50
    buffer_load_dwordx4 v14, s[60:63], s11 offen offset:2048 lds
    v_lshlrev_b32 v136, 16, v68
    v_lshlrev_b32 v137, 16, v70
    v_and_b32 v138, s12, v68
    v_and_b32 v139, s12, v70
    v_lshlrev_b32 v140, 16, v69
    v_lshlrev_b32 v141, 16, v71
    v_and_b32 v142, s12, v69
    v_and_b32 v143, s12, v71
    ds_read_b32 v208, v21 offset:0
    buffer_load_dwordx4 v15, s[60:63], s11 offen offset:3072 lds
    ds_read_b32 v209, v21 offset:128
    ds_read_b32 v210, v21 offset:256
    ds_read_b32 v211, v21 offset:384
    ds_read_b32 v212, v21 offset:512
    ds_read_b32 v213, v21 offset:640
    ds_read_b32 v214, v21 offset:768
    ds_read_b32 v215, v21 offset:896
    s_waitcnt lgkmcnt(0)
    ds_read_b32 v216, v21 offset:1024
    ds_read_b32 v217, v21 offset:1152
    s_waitcnt vmcnt(8)
    s_barrier
    s_add_u32 s11, s90, 8
    s_and_b32 s11, s11, 15
    s_lshl_b32 s11, s11, 7
    s_add_u32 m0, s10, 0x10000
    s_nop 0
    buffer_load_dwordx4 v8, s[56:59], s11 offen offset:0 lds
    ds_read_b32 v218, v21 offset:1280
    ds_read_b32 v219, v21 offset:1408
    ds_read_b32 v220, v21 offset:1536
    ds_read_b32 v221, v21 offset:1664
    ds_read_b32 v222, v21 offset:1792
    ds_read_b32 v223, v21 offset:1920
    s_waitcnt lgkmcnt(0)
    v_lshlrev_b32 v176, 16, v208
    v_and_b32 v177, s12, v208
    v_mul_f32 v144, v96, v142
    buffer_load_dwordx4 v9, s[56:59], s11 offen offset:1024 lds
    v_mul_f32 v145, v97, v143
    v_fmac_f32 v144, v98, v140
    v_fmac_f32 v145, v99, v141
    v_fmac_f32 v144, v100, v138
    v_fmac_f32 v145, v101, v139
    v_fmac_f32 v144, v102, v136
    v_fmac_f32 v145, v103, v137
    v_mul_f32 v144, v144, v176
    v_mul_f32 v145, v145, v177
    v_lshlrev_b32 v178, 16, v209
    buffer_load_dwordx4 v10, s[56:59], s11 offen offset:2048 lds
    v_and_b32 v179, s12, v209
    v_mul_f32 v146, v98, v142
    v_mul_f32 v147, v99, v143
    v_fmac_f32 v146, v100, v140
    v_fmac_f32 v147, v101, v141
    v_fmac_f32 v146, v102, v138
    v_fmac_f32 v147, v103, v139
    v_fmac_f32 v146, v104, v136
    v_fmac_f32 v147, v105, v137
    v_mul_f32 v146, v146, v178
    buffer_load_dwordx4 v11, s[56:59], s11 offen offset:3072 lds
    v_mul_f32 v147, v147, v179
    v_lshlrev_b32 v176, 16, v210
    v_and_b32 v177, s12, v210
    v_mul_f32 v148, v100, v142
    v_mul_f32 v149, v101, v143
    v_fmac_f32 v148, v102, v140
    v_fmac_f32 v149, v103, v141
    v_fmac_f32 v148, v104, v138
    v_fmac_f32 v149, v105, v139
    v_fmac_f32 v148, v106, v136
    s_add_u32 m0, s10, 0x14000
    s_nop 0
    buffer_load_dwordx4 v12, s[60:63], s11 offen offset:0 lds
    v_fmac_f32 v149, v107, v137
    v_mul_f32 v148, v148, v176
    v_mul_f32 v149, v149, v177
    v_lshlrev_b32 v178, 16, v211
    v_and_b32 v179, s12, v211
    v_mul_f32 v150, v102, v142
    v_mul_f32 v151, v103, v143
    v_fmac_f32 v150, v104, v140
    v_fmac_f32 v151, v105, v141
    v_fmac_f32 v150, v106, v138
    buffer_load_dwordx4 v13, s[60:63], s11 offen offset:1024 lds
    v_fmac_f32 v151, v107, v139
    v_fmac_f32 v150, v108, v136
    v_fmac_f32 v151, v109, v137
    v_mul_f32 v150, v150, v178
    v_mul_f32 v151, v151, v179
    v_lshlrev_b32 v176, 16, v212
    v_and_b32 v177, s12, v212
    v_mul_f32 v152, v104, v142
    v_mul_f32 v153, v105, v143
    v_fmac_f32 v152, v106, v140
    buffer_load_dwordx4 v14, s[60:63], s11 offen offset:2048 lds
    v_fmac_f32 v153, v107, v141
    v_fmac_f32 v152, v108, v138
    v_fmac_f32 v153, v109, v139
    v_fmac_f32 v152, v110, v136
    v_fmac_f32 v153, v111, v137
    v_mul_f32 v152, v152, v176
    v_mul_f32 v153, v153, v177
    v_lshlrev_b32 v178, 16, v213
    v_and_b32 v179, s12, v213
    v_mul_f32 v154, v106, v142
    buffer_load_dwordx4 v15, s[60:63], s11 offen offset:3072 lds
    v_mul_f32 v155, v107, v143
    v_fmac_f32 v154, v108, v140
    v_fmac_f32 v155, v109, v141
    v_fmac_f32 v154, v110, v138
    v_fmac_f32 v155, v111, v139
    v_fmac_f32 v154, v112, v136
    v_fmac_f32 v155, v113, v137
    v_mul_f32 v154, v154, v178
    v_mul_f32 v155, v155, v179
    v_lshlrev_b32 v176, 16, v214
    s_waitcnt vmcnt(8)
    s_barrier
    s_add_u32 s11, s90, 9
    s_and_b32 s11, s11, 15
    s_lshl_b32 s11, s11, 7
    s_add_u32 m0, s10, 0x0
    s_nop 0
    buffer_load_dwordx4 v8, s[56:59], s11 offen offset:0 lds
    v_and_b32 v177, s12, v214
    v_mul_f32 v156, v108, v142
    v_mul_f32 v157, v109, v143
    v_fmac_f32 v156, v110, v140
    v_fmac_f32 v157, v111, v141
    v_fmac_f32 v156, v112, v138
    v_fmac_f32 v157, v113, v139
    v_fmac_f32 v156, v114, v136
    v_fmac_f32 v157, v115, v137
    v_mul_f32 v156, v156, v176
    buffer_load_dwordx4 v9, s[56:59], s11 offen offset:1024 lds
    v_mul_f32 v157, v157, v177
    v_lshlrev_b32 v178, 16, v215
    v_and_b32 v179, s12, v215
    v_mul_f32 v158, v110, v142
    v_mul_f32 v159, v111, v143
    v_fmac_f32 v158, v112, v140
    v_fmac_f32 v159, v113, v141
    v_fmac_f32 v158, v114, v138
    v_fmac_f32 v159, v115, v139
    v_fmac_f32 v158, v116, v136
    buffer_load_dwordx4 v10, s[56:59], s11 offen offset:2048 lds
    v_fmac_f32 v159, v117, v137
    v_mul_f32 v158, v158, v178
    v_mul_f32 v159, v159, v179
    v_lshlrev_b32 v176, 16, v216
    v_and_b32 v177, s12, v216
    v_mul_f32 v160, v112, v142
    v_mul_f32 v161, v113, v143
    v_fmac_f32 v160, v114, v140
    v_fmac_f32 v161, v115, v141
    v_fmac_f32 v160, v116, v138
    buffer_load_dwordx4 v11, s[56:59], s11 offen offset:3072 lds
    v_fmac_f32 v161, v117, v139
    v_fmac_f32 v160, v118, v136
    v_fmac_f32 v161, v119, v137
    v_mul_f32 v160, v160, v176
    v_mul_f32 v161, v161, v177
    v_lshlrev_b32 v178, 16, v217
    v_and_b32 v179, s12, v217
    v_mul_f32 v162, v114, v142
    v_mul_f32 v163, v115, v143
    v_fmac_f32 v162, v116, v140
    s_add_u32 m0, s10, 0x4000
    s_nop 0
    buffer_load_dwordx4 v12, s[60:63], s11 offen offset:0 lds
    v_fmac_f32 v163, v117, v141
    v_fmac_f32 v162, v118, v138
    v_fmac_f32 v163, v119, v139
    v_fmac_f32 v162, v120, v136
    v_fmac_f32 v163, v121, v137
    v_mul_f32 v162, v162, v178
    v_mul_f32 v163, v163, v179
    v_lshlrev_b32 v176, 16, v218
    v_and_b32 v177, s12, v218
    v_mul_f32 v164, v116, v142
    buffer_load_dwordx4 v13, s[60:63], s11 offen offset:1024 lds
    v_mul_f32 v165, v117, v143
    v_fmac_f32 v164, v118, v140
    v_fmac_f32 v165, v119, v141
    v_fmac_f32 v164, v120, v138
    v_fmac_f32 v165, v121, v139
    v_fmac_f32 v164, v122, v136
    v_fmac_f32 v165, v123, v137
    v_mul_f32 v164, v164, v176
    v_mul_f32 v165, v165, v177
    v_lshlrev_b32 v178, 16, v219
    buffer_load_dwordx4 v14, s[60:63], s11 offen offset:2048 lds
    v_and_b32 v179, s12, v219
    v_mul_f32 v166, v118, v142
    v_mul_f32 v167, v119, v143
    v_fmac_f32 v166, v120, v140
    v_fmac_f32 v167, v121, v141
    v_fmac_f32 v166, v122, v138
    v_fmac_f32 v167, v123, v139
    v_fmac_f32 v166, v124, v136
    v_fmac_f32 v167, v125, v137
    v_mul_f32 v166, v166, v178
    buffer_load_dwordx4 v15, s[60:63], s11 offen offset:3072 lds
    v_mul_f32 v167, v167, v179
    v_lshlrev_b32 v176, 16, v220
    v_and_b32 v177, s12, v220
    v_mul_f32 v168, v120, v142
    v_mul_f32 v169, v121, v143
    v_fmac_f32 v168, v122, v140
    v_fmac_f32 v169, v123, v141
    v_fmac_f32 v168, v124, v138
    v_fmac_f32 v169, v125, v139
    v_fmac_f32 v168, v126, v136
    s_cmp_ge_u32 s3, 2
    s_cselect_b32 s96, s28, s26
    s_cselect_b32 s97, s29, s27
    s_lshl_b32 s98, s2, 13
    s_and_b32 s99, s3, 1
    s_lshl_b32 s99, s99, 12
    s_add_u32 s98, s98, s99
    v_and_b32 v240, 31, v1
    v_lshl_add_u32 v240, v240, 7, s98
    global_load_dword v241, v240, s[96:97]
    v_lshlrev_b32 v246, 2, v1
    global_load_dword v247, v246, s[50:51] sc1
    s_waitcnt vmcnt(10)
    s_barrier
    s_add_u32 s11, s90, 10
    s_and_b32 s11, s11, 15
    s_lshl_b32 s11, s11, 7
    s_add_u32 m0, s10, 0x8000
    s_nop 0
    buffer_load_dwordx4 v8, s[56:59], s11 offen offset:0 lds
    v_fmac_f32 v169, v127, v137
    v_mul_f32 v168, v168, v176
    v_mul_f32 v169, v169, v177
    v_lshlrev_b32 v178, 16, v221
    v_and_b32 v179, s12, v221
    v_mul_f32 v170, v122, v142
    v_mul_f32 v171, v123, v143
    v_fmac_f32 v170, v124, v140
    v_fmac_f32 v171, v125, v141
    v_fmac_f32 v170, v126, v138
    buffer_load_dwordx4 v9, s[56:59], s11 offen offset:1024 lds
    v_fmac_f32 v171, v127, v139
    v_fmac_f32 v170, v128, v136
    v_fmac_f32 v171, v129, v137
    v_mul_f32 v170, v170, v178
    v_mul_f32 v171, v171, v179
    v_lshlrev_b32 v176, 16, v222
    v_and_b32 v177, s12, v222
    v_mul_f32 v172, v124, v142
    v_mul_f32 v173, v125, v143
    v_fmac_f32 v172, v126, v140
    buffer_load_dwordx4 v10, s[56:59], s11 offen offset:2048 lds
    v_fmac_f32 v173, v127, v141
    v_fmac_f32 v172, v128, v138
    v_fmac_f32 v173, v129, v139
    v_fmac_f32 v172, v130, v136
    v_fmac_f32 v173, v131, v137
    v_mul_f32 v172, v172, v176
    v_mul_f32 v173, v173, v177
    v_lshlrev_b32 v178, 16, v223
    v_and_b32 v179, s12, v223
    v_mul_f32 v174, v126, v142
    buffer_load_dwordx4 v11, s[56:59], s11 offen offset:3072 lds
    v_mul_f32 v175, v127, v143
    v_fmac_f32 v174, v128, v140
    v_fmac_f32 v175, v129, v141
    v_fmac_f32 v174, v130, v138
    v_fmac_f32 v175, v131, v139
    v_fmac_f32 v174, v132, v136
    v_fmac_f32 v175, v133, v137
    v_mul_f32 v174, v174, v178
    v_mul_f32 v175, v175, v179
    v_cvt_pk_bf16_f32 v192, v174, v172
    s_add_u32 m0, s10, 0xc000
    s_nop 0
    buffer_load_dwordx4 v12, s[60:63], s11 offen offset:0 lds
    v_cvt_pk_bf16_f32 v193, v170, v168
    v_cvt_pk_bf16_f32 v194, v166, v164
    v_cvt_pk_bf16_f32 v195, v162, v160
    ds_write_b128 v23, v[192:195] offset:0
    v_cvt_pk_bf16_f32 v196, v158, v156
    v_cvt_pk_bf16_f32 v197, v154, v152
    v_cvt_pk_bf16_f32 v198, v150, v148
    v_cvt_pk_bf16_f32 v199, v146, v144
    ds_write_b128 v23, v[196:199] offset:16
    v_cvt_pk_bf16_f32 v200, v175, v173
    buffer_load_dwordx4 v13, s[60:63], s11 offen offset:1024 lds
    v_cvt_pk_bf16_f32 v201, v171, v169
    v_cvt_pk_bf16_f32 v202, v167, v165
    v_cvt_pk_bf16_f32 v203, v163, v161
    ds_write_b128 v23, v[200:203] offset:272
    v_cvt_pk_bf16_f32 v204, v159, v157
    v_cvt_pk_bf16_f32 v205, v155, v153
    v_cvt_pk_bf16_f32 v206, v151, v149
    v_cvt_pk_bf16_f32 v207, v147, v145
    ds_write_b128 v23, v[204:207] offset:288
    s_waitcnt lgkmcnt(0)
    buffer_load_dwordx4 v14, s[60:63], s11 offen offset:2048 lds
    buffer_load_dwordx4 v15, s[60:63], s11 offen offset:3072 lds
    s_waitcnt vmcnt(10)
    s_barrier
    s_add_u32 s11, s90, 11
    s_and_b32 s11, s11, 15
    s_lshl_b32 s11, s11, 7
    s_add_u32 m0, s10, 0x10000
    s_nop 0
    buffer_load_dwordx4 v8, s[56:59], s11 offen offset:0 lds
    ds_read_b128 v[192:195], v24 offset:0
    ds_read_b128 v[196:199], v24 offset:1088
    ds_read_b128 v[200:203], v24 offset:2176
    ds_read_b128 v[204:207], v24 offset:3264
    s_waitcnt vmcnt(9)
    s_getreg_b32 s98, hwreg(HW_REG_XCC_ID, 0, 4)
    s_lshl_b32 s98, 0x100, s98
    s_or_b32 s98, s98, 15
    v_and_b32 v246, 7, v1
    v_cmp_eq_u32 s[96:97], s54, v246
    v_cmp_ne_u32 vcc, s98, v247
    s_nop 1
    s_and_b64 vcc, vcc, s[96:97]
    s_cbranch_scc0 h_kvl
    s_waitcnt lgkmcnt(3)
    buffer_store_dwordx4 v[192:195], v27, s[72:75], s80 offen sc1
    s_waitcnt lgkmcnt(2)
    buffer_store_dwordx4 v[196:199], v27, s[72:75], s84 offen sc1
    s_waitcnt lgkmcnt(1)
    buffer_store_dwordx4 v[200:203], v3, s[72:75], s80 offen sc1
    s_waitcnt lgkmcnt(0)
    buffer_store_dwordx4 v[204:207], v3, s[72:75], s84 offen sc1
    s_branch h_kve
h_kvl:
    s_waitcnt lgkmcnt(3)
    buffer_store_dwordx4 v[192:195], v27, s[72:75], s80 offen
    s_waitcnt lgkmcnt(2)
    buffer_store_dwordx4 v[196:199], v27, s[72:75], s84 offen
    s_waitcnt lgkmcnt(1)
    buffer_store_dwordx4 v[200:203], v3, s[72:75], s80 offen
    s_waitcnt lgkmcnt(0)
    buffer_store_dwordx4 v[204:207], v3, s[72:75], s84 offen
h_kve:
    s_lshl_b32 s12, s88, 12
    s_add_u32 s64, s42, s12
    s_addc_u32 s65, s43, 0
    s_mov_b32 s66, 0x1000
    s_mov_b32 s67, 0x20000
    buffer_load_dwordx4 v9, s[56:59], s11 offen offset:1024 lds
    s_add_u32 s68, s52, s12
    s_addc_u32 s69, s53, 0
    s_add_u32 s68, s68, 0x800000
    s_addc_u32 s69, s69, 0
    s_mov_b32 s70, 0x1000
    s_mov_b32 s71, 0x20000
    s_mov_b32 s80, s100
    s_mov_b32 s81, s101
    v_and_b32 v37, 15, v1
    s_lshr_b32 s8, s88, 6
    buffer_load_dwordx4 v10, s[56:59], s11 offen offset:2048 lds
    s_and_b32 s8, s8, 1
    s_lshl_b32 s8, s8, 3
    s_add_u32 s8, s8, s54
    v_lshl_add_u32 v32, v37, 4, s8
    s_lshr_b32 s8, s4, 2
    s_lshl_b32 s8, s8, 1
    s_and_b32 s9, s4, 3
    s_lshl_b32 s9, s9, 3
    s_add_u32 s8, s8, s9
    v_lshrrev_b32 v38, 3, v37
    buffer_load_dwordx4 v11, s[56:59], s11 offen offset:3072 lds
    v_and_b32 v39, 7, v37
    v_lshl_add_u32 v38, v39, 5, v38
    v_add_u32 v38, s8, v38
    v_and_b32 v39, 16, v1
    v_cmp_ne_u32 vcc, 0, v39
    s_nop 1
    v_cndmask_b32 v32, v32, v38, vcc
    v_lshlrev_b32 v32, 7, v32
    v_add_u32 v32, 0x20000, v32
    v_lshlrev_b32 v33, 2, v1
    s_mov_b32 s76, s50
    s_add_u32 m0, s10, 0x14000
    s_nop 0
    buffer_load_dwordx4 v12, s[60:63], s11 offen offset:0 lds
    s_mov_b32 s77, s51
    s_mov_b32 s78, 0x100
    s_mov_b32 s79, 0x20000
    s_mul_i32 s13, s3, 8320
    s_add_u32 s13, s13, 98304
    s_mul_i32 s82, s3, 4608
    s_add_u32 s82, s82, 131584
    v_add_u32 v36, 2, v25
    v_and_b32 v38, 7, v1
    v_lshlrev_b32 v38, 2, v38
    buffer_load_dwordx4 v13, s[60:63], s11 offen offset:1024 lds
    v_bfe_u32 v39, v1, 3, 1
    v_mul_u32_u24 v39, 4160, v39
    v_add3_u32 v38, v38, v39, s13
    s_lshl_b32 s80, s80, 16
    v_mov_b32 v56, s80
    v_cmp_eq_u32 vcc, 15, v37
    s_nop 1
    v_cndmask_b32 v56, 0, v56, vcc
    ds_write_b32 v38, v56
    s_and_b32 s14, s88, 1
    s_lshl_b32 s14, s14, 4
    buffer_load_dwordx4 v14, s[60:63], s11 offen offset:2048 lds
    s_lshr_b32 s81, s81, s14
    s_lshl_b32 s81, s81, 16
    v_mov_b32 v60, 0x24a00
    v_mov_b32 v61, 1
    buffer_load_dwordx4 v15, s[60:63], s11 offen offset:3072 lds
    s_waitcnt vmcnt(12)
    s_barrier
    s_add_u32 s11, s90, 12
    s_and_b32 s11, s11, 15
    s_lshl_b32 s11, s11, 7
    s_add_u32 m0, s10, 0x0
    s_nop 0
    buffer_load_dwordx4 v8, s[56:59], s11 offen offset:0 lds
    buffer_load_dwordx4 v9, s[56:59], s11 offen offset:1024 lds
    buffer_load_dwordx4 v10, s[56:59], s11 offen offset:2048 lds
    buffer_load_dwordx4 v11, s[56:59], s11 offen offset:3072 lds
    s_add_u32 m0, s10, 0x4000
    s_nop 0
    buffer_load_dwordx4 v12, s[60:63], s11 offen offset:0 lds
    buffer_load_dwordx4 v13, s[60:63], s11 offen offset:1024 lds
    buffer_load_dwordx4 v14, s[60:63], s11 offen offset:2048 lds
    buffer_load_dwordx4 v15, s[60:63], s11 offen offset:3072 lds
    s_waitcnt vmcnt(8)
    s_barrier
    s_cmp_lg_u32 s3, 0
    s_cbranch_scc1 h_kflag
    v_mov_b32 v6, 1
    buffer_store_dword v6, v30, s[92:95], 0 offen sc1
h_kflag:
    s_add_u32 s11, s90, 13
    s_and_b32 s11, s11, 15
    s_lshl_b32 s11, s11, 7
    s_add_u32 m0, s10, 0x8000
    s_nop 0
    buffer_load_dwordx4 v8, s[56:59], s11 offen offset:0 lds
    buffer_load_dwordx4 v9, s[56:59], s11 offen offset:1024 lds
    buffer_load_dwordx4 v10, s[56:59], s11 offen offset:2048 lds
    buffer_load_dwordx4 v11, s[56:59], s11 offen offset:3072 lds
    s_add_u32 m0, s10, 0xc000
    s_nop 0
    buffer_load_dwordx4 v12, s[60:63], s11 offen offset:0 lds
    buffer_load_dwordx4 v13, s[60:63], s11 offen offset:1024 lds
    buffer_load_dwordx4 v14, s[60:63], s11 offen offset:2048 lds
    buffer_load_dwordx4 v15, s[60:63], s11 offen offset:3072 lds
    s_waitcnt vmcnt(8)
    s_barrier
    s_add_u32 s11, s90, 14
    s_and_b32 s11, s11, 15
    s_lshl_b32 s11, s11, 7
    s_add_u32 m0, s10, 0x10000
    s_nop 0
    buffer_load_dwordx4 v8, s[56:59], s11 offen offset:0 lds
    buffer_load_dwordx4 v9, s[56:59], s11 offen offset:1024 lds
    buffer_load_dwordx4 v10, s[56:59], s11 offen offset:2048 lds
    buffer_load_dwordx4 v11, s[56:59], s11 offen offset:3072 lds
    s_add_u32 m0, s10, 0x14000
    s_nop 0
    buffer_load_dwordx4 v12, s[60:63], s11 offen offset:0 lds
    buffer_load_dwordx4 v13, s[60:63], s11 offen offset:1024 lds
    buffer_load_dwordx4 v14, s[60:63], s11 offen offset:2048 lds
    buffer_load_dwordx4 v15, s[60:63], s11 offen offset:3072 lds
    s_add_u32 m0, s13, 32
    s_nop 0
    buffer_load_dwordx4 v25, s[64:67], 0 offen offset:0 lds
    buffer_load_dwordx4 v25, s[64:67], 0 offen offset:1024 lds
    buffer_load_dwordx4 v25, s[64:67], 0 offen offset:2048 lds
    buffer_load_dwordx4 v25, s[64:67], 0 offen offset:3072 lds
    s_add_u32 m0, s13, 4192
    s_nop 0
    buffer_load_dwordx4 v36, s[64:67], 0 offen offset:0 lds
    buffer_load_dwordx4 v36, s[64:67], 0 offen offset:1024 lds
    buffer_load_dwordx4 v36, s[64:67], 0 offen offset:2048 lds
    buffer_load_dwordx4 v36, s[64:67], 0 offen offset:3072 lds
    s_waitcnt vmcnt(16)
    s_barrier
    s_add_u32 s11, s90, 15
    s_and_b32 s11, s11, 15
    s_lshl_b32 s11, s11, 7
    s_add_u32 m0, s10, 0x0
    s_nop 0
    buffer_load_dwordx4 v8, s[56:59], s11 offen offset:0 lds
    buffer_load_dwordx4 v9, s[56:59], s11 offen offset:1024 lds
    buffer_load_dwordx4 v10, s[56:59], s11 offen offset:2048 lds
    buffer_load_dwordx4 v11, s[56:59], s11 offen offset:3072 lds
    s_add_u32 m0, s10, 0x4000
    s_nop 0
    buffer_load_dwordx4 v12, s[60:63], s11 offen offset:0 lds
    buffer_load_dwordx4 v13, s[60:63], s11 offen offset:1024 lds
    buffer_load_dwordx4 v14, s[60:63], s11 offen offset:2048 lds
    buffer_load_dwordx4 v15, s[60:63], s11 offen offset:3072 lds
    buffer_load_dword v34, v33, s[76:79], 0 offen sc1
    buffer_load_dword v35, v32, s[92:95], 0 offen sc1
    s_waitcnt vmcnt(18)
    s_barrier
    s_mov_b32 s56, s26
    s_mov_b32 s57, s27
    s_mov_b32 s58, 0x200000
    s_mov_b32 s59, 0x20000
    s_mov_b32 s60, s28
    s_mov_b32 s61, s29
    s_mov_b32 s62, 0x200000
    s_mov_b32 s63, 0x20000
    s_lshl_b32 s10, s3, 11
    s_add_u32 s10, s10, 0x8000
    s_lshr_b32 s90, s5, 3
    s_xor_b32 s91, s90, 1
    s_lshl_b32 s91, s91, 20
    s_lshl_b32 s11, s90, 10
    s_add_u32 s91, s91, s11
    s_mul_i32 s90, s90, 0x100400
    v_mov_b32 v56, 0
    v_mov_b32 v57, 0
    v_lshlrev_b32 v38, 3, v1
    v_add_u32 v38, s82, v38
    ds_write_b64 v38, v[56:57] offset:4096
    s_waitcnt vmcnt(0)
    s_mov_b32 s83, 0
    v_and_b32 v34, 15, v34
    v_cmp_ne_u32 vcc, 15, v34
    v_cmp_ne_u32 s[84:85], 1, v35
    s_nop 1
    s_or_b64 vcc, vcc, s[84:85]
    s_cbranch_scc1 h_nou
    s_mov_b32 s83, 1
    buffer_load_dwordx4 v[40:43], v25, s[68:71], 0 offen offset:0 sc1
    buffer_load_dwordx4 v[44:47], v25, s[68:71], 0 offen offset:1024 sc1
    buffer_load_dwordx4 v[48:51], v25, s[68:71], 0 offen offset:2048 sc1
    buffer_load_dwordx4 v[52:55], v25, s[68:71], 0 offen offset:3072 sc1
h_nou:
    s_barrier
    v_lshrrev_b32 v5, 4, v1
    v_and_b32 v37, 15, v1
    v_lshl_add_u32 v38, v5, 3, v37
    v_lshlrev_b32 v38, 1, v38
    v_and_b32 v39, 1, v1
    v_mul_u32_u24 v39, 4158, v39
    v_sub_u32 v38, v38, v39
    s_add_u32 s14, s13, 4160
    v_add_u32 v16, s14, v38
    v_add_u32 v17, 1024, v16
    v_add_u32 v18, 2048, v16
    v_add_u32 v19, 3072, v16
    v_lshlrev_b32 v38, 5, v37
    v_lshlrev_b32 v39, 4, v5
    v_sub_u32 v20, v39, v38
    s_add_u32 s14, s82, 480
    v_add_u32 v20, s14, v20
    v_lshl_add_u32 v39, v5, 3, v38
    s_add_u32 s14, s82, 504
    v_sub_u32 v21, s14, v39
    v_and_b32 v39, 1, v5
    v_lshl_add_u32 v22, v39, 9, v38
    v_lshrrev_b32 v39, 1, v5
    v_lshl_add_u32 v22, v39, 4, v22
    v_add_u32 v23, s82, v25
    s_cmp_lg_u32 s83, 1
    s_cbranch_scc1 h_nouw
    s_waitcnt vmcnt(0)
    ds_write_b128 v23, v[40:43] offset:0
    ds_write_b128 v23, v[44:47] offset:1024
    ds_write_b128 v23, v[48:51] offset:2048
    ds_write_b128 v23, v[52:55] offset:3072
h_nouw:
    s_barrier
    s_mov_b32 s11, s15
    s_lshl_b32 s11, s11, 7
    s_add_u32 s99, s11, s91
    s_add_u32 m0, s10, 0x0
    s_nop 0
    buffer_load_dwordx4 v28, s[56:59], s99 offen offset:0 lds
    buffer_load_dwordx4 v29, s[56:59], s99 offen offset:1024 lds
    s_add_u32 s11, s11, s90
    s_add_u32 m0, s10, 0x2000
    s_nop 0
    buffer_load_dwordx4 v28, s[56:59], s11 offen offset:0 lds
    buffer_load_dwordx4 v29, s[56:59], s11 offen offset:1024 lds
    s_mov_b32 s11, s15
    s_lshl_b32 s11, s11, 7
    s_add_u32 s99, s11, s91
    s_add_u32 m0, s10, 0x4000
    s_nop 0
    buffer_load_dwordx4 v28, s[60:63], s99 offen offset:0 lds
    buffer_load_dwordx4 v29, s[60:63], s99 offen offset:1024 lds
    s_add_u32 s11, s11, s90
    s_add_u32 m0, s10, 0x6000
    s_nop 0
    buffer_load_dwordx4 v28, s[60:63], s11 offen offset:0 lds
    buffer_load_dwordx4 v29, s[60:63], s11 offen offset:1024 lds
    s_cmp_lg_u32 s83, 0
    s_cbranch_scc1 h_haveu
    s_mov_b32 s89, 65536
h_init_chk:
    v_and_b32 v34, 15, v34
    v_cmp_ne_u32 vcc, 15, v34
    s_nop 1
    s_cmp_eq_u64 vcc, 0
    s_cbranch_scc1 h_init_ok
    s_sub_u32 s89, s89, 1
    s_cbranch_scc1 h_init_ok
    s_sleep 4
    buffer_load_dword v34, v33, s[76:79], 0 offen sc1
    s_waitcnt vmcnt(0)
    s_branch h_init_chk
h_init_ok:
    s_mov_b32 s89, 65536
h_kf_chk:
    v_cmp_ne_u32 vcc, 1, v35
    s_nop 1
    s_cmp_eq_u64 vcc, 0
    s_cbranch_scc1 h_kf_ok
    s_sub_u32 s89, s89, 1
    s_cbranch_scc1 h_kf_ok
    s_sleep 4
    buffer_load_dword v35, v32, s[92:95], 0 offen sc1
    s_waitcnt vmcnt(0)
    s_branch h_kf_chk
h_kf_ok:
    buffer_load_dwordx4 v[40:43], v25, s[68:71], 0 offen offset:0 sc1
    buffer_load_dwordx4 v[44:47], v25, s[68:71], 0 offen offset:1024 sc1
    buffer_load_dwordx4 v[48:51], v25, s[68:71], 0 offen offset:2048 sc1
    buffer_load_dwordx4 v[52:55], v25, s[68:71], 0 offen offset:3072 sc1
    s_waitcnt vmcnt(0)
    ds_write_b128 v23, v[40:43] offset:0
    ds_write_b128 v23, v[44:47] offset:1024
    ds_write_b128 v23, v[48:51] offset:2048
    ds_write_b128 v23, v[52:55] offset:3072
h_haveu:
    s_mov_b64 exec, 1
    ds_add_u32 v60, v61 offset:8
    s_mov_b64 exec, -1
    s_mov_b32 s84, s68
    s_mov_b32 s85, s69
    s_mov_b32 s86, s70
    s_mov_b32 s87, s71
    s_add_u32 s68, s52, 0x800000
    s_addc_u32 s69, s53, 0
    s_mov_b32 s70, 0x400000
    s_mov_b32 s71, 0x20000
    s_waitcnt lgkmcnt(0)
    ds_read_b64 v[40:41], v21 offset:3584
    ds_read_b64 v[42:43], v21 offset:3072
    ds_read_b64 v[44:45], v21 offset:2560
    ds_read_b64 v[46:47], v21 offset:2048
    ds_read_b64 v[48:49], v21 offset:1536
    ds_read_b64 v[50:51], v21 offset:1024
    ds_read_b64 v[52:53], v21 offset:512
    ds_read_b64 v[54:55], v21 offset:0
    ds_read2_b32 v[160:161], v16 offset0:0 offset1:1
    ds_read2_b32 v[162:163], v16 offset0:2 offset1:3
    ds_read_b128 v[96:99], v20 offset:3584
    ds_read_b128 v[100:103], v20 offset:3072
    ds_read_b128 v[104:107], v20 offset:2560
    ds_read_b128 v[108:111], v20 offset:2048
    ds_read_b128 v[112:115], v20 offset:1536
    ds_read_b128 v[116:119], v20 offset:1024
    ds_read_b128 v[120:123], v20 offset:512
    ds_read_b128 v[124:127], v20 offset:0
    ds_read2_b32 v[164:165], v16 offset0:128 offset1:129
    ds_read2_b32 v[166:167], v16 offset0:130 offset1:131
    ds_read2_b32 v[168:169], v17 offset0:0 offset1:1
    ds_read2_b32 v[170:171], v17 offset0:2 offset1:3
    ds_read2_b32 v[172:173], v17 offset0:128 offset1:129
    ds_read2_b32 v[174:175], v17 offset0:130 offset1:131
    ds_read2_b32 v[176:177], v18 offset0:0 offset1:1
    ds_read2_b32 v[178:179], v18 offset0:2 offset1:3
    ds_read2_b32 v[180:181], v18 offset0:128 offset1:129
    ds_read2_b32 v[182:183], v18 offset0:130 offset1:131
    ds_read2_b32 v[184:185], v19 offset0:0 offset1:1
    ds_read2_b32 v[186:187], v19 offset0:2 offset1:3
    ds_read2_b32 v[188:189], v19 offset0:128 offset1:129
    ds_read2_b32 v[190:191], v19 offset0:130 offset1:131
    s_waitcnt lgkmcnt(15)
    v_mfma_f32_16x16x32_bf16 v[64:67], v[160:163], v[96:99], 0
    s_mov_b32 s12, 0xffff0000
    v_mov_b32 v26, s81
    v_mfma_f32_16x16x32_bf16 v[68:71], v[160:163], v[100:103], 0
    ds_read2_b32 v[192:193], v16 offset0:16 offset1:17
    v_mfma_f32_16x16x32_bf16 v[72:75], v[160:163], v[104:107], 0
    ds_read2_b32 v[194:195], v16 offset0:18 offset1:19
    v_mfma_f32_16x16x32_bf16 v[76:79], v[160:163], v[108:111], 0
    ds_read_b128 v[128:131], v20 offset:3648
    v_mfma_f32_16x16x32_bf16 v[80:83], v[160:163], v[112:115], 0
    ds_read_b128 v[132:135], v20 offset:3136
    v_mfma_f32_16x16x32_bf16 v[84:87], v[160:163], v[116:119], 0
    ds_read_b128 v[136:139], v20 offset:2624
    v_mfma_f32_16x16x32_bf16 v[88:91], v[160:163], v[120:123], 0
    ds_read_b128 v[140:143], v20 offset:2112
    s_waitcnt lgkmcnt(15)
    v_mfma_f32_16x16x32_bf16 v[92:95], v[160:163], v[124:127], 0
    ds_read_b128 v[144:147], v20 offset:1600
    v_mfma_f32_16x16x32_bf16 v[68:71], v[164:167], v[96:99], v[68:71]
    ds_read_b128 v[148:151], v20 offset:1088
    v_mfma_f32_16x16x32_bf16 v[72:75], v[164:167], v[100:103], v[72:75]
    ds_read_b128 v[152:155], v20 offset:576
    v_mfma_f32_16x16x32_bf16 v[76:79], v[164:167], v[104:107], v[76:79]
    ds_read_b128 v[156:159], v20 offset:64
    v_mfma_f32_16x16x32_bf16 v[80:83], v[164:167], v[108:111], v[80:83]
    ds_read2_b32 v[196:197], v16 offset0:144 offset1:145
    v_mfma_f32_16x16x32_bf16 v[84:87], v[164:167], v[112:115], v[84:87]
    ds_read2_b32 v[198:199], v16 offset0:146 offset1:147
    v_mfma_f32_16x16x32_bf16 v[88:91], v[164:167], v[116:119], v[88:91]
    ds_read2_b32 v[200:201], v17 offset0:16 offset1:17
    v_mfma_f32_16x16x32_bf16 v[92:95], v[164:167], v[120:123], v[92:95]
    ds_read2_b32 v[202:203], v17 offset0:18 offset1:19
    v_mfma_f32_16x16x32_bf16 v[72:75], v[168:171], v[96:99], v[72:75]
    ds_read2_b32 v[204:205], v17 offset0:144 offset1:145
    v_mfma_f32_16x16x32_bf16 v[76:79], v[168:171], v[100:103], v[76:79]
    ds_read2_b32 v[206:207], v17 offset0:146 offset1:147
    v_mfma_f32_16x16x32_bf16 v[80:83], v[168:171], v[104:107], v[80:83]
    ds_read2_b32 v[208:209], v18 offset0:16 offset1:17
    v_mfma_f32_16x16x32_bf16 v[84:87], v[168:171], v[108:111], v[84:87]
    ds_read2_b32 v[210:211], v18 offset0:18 offset1:19
    v_mfma_f32_16x16x32_bf16 v[88:91], v[168:171], v[112:115], v[88:91]
    ds_read2_b32 v[212:213], v18 offset0:144 offset1:145
    v_mfma_f32_16x16x32_bf16 v[92:95], v[168:171], v[116:119], v[92:95]
    ds_read2_b32 v[214:215], v18 offset0:146 offset1:147
    s_waitcnt lgkmcnt(15)
    v_mfma_f32_16x16x32_bf16 v[76:79], v[172:175], v[96:99], v[76:79]
    ds_read2_b32 v[216:217], v19 offset0:16 offset1:17
    v_mfma_f32_16x16x32_bf16 v[80:83], v[172:175], v[100:103], v[80:83]
    ds_read2_b32 v[218:219], v19 offset0:18 offset1:19
    v_mfma_f32_16x16x32_bf16 v[84:87], v[172:175], v[104:107], v[84:87]
    ds_read2_b32 v[220:221], v19 offset0:144 offset1:145
    v_mfma_f32_16x16x32_bf16 v[88:91], v[172:175], v[108:111], v[88:91]
    ds_read2_b32 v[222:223], v19 offset0:146 offset1:147
    v_mfma_f32_16x16x32_bf16 v[92:95], v[172:175], v[112:115], v[92:95]
    v_and_b32 v224, s12, v41
    v_lshlrev_b32 v225, 16, v41
    v_mfma_f32_16x16x32_bf16 v[80:83], v[176:179], v[96:99], v[80:83]
    v_and_b32 v226, s12, v40
    v_lshlrev_b32 v227, 16, v40
    v_mfma_f32_16x16x32_bf16 v[84:87], v[176:179], v[100:103], v[84:87]
    v_mul_f32 v224, v224, v26
    v_mul_f32 v225, v225, v26
    v_mfma_f32_16x16x32_bf16 v[88:91], v[176:179], v[104:107], v[88:91]
    v_mul_f32 v226, v226, v26
    v_mul_f32 v227, v227, v26
    v_mfma_f32_16x16x32_bf16 v[92:95], v[176:179], v[108:111], v[92:95]
    v_cvt_pk_bf16_f32 v56, v224, v225
    v_cvt_pk_bf16_f32 v57, v226, v227
    v_mfma_f32_16x16x32_bf16 v[84:87], v[180:183], v[96:99], v[84:87]
    v_lshlrev_b32 v224, 16, v56
    v_and_b32 v225, s12, v56
    v_mfma_f32_16x16x32_bf16 v[88:91], v[180:183], v[100:103], v[88:91]
    v_lshlrev_b32 v226, 16, v57
    v_and_b32 v227, s12, v57
    v_mfma_f32_16x16x32_bf16 v[92:95], v[180:183], v[104:107], v[92:95]
    v_and_b32 v228, s12, v43
    v_lshlrev_b32 v229, 16, v43
    v_mfma_f32_16x16x32_bf16 v[88:91], v[184:187], v[96:99], v[88:91]
    v_and_b32 v230, s12, v42
    v_lshlrev_b32 v231, 16, v42
    v_mfma_f32_16x16x32_bf16 v[92:95], v[184:187], v[100:103], v[92:95]
    v_mul_f32 v228, v228, v26
    v_mul_f32 v229, v229, v26
    v_mfma_f32_16x16x32_bf16 v[92:95], v[188:191], v[96:99], v[92:95]
    v_mul_f32 v230, v230, v26
    v_mul_f32 v231, v231, v26
    v_mfma_f32_16x16x32_bf16 v[64:67], v[192:195], v[128:131], v[64:67]
    v_cvt_pk_bf16_f32 v56, v228, v229
    v_cvt_pk_bf16_f32 v57, v230, v231
    v_mfma_f32_16x16x32_bf16 v[68:71], v[192:195], v[132:135], v[68:71]
    ds_read2_b32 v[160:161], v16 offset0:32 offset1:33
    v_mfma_f32_16x16x32_bf16 v[72:75], v[192:195], v[136:139], v[72:75]
    ds_read2_b32 v[162:163], v16 offset0:34 offset1:35
    s_waitcnt lgkmcnt(15)
    v_mfma_f32_16x16x32_bf16 v[76:79], v[192:195], v[140:143], v[76:79]
    ds_read_b128 v[96:99], v20 offset:3712
    v_mfma_f32_16x16x32_bf16 v[80:83], v[192:195], v[144:147], v[80:83]
    ds_read_b128 v[100:103], v20 offset:3200
    v_mfma_f32_16x16x32_bf16 v[84:87], v[192:195], v[148:151], v[84:87]
    ds_read_b128 v[104:107], v20 offset:2688
    v_mfma_f32_16x16x32_bf16 v[88:91], v[192:195], v[152:155], v[88:91]
    ds_read_b128 v[108:111], v20 offset:2176
    v_mfma_f32_16x16x32_bf16 v[92:95], v[192:195], v[156:159], v[92:95]
    ds_read_b128 v[112:115], v20 offset:1664
    s_waitcnt lgkmcnt(15)
    v_mfma_f32_16x16x32_bf16 v[68:71], v[196:199], v[128:131], v[68:71]
    ds_read_b128 v[116:119], v20 offset:1152
    v_mfma_f32_16x16x32_bf16 v[72:75], v[196:199], v[132:135], v[72:75]
    ds_read_b128 v[120:123], v20 offset:640
    v_mfma_f32_16x16x32_bf16 v[76:79], v[196:199], v[136:139], v[76:79]
    ds_read_b128 v[124:127], v20 offset:128
    v_mfma_f32_16x16x32_bf16 v[80:83], v[196:199], v[140:143], v[80:83]
    ds_read2_b32 v[164:165], v16 offset0:160 offset1:161
    v_mfma_f32_16x16x32_bf16 v[84:87], v[196:199], v[144:147], v[84:87]
    ds_read2_b32 v[166:167], v16 offset0:162 offset1:163
    v_mfma_f32_16x16x32_bf16 v[88:91], v[196:199], v[148:151], v[88:91]
    ds_read2_b32 v[168:169], v17 offset0:32 offset1:33
    v_mfma_f32_16x16x32_bf16 v[92:95], v[196:199], v[152:155], v[92:95]
    ds_read2_b32 v[170:171], v17 offset0:34 offset1:35
    v_mfma_f32_16x16x32_bf16 v[72:75], v[200:203], v[128:131], v[72:75]
    ds_read2_b32 v[172:173], v17 offset0:160 offset1:161
    v_mfma_f32_16x16x32_bf16 v[76:79], v[200:203], v[132:135], v[76:79]
    ds_read2_b32 v[174:175], v17 offset0:162 offset1:163
    v_mfma_f32_16x16x32_bf16 v[80:83], v[200:203], v[136:139], v[80:83]
    ds_read2_b32 v[176:177], v18 offset0:32 offset1:33
    v_mfma_f32_16x16x32_bf16 v[84:87], v[200:203], v[140:143], v[84:87]
    ds_read2_b32 v[178:179], v18 offset0:34 offset1:35
    v_mfma_f32_16x16x32_bf16 v[88:91], v[200:203], v[144:147], v[88:91]
    ds_read2_b32 v[180:181], v18 offset0:160 offset1:161
    v_mfma_f32_16x16x32_bf16 v[92:95], v[200:203], v[148:151], v[92:95]
    ds_read2_b32 v[182:183], v18 offset0:162 offset1:163
    v_mfma_f32_16x16x32_bf16 v[76:79], v[204:207], v[128:131], v[76:79]
    ds_read2_b32 v[184:185], v19 offset0:32 offset1:33
    v_mfma_f32_16x16x32_bf16 v[80:83], v[204:207], v[132:135], v[80:83]
    ds_read2_b32 v[186:187], v19 offset0:34 offset1:35
    v_mfma_f32_16x16x32_bf16 v[84:87], v[204:207], v[136:139], v[84:87]
    ds_read2_b32 v[188:189], v19 offset0:160 offset1:161
    v_mfma_f32_16x16x32_bf16 v[88:91], v[204:207], v[140:143], v[88:91]
    ds_read2_b32 v[190:191], v19 offset0:162 offset1:163
    v_mfma_f32_16x16x32_bf16 v[92:95], v[204:207], v[144:147], v[92:95]
    v_lshlrev_b32 v228, 16, v56
    v_and_b32 v229, s12, v56
    s_waitcnt lgkmcnt(15)
    v_mfma_f32_16x16x32_bf16 v[80:83], v[208:211], v[128:131], v[80:83]
    v_lshlrev_b32 v230, 16, v57
    v_and_b32 v231, s12, v57
    v_mfma_f32_16x16x32_bf16 v[84:87], v[208:211], v[132:135], v[84:87]
    v_and_b32 v232, s12, v45
    v_lshlrev_b32 v233, 16, v45
    v_mfma_f32_16x16x32_bf16 v[88:91], v[208:211], v[136:139], v[88:91]
    v_and_b32 v234, s12, v44
    v_lshlrev_b32 v235, 16, v44
    v_mfma_f32_16x16x32_bf16 v[92:95], v[208:211], v[140:143], v[92:95]
    v_mul_f32 v232, v232, v26
    v_mul_f32 v233, v233, v26
    v_mfma_f32_16x16x32_bf16 v[84:87], v[212:215], v[128:131], v[84:87]
    v_mul_f32 v234, v234, v26
    v_mul_f32 v235, v235, v26
    v_mfma_f32_16x16x32_bf16 v[88:91], v[212:215], v[132:135], v[88:91]
    v_cvt_pk_bf16_f32 v56, v232, v233
    v_cvt_pk_bf16_f32 v57, v234, v235
    v_mfma_f32_16x16x32_bf16 v[92:95], v[212:215], v[136:139], v[92:95]
    v_lshlrev_b32 v232, 16, v56
    v_and_b32 v233, s12, v56
    v_mfma_f32_16x16x32_bf16 v[88:91], v[216:219], v[128:131], v[88:91]
    v_lshlrev_b32 v234, 16, v57
    v_and_b32 v235, s12, v57
    v_mfma_f32_16x16x32_bf16 v[92:95], v[216:219], v[132:135], v[92:95]
    v_and_b32 v236, s12, v47
    v_lshlrev_b32 v237, 16, v47
    v_mfma_f32_16x16x32_bf16 v[92:95], v[220:223], v[128:131], v[92:95]
    v_and_b32 v238, s12, v46
    v_lshlrev_b32 v239, 16, v46
    v_mfma_f32_16x16x32_bf16 v[64:67], v[160:163], v[96:99], v[64:67]
    v_mul_f32 v236, v236, v26
    v_mul_f32 v237, v237, v26
    v_mfma_f32_16x16x32_bf16 v[68:71], v[160:163], v[100:103], v[68:71]
    ds_read2_b32 v[192:193], v16 offset0:48 offset1:49
    v_mfma_f32_16x16x32_bf16 v[72:75], v[160:163], v[104:107], v[72:75]
    ds_read2_b32 v[194:195], v16 offset0:50 offset1:51
    v_mfma_f32_16x16x32_bf16 v[76:79], v[160:163], v[108:111], v[76:79]
    ds_read_b128 v[128:131], v20 offset:3776
    v_mfma_f32_16x16x32_bf16 v[80:83], v[160:163], v[112:115], v[80:83]
    ds_read_b128 v[132:135], v20 offset:3264
    v_mfma_f32_16x16x32_bf16 v[84:87], v[160:163], v[116:119], v[84:87]
    ds_read_b128 v[136:139], v20 offset:2752
    v_mfma_f32_16x16x32_bf16 v[88:91], v[160:163], v[120:123], v[88:91]
    ds_read_b128 v[140:143], v20 offset:2240
    s_waitcnt lgkmcnt(15)
    v_mfma_f32_16x16x32_bf16 v[92:95], v[160:163], v[124:127], v[92:95]
    ds_read_b128 v[144:147], v20 offset:1728
    s_waitcnt vmcnt(0)
    s_mov_b64 exec, 1
    ds_add_u32 v60, v61 offset:16
    s_mov_b64 exec, -1
    v_mfma_f32_16x16x32_bf16 v[68:71], v[164:167], v[96:99], v[68:71]
    ds_read_b128 v[148:151], v20 offset:1216
    v_mfma_f32_16x16x32_bf16 v[72:75], v[164:167], v[100:103], v[72:75]
    ds_read_b128 v[152:155], v20 offset:704
    v_mfma_f32_16x16x32_bf16 v[76:79], v[164:167], v[104:107], v[76:79]
    ds_read_b128 v[156:159], v20 offset:192
    v_mfma_f32_16x16x32_bf16 v[80:83], v[164:167], v[108:111], v[80:83]
    ds_read2_b32 v[196:197], v16 offset0:176 offset1:177
    v_mfma_f32_16x16x32_bf16 v[84:87], v[164:167], v[112:115], v[84:87]
    ds_read2_b32 v[198:199], v16 offset0:178 offset1:179
    v_mfma_f32_16x16x32_bf16 v[88:91], v[164:167], v[116:119], v[88:91]
    ds_read2_b32 v[200:201], v17 offset0:48 offset1:49
    v_mfma_f32_16x16x32_bf16 v[92:95], v[164:167], v[120:123], v[92:95]
    ds_read2_b32 v[202:203], v17 offset0:50 offset1:51
    v_mfma_f32_16x16x32_bf16 v[72:75], v[168:171], v[96:99], v[72:75]
    ds_read2_b32 v[204:205], v17 offset0:176 offset1:177
    v_mfma_f32_16x16x32_bf16 v[76:79], v[168:171], v[100:103], v[76:79]
    ds_read2_b32 v[206:207], v17 offset0:178 offset1:179
    v_mfma_f32_16x16x32_bf16 v[80:83], v[168:171], v[104:107], v[80:83]
    ds_read2_b32 v[208:209], v18 offset0:48 offset1:49
    v_mfma_f32_16x16x32_bf16 v[84:87], v[168:171], v[108:111], v[84:87]
    ds_read2_b32 v[210:211], v18 offset0:50 offset1:51
    v_mfma_f32_16x16x32_bf16 v[88:91], v[168:171], v[112:115], v[88:91]
    ds_read2_b32 v[212:213], v18 offset0:176 offset1:177
    v_mfma_f32_16x16x32_bf16 v[92:95], v[168:171], v[116:119], v[92:95]
    ds_read2_b32 v[214:215], v18 offset0:178 offset1:179
    s_waitcnt lgkmcnt(15)
    v_mfma_f32_16x16x32_bf16 v[76:79], v[172:175], v[96:99], v[76:79]
    ds_read2_b32 v[216:217], v19 offset0:48 offset1:49
    v_mfma_f32_16x16x32_bf16 v[80:83], v[172:175], v[100:103], v[80:83]
    ds_read2_b32 v[218:219], v19 offset0:50 offset1:51
    v_mfma_f32_16x16x32_bf16 v[84:87], v[172:175], v[104:107], v[84:87]
    ds_read2_b32 v[220:221], v19 offset0:176 offset1:177
    v_mfma_f32_16x16x32_bf16 v[88:91], v[172:175], v[108:111], v[88:91]
    ds_read2_b32 v[222:223], v19 offset0:178 offset1:179
    v_mfma_f32_16x16x32_bf16 v[92:95], v[172:175], v[112:115], v[92:95]
    v_mul_f32 v238, v238, v26
    v_mul_f32 v239, v239, v26
    v_mfma_f32_16x16x32_bf16 v[80:83], v[176:179], v[96:99], v[80:83]
    v_cvt_pk_bf16_f32 v56, v236, v237
    v_cvt_pk_bf16_f32 v57, v238, v239
    v_mfma_f32_16x16x32_bf16 v[84:87], v[176:179], v[100:103], v[84:87]
    v_lshlrev_b32 v236, 16, v56
    v_and_b32 v237, s12, v56
    v_mfma_f32_16x16x32_bf16 v[88:91], v[176:179], v[104:107], v[88:91]
    v_lshlrev_b32 v238, 16, v57
    v_and_b32 v239, s12, v57
    v_mfma_f32_16x16x32_bf16 v[92:95], v[176:179], v[108:111], v[92:95]
    v_and_b32 v240, s12, v49
    v_lshlrev_b32 v241, 16, v49
    v_mfma_f32_16x16x32_bf16 v[84:87], v[180:183], v[96:99], v[84:87]
    v_and_b32 v242, s12, v48
    v_lshlrev_b32 v243, 16, v48
    v_mfma_f32_16x16x32_bf16 v[88:91], v[180:183], v[100:103], v[88:91]
    v_mul_f32 v240, v240, v26
    v_mul_f32 v241, v241, v26
    v_mfma_f32_16x16x32_bf16 v[92:95], v[180:183], v[104:107], v[92:95]
    v_mul_f32 v242, v242, v26
    v_mul_f32 v243, v243, v26
    v_mfma_f32_16x16x32_bf16 v[88:91], v[184:187], v[96:99], v[88:91]
    v_cvt_pk_bf16_f32 v56, v240, v241
    v_cvt_pk_bf16_f32 v57, v242, v243
    v_mfma_f32_16x16x32_bf16 v[92:95], v[184:187], v[100:103], v[92:95]
    v_lshlrev_b32 v240, 16, v56
    v_and_b32 v241, s12, v56
    v_mfma_f32_16x16x32_bf16 v[92:95], v[188:191], v[96:99], v[92:95]
    v_lshlrev_b32 v242, 16, v57
    v_and_b32 v243, s12, v57
    v_mfma_f32_16x16x32_bf16 v[64:67], v[192:195], v[128:131], v[64:67]
    v_and_b32 v244, s12, v51
    v_lshlrev_b32 v245, 16, v51
    v_mfma_f32_16x16x32_bf16 v[68:71], v[192:195], v[132:135], v[68:71]
    ds_read2_b32 v[160:161], v16 offset0:64 offset1:65
    v_mfma_f32_16x16x32_bf16 v[72:75], v[192:195], v[136:139], v[72:75]
    ds_read2_b32 v[162:163], v16 offset0:66 offset1:67
    v_mfma_f32_16x16x32_bf16 v[76:79], v[192:195], v[140:143], v[76:79]
    ds_read_b128 v[96:99], v20 offset:3840
    s_waitcnt lgkmcnt(15)
    v_mfma_f32_16x16x32_bf16 v[80:83], v[192:195], v[144:147], v[80:83]
    ds_read_b128 v[100:103], v20 offset:3328
    v_mfma_f32_16x16x32_bf16 v[84:87], v[192:195], v[148:151], v[84:87]
    ds_read_b128 v[104:107], v20 offset:2816
    v_mfma_f32_16x16x32_bf16 v[88:91], v[192:195], v[152:155], v[88:91]
    ds_read_b128 v[108:111], v20 offset:2304
    v_mfma_f32_16x16x32_bf16 v[92:95], v[192:195], v[156:159], v[92:95]
    ds_read_b128 v[112:115], v20 offset:1792
    v_mfma_f32_16x16x32_bf16 v[68:71], v[196:199], v[128:131], v[68:71]
    ds_read_b128 v[116:119], v20 offset:1280
    v_mfma_f32_16x16x32_bf16 v[72:75], v[196:199], v[132:135], v[72:75]
    ds_read_b128 v[120:123], v20 offset:768
    v_mfma_f32_16x16x32_bf16 v[76:79], v[196:199], v[136:139], v[76:79]
    ds_read_b128 v[124:127], v20 offset:256
    v_mfma_f32_16x16x32_bf16 v[80:83], v[196:199], v[140:143], v[80:83]
    ds_read2_b32 v[164:165], v16 offset0:192 offset1:193
    v_mfma_f32_16x16x32_bf16 v[84:87], v[196:199], v[144:147], v[84:87]
    ds_read2_b32 v[166:167], v16 offset0:194 offset1:195
    v_mfma_f32_16x16x32_bf16 v[88:91], v[196:199], v[148:151], v[88:91]
    ds_read2_b32 v[168:169], v17 offset0:64 offset1:65
    v_mfma_f32_16x16x32_bf16 v[92:95], v[196:199], v[152:155], v[92:95]
    ds_read2_b32 v[170:171], v17 offset0:66 offset1:67
    s_waitcnt lgkmcnt(15)
    v_mfma_f32_16x16x32_bf16 v[72:75], v[200:203], v[128:131], v[72:75]
    ds_read2_b32 v[172:173], v17 offset0:192 offset1:193
    v_mfma_f32_16x16x32_bf16 v[76:79], v[200:203], v[132:135], v[76:79]
    ds_read2_b32 v[174:175], v17 offset0:194 offset1:195
    v_mfma_f32_16x16x32_bf16 v[80:83], v[200:203], v[136:139], v[80:83]
    ds_read2_b32 v[176:177], v18 offset0:64 offset1:65
    v_mfma_f32_16x16x32_bf16 v[84:87], v[200:203], v[140:143], v[84:87]
    ds_read2_b32 v[178:179], v18 offset0:66 offset1:67
    v_mfma_f32_16x16x32_bf16 v[88:91], v[200:203], v[144:147], v[88:91]
    ds_read2_b32 v[180:181], v18 offset0:192 offset1:193
    v_mfma_f32_16x16x32_bf16 v[92:95], v[200:203], v[148:151], v[92:95]
    ds_read2_b32 v[182:183], v18 offset0:194 offset1:195
    v_mfma_f32_16x16x32_bf16 v[76:79], v[204:207], v[128:131], v[76:79]
    ds_read2_b32 v[184:185], v19 offset0:64 offset1:65
    v_mfma_f32_16x16x32_bf16 v[80:83], v[204:207], v[132:135], v[80:83]
    ds_read2_b32 v[186:187], v19 offset0:66 offset1:67
    v_mfma_f32_16x16x32_bf16 v[84:87], v[204:207], v[136:139], v[84:87]
    ds_read2_b32 v[188:189], v19 offset0:192 offset1:193
    v_mfma_f32_16x16x32_bf16 v[88:91], v[204:207], v[140:143], v[88:91]
    ds_read2_b32 v[190:191], v19 offset0:194 offset1:195
    v_mfma_f32_16x16x32_bf16 v[92:95], v[204:207], v[144:147], v[92:95]
    v_and_b32 v246, s12, v50
    v_lshlrev_b32 v247, 16, v50
    v_mfma_f32_16x16x32_bf16 v[80:83], v[208:211], v[128:131], v[80:83]
    v_mul_f32 v244, v244, v26
    v_mul_f32 v245, v245, v26
    v_mfma_f32_16x16x32_bf16 v[84:87], v[208:211], v[132:135], v[84:87]
    v_mul_f32 v246, v246, v26
    v_mul_f32 v247, v247, v26
    v_mfma_f32_16x16x32_bf16 v[88:91], v[208:211], v[136:139], v[88:91]
    v_cvt_pk_bf16_f32 v56, v244, v245
    v_cvt_pk_bf16_f32 v57, v246, v247
    v_mfma_f32_16x16x32_bf16 v[92:95], v[208:211], v[140:143], v[92:95]
    v_lshlrev_b32 v244, 16, v56
    v_and_b32 v245, s12, v56
    v_mfma_f32_16x16x32_bf16 v[84:87], v[212:215], v[128:131], v[84:87]
    v_lshlrev_b32 v246, 16, v57
    v_and_b32 v247, s12, v57
    v_mfma_f32_16x16x32_bf16 v[88:91], v[212:215], v[132:135], v[88:91]
    v_and_b32 v248, s12, v53
    v_lshlrev_b32 v249, 16, v53
    v_mfma_f32_16x16x32_bf16 v[92:95], v[212:215], v[136:139], v[92:95]
    v_and_b32 v250, s12, v52
    v_lshlrev_b32 v251, 16, v52
    v_mfma_f32_16x16x32_bf16 v[88:91], v[216:219], v[128:131], v[88:91]
    v_mul_f32 v248, v248, v26
    v_mul_f32 v249, v249, v26
    v_mfma_f32_16x16x32_bf16 v[92:95], v[216:219], v[132:135], v[92:95]
    v_mul_f32 v250, v250, v26
    v_mul_f32 v251, v251, v26
    s_waitcnt lgkmcnt(15)
    v_mfma_f32_16x16x32_bf16 v[92:95], v[220:223], v[128:131], v[92:95]
    v_cvt_pk_bf16_f32 v56, v248, v249
    v_cvt_pk_bf16_f32 v57, v250, v251
    v_mfma_f32_16x16x32_bf16 v[64:67], v[160:163], v[96:99], v[64:67]
    v_lshlrev_b32 v248, 16, v56
    v_and_b32 v249, s12, v56
    v_mfma_f32_16x16x32_bf16 v[68:71], v[160:163], v[100:103], v[68:71]
    ds_read2_b32 v[192:193], v16 offset0:80 offset1:81
    v_mfma_f32_16x16x32_bf16 v[72:75], v[160:163], v[104:107], v[72:75]
    ds_read2_b32 v[194:195], v16 offset0:82 offset1:83
    v_mfma_f32_16x16x32_bf16 v[76:79], v[160:163], v[108:111], v[76:79]
    ds_read_b128 v[128:131], v20 offset:3904
    v_mfma_f32_16x16x32_bf16 v[80:83], v[160:163], v[112:115], v[80:83]
    ds_read_b128 v[132:135], v20 offset:3392
    v_mfma_f32_16x16x32_bf16 v[84:87], v[160:163], v[116:119], v[84:87]
    ds_read_b128 v[136:139], v20 offset:2880
    v_mfma_f32_16x16x32_bf16 v[88:91], v[160:163], v[120:123], v[88:91]
    ds_read_b128 v[140:143], v20 offset:2368
    s_waitcnt lgkmcnt(15)
    v_mfma_f32_16x16x32_bf16 v[92:95], v[160:163], v[124:127], v[92:95]
    ds_read_b128 v[144:147], v20 offset:1856
    v_mfma_f32_16x16x32_bf16 v[68:71], v[164:167], v[96:99], v[68:71]
    ds_read_b128 v[148:151], v20 offset:1344
    v_mfma_f32_16x16x32_bf16 v[72:75], v[164:167], v[100:103], v[72:75]
    ds_read_b128 v[152:155], v20 offset:832
    v_mfma_f32_16x16x32_bf16 v[76:79], v[164:167], v[104:107], v[76:79]
    ds_read_b128 v[156:159], v20 offset:320
    v_mfma_f32_16x16x32_bf16 v[80:83], v[164:167], v[108:111], v[80:83]
    ds_read2_b32 v[196:197], v16 offset0:208 offset1:209
    v_mfma_f32_16x16x32_bf16 v[84:87], v[164:167], v[112:115], v[84:87]
    ds_read2_b32 v[198:199], v16 offset0:210 offset1:211
    v_mfma_f32_16x16x32_bf16 v[88:91], v[164:167], v[116:119], v[88:91]
    ds_read2_b32 v[200:201], v17 offset0:80 offset1:81
    v_mfma_f32_16x16x32_bf16 v[92:95], v[164:167], v[120:123], v[92:95]
    ds_read2_b32 v[202:203], v17 offset0:82 offset1:83
    v_mfma_f32_16x16x32_bf16 v[72:75], v[168:171], v[96:99], v[72:75]
    ds_read2_b32 v[204:205], v17 offset0:208 offset1:209
    v_mfma_f32_16x16x32_bf16 v[76:79], v[168:171], v[100:103], v[76:79]
    ds_read2_b32 v[206:207], v17 offset0:210 offset1:211
    v_mfma_f32_16x16x32_bf16 v[80:83], v[168:171], v[104:107], v[80:83]
    ds_read2_b32 v[208:209], v18 offset0:80 offset1:81
    v_mfma_f32_16x16x32_bf16 v[84:87], v[168:171], v[108:111], v[84:87]
    ds_read2_b32 v[210:211], v18 offset0:82 offset1:83
    v_mfma_f32_16x16x32_bf16 v[88:91], v[168:171], v[112:115], v[88:91]
    ds_read2_b32 v[212:213], v18 offset0:208 offset1:209
    v_mfma_f32_16x16x32_bf16 v[92:95], v[168:171], v[116:119], v[92:95]
    ds_read2_b32 v[214:215], v18 offset0:210 offset1:211
    s_waitcnt lgkmcnt(15)
    v_mfma_f32_16x16x32_bf16 v[76:79], v[172:175], v[96:99], v[76:79]
    ds_read2_b32 v[216:217], v19 offset0:80 offset1:81
    v_mfma_f32_16x16x32_bf16 v[80:83], v[172:175], v[100:103], v[80:83]
    ds_read2_b32 v[218:219], v19 offset0:82 offset1:83
    v_mfma_f32_16x16x32_bf16 v[84:87], v[172:175], v[104:107], v[84:87]
    ds_read2_b32 v[220:221], v19 offset0:208 offset1:209
    v_mfma_f32_16x16x32_bf16 v[88:91], v[172:175], v[108:111], v[88:91]
    ds_read2_b32 v[222:223], v19 offset0:210 offset1:211
    v_mfma_f32_16x16x32_bf16 v[92:95], v[172:175], v[112:115], v[92:95]
    v_lshlrev_b32 v250, 16, v57
    v_and_b32 v251, s12, v57
    s_cmp_le_u32 s15, 0
    s_cselect_b32 s11, 1, 0
    s_lshl_b32 s11, s11, 7
    s_add_u32 s99, s11, s91
    s_add_u32 m0, s10, 0x8000
    s_nop 0
    buffer_load_dwordx4 v28, s[56:59], s99 offen offset:0 lds
    buffer_load_dwordx4 v29, s[56:59], s99 offen offset:1024 lds
    s_add_u32 s11, s11, s90
    s_add_u32 m0, s10, 0xa000
    s_nop 0
    buffer_load_dwordx4 v28, s[56:59], s11 offen offset:0 lds
    buffer_load_dwordx4 v29, s[56:59], s11 offen offset:1024 lds
    s_cmp_le_u32 s15, 0
    s_cselect_b32 s11, 1, 0
    s_lshl_b32 s11, s11, 7
    s_add_u32 s99, s11, s91
    s_add_u32 m0, s10, 0xc000
    s_nop 0
    buffer_load_dwordx4 v28, s[60:63], s99 offen offset:0 lds
    buffer_load_dwordx4 v29, s[60:63], s99 offen offset:1024 lds
    s_add_u32 s11, s11, s90
    s_add_u32 m0, s10, 0xe000
    s_nop 0
    buffer_load_dwordx4 v28, s[60:63], s11 offen offset:0 lds
    buffer_load_dwordx4 v29, s[60:63], s11 offen offset:1024 lds
    v_mfma_f32_16x16x32_bf16 v[80:83], v[176:179], v[96:99], v[80:83]
    v_and_b32 v252, s12, v55
    v_lshlrev_b32 v253, 16, v55
    v_mfma_f32_16x16x32_bf16 v[84:87], v[176:179], v[100:103], v[84:87]
    v_and_b32 v254, s12, v54
    v_lshlrev_b32 v255, 16, v54
    v_mfma_f32_16x16x32_bf16 v[88:91], v[176:179], v[104:107], v[88:91]
    v_mul_f32 v252, v252, v26
    v_mul_f32 v253, v253, v26
    v_mfma_f32_16x16x32_bf16 v[92:95], v[176:179], v[108:111], v[92:95]
    v_mul_f32 v254, v254, v26
    v_mul_f32 v255, v255, v26
    v_mfma_f32_16x16x32_bf16 v[84:87], v[180:183], v[96:99], v[84:87]
    v_cvt_pk_bf16_f32 v56, v252, v253
    v_cvt_pk_bf16_f32 v57, v254, v255
    v_mfma_f32_16x16x32_bf16 v[88:91], v[180:183], v[100:103], v[88:91]
    v_lshlrev_b32 v252, 16, v56
    v_and_b32 v253, s12, v56
    v_mfma_f32_16x16x32_bf16 v[92:95], v[180:183], v[104:107], v[92:95]
    v_lshlrev_b32 v254, 16, v57
    v_and_b32 v255, s12, v57
    v_mfma_f32_16x16x32_bf16 v[88:91], v[184:187], v[96:99], v[88:91]
    v_mfma_f32_16x16x32_bf16 v[92:95], v[184:187], v[100:103], v[92:95]
    v_mfma_f32_16x16x32_bf16 v[92:95], v[188:191], v[96:99], v[92:95]
    v_mfma_f32_16x16x32_bf16 v[64:67], v[192:195], v[128:131], v[64:67]
    v_mfma_f32_16x16x32_bf16 v[68:71], v[192:195], v[132:135], v[68:71]
    ds_read2_b32 v[160:161], v16 offset0:96 offset1:97
    v_mfma_f32_16x16x32_bf16 v[72:75], v[192:195], v[136:139], v[72:75]
    ds_read2_b32 v[162:163], v16 offset0:98 offset1:99
    s_waitcnt lgkmcnt(15)
    v_mfma_f32_16x16x32_bf16 v[76:79], v[192:195], v[140:143], v[76:79]
    ds_read_b128 v[96:99], v20 offset:3968
    v_mfma_f32_16x16x32_bf16 v[80:83], v[192:195], v[144:147], v[80:83]
    ds_read_b128 v[100:103], v20 offset:3456
    v_mfma_f32_16x16x32_bf16 v[84:87], v[192:195], v[148:151], v[84:87]
    ds_read_b128 v[104:107], v20 offset:2944
    v_mfma_f32_16x16x32_bf16 v[88:91], v[192:195], v[152:155], v[88:91]
    ds_read_b128 v[108:111], v20 offset:2432
    v_mfma_f32_16x16x32_bf16 v[92:95], v[192:195], v[156:159], v[92:95]
    ds_read_b128 v[112:115], v20 offset:1920
    s_waitcnt lgkmcnt(15)
    v_mfma_f32_16x16x32_bf16 v[68:71], v[196:199], v[128:131], v[68:71]
    ds_read_b128 v[116:119], v20 offset:1408
    v_mfma_f32_16x16x32_bf16 v[72:75], v[196:199], v[132:135], v[72:75]
    ds_read_b128 v[120:123], v20 offset:896
    v_mfma_f32_16x16x32_bf16 v[76:79], v[196:199], v[136:139], v[76:79]
    ds_read_b128 v[124:127], v20 offset:384
    v_mfma_f32_16x16x32_bf16 v[80:83], v[196:199], v[140:143], v[80:83]
    ds_read2_b32 v[164:165], v16 offset0:224 offset1:225
    v_mfma_f32_16x16x32_bf16 v[84:87], v[196:199], v[144:147], v[84:87]
    ds_read2_b32 v[166:167], v16 offset0:226 offset1:227
    v_mfma_f32_16x16x32_bf16 v[88:91], v[196:199], v[148:151], v[88:91]
    ds_read2_b32 v[168:169], v17 offset0:96 offset1:97
    v_mfma_f32_16x16x32_bf16 v[92:95], v[196:199], v[152:155], v[92:95]
    ds_read2_b32 v[170:171], v17 offset0:98 offset1:99
    v_mfma_f32_16x16x32_bf16 v[72:75], v[200:203], v[128:131], v[72:75]
    ds_read2_b32 v[172:173], v17 offset0:224 offset1:225
    v_mfma_f32_16x16x32_bf16 v[76:79], v[200:203], v[132:135], v[76:79]
    ds_read2_b32 v[174:175], v17 offset0:226 offset1:227
    v_mfma_f32_16x16x32_bf16 v[80:83], v[200:203], v[136:139], v[80:83]
    ds_read2_b32 v[176:177], v18 offset0:96 offset1:97
    v_mfma_f32_16x16x32_bf16 v[84:87], v[200:203], v[140:143], v[84:87]
    ds_read2_b32 v[178:179], v18 offset0:98 offset1:99
    v_mfma_f32_16x16x32_bf16 v[88:91], v[200:203], v[144:147], v[88:91]
    ds_read2_b32 v[180:181], v18 offset0:224 offset1:225
    v_mfma_f32_16x16x32_bf16 v[92:95], v[200:203], v[148:151], v[92:95]
    ds_read2_b32 v[182:183], v18 offset0:226 offset1:227
    v_mfma_f32_16x16x32_bf16 v[76:79], v[204:207], v[128:131], v[76:79]
    ds_read2_b32 v[184:185], v19 offset0:96 offset1:97
    v_mfma_f32_16x16x32_bf16 v[80:83], v[204:207], v[132:135], v[80:83]
    ds_read2_b32 v[186:187], v19 offset0:98 offset1:99
    v_mfma_f32_16x16x32_bf16 v[84:87], v[204:207], v[136:139], v[84:87]
    ds_read2_b32 v[188:189], v19 offset0:224 offset1:225
    v_mfma_f32_16x16x32_bf16 v[88:91], v[204:207], v[140:143], v[88:91]
    ds_read2_b32 v[190:191], v19 offset0:226 offset1:227
    v_mfma_f32_16x16x32_bf16 v[92:95], v[204:207], v[144:147], v[92:95]
    s_waitcnt lgkmcnt(15)
    v_mfma_f32_16x16x32_bf16 v[80:83], v[208:211], v[128:131], v[80:83]
    v_mfma_f32_16x16x32_bf16 v[84:87], v[208:211], v[132:135], v[84:87]
    v_mfma_f32_16x16x32_bf16 v[88:91], v[208:211], v[136:139], v[88:91]
    v_mfma_f32_16x16x32_bf16 v[92:95], v[208:211], v[140:143], v[92:95]
    v_mfma_f32_16x16x32_bf16 v[84:87], v[212:215], v[128:131], v[84:87]
    v_mfma_f32_16x16x32_bf16 v[88:91], v[212:215], v[132:135], v[88:91]
    v_mfma_f32_16x16x32_bf16 v[92:95], v[212:215], v[136:139], v[92:95]
    v_mfma_f32_16x16x32_bf16 v[88:91], v[216:219], v[128:131], v[88:91]
    v_mfma_f32_16x16x32_bf16 v[92:95], v[216:219], v[132:135], v[92:95]
    v_mfma_f32_16x16x32_bf16 v[92:95], v[220:223], v[128:131], v[92:95]
    v_mfma_f32_16x16x32_bf16 v[64:67], v[160:163], v[96:99], v[64:67]
    v_mfma_f32_16x16x32_bf16 v[68:71], v[160:163], v[100:103], v[68:71]
    ds_read2_b32 v[192:193], v16 offset0:112 offset1:113
    v_mfma_f32_16x16x32_bf16 v[72:75], v[160:163], v[104:107], v[72:75]
    ds_read2_b32 v[194:195], v16 offset0:114 offset1:115
    v_mfma_f32_16x16x32_bf16 v[76:79], v[160:163], v[108:111], v[76:79]
    ds_read_b128 v[128:131], v20 offset:4032
    v_mfma_f32_16x16x32_bf16 v[80:83], v[160:163], v[112:115], v[80:83]
    ds_read_b128 v[132:135], v20 offset:3520
    v_mfma_f32_16x16x32_bf16 v[84:87], v[160:163], v[116:119], v[84:87]
    ds_read_b128 v[136:139], v20 offset:3008
    v_mfma_f32_16x16x32_bf16 v[88:91], v[160:163], v[120:123], v[88:91]
    ds_read_b128 v[140:143], v20 offset:2496
    s_waitcnt lgkmcnt(15)
    v_mfma_f32_16x16x32_bf16 v[92:95], v[160:163], v[124:127], v[92:95]
    ds_read_b128 v[144:147], v20 offset:1984
    v_mfma_f32_16x16x32_bf16 v[68:71], v[164:167], v[96:99], v[68:71]
    ds_read_b128 v[148:151], v20 offset:1472
    v_mfma_f32_16x16x32_bf16 v[72:75], v[164:167], v[100:103], v[72:75]
    ds_read_b128 v[152:155], v20 offset:960
    v_mfma_f32_16x16x32_bf16 v[76:79], v[164:167], v[104:107], v[76:79]
    ds_read_b128 v[156:159], v20 offset:448
    v_mfma_f32_16x16x32_bf16 v[80:83], v[164:167], v[108:111], v[80:83]
    ds_read2_b32 v[196:197], v16 offset0:240 offset1:241
    v_mfma_f32_16x16x32_bf16 v[84:87], v[164:167], v[112:115], v[84:87]
    ds_read2_b32 v[198:199], v16 offset0:242 offset1:243
    v_mfma_f32_16x16x32_bf16 v[88:91], v[164:167], v[116:119], v[88:91]
    ds_read2_b32 v[200:201], v17 offset0:112 offset1:113
    v_mfma_f32_16x16x32_bf16 v[92:95], v[164:167], v[120:123], v[92:95]
    ds_read2_b32 v[202:203], v17 offset0:114 offset1:115
    v_mfma_f32_16x16x32_bf16 v[72:75], v[168:171], v[96:99], v[72:75]
    ds_read2_b32 v[204:205], v17 offset0:240 offset1:241
    v_mfma_f32_16x16x32_bf16 v[76:79], v[168:171], v[100:103], v[76:79]
    ds_read2_b32 v[206:207], v17 offset0:242 offset1:243
    v_mfma_f32_16x16x32_bf16 v[80:83], v[168:171], v[104:107], v[80:83]
    ds_read2_b32 v[208:209], v18 offset0:112 offset1:113
    v_mfma_f32_16x16x32_bf16 v[84:87], v[168:171], v[108:111], v[84:87]
    ds_read2_b32 v[210:211], v18 offset0:114 offset1:115
    v_mfma_f32_16x16x32_bf16 v[88:91], v[168:171], v[112:115], v[88:91]
    ds_read2_b32 v[212:213], v18 offset0:240 offset1:241
    v_mfma_f32_16x16x32_bf16 v[92:95], v[168:171], v[116:119], v[92:95]
    ds_read2_b32 v[214:215], v18 offset0:242 offset1:243
    s_waitcnt lgkmcnt(15)
    v_mfma_f32_16x16x32_bf16 v[76:79], v[172:175], v[96:99], v[76:79]
    ds_read2_b32 v[216:217], v19 offset0:112 offset1:113
    v_mfma_f32_16x16x32_bf16 v[80:83], v[172:175], v[100:103], v[80:83]
    ds_read2_b32 v[218:219], v19 offset0:114 offset1:115
    v_mfma_f32_16x16x32_bf16 v[84:87], v[172:175], v[104:107], v[84:87]
    ds_read2_b32 v[220:221], v19 offset0:240 offset1:241
    s_waitcnt vmcnt(0)
    s_mov_b64 exec, 1
    ds_add_u32 v60, v61 offset:20
    s_mov_b64 exec, -1
    v_mfma_f32_16x16x32_bf16 v[88:91], v[172:175], v[108:111], v[88:91]
    ds_read2_b32 v[222:223], v19 offset0:242 offset1:243
    v_mfma_f32_16x16x32_bf16 v[92:95], v[172:175], v[112:115], v[92:95]
    v_mfma_f32_16x16x32_bf16 v[80:83], v[176:179], v[96:99], v[80:83]
    v_mfma_f32_16x16x32_bf16 v[84:87], v[176:179], v[100:103], v[84:87]
    v_mfma_f32_16x16x32_bf16 v[88:91], v[176:179], v[104:107], v[88:91]
    v_mfma_f32_16x16x32_bf16 v[92:95], v[176:179], v[108:111], v[92:95]
    v_mfma_f32_16x16x32_bf16 v[84:87], v[180:183], v[96:99], v[84:87]
    v_mfma_f32_16x16x32_bf16 v[88:91], v[180:183], v[100:103], v[88:91]
    v_mfma_f32_16x16x32_bf16 v[92:95], v[180:183], v[104:107], v[92:95]
    v_mfma_f32_16x16x32_bf16 v[88:91], v[184:187], v[96:99], v[88:91]
    v_mfma_f32_16x16x32_bf16 v[92:95], v[184:187], v[100:103], v[92:95]
    v_mfma_f32_16x16x32_bf16 v[92:95], v[188:191], v[96:99], v[92:95]
    v_mfma_f32_16x16x32_bf16 v[64:67], v[192:195], v[128:131], v[64:67]
    v_mfma_f32_16x16x32_bf16 v[68:71], v[192:195], v[132:135], v[68:71]
    v_mfma_f32_16x16x32_bf16 v[72:75], v[192:195], v[136:139], v[72:75]
    s_waitcnt lgkmcnt(15)
    v_mfma_f32_16x16x32_bf16 v[76:79], v[192:195], v[140:143], v[76:79]
    s_nop 3
    v_cvt_pk_bf16_f32 v56, v64, v65
    v_cvt_pk_bf16_f32 v57, v66, v67
    v_lshlrev_b32 v64, 16, v56
    v_mfma_f32_16x16x32_bf16 v[80:83], v[192:195], v[144:147], v[80:83]
    v_and_b32 v65, s12, v56
    v_lshlrev_b32 v66, 16, v57
    v_and_b32 v67, s12, v57
    v_mfma_f32_16x16x32_bf16 v[84:87], v[192:195], v[148:151], v[84:87]
    v_add_f32 v224, v224, v64
    v_add_f32 v225, v225, v65
    v_add_f32 v226, v226, v66
    v_mfma_f32_16x16x32_bf16 v[88:91], v[192:195], v[152:155], v[88:91]
    v_add_f32 v227, v227, v67
    v_cvt_pk_bf16_f32 v40, v224, v225
    v_cvt_pk_bf16_f32 v41, v226, v227
    v_mfma_f32_16x16x32_bf16 v[92:95], v[192:195], v[156:159], v[92:95]
    s_waitcnt lgkmcnt(13)
    v_mfma_f32_16x16x32_bf16 v[68:71], v[196:199], v[128:131], v[68:71]
    v_mfma_f32_16x16x32_bf16 v[72:75], v[196:199], v[132:135], v[72:75]
    v_mfma_f32_16x16x32_bf16 v[76:79], v[196:199], v[136:139], v[76:79]
    v_mfma_f32_16x16x32_bf16 v[80:83], v[196:199], v[140:143], v[80:83]
    s_nop 4
    v_cvt_pk_bf16_f32 v56, v68, v69
    v_cvt_pk_bf16_f32 v57, v70, v71
    v_lshlrev_b32 v68, 16, v56
    v_mfma_f32_16x16x32_bf16 v[84:87], v[196:199], v[144:147], v[84:87]
    v_and_b32 v69, s12, v56
    v_lshlrev_b32 v70, 16, v57
    v_and_b32 v71, s12, v57
    v_mfma_f32_16x16x32_bf16 v[88:91], v[196:199], v[148:151], v[88:91]
    v_add_f32 v228, v228, v68
    v_add_f32 v229, v229, v69
    v_add_f32 v230, v230, v70
    v_mfma_f32_16x16x32_bf16 v[92:95], v[196:199], v[152:155], v[92:95]
    v_add_f32 v231, v231, v71
    v_cvt_pk_bf16_f32 v42, v228, v229
    v_cvt_pk_bf16_f32 v43, v230, v231
    s_waitcnt lgkmcnt(11)
    v_mfma_f32_16x16x32_bf16 v[72:75], v[200:203], v[128:131], v[72:75]
    v_permlane16_swap_b32 v40, v42
    v_permlane16_swap_b32 v41, v43
    v_mfma_f32_16x16x32_bf16 v[76:79], v[200:203], v[132:135], v[76:79]
    v_mfma_f32_16x16x32_bf16 v[80:83], v[200:203], v[136:139], v[80:83]
    v_mfma_f32_16x16x32_bf16 v[84:87], v[200:203], v[140:143], v[84:87]
    s_nop 2
    v_cvt_pk_bf16_f32 v56, v72, v73
    v_cvt_pk_bf16_f32 v57, v74, v75
    v_lshlrev_b32 v72, 16, v56
    v_mfma_f32_16x16x32_bf16 v[88:91], v[200:203], v[144:147], v[88:91]
    v_and_b32 v73, s12, v56
    v_lshlrev_b32 v74, 16, v57
    v_and_b32 v75, s12, v57
    v_mfma_f32_16x16x32_bf16 v[92:95], v[200:203], v[148:151], v[92:95]
    v_add_f32 v232, v232, v72
    v_add_f32 v233, v233, v73
    v_add_f32 v234, v234, v74
    s_waitcnt lgkmcnt(9)
    v_mfma_f32_16x16x32_bf16 v[76:79], v[204:207], v[128:131], v[76:79]
    v_add_f32 v235, v235, v75
    v_cvt_pk_bf16_f32 v44, v232, v233
    v_cvt_pk_bf16_f32 v45, v234, v235
    v_mfma_f32_16x16x32_bf16 v[80:83], v[204:207], v[132:135], v[80:83]
    v_mfma_f32_16x16x32_bf16 v[84:87], v[204:207], v[136:139], v[84:87]
    v_mfma_f32_16x16x32_bf16 v[88:91], v[204:207], v[140:143], v[88:91]
    s_nop 1
    v_cvt_pk_bf16_f32 v56, v76, v77
    v_cvt_pk_bf16_f32 v57, v78, v79
    v_lshlrev_b32 v76, 16, v56
    v_mfma_f32_16x16x32_bf16 v[92:95], v[204:207], v[144:147], v[92:95]
    v_and_b32 v77, s12, v56
    v_lshlrev_b32 v78, 16, v57
    v_and_b32 v79, s12, v57
    s_waitcnt lgkmcnt(7)
    v_mfma_f32_16x16x32_bf16 v[80:83], v[208:211], v[128:131], v[80:83]
    v_add_f32 v236, v236, v76
    v_add_f32 v237, v237, v77
    v_add_f32 v238, v238, v78
    v_mfma_f32_16x16x32_bf16 v[84:87], v[208:211], v[132:135], v[84:87]
    v_add_f32 v239, v239, v79
    v_cvt_pk_bf16_f32 v46, v236, v237
    v_cvt_pk_bf16_f32 v47, v238, v239
    v_mfma_f32_16x16x32_bf16 v[88:91], v[208:211], v[136:139], v[88:91]
    v_permlane16_swap_b32 v44, v46
    v_permlane16_swap_b32 v45, v47
    v_mfma_f32_16x16x32_bf16 v[92:95], v[208:211], v[140:143], v[92:95]
    v_cvt_pk_bf16_f32 v56, v80, v81
    v_cvt_pk_bf16_f32 v57, v82, v83
    v_lshlrev_b32 v80, 16, v56
    s_waitcnt lgkmcnt(5)
    v_mfma_f32_16x16x32_bf16 v[84:87], v[212:215], v[128:131], v[84:87]
    v_and_b32 v81, s12, v56
    v_lshlrev_b32 v82, 16, v57
    v_and_b32 v83, s12, v57
    v_mfma_f32_16x16x32_bf16 v[88:91], v[212:215], v[132:135], v[88:91]
    v_add_f32 v240, v240, v80
    v_add_f32 v241, v241, v81
    v_add_f32 v242, v242, v82
    v_mfma_f32_16x16x32_bf16 v[92:95], v[212:215], v[136:139], v[92:95]
    v_add_f32 v243, v243, v83
    v_cvt_pk_bf16_f32 v48, v240, v241
    v_cvt_pk_bf16_f32 v49, v242, v243
    s_waitcnt lgkmcnt(3)
    v_mfma_f32_16x16x32_bf16 v[88:91], v[216:219], v[128:131], v[88:91]
    v_cvt_pk_bf16_f32 v56, v84, v85
    v_cvt_pk_bf16_f32 v57, v86, v87
    v_lshlrev_b32 v84, 16, v56
    v_mfma_f32_16x16x32_bf16 v[92:95], v[216:219], v[132:135], v[92:95]
    v_and_b32 v85, s12, v56
    v_lshlrev_b32 v86, 16, v57
    v_and_b32 v87, s12, v57
    s_waitcnt lgkmcnt(0)
    v_mfma_f32_16x16x32_bf16 v[92:95], v[220:223], v[128:131], v[92:95]
    v_add_f32 v244, v244, v84
    v_add_f32 v245, v245, v85
    v_add_f32 v246, v246, v86
    v_add_f32 v247, v247, v87
    v_cvt_pk_bf16_f32 v50, v244, v245
    v_cvt_pk_bf16_f32 v51, v246, v247
    s_nop 0
    v_permlane16_swap_b32 v48, v50
    v_permlane16_swap_b32 v49, v51
    v_cvt_pk_bf16_f32 v56, v88, v89
    v_cvt_pk_bf16_f32 v57, v90, v91
    v_lshlrev_b32 v88, 16, v56
    v_and_b32 v89, s12, v56
    v_lshlrev_b32 v90, 16, v57
    v_and_b32 v91, s12, v57
    v_add_f32 v248, v248, v88
    v_add_f32 v249, v249, v89
    v_add_f32 v250, v250, v90
    v_add_f32 v251, v251, v91
    v_cvt_pk_bf16_f32 v52, v248, v249
    v_cvt_pk_bf16_f32 v53, v250, v251
    v_cvt_pk_bf16_f32 v56, v92, v93
    v_cvt_pk_bf16_f32 v57, v94, v95
    v_lshlrev_b32 v92, 16, v56
    v_and_b32 v93, s12, v56
    v_lshlrev_b32 v94, 16, v57
    v_and_b32 v95, s12, v57
    v_add_f32 v252, v252, v92
    v_add_f32 v253, v253, v93
    v_add_f32 v254, v254, v94
    v_add_f32 v255, v255, v95
    v_cvt_pk_bf16_f32 v54, v252, v253
    v_cvt_pk_bf16_f32 v55, v254, v255
    s_nop 0
    v_permlane16_swap_b32 v52, v54
    v_permlane16_swap_b32 v53, v55
    buffer_store_dwordx4 v[40:43], v22, s[84:87], 0 offen offset:0 sc1
    buffer_store_dwordx4 v[44:47], v22, s[84:87], 0 offen offset:1024 sc1
    buffer_store_dwordx4 v[48:51], v22, s[84:87], 0 offen offset:2048 sc1
    buffer_store_dwordx4 v[52:55], v22, s[84:87], 0 offen offset:3072 sc1
    v_lshrrev_b32 v8, 4, v1
    s_lshl_b32 s8, s3, 4
    v_add_u32 v8, s8, v8
    v_and_b32 v11, 15, v1
    s_lshl_b32 s9, s5, 11
    s_add_u32 s9, s9, 0x28000
    v_lshl_add_u32 v10, v11, 7, s9
    v_lshlrev_b32 v11, 4, v11
    v_mul_u32_u24 v9, 272, v8
    v_add_u32 v9, v9, v11
    s_lshl_b32 s8, s5, 6
    v_add_u32 v8, s8, v8
    v_lshl_add_u32 v8, v8, 12, v11
    s_lshl_b32 s8, s4, 8
    v_add_u32 v8, s8, v8
    s_barrier
    s_cmp_le_u32 s15, 1
    s_cselect_b32 s11, 2, 1
    s_lshl_b32 s11, s11, 7
    s_add_u32 s99, s11, s91
    s_add_u32 m0, s10, 0x0
    s_nop 0
    buffer_load_dwordx4 v28, s[56:59], s99 offen offset:0 lds
    buffer_load_dwordx4 v29, s[56:59], s99 offen offset:1024 lds
    s_add_u32 s11, s11, s90
    s_add_u32 m0, s10, 0x2000
    s_nop 0
    buffer_load_dwordx4 v28, s[56:59], s11 offen offset:0 lds
    buffer_load_dwordx4 v29, s[56:59], s11 offen offset:1024 lds
    s_cmp_le_u32 s15, 1
    s_cselect_b32 s11, 2, 1
    s_lshl_b32 s11, s11, 7
    s_add_u32 s99, s11, s91
    s_add_u32 m0, s10, 0x4000
    s_nop 0
    buffer_load_dwordx4 v28, s[60:63], s99 offen offset:0 lds
    buffer_load_dwordx4 v29, s[60:63], s99 offen offset:1024 lds
    s_add_u32 s11, s11, s90
    s_add_u32 m0, s10, 0x6000
    s_nop 0
    buffer_load_dwordx4 v28, s[60:63], s11 offen offset:0 lds
    buffer_load_dwordx4 v29, s[60:63], s11 offen offset:1024 lds
    s_waitcnt vmcnt(4)
    s_barrier
    s_cmp_le_u32 s15, 2
    s_cselect_b32 s11, 3, 2
    s_lshl_b32 s11, s11, 7
    s_add_u32 s99, s11, s91
    s_add_u32 m0, s10, 0x8000
    s_nop 0
    buffer_load_dwordx4 v28, s[56:59], s99 offen offset:0 lds
    buffer_load_dwordx4 v29, s[56:59], s99 offen offset:1024 lds
    s_add_u32 s11, s11, s90
    s_add_u32 m0, s10, 0xa000
    s_nop 0
    buffer_load_dwordx4 v28, s[56:59], s11 offen offset:0 lds
    buffer_load_dwordx4 v29, s[56:59], s11 offen offset:1024 lds
    s_waitcnt vmcnt(4)
    s_barrier
    s_cmp_le_u32 s15, 2
    s_cselect_b32 s11, 3, 2
    s_lshl_b32 s11, s11, 7
    s_add_u32 s99, s11, s91
    s_add_u32 m0, s10, 0xc000
    s_nop 0
    buffer_load_dwordx4 v28, s[60:63], s99 offen offset:0 lds
    buffer_load_dwordx4 v29, s[60:63], s99 offen offset:1024 lds
    s_add_u32 s11, s11, s90
    s_add_u32 m0, s10, 0xe000
    s_nop 0
    buffer_load_dwordx4 v28, s[60:63], s11 offen offset:0 lds
    buffer_load_dwordx4 v29, s[60:63], s11 offen offset:1024 lds
    s_waitcnt vmcnt(4)
    s_barrier
    s_cmp_le_u32 s15, 3
    s_cselect_b32 s11, 4, 3
    s_lshl_b32 s11, s11, 7
    s_add_u32 s99, s11, s91
    s_add_u32 m0, s10, 0x0
    s_nop 0
    buffer_load_dwordx4 v28, s[56:59], s99 offen offset:0 lds
    buffer_load_dwordx4 v29, s[56:59], s99 offen offset:1024 lds
    s_add_u32 s11, s11, s90
    s_add_u32 m0, s10, 0x2000
    s_nop 0
    buffer_load_dwordx4 v28, s[56:59], s11 offen offset:0 lds
    buffer_load_dwordx4 v29, s[56:59], s11 offen offset:1024 lds
    s_mov_b64 exec, 1
    ds_add_rtn_u32 v62, v60, v61 offset:4
    s_mov_b64 exec, -1
    s_waitcnt lgkmcnt(0)
    v_readfirstlane_b32 s83, v62
    s_nop 1
    s_cmp_lg_u32 s83, 3
    s_cbranch_scc1 h_noy
    buffer_store_dword v61, v31, s[92:95], 0 offen sc1
h_noy:
    s_waitcnt vmcnt(4)
    s_barrier
    s_cmp_le_u32 s15, 3
    s_cselect_b32 s11, 4, 3
    s_lshl_b32 s11, s11, 7
    s_add_u32 s99, s11, s91
    s_add_u32 m0, s10, 0x4000
    s_nop 0
    buffer_load_dwordx4 v28, s[60:63], s99 offen offset:0 lds
    buffer_load_dwordx4 v29, s[60:63], s99 offen offset:1024 lds
    s_add_u32 s11, s11, s90
    s_add_u32 m0, s10, 0x6000
    s_nop 0
    buffer_load_dwordx4 v28, s[60:63], s11 offen offset:0 lds
    buffer_load_dwordx4 v29, s[60:63], s11 offen offset:1024 lds
    s_waitcnt vmcnt(4)
    s_barrier
    s_cmp_le_u32 s15, 4
    s_cselect_b32 s11, 5, 4
    s_lshl_b32 s11, s11, 7
    s_add_u32 s99, s11, s91
    s_add_u32 m0, s10, 0x8000
    s_nop 0
    buffer_load_dwordx4 v28, s[56:59], s99 offen offset:0 lds
    buffer_load_dwordx4 v29, s[56:59], s99 offen offset:1024 lds
    s_add_u32 s11, s11, s90
    s_add_u32 m0, s10, 0xa000
    s_nop 0
    buffer_load_dwordx4 v28, s[56:59], s11 offen offset:0 lds
    buffer_load_dwordx4 v29, s[56:59], s11 offen offset:1024 lds
    s_waitcnt vmcnt(4)
    s_barrier
    s_cmp_le_u32 s15, 4
    s_cselect_b32 s11, 5, 4
    s_lshl_b32 s11, s11, 7
    s_add_u32 s99, s11, s91
    s_add_u32 m0, s10, 0xc000
    s_nop 0
    buffer_load_dwordx4 v28, s[60:63], s99 offen offset:0 lds
    buffer_load_dwordx4 v29, s[60:63], s99 offen offset:1024 lds
    s_add_u32 s11, s11, s90
    s_add_u32 m0, s10, 0xe000
    s_nop 0
    buffer_load_dwordx4 v28, s[60:63], s11 offen offset:0 lds
    buffer_load_dwordx4 v29, s[60:63], s11 offen offset:1024 lds
    buffer_load_dword v19, v10, s[92:95], 0 offen sc1
    s_waitcnt vmcnt(5)
    s_barrier
    s_cmp_le_u32 s15, 5
    s_cselect_b32 s11, 6, 5
    s_lshl_b32 s11, s11, 7
    s_add_u32 s99, s11, s91
    s_add_u32 m0, s10, 0x0
    s_nop 0
    buffer_load_dwordx4 v28, s[56:59], s99 offen offset:0 lds
    buffer_load_dwordx4 v29, s[56:59], s99 offen offset:1024 lds
    s_add_u32 s11, s11, s90
    s_add_u32 m0, s10, 0x2000
    s_nop 0
    buffer_load_dwordx4 v28, s[56:59], s11 offen offset:0 lds
    buffer_load_dwordx4 v29, s[56:59], s11 offen offset:1024 lds
    s_waitcnt vmcnt(5)
    s_barrier
    s_cmp_le_u32 s15, 5
    s_cselect_b32 s11, 6, 5
    s_lshl_b32 s11, s11, 7
    s_add_u32 s99, s11, s91
    s_add_u32 m0, s10, 0x4000
    s_nop 0
    buffer_load_dwordx4 v28, s[60:63], s99 offen offset:0 lds
    buffer_load_dwordx4 v29, s[60:63], s99 offen offset:1024 lds
    s_add_u32 s11, s11, s90
    s_add_u32 m0, s10, 0x6000
    s_nop 0
    buffer_load_dwordx4 v28, s[60:63], s11 offen offset:0 lds
    buffer_load_dwordx4 v29, s[60:63], s11 offen offset:1024 lds
    s_waitcnt vmcnt(8)
    s_mov_b32 s89, 65536
h_yf_chk:
    v_cmp_ne_u32 vcc, 1, v19
    s_nop 1
    s_cmp_eq_u64 vcc, 0
    s_cbranch_scc1 h_yf_ok
    s_sub_u32 s89, s89, 1
    s_cbranch_scc1 h_yf_ok
    s_sleep 4
    buffer_load_dword v19, v10, s[92:95], 0 offen sc1
    s_waitcnt vmcnt(0)
    s_branch h_yf_chk
h_yf_ok:
    s_mov_b32 s8, 0
    buffer_load_dwordx4 v[116:119], v8, s[68:71], s8 offen sc1
    s_mov_b32 s8, 16384
    buffer_load_dwordx4 v[120:123], v8, s[68:71], s8 offen sc1
    s_mov_b32 s8, 32768
    buffer_load_dwordx4 v[124:127], v8, s[68:71], s8 offen sc1
    s_mov_b32 s8, 49152
    buffer_load_dwordx4 v[128:131], v8, s[68:71], s8 offen sc1
    s_waitcnt vmcnt(8)
    s_barrier
    s_cmp_le_u32 s15, 6
    s_cselect_b32 s11, 7, 6
    s_lshl_b32 s11, s11, 7
    s_add_u32 s99, s11, s91
    s_add_u32 m0, s10, 0x8000
    s_nop 0
    buffer_load_dwordx4 v28, s[56:59], s99 offen offset:0 lds
    buffer_load_dwordx4 v29, s[56:59], s99 offen offset:1024 lds
    s_add_u32 s11, s11, s90
    s_add_u32 m0, s10, 0xa000
    s_nop 0
    buffer_load_dwordx4 v28, s[56:59], s11 offen offset:0 lds
    buffer_load_dwordx4 v29, s[56:59], s11 offen offset:1024 lds
    s_waitcnt vmcnt(8)
    s_barrier
    s_cmp_le_u32 s15, 6
    s_cselect_b32 s11, 7, 6
    s_lshl_b32 s11, s11, 7
    s_add_u32 s99, s11, s91
    s_add_u32 m0, s10, 0xc000
    s_nop 0
    buffer_load_dwordx4 v28, s[60:63], s99 offen offset:0 lds
    buffer_load_dwordx4 v29, s[60:63], s99 offen offset:1024 lds
    s_add_u32 s11, s11, s90
    s_add_u32 m0, s10, 0xe000
    s_nop 0
    buffer_load_dwordx4 v28, s[60:63], s11 offen offset:0 lds
    buffer_load_dwordx4 v29, s[60:63], s11 offen offset:1024 lds
    s_waitcnt vmcnt(8)
    ds_write_b128 v9, v[116:119] offset:0
    ds_write_b128 v9, v[120:123] offset:1088
    ds_write_b128 v9, v[124:127] offset:2176
    ds_write_b128 v9, v[128:131] offset:3264
    s_waitcnt lgkmcnt(0)
    s_waitcnt vmcnt(4)
    s_barrier
    s_waitcnt vmcnt(0)
    s_barrier
    s_endpgm
L_consumer:
    s_setprio 2
    s_and_b32 s6, s3, 1
    s_lshr_b32 s7, s3, 1
    v_and_b32 v4, 31, v1
    s_lshl_b32 s8, s5, 6
    s_lshl_b32 s9, s7, 5
    s_add_u32 s8, s8, s9
    v_add_u32 v3, s8, v4
    v_lshlrev_b32 v5, 1, v3
    v_lshrrev_b32 v6, 5, v1
    s_lshl_b32 s10, s4, 1
    s_add_u32 s10, s10, s6
    s_getpc_b64 s[12:13]
c_pc:
    s_sub_u32 s12, s12, c_pc-gated_mix__ssm_conv_s5__ssm_conv_h3__prompt_kernel
    s_subb_u32 s13, s13, 0
    s_lshl_b32 s11, s55, 2
    s_add_u32 s11, s11, s3
    s_lshl_b32 s11, s11, 9
    v_and_b32 v24, 3, v1
    v_lshl_add_u32 v24, v24, 7, s11
    v_min_u32 v24, 0x8bd4, v24
    global_load_dword v25, v24, s[12:13]
    s_waitcnt lgkmcnt(0)
    global_load_ushort v8, v5, s[18:19]
    global_load_ushort v9, v5, s[20:21]
    global_load_ushort v10, v5, s[30:31]
    s_add_u32 s56, s52, 0x1100000
    s_addc_u32 s57, s53, 0
    s_mov_b32 s58, 0x40000
    s_mov_b32 s59, 0x20000
    s_mov_b32 s60, s52
    s_mov_b32 s61, s53
    s_mov_b32 s62, 0x800000
    s_mov_b32 s63, 0x20000
    s_mov_b32 s64, s50
    s_mov_b32 s65, s51
    s_mov_b32 s66, 0x100
    s_mov_b32 s67, 0x20000
    s_add_u32 s68, s52, 0x1200000
    s_addc_u32 s69, s53, 0
    s_mov_b32 s70, 0x50000
    s_mov_b32 s71, 0x20000
    s_lshl_b32 s11, s10, 13
    v_lshl_add_u32 v7, v3, 3, s11
    v_mov_b32 v12, 0
    v_mov_b32 v13, 0
    buffer_store_dwordx2 v[12:13], v7, s[56:59], 0 offen sc1
    s_lshl_b32 s11, s10, 4
    s_add_u32 s11, s11, s5
    s_lshl_b32 s11, s11, 1
    s_add_u32 s11, s11, s7
    s_lshl_b32 s11, s11, 7
    v_mov_b32 v60, s11
    buffer_store_dword v12, v60, s[68:71], 0 offen sc1
    s_lshl_b32 s72, s4, 4
    s_add_u32 s72, s72, s5
    s_lshl_b32 s72, s72, 2
    s_add_u32 s72, s72, s3
    s_lshl_b32 s72, s72, 7
    s_add_u32 s11, s72, 0x30000
    v_mov_b32 v30, s11
    buffer_store_dword v12, v30, s[68:71], 0 offen sc1
    v_mov_b32 v23, 1
    v_bfe_u32 v11, v1, 1, 3
    v_xor_b32 v11, v11, v6
    s_lshl_b32 s11, s6, 13
    v_lshl_add_u32 v14, v4, 7, s11
    s_lshl_b32 s11, s7, 12
    s_add_u32 s11, s11, 16384
    v_lshl_add_u32 v15, v4, 7, s11
    v_xor_b32 v16, 0, v11
    v_lshl_add_u32 v160, v16, 4, v14
    v_lshl_add_u32 v168, v16, 4, v15
    v_add_u32 v164, 0x10000, v160
    v_add_u32 v172, 0x10000, v168
    v_xor_b32 v16, 2, v11
    v_lshl_add_u32 v161, v16, 4, v14
    v_lshl_add_u32 v169, v16, 4, v15
    v_add_u32 v165, 0x10000, v161
    v_add_u32 v173, 0x10000, v169
    v_xor_b32 v16, 4, v11
    v_lshl_add_u32 v162, v16, 4, v14
    v_lshl_add_u32 v170, v16, 4, v15
    v_add_u32 v166, 0x10000, v162
    v_add_u32 v174, 0x10000, v170
    v_xor_b32 v16, 6, v11
    v_lshl_add_u32 v163, v16, 4, v14
    v_lshl_add_u32 v171, v16, 4, v15
    v_add_u32 v167, 0x10000, v163
    v_add_u32 v175, 0x10000, v171
    v_lshlrev_b32 v21, 2, v1
    s_waitcnt vmcnt(0)
    v_lshlrev_b32 v8, 16, v8
    v_lshlrev_b32 v9, 16, v9
    v_lshlrev_b32 v10, 16, v10
    s_mov_b32 s12, 0x3fb8aa3b
    v_mul_f32 v10, s12, v10
    v_exp_f32 v10, v10
    s_nop 0
    v_cvt_pk_bf16_f32 v10, v10, v10
    v_lshlrev_b32 v10, 16, v10
    v_mul_f32 v16, v10, v8
    v_mul_f32 v17, v10, v9
    v_mul_f32 v16, s12, v16
    v_exp_f32 v16, v16
    v_mul_f32 v17, 0.15915494, v17
    v_rndne_f32 v18, v17
    v_sub_f32 v17, v17, v18
    v_cos_f32 v18, v17
    v_sin_f32 v19, v17
    v_mul_f32 v176, v16, v18
    v_mul_f32 v177, v16, v19
    v_add_f32 v16, -1.0, v176
    v_mul_f32 v17, v8, v8
    v_fma_f32 v17, v9, v9, v17
    v_rcp_f32 v17, v17
    v_mul_f32 v18, v16, v8
    v_fma_f32 v18, v177, v9, v18
    v_mul_f32 v19, v177, v8
    v_fma_f32 v19, -v16, v9, v19
    v_add_f32 v17, v17, v17
    v_mul_f32 v178, v18, v17
    v_mul_f32 v179, v19, v17
    v_mul_f32 v16, v176, v176
    v_mul_f32 v17, v176, v177
    v_fma_f32 v16, -v177, v177, v16
    v_fma_f32 v17, v177, v176, v17
    v_mul_f32 v18, v16, v16
    v_mul_f32 v19, v16, v17
    v_fma_f32 v18, -v17, v17, v18
    v_fma_f32 v19, v17, v16, v19
    v_mul_f32 v16, v18, v18
    v_mul_f32 v17, v18, v19
    v_fma_f32 v16, -v19, v19, v16
    v_fma_f32 v17, v19, v18, v17
    v_mul_f32 v180, v16, v16
    v_mul_f32 v181, v16, v17
    v_fma_f32 v180, -v17, v17, v180
    v_fma_f32 v181, v17, v16, v181
    v_mul_f32 v182, v180, v180
    v_mul_f32 v183, v180, v181
    v_fma_f32 v182, -v181, v181, v182
    v_fma_f32 v183, v181, v180, v183
    v_mul_f32 v184, v182, v182
    v_mul_f32 v185, v182, v183
    v_fma_f32 v184, -v183, v183, v184
    v_fma_f32 v185, v183, v182, v185
    v_mul_f32 v186, v184, v184
    v_mul_f32 v187, v184, v185
    v_fma_f32 v186, -v185, v185, v186
    v_fma_f32 v187, v185, v184, v187
    v_mul_f32 v48, v178, v182
    v_mul_f32 v49, v178, v183
    v_fma_f32 v48, -v179, v183, v48
    v_fma_f32 v49, v179, v182, v49
    v_cmp_lt_u32 vcc, 31, v1
    s_nop 1
    v_cndmask_b32 v48, v178, v48, vcc
    v_cndmask_b32 v49, v179, v49, vcc
    v_lshlrev_b32 v50, 13, v6
    v_sub_u32 v50, v7, v50
    s_add_u32 s11, s10, 1
    v_sub_u32 v51, s11, v6
    v_lshrrev_b32 v51, 1, v51
    s_lshl_b32 s11, s4, 2
    s_add_u32 s11, s11, s3
    s_lshl_b32 s11, s11, 5
    v_lshrrev_b32 v52, 3, v1
    v_add_u32 v52, s11, v52
    v_lshlrev_b32 v52, 11, v52
    v_and_b32 v16, 7, v1
    v_lshl_add_u32 v52, v16, 4, v52
    s_lshl_b32 s11, s5, 7
    v_add_u32 v52, s11, v52
    s_lshl_b32 s11, s3, 13
    v_lshlrev_b32 v53, 11, v6
    v_lshl_add_u32 v53, v4, 1, v53
    v_add_u32 v53, s11, v53
    s_lshl_b32 s11, s5, 6
    v_add_u32 v54, s11, v4
    v_lshlrev_b32 v54, 1, v54
    s_mov_b32 s76, s16
    s_mov_b32 s77, s17
    s_mov_b32 s78, 0x400000
    s_mov_b32 s79, 0x20000
    s_add_u32 s92, s52, 0x1800000
    s_addc_u32 s93, s53, 0
    s_mov_b32 s94, 0x800000
    s_mov_b32 s95, 0x20000
    s_xor_b32 s73, s72, 4096
    s_lshl_b32 s74, s73, 6
    s_add_u32 s75, s74, 4096
    v_lshlrev_b32 v59, 4, v1
    s_barrier
    s_cmp_lg_u32 s3, 0
    s_cbranch_scc1 c_noflag
    s_lshr_b32 s11, s2, 6
    s_lshl_b32 s11, 1, s11
    s_getreg_b32 s12, hwreg(HW_REG_XCC_ID, 0, 4)
    s_lshl_b32 s12, 0x100, s12
    s_or_b32 s11, s11, s12
    v_mov_b32 v16, s11
    s_and_b32 s11, s2, 63
    s_lshl_b32 s11, s11, 2
    v_mov_b32 v17, s11
    s_mov_b64 exec, 1
    buffer_atomic_or v16, v17, s[64:67], 0 offen sc1
    s_mov_b64 exec, -1
c_noflag:
    ds_read_b128 v[128:131], v160 offset:0
    ds_read_b128 v[144:147], v168 offset:0
    ds_read_b128 v[132:135], v160 offset:4096
    ds_read_b128 v[148:151], v168 offset:8192
    s_waitcnt lgkmcnt(2)
    v_mfma_f32_32x32x16_bf16 v[64:79], v[128:131], v[144:147], 0
    ds_read_b128 v[136:139], v161 offset:0
    s_waitcnt lgkmcnt(2)
    v_mfma_f32_32x32x16_bf16 v[80:95], v[132:135], v[144:147], 0
    ds_read_b128 v[152:155], v169 offset:0
    s_waitcnt lgkmcnt(2)
    v_mfma_f32_32x32x16_bf16 v[112:127], v[132:135], v[148:151], 0
    ds_read_b128 v[140:143], v161 offset:4096
    v_mfma_f32_32x32x16_bf16 v[96:111], v[128:131], v[148:151], 0
    ds_read_b128 v[156:159], v169 offset:8192
    s_waitcnt lgkmcnt(2)
    v_mfma_f32_32x32x16_bf16 v[64:79], v[136:139], v[152:155], v[64:79]
    ds_read_b128 v[128:131], v162 offset:0
    s_waitcnt lgkmcnt(2)
    v_mfma_f32_32x32x16_bf16 v[80:95], v[140:143], v[152:155], v[80:95]
    ds_read_b128 v[144:147], v170 offset:0
    s_waitcnt lgkmcnt(2)
    v_mfma_f32_32x32x16_bf16 v[112:127], v[140:143], v[156:159], v[112:127]
    ds_read_b128 v[132:135], v162 offset:4096
    v_mfma_f32_32x32x16_bf16 v[96:111], v[136:139], v[156:159], v[96:111]
    ds_read_b128 v[148:151], v170 offset:8192
    s_waitcnt lgkmcnt(2)
    v_mfma_f32_32x32x16_bf16 v[64:79], v[128:131], v[144:147], v[64:79]
    ds_read_b128 v[136:139], v163 offset:0
    s_waitcnt lgkmcnt(2)
    v_mfma_f32_32x32x16_bf16 v[80:95], v[132:135], v[144:147], v[80:95]
    ds_read_b128 v[152:155], v171 offset:0
    s_waitcnt lgkmcnt(2)
    v_mfma_f32_32x32x16_bf16 v[112:127], v[132:135], v[148:151], v[112:127]
    ds_read_b128 v[140:143], v163 offset:4096
    v_mfma_f32_32x32x16_bf16 v[96:111], v[128:131], v[148:151], v[96:111]
    ds_read_b128 v[156:159], v171 offset:8192
    s_waitcnt lgkmcnt(0)
    s_barrier
    v_mfma_f32_32x32x16_bf16 v[64:79], v[136:139], v[152:155], v[64:79]
    ds_read_b128 v[128:131], v160 offset:32768
    v_mfma_f32_32x32x16_bf16 v[80:95], v[140:143], v[152:155], v[80:95]
    ds_read_b128 v[144:147], v168 offset:32768
    v_mfma_f32_32x32x16_bf16 v[112:127], v[140:143], v[156:159], v[112:127]
    ds_read_b128 v[132:135], v160 offset:36864
    v_mfma_f32_32x32x16_bf16 v[96:111], v[136:139], v[156:159], v[96:111]
    ds_read_b128 v[148:151], v168 offset:40960
    s_waitcnt lgkmcnt(2)
    v_mfma_f32_32x32x16_bf16 v[64:79], v[128:131], v[144:147], v[64:79]
    ds_read_b128 v[136:139], v161 offset:32768
    s_waitcnt lgkmcnt(2)
    v_mfma_f32_32x32x16_bf16 v[80:95], v[132:135], v[144:147], v[80:95]
    ds_read_b128 v[152:155], v169 offset:32768
    s_waitcnt lgkmcnt(2)
    v_mfma_f32_32x32x16_bf16 v[112:127], v[132:135], v[148:151], v[112:127]
    ds_read_b128 v[140:143], v161 offset:36864
    v_mfma_f32_32x32x16_bf16 v[96:111], v[128:131], v[148:151], v[96:111]
    ds_read_b128 v[156:159], v169 offset:40960
    s_waitcnt lgkmcnt(2)
    v_mfma_f32_32x32x16_bf16 v[64:79], v[136:139], v[152:155], v[64:79]
    ds_read_b128 v[128:131], v162 offset:32768
    s_waitcnt lgkmcnt(2)
    v_mfma_f32_32x32x16_bf16 v[80:95], v[140:143], v[152:155], v[80:95]
    ds_read_b128 v[144:147], v170 offset:32768
    s_waitcnt lgkmcnt(2)
    v_mfma_f32_32x32x16_bf16 v[112:127], v[140:143], v[156:159], v[112:127]
    ds_read_b128 v[132:135], v162 offset:36864
    v_mfma_f32_32x32x16_bf16 v[96:111], v[136:139], v[156:159], v[96:111]
    ds_read_b128 v[148:151], v170 offset:40960
    s_waitcnt lgkmcnt(2)
    v_mfma_f32_32x32x16_bf16 v[64:79], v[128:131], v[144:147], v[64:79]
    ds_read_b128 v[136:139], v163 offset:32768
    s_waitcnt lgkmcnt(2)
    v_mfma_f32_32x32x16_bf16 v[80:95], v[132:135], v[144:147], v[80:95]
    ds_read_b128 v[152:155], v171 offset:32768
    s_waitcnt lgkmcnt(2)
    v_mfma_f32_32x32x16_bf16 v[112:127], v[132:135], v[148:151], v[112:127]
    ds_read_b128 v[140:143], v163 offset:36864
    v_mfma_f32_32x32x16_bf16 v[96:111], v[128:131], v[148:151], v[96:111]
    ds_read_b128 v[156:159], v171 offset:40960
    s_waitcnt lgkmcnt(0)
    s_barrier
    v_mfma_f32_32x32x16_bf16 v[64:79], v[136:139], v[152:155], v[64:79]
    ds_read_b128 v[128:131], v164 offset:0
    v_mfma_f32_32x32x16_bf16 v[80:95], v[140:143], v[152:155], v[80:95]
    ds_read_b128 v[144:147], v172 offset:0
    v_mfma_f32_32x32x16_bf16 v[112:127], v[140:143], v[156:159], v[112:127]
    ds_read_b128 v[132:135], v164 offset:4096
    v_mfma_f32_32x32x16_bf16 v[96:111], v[136:139], v[156:159], v[96:111]
    ds_read_b128 v[148:151], v172 offset:8192
    s_waitcnt lgkmcnt(2)
    v_mfma_f32_32x32x16_bf16 v[64:79], v[128:131], v[144:147], v[64:79]
    ds_read_b128 v[136:139], v165 offset:0
    s_waitcnt lgkmcnt(2)
    v_mfma_f32_32x32x16_bf16 v[80:95], v[132:135], v[144:147], v[80:95]
    ds_read_b128 v[152:155], v173 offset:0
    s_waitcnt lgkmcnt(2)
    v_mfma_f32_32x32x16_bf16 v[112:127], v[132:135], v[148:151], v[112:127]
    ds_read_b128 v[140:143], v165 offset:4096
    v_mfma_f32_32x32x16_bf16 v[96:111], v[128:131], v[148:151], v[96:111]
    ds_read_b128 v[156:159], v173 offset:8192
    s_waitcnt lgkmcnt(2)
    v_mfma_f32_32x32x16_bf16 v[64:79], v[136:139], v[152:155], v[64:79]
    ds_read_b128 v[128:131], v166 offset:0
    s_waitcnt lgkmcnt(2)
    v_mfma_f32_32x32x16_bf16 v[80:95], v[140:143], v[152:155], v[80:95]
    ds_read_b128 v[144:147], v174 offset:0
    s_waitcnt lgkmcnt(2)
    v_mfma_f32_32x32x16_bf16 v[112:127], v[140:143], v[156:159], v[112:127]
    ds_read_b128 v[132:135], v166 offset:4096
    v_mfma_f32_32x32x16_bf16 v[96:111], v[136:139], v[156:159], v[96:111]
    ds_read_b128 v[148:151], v174 offset:8192
    s_waitcnt lgkmcnt(2)
    v_mfma_f32_32x32x16_bf16 v[64:79], v[128:131], v[144:147], v[64:79]
    ds_read_b128 v[136:139], v167 offset:0
    s_waitcnt lgkmcnt(2)
    v_mfma_f32_32x32x16_bf16 v[80:95], v[132:135], v[144:147], v[80:95]
    ds_read_b128 v[152:155], v175 offset:0
    s_waitcnt lgkmcnt(2)
    v_mfma_f32_32x32x16_bf16 v[112:127], v[132:135], v[148:151], v[112:127]
    ds_read_b128 v[140:143], v167 offset:4096
    v_mfma_f32_32x32x16_bf16 v[96:111], v[128:131], v[148:151], v[96:111]
    ds_read_b128 v[156:159], v175 offset:8192
    s_waitcnt lgkmcnt(0)
    s_barrier
    v_mfma_f32_32x32x16_bf16 v[64:79], v[136:139], v[152:155], v[64:79]
    ds_read_b128 v[128:131], v160 offset:0
    v_mfma_f32_32x32x16_bf16 v[80:95], v[140:143], v[152:155], v[80:95]
    ds_read_b128 v[144:147], v168 offset:0
    v_mfma_f32_32x32x16_bf16 v[112:127], v[140:143], v[156:159], v[112:127]
    ds_read_b128 v[132:135], v160 offset:4096
    v_mfma_f32_32x32x16_bf16 v[96:111], v[136:139], v[156:159], v[96:111]
    ds_read_b128 v[148:151], v168 offset:8192
    s_waitcnt lgkmcnt(2)
    v_mfma_f32_32x32x16_bf16 v[64:79], v[128:131], v[144:147], v[64:79]
    ds_read_b128 v[136:139], v161 offset:0
    s_waitcnt lgkmcnt(2)
    v_mfma_f32_32x32x16_bf16 v[80:95], v[132:135], v[144:147], v[80:95]
    ds_read_b128 v[152:155], v169 offset:0
    s_waitcnt lgkmcnt(2)
    v_mfma_f32_32x32x16_bf16 v[112:127], v[132:135], v[148:151], v[112:127]
    ds_read_b128 v[140:143], v161 offset:4096
    v_mfma_f32_32x32x16_bf16 v[96:111], v[128:131], v[148:151], v[96:111]
    ds_read_b128 v[156:159], v169 offset:8192
    s_waitcnt lgkmcnt(2)
    v_mfma_f32_32x32x16_bf16 v[64:79], v[136:139], v[152:155], v[64:79]
    ds_read_b128 v[128:131], v162 offset:0
    s_waitcnt lgkmcnt(2)
    v_mfma_f32_32x32x16_bf16 v[80:95], v[140:143], v[152:155], v[80:95]
    ds_read_b128 v[144:147], v170 offset:0
    s_waitcnt lgkmcnt(2)
    v_mfma_f32_32x32x16_bf16 v[112:127], v[140:143], v[156:159], v[112:127]
    ds_read_b128 v[132:135], v162 offset:4096
    v_mfma_f32_32x32x16_bf16 v[96:111], v[136:139], v[156:159], v[96:111]
    ds_read_b128 v[148:151], v170 offset:8192
    s_waitcnt lgkmcnt(2)
    v_mfma_f32_32x32x16_bf16 v[64:79], v[128:131], v[144:147], v[64:79]
    ds_read_b128 v[136:139], v163 offset:0
    s_waitcnt lgkmcnt(2)
    v_mfma_f32_32x32x16_bf16 v[80:95], v[132:135], v[144:147], v[80:95]
    ds_read_b128 v[152:155], v171 offset:0
    s_waitcnt lgkmcnt(2)
    v_mfma_f32_32x32x16_bf16 v[112:127], v[132:135], v[148:151], v[112:127]
    ds_read_b128 v[140:143], v163 offset:4096
    v_mfma_f32_32x32x16_bf16 v[96:111], v[128:131], v[148:151], v[96:111]
    ds_read_b128 v[156:159], v171 offset:8192
    s_waitcnt lgkmcnt(0)
    s_barrier
    v_mfma_f32_32x32x16_bf16 v[64:79], v[136:139], v[152:155], v[64:79]
    ds_read_b128 v[128:131], v160 offset:32768
    v_mfma_f32_32x32x16_bf16 v[80:95], v[140:143], v[152:155], v[80:95]
    ds_read_b128 v[144:147], v168 offset:32768
    v_mfma_f32_32x32x16_bf16 v[112:127], v[140:143], v[156:159], v[112:127]
    ds_read_b128 v[132:135], v160 offset:36864
    v_mfma_f32_32x32x16_bf16 v[96:111], v[136:139], v[156:159], v[96:111]
    ds_read_b128 v[148:151], v168 offset:40960
    s_waitcnt lgkmcnt(2)
    v_mfma_f32_32x32x16_bf16 v[64:79], v[128:131], v[144:147], v[64:79]
    ds_read_b128 v[136:139], v161 offset:32768
    s_waitcnt lgkmcnt(2)
    v_mfma_f32_32x32x16_bf16 v[80:95], v[132:135], v[144:147], v[80:95]
    ds_read_b128 v[152:155], v169 offset:32768
    s_waitcnt lgkmcnt(2)
    v_mfma_f32_32x32x16_bf16 v[112:127], v[132:135], v[148:151], v[112:127]
    ds_read_b128 v[140:143], v161 offset:36864
    v_mfma_f32_32x32x16_bf16 v[96:111], v[128:131], v[148:151], v[96:111]
    ds_read_b128 v[156:159], v169 offset:40960
    s_waitcnt lgkmcnt(2)
    v_mfma_f32_32x32x16_bf16 v[64:79], v[136:139], v[152:155], v[64:79]
    ds_read_b128 v[128:131], v162 offset:32768
    s_waitcnt lgkmcnt(2)
    v_mfma_f32_32x32x16_bf16 v[80:95], v[140:143], v[152:155], v[80:95]
    ds_read_b128 v[144:147], v170 offset:32768
    s_waitcnt lgkmcnt(2)
    v_mfma_f32_32x32x16_bf16 v[112:127], v[140:143], v[156:159], v[112:127]
    ds_read_b128 v[132:135], v162 offset:36864
    v_mfma_f32_32x32x16_bf16 v[96:111], v[136:139], v[156:159], v[96:111]
    ds_read_b128 v[148:151], v170 offset:40960
    s_waitcnt lgkmcnt(2)
    v_mfma_f32_32x32x16_bf16 v[64:79], v[128:131], v[144:147], v[64:79]
    ds_read_b128 v[136:139], v163 offset:32768
    s_waitcnt lgkmcnt(2)
    v_mfma_f32_32x32x16_bf16 v[80:95], v[132:135], v[144:147], v[80:95]
    ds_read_b128 v[152:155], v171 offset:32768
    s_waitcnt lgkmcnt(2)
    v_mfma_f32_32x32x16_bf16 v[112:127], v[132:135], v[148:151], v[112:127]
    ds_read_b128 v[140:143], v163 offset:36864
    v_mfma_f32_32x32x16_bf16 v[96:111], v[128:131], v[148:151], v[96:111]
    ds_read_b128 v[156:159], v171 offset:40960
    s_waitcnt lgkmcnt(0)
    s_barrier
    v_mfma_f32_32x32x16_bf16 v[64:79], v[136:139], v[152:155], v[64:79]
    ds_read_b128 v[128:131], v164 offset:0
    v_mfma_f32_32x32x16_bf16 v[80:95], v[140:143], v[152:155], v[80:95]
    ds_read_b128 v[144:147], v172 offset:0
    v_mfma_f32_32x32x16_bf16 v[112:127], v[140:143], v[156:159], v[112:127]
    ds_read_b128 v[132:135], v164 offset:4096
    v_mfma_f32_32x32x16_bf16 v[96:111], v[136:139], v[156:159], v[96:111]
    ds_read_b128 v[148:151], v172 offset:8192
    s_waitcnt lgkmcnt(2)
    v_mfma_f32_32x32x16_bf16 v[64:79], v[128:131], v[144:147], v[64:79]
    ds_read_b128 v[136:139], v165 offset:0
    s_waitcnt lgkmcnt(2)
    v_mfma_f32_32x32x16_bf16 v[80:95], v[132:135], v[144:147], v[80:95]
    ds_read_b128 v[152:155], v173 offset:0
    s_waitcnt lgkmcnt(2)
    v_mfma_f32_32x32x16_bf16 v[112:127], v[132:135], v[148:151], v[112:127]
    ds_read_b128 v[140:143], v165 offset:4096
    v_mfma_f32_32x32x16_bf16 v[96:111], v[128:131], v[148:151], v[96:111]
    ds_read_b128 v[156:159], v173 offset:8192
    s_waitcnt lgkmcnt(2)
    v_mfma_f32_32x32x16_bf16 v[64:79], v[136:139], v[152:155], v[64:79]
    ds_read_b128 v[128:131], v166 offset:0
    s_waitcnt lgkmcnt(2)
    v_mfma_f32_32x32x16_bf16 v[80:95], v[140:143], v[152:155], v[80:95]
    ds_read_b128 v[144:147], v174 offset:0
    s_waitcnt lgkmcnt(2)
    v_mfma_f32_32x32x16_bf16 v[112:127], v[140:143], v[156:159], v[112:127]
    ds_read_b128 v[132:135], v166 offset:4096
    v_mfma_f32_32x32x16_bf16 v[96:111], v[136:139], v[156:159], v[96:111]
    ds_read_b128 v[148:151], v174 offset:8192
    s_waitcnt lgkmcnt(2)
    v_mfma_f32_32x32x16_bf16 v[64:79], v[128:131], v[144:147], v[64:79]
    ds_read_b128 v[136:139], v167 offset:0
    s_waitcnt lgkmcnt(2)
    v_mfma_f32_32x32x16_bf16 v[80:95], v[132:135], v[144:147], v[80:95]
    ds_read_b128 v[152:155], v175 offset:0
    s_waitcnt lgkmcnt(2)
    v_mfma_f32_32x32x16_bf16 v[112:127], v[132:135], v[148:151], v[112:127]
    ds_read_b128 v[140:143], v167 offset:4096
    v_mfma_f32_32x32x16_bf16 v[96:111], v[128:131], v[148:151], v[96:111]
    ds_read_b128 v[156:159], v175 offset:8192
    s_waitcnt lgkmcnt(0)
    s_barrier
    v_mfma_f32_32x32x16_bf16 v[64:79], v[136:139], v[152:155], v[64:79]
    ds_read_b128 v[128:131], v160 offset:0
    v_mfma_f32_32x32x16_bf16 v[80:95], v[140:143], v[152:155], v[80:95]
    ds_read_b128 v[144:147], v168 offset:0
    v_mfma_f32_32x32x16_bf16 v[112:127], v[140:143], v[156:159], v[112:127]
    ds_read_b128 v[132:135], v160 offset:4096
    v_mfma_f32_32x32x16_bf16 v[96:111], v[136:139], v[156:159], v[96:111]
    ds_read_b128 v[148:151], v168 offset:8192
    s_waitcnt lgkmcnt(2)
    v_mfma_f32_32x32x16_bf16 v[64:79], v[128:131], v[144:147], v[64:79]
    ds_read_b128 v[136:139], v161 offset:0
    s_waitcnt lgkmcnt(2)
    v_mfma_f32_32x32x16_bf16 v[80:95], v[132:135], v[144:147], v[80:95]
    ds_read_b128 v[152:155], v169 offset:0
    s_waitcnt lgkmcnt(2)
    v_mfma_f32_32x32x16_bf16 v[112:127], v[132:135], v[148:151], v[112:127]
    ds_read_b128 v[140:143], v161 offset:4096
    v_mfma_f32_32x32x16_bf16 v[96:111], v[128:131], v[148:151], v[96:111]
    ds_read_b128 v[156:159], v169 offset:8192
    s_waitcnt lgkmcnt(2)
    v_mfma_f32_32x32x16_bf16 v[64:79], v[136:139], v[152:155], v[64:79]
    ds_read_b128 v[128:131], v162 offset:0
    s_waitcnt lgkmcnt(2)
    v_mfma_f32_32x32x16_bf16 v[80:95], v[140:143], v[152:155], v[80:95]
    ds_read_b128 v[144:147], v170 offset:0
    s_waitcnt lgkmcnt(2)
    v_mfma_f32_32x32x16_bf16 v[112:127], v[140:143], v[156:159], v[112:127]
    ds_read_b128 v[132:135], v162 offset:4096
    v_mfma_f32_32x32x16_bf16 v[96:111], v[136:139], v[156:159], v[96:111]
    ds_read_b128 v[148:151], v170 offset:8192
    s_waitcnt lgkmcnt(2)
    v_mfma_f32_32x32x16_bf16 v[64:79], v[128:131], v[144:147], v[64:79]
    ds_read_b128 v[136:139], v163 offset:0
    s_waitcnt lgkmcnt(2)
    v_mfma_f32_32x32x16_bf16 v[80:95], v[132:135], v[144:147], v[80:95]
    ds_read_b128 v[152:155], v171 offset:0
    s_waitcnt lgkmcnt(2)
    v_mfma_f32_32x32x16_bf16 v[112:127], v[132:135], v[148:151], v[112:127]
    ds_read_b128 v[140:143], v163 offset:4096
    v_mfma_f32_32x32x16_bf16 v[96:111], v[128:131], v[148:151], v[96:111]
    ds_read_b128 v[156:159], v171 offset:8192
    s_waitcnt lgkmcnt(0)
    s_barrier
    v_mfma_f32_32x32x16_bf16 v[64:79], v[136:139], v[152:155], v[64:79]
    ds_read_b128 v[128:131], v160 offset:32768
    v_mfma_f32_32x32x16_bf16 v[80:95], v[140:143], v[152:155], v[80:95]
    ds_read_b128 v[144:147], v168 offset:32768
    v_mfma_f32_32x32x16_bf16 v[112:127], v[140:143], v[156:159], v[112:127]
    ds_read_b128 v[132:135], v160 offset:36864
    v_mfma_f32_32x32x16_bf16 v[96:111], v[136:139], v[156:159], v[96:111]
    ds_read_b128 v[148:151], v168 offset:40960
    s_waitcnt lgkmcnt(2)
    v_mfma_f32_32x32x16_bf16 v[64:79], v[128:131], v[144:147], v[64:79]
    ds_read_b128 v[136:139], v161 offset:32768
    s_waitcnt lgkmcnt(2)
    v_mfma_f32_32x32x16_bf16 v[80:95], v[132:135], v[144:147], v[80:95]
    ds_read_b128 v[152:155], v169 offset:32768
    s_waitcnt lgkmcnt(2)
    v_mfma_f32_32x32x16_bf16 v[112:127], v[132:135], v[148:151], v[112:127]
    ds_read_b128 v[140:143], v161 offset:36864
    v_mfma_f32_32x32x16_bf16 v[96:111], v[128:131], v[148:151], v[96:111]
    ds_read_b128 v[156:159], v169 offset:40960
    s_waitcnt lgkmcnt(2)
    v_mfma_f32_32x32x16_bf16 v[64:79], v[136:139], v[152:155], v[64:79]
    ds_read_b128 v[128:131], v162 offset:32768
    s_waitcnt lgkmcnt(2)
    v_mfma_f32_32x32x16_bf16 v[80:95], v[140:143], v[152:155], v[80:95]
    ds_read_b128 v[144:147], v170 offset:32768
    s_waitcnt lgkmcnt(2)
    v_mfma_f32_32x32x16_bf16 v[112:127], v[140:143], v[156:159], v[112:127]
    ds_read_b128 v[132:135], v162 offset:36864
    v_mfma_f32_32x32x16_bf16 v[96:111], v[136:139], v[156:159], v[96:111]
    ds_read_b128 v[148:151], v170 offset:40960
    s_waitcnt lgkmcnt(2)
    v_mfma_f32_32x32x16_bf16 v[64:79], v[128:131], v[144:147], v[64:79]
    ds_read_b128 v[136:139], v163 offset:32768
    s_waitcnt lgkmcnt(2)
    v_mfma_f32_32x32x16_bf16 v[80:95], v[132:135], v[144:147], v[80:95]
    ds_read_b128 v[152:155], v171 offset:32768
    s_waitcnt lgkmcnt(2)
    v_mfma_f32_32x32x16_bf16 v[112:127], v[132:135], v[148:151], v[112:127]
    ds_read_b128 v[140:143], v163 offset:36864
    v_mfma_f32_32x32x16_bf16 v[96:111], v[128:131], v[148:151], v[96:111]
    ds_read_b128 v[156:159], v171 offset:40960
    s_waitcnt lgkmcnt(0)
    s_barrier
    v_mfma_f32_32x32x16_bf16 v[64:79], v[136:139], v[152:155], v[64:79]
    ds_read_b128 v[128:131], v164 offset:0
    v_mfma_f32_32x32x16_bf16 v[80:95], v[140:143], v[152:155], v[80:95]
    ds_read_b128 v[144:147], v172 offset:0
    v_mfma_f32_32x32x16_bf16 v[112:127], v[140:143], v[156:159], v[112:127]
    ds_read_b128 v[132:135], v164 offset:4096
    v_mfma_f32_32x32x16_bf16 v[96:111], v[136:139], v[156:159], v[96:111]
    ds_read_b128 v[148:151], v172 offset:8192
    s_waitcnt lgkmcnt(2)
    v_mfma_f32_32x32x16_bf16 v[64:79], v[128:131], v[144:147], v[64:79]
    ds_read_b128 v[136:139], v165 offset:0
    s_waitcnt lgkmcnt(2)
    v_mfma_f32_32x32x16_bf16 v[80:95], v[132:135], v[144:147], v[80:95]
    ds_read_b128 v[152:155], v173 offset:0
    s_waitcnt lgkmcnt(2)
    v_mfma_f32_32x32x16_bf16 v[112:127], v[132:135], v[148:151], v[112:127]
    ds_read_b128 v[140:143], v165 offset:4096
    v_mfma_f32_32x32x16_bf16 v[96:111], v[128:131], v[148:151], v[96:111]
    ds_read_b128 v[156:159], v173 offset:8192
    s_waitcnt lgkmcnt(2)
    v_mfma_f32_32x32x16_bf16 v[64:79], v[136:139], v[152:155], v[64:79]
    ds_read_b128 v[128:131], v166 offset:0
    s_waitcnt lgkmcnt(2)
    v_mfma_f32_32x32x16_bf16 v[80:95], v[140:143], v[152:155], v[80:95]
    ds_read_b128 v[144:147], v174 offset:0
    s_waitcnt lgkmcnt(2)
    v_mfma_f32_32x32x16_bf16 v[112:127], v[140:143], v[156:159], v[112:127]
    ds_read_b128 v[132:135], v166 offset:4096
    v_mfma_f32_32x32x16_bf16 v[96:111], v[136:139], v[156:159], v[96:111]
    ds_read_b128 v[148:151], v174 offset:8192
    s_waitcnt lgkmcnt(2)
    v_mfma_f32_32x32x16_bf16 v[64:79], v[128:131], v[144:147], v[64:79]
    ds_read_b128 v[136:139], v167 offset:0
    s_waitcnt lgkmcnt(2)
    v_mfma_f32_32x32x16_bf16 v[80:95], v[132:135], v[144:147], v[80:95]
    ds_read_b128 v[152:155], v175 offset:0
    s_waitcnt lgkmcnt(2)
    v_mfma_f32_32x32x16_bf16 v[112:127], v[132:135], v[148:151], v[112:127]
    ds_read_b128 v[140:143], v167 offset:4096
    v_mfma_f32_32x32x16_bf16 v[96:111], v[128:131], v[148:151], v[96:111]
    ds_read_b128 v[156:159], v175 offset:8192
    s_waitcnt lgkmcnt(0)
    s_barrier
    v_mfma_f32_32x32x16_bf16 v[64:79], v[136:139], v[152:155], v[64:79]
    ds_read_b128 v[128:131], v160 offset:0
    v_mfma_f32_32x32x16_bf16 v[80:95], v[140:143], v[152:155], v[80:95]
    ds_read_b128 v[144:147], v168 offset:0
    v_mfma_f32_32x32x16_bf16 v[112:127], v[140:143], v[156:159], v[112:127]
    ds_read_b128 v[132:135], v160 offset:4096
    v_mfma_f32_32x32x16_bf16 v[96:111], v[136:139], v[156:159], v[96:111]
    ds_read_b128 v[148:151], v168 offset:8192
    s_waitcnt lgkmcnt(2)
    v_mfma_f32_32x32x16_bf16 v[64:79], v[128:131], v[144:147], v[64:79]
    ds_read_b128 v[136:139], v161 offset:0
    s_waitcnt lgkmcnt(2)
    v_mfma_f32_32x32x16_bf16 v[80:95], v[132:135], v[144:147], v[80:95]
    ds_read_b128 v[152:155], v169 offset:0
    s_waitcnt lgkmcnt(2)
    v_mfma_f32_32x32x16_bf16 v[112:127], v[132:135], v[148:151], v[112:127]
    ds_read_b128 v[140:143], v161 offset:4096
    v_mfma_f32_32x32x16_bf16 v[96:111], v[128:131], v[148:151], v[96:111]
    ds_read_b128 v[156:159], v169 offset:8192
    s_waitcnt lgkmcnt(2)
    v_mfma_f32_32x32x16_bf16 v[64:79], v[136:139], v[152:155], v[64:79]
    ds_read_b128 v[128:131], v162 offset:0
    s_waitcnt lgkmcnt(2)
    v_mfma_f32_32x32x16_bf16 v[80:95], v[140:143], v[152:155], v[80:95]
    ds_read_b128 v[144:147], v170 offset:0
    s_waitcnt lgkmcnt(2)
    v_mfma_f32_32x32x16_bf16 v[112:127], v[140:143], v[156:159], v[112:127]
    ds_read_b128 v[132:135], v162 offset:4096
    v_mfma_f32_32x32x16_bf16 v[96:111], v[136:139], v[156:159], v[96:111]
    ds_read_b128 v[148:151], v170 offset:8192
    s_waitcnt lgkmcnt(2)
    v_mfma_f32_32x32x16_bf16 v[64:79], v[128:131], v[144:147], v[64:79]
    ds_read_b128 v[136:139], v163 offset:0
    s_waitcnt lgkmcnt(2)
    v_mfma_f32_32x32x16_bf16 v[80:95], v[132:135], v[144:147], v[80:95]
    ds_read_b128 v[152:155], v171 offset:0
    s_waitcnt lgkmcnt(2)
    v_mfma_f32_32x32x16_bf16 v[112:127], v[132:135], v[148:151], v[112:127]
    ds_read_b128 v[140:143], v163 offset:4096
    v_mfma_f32_32x32x16_bf16 v[96:111], v[128:131], v[148:151], v[96:111]
    ds_read_b128 v[156:159], v171 offset:8192
    s_waitcnt lgkmcnt(0)
    s_barrier
    v_mfma_f32_32x32x16_bf16 v[64:79], v[136:139], v[152:155], v[64:79]
    ds_read_b128 v[128:131], v160 offset:32768
    v_mfma_f32_32x32x16_bf16 v[80:95], v[140:143], v[152:155], v[80:95]
    ds_read_b128 v[144:147], v168 offset:32768
    v_mfma_f32_32x32x16_bf16 v[112:127], v[140:143], v[156:159], v[112:127]
    ds_read_b128 v[132:135], v160 offset:36864
    v_mfma_f32_32x32x16_bf16 v[96:111], v[136:139], v[156:159], v[96:111]
    ds_read_b128 v[148:151], v168 offset:40960
    s_waitcnt lgkmcnt(2)
    v_mfma_f32_32x32x16_bf16 v[64:79], v[128:131], v[144:147], v[64:79]
    ds_read_b128 v[136:139], v161 offset:32768
    s_waitcnt lgkmcnt(2)
    v_mfma_f32_32x32x16_bf16 v[80:95], v[132:135], v[144:147], v[80:95]
    ds_read_b128 v[152:155], v169 offset:32768
    s_waitcnt lgkmcnt(2)
    v_mfma_f32_32x32x16_bf16 v[112:127], v[132:135], v[148:151], v[112:127]
    ds_read_b128 v[140:143], v161 offset:36864
    v_mfma_f32_32x32x16_bf16 v[96:111], v[128:131], v[148:151], v[96:111]
    ds_read_b128 v[156:159], v169 offset:40960
    s_waitcnt lgkmcnt(2)
    v_mfma_f32_32x32x16_bf16 v[64:79], v[136:139], v[152:155], v[64:79]
    ds_read_b128 v[128:131], v162 offset:32768
    s_waitcnt lgkmcnt(2)
    v_mfma_f32_32x32x16_bf16 v[80:95], v[140:143], v[152:155], v[80:95]
    ds_read_b128 v[144:147], v170 offset:32768
    s_waitcnt lgkmcnt(2)
    v_mfma_f32_32x32x16_bf16 v[112:127], v[140:143], v[156:159], v[112:127]
    ds_read_b128 v[132:135], v162 offset:36864
    v_mfma_f32_32x32x16_bf16 v[96:111], v[136:139], v[156:159], v[96:111]
    ds_read_b128 v[148:151], v170 offset:40960
    s_waitcnt lgkmcnt(2)
    v_mfma_f32_32x32x16_bf16 v[64:79], v[128:131], v[144:147], v[64:79]
    ds_read_b128 v[136:139], v163 offset:32768
    s_waitcnt lgkmcnt(2)
    v_mfma_f32_32x32x16_bf16 v[80:95], v[132:135], v[144:147], v[80:95]
    ds_read_b128 v[152:155], v171 offset:32768
    s_waitcnt lgkmcnt(2)
    v_mfma_f32_32x32x16_bf16 v[112:127], v[132:135], v[148:151], v[112:127]
    ds_read_b128 v[140:143], v163 offset:36864
    v_mfma_f32_32x32x16_bf16 v[96:111], v[128:131], v[148:151], v[96:111]
    ds_read_b128 v[156:159], v171 offset:40960
    s_waitcnt lgkmcnt(0)
    s_barrier
    v_mfma_f32_32x32x16_bf16 v[64:79], v[136:139], v[152:155], v[64:79]
    ds_read_b128 v[128:131], v164 offset:0
    v_mfma_f32_32x32x16_bf16 v[80:95], v[140:143], v[152:155], v[80:95]
    ds_read_b128 v[144:147], v172 offset:0
    v_mfma_f32_32x32x16_bf16 v[112:127], v[140:143], v[156:159], v[112:127]
    ds_read_b128 v[132:135], v164 offset:4096
    v_mfma_f32_32x32x16_bf16 v[96:111], v[136:139], v[156:159], v[96:111]
    ds_read_b128 v[148:151], v172 offset:8192
    s_waitcnt lgkmcnt(2)
    v_mfma_f32_32x32x16_bf16 v[64:79], v[128:131], v[144:147], v[64:79]
    ds_read_b128 v[136:139], v165 offset:0
    s_waitcnt lgkmcnt(2)
    v_mfma_f32_32x32x16_bf16 v[80:95], v[132:135], v[144:147], v[80:95]
    ds_read_b128 v[152:155], v173 offset:0
    s_waitcnt lgkmcnt(2)
    v_mfma_f32_32x32x16_bf16 v[112:127], v[132:135], v[148:151], v[112:127]
    ds_read_b128 v[140:143], v165 offset:4096
    v_mfma_f32_32x32x16_bf16 v[96:111], v[128:131], v[148:151], v[96:111]
    ds_read_b128 v[156:159], v173 offset:8192
    s_waitcnt lgkmcnt(2)
    v_mfma_f32_32x32x16_bf16 v[64:79], v[136:139], v[152:155], v[64:79]
    ds_read_b128 v[128:131], v166 offset:0
    s_waitcnt lgkmcnt(2)
    v_mfma_f32_32x32x16_bf16 v[80:95], v[140:143], v[152:155], v[80:95]
    ds_read_b128 v[144:147], v174 offset:0
    s_waitcnt lgkmcnt(2)
    v_mfma_f32_32x32x16_bf16 v[112:127], v[140:143], v[156:159], v[112:127]
    ds_read_b128 v[132:135], v166 offset:4096
    v_mfma_f32_32x32x16_bf16 v[96:111], v[136:139], v[156:159], v[96:111]
    ds_read_b128 v[148:151], v174 offset:8192
    s_waitcnt lgkmcnt(2)
    v_mfma_f32_32x32x16_bf16 v[64:79], v[128:131], v[144:147], v[64:79]
    ds_read_b128 v[136:139], v167 offset:0
    s_waitcnt lgkmcnt(2)
    v_mfma_f32_32x32x16_bf16 v[80:95], v[132:135], v[144:147], v[80:95]
    ds_read_b128 v[152:155], v175 offset:0
    s_waitcnt lgkmcnt(2)
    v_mfma_f32_32x32x16_bf16 v[112:127], v[132:135], v[148:151], v[112:127]
    ds_read_b128 v[140:143], v167 offset:4096
    v_mfma_f32_32x32x16_bf16 v[96:111], v[128:131], v[148:151], v[96:111]
    ds_read_b128 v[156:159], v175 offset:8192
    s_waitcnt lgkmcnt(0)
    s_barrier
    v_mfma_f32_32x32x16_bf16 v[64:79], v[136:139], v[152:155], v[64:79]
    ds_read_b128 v[128:131], v160 offset:0
    v_mfma_f32_32x32x16_bf16 v[80:95], v[140:143], v[152:155], v[80:95]
    ds_read_b128 v[144:147], v168 offset:0
    v_mfma_f32_32x32x16_bf16 v[112:127], v[140:143], v[156:159], v[112:127]
    ds_read_b128 v[132:135], v160 offset:4096
    v_mfma_f32_32x32x16_bf16 v[96:111], v[136:139], v[156:159], v[96:111]
    ds_read_b128 v[148:151], v168 offset:8192
    s_waitcnt lgkmcnt(2)
    v_mfma_f32_32x32x16_bf16 v[64:79], v[128:131], v[144:147], v[64:79]
    ds_read_b128 v[136:139], v161 offset:0
    s_waitcnt lgkmcnt(2)
    v_mfma_f32_32x32x16_bf16 v[80:95], v[132:135], v[144:147], v[80:95]
    ds_read_b128 v[152:155], v169 offset:0
    s_waitcnt lgkmcnt(2)
    v_mfma_f32_32x32x16_bf16 v[112:127], v[132:135], v[148:151], v[112:127]
    ds_read_b128 v[140:143], v161 offset:4096
    v_mfma_f32_32x32x16_bf16 v[96:111], v[128:131], v[148:151], v[96:111]
    ds_read_b128 v[156:159], v169 offset:8192
    buffer_load_dword v20, v21, s[64:67], 0 offen sc1
    s_waitcnt lgkmcnt(2)
    v_mfma_f32_32x32x16_bf16 v[64:79], v[136:139], v[152:155], v[64:79]
    ds_read_b128 v[128:131], v162 offset:0
    s_waitcnt lgkmcnt(2)
    v_mfma_f32_32x32x16_bf16 v[80:95], v[140:143], v[152:155], v[80:95]
    ds_read_b128 v[144:147], v170 offset:0
    s_waitcnt lgkmcnt(2)
    v_mfma_f32_32x32x16_bf16 v[112:127], v[140:143], v[156:159], v[112:127]
    ds_read_b128 v[132:135], v162 offset:4096
    v_mfma_f32_32x32x16_bf16 v[96:111], v[136:139], v[156:159], v[96:111]
    ds_read_b128 v[148:151], v170 offset:8192
    s_waitcnt lgkmcnt(2)
    v_mfma_f32_32x32x16_bf16 v[64:79], v[128:131], v[144:147], v[64:79]
    ds_read_b128 v[136:139], v163 offset:0
    s_waitcnt lgkmcnt(2)
    v_mfma_f32_32x32x16_bf16 v[80:95], v[132:135], v[144:147], v[80:95]
    ds_read_b128 v[152:155], v171 offset:0
    s_waitcnt lgkmcnt(2)
    v_mfma_f32_32x32x16_bf16 v[112:127], v[132:135], v[148:151], v[112:127]
    ds_read_b128 v[140:143], v163 offset:4096
    v_mfma_f32_32x32x16_bf16 v[96:111], v[128:131], v[148:151], v[96:111]
    ds_read_b128 v[156:159], v171 offset:8192
    s_waitcnt lgkmcnt(0)
    s_barrier
    v_mfma_f32_32x32x16_bf16 v[64:79], v[136:139], v[152:155], v[64:79]
    ds_read_b128 v[128:131], v160 offset:32768
    v_mfma_f32_32x32x16_bf16 v[80:95], v[140:143], v[152:155], v[80:95]
    ds_read_b128 v[144:147], v168 offset:32768
    v_mfma_f32_32x32x16_bf16 v[112:127], v[140:143], v[156:159], v[112:127]
    ds_read_b128 v[132:135], v160 offset:36864
    v_mfma_f32_32x32x16_bf16 v[96:111], v[136:139], v[156:159], v[96:111]
    ds_read_b128 v[148:151], v168 offset:40960
    s_waitcnt lgkmcnt(2)
    v_mfma_f32_32x32x16_bf16 v[64:79], v[128:131], v[144:147], v[64:79]
    ds_read_b128 v[136:139], v161 offset:32768
    s_waitcnt lgkmcnt(2)
    v_mfma_f32_32x32x16_bf16 v[80:95], v[132:135], v[144:147], v[80:95]
    ds_read_b128 v[152:155], v169 offset:32768
    s_waitcnt lgkmcnt(2)
    v_mfma_f32_32x32x16_bf16 v[112:127], v[132:135], v[148:151], v[112:127]
    ds_read_b128 v[140:143], v161 offset:36864
    v_mfma_f32_32x32x16_bf16 v[96:111], v[128:131], v[148:151], v[96:111]
    ds_read_b128 v[156:159], v169 offset:40960
    s_waitcnt lgkmcnt(2)
    v_mfma_f32_32x32x16_bf16 v[64:79], v[136:139], v[152:155], v[64:79]
    ds_read_b128 v[128:131], v162 offset:32768
    s_waitcnt lgkmcnt(2)
    v_mfma_f32_32x32x16_bf16 v[80:95], v[140:143], v[152:155], v[80:95]
    ds_read_b128 v[144:147], v170 offset:32768
    s_waitcnt lgkmcnt(2)
    v_mfma_f32_32x32x16_bf16 v[112:127], v[140:143], v[156:159], v[112:127]
    ds_read_b128 v[132:135], v162 offset:36864
    v_mfma_f32_32x32x16_bf16 v[96:111], v[136:139], v[156:159], v[96:111]
    ds_read_b128 v[148:151], v170 offset:40960
    s_waitcnt lgkmcnt(2)
    v_mfma_f32_32x32x16_bf16 v[64:79], v[128:131], v[144:147], v[64:79]
    ds_read_b128 v[136:139], v163 offset:32768
    s_waitcnt lgkmcnt(2)
    v_mfma_f32_32x32x16_bf16 v[80:95], v[132:135], v[144:147], v[80:95]
    ds_read_b128 v[152:155], v171 offset:32768
    s_waitcnt lgkmcnt(2)
    v_mfma_f32_32x32x16_bf16 v[112:127], v[132:135], v[148:151], v[112:127]
    ds_read_b128 v[140:143], v163 offset:36864
    v_mfma_f32_32x32x16_bf16 v[96:111], v[128:131], v[148:151], v[96:111]
    ds_read_b128 v[156:159], v171 offset:40960
    s_waitcnt lgkmcnt(0)
    s_barrier
    v_mfma_f32_32x32x16_bf16 v[64:79], v[136:139], v[152:155], v[64:79]
    ds_read_b128 v[128:131], v164 offset:0
    v_mfma_f32_32x32x16_bf16 v[80:95], v[140:143], v[152:155], v[80:95]
    ds_read_b128 v[144:147], v172 offset:0
    v_mfma_f32_32x32x16_bf16 v[112:127], v[140:143], v[156:159], v[112:127]
    ds_read_b128 v[132:135], v164 offset:4096
    v_mfma_f32_32x32x16_bf16 v[96:111], v[136:139], v[156:159], v[96:111]
    ds_read_b128 v[148:151], v172 offset:8192
    s_waitcnt lgkmcnt(2)
    v_mfma_f32_32x32x16_bf16 v[64:79], v[128:131], v[144:147], v[64:79]
    ds_read_b128 v[136:139], v165 offset:0
    s_waitcnt lgkmcnt(2)
    v_mfma_f32_32x32x16_bf16 v[80:95], v[132:135], v[144:147], v[80:95]
    ds_read_b128 v[152:155], v173 offset:0
    s_waitcnt lgkmcnt(2)
    v_mfma_f32_32x32x16_bf16 v[112:127], v[132:135], v[148:151], v[112:127]
    ds_read_b128 v[140:143], v165 offset:4096
    v_mfma_f32_32x32x16_bf16 v[96:111], v[128:131], v[148:151], v[96:111]
    ds_read_b128 v[156:159], v173 offset:8192
    s_waitcnt lgkmcnt(2)
    v_mfma_f32_32x32x16_bf16 v[64:79], v[136:139], v[152:155], v[64:79]
    ds_read_b128 v[128:131], v166 offset:0
    s_waitcnt lgkmcnt(2)
    v_mfma_f32_32x32x16_bf16 v[80:95], v[140:143], v[152:155], v[80:95]
    ds_read_b128 v[144:147], v174 offset:0
    s_waitcnt lgkmcnt(2)
    v_mfma_f32_32x32x16_bf16 v[112:127], v[140:143], v[156:159], v[112:127]
    ds_read_b128 v[132:135], v166 offset:4096
    v_mfma_f32_32x32x16_bf16 v[96:111], v[136:139], v[156:159], v[96:111]
    ds_read_b128 v[148:151], v174 offset:8192
    s_waitcnt lgkmcnt(2)
    v_mfma_f32_32x32x16_bf16 v[64:79], v[128:131], v[144:147], v[64:79]
    ds_read_b128 v[136:139], v167 offset:0
    s_waitcnt lgkmcnt(2)
    v_mfma_f32_32x32x16_bf16 v[80:95], v[132:135], v[144:147], v[80:95]
    ds_read_b128 v[152:155], v175 offset:0
    s_waitcnt lgkmcnt(2)
    v_mfma_f32_32x32x16_bf16 v[112:127], v[132:135], v[148:151], v[112:127]
    ds_read_b128 v[140:143], v167 offset:4096
    v_mfma_f32_32x32x16_bf16 v[96:111], v[128:131], v[148:151], v[96:111]
    ds_read_b128 v[156:159], v175 offset:8192
    s_waitcnt lgkmcnt(0)
    s_barrier
    v_mfma_f32_32x32x16_bf16 v[64:79], v[136:139], v[152:155], v[64:79]
    ds_read_b128 v[128:131], v160 offset:0
    v_mfma_f32_32x32x16_bf16 v[80:95], v[140:143], v[152:155], v[80:95]
    ds_read_b128 v[144:147], v168 offset:0
    v_mfma_f32_32x32x16_bf16 v[112:127], v[140:143], v[156:159], v[112:127]
    ds_read_b128 v[132:135], v160 offset:4096
    v_mfma_f32_32x32x16_bf16 v[96:111], v[136:139], v[156:159], v[96:111]
    ds_read_b128 v[148:151], v168 offset:8192
    s_waitcnt lgkmcnt(2)
    v_mfma_f32_32x32x16_bf16 v[64:79], v[128:131], v[144:147], v[64:79]
    ds_read_b128 v[136:139], v161 offset:0
    s_waitcnt lgkmcnt(2)
    v_mfma_f32_32x32x16_bf16 v[80:95], v[132:135], v[144:147], v[80:95]
    ds_read_b128 v[152:155], v169 offset:0
    s_waitcnt lgkmcnt(2)
    v_mfma_f32_32x32x16_bf16 v[112:127], v[132:135], v[148:151], v[112:127]
    ds_read_b128 v[140:143], v161 offset:4096
    v_mfma_f32_32x32x16_bf16 v[96:111], v[128:131], v[148:151], v[96:111]
    ds_read_b128 v[156:159], v169 offset:8192
    s_waitcnt lgkmcnt(2)
    v_mfma_f32_32x32x16_bf16 v[64:79], v[136:139], v[152:155], v[64:79]
    ds_read_b128 v[128:131], v162 offset:0
    s_waitcnt lgkmcnt(2)
    v_mfma_f32_32x32x16_bf16 v[80:95], v[140:143], v[152:155], v[80:95]
    ds_read_b128 v[144:147], v170 offset:0
    s_waitcnt lgkmcnt(2)
    v_mfma_f32_32x32x16_bf16 v[112:127], v[140:143], v[156:159], v[112:127]
    ds_read_b128 v[132:135], v162 offset:4096
    v_mfma_f32_32x32x16_bf16 v[96:111], v[136:139], v[156:159], v[96:111]
    ds_read_b128 v[148:151], v170 offset:8192
    s_waitcnt lgkmcnt(2)
    v_mfma_f32_32x32x16_bf16 v[64:79], v[128:131], v[144:147], v[64:79]
    ds_read_b128 v[136:139], v163 offset:0
    s_waitcnt lgkmcnt(2)
    v_mfma_f32_32x32x16_bf16 v[80:95], v[132:135], v[144:147], v[80:95]
    ds_read_b128 v[152:155], v171 offset:0
    s_waitcnt lgkmcnt(2)
    v_mfma_f32_32x32x16_bf16 v[112:127], v[132:135], v[148:151], v[112:127]
    ds_read_b128 v[140:143], v163 offset:4096
    v_mfma_f32_32x32x16_bf16 v[96:111], v[128:131], v[148:151], v[96:111]
    ds_read_b128 v[156:159], v171 offset:8192
    s_waitcnt lgkmcnt(0)
    s_barrier
    v_mfma_f32_32x32x16_bf16 v[64:79], v[136:139], v[152:155], v[64:79]
    v_mfma_f32_32x32x16_bf16 v[80:95], v[140:143], v[152:155], v[80:95]
    v_mfma_f32_32x32x16_bf16 v[112:127], v[140:143], v[156:159], v[112:127]
    v_mfma_f32_32x32x16_bf16 v[96:111], v[136:139], v[156:159], v[96:111]
    s_nop 8
    v_fma_f32 v28, v64, v176, v66
    v_fma_f32 v29, v65, v176, v67
    s_nop 0
    v_fma_f32 v44, v96, v176, v98
    v_fma_f32 v45, v97, v176, v99
    v_fma_f32 v28, v96, -v177, v28
    v_fma_f32 v29, v97, -v177, v29
    v_fma_f32 v44, v64, v177, v44
    v_fma_f32 v45, v65, v177, v45
    v_fma_f32 v24, v28, v176, v68
    v_fma_f32 v25, v29, v176, v69
    v_fma_f32 v26, v44, v176, v100
    v_fma_f32 v27, v45, v176, v101
    v_fma_f32 v24, v44, -v177, v24
    v_fma_f32 v25, v45, -v177, v25
    v_fma_f32 v26, v28, v177, v26
    v_fma_f32 v27, v29, v177, v27
    v_fma_f32 v28, v24, v176, v70
    v_fma_f32 v29, v25, v176, v71
    v_fma_f32 v44, v26, v176, v102
    v_fma_f32 v45, v27, v176, v103
    v_fma_f32 v28, v26, -v177, v28
    v_fma_f32 v29, v27, -v177, v29
    v_fma_f32 v44, v24, v177, v44
    v_fma_f32 v45, v25, v177, v45
    v_fma_f32 v24, v28, v176, v72
    v_fma_f32 v25, v29, v176, v73
    v_fma_f32 v26, v44, v176, v104
    v_fma_f32 v27, v45, v176, v105
    v_fma_f32 v24, v44, -v177, v24
    v_fma_f32 v25, v45, -v177, v25
    v_fma_f32 v26, v28, v177, v26
    v_fma_f32 v27, v29, v177, v27
    v_fma_f32 v28, v24, v176, v74
    v_fma_f32 v29, v25, v176, v75
    v_fma_f32 v44, v26, v176, v106
    v_fma_f32 v45, v27, v176, v107
    v_fma_f32 v28, v26, -v177, v28
    v_fma_f32 v29, v27, -v177, v29
    v_fma_f32 v44, v24, v177, v44
    v_fma_f32 v45, v25, v177, v45
    v_fma_f32 v24, v28, v176, v76
    v_fma_f32 v25, v29, v176, v77
    v_fma_f32 v26, v44, v176, v108
    v_fma_f32 v27, v45, v176, v109
    v_fma_f32 v24, v44, -v177, v24
    v_fma_f32 v25, v45, -v177, v25
    v_fma_f32 v26, v28, v177, v26
    v_fma_f32 v27, v29, v177, v27
    v_fma_f32 v28, v24, v176, v78
    v_fma_f32 v29, v25, v176, v79
    v_fma_f32 v44, v26, v176, v110
    v_fma_f32 v45, v27, v176, v111
    v_fma_f32 v28, v26, -v177, v28
    v_fma_f32 v29, v27, -v177, v29
    v_fma_f32 v44, v24, v177, v44
    v_fma_f32 v45, v25, v177, v45
    v_fma_f32 v24, v28, v176, v80
    v_fma_f32 v25, v29, v176, v81
    v_fma_f32 v26, v44, v176, v112
    v_fma_f32 v27, v45, v176, v113
    v_fma_f32 v24, v44, -v177, v24
    v_fma_f32 v25, v45, -v177, v25
    v_fma_f32 v26, v28, v177, v26
    v_fma_f32 v27, v29, v177, v27
    v_fma_f32 v28, v24, v176, v82
    v_fma_f32 v29, v25, v176, v83
    v_fma_f32 v44, v26, v176, v114
    v_fma_f32 v45, v27, v176, v115
    v_fma_f32 v28, v26, -v177, v28
    v_fma_f32 v29, v27, -v177, v29
    v_fma_f32 v44, v24, v177, v44
    v_fma_f32 v45, v25, v177, v45
    v_fma_f32 v24, v28, v176, v84
    v_fma_f32 v25, v29, v176, v85
    v_fma_f32 v26, v44, v176, v116
    v_fma_f32 v27, v45, v176, v117
    v_fma_f32 v24, v44, -v177, v24
    v_fma_f32 v25, v45, -v177, v25
    v_fma_f32 v26, v28, v177, v26
    v_fma_f32 v27, v29, v177, v27
    v_fma_f32 v28, v24, v176, v86
    v_fma_f32 v29, v25, v176, v87
    v_fma_f32 v44, v26, v176, v118
    v_fma_f32 v45, v27, v176, v119
    v_fma_f32 v28, v26, -v177, v28
    v_fma_f32 v29, v27, -v177, v29
    v_fma_f32 v44, v24, v177, v44
    v_fma_f32 v45, v25, v177, v45
    v_fma_f32 v24, v28, v176, v88
    v_fma_f32 v25, v29, v176, v89
    v_fma_f32 v26, v44, v176, v120
    v_fma_f32 v27, v45, v176, v121
    v_fma_f32 v24, v44, -v177, v24
    v_fma_f32 v25, v45, -v177, v25
    v_fma_f32 v26, v28, v177, v26
    v_fma_f32 v27, v29, v177, v27
    v_fma_f32 v28, v24, v176, v90
    v_fma_f32 v29, v25, v176, v91
    v_fma_f32 v44, v26, v176, v122
    v_fma_f32 v45, v27, v176, v123
    v_fma_f32 v28, v26, -v177, v28
    v_fma_f32 v29, v27, -v177, v29
    v_fma_f32 v44, v24, v177, v44
    v_fma_f32 v45, v25, v177, v45
    v_fma_f32 v24, v28, v176, v92
    v_fma_f32 v25, v29, v176, v93
    v_fma_f32 v26, v44, v176, v124
    v_fma_f32 v27, v45, v176, v125
    v_fma_f32 v24, v44, -v177, v24
    v_fma_f32 v25, v45, -v177, v25
    v_fma_f32 v26, v28, v177, v26
    v_fma_f32 v27, v29, v177, v27
    v_fma_f32 v28, v24, v176, v94
    v_fma_f32 v29, v25, v176, v95
    v_fma_f32 v44, v26, v176, v126
    v_fma_f32 v45, v27, v176, v127
    v_fma_f32 v28, v26, -v177, v28
    v_fma_f32 v29, v27, -v177, v29
    v_fma_f32 v44, v24, v177, v44
    v_fma_f32 v45, v25, v177, v45
    v_mov_b32 v32, v28
    v_mov_b32 v33, v44
    v_mov_b32 v34, v29
    v_mov_b32 v35, v45
    v_fma_f32 v36, v180, v32, v34
    v_fma_f32 v37, v180, v33, v35
    v_fma_f32 v36, -v181, v33, v36
    v_fma_f32 v37, v181, v32, v37
    v_mov_b32 v38, v36
    v_mov_b32 v39, v37
    v_mov_b32 v40, 0
    v_mov_b32 v41, 0
    s_nop 0
    v_permlane32_swap_b32 v40, v38
    v_permlane32_swap_b32 v41, v39
    v_fma_f32 v42, v182, v40, v36
    v_fma_f32 v43, v182, v41, v37
    v_fma_f32 v42, -v183, v41, v42
    v_fma_f32 v43, v183, v40, v43
    v_or_b32 v42, 1, v42
    s_mov_b32 s12, 0
    s_mov_b32 s13, -1
    s_mov_b64 exec, s[12:13]
    buffer_store_dwordx2 v[42:43], v7, s[56:59], 0 offen sc1
    s_mov_b64 exec, -1
    s_lshl_b32 s9, s3, 13
    s_add_u32 m0, s9, 0
    s_mov_b32 s8, 0
    buffer_load_dwordx4 v52, s[76:79], s8 offen lds
    s_add_u32 m0, s9, 1024
    s_mov_b32 s8, 16384
    buffer_load_dwordx4 v52, s[76:79], s8 offen lds
    s_add_u32 m0, s9, 2048
    s_mov_b32 s8, 32768
    buffer_load_dwordx4 v52, s[76:79], s8 offen lds
    s_add_u32 m0, s9, 3072
    s_mov_b32 s8, 49152
    buffer_load_dwordx4 v52, s[76:79], s8 offen lds
    global_load_ushort v9, v54, s[32:33] offset:0
    global_load_ushort v10, v54, s[32:33] offset:64
    v_mov_b32 v24, -1
    v_mov_b32 v25, -1
    v_mov_b32 v26, -1
    v_mov_b32 v27, -1
    buffer_store_dwordx4 v[24:27], v59, s[92:95], s74 offen offset:0 sc1
    buffer_store_dwordx4 v[24:27], v59, s[92:95], s74 offen offset:1024 sc1
    buffer_store_dwordx4 v[24:27], v59, s[92:95], s74 offen offset:2048 sc1
    buffer_store_dwordx4 v[24:27], v59, s[92:95], s74 offen offset:3072 sc1
    v_mul_f32 v224, v64, v178
    v_mul_f32 v225, v65, v178
    v_fma_f32 v224, v96, -v179, v224
    v_fma_f32 v225, v97, -v179, v225
    v_mul_f32 v96, v96, v178
    v_mul_f32 v97, v97, v178
    v_fma_f32 v96, v64, v179, v96
    v_fma_f32 v97, v65, v179, v97
    v_mul_f32 v226, v66, v178
    v_mul_f32 v227, v67, v178
    v_fma_f32 v226, v98, -v179, v226
    v_fma_f32 v227, v99, -v179, v227
    v_mul_f32 v98, v98, v178
    v_mul_f32 v99, v99, v178
    v_fma_f32 v98, v66, v179, v98
    v_fma_f32 v99, v67, v179, v99
    v_mul_f32 v228, v68, v178
    v_mul_f32 v229, v69, v178
    v_fma_f32 v228, v100, -v179, v228
    v_fma_f32 v229, v101, -v179, v229
    v_mul_f32 v100, v100, v178
    v_mul_f32 v101, v101, v178
    v_fma_f32 v100, v68, v179, v100
    v_fma_f32 v101, v69, v179, v101
    v_mul_f32 v230, v70, v178
    v_mul_f32 v231, v71, v178
    v_fma_f32 v230, v102, -v179, v230
    v_fma_f32 v231, v103, -v179, v231
    v_mul_f32 v102, v102, v178
    v_mul_f32 v103, v103, v178
    v_fma_f32 v102, v70, v179, v102
    v_fma_f32 v103, v71, v179, v103
    v_mul_f32 v232, v72, v178
    v_mul_f32 v233, v73, v178
    v_fma_f32 v232, v104, -v179, v232
    v_fma_f32 v233, v105, -v179, v233
    v_mul_f32 v104, v104, v178
    v_mul_f32 v105, v105, v178
    v_fma_f32 v104, v72, v179, v104
    v_fma_f32 v105, v73, v179, v105
    v_mul_f32 v234, v74, v178
    v_mul_f32 v235, v75, v178
    v_fma_f32 v234, v106, -v179, v234
    v_fma_f32 v235, v107, -v179, v235
    v_mul_f32 v106, v106, v178
    v_mul_f32 v107, v107, v178
    v_fma_f32 v106, v74, v179, v106
    v_fma_f32 v107, v75, v179, v107
    v_mul_f32 v236, v76, v178
    v_mul_f32 v237, v77, v178
    v_fma_f32 v236, v108, -v179, v236
    v_fma_f32 v237, v109, -v179, v237
    v_mul_f32 v108, v108, v178
    v_mul_f32 v109, v109, v178
    v_fma_f32 v108, v76, v179, v108
    v_fma_f32 v109, v77, v179, v109
    v_mul_f32 v238, v78, v178
    v_mul_f32 v239, v79, v178
    v_fma_f32 v238, v110, -v179, v238
    v_fma_f32 v239, v111, -v179, v239
    v_mul_f32 v110, v110, v178
    v_mul_f32 v111, v111, v178
    v_fma_f32 v110, v78, v179, v110
    v_fma_f32 v111, v79, v179, v111
    v_mul_f32 v240, v80, v178
    v_mul_f32 v241, v81, v178
    v_fma_f32 v240, v112, -v179, v240
    v_fma_f32 v241, v113, -v179, v241
    v_mul_f32 v112, v112, v178
    v_mul_f32 v113, v113, v178
    v_fma_f32 v112, v80, v179, v112
    v_fma_f32 v113, v81, v179, v113
    v_mul_f32 v242, v82, v178
    v_mul_f32 v243, v83, v178
    v_fma_f32 v242, v114, -v179, v242
    v_fma_f32 v243, v115, -v179, v243
    v_mul_f32 v114, v114, v178
    v_mul_f32 v115, v115, v178
    v_fma_f32 v114, v82, v179, v114
    v_fma_f32 v115, v83, v179, v115
    v_mul_f32 v244, v84, v178
    v_mul_f32 v245, v85, v178
    v_fma_f32 v244, v116, -v179, v244
    v_fma_f32 v245, v117, -v179, v245
    v_mul_f32 v116, v116, v178
    v_mul_f32 v117, v117, v178
    v_fma_f32 v116, v84, v179, v116
    v_fma_f32 v117, v85, v179, v117
    v_mul_f32 v246, v86, v178
    v_mul_f32 v247, v87, v178
    v_fma_f32 v246, v118, -v179, v246
    v_fma_f32 v247, v119, -v179, v247
    v_mul_f32 v118, v118, v178
    v_mul_f32 v119, v119, v178
    v_fma_f32 v118, v86, v179, v118
    v_fma_f32 v119, v87, v179, v119
    v_mul_f32 v248, v88, v178
    v_mul_f32 v249, v89, v178
    v_fma_f32 v248, v120, -v179, v248
    v_fma_f32 v249, v121, -v179, v249
    v_mul_f32 v120, v120, v178
    v_mul_f32 v121, v121, v178
    v_fma_f32 v120, v88, v179, v120
    v_fma_f32 v121, v89, v179, v121
    v_mul_f32 v250, v90, v178
    v_mul_f32 v251, v91, v178
    v_fma_f32 v250, v122, -v179, v250
    v_fma_f32 v251, v123, -v179, v251
    v_mul_f32 v122, v122, v178
    v_mul_f32 v123, v123, v178
    v_fma_f32 v122, v90, v179, v122
    v_fma_f32 v123, v91, v179, v123
    v_mul_f32 v252, v92, v178
    v_mul_f32 v253, v93, v178
    v_fma_f32 v252, v124, -v179, v252
    v_fma_f32 v253, v125, -v179, v253
    v_mul_f32 v124, v124, v178
    v_mul_f32 v125, v125, v178
    v_fma_f32 v124, v92, v179, v124
    v_fma_f32 v125, v93, v179, v125
    v_mul_f32 v254, v94, v178
    v_mul_f32 v255, v95, v178
    v_fma_f32 v254, v126, -v179, v254
    v_fma_f32 v255, v127, -v179, v255
    v_mul_f32 v126, v126, v178
    v_mul_f32 v127, v127, v178
    v_fma_f32 v126, v94, v179, v126
    v_fma_f32 v127, v95, v179, v127
    v_mul_f32 v44, v178, v40
    v_mul_f32 v45, v178, v41
    v_fma_f32 v44, -v179, v41, v44
    v_fma_f32 v45, v179, v40, v45
    v_mul_f32 v46, v178, v32
    v_mul_f32 v47, v178, v33
    v_fma_f32 v46, -v179, v33, v46
    v_fma_f32 v47, v179, v32, v47
    v_subrev_u32 v128, 0x2000, v50
    v_subrev_u32 v129, 0x6000, v50
    v_subrev_u32 v130, 0xa000, v50
    v_subrev_u32 v131, 0xe000, v50
    v_subrev_u32 v132, 0x12000, v50
    v_subrev_u32 v133, 0x16000, v50
    v_subrev_u32 v134, 0x1a000, v50
    v_subrev_u32 v135, 0x1e000, v50
    v_subrev_u32 v136, 0x22000, v50
    v_subrev_u32 v137, 0x26000, v50
    v_subrev_u32 v138, 0x2a000, v50
    v_subrev_u32 v139, 0x2e000, v50
    v_subrev_u32 v140, 0x32000, v50
    v_subrev_u32 v141, 0x36000, v50
    v_subrev_u32 v142, 0x3a000, v50
    v_subrev_u32 v143, 0x3e000, v50
    s_waitcnt vmcnt(11)
    s_mov_b32 s89, 65536
c_init_chk:
    v_and_b32 v52, 15, v20
    v_cmp_ne_u32 vcc, 15, v52
    s_nop 1
    s_cmp_eq_u64 vcc, 0
    s_cbranch_scc1 c_init_ok
    s_sub_u32 s89, s89, 1
    s_cbranch_scc1 c_init_ok
    s_sleep 4
    buffer_load_dword v20, v21, s[64:67], 0 offen sc1
    s_waitcnt vmcnt(0)
    s_branch c_init_chk
c_init_ok:
    s_getreg_b32 s11, hwreg(HW_REG_XCC_ID, 0, 4)
    s_lshl_b32 s11, 0x100, s11
    s_or_b32 s11, s11, 15
    v_and_b32 v52, 7, v1
    v_cmp_eq_u32 s[12:13], s54, v52
    v_cmp_ne_u32 vcc, s11, v20
    s_nop 1
    s_and_b64 vcc, vcc, s[12:13]
    s_cselect_b32 s14, 0, 1
    buffer_load_dwordx2 v[192:193], v128, s[56:59], 0 offen sc1
    buffer_load_dwordx2 v[194:195], v129, s[56:59], 0 offen sc1
    buffer_load_dwordx2 v[196:197], v130, s[56:59], 0 offen sc1
    buffer_load_dwordx2 v[198:199], v131, s[56:59], 0 offen sc1
    buffer_load_dwordx2 v[200:201], v132, s[56:59], 0 offen sc1
    buffer_load_dwordx2 v[202:203], v133, s[56:59], 0 offen sc1
    buffer_load_dwordx2 v[204:205], v134, s[56:59], 0 offen sc1
    buffer_load_dwordx2 v[206:207], v135, s[56:59], 0 offen sc1
    buffer_load_dwordx2 v[208:209], v136, s[56:59], 0 offen sc1
    buffer_load_dwordx2 v[210:211], v137, s[56:59], 0 offen sc1
    buffer_load_dwordx2 v[212:213], v138, s[56:59], 0 offen sc1
    buffer_load_dwordx2 v[214:215], v139, s[56:59], 0 offen sc1
    buffer_load_dwordx2 v[216:217], v140, s[56:59], 0 offen sc1
    buffer_load_dwordx2 v[218:219], v141, s[56:59], 0 offen sc1
    buffer_load_dwordx2 v[220:221], v142, s[56:59], 0 offen sc1
    buffer_load_dwordx2 v[222:223], v143, s[56:59], 0 offen sc1
    s_waitcnt vmcnt(20)
    ds_read_u16 v160, v53 offset:0
    ds_read_u16 v161, v53 offset:128
    ds_read_u16 v162, v53 offset:256
    ds_read_u16 v163, v53 offset:384
    ds_read_u16 v164, v53 offset:512
    ds_read_u16 v165, v53 offset:640
    ds_read_u16 v166, v53 offset:768
    ds_read_u16 v167, v53 offset:896
    ds_read_u16 v168, v53 offset:1024
    ds_read_u16 v169, v53 offset:1152
    ds_read_u16 v170, v53 offset:1280
    ds_read_u16 v171, v53 offset:1408
    ds_read_u16 v172, v53 offset:1536
    ds_read_u16 v173, v53 offset:1664
    ds_read_u16 v174, v53 offset:1792
    ds_read_u16 v175, v53 offset:1920
    ds_read_u16 v73, v53 offset:64
    ds_read_u16 v74, v53 offset:192
    ds_read_u16 v75, v53 offset:320
    ds_read_u16 v76, v53 offset:448
    ds_read_u16 v77, v53 offset:576
    ds_read_u16 v78, v53 offset:704
    ds_read_u16 v79, v53 offset:832
    ds_read_u16 v80, v53 offset:960
    ds_read_u16 v81, v53 offset:1088
    ds_read_u16 v82, v53 offset:1216
    ds_read_u16 v83, v53 offset:1344
    ds_read_u16 v84, v53 offset:1472
    ds_read_u16 v85, v53 offset:1600
    ds_read_u16 v86, v53 offset:1728
    ds_read_u16 v87, v53 offset:1856
    ds_read_u16 v88, v53 offset:1984
    s_waitcnt lgkmcnt(0)
    v_lshl_or_b32 v64, v74, 16, v73
    v_lshl_or_b32 v65, v76, 16, v75
    v_lshl_or_b32 v66, v78, 16, v77
    v_lshl_or_b32 v67, v80, 16, v79
    v_lshl_or_b32 v68, v82, 16, v81
    v_lshl_or_b32 v69, v84, 16, v83
    v_lshl_or_b32 v70, v86, 16, v85
    v_lshl_or_b32 v71, v88, 16, v87
    v_lshl_or_b32 v73, v161, 16, v160
    v_lshl_or_b32 v74, v163, 16, v162
    v_lshl_or_b32 v75, v165, 16, v164
    v_lshl_or_b32 v76, v167, 16, v166
    v_lshl_or_b32 v77, v169, 16, v168
    v_lshl_or_b32 v78, v171, 16, v170
    v_lshl_or_b32 v79, v173, 16, v172
    v_lshl_or_b32 v80, v175, 16, v174
    v_mov_b32 v81, v64
    v_mov_b32 v82, v65
    v_mov_b32 v83, v66
    v_mov_b32 v84, v67
    v_mov_b32 v85, v68
    v_mov_b32 v86, v69
    v_mov_b32 v87, v70
    v_mov_b32 v88, v71
    s_lshl_b32 s11, s3, 13
    v_lshl_add_u32 v16, v6, 11, s11
    v_lshl_add_u32 v16, v4, 6, v16
    v_bfe_u32 v17, v1, 1, 2
    v_xor_b32 v18, 0, v17
    v_lshl_add_u32 v64, v18, 4, v16
    v_xor_b32 v18, 1, v17
    v_lshl_add_u32 v65, v18, 4, v16
    v_xor_b32 v18, 2, v17
    v_lshl_add_u32 v66, v18, 4, v16
    v_xor_b32 v18, 3, v17
    v_lshl_add_u32 v67, v18, 4, v16
    v_mov_b32 v31, 1
    v_bfe_u32 v16, v1, 2, 2
    v_lshl_add_u32 v16, v6, 3, v16
    v_and_b32 v24, 1, v1
    v_bfe_u32 v18, v1, 4, 1
    v_lshl_add_u32 v24, v24, 1, v18
    v_bfe_u32 v18, v16, 1, 2
    v_xor_b32 v24, v24, v18
    v_lshlrev_b32 v24, 4, v24
    v_lshl_add_u32 v24, v16, 6, v24
    v_bfe_u32 v18, v1, 1, 1
    v_lshl_add_u32 v24, v18, 3, v24
    v_xor_b32 v25, 32, v24
    v_add_u32 v25, 256, v25
    v_add_u32 v68, s11, v24
    v_add_u32 v69, s11, v25
    s_lshl_b32 s11, s4, 7
    s_lshl_b32 s12, s6, 6
    s_add_u32 s11, s11, s12
    s_and_b32 s12, s5, 7
    s_lshl_b32 s12, s12, 2
    s_add_u32 s11, s11, s12
    s_add_u32 s11, s11, s7
    s_lshl_b32 s11, s11, 12
    s_lshr_b32 s13, s5, 3
    s_lshl_b32 s13, s13, 11
    s_add_u32 s11, s11, s13
    v_lshl_add_u32 v72, v1, 4, s11
    v_mov_b32 v20, 0x24a00
    s_lshl_b32 s6, s4, 2
    s_add_u32 s6, s6, s3
    s_lshr_b32 s7, s3, 1
    s_lshl_b32 s7, s7, 13
    s_and_b32 s8, s3, 1
    s_lshl_b32 s8, s8, 11
    s_add_u32 s7, s7, s8
    v_add_u32 v70, s7, v24
    v_add_u32 v71, s7, v25
    s_lshl_b32 s7, s6, 17
    s_add_u32 s7, s7, s13
    v_lshl_add_u32 v3, v1, 4, s7
    v_add_u32 v2, 0x1000, v3
    v_lshlrev_b32 v14, 7, v4
    v_add_u32 v14, 0x8000, v14
    v_xor_b32 v16, 0, v11
    v_lshl_add_u32 v32, v16, 4, v14
    v_xor_b32 v16, 2, v11
    v_lshl_add_u32 v33, v16, 4, v14
    v_xor_b32 v16, 4, v11
    v_lshl_add_u32 v34, v16, 4, v14
    v_xor_b32 v16, 6, v11
    v_lshl_add_u32 v35, v16, 4, v14
    s_lshr_b32 s7, s6, 1
    s_lshl_b32 s7, s7, 12
    s_add_u32 s7, s7, s13
    v_bfe_u32 v16, v1, 1, 3
    v_subrev_u32 v14, 1, v16
    v_cmp_le_u32 vcc, s15, v14
    s_nop 1
    v_cndmask_b32 v14, v14, v16, vcc
    v_mov_b32 v19, s15
    v_cmp_eq_u32 vcc, 0, v16
    s_nop 1
    v_cndmask_b32 v16, v14, v19, vcc
    v_and_b32 v14, 1, v1
    v_lshl_add_u32 v16, v16, 1, v14
    v_lshl_add_u32 v22, v16, 7, s7
    s_add_u32 s64, s52, 0x1000000
    s_addc_u32 s65, s53, 0
    s_mov_b32 s66, 0x2000
    s_mov_b32 s67, 0x20000
    s_mov_b32 s76, s48
    s_mov_b32 s77, s49
    s_mov_b32 s78, 0x800000
    s_mov_b32 s79, 0x20000
    s_mov_b32 s80, 0
    s_mov_b32 s81, 4096
    s_mov_b32 s82, 8192
    s_mov_b32 s83, 12288
    s_mov_b32 s84, 16384
    s_mov_b32 s85, 20480
    s_mov_b32 s86, 24576
    s_mov_b32 s87, 28672
    s_lshl_b32 s7, s6, 5
    v_lshl_add_u32 v7, v6, 4, s7
    s_lshl_b32 s8, s5, 6
    v_add_u32 v8, s8, v4
    v_lshlrev_b32 v26, 12, v7
    v_lshl_add_u32 v26, v8, 2, v26
    v_add_u32 v27, 0x8000, v26
    v_lshlrev_b32 v7, 2, v7
    v_mul_u32_u24 v21, 272, v4
    v_lshl_add_u32 v21, v6, 5, v21
    s_lshl_b32 s8, s3, 6
    v_add_u32 v21, s8, v21
    s_add_u32 s8, s73, 0x30000
    v_mov_b32 v29, s8
    v_lshlrev_b32 v28, 4, v1
    v_mov_b32 v23, 1
    s_mov_b32 s88, 65536
c_poll:
    s_waitcnt vmcnt(0)
    v_mov_b32 v52, 0
    v_and_b32 v144, 1, v192
    v_and_b32 v145, 1, v194
    v_and_b32 v146, 1, v196
    v_and_b32 v147, 1, v198
    v_and_b32 v148, 1, v200
    v_and_b32 v149, 1, v202
    v_and_b32 v150, 1, v204
    v_and_b32 v151, 1, v206
    v_and_b32 v152, 1, v208
    v_and_b32 v153, 1, v210
    v_and_b32 v154, 1, v212
    v_and_b32 v155, 1, v214
    v_and_b32 v156, 1, v216
    v_and_b32 v157, 1, v218
    v_and_b32 v158, 1, v220
    v_and_b32 v159, 1, v222
    v_add3_u32 v52, v52, v144, v145
    v_add3_u32 v52, v52, v146, v147
    v_add3_u32 v52, v52, v148, v149
    v_add3_u32 v52, v52, v150, v151
    v_add3_u32 v52, v52, v152, v153
    v_add3_u32 v52, v52, v154, v155
    v_add3_u32 v52, v52, v156, v157
    v_add3_u32 v52, v52, v158, v159
    v_cmp_ne_u32 vcc, v52, v51
    s_nop 1
    s_cmp_eq_u64 vcc, 0
    s_cbranch_scc1 c_polled
    s_sub_u32 s88, s88, 1
    s_cbranch_scc1 c_polled
    s_sleep 4
    v_cmp_eq_u32 vcc, 0, v144
    s_nop 1
    s_mov_b64 exec, vcc
    buffer_load_dwordx2 v[192:193], v128, s[56:59], 0 offen sc1
    s_mov_b64 exec, -1
    v_cmp_eq_u32 vcc, 0, v145
    s_nop 1
    s_mov_b64 exec, vcc
    buffer_load_dwordx2 v[194:195], v129, s[56:59], 0 offen sc1
    s_mov_b64 exec, -1
    v_cmp_eq_u32 vcc, 0, v146
    s_nop 1
    s_mov_b64 exec, vcc
    buffer_load_dwordx2 v[196:197], v130, s[56:59], 0 offen sc1
    s_mov_b64 exec, -1
    v_cmp_eq_u32 vcc, 0, v147
    s_nop 1
    s_mov_b64 exec, vcc
    buffer_load_dwordx2 v[198:199], v131, s[56:59], 0 offen sc1
    s_mov_b64 exec, -1
    v_cmp_eq_u32 vcc, 0, v148
    s_nop 1
    s_mov_b64 exec, vcc
    buffer_load_dwordx2 v[200:201], v132, s[56:59], 0 offen sc1
    s_mov_b64 exec, -1
    v_cmp_eq_u32 vcc, 0, v149
    s_nop 1
    s_mov_b64 exec, vcc
    buffer_load_dwordx2 v[202:203], v133, s[56:59], 0 offen sc1
    s_mov_b64 exec, -1
    v_cmp_eq_u32 vcc, 0, v150
    s_nop 1
    s_mov_b64 exec, vcc
    buffer_load_dwordx2 v[204:205], v134, s[56:59], 0 offen sc1
    s_mov_b64 exec, -1
    v_cmp_eq_u32 vcc, 0, v151
    s_nop 1
    s_mov_b64 exec, vcc
    buffer_load_dwordx2 v[206:207], v135, s[56:59], 0 offen sc1
    s_mov_b64 exec, -1
    v_cmp_eq_u32 vcc, 0, v152
    s_nop 1
    s_mov_b64 exec, vcc
    buffer_load_dwordx2 v[208:209], v136, s[56:59], 0 offen sc1
    s_mov_b64 exec, -1
    v_cmp_eq_u32 vcc, 0, v153
    s_nop 1
    s_mov_b64 exec, vcc
    buffer_load_dwordx2 v[210:211], v137, s[56:59], 0 offen sc1
    s_mov_b64 exec, -1
    v_cmp_eq_u32 vcc, 0, v154
    s_nop 1
    s_mov_b64 exec, vcc
    buffer_load_dwordx2 v[212:213], v138, s[56:59], 0 offen sc1
    s_mov_b64 exec, -1
    v_cmp_eq_u32 vcc, 0, v155
    s_nop 1
    s_mov_b64 exec, vcc
    buffer_load_dwordx2 v[214:215], v139, s[56:59], 0 offen sc1
    s_mov_b64 exec, -1
    v_cmp_eq_u32 vcc, 0, v156
    s_nop 1
    s_mov_b64 exec, vcc
    buffer_load_dwordx2 v[216:217], v140, s[56:59], 0 offen sc1
    s_mov_b64 exec, -1
    v_cmp_eq_u32 vcc, 0, v157
    s_nop 1
    s_mov_b64 exec, vcc
    buffer_load_dwordx2 v[218:219], v141, s[56:59], 0 offen sc1
    s_mov_b64 exec, -1
    v_cmp_eq_u32 vcc, 0, v158
    s_nop 1
    s_mov_b64 exec, vcc
    buffer_load_dwordx2 v[220:221], v142, s[56:59], 0 offen sc1
    s_mov_b64 exec, -1
    v_cmp_eq_u32 vcc, 0, v159
    s_nop 1
    s_mov_b64 exec, vcc
    buffer_load_dwordx2 v[222:223], v143, s[56:59], 0 offen sc1
    s_mov_b64 exec, -1
    s_branch c_poll
c_polled:
    v_fma_f32 v52, v222, v186, v220
    v_fma_f32 v53, v223, v186, v221
    v_fma_f32 v52, -v223, v187, v52
    v_fma_f32 v53, v222, v187, v53
    v_fma_f32 v54, v52, v186, v218
    v_fma_f32 v55, v53, v186, v219
    v_fma_f32 v54, -v53, v187, v54
    v_fma_f32 v55, v52, v187, v55
    v_fma_f32 v52, v54, v186, v216
    v_fma_f32 v53, v55, v186, v217
    v_fma_f32 v52, -v55, v187, v52
    v_fma_f32 v53, v54, v187, v53
    v_fma_f32 v54, v52, v186, v214
    v_fma_f32 v55, v53, v186, v215
    v_fma_f32 v54, -v53, v187, v54
    v_fma_f32 v55, v52, v187, v55
    v_fma_f32 v52, v54, v186, v212
    v_fma_f32 v53, v55, v186, v213
    v_fma_f32 v52, -v55, v187, v52
    v_fma_f32 v53, v54, v187, v53
    v_fma_f32 v54, v52, v186, v210
    v_fma_f32 v55, v53, v186, v211
    v_fma_f32 v54, -v53, v187, v54
    v_fma_f32 v55, v52, v187, v55
    v_fma_f32 v52, v54, v186, v208
    v_fma_f32 v53, v55, v186, v209
    v_fma_f32 v52, -v55, v187, v52
    v_fma_f32 v53, v54, v187, v53
    v_fma_f32 v54, v52, v186, v206
    v_fma_f32 v55, v53, v186, v207
    v_fma_f32 v54, -v53, v187, v54
    v_fma_f32 v55, v52, v187, v55
    v_fma_f32 v52, v54, v186, v204
    v_fma_f32 v53, v55, v186, v205
    v_fma_f32 v52, -v55, v187, v52
    v_fma_f32 v53, v54, v187, v53
    v_fma_f32 v54, v52, v186, v202
    v_fma_f32 v55, v53, v186, v203
    v_fma_f32 v54, -v53, v187, v54
    v_fma_f32 v55, v52, v187, v55
    v_fma_f32 v52, v54, v186, v200
    v_fma_f32 v53, v55, v186, v201
    v_fma_f32 v52, -v55, v187, v52
    v_fma_f32 v53, v54, v187, v53
    v_fma_f32 v54, v52, v186, v198
    v_fma_f32 v55, v53, v186, v199
    v_fma_f32 v54, -v53, v187, v54
    v_fma_f32 v55, v52, v187, v55
    v_fma_f32 v52, v54, v186, v196
    v_fma_f32 v53, v55, v186, v197
    v_fma_f32 v52, -v55, v187, v52
    v_fma_f32 v53, v54, v187, v53
    v_fma_f32 v54, v52, v186, v194
    v_fma_f32 v55, v53, v186, v195
    v_fma_f32 v54, -v53, v187, v54
    v_fma_f32 v55, v52, v187, v55
    v_fma_f32 v52, v54, v186, v192
    v_fma_f32 v53, v55, v186, v193
    v_fma_f32 v52, -v55, v187, v52
    v_fma_f32 v53, v54, v187, v53
    v_mov_b32 v54, v52
    v_mov_b32 v55, v53
    v_mov_b32 v56, v52
    v_mov_b32 v57, v53
    s_nop 0
    v_permlane32_swap_b32 v54, v56
    v_permlane32_swap_b32 v55, v57
    v_fma_f32 v58, v184, v56, v54
    v_fma_f32 v59, v184, v57, v55
    v_fma_f32 v58, -v185, v57, v58
    v_fma_f32 v59, v185, v56, v59
    v_fma_f32 v52, v48, v58, v44
    v_fma_f32 v53, v48, v59, v45
    v_fma_f32 v52, -v49, v59, v52
    v_fma_f32 v53, v49, v58, v53
    v_fma_f32 v54, v180, v52, v46
    v_fma_f32 v55, v180, v53, v47
    v_fma_f32 v54, -v181, v53, v54
    v_fma_f32 v55, v181, v52, v55
    v_mov_b32 v56, v52
    v_mov_b32 v57, v54
    v_mov_b32 v58, v53
    v_mov_b32 v59, v55
    v_fma_f32 v224, v56, v176, v224
    v_fma_f32 v225, v57, v176, v225
    v_fma_f32 v96, v58, v176, v96
    v_fma_f32 v97, v59, v176, v97
    v_fma_f32 v224, v58, -v177, v224
    v_fma_f32 v225, v59, -v177, v225
    v_fma_f32 v96, v56, v177, v96
    v_fma_f32 v97, v57, v177, v97
    v_fma_f32 v226, v224, v176, v226
    v_fma_f32 v227, v225, v176, v227
    v_fma_f32 v98, v96, v176, v98
    v_fma_f32 v99, v97, v176, v99
    v_fma_f32 v226, v96, -v177, v226
    v_fma_f32 v227, v97, -v177, v227
    v_fma_f32 v98, v224, v177, v98
    v_fma_f32 v99, v225, v177, v99
    v_fma_f32 v228, v226, v176, v228
    v_fma_f32 v229, v227, v176, v229
    v_fma_f32 v100, v98, v176, v100
    v_fma_f32 v101, v99, v176, v101
    v_fma_f32 v228, v98, -v177, v228
    v_fma_f32 v229, v99, -v177, v229
    v_fma_f32 v100, v226, v177, v100
    v_fma_f32 v101, v227, v177, v101
    v_fma_f32 v230, v228, v176, v230
    v_fma_f32 v231, v229, v176, v231
    v_fma_f32 v102, v100, v176, v102
    v_fma_f32 v103, v101, v176, v103
    v_fma_f32 v230, v100, -v177, v230
    v_fma_f32 v231, v101, -v177, v231
    v_fma_f32 v102, v228, v177, v102
    v_fma_f32 v103, v229, v177, v103
    v_fma_f32 v232, v230, v176, v232
    v_fma_f32 v233, v231, v176, v233
    v_fma_f32 v104, v102, v176, v104
    v_fma_f32 v105, v103, v176, v105
    v_fma_f32 v232, v102, -v177, v232
    v_fma_f32 v233, v103, -v177, v233
    v_fma_f32 v104, v230, v177, v104
    v_fma_f32 v105, v231, v177, v105
    v_fma_f32 v234, v232, v176, v234
    v_fma_f32 v235, v233, v176, v235
    v_fma_f32 v106, v104, v176, v106
    v_fma_f32 v107, v105, v176, v107
    v_fma_f32 v234, v104, -v177, v234
    v_fma_f32 v235, v105, -v177, v235
    v_fma_f32 v106, v232, v177, v106
    v_fma_f32 v107, v233, v177, v107
    v_fma_f32 v236, v234, v176, v236
    v_fma_f32 v237, v235, v176, v237
    v_fma_f32 v108, v106, v176, v108
    v_fma_f32 v109, v107, v176, v109
    v_fma_f32 v236, v106, -v177, v236
    v_fma_f32 v237, v107, -v177, v237
    v_fma_f32 v108, v234, v177, v108
    v_fma_f32 v109, v235, v177, v109
    v_fma_f32 v238, v236, v176, v238
    v_fma_f32 v239, v237, v176, v239
    v_fma_f32 v110, v108, v176, v110
    v_fma_f32 v111, v109, v176, v111
    v_fma_f32 v238, v108, -v177, v238
    v_fma_f32 v239, v109, -v177, v239
    v_fma_f32 v110, v236, v177, v110
    v_fma_f32 v111, v237, v177, v111
    v_cvt_pk_bf16_f32 v128, v224, v226
    v_cvt_pk_bf16_f32 v129, v228, v230
    v_cvt_pk_bf16_f32 v130, v232, v234
    v_cvt_pk_bf16_f32 v131, v236, v238
    ds_write_b128 v64, v[128:131] offset:0
    v_cvt_pk_bf16_f32 v136, v225, v227
    v_cvt_pk_bf16_f32 v137, v229, v231
    v_cvt_pk_bf16_f32 v138, v233, v235
    v_cvt_pk_bf16_f32 v139, v237, v239
    ds_write_b128 v66, v[136:139] offset:0
    v_cvt_pk_bf16_f32 v144, -v96, -v98
    v_cvt_pk_bf16_f32 v145, -v100, -v102
    v_cvt_pk_bf16_f32 v146, -v104, -v106
    v_cvt_pk_bf16_f32 v147, -v108, -v110
    ds_write_b128 v64, v[144:147] offset:4096
    v_cvt_pk_bf16_f32 v152, -v97, -v99
    v_cvt_pk_bf16_f32 v153, -v101, -v103
    v_cvt_pk_bf16_f32 v154, -v105, -v107
    v_cvt_pk_bf16_f32 v155, -v109, -v111
    ds_write_b128 v66, v[152:155] offset:4096
    v_fma_f32 v240, v238, v176, v240
    v_fma_f32 v241, v239, v176, v241
    v_fma_f32 v112, v110, v176, v112
    v_fma_f32 v113, v111, v176, v113
    v_fma_f32 v240, v110, -v177, v240
    v_fma_f32 v241, v111, -v177, v241
    v_fma_f32 v112, v238, v177, v112
    v_fma_f32 v113, v239, v177, v113
    v_fma_f32 v242, v240, v176, v242
    v_fma_f32 v243, v241, v176, v243
    v_fma_f32 v114, v112, v176, v114
    v_fma_f32 v115, v113, v176, v115
    v_fma_f32 v242, v112, -v177, v242
    v_fma_f32 v243, v113, -v177, v243
    v_fma_f32 v114, v240, v177, v114
    v_fma_f32 v115, v241, v177, v115
    v_fma_f32 v244, v242, v176, v244
    v_fma_f32 v245, v243, v176, v245
    v_fma_f32 v116, v114, v176, v116
    v_fma_f32 v117, v115, v176, v117
    v_fma_f32 v244, v114, -v177, v244
    v_fma_f32 v245, v115, -v177, v245
    v_fma_f32 v116, v242, v177, v116
    v_fma_f32 v117, v243, v177, v117
    v_fma_f32 v246, v244, v176, v246
    v_fma_f32 v247, v245, v176, v247
    v_fma_f32 v118, v116, v176, v118
    v_fma_f32 v119, v117, v176, v119
    v_fma_f32 v246, v116, -v177, v246
    v_fma_f32 v247, v117, -v177, v247
    v_fma_f32 v118, v244, v177, v118
    v_fma_f32 v119, v245, v177, v119
    v_fma_f32 v248, v246, v176, v248
    v_fma_f32 v249, v247, v176, v249
    v_fma_f32 v120, v118, v176, v120
    v_fma_f32 v121, v119, v176, v121
    v_fma_f32 v248, v118, -v177, v248
    v_fma_f32 v249, v119, -v177, v249
    v_fma_f32 v120, v246, v177, v120
    v_fma_f32 v121, v247, v177, v121
    v_fma_f32 v250, v248, v176, v250
    v_fma_f32 v251, v249, v176, v251
    v_fma_f32 v122, v120, v176, v122
    v_fma_f32 v123, v121, v176, v123
    v_fma_f32 v250, v120, -v177, v250
    v_fma_f32 v251, v121, -v177, v251
    v_fma_f32 v122, v248, v177, v122
    v_fma_f32 v123, v249, v177, v123
    v_fma_f32 v252, v250, v176, v252
    v_fma_f32 v253, v251, v176, v253
    v_fma_f32 v124, v122, v176, v124
    v_fma_f32 v125, v123, v176, v125
    v_fma_f32 v252, v122, -v177, v252
    v_fma_f32 v253, v123, -v177, v253
    v_fma_f32 v124, v250, v177, v124
    v_fma_f32 v125, v251, v177, v125
    v_fma_f32 v254, v252, v176, v254
    v_fma_f32 v255, v253, v176, v255
    v_fma_f32 v126, v124, v176, v126
    v_fma_f32 v127, v125, v176, v127
    v_fma_f32 v254, v124, -v177, v254
    v_fma_f32 v255, v125, -v177, v255
    v_fma_f32 v126, v252, v177, v126
    v_fma_f32 v127, v253, v177, v127
    v_cvt_pk_bf16_f32 v132, v240, v242
    v_cvt_pk_bf16_f32 v133, v244, v246
    v_cvt_pk_bf16_f32 v134, v248, v250
    v_cvt_pk_bf16_f32 v135, v252, v254
    ds_write_b128 v65, v[132:135] offset:0
    v_cvt_pk_bf16_f32 v140, v241, v243
    v_cvt_pk_bf16_f32 v141, v245, v247
    v_cvt_pk_bf16_f32 v142, v249, v251
    v_cvt_pk_bf16_f32 v143, v253, v255
    ds_write_b128 v67, v[140:143] offset:0
    v_cvt_pk_bf16_f32 v148, -v112, -v114
    v_cvt_pk_bf16_f32 v149, -v116, -v118
    v_cvt_pk_bf16_f32 v150, -v120, -v122
    v_cvt_pk_bf16_f32 v151, -v124, -v126
    ds_write_b128 v65, v[148:151] offset:4096
    v_cvt_pk_bf16_f32 v156, -v113, -v115
    v_cvt_pk_bf16_f32 v157, -v117, -v119
    v_cvt_pk_bf16_f32 v158, -v121, -v123
    v_cvt_pk_bf16_f32 v159, -v125, -v127
    ds_write_b128 v67, v[156:159] offset:4096
    s_waitcnt lgkmcnt(0)
    s_mov_b64 exec, 1
    ds_add_u32 v20, v31 offset:12
    s_mov_b64 exec, -1
    ds_read_b64_tr_b16 v[160:161], v68 offset:0
    ds_read_b64_tr_b16 v[162:163], v69 offset:0
    ds_read_b64_tr_b16 v[164:165], v68 offset:1024
    ds_read_b64_tr_b16 v[166:167], v69 offset:1024
    ds_read_b64_tr_b16 v[168:169], v68 offset:4096
    ds_read_b64_tr_b16 v[170:171], v69 offset:4096
    ds_read_b64_tr_b16 v[172:173], v68 offset:5120
    ds_read_b64_tr_b16 v[174:175], v69 offset:5120
    ds_read_b64_tr_b16 v[176:177], v68 offset:2048
    ds_read_b64_tr_b16 v[178:179], v69 offset:2048
    ds_read_b64_tr_b16 v[180:181], v68 offset:3072
    ds_read_b64_tr_b16 v[182:183], v69 offset:3072
    ds_read_b64_tr_b16 v[184:185], v68 offset:6144
    ds_read_b64_tr_b16 v[186:187], v69 offset:6144
    ds_read_b64_tr_b16 v[188:189], v68 offset:7168
    ds_read_b64_tr_b16 v[190:191], v69 offset:7168
    s_mov_b32 s12, 0x0
    s_waitcnt lgkmcnt(14)
    buffer_store_dwordx4 v[160:163], v72, s[60:63], s12 offen offset:0 sc1
    s_waitcnt lgkmcnt(12)
    buffer_store_dwordx4 v[164:167], v72, s[60:63], s12 offen offset:1024 sc1
    s_mov_b32 s12, 0x2000
    s_waitcnt lgkmcnt(10)
    buffer_store_dwordx4 v[168:171], v72, s[60:63], s12 offen offset:0 sc1
    s_waitcnt lgkmcnt(8)
    buffer_store_dwordx4 v[172:175], v72, s[60:63], s12 offen offset:1024 sc1
    s_mov_b32 s12, 0x20000
    s_waitcnt lgkmcnt(6)
    buffer_store_dwordx4 v[176:179], v72, s[60:63], s12 offen offset:0 sc1
    s_waitcnt lgkmcnt(4)
    buffer_store_dwordx4 v[180:183], v72, s[60:63], s12 offen offset:1024 sc1
    s_mov_b32 s12, 0x22000
    s_waitcnt lgkmcnt(2)
    buffer_store_dwordx4 v[184:187], v72, s[60:63], s12 offen offset:0 sc1
    s_waitcnt lgkmcnt(0)
    buffer_store_dwordx4 v[188:191], v72, s[60:63], s12 offen offset:1024 sc1
    s_mov_b32 s89, 262144
c_lw:
    ds_read_b128 v[52:55], v20 offset:4
    s_waitcnt lgkmcnt(0)
    v_min_u32 v54, v54, v55
    v_min_u32 v53, 1, v53
    v_readfirstlane_b32 s8, v54
    v_readfirstlane_b32 s9, v53
    s_nop 1
    s_add_u32 s8, s8, s9
    s_cmp_ge_u32 s8, 5
    s_cbranch_scc1 c_lwok
    s_sub_u32 s89, s89, 1
    s_cbranch_scc0 c_lw
c_lwok:
    ds_read_b64_tr_b16 v[160:161], v70 offset:0
    ds_read_b64_tr_b16 v[162:163], v71 offset:0
    ds_read_b64_tr_b16 v[164:165], v70 offset:1024
    ds_read_b64_tr_b16 v[166:167], v71 offset:1024
    ds_read_b64_tr_b16 v[168:169], v70 offset:16384
    ds_read_b64_tr_b16 v[170:171], v71 offset:16384
    ds_read_b64_tr_b16 v[172:173], v70 offset:17408
    ds_read_b64_tr_b16 v[174:175], v71 offset:17408
    ds_read_b64_tr_b16 v[176:177], v70 offset:4096
    ds_read_b64_tr_b16 v[178:179], v71 offset:4096
    ds_read_b64_tr_b16 v[180:181], v70 offset:5120
    ds_read_b64_tr_b16 v[182:183], v71 offset:5120
    ds_read_b64_tr_b16 v[184:185], v70 offset:20480
    ds_read_b64_tr_b16 v[186:187], v71 offset:20480
    ds_read_b64_tr_b16 v[188:189], v70 offset:21504
    ds_read_b64_tr_b16 v[190:191], v71 offset:21504
    s_mov_b32 s13, 0
    buffer_load_dwordx4 v[36:39], v7, s[64:67], 0 offen offset:0 sc1
    buffer_load_dwordx4 v[40:43], v7, s[64:67], 0 offen offset:16 sc1
    buffer_load_dwordx4 v[44:47], v7, s[64:67], 0 offen offset:32 sc1
    buffer_load_dwordx4 v[48:51], v7, s[64:67], 0 offen offset:48 sc1
    ds_read_b128 v[224:227], v32 offset:0
    ds_read_b128 v[228:231], v32 offset:4096
    ds_read_b128 v[232:235], v32 offset:8192
    ds_read_b128 v[236:239], v32 offset:12288
    s_waitcnt lgkmcnt(15)
    s_waitcnt lgkmcnt(3)
    v_mfma_f32_32x32x16_bf16 v[96:111], v[160:163], v[224:227], 0
    ds_read_b128 v[240:243], v33 offset:0
    s_waitcnt lgkmcnt(3)
    v_mfma_f32_32x32x16_bf16 v[112:127], v[160:163], v[228:231], 0
    ds_read_b128 v[244:247], v33 offset:4096
    s_waitcnt lgkmcnt(3)
    v_mfma_f32_32x32x16_bf16 v[128:143], v[160:163], v[232:235], 0
    ds_read_b128 v[248:251], v33 offset:8192
    s_waitcnt lgkmcnt(3)
    v_mfma_f32_32x32x16_bf16 v[144:159], v[160:163], v[236:239], 0
    ds_read_b128 v[252:255], v33 offset:12288
    s_waitcnt lgkmcnt(3)
    v_mfma_f32_32x32x16_bf16 v[96:111], v[164:167], v[240:243], v[96:111]
    ds_read_b128 v[224:227], v34 offset:0
    s_waitcnt lgkmcnt(3)
    v_mfma_f32_32x32x16_bf16 v[112:127], v[164:167], v[244:247], v[112:127]
    ds_read_b128 v[228:231], v34 offset:4096
    s_waitcnt lgkmcnt(3)
    v_mfma_f32_32x32x16_bf16 v[128:143], v[164:167], v[248:251], v[128:143]
    ds_read_b128 v[232:235], v34 offset:8192
    s_waitcnt lgkmcnt(3)
    v_mfma_f32_32x32x16_bf16 v[144:159], v[164:167], v[252:255], v[144:159]
    ds_read_b128 v[236:239], v34 offset:12288
    s_waitcnt lgkmcnt(3)
    v_mfma_f32_32x32x16_bf16 v[96:111], v[168:171], v[224:227], v[96:111]
    ds_read_b128 v[240:243], v35 offset:0
    s_waitcnt lgkmcnt(3)
    v_mfma_f32_32x32x16_bf16 v[112:127], v[168:171], v[228:231], v[112:127]
    ds_read_b128 v[244:247], v35 offset:4096
    s_waitcnt lgkmcnt(3)
    v_mfma_f32_32x32x16_bf16 v[128:143], v[168:171], v[232:235], v[128:143]
    ds_read_b128 v[248:251], v35 offset:8192
    s_waitcnt lgkmcnt(3)
    v_mfma_f32_32x32x16_bf16 v[144:159], v[168:171], v[236:239], v[144:159]
    ds_read_b128 v[252:255], v35 offset:12288
    s_waitcnt lgkmcnt(3)
    v_mfma_f32_32x32x16_bf16 v[96:111], v[172:175], v[240:243], v[96:111]
    ds_read_b128 v[224:227], v32 offset:16384
    s_waitcnt lgkmcnt(3)
    v_mfma_f32_32x32x16_bf16 v[112:127], v[172:175], v[244:247], v[112:127]
    ds_read_b128 v[228:231], v32 offset:20480
    s_waitcnt lgkmcnt(3)
    v_mfma_f32_32x32x16_bf16 v[128:143], v[172:175], v[248:251], v[128:143]
    ds_read_b128 v[232:235], v32 offset:24576
    s_waitcnt lgkmcnt(3)
    v_mfma_f32_32x32x16_bf16 v[144:159], v[172:175], v[252:255], v[144:159]
    ds_read_b128 v[236:239], v32 offset:28672
    s_waitcnt vmcnt(4)
    s_cmp_eq_u32 s14, 1
    s_cbranch_scc1 c_hfs_l
    buffer_store_dword v23, v60, s[68:71], 0 offen sc1
    s_branch c_hfs_e
c_hfs_l:
    buffer_store_dword v23, v60, s[68:71], 0 offen
c_hfs_e:
    buffer_store_dword v23, v30, s[68:71], 0 offen sc1
    buffer_load_dword v19, v22, s[68:71], 0 offen sc1
    s_waitcnt lgkmcnt(3)
    v_mfma_f32_32x32x16_bf16 v[96:111], v[176:179], v[224:227], v[96:111]
    ds_read_b128 v[240:243], v33 offset:16384
    s_waitcnt lgkmcnt(3)
    v_mfma_f32_32x32x16_bf16 v[112:127], v[176:179], v[228:231], v[112:127]
    ds_read_b128 v[244:247], v33 offset:20480
    s_waitcnt lgkmcnt(3)
    v_mfma_f32_32x32x16_bf16 v[128:143], v[176:179], v[232:235], v[128:143]
    ds_read_b128 v[248:251], v33 offset:24576
    s_waitcnt lgkmcnt(3)
    v_mfma_f32_32x32x16_bf16 v[144:159], v[176:179], v[236:239], v[144:159]
    ds_read_b128 v[252:255], v33 offset:28672
    s_waitcnt lgkmcnt(3)
    v_mfma_f32_32x32x16_bf16 v[96:111], v[180:183], v[240:243], v[96:111]
    ds_read_b128 v[224:227], v34 offset:16384
    s_waitcnt lgkmcnt(3)
    v_mfma_f32_32x32x16_bf16 v[112:127], v[180:183], v[244:247], v[112:127]
    ds_read_b128 v[228:231], v34 offset:20480
    s_waitcnt lgkmcnt(3)
    v_mfma_f32_32x32x16_bf16 v[128:143], v[180:183], v[248:251], v[128:143]
    ds_read_b128 v[232:235], v34 offset:24576
    s_waitcnt lgkmcnt(3)
    v_mfma_f32_32x32x16_bf16 v[144:159], v[180:183], v[252:255], v[144:159]
    ds_read_b128 v[236:239], v34 offset:28672
    s_waitcnt lgkmcnt(3)
    v_mfma_f32_32x32x16_bf16 v[96:111], v[184:187], v[224:227], v[96:111]
    ds_read_b128 v[240:243], v35 offset:16384
    s_waitcnt lgkmcnt(3)
    v_mfma_f32_32x32x16_bf16 v[112:127], v[184:187], v[228:231], v[112:127]
    ds_read_b128 v[244:247], v35 offset:20480
    s_waitcnt lgkmcnt(3)
    v_mfma_f32_32x32x16_bf16 v[128:143], v[184:187], v[232:235], v[128:143]
    ds_read_b128 v[248:251], v35 offset:24576
    s_waitcnt lgkmcnt(3)
    v_mfma_f32_32x32x16_bf16 v[144:159], v[184:187], v[236:239], v[144:159]
    ds_read_b128 v[252:255], v35 offset:28672
    s_waitcnt vmcnt(0)
    v_cmp_eq_u32 s[90:91], 1, v19
    s_nop 1
    s_and_b32 s88, s90, 0xc
    s_cmp_eq_u32 s88, 0xc
    s_cbranch_scc0 c_n0_s
c_n0:
    s_cmp_le_u32 s15, 0
    s_cselect_b32 s11, 1, 0
    s_lshl_b32 s11, s11, 14
    buffer_load_dwordx4 v[192:195], v3, s[60:63], s11 offen offset:0 sc1
    buffer_load_dwordx4 v[196:199], v3, s[60:63], s11 offen offset:1024 sc1
    buffer_load_dwordx4 v[200:203], v2, s[60:63], s11 offen offset:0 sc1
    buffer_load_dwordx4 v[204:207], v2, s[60:63], s11 offen offset:1024 sc1
    s_cmp_le_u32 s15, 0
    s_cselect_b32 s11, 1, 0
    s_lshl_b32 s11, s11, 14
    s_add_u32 s11, s11, 8192
    buffer_load_dwordx4 v[208:211], v3, s[60:63], s11 offen offset:0 sc1
    buffer_load_dwordx4 v[212:215], v3, s[60:63], s11 offen offset:1024 sc1
    buffer_load_dwordx4 v[216:219], v2, s[60:63], s11 offen offset:0 sc1
    buffer_load_dwordx4 v[220:223], v2, s[60:63], s11 offen offset:1024 sc1
    buffer_load_dword v19, v22, s[68:71], 0 offen sc1
    s_mov_b32 s89, 262144
c_cf2:
    ds_read_b32 v14, v20 offset:20
    s_waitcnt lgkmcnt(0)
    v_readfirstlane_b32 s8, v14
    s_nop 1
    s_cmp_ge_u32 s8, 4
    s_cbranch_scc1 c_cf2_ok
    s_sub_u32 s89, s89, 1
    s_cbranch_scc0 c_cf2
c_cf2_ok:
    v_mfma_f32_32x32x16_bf16 v[96:111], v[188:191], v[240:243], v[96:111]
    ds_read_b128 v[224:227], v32 offset:32768
    v_mfma_f32_32x32x16_bf16 v[112:127], v[188:191], v[244:247], v[112:127]
    ds_read_b128 v[228:231], v32 offset:36864
    v_mfma_f32_32x32x16_bf16 v[128:143], v[188:191], v[248:251], v[128:143]
    ds_read_b128 v[232:235], v32 offset:40960
    v_mfma_f32_32x32x16_bf16 v[144:159], v[188:191], v[252:255], v[144:159]
    ds_read_b128 v[236:239], v32 offset:45056
    v_lshlrev_b32 v9, 16, v9
    v_lshlrev_b32 v10, 16, v10
    s_mov_b32 s12, 0xffff0000
    v_lshlrev_b32 v13, 16, v73
    v_lshlrev_b32 v16, 16, v74
    v_lshlrev_b32 v18, 16, v75
    v_lshlrev_b32 v25, 16, v76
    v_and_b32 v15, s12, v73
    v_and_b32 v17, s12, v74
    v_and_b32 v24, s12, v75
    v_and_b32 v8, s12, v76
    v_mul_f32 v13, v13, v9
    v_mul_f32 v16, v16, v9
    v_mul_f32 v18, v18, v9
    v_mul_f32 v25, v25, v9
    v_mul_f32 v15, v15, v9
    v_mul_f32 v17, v17, v9
    v_mul_f32 v24, v24, v9
    v_mul_f32 v8, v8, v9
    v_cvt_pk_bf16_f32 v89, v13, v15
    v_cvt_pk_bf16_f32 v90, v16, v17
    v_cvt_pk_bf16_f32 v91, v18, v24
    v_cvt_pk_bf16_f32 v92, v25, v8
    v_lshlrev_b32 v13, 16, v77
    v_lshlrev_b32 v16, 16, v78
    v_lshlrev_b32 v18, 16, v79
    v_lshlrev_b32 v25, 16, v80
    v_and_b32 v15, s12, v77
    v_and_b32 v17, s12, v78
    v_and_b32 v24, s12, v79
    v_and_b32 v8, s12, v80
    v_mul_f32 v13, v13, v9
    v_mul_f32 v16, v16, v9
    v_mul_f32 v18, v18, v9
    v_mul_f32 v25, v25, v9
    v_mul_f32 v15, v15, v9
    v_mul_f32 v17, v17, v9
    v_mul_f32 v24, v24, v9
    v_mul_f32 v8, v8, v9
    v_cvt_pk_bf16_f32 v93, v13, v15
    v_cvt_pk_bf16_f32 v94, v16, v17
    v_cvt_pk_bf16_f32 v95, v18, v24
    v_cvt_pk_bf16_f32 v54, v25, v8
    v_lshlrev_b32 v13, 16, v81
    v_lshlrev_b32 v16, 16, v82
    v_lshlrev_b32 v18, 16, v83
    v_lshlrev_b32 v25, 16, v84
    v_and_b32 v15, s12, v81
    v_and_b32 v17, s12, v82
    v_and_b32 v24, s12, v83
    v_and_b32 v8, s12, v84
    v_mul_f32 v13, v13, v10
    v_mul_f32 v16, v16, v10
    v_mul_f32 v18, v18, v10
    v_mul_f32 v25, v25, v10
    v_mul_f32 v15, v15, v10
    v_mul_f32 v17, v17, v10
    v_mul_f32 v24, v24, v10
    v_mul_f32 v8, v8, v10
    v_cvt_pk_bf16_f32 v55, v13, v15
    v_cvt_pk_bf16_f32 v56, v16, v17
    v_cvt_pk_bf16_f32 v57, v18, v24
    v_cvt_pk_bf16_f32 v58, v25, v8
    v_lshlrev_b32 v13, 16, v85
    v_lshlrev_b32 v16, 16, v86
    v_lshlrev_b32 v18, 16, v87
    v_lshlrev_b32 v25, 16, v88
    v_and_b32 v15, s12, v85
    v_and_b32 v17, s12, v86
    v_and_b32 v24, s12, v87
    v_and_b32 v8, s12, v88
    v_mul_f32 v13, v13, v10
    v_mul_f32 v16, v16, v10
    v_mul_f32 v18, v18, v10
    v_mul_f32 v25, v25, v10
    v_mul_f32 v15, v15, v10
    v_mul_f32 v17, v17, v10
    v_mul_f32 v24, v24, v10
    v_mul_f32 v8, v8, v10
    v_cvt_pk_bf16_f32 v59, v13, v15
    v_cvt_pk_bf16_f32 v61, v16, v17
    v_cvt_pk_bf16_f32 v5, v18, v24
    v_cvt_pk_bf16_f32 v12, v25, v8
    s_waitcnt vmcnt(8)
    s_waitcnt lgkmcnt(3)
    v_mfma_f32_32x32x16_bf16 v[96:111], v[192:195], v[224:227], v[96:111]
    ds_read_b128 v[240:243], v33 offset:32768
    s_waitcnt lgkmcnt(3)
    v_mfma_f32_32x32x16_bf16 v[112:127], v[192:195], v[228:231], v[112:127]
    ds_read_b128 v[244:247], v33 offset:36864
    s_waitcnt lgkmcnt(3)
    v_mfma_f32_32x32x16_bf16 v[128:143], v[192:195], v[232:235], v[128:143]
    ds_read_b128 v[248:251], v33 offset:40960
    s_waitcnt lgkmcnt(3)
    v_mfma_f32_32x32x16_bf16 v[144:159], v[192:195], v[236:239], v[144:159]
    ds_read_b128 v[252:255], v33 offset:45056
    s_waitcnt vmcnt(0)
    v_cmp_eq_u32 s[90:91], 1, v19
    s_nop 1
    s_and_b32 s88, s90, 0x3c
    s_cmp_eq_u32 s88, 0x3c
    s_cbranch_scc0 c_n1_s
c_n1:
    s_cmp_le_u32 s15, 1
    s_cselect_b32 s11, 2, 1
    s_lshl_b32 s11, s11, 14
    buffer_load_dwordx4 v[160:163], v3, s[60:63], s11 offen offset:0 sc1
    buffer_load_dwordx4 v[164:167], v3, s[60:63], s11 offen offset:1024 sc1
    buffer_load_dwordx4 v[168:171], v2, s[60:63], s11 offen offset:0 sc1
    buffer_load_dwordx4 v[172:175], v2, s[60:63], s11 offen offset:1024 sc1
    buffer_load_dword v19, v22, s[68:71], 0 offen sc1
    s_cmp_le_u32 s15, 1
    s_cselect_b32 s11, 2, 1
    s_lshl_b32 s11, s11, 14
    s_add_u32 s11, s11, 8192
    buffer_load_dwordx4 v[176:179], v3, s[60:63], s11 offen offset:0 sc1
    s_waitcnt lgkmcnt(3)
    v_mfma_f32_32x32x16_bf16 v[96:111], v[196:199], v[240:243], v[96:111]
    ds_read_b128 v[224:227], v34 offset:32768
    s_waitcnt lgkmcnt(3)
    v_mfma_f32_32x32x16_bf16 v[112:127], v[196:199], v[244:247], v[112:127]
    ds_read_b128 v[228:231], v34 offset:36864
    s_waitcnt lgkmcnt(3)
    v_mfma_f32_32x32x16_bf16 v[128:143], v[196:199], v[248:251], v[128:143]
    ds_read_b128 v[232:235], v34 offset:40960
    s_waitcnt lgkmcnt(3)
    v_mfma_f32_32x32x16_bf16 v[144:159], v[196:199], v[252:255], v[144:159]
    ds_read_b128 v[236:239], v34 offset:45056
    buffer_load_dwordx4 v[180:183], v3, s[60:63], s11 offen offset:1024 sc1
    s_waitcnt lgkmcnt(3)
    v_mfma_f32_32x32x16_bf16 v[96:111], v[200:203], v[224:227], v[96:111]
    ds_read_b128 v[240:243], v35 offset:32768
    s_waitcnt lgkmcnt(3)
    v_mfma_f32_32x32x16_bf16 v[112:127], v[200:203], v[228:231], v[112:127]
    ds_read_b128 v[244:247], v35 offset:36864
    s_waitcnt lgkmcnt(3)
    v_mfma_f32_32x32x16_bf16 v[128:143], v[200:203], v[232:235], v[128:143]
    ds_read_b128 v[248:251], v35 offset:40960
    s_waitcnt lgkmcnt(3)
    v_mfma_f32_32x32x16_bf16 v[144:159], v[200:203], v[236:239], v[144:159]
    ds_read_b128 v[252:255], v35 offset:45056
    buffer_load_dwordx4 v[184:187], v2, s[60:63], s11 offen offset:0 sc1
    s_barrier
    s_waitcnt lgkmcnt(3)
    v_mfma_f32_32x32x16_bf16 v[96:111], v[204:207], v[240:243], v[96:111]
    ds_read_b128 v[224:227], v32 offset:49152
    s_waitcnt lgkmcnt(3)
    v_mfma_f32_32x32x16_bf16 v[112:127], v[204:207], v[244:247], v[112:127]
    ds_read_b128 v[228:231], v32 offset:53248
    s_waitcnt lgkmcnt(3)
    v_mfma_f32_32x32x16_bf16 v[128:143], v[204:207], v[248:251], v[128:143]
    ds_read_b128 v[232:235], v32 offset:57344
    s_waitcnt lgkmcnt(3)
    v_mfma_f32_32x32x16_bf16 v[144:159], v[204:207], v[252:255], v[144:159]
    ds_read_b128 v[236:239], v32 offset:61440
    buffer_load_dwordx4 v[188:191], v2, s[60:63], s11 offen offset:1024 sc1
    s_waitcnt lgkmcnt(3)
    v_mfma_f32_32x32x16_bf16 v[96:111], v[208:211], v[224:227], v[96:111]
    ds_read_b128 v[240:243], v33 offset:49152
    s_waitcnt lgkmcnt(3)
    v_mfma_f32_32x32x16_bf16 v[112:127], v[208:211], v[228:231], v[112:127]
    ds_read_b128 v[244:247], v33 offset:53248
    s_waitcnt lgkmcnt(3)
    v_mfma_f32_32x32x16_bf16 v[128:143], v[208:211], v[232:235], v[128:143]
    ds_read_b128 v[248:251], v33 offset:57344
    s_waitcnt lgkmcnt(3)
    v_mfma_f32_32x32x16_bf16 v[144:159], v[208:211], v[236:239], v[144:159]
    ds_read_b128 v[252:255], v33 offset:61440
    s_waitcnt vmcnt(4)
    v_cmp_eq_u32 s[90:91], 1, v19
    s_nop 1
    s_and_b32 s88, s90, 0xfc
    s_cmp_eq_u32 s88, 0xfc
    s_cbranch_scc0 c_n2_s
c_n2:
    s_cmp_le_u32 s15, 2
    s_cselect_b32 s11, 3, 2
    s_lshl_b32 s11, s11, 14
    buffer_load_dwordx4 v[192:195], v3, s[60:63], s11 offen offset:0 sc1
    s_waitcnt lgkmcnt(3)
    v_mfma_f32_32x32x16_bf16 v[96:111], v[212:215], v[240:243], v[96:111]
    ds_read_b128 v[224:227], v34 offset:49152
    s_waitcnt lgkmcnt(3)
    v_mfma_f32_32x32x16_bf16 v[112:127], v[212:215], v[244:247], v[112:127]
    ds_read_b128 v[228:231], v34 offset:53248
    s_waitcnt lgkmcnt(3)
    v_mfma_f32_32x32x16_bf16 v[128:143], v[212:215], v[248:251], v[128:143]
    ds_read_b128 v[232:235], v34 offset:57344
    s_waitcnt lgkmcnt(3)
    v_mfma_f32_32x32x16_bf16 v[144:159], v[212:215], v[252:255], v[144:159]
    ds_read_b128 v[236:239], v34 offset:61440
    buffer_load_dwordx4 v[196:199], v3, s[60:63], s11 offen offset:1024 sc1
    s_waitcnt lgkmcnt(3)
    v_mfma_f32_32x32x16_bf16 v[96:111], v[216:219], v[224:227], v[96:111]
    ds_read_b128 v[240:243], v35 offset:49152
    s_waitcnt lgkmcnt(3)
    v_mfma_f32_32x32x16_bf16 v[112:127], v[216:219], v[228:231], v[112:127]
    ds_read_b128 v[244:247], v35 offset:53248
    s_waitcnt lgkmcnt(3)
    v_mfma_f32_32x32x16_bf16 v[128:143], v[216:219], v[232:235], v[128:143]
    ds_read_b128 v[248:251], v35 offset:57344
    s_waitcnt lgkmcnt(3)
    v_mfma_f32_32x32x16_bf16 v[144:159], v[216:219], v[236:239], v[144:159]
    ds_read_b128 v[252:255], v35 offset:61440
    buffer_load_dwordx4 v[200:203], v2, s[60:63], s11 offen offset:0 sc1
    s_barrier
    s_waitcnt lgkmcnt(3)
    v_mfma_f32_32x32x16_bf16 v[96:111], v[220:223], v[240:243], v[96:111]
    ds_read_b128 v[224:227], v32 offset:0
    s_waitcnt lgkmcnt(3)
    v_mfma_f32_32x32x16_bf16 v[112:127], v[220:223], v[244:247], v[112:127]
    ds_read_b128 v[228:231], v32 offset:4096
    s_waitcnt lgkmcnt(3)
    v_mfma_f32_32x32x16_bf16 v[128:143], v[220:223], v[248:251], v[128:143]
    ds_read_b128 v[232:235], v32 offset:8192
    s_waitcnt lgkmcnt(3)
    v_mfma_f32_32x32x16_bf16 v[144:159], v[220:223], v[252:255], v[144:159]
    ds_read_b128 v[236:239], v32 offset:12288
    buffer_load_dwordx4 v[204:207], v2, s[60:63], s11 offen offset:1024 sc1
    s_waitcnt lgkmcnt(3)
    v_mfma_f32_32x32x16_bf16 v[96:111], v[160:163], v[224:227], v[96:111]
    ds_read_b128 v[240:243], v33 offset:0
    s_waitcnt lgkmcnt(3)
    v_mfma_f32_32x32x16_bf16 v[112:127], v[160:163], v[228:231], v[112:127]
    ds_read_b128 v[244:247], v33 offset:4096
    s_waitcnt lgkmcnt(3)
    v_mfma_f32_32x32x16_bf16 v[128:143], v[160:163], v[232:235], v[128:143]
    ds_read_b128 v[248:251], v33 offset:8192
    s_waitcnt lgkmcnt(3)
    v_mfma_f32_32x32x16_bf16 v[144:159], v[160:163], v[236:239], v[144:159]
    ds_read_b128 v[252:255], v33 offset:12288
    s_cmp_le_u32 s15, 2
    s_cselect_b32 s11, 3, 2
    s_lshl_b32 s11, s11, 14
    s_add_u32 s11, s11, 8192
    buffer_load_dwordx4 v[208:211], v3, s[60:63], s11 offen offset:0 sc1
    s_waitcnt lgkmcnt(3)
    v_mfma_f32_32x32x16_bf16 v[96:111], v[164:167], v[240:243], v[96:111]
    ds_read_b128 v[224:227], v34 offset:0
    s_waitcnt lgkmcnt(3)
    v_mfma_f32_32x32x16_bf16 v[112:127], v[164:167], v[244:247], v[112:127]
    ds_read_b128 v[228:231], v34 offset:4096
    s_waitcnt lgkmcnt(3)
    v_mfma_f32_32x32x16_bf16 v[128:143], v[164:167], v[248:251], v[128:143]
    ds_read_b128 v[232:235], v34 offset:8192
    s_waitcnt lgkmcnt(3)
    v_mfma_f32_32x32x16_bf16 v[144:159], v[164:167], v[252:255], v[144:159]
    ds_read_b128 v[236:239], v34 offset:12288
    buffer_load_dwordx4 v[212:215], v3, s[60:63], s11 offen offset:1024 sc1
    s_waitcnt lgkmcnt(3)
    v_mfma_f32_32x32x16_bf16 v[96:111], v[168:171], v[224:227], v[96:111]
    ds_read_b128 v[240:243], v35 offset:0
    s_waitcnt lgkmcnt(3)
    v_mfma_f32_32x32x16_bf16 v[112:127], v[168:171], v[228:231], v[112:127]
    ds_read_b128 v[244:247], v35 offset:4096
    s_waitcnt lgkmcnt(3)
    v_mfma_f32_32x32x16_bf16 v[128:143], v[168:171], v[232:235], v[128:143]
    ds_read_b128 v[248:251], v35 offset:8192
    s_waitcnt lgkmcnt(3)
    v_mfma_f32_32x32x16_bf16 v[144:159], v[168:171], v[236:239], v[144:159]
    ds_read_b128 v[252:255], v35 offset:12288
    buffer_load_dwordx4 v[216:219], v2, s[60:63], s11 offen offset:0 sc1
    s_barrier
    s_waitcnt lgkmcnt(3)
    v_mfma_f32_32x32x16_bf16 v[96:111], v[172:175], v[240:243], v[96:111]
    ds_read_b128 v[224:227], v32 offset:16384
    s_waitcnt lgkmcnt(3)
    v_mfma_f32_32x32x16_bf16 v[112:127], v[172:175], v[244:247], v[112:127]
    ds_read_b128 v[228:231], v32 offset:20480
    s_waitcnt lgkmcnt(3)
    v_mfma_f32_32x32x16_bf16 v[128:143], v[172:175], v[248:251], v[128:143]
    ds_read_b128 v[232:235], v32 offset:24576
    s_waitcnt lgkmcnt(3)
    v_mfma_f32_32x32x16_bf16 v[144:159], v[172:175], v[252:255], v[144:159]
    ds_read_b128 v[236:239], v32 offset:28672
    buffer_load_dwordx4 v[220:223], v2, s[60:63], s11 offen offset:1024 sc1
    s_waitcnt vmcnt(11)
    s_waitcnt lgkmcnt(3)
    v_mfma_f32_32x32x16_bf16 v[96:111], v[176:179], v[224:227], v[96:111]
    ds_read_b128 v[240:243], v33 offset:16384
    s_waitcnt lgkmcnt(3)
    v_mfma_f32_32x32x16_bf16 v[112:127], v[176:179], v[228:231], v[112:127]
    ds_read_b128 v[244:247], v33 offset:20480
    s_waitcnt lgkmcnt(3)
    v_mfma_f32_32x32x16_bf16 v[128:143], v[176:179], v[232:235], v[128:143]
    ds_read_b128 v[248:251], v33 offset:24576
    s_waitcnt lgkmcnt(3)
    v_mfma_f32_32x32x16_bf16 v[144:159], v[176:179], v[236:239], v[144:159]
    ds_read_b128 v[252:255], v33 offset:28672
    s_and_b32 s88, s90, 0x3fc
    s_cmp_eq_u32 s88, 0x3fc
    s_cbranch_scc0 c_n3_s
c_n3:
    s_cmp_le_u32 s15, 3
    s_cselect_b32 s11, 4, 3
    s_lshl_b32 s11, s11, 14
    buffer_load_dwordx4 v[160:163], v3, s[60:63], s11 offen offset:0 sc1
    buffer_load_dword v14, v29, s[68:71], 0 offen sc1
    s_waitcnt vmcnt(12)
    s_waitcnt lgkmcnt(3)
    v_mfma_f32_32x32x16_bf16 v[96:111], v[180:183], v[240:243], v[96:111]
    ds_read_b128 v[224:227], v34 offset:16384
    s_waitcnt lgkmcnt(3)
    v_mfma_f32_32x32x16_bf16 v[112:127], v[180:183], v[244:247], v[112:127]
    ds_read_b128 v[228:231], v34 offset:20480
    s_waitcnt lgkmcnt(3)
    v_mfma_f32_32x32x16_bf16 v[128:143], v[180:183], v[248:251], v[128:143]
    ds_read_b128 v[232:235], v34 offset:24576
    s_waitcnt lgkmcnt(3)
    v_mfma_f32_32x32x16_bf16 v[144:159], v[180:183], v[252:255], v[144:159]
    ds_read_b128 v[236:239], v34 offset:28672
    buffer_load_dwordx4 v[164:167], v3, s[60:63], s11 offen offset:1024 sc1
    s_waitcnt vmcnt(12)
    s_waitcnt lgkmcnt(3)
    v_mfma_f32_32x32x16_bf16 v[96:111], v[184:187], v[224:227], v[96:111]
    ds_read_b128 v[240:243], v35 offset:16384
    s_waitcnt lgkmcnt(3)
    v_mfma_f32_32x32x16_bf16 v[112:127], v[184:187], v[228:231], v[112:127]
    ds_read_b128 v[244:247], v35 offset:20480
    s_waitcnt lgkmcnt(3)
    v_mfma_f32_32x32x16_bf16 v[128:143], v[184:187], v[232:235], v[128:143]
    ds_read_b128 v[248:251], v35 offset:24576
    s_waitcnt lgkmcnt(3)
    v_mfma_f32_32x32x16_bf16 v[144:159], v[184:187], v[236:239], v[144:159]
    ds_read_b128 v[252:255], v35 offset:28672
    buffer_load_dwordx4 v[168:171], v2, s[60:63], s11 offen offset:0 sc1
    s_barrier
    s_waitcnt vmcnt(12)
    s_waitcnt lgkmcnt(3)
    v_mfma_f32_32x32x16_bf16 v[96:111], v[188:191], v[240:243], v[96:111]
    ds_read_b128 v[224:227], v32 offset:32768
    s_waitcnt lgkmcnt(3)
    v_mfma_f32_32x32x16_bf16 v[112:127], v[188:191], v[244:247], v[112:127]
    ds_read_b128 v[228:231], v32 offset:36864
    s_waitcnt lgkmcnt(3)
    v_mfma_f32_32x32x16_bf16 v[128:143], v[188:191], v[248:251], v[128:143]
    ds_read_b128 v[232:235], v32 offset:40960
    s_waitcnt lgkmcnt(3)
    v_mfma_f32_32x32x16_bf16 v[144:159], v[188:191], v[252:255], v[144:159]
    ds_read_b128 v[236:239], v32 offset:45056
    buffer_load_dwordx4 v[172:175], v2, s[60:63], s11 offen offset:1024 sc1
    s_waitcnt vmcnt(12)
    s_waitcnt lgkmcnt(3)
    v_mfma_f32_32x32x16_bf16 v[96:111], v[192:195], v[224:227], v[96:111]
    ds_read_b128 v[240:243], v33 offset:32768
    s_waitcnt lgkmcnt(3)
    v_mfma_f32_32x32x16_bf16 v[112:127], v[192:195], v[228:231], v[112:127]
    ds_read_b128 v[244:247], v33 offset:36864
    s_waitcnt lgkmcnt(3)
    v_mfma_f32_32x32x16_bf16 v[128:143], v[192:195], v[232:235], v[128:143]
    ds_read_b128 v[248:251], v33 offset:40960
    s_waitcnt lgkmcnt(3)
    v_mfma_f32_32x32x16_bf16 v[144:159], v[192:195], v[236:239], v[144:159]
    ds_read_b128 v[252:255], v33 offset:45056
    s_cmp_le_u32 s15, 3
    s_cselect_b32 s11, 4, 3
    s_lshl_b32 s11, s11, 14
    s_add_u32 s11, s11, 8192
    buffer_load_dwordx4 v[176:179], v3, s[60:63], s11 offen offset:0 sc1
    s_waitcnt vmcnt(12)
    s_waitcnt lgkmcnt(3)
    v_mfma_f32_32x32x16_bf16 v[96:111], v[196:199], v[240:243], v[96:111]
    ds_read_b128 v[224:227], v34 offset:32768
    s_waitcnt lgkmcnt(3)
    v_mfma_f32_32x32x16_bf16 v[112:127], v[196:199], v[244:247], v[112:127]
    ds_read_b128 v[228:231], v34 offset:36864
    s_waitcnt lgkmcnt(3)
    v_mfma_f32_32x32x16_bf16 v[128:143], v[196:199], v[248:251], v[128:143]
    ds_read_b128 v[232:235], v34 offset:40960
    s_waitcnt lgkmcnt(3)
    v_mfma_f32_32x32x16_bf16 v[144:159], v[196:199], v[252:255], v[144:159]
    ds_read_b128 v[236:239], v34 offset:45056
    buffer_load_dwordx4 v[180:183], v3, s[60:63], s11 offen offset:1024 sc1
    s_waitcnt vmcnt(12)
    s_waitcnt lgkmcnt(3)
    v_mfma_f32_32x32x16_bf16 v[96:111], v[200:203], v[224:227], v[96:111]
    ds_read_b128 v[240:243], v35 offset:32768
    s_waitcnt lgkmcnt(3)
    v_mfma_f32_32x32x16_bf16 v[112:127], v[200:203], v[228:231], v[112:127]
    ds_read_b128 v[244:247], v35 offset:36864
    s_waitcnt lgkmcnt(3)
    v_mfma_f32_32x32x16_bf16 v[128:143], v[200:203], v[232:235], v[128:143]
    ds_read_b128 v[248:251], v35 offset:40960
    s_waitcnt lgkmcnt(3)
    v_mfma_f32_32x32x16_bf16 v[144:159], v[200:203], v[236:239], v[144:159]
    ds_read_b128 v[252:255], v35 offset:45056
    buffer_load_dwordx4 v[184:187], v2, s[60:63], s11 offen offset:0 sc1
    s_barrier
    s_waitcnt vmcnt(12)
    s_waitcnt lgkmcnt(3)
    v_mfma_f32_32x32x16_bf16 v[96:111], v[204:207], v[240:243], v[96:111]
    ds_read_b128 v[224:227], v32 offset:49152
    s_waitcnt lgkmcnt(3)
    v_mfma_f32_32x32x16_bf16 v[112:127], v[204:207], v[244:247], v[112:127]
    ds_read_b128 v[228:231], v32 offset:53248
    s_waitcnt lgkmcnt(3)
    v_mfma_f32_32x32x16_bf16 v[128:143], v[204:207], v[248:251], v[128:143]
    ds_read_b128 v[232:235], v32 offset:57344
    s_waitcnt lgkmcnt(3)
    v_mfma_f32_32x32x16_bf16 v[144:159], v[204:207], v[252:255], v[144:159]
    ds_read_b128 v[236:239], v32 offset:61440
    buffer_load_dwordx4 v[188:191], v2, s[60:63], s11 offen offset:1024 sc1
    s_waitcnt vmcnt(12)
    s_waitcnt lgkmcnt(3)
    v_mfma_f32_32x32x16_bf16 v[96:111], v[208:211], v[224:227], v[96:111]
    ds_read_b128 v[240:243], v33 offset:49152
    s_waitcnt lgkmcnt(3)
    v_mfma_f32_32x32x16_bf16 v[112:127], v[208:211], v[228:231], v[112:127]
    ds_read_b128 v[244:247], v33 offset:53248
    s_waitcnt lgkmcnt(3)
    v_mfma_f32_32x32x16_bf16 v[128:143], v[208:211], v[232:235], v[128:143]
    ds_read_b128 v[248:251], v33 offset:57344
    s_waitcnt lgkmcnt(3)
    v_mfma_f32_32x32x16_bf16 v[144:159], v[208:211], v[236:239], v[144:159]
    ds_read_b128 v[252:255], v33 offset:61440
    s_and_b32 s88, s90, 0xffc
    s_cmp_eq_u32 s88, 0xffc
    s_cbranch_scc0 c_n4_s
c_n4:
    s_cmp_le_u32 s15, 4
    s_cselect_b32 s11, 5, 4
    s_lshl_b32 s11, s11, 14
    buffer_load_dwordx4 v[192:195], v3, s[60:63], s11 offen offset:0 sc1
    s_waitcnt vmcnt(12)
    s_waitcnt lgkmcnt(3)
    v_mfma_f32_32x32x16_bf16 v[96:111], v[212:215], v[240:243], v[96:111]
    ds_read_b128 v[224:227], v34 offset:49152
    s_waitcnt lgkmcnt(3)
    v_mfma_f32_32x32x16_bf16 v[112:127], v[212:215], v[244:247], v[112:127]
    ds_read_b128 v[228:231], v34 offset:53248
    s_waitcnt lgkmcnt(3)
    v_mfma_f32_32x32x16_bf16 v[128:143], v[212:215], v[248:251], v[128:143]
    ds_read_b128 v[232:235], v34 offset:57344
    s_waitcnt lgkmcnt(3)
    v_mfma_f32_32x32x16_bf16 v[144:159], v[212:215], v[252:255], v[144:159]
    ds_read_b128 v[236:239], v34 offset:61440
    buffer_load_dwordx4 v[196:199], v3, s[60:63], s11 offen offset:1024 sc1
    s_waitcnt vmcnt(12)
    s_waitcnt lgkmcnt(3)
    v_mfma_f32_32x32x16_bf16 v[96:111], v[216:219], v[224:227], v[96:111]
    ds_read_b128 v[240:243], v35 offset:49152
    s_waitcnt lgkmcnt(3)
    v_mfma_f32_32x32x16_bf16 v[112:127], v[216:219], v[228:231], v[112:127]
    ds_read_b128 v[244:247], v35 offset:53248
    s_waitcnt lgkmcnt(3)
    v_mfma_f32_32x32x16_bf16 v[128:143], v[216:219], v[232:235], v[128:143]
    ds_read_b128 v[248:251], v35 offset:57344
    s_waitcnt lgkmcnt(3)
    v_mfma_f32_32x32x16_bf16 v[144:159], v[216:219], v[236:239], v[144:159]
    ds_read_b128 v[252:255], v35 offset:61440
    buffer_load_dwordx4 v[200:203], v2, s[60:63], s11 offen offset:0 sc1
    s_barrier
    s_waitcnt vmcnt(12)
    s_waitcnt lgkmcnt(3)
    v_mfma_f32_32x32x16_bf16 v[96:111], v[220:223], v[240:243], v[96:111]
    ds_read_b128 v[224:227], v32 offset:0
    s_waitcnt lgkmcnt(3)
    v_mfma_f32_32x32x16_bf16 v[112:127], v[220:223], v[244:247], v[112:127]
    ds_read_b128 v[228:231], v32 offset:4096
    s_waitcnt lgkmcnt(3)
    v_mfma_f32_32x32x16_bf16 v[128:143], v[220:223], v[248:251], v[128:143]
    ds_read_b128 v[232:235], v32 offset:8192
    s_waitcnt lgkmcnt(3)
    v_mfma_f32_32x32x16_bf16 v[144:159], v[220:223], v[252:255], v[144:159]
    ds_read_b128 v[236:239], v32 offset:12288
    buffer_load_dwordx4 v[204:207], v2, s[60:63], s11 offen offset:1024 sc1
    s_waitcnt vmcnt(12)
    s_waitcnt lgkmcnt(3)
    v_mfma_f32_32x32x16_bf16 v[96:111], v[160:163], v[224:227], v[96:111]
    ds_read_b128 v[240:243], v33 offset:0
    s_waitcnt lgkmcnt(3)
    v_mfma_f32_32x32x16_bf16 v[112:127], v[160:163], v[228:231], v[112:127]
    ds_read_b128 v[244:247], v33 offset:4096
    s_waitcnt lgkmcnt(3)
    v_mfma_f32_32x32x16_bf16 v[128:143], v[160:163], v[232:235], v[128:143]
    ds_read_b128 v[248:251], v33 offset:8192
    s_waitcnt lgkmcnt(3)
    v_mfma_f32_32x32x16_bf16 v[144:159], v[160:163], v[236:239], v[144:159]
    ds_read_b128 v[252:255], v33 offset:12288
    s_cmp_le_u32 s15, 4
    s_cselect_b32 s11, 5, 4
    s_lshl_b32 s11, s11, 14
    s_add_u32 s11, s11, 8192
    buffer_load_dwordx4 v[208:211], v3, s[60:63], s11 offen offset:0 sc1
    s_waitcnt vmcnt(12)
    v_cmp_ne_u32 vcc, 1, v14
    s_nop 1
    s_cmp_eq_u64 vcc, 0
    s_cbranch_scc0 c_pfs
c_pfr:
    s_waitcnt vmcnt(11)
    s_waitcnt lgkmcnt(3)
    v_mfma_f32_32x32x16_bf16 v[96:111], v[164:167], v[240:243], v[96:111]
    ds_read_b128 v[224:227], v34 offset:0
    s_waitcnt lgkmcnt(3)
    v_mfma_f32_32x32x16_bf16 v[112:127], v[164:167], v[244:247], v[112:127]
    ds_read_b128 v[228:231], v34 offset:4096
    s_waitcnt lgkmcnt(3)
    v_mfma_f32_32x32x16_bf16 v[128:143], v[164:167], v[248:251], v[128:143]
    ds_read_b128 v[232:235], v34 offset:8192
    s_waitcnt lgkmcnt(3)
    v_mfma_f32_32x32x16_bf16 v[144:159], v[164:167], v[252:255], v[144:159]
    ds_read_b128 v[236:239], v34 offset:12288
    buffer_load_dwordx4 v[212:215], v3, s[60:63], s11 offen offset:1024 sc1
    s_waitcnt vmcnt(11)
    s_waitcnt lgkmcnt(3)
    v_mfma_f32_32x32x16_bf16 v[96:111], v[168:171], v[224:227], v[96:111]
    ds_read_b128 v[240:243], v35 offset:0
    s_waitcnt lgkmcnt(3)
    v_mfma_f32_32x32x16_bf16 v[112:127], v[168:171], v[228:231], v[112:127]
    ds_read_b128 v[244:247], v35 offset:4096
    s_waitcnt lgkmcnt(3)
    v_mfma_f32_32x32x16_bf16 v[128:143], v[168:171], v[232:235], v[128:143]
    ds_read_b128 v[248:251], v35 offset:8192
    s_waitcnt lgkmcnt(3)
    v_mfma_f32_32x32x16_bf16 v[144:159], v[168:171], v[236:239], v[144:159]
    ds_read_b128 v[252:255], v35 offset:12288
    buffer_load_dwordx4 v[216:219], v2, s[60:63], s11 offen offset:0 sc1
    s_barrier
    s_waitcnt vmcnt(11)
    s_waitcnt lgkmcnt(3)
    v_mfma_f32_32x32x16_bf16 v[96:111], v[172:175], v[240:243], v[96:111]
    ds_read_b128 v[224:227], v32 offset:16384
    s_waitcnt lgkmcnt(3)
    v_mfma_f32_32x32x16_bf16 v[112:127], v[172:175], v[244:247], v[112:127]
    ds_read_b128 v[228:231], v32 offset:20480
    s_waitcnt lgkmcnt(3)
    v_mfma_f32_32x32x16_bf16 v[128:143], v[172:175], v[248:251], v[128:143]
    ds_read_b128 v[232:235], v32 offset:24576
    s_waitcnt lgkmcnt(3)
    v_mfma_f32_32x32x16_bf16 v[144:159], v[172:175], v[252:255], v[144:159]
    ds_read_b128 v[236:239], v32 offset:28672
    buffer_load_dwordx4 v[220:223], v2, s[60:63], s11 offen offset:1024 sc1
    s_waitcnt vmcnt(11)
    s_waitcnt lgkmcnt(3)
    v_mfma_f32_32x32x16_bf16 v[96:111], v[176:179], v[224:227], v[96:111]
    ds_read_b128 v[240:243], v33 offset:16384
    s_waitcnt lgkmcnt(3)
    v_mfma_f32_32x32x16_bf16 v[112:127], v[176:179], v[228:231], v[112:127]
    ds_read_b128 v[244:247], v33 offset:20480
    s_waitcnt lgkmcnt(3)
    v_mfma_f32_32x32x16_bf16 v[128:143], v[176:179], v[232:235], v[128:143]
    ds_read_b128 v[248:251], v33 offset:24576
    s_waitcnt lgkmcnt(3)
    v_mfma_f32_32x32x16_bf16 v[144:159], v[176:179], v[236:239], v[144:159]
    ds_read_b128 v[252:255], v33 offset:28672
    s_and_b32 s88, s90, 0x3ffc
    s_cmp_eq_u32 s88, 0x3ffc
    s_cbranch_scc0 c_n5_s
c_n5:
    s_cmp_le_u32 s15, 5
    s_cselect_b32 s11, 6, 5
    s_lshl_b32 s11, s11, 14
    buffer_load_dwordx4 v[160:163], v3, s[60:63], s11 offen offset:0 sc1
    s_waitcnt vmcnt(11)
    s_waitcnt lgkmcnt(3)
    v_mfma_f32_32x32x16_bf16 v[96:111], v[180:183], v[240:243], v[96:111]
    ds_read_b128 v[224:227], v34 offset:16384
    s_waitcnt lgkmcnt(3)
    v_mfma_f32_32x32x16_bf16 v[112:127], v[180:183], v[244:247], v[112:127]
    ds_read_b128 v[228:231], v34 offset:20480
    s_waitcnt lgkmcnt(3)
    v_mfma_f32_32x32x16_bf16 v[128:143], v[180:183], v[248:251], v[128:143]
    ds_read_b128 v[232:235], v34 offset:24576
    s_waitcnt lgkmcnt(3)
    v_mfma_f32_32x32x16_bf16 v[144:159], v[180:183], v[252:255], v[144:159]
    ds_read_b128 v[236:239], v34 offset:28672
    buffer_load_dwordx4 v[164:167], v3, s[60:63], s11 offen offset:1024 sc1
    s_waitcnt vmcnt(11)
    s_waitcnt lgkmcnt(3)
    v_mfma_f32_32x32x16_bf16 v[96:111], v[184:187], v[224:227], v[96:111]
    ds_read_b128 v[240:243], v35 offset:16384
    s_waitcnt lgkmcnt(3)
    v_mfma_f32_32x32x16_bf16 v[112:127], v[184:187], v[228:231], v[112:127]
    ds_read_b128 v[244:247], v35 offset:20480
    s_waitcnt lgkmcnt(3)
    v_mfma_f32_32x32x16_bf16 v[128:143], v[184:187], v[232:235], v[128:143]
    ds_read_b128 v[248:251], v35 offset:24576
    s_waitcnt lgkmcnt(3)
    v_mfma_f32_32x32x16_bf16 v[144:159], v[184:187], v[236:239], v[144:159]
    ds_read_b128 v[252:255], v35 offset:28672
    buffer_load_dwordx4 v[168:171], v2, s[60:63], s11 offen offset:0 sc1
    s_barrier
    s_waitcnt vmcnt(11)
    s_waitcnt lgkmcnt(3)
    v_mfma_f32_32x32x16_bf16 v[96:111], v[188:191], v[240:243], v[96:111]
    ds_read_b128 v[224:227], v32 offset:32768
    s_waitcnt lgkmcnt(3)
    v_mfma_f32_32x32x16_bf16 v[112:127], v[188:191], v[244:247], v[112:127]
    ds_read_b128 v[228:231], v32 offset:36864
    s_waitcnt lgkmcnt(3)
    v_mfma_f32_32x32x16_bf16 v[128:143], v[188:191], v[248:251], v[128:143]
    ds_read_b128 v[232:235], v32 offset:40960
    s_waitcnt lgkmcnt(3)
    v_mfma_f32_32x32x16_bf16 v[144:159], v[188:191], v[252:255], v[144:159]
    ds_read_b128 v[236:239], v32 offset:45056
    buffer_load_dwordx4 v[172:175], v2, s[60:63], s11 offen offset:1024 sc1
    s_waitcnt vmcnt(11)
    s_waitcnt lgkmcnt(3)
    v_mfma_f32_32x32x16_bf16 v[96:111], v[192:195], v[224:227], v[96:111]
    ds_read_b128 v[240:243], v33 offset:32768
    s_waitcnt lgkmcnt(3)
    v_mfma_f32_32x32x16_bf16 v[112:127], v[192:195], v[228:231], v[112:127]
    ds_read_b128 v[244:247], v33 offset:36864
    s_waitcnt lgkmcnt(3)
    v_mfma_f32_32x32x16_bf16 v[128:143], v[192:195], v[232:235], v[128:143]
    ds_read_b128 v[248:251], v33 offset:40960
    s_waitcnt lgkmcnt(3)
    v_mfma_f32_32x32x16_bf16 v[144:159], v[192:195], v[236:239], v[144:159]
    ds_read_b128 v[252:255], v33 offset:45056
    s_cmp_le_u32 s15, 5
    s_cselect_b32 s11, 6, 5
    s_lshl_b32 s11, s11, 14
    s_add_u32 s11, s11, 8192
    buffer_load_dwordx4 v[176:179], v3, s[60:63], s11 offen offset:0 sc1
    s_waitcnt vmcnt(11)
    s_waitcnt lgkmcnt(3)
    v_mfma_f32_32x32x16_bf16 v[96:111], v[196:199], v[240:243], v[96:111]
    ds_read_b128 v[224:227], v34 offset:32768
    s_waitcnt lgkmcnt(3)
    v_mfma_f32_32x32x16_bf16 v[112:127], v[196:199], v[244:247], v[112:127]
    ds_read_b128 v[228:231], v34 offset:36864
    s_waitcnt lgkmcnt(3)
    v_mfma_f32_32x32x16_bf16 v[128:143], v[196:199], v[248:251], v[128:143]
    ds_read_b128 v[232:235], v34 offset:40960
    s_waitcnt lgkmcnt(3)
    v_mfma_f32_32x32x16_bf16 v[144:159], v[196:199], v[252:255], v[144:159]
    ds_read_b128 v[236:239], v34 offset:45056
    buffer_load_dwordx4 v[180:183], v3, s[60:63], s11 offen offset:1024 sc1
    s_waitcnt vmcnt(11)
    s_waitcnt lgkmcnt(3)
    v_mfma_f32_32x32x16_bf16 v[96:111], v[200:203], v[224:227], v[96:111]
    ds_read_b128 v[240:243], v35 offset:32768
    s_waitcnt lgkmcnt(3)
    v_mfma_f32_32x32x16_bf16 v[112:127], v[200:203], v[228:231], v[112:127]
    ds_read_b128 v[244:247], v35 offset:36864
    s_waitcnt lgkmcnt(3)
    v_mfma_f32_32x32x16_bf16 v[128:143], v[200:203], v[232:235], v[128:143]
    ds_read_b128 v[248:251], v35 offset:40960
    s_waitcnt lgkmcnt(3)
    v_mfma_f32_32x32x16_bf16 v[144:159], v[200:203], v[236:239], v[144:159]
    ds_read_b128 v[252:255], v35 offset:45056
    buffer_load_dwordx4 v[184:187], v2, s[60:63], s11 offen offset:0 sc1
    s_barrier
    s_waitcnt vmcnt(11)
    s_waitcnt lgkmcnt(3)
    v_mfma_f32_32x32x16_bf16 v[96:111], v[204:207], v[240:243], v[96:111]
    ds_read_b128 v[224:227], v32 offset:49152
    s_waitcnt lgkmcnt(3)
    v_mfma_f32_32x32x16_bf16 v[112:127], v[204:207], v[244:247], v[112:127]
    ds_read_b128 v[228:231], v32 offset:53248
    s_waitcnt lgkmcnt(3)
    v_mfma_f32_32x32x16_bf16 v[128:143], v[204:207], v[248:251], v[128:143]
    ds_read_b128 v[232:235], v32 offset:57344
    s_waitcnt lgkmcnt(3)
    v_mfma_f32_32x32x16_bf16 v[144:159], v[204:207], v[252:255], v[144:159]
    ds_read_b128 v[236:239], v32 offset:61440
    buffer_load_dwordx4 v[188:191], v2, s[60:63], s11 offen offset:1024 sc1
    s_waitcnt vmcnt(11)
    s_waitcnt lgkmcnt(3)
    v_mfma_f32_32x32x16_bf16 v[96:111], v[208:211], v[224:227], v[96:111]
    ds_read_b128 v[240:243], v33 offset:49152
    s_waitcnt lgkmcnt(3)
    v_mfma_f32_32x32x16_bf16 v[112:127], v[208:211], v[228:231], v[112:127]
    ds_read_b128 v[244:247], v33 offset:53248
    s_waitcnt lgkmcnt(3)
    v_mfma_f32_32x32x16_bf16 v[128:143], v[208:211], v[232:235], v[128:143]
    ds_read_b128 v[248:251], v33 offset:57344
    s_waitcnt lgkmcnt(3)
    v_mfma_f32_32x32x16_bf16 v[144:159], v[208:211], v[236:239], v[144:159]
    ds_read_b128 v[252:255], v33 offset:61440
    s_and_b32 s88, s90, 0xfffc
    s_cmp_eq_u32 s88, 0xfffc
    s_cbranch_scc0 c_n6_s
c_n6:
    s_cmp_le_u32 s15, 6
    s_cselect_b32 s11, 7, 6
    s_lshl_b32 s11, s11, 14
    buffer_load_dwordx4 v[192:195], v3, s[60:63], s11 offen offset:0 sc1
    s_waitcnt vmcnt(11)
    s_waitcnt lgkmcnt(3)
    v_mfma_f32_32x32x16_bf16 v[96:111], v[212:215], v[240:243], v[96:111]
    ds_read_b128 v[224:227], v34 offset:49152
    s_waitcnt lgkmcnt(3)
    v_mfma_f32_32x32x16_bf16 v[112:127], v[212:215], v[244:247], v[112:127]
    ds_read_b128 v[228:231], v34 offset:53248
    s_waitcnt lgkmcnt(3)
    v_mfma_f32_32x32x16_bf16 v[128:143], v[212:215], v[248:251], v[128:143]
    ds_read_b128 v[232:235], v34 offset:57344
    s_waitcnt lgkmcnt(3)
    v_mfma_f32_32x32x16_bf16 v[144:159], v[212:215], v[252:255], v[144:159]
    ds_read_b128 v[236:239], v34 offset:61440
    buffer_load_dwordx4 v[196:199], v3, s[60:63], s11 offen offset:1024 sc1
    s_waitcnt vmcnt(11)
    s_waitcnt lgkmcnt(3)
    v_mfma_f32_32x32x16_bf16 v[96:111], v[216:219], v[224:227], v[96:111]
    ds_read_b128 v[240:243], v35 offset:49152
    s_waitcnt lgkmcnt(3)
    v_mfma_f32_32x32x16_bf16 v[112:127], v[216:219], v[228:231], v[112:127]
    ds_read_b128 v[244:247], v35 offset:53248
    s_waitcnt lgkmcnt(3)
    v_mfma_f32_32x32x16_bf16 v[128:143], v[216:219], v[232:235], v[128:143]
    ds_read_b128 v[248:251], v35 offset:57344
    s_waitcnt lgkmcnt(3)
    v_mfma_f32_32x32x16_bf16 v[144:159], v[216:219], v[236:239], v[144:159]
    ds_read_b128 v[252:255], v35 offset:61440
    buffer_load_dwordx4 v[200:203], v2, s[60:63], s11 offen offset:0 sc1
    s_barrier
    s_waitcnt vmcnt(11)
    s_waitcnt lgkmcnt(3)
    v_mfma_f32_32x32x16_bf16 v[96:111], v[220:223], v[240:243], v[96:111]
    ds_read_b128 v[224:227], v32 offset:0
    s_waitcnt lgkmcnt(3)
    v_mfma_f32_32x32x16_bf16 v[112:127], v[220:223], v[244:247], v[112:127]
    ds_read_b128 v[228:231], v32 offset:4096
    s_waitcnt lgkmcnt(3)
    v_mfma_f32_32x32x16_bf16 v[128:143], v[220:223], v[248:251], v[128:143]
    ds_read_b128 v[232:235], v32 offset:8192
    s_waitcnt lgkmcnt(3)
    v_mfma_f32_32x32x16_bf16 v[144:159], v[220:223], v[252:255], v[144:159]
    ds_read_b128 v[236:239], v32 offset:12288
    buffer_load_dwordx4 v[204:207], v2, s[60:63], s11 offen offset:1024 sc1
    s_cmp_le_u32 s15, 6
    s_cselect_b32 s11, 7, 6
    s_lshl_b32 s11, s11, 14
    s_add_u32 s11, s11, 8192
    buffer_load_dwordx4 v[208:211], v3, s[60:63], s11 offen offset:0 sc1
    buffer_load_dwordx4 v[212:215], v3, s[60:63], s11 offen offset:1024 sc1
    buffer_load_dwordx4 v[216:219], v2, s[60:63], s11 offen offset:0 sc1
    buffer_load_dwordx4 v[220:223], v2, s[60:63], s11 offen offset:1024 sc1
    ds_read_b128 v[240:243], v33 offset:0
    ds_read_b128 v[244:247], v33 offset:4096
    ds_read_b128 v[248:251], v34 offset:0
    s_waitcnt vmcnt(15)
    s_waitcnt lgkmcnt(6)
    v_mfma_f32_32x32x16_bf16 v[96:111], v[160:163], v[224:227], v[96:111]
    ds_read_b128 v[252:255], v34 offset:4096
    s_waitcnt lgkmcnt(6)
    v_mfma_f32_32x32x16_bf16 v[112:127], v[160:163], v[228:231], v[112:127]
    ds_read_b128 v[224:227], v35 offset:0
    s_waitcnt vmcnt(14)
    s_waitcnt lgkmcnt(4)
    v_mfma_f32_32x32x16_bf16 v[96:111], v[164:167], v[240:243], v[96:111]
    ds_read_b128 v[228:231], v35 offset:4096
    s_waitcnt lgkmcnt(4)
    v_mfma_f32_32x32x16_bf16 v[112:127], v[164:167], v[244:247], v[112:127]
    s_barrier
    ds_read_b128 v[240:243], v32 offset:16384
    s_waitcnt vmcnt(13)
    s_waitcnt lgkmcnt(4)
    v_mfma_f32_32x32x16_bf16 v[96:111], v[168:171], v[248:251], v[96:111]
    ds_read_b128 v[244:247], v32 offset:20480
    s_waitcnt lgkmcnt(4)
    v_mfma_f32_32x32x16_bf16 v[112:127], v[168:171], v[252:255], v[112:127]
    ds_read_b128 v[248:251], v33 offset:16384
    s_waitcnt vmcnt(12)
    s_waitcnt lgkmcnt(4)
    v_mfma_f32_32x32x16_bf16 v[96:111], v[172:175], v[224:227], v[96:111]
    ds_read_b128 v[252:255], v33 offset:20480
    s_waitcnt lgkmcnt(4)
    v_mfma_f32_32x32x16_bf16 v[112:127], v[172:175], v[228:231], v[112:127]
    ds_read_b128 v[224:227], v34 offset:16384
    s_waitcnt vmcnt(11)
    s_waitcnt lgkmcnt(4)
    v_mfma_f32_32x32x16_bf16 v[96:111], v[176:179], v[240:243], v[96:111]
    ds_read_b128 v[228:231], v34 offset:20480
    s_waitcnt lgkmcnt(4)
    v_mfma_f32_32x32x16_bf16 v[112:127], v[176:179], v[244:247], v[112:127]
    ds_read_b128 v[240:243], v35 offset:16384
    s_waitcnt vmcnt(10)
    s_waitcnt lgkmcnt(4)
    v_mfma_f32_32x32x16_bf16 v[96:111], v[180:183], v[248:251], v[96:111]
    ds_read_b128 v[244:247], v35 offset:20480
    s_waitcnt lgkmcnt(4)
    v_mfma_f32_32x32x16_bf16 v[112:127], v[180:183], v[252:255], v[112:127]
    ds_read_b128 v[248:251], v33 offset:8192
    s_waitcnt vmcnt(9)
    s_waitcnt lgkmcnt(4)
    v_mfma_f32_32x32x16_bf16 v[96:111], v[184:187], v[224:227], v[96:111]
    ds_read_b128 v[252:255], v33 offset:12288
    s_waitcnt lgkmcnt(4)
    v_mfma_f32_32x32x16_bf16 v[112:127], v[184:187], v[228:231], v[112:127]
    ds_read_b128 v[224:227], v34 offset:8192
    s_waitcnt vmcnt(8)
    s_waitcnt lgkmcnt(4)
    v_mfma_f32_32x32x16_bf16 v[96:111], v[188:191], v[240:243], v[96:111]
    ds_read_b128 v[228:231], v34 offset:12288
    s_waitcnt lgkmcnt(4)
    v_mfma_f32_32x32x16_bf16 v[112:127], v[188:191], v[244:247], v[112:127]
    ds_read_b128 v[240:243], v35 offset:8192
    v_mfma_f32_32x32x16_bf16 v[128:143], v[160:163], v[232:235], v[128:143]
    ds_read_b128 v[244:247], v35 offset:12288
    v_mfma_f32_32x32x16_bf16 v[144:159], v[160:163], v[236:239], v[144:159]
    s_waitcnt lgkmcnt(5)
    v_mfma_f32_32x32x16_bf16 v[128:143], v[164:167], v[248:251], v[128:143]
    s_waitcnt lgkmcnt(4)
    v_mfma_f32_32x32x16_bf16 v[144:159], v[164:167], v[252:255], v[144:159]
    s_barrier
    ds_read_b128 v[232:235], v32 offset:32768
    ds_read_b128 v[236:239], v32 offset:36864
    ds_read_b128 v[248:251], v33 offset:32768
    s_waitcnt lgkmcnt(6)
    v_mfma_f32_32x32x16_bf16 v[128:143], v[168:171], v[224:227], v[128:143]
    ds_read_b128 v[252:255], v33 offset:36864
    s_waitcnt lgkmcnt(6)
    v_mfma_f32_32x32x16_bf16 v[144:159], v[168:171], v[228:231], v[144:159]
    ds_read_b128 v[224:227], v34 offset:32768
    s_waitcnt lgkmcnt(6)
    v_mfma_f32_32x32x16_bf16 v[128:143], v[172:175], v[240:243], v[128:143]
    ds_read_b128 v[228:231], v34 offset:36864
    s_waitcnt lgkmcnt(6)
    v_mfma_f32_32x32x16_bf16 v[144:159], v[172:175], v[244:247], v[144:159]
    ds_read_b128 v[240:243], v35 offset:32768
    s_waitcnt vmcnt(7)
    s_waitcnt lgkmcnt(6)
    v_mfma_f32_32x32x16_bf16 v[96:111], v[192:195], v[232:235], v[96:111]
    ds_read_b128 v[244:247], v35 offset:36864
    s_waitcnt lgkmcnt(6)
    v_mfma_f32_32x32x16_bf16 v[112:127], v[192:195], v[236:239], v[112:127]
    s_waitcnt vmcnt(6)
    s_waitcnt lgkmcnt(5)
    v_mfma_f32_32x32x16_bf16 v[96:111], v[196:199], v[248:251], v[96:111]
    s_waitcnt lgkmcnt(4)
    v_mfma_f32_32x32x16_bf16 v[112:127], v[196:199], v[252:255], v[112:127]
    s_barrier
    ds_read_b128 v[232:235], v32 offset:49152
    ds_read_b128 v[236:239], v32 offset:53248
    ds_read_b128 v[248:251], v33 offset:49152
    s_waitcnt vmcnt(5)
    s_waitcnt lgkmcnt(6)
    v_mfma_f32_32x32x16_bf16 v[96:111], v[200:203], v[224:227], v[96:111]
    ds_read_b128 v[252:255], v33 offset:53248
    s_waitcnt lgkmcnt(6)
    v_mfma_f32_32x32x16_bf16 v[112:127], v[200:203], v[228:231], v[112:127]
    ds_read_b128 v[224:227], v34 offset:49152
    s_waitcnt vmcnt(4)
    s_waitcnt lgkmcnt(6)
    v_mfma_f32_32x32x16_bf16 v[96:111], v[204:207], v[240:243], v[96:111]
    ds_read_b128 v[228:231], v34 offset:53248
    s_waitcnt lgkmcnt(6)
    v_mfma_f32_32x32x16_bf16 v[112:127], v[204:207], v[244:247], v[112:127]
    ds_read_b128 v[240:243], v35 offset:49152
    s_waitcnt vmcnt(3)
    s_waitcnt lgkmcnt(6)
    v_mfma_f32_32x32x16_bf16 v[96:111], v[208:211], v[232:235], v[96:111]
    ds_read_b128 v[244:247], v35 offset:53248
    s_waitcnt lgkmcnt(6)
    v_mfma_f32_32x32x16_bf16 v[112:127], v[208:211], v[236:239], v[112:127]
    ds_read_b128 v[232:235], v32 offset:24576
    s_waitcnt vmcnt(2)
    s_waitcnt lgkmcnt(6)
    v_mfma_f32_32x32x16_bf16 v[96:111], v[212:215], v[248:251], v[96:111]
    ds_read_b128 v[236:239], v32 offset:28672
    s_waitcnt lgkmcnt(6)
    v_mfma_f32_32x32x16_bf16 v[112:127], v[212:215], v[252:255], v[112:127]
    ds_read_b128 v[248:251], v33 offset:24576
    s_waitcnt vmcnt(1)
    s_waitcnt lgkmcnt(6)
    v_mfma_f32_32x32x16_bf16 v[96:111], v[216:219], v[224:227], v[96:111]
    ds_read_b128 v[252:255], v33 offset:28672
    s_waitcnt lgkmcnt(6)
    v_mfma_f32_32x32x16_bf16 v[112:127], v[216:219], v[228:231], v[112:127]
    ds_read_b128 v[224:227], v34 offset:24576
    s_waitcnt vmcnt(0)
    s_waitcnt lgkmcnt(6)
    v_mfma_f32_32x32x16_bf16 v[96:111], v[220:223], v[240:243], v[96:111]
    ds_read_b128 v[228:231], v34 offset:28672
    s_waitcnt lgkmcnt(6)
    v_mfma_f32_32x32x16_bf16 v[112:127], v[220:223], v[244:247], v[112:127]
    ds_read_b128 v[240:243], v35 offset:24576
    s_waitcnt lgkmcnt(6)
    v_mfma_f32_32x32x16_bf16 v[128:143], v[176:179], v[232:235], v[128:143]
    ds_read_b128 v[244:247], v35 offset:28672
    s_waitcnt lgkmcnt(6)
    v_mfma_f32_32x32x16_bf16 v[144:159], v[176:179], v[236:239], v[144:159]
    ds_read_b128 v[232:235], v32 offset:40960
    s_waitcnt lgkmcnt(6)
    v_mfma_f32_32x32x16_bf16 v[128:143], v[180:183], v[248:251], v[128:143]
    ds_read_b128 v[236:239], v32 offset:45056
    v_cvt_pk_bf16_f32 v96, v96, v97
    v_cvt_pk_bf16_f32 v97, v98, v99
    v_cvt_pk_bf16_f32 v98, v100, v101
    v_cvt_pk_bf16_f32 v99, v102, v103
    buffer_store_dwordx4 v[96:99], v28, s[92:95], s74 offen offset:0 sc1
    s_waitcnt lgkmcnt(6)
    v_mfma_f32_32x32x16_bf16 v[144:159], v[180:183], v[252:255], v[144:159]
    ds_read_b128 v[248:251], v33 offset:40960
    v_cvt_pk_bf16_f32 v100, v104, v105
    v_cvt_pk_bf16_f32 v101, v106, v107
    v_cvt_pk_bf16_f32 v102, v108, v109
    v_cvt_pk_bf16_f32 v103, v110, v111
    buffer_store_dwordx4 v[100:103], v28, s[92:95], s74 offen offset:1024 sc1
    s_waitcnt lgkmcnt(6)
    v_mfma_f32_32x32x16_bf16 v[128:143], v[184:187], v[224:227], v[128:143]
    ds_read_b128 v[252:255], v33 offset:45056
    v_cvt_pk_bf16_f32 v104, v112, v113
    v_cvt_pk_bf16_f32 v105, v114, v115
    v_cvt_pk_bf16_f32 v106, v116, v117
    v_cvt_pk_bf16_f32 v107, v118, v119
    buffer_store_dwordx4 v[104:107], v28, s[92:95], s74 offen offset:2048 sc1
    s_waitcnt lgkmcnt(6)
    v_mfma_f32_32x32x16_bf16 v[144:159], v[184:187], v[228:231], v[144:159]
    ds_read_b128 v[224:227], v34 offset:40960
    v_cvt_pk_bf16_f32 v108, v120, v121
    v_cvt_pk_bf16_f32 v109, v122, v123
    v_cvt_pk_bf16_f32 v110, v124, v125
    v_cvt_pk_bf16_f32 v111, v126, v127
    buffer_store_dwordx4 v[108:111], v28, s[92:95], s74 offen offset:3072 sc1
    s_waitcnt lgkmcnt(6)
    v_mfma_f32_32x32x16_bf16 v[128:143], v[188:191], v[240:243], v[128:143]
    ds_read_b128 v[228:231], v34 offset:45056
    s_waitcnt lgkmcnt(6)
    v_mfma_f32_32x32x16_bf16 v[144:159], v[188:191], v[244:247], v[144:159]
    ds_read_b128 v[240:243], v35 offset:40960
    s_waitcnt lgkmcnt(6)
    v_mfma_f32_32x32x16_bf16 v[128:143], v[192:195], v[232:235], v[128:143]
    ds_read_b128 v[244:247], v35 offset:45056
    s_waitcnt lgkmcnt(6)
    v_mfma_f32_32x32x16_bf16 v[144:159], v[192:195], v[236:239], v[144:159]
    ds_read_b128 v[232:235], v32 offset:57344
    s_waitcnt lgkmcnt(6)
    v_mfma_f32_32x32x16_bf16 v[128:143], v[196:199], v[248:251], v[128:143]
    ds_read_b128 v[236:239], v32 offset:61440
    s_waitcnt lgkmcnt(6)
    v_mfma_f32_32x32x16_bf16 v[144:159], v[196:199], v[252:255], v[144:159]
    ds_read_b128 v[248:251], v33 offset:57344
    s_waitcnt lgkmcnt(6)
    v_mfma_f32_32x32x16_bf16 v[128:143], v[200:203], v[224:227], v[128:143]
    ds_read_b128 v[252:255], v33 offset:61440
    s_waitcnt lgkmcnt(6)
    v_mfma_f32_32x32x16_bf16 v[144:159], v[200:203], v[228:231], v[144:159]
    ds_read_b128 v[224:227], v34 offset:57344
    s_waitcnt lgkmcnt(6)
    v_mfma_f32_32x32x16_bf16 v[128:143], v[204:207], v[240:243], v[128:143]
    ds_read_b128 v[228:231], v34 offset:61440
    s_waitcnt lgkmcnt(6)
    v_mfma_f32_32x32x16_bf16 v[144:159], v[204:207], v[244:247], v[144:159]
    ds_read_b128 v[240:243], v35 offset:57344
    s_waitcnt lgkmcnt(6)
    v_mfma_f32_32x32x16_bf16 v[128:143], v[208:211], v[232:235], v[128:143]
    ds_read_b128 v[244:247], v35 offset:61440
    s_waitcnt lgkmcnt(6)
    v_mfma_f32_32x32x16_bf16 v[144:159], v[208:211], v[236:239], v[144:159]
    s_waitcnt lgkmcnt(5)
    v_mfma_f32_32x32x16_bf16 v[128:143], v[212:215], v[248:251], v[128:143]
    s_waitcnt lgkmcnt(4)
    v_mfma_f32_32x32x16_bf16 v[144:159], v[212:215], v[252:255], v[144:159]
    s_waitcnt lgkmcnt(3)
    v_mfma_f32_32x32x16_bf16 v[128:143], v[216:219], v[224:227], v[128:143]
    s_waitcnt lgkmcnt(2)
    v_mfma_f32_32x32x16_bf16 v[144:159], v[216:219], v[228:231], v[144:159]
    s_waitcnt lgkmcnt(1)
    v_mfma_f32_32x32x16_bf16 v[128:143], v[220:223], v[240:243], v[128:143]
    s_waitcnt lgkmcnt(0)
    v_mfma_f32_32x32x16_bf16 v[144:159], v[220:223], v[244:247], v[144:159]
    s_mov_b32 s12, 0xffff0000
    ds_read_b128 v[160:163], v21 offset:0
    ds_read_b128 v[164:167], v21 offset:16
    ds_read_b128 v[168:171], v21 offset:8704
    ds_read_b128 v[172:175], v21 offset:8720
    v_lshlrev_b32 v192, 16, v36
    v_and_b32 v176, s12, v36
    v_lshlrev_b32 v193, 16, v37
    v_and_b32 v177, s12, v37
    v_lshlrev_b32 v194, 16, v38
    v_and_b32 v178, s12, v38
    v_lshlrev_b32 v195, 16, v39
    v_and_b32 v179, s12, v39
    v_lshlrev_b32 v196, 16, v40
    v_and_b32 v180, s12, v40
    v_lshlrev_b32 v197, 16, v41
    v_and_b32 v181, s12, v41
    v_lshlrev_b32 v198, 16, v42
    v_and_b32 v182, s12, v42
    v_lshlrev_b32 v199, 16, v43
    v_and_b32 v183, s12, v43
    v_lshlrev_b32 v200, 16, v44
    v_and_b32 v184, s12, v44
    v_lshlrev_b32 v201, 16, v45
    v_and_b32 v185, s12, v45
    v_lshlrev_b32 v202, 16, v46
    v_and_b32 v186, s12, v46
    v_lshlrev_b32 v203, 16, v47
    v_and_b32 v187, s12, v47
    v_lshlrev_b32 v204, 16, v48
    v_and_b32 v188, s12, v48
    v_lshlrev_b32 v205, 16, v49
    v_and_b32 v189, s12, v49
    v_lshlrev_b32 v206, 16, v50
    v_and_b32 v190, s12, v50
    v_lshlrev_b32 v207, 16, v51
    v_and_b32 v191, s12, v51
    s_waitcnt lgkmcnt(0)
    s_lshl_b32 s90, s72, 6
    s_add_u32 s91, s90, 4096
    v_lshlrev_b32 v208, 16, v160
    v_lshlrev_b32 v214, 16, v161
    v_lshlrev_b32 v220, 16, v162
    v_lshlrev_b32 v226, 16, v163
    v_and_b32 v209, s12, v160
    v_and_b32 v215, s12, v161
    v_and_b32 v221, s12, v162
    v_and_b32 v227, s12, v163
    v_lshlrev_b32 v210, 16, v73
    v_lshlrev_b32 v216, 16, v74
    v_lshlrev_b32 v222, 16, v75
    v_lshlrev_b32 v228, 16, v76
    v_and_b32 v211, s12, v73
    v_and_b32 v217, s12, v74
    v_and_b32 v223, s12, v75
    v_and_b32 v229, s12, v76
    v_mul_f32 v208, v210, v208
    v_mul_f32 v214, v216, v214
    v_mul_f32 v220, v222, v220
    v_mul_f32 v226, v228, v226
    v_mul_f32 v209, v211, v209
    v_mul_f32 v215, v217, v215
    v_mul_f32 v221, v223, v221
    v_mul_f32 v227, v229, v227
    v_lshlrev_b32 v210, 16, v89
    v_lshlrev_b32 v216, 16, v90
    v_lshlrev_b32 v222, 16, v91
    v_lshlrev_b32 v228, 16, v92
    v_and_b32 v211, s12, v89
    v_and_b32 v217, s12, v90
    v_and_b32 v223, s12, v91
    v_and_b32 v229, s12, v92
    v_cvt_pk_bf16_f32 v212, v208, v209
    v_cvt_pk_bf16_f32 v218, v214, v215
    v_cvt_pk_bf16_f32 v224, v220, v221
    v_cvt_pk_bf16_f32 v230, v226, v227
    v_add_f32 v128, v128, v210
    v_add_f32 v130, v130, v216
    v_add_f32 v132, v132, v222
    v_add_f32 v134, v134, v228
    v_add_f32 v129, v129, v211
    v_add_f32 v131, v131, v217
    v_add_f32 v133, v133, v223
    v_add_f32 v135, v135, v229
    v_lshlrev_b32 v208, 16, v212
    v_lshlrev_b32 v214, 16, v218
    v_lshlrev_b32 v220, 16, v224
    v_lshlrev_b32 v226, 16, v230
    v_and_b32 v209, s12, v212
    v_and_b32 v215, s12, v218
    v_and_b32 v221, s12, v224
    v_and_b32 v227, s12, v230
    v_mul_f32 v208, v208, v176
    v_mul_f32 v214, v214, v178
    v_mul_f32 v220, v220, v180
    v_mul_f32 v226, v226, v182
    v_mul_f32 v209, v209, v177
    v_mul_f32 v215, v215, v179
    v_mul_f32 v221, v221, v181
    v_mul_f32 v227, v227, v183
    v_cvt_pk_bf16_f32 v212, v208, v209
    v_cvt_pk_bf16_f32 v218, v214, v215
    v_cvt_pk_bf16_f32 v224, v220, v221
    v_cvt_pk_bf16_f32 v230, v226, v227
    v_lshlrev_b32 v208, 16, v212
    v_lshlrev_b32 v214, 16, v218
    v_lshlrev_b32 v220, 16, v224
    v_lshlrev_b32 v226, 16, v230
    v_and_b32 v209, s12, v212
    v_and_b32 v215, s12, v218
    v_and_b32 v221, s12, v224
    v_and_b32 v227, s12, v230
    v_fma_f32 v128, v128, v192, v208
    v_fma_f32 v130, v130, v194, v214
    v_fma_f32 v132, v132, v196, v220
    v_fma_f32 v134, v134, v198, v226
    v_fma_f32 v129, v129, v193, v209
    v_fma_f32 v131, v131, v195, v215
    v_fma_f32 v133, v133, v197, v221
    v_fma_f32 v135, v135, v199, v227
    v_lshlrev_b32 v208, 16, v164
    v_lshlrev_b32 v214, 16, v165
    v_lshlrev_b32 v220, 16, v166
    v_lshlrev_b32 v226, 16, v167
    v_and_b32 v209, s12, v164
    v_and_b32 v215, s12, v165
    v_and_b32 v221, s12, v166
    v_and_b32 v227, s12, v167
    v_lshlrev_b32 v210, 16, v77
    v_lshlrev_b32 v216, 16, v78
    v_lshlrev_b32 v222, 16, v79
    v_lshlrev_b32 v228, 16, v80
    v_and_b32 v211, s12, v77
    v_and_b32 v217, s12, v78
    v_and_b32 v223, s12, v79
    v_and_b32 v229, s12, v80
    v_mul_f32 v208, v210, v208
    v_mul_f32 v214, v216, v214
    v_mul_f32 v220, v222, v220
    v_mul_f32 v226, v228, v226
    v_mul_f32 v209, v211, v209
    v_mul_f32 v215, v217, v215
    v_mul_f32 v221, v223, v221
    v_mul_f32 v227, v229, v227
    v_lshlrev_b32 v210, 16, v93
    v_lshlrev_b32 v216, 16, v94
    v_lshlrev_b32 v222, 16, v95
    v_lshlrev_b32 v228, 16, v54
    v_and_b32 v211, s12, v93
    v_and_b32 v217, s12, v94
    v_and_b32 v223, s12, v95
    v_and_b32 v229, s12, v54
    v_cvt_pk_bf16_f32 v212, v208, v209
    v_cvt_pk_bf16_f32 v218, v214, v215
    v_cvt_pk_bf16_f32 v224, v220, v221
    v_cvt_pk_bf16_f32 v230, v226, v227
    v_add_f32 v136, v136, v210
    v_add_f32 v138, v138, v216
    v_add_f32 v140, v140, v222
    v_add_f32 v142, v142, v228
    v_add_f32 v137, v137, v211
    v_add_f32 v139, v139, v217
    v_add_f32 v141, v141, v223
    v_add_f32 v143, v143, v229
    v_lshlrev_b32 v208, 16, v212
    v_lshlrev_b32 v214, 16, v218
    v_lshlrev_b32 v220, 16, v224
    v_lshlrev_b32 v226, 16, v230
    v_and_b32 v209, s12, v212
    v_and_b32 v215, s12, v218
    v_and_b32 v221, s12, v224
    v_and_b32 v227, s12, v230
    v_mul_f32 v208, v208, v184
    v_mul_f32 v214, v214, v186
    v_mul_f32 v220, v220, v188
    v_mul_f32 v226, v226, v190
    v_mul_f32 v209, v209, v185
    v_mul_f32 v215, v215, v187
    v_mul_f32 v221, v221, v189
    v_mul_f32 v227, v227, v191
    v_cvt_pk_bf16_f32 v212, v208, v209
    v_cvt_pk_bf16_f32 v218, v214, v215
    v_cvt_pk_bf16_f32 v224, v220, v221
    v_cvt_pk_bf16_f32 v230, v226, v227
    v_lshlrev_b32 v208, 16, v212
    v_lshlrev_b32 v214, 16, v218
    v_lshlrev_b32 v220, 16, v224
    v_lshlrev_b32 v226, 16, v230
    v_and_b32 v209, s12, v212
    v_and_b32 v215, s12, v218
    v_and_b32 v221, s12, v224
    v_and_b32 v227, s12, v230
    v_fma_f32 v136, v136, v200, v208
    v_fma_f32 v138, v138, v202, v214
    v_fma_f32 v140, v140, v204, v220
    v_fma_f32 v142, v142, v206, v226
    v_fma_f32 v137, v137, v201, v209
    v_fma_f32 v139, v139, v203, v215
    v_fma_f32 v141, v141, v205, v221
    v_fma_f32 v143, v143, v207, v227
    buffer_load_dwordx4 v[96:99], v28, s[92:95], s90 offen offset:0 sc1
    buffer_load_dwordx4 v[100:103], v28, s[92:95], s90 offen offset:1024 sc1
    buffer_load_dwordx4 v[104:107], v28, s[92:95], s90 offen offset:2048 sc1
    buffer_load_dwordx4 v[108:111], v28, s[92:95], s90 offen offset:3072 sc1
    v_lshlrev_b32 v208, 16, v168
    v_lshlrev_b32 v214, 16, v169
    v_lshlrev_b32 v220, 16, v170
    v_lshlrev_b32 v226, 16, v171
    v_and_b32 v209, s12, v168
    v_and_b32 v215, s12, v169
    v_and_b32 v221, s12, v170
    v_and_b32 v227, s12, v171
    v_lshlrev_b32 v210, 16, v81
    v_lshlrev_b32 v216, 16, v82
    v_lshlrev_b32 v222, 16, v83
    v_lshlrev_b32 v228, 16, v84
    v_and_b32 v211, s12, v81
    v_and_b32 v217, s12, v82
    v_and_b32 v223, s12, v83
    v_and_b32 v229, s12, v84
    v_mul_f32 v208, v210, v208
    v_mul_f32 v214, v216, v214
    v_mul_f32 v220, v222, v220
    v_mul_f32 v226, v228, v226
    v_mul_f32 v209, v211, v209
    v_mul_f32 v215, v217, v215
    v_mul_f32 v221, v223, v221
    v_mul_f32 v227, v229, v227
    v_lshlrev_b32 v210, 16, v55
    v_lshlrev_b32 v216, 16, v56
    v_lshlrev_b32 v222, 16, v57
    v_lshlrev_b32 v228, 16, v58
    v_and_b32 v211, s12, v55
    v_and_b32 v217, s12, v56
    v_and_b32 v223, s12, v57
    v_and_b32 v229, s12, v58
    v_cvt_pk_bf16_f32 v212, v208, v209
    v_cvt_pk_bf16_f32 v218, v214, v215
    v_cvt_pk_bf16_f32 v224, v220, v221
    v_cvt_pk_bf16_f32 v230, v226, v227
    v_add_f32 v144, v144, v210
    v_add_f32 v146, v146, v216
    v_add_f32 v148, v148, v222
    v_add_f32 v150, v150, v228
    v_add_f32 v145, v145, v211
    v_add_f32 v147, v147, v217
    v_add_f32 v149, v149, v223
    v_add_f32 v151, v151, v229
    v_lshlrev_b32 v208, 16, v212
    v_lshlrev_b32 v214, 16, v218
    v_lshlrev_b32 v220, 16, v224
    v_lshlrev_b32 v226, 16, v230
    v_and_b32 v209, s12, v212
    v_and_b32 v215, s12, v218
    v_and_b32 v221, s12, v224
    v_and_b32 v227, s12, v230
    v_mul_f32 v208, v208, v176
    v_mul_f32 v214, v214, v178
    v_mul_f32 v220, v220, v180
    v_mul_f32 v226, v226, v182
    v_mul_f32 v209, v209, v177
    v_mul_f32 v215, v215, v179
    v_mul_f32 v221, v221, v181
    v_mul_f32 v227, v227, v183
    v_cvt_pk_bf16_f32 v212, v208, v209
    v_cvt_pk_bf16_f32 v218, v214, v215
    v_cvt_pk_bf16_f32 v224, v220, v221
    v_cvt_pk_bf16_f32 v230, v226, v227
    v_lshlrev_b32 v208, 16, v212
    v_lshlrev_b32 v214, 16, v218
    v_lshlrev_b32 v220, 16, v224
    v_lshlrev_b32 v226, 16, v230
    v_and_b32 v209, s12, v212
    v_and_b32 v215, s12, v218
    v_and_b32 v221, s12, v224
    v_and_b32 v227, s12, v230
    v_fma_f32 v144, v144, v192, v208
    v_fma_f32 v146, v146, v194, v214
    v_fma_f32 v148, v148, v196, v220
    v_fma_f32 v150, v150, v198, v226
    v_fma_f32 v145, v145, v193, v209
    v_fma_f32 v147, v147, v195, v215
    v_fma_f32 v149, v149, v197, v221
    v_fma_f32 v151, v151, v199, v227
    v_lshlrev_b32 v208, 16, v172
    v_lshlrev_b32 v214, 16, v173
    v_lshlrev_b32 v220, 16, v174
    v_lshlrev_b32 v226, 16, v175
    v_and_b32 v209, s12, v172
    v_and_b32 v215, s12, v173
    v_and_b32 v221, s12, v174
    v_and_b32 v227, s12, v175
    v_lshlrev_b32 v210, 16, v85
    v_lshlrev_b32 v216, 16, v86
    v_lshlrev_b32 v222, 16, v87
    v_lshlrev_b32 v228, 16, v88
    v_and_b32 v211, s12, v85
    v_and_b32 v217, s12, v86
    v_and_b32 v223, s12, v87
    v_and_b32 v229, s12, v88
    v_mul_f32 v208, v210, v208
    v_mul_f32 v214, v216, v214
    v_mul_f32 v220, v222, v220
    v_mul_f32 v226, v228, v226
    v_mul_f32 v209, v211, v209
    v_mul_f32 v215, v217, v215
    v_mul_f32 v221, v223, v221
    v_mul_f32 v227, v229, v227
    v_lshlrev_b32 v210, 16, v59
    v_lshlrev_b32 v216, 16, v61
    v_lshlrev_b32 v222, 16, v5
    v_lshlrev_b32 v228, 16, v12
    v_and_b32 v211, s12, v59
    v_and_b32 v217, s12, v61
    v_and_b32 v223, s12, v5
    v_and_b32 v229, s12, v12
    v_cvt_pk_bf16_f32 v212, v208, v209
    v_cvt_pk_bf16_f32 v218, v214, v215
    v_cvt_pk_bf16_f32 v224, v220, v221
    v_cvt_pk_bf16_f32 v230, v226, v227
    v_add_f32 v152, v152, v210
    v_add_f32 v154, v154, v216
    v_add_f32 v156, v156, v222
    v_add_f32 v158, v158, v228
    v_add_f32 v153, v153, v211
    v_add_f32 v155, v155, v217
    v_add_f32 v157, v157, v223
    v_add_f32 v159, v159, v229
    v_lshlrev_b32 v208, 16, v212
    v_lshlrev_b32 v214, 16, v218
    v_lshlrev_b32 v220, 16, v224
    v_lshlrev_b32 v226, 16, v230
    v_and_b32 v209, s12, v212
    v_and_b32 v215, s12, v218
    v_and_b32 v221, s12, v224
    v_and_b32 v227, s12, v230
    v_mul_f32 v208, v208, v184
    v_mul_f32 v214, v214, v186
    v_mul_f32 v220, v220, v188
    v_mul_f32 v226, v226, v190
    v_mul_f32 v209, v209, v185
    v_mul_f32 v215, v215, v187
    v_mul_f32 v221, v221, v189
    v_mul_f32 v227, v227, v191
    v_cvt_pk_bf16_f32 v212, v208, v209
    v_cvt_pk_bf16_f32 v218, v214, v215
    v_cvt_pk_bf16_f32 v224, v220, v221
    v_cvt_pk_bf16_f32 v230, v226, v227
    v_lshlrev_b32 v208, 16, v212
    v_lshlrev_b32 v214, 16, v218
    v_lshlrev_b32 v220, 16, v224
    v_lshlrev_b32 v226, 16, v230
    v_and_b32 v209, s12, v212
    v_and_b32 v215, s12, v218
    v_and_b32 v221, s12, v224
    v_and_b32 v227, s12, v230
    v_fma_f32 v152, v152, v200, v208
    v_fma_f32 v154, v154, v202, v214
    v_fma_f32 v156, v156, v204, v220
    v_fma_f32 v158, v158, v206, v226
    v_fma_f32 v153, v153, v201, v209
    v_fma_f32 v155, v155, v203, v215
    v_fma_f32 v157, v157, v205, v221
    v_fma_f32 v159, v159, v207, v227
    s_mov_b32 s89, 65536
c_rc:
    s_waitcnt vmcnt(0)
    v_max3_u32 v19, v96, v97, v98
    v_max3_u32 v19, v19, v99, v100
    v_max3_u32 v19, v19, v101, v102
    v_max3_u32 v19, v19, v103, v104
    v_max3_u32 v19, v19, v105, v106
    v_max3_u32 v19, v19, v107, v108
    v_max3_u32 v19, v19, v109, v110
    v_max_u32 v19, v19, v111
    v_cmp_eq_u32 vcc, -1, v19
    s_nop 1
    s_cmp_eq_u64 vcc, 0
    s_cbranch_scc1 c_rcok
    s_sub_u32 s89, s89, 1
    s_cbranch_scc1 c_rcok
    buffer_load_dwordx4 v[96:99], v28, s[92:95], s90 offen offset:0 sc1
    buffer_load_dwordx4 v[100:103], v28, s[92:95], s90 offen offset:1024 sc1
    buffer_load_dwordx4 v[104:107], v28, s[92:95], s90 offen offset:2048 sc1
    buffer_load_dwordx4 v[108:111], v28, s[92:95], s90 offen offset:3072 sc1
    s_branch c_rc
c_rcok:
    v_lshlrev_b32 v208, 16, v96
    v_fma_f32 v128, v208, v192, v128
    buffer_store_dword v128, v26, s[76:79], s80 offen offset:0 nt
    v_and_b32 v209, s12, v96
    v_fma_f32 v129, v209, v193, v129
    buffer_store_dword v129, v26, s[76:79], s81 offen offset:0 nt
    v_lshlrev_b32 v210, 16, v97
    v_fma_f32 v130, v210, v194, v130
    buffer_store_dword v130, v26, s[76:79], s82 offen offset:0 nt
    v_and_b32 v211, s12, v97
    v_fma_f32 v131, v211, v195, v131
    buffer_store_dword v131, v26, s[76:79], s83 offen offset:0 nt
    v_lshlrev_b32 v208, 16, v98
    v_fma_f32 v132, v208, v196, v132
    buffer_store_dword v132, v26, s[76:79], s84 offen offset:0 nt
    v_and_b32 v209, s12, v98
    v_fma_f32 v133, v209, v197, v133
    buffer_store_dword v133, v26, s[76:79], s85 offen offset:0 nt
    v_lshlrev_b32 v210, 16, v99
    v_fma_f32 v134, v210, v198, v134
    buffer_store_dword v134, v26, s[76:79], s86 offen offset:0 nt
    v_and_b32 v211, s12, v99
    v_fma_f32 v135, v211, v199, v135
    buffer_store_dword v135, v26, s[76:79], s87 offen offset:0 nt
    v_lshlrev_b32 v208, 16, v100
    v_fma_f32 v136, v208, v200, v136
    buffer_store_dword v136, v27, s[76:79], s80 offen offset:0 nt
    v_and_b32 v209, s12, v100
    v_fma_f32 v137, v209, v201, v137
    buffer_store_dword v137, v27, s[76:79], s81 offen offset:0 nt
    v_lshlrev_b32 v210, 16, v101
    v_fma_f32 v138, v210, v202, v138
    buffer_store_dword v138, v27, s[76:79], s82 offen offset:0 nt
    v_and_b32 v211, s12, v101
    v_fma_f32 v139, v211, v203, v139
    buffer_store_dword v139, v27, s[76:79], s83 offen offset:0 nt
    v_lshlrev_b32 v208, 16, v102
    v_fma_f32 v140, v208, v204, v140
    buffer_store_dword v140, v27, s[76:79], s84 offen offset:0 nt
    v_and_b32 v209, s12, v102
    v_fma_f32 v141, v209, v205, v141
    buffer_store_dword v141, v27, s[76:79], s85 offen offset:0 nt
    v_lshlrev_b32 v210, 16, v103
    v_fma_f32 v142, v210, v206, v142
    buffer_store_dword v142, v27, s[76:79], s86 offen offset:0 nt
    v_and_b32 v211, s12, v103
    v_fma_f32 v143, v211, v207, v143
    buffer_store_dword v143, v27, s[76:79], s87 offen offset:0 nt
    v_lshlrev_b32 v208, 16, v104
    v_fma_f32 v144, v208, v192, v144
    buffer_store_dword v144, v26, s[76:79], s80 offen offset:128 nt
    v_and_b32 v209, s12, v104
    v_fma_f32 v145, v209, v193, v145
    buffer_store_dword v145, v26, s[76:79], s81 offen offset:128 nt
    v_lshlrev_b32 v210, 16, v105
    v_fma_f32 v146, v210, v194, v146
    buffer_store_dword v146, v26, s[76:79], s82 offen offset:128 nt
    v_and_b32 v211, s12, v105
    v_fma_f32 v147, v211, v195, v147
    buffer_store_dword v147, v26, s[76:79], s83 offen offset:128 nt
    v_lshlrev_b32 v208, 16, v106
    v_fma_f32 v148, v208, v196, v148
    buffer_store_dword v148, v26, s[76:79], s84 offen offset:128 nt
    v_and_b32 v209, s12, v106
    v_fma_f32 v149, v209, v197, v149
    buffer_store_dword v149, v26, s[76:79], s85 offen offset:128 nt
    v_lshlrev_b32 v210, 16, v107
    v_fma_f32 v150, v210, v198, v150
    buffer_store_dword v150, v26, s[76:79], s86 offen offset:128 nt
    v_and_b32 v211, s12, v107
    v_fma_f32 v151, v211, v199, v151
    buffer_store_dword v151, v26, s[76:79], s87 offen offset:128 nt
    v_lshlrev_b32 v208, 16, v108
    v_fma_f32 v152, v208, v200, v152
    buffer_store_dword v152, v27, s[76:79], s80 offen offset:128 nt
    v_and_b32 v209, s12, v108
    v_fma_f32 v153, v209, v201, v153
    buffer_store_dword v153, v27, s[76:79], s81 offen offset:128 nt
    v_lshlrev_b32 v210, 16, v109
    v_fma_f32 v154, v210, v202, v154
    buffer_store_dword v154, v27, s[76:79], s82 offen offset:128 nt
    v_and_b32 v211, s12, v109
    v_fma_f32 v155, v211, v203, v155
    buffer_store_dword v155, v27, s[76:79], s83 offen offset:128 nt
    v_lshlrev_b32 v208, 16, v110
    v_fma_f32 v156, v208, v204, v156
    buffer_store_dword v156, v27, s[76:79], s84 offen offset:128 nt
    v_and_b32 v209, s12, v110
    v_fma_f32 v157, v209, v205, v157
    buffer_store_dword v157, v27, s[76:79], s85 offen offset:128 nt
    v_lshlrev_b32 v210, 16, v111
    v_fma_f32 v158, v210, v206, v158
    buffer_store_dword v158, v27, s[76:79], s86 offen offset:128 nt
    v_and_b32 v211, s12, v111
    v_fma_f32 v159, v211, v207, v159
    buffer_store_dword v159, v27, s[76:79], s87 offen offset:128 nt
    s_endpgm
c_pfs:
    s_mov_b32 s89, 65536
c_pfs_l:
    s_waitcnt vmcnt(0)
    buffer_load_dword v14, v29, s[68:71], 0 offen sc1
    s_waitcnt vmcnt(0)
    v_cmp_ne_u32 vcc, 1, v14
    s_nop 1
    s_cmp_eq_u64 vcc, 0
    s_cbranch_scc1 c_pfr
    s_sub_u32 s89, s89, 1
    s_cbranch_scc1 c_pfr
    s_branch c_pfs_l
c_n0_s:
    s_mov_b32 s89, 65536
c_n0_l:
    s_waitcnt vmcnt(0)
    buffer_load_dword v19, v22, s[68:71], 0 offen sc1
    s_waitcnt vmcnt(0)
    v_cmp_eq_u32 s[90:91], 1, v19
    s_nop 1
    s_and_b32 s88, s90, 0xc
    s_cmp_eq_u32 s88, 0xc
    s_cbranch_scc1 c_n0
    s_sub_u32 s89, s89, 1
    s_cbranch_scc1 c_n0
    s_branch c_n0_l
c_n1_s:
    s_mov_b32 s89, 65536
c_n1_l:
    s_waitcnt vmcnt(0)
    buffer_load_dword v19, v22, s[68:71], 0 offen sc1
    s_waitcnt vmcnt(0)
    v_cmp_eq_u32 s[90:91], 1, v19
    s_nop 1
    s_and_b32 s88, s90, 0x3c
    s_cmp_eq_u32 s88, 0x3c
    s_cbranch_scc1 c_n1
    s_sub_u32 s89, s89, 1
    s_cbranch_scc1 c_n1
    s_branch c_n1_l
c_n2_s:
    s_mov_b32 s89, 65536
c_n2_l:
    s_waitcnt vmcnt(0)
    buffer_load_dword v19, v22, s[68:71], 0 offen sc1
    s_waitcnt vmcnt(0)
    v_cmp_eq_u32 s[90:91], 1, v19
    s_nop 1
    s_and_b32 s88, s90, 0xfc
    s_cmp_eq_u32 s88, 0xfc
    s_cbranch_scc1 c_n2
    s_sub_u32 s89, s89, 1
    s_cbranch_scc1 c_n2
    s_branch c_n2_l
c_n3_s:
    s_mov_b32 s89, 65536
c_n3_l:
    s_waitcnt vmcnt(0)
    buffer_load_dword v19, v22, s[68:71], 0 offen sc1
    s_waitcnt vmcnt(0)
    v_cmp_eq_u32 s[90:91], 1, v19
    s_nop 1
    s_and_b32 s88, s90, 0x3fc
    s_cmp_eq_u32 s88, 0x3fc
    s_cbranch_scc1 c_n3
    s_sub_u32 s89, s89, 1
    s_cbranch_scc1 c_n3
    s_branch c_n3_l
c_n4_s:
    s_mov_b32 s89, 65536
c_n4_l:
    s_waitcnt vmcnt(0)
    buffer_load_dword v19, v22, s[68:71], 0 offen sc1
    s_waitcnt vmcnt(0)
    v_cmp_eq_u32 s[90:91], 1, v19
    s_nop 1
    s_and_b32 s88, s90, 0xffc
    s_cmp_eq_u32 s88, 0xffc
    s_cbranch_scc1 c_n4
    s_sub_u32 s89, s89, 1
    s_cbranch_scc1 c_n4
    s_branch c_n4_l
c_n5_s:
    s_mov_b32 s89, 65536
c_n5_l:
    s_waitcnt vmcnt(0)
    buffer_load_dword v19, v22, s[68:71], 0 offen sc1
    s_waitcnt vmcnt(0)
    v_cmp_eq_u32 s[90:91], 1, v19
    s_nop 1
    s_and_b32 s88, s90, 0x3ffc
    s_cmp_eq_u32 s88, 0x3ffc
    s_cbranch_scc1 c_n5
    s_sub_u32 s89, s89, 1
    s_cbranch_scc1 c_n5
    s_branch c_n5_l
c_n6_s:
    s_mov_b32 s89, 65536
c_n6_l:
    s_waitcnt vmcnt(0)
    buffer_load_dword v19, v22, s[68:71], 0 offen sc1
    s_waitcnt vmcnt(0)
    v_cmp_eq_u32 s[90:91], 1, v19
    s_nop 1
    s_and_b32 s88, s90, 0xfffc
    s_cmp_eq_u32 s88, 0xfffc
    s_cbranch_scc1 c_n6
    s_sub_u32 s89, s89, 1
    s_cbranch_scc1 c_n6
    s_branch c_n6_l
L_end:
    s_endpgm
.section .rodata,"a"
.p2align 6
.amdhsa_kernel gated_mix__ssm_conv_s5__ssm_conv_h3__prompt_kernel
  .amdhsa_next_free_vgpr 256
  .amdhsa_next_free_sgpr 102
  .amdhsa_accum_offset 256
  .amdhsa_group_segment_fixed_size 0
  .amdhsa_kernarg_size 152
  .amdhsa_user_sgpr_count 2
  .amdhsa_user_sgpr_kernarg_segment_ptr 1
  .amdhsa_system_sgpr_workgroup_id_x 1
  .amdhsa_float_denorm_mode_32 3
.end_amdhsa_kernel
```
